```python
import torch

def _softmax(x, axis=-1):
    return torch.softmax(x, dim=axis)
def _gelu(x):
    return torch.nn.functional.gelu(x, approximate="tanh")
def _silu(x):
    return torch.nn.functional.silu(x)
def _sigmoid(x):
    return torch.sigmoid(x)
def _layernorm(x, axis=-1, eps=1e-5):
    m = x.mean(dim=axis, keepdim=True)
    v = x.var(dim=axis, keepdim=True, unbiased=False)
    return (x - m) / torch.sqrt(v + eps)
def _scatter_add(tgt, idx, src, axis=0):
    return tgt.clone().index_add_(axis, idx, src)
def _segment_sum(src, seg, n):
    out = torch.zeros((n,) + src.shape[1:], dtype=src.dtype)
    return out.index_add_(0, seg, src)
def _pad(x, pw):
    flat = tuple(v for pair in reversed(pw) for v in pair)
    return torch.nn.functional.pad(x, flat)

kernel_name = 'recurrent_scan__mha_block_cached__mixer_s_mlp__prompt'

def setup_inputs():

    _w = (lambda a: (lambda t: t.to(torch.bfloat16) if t.is_floating_point() else t)(torch.as_tensor(a)))
    def _A_setup():
        B, Sq, D = 1, 2048, 640
        H, Sk, Dh = 32, 2048, 192
        return {
            "x": _w((lambda *s: torch.randn(*s, dtype=torch.bfloat16) * 0.05)(B, Sq, D)),
            "k_cache": _w((lambda *s: torch.randn(*s, dtype=torch.bfloat16) * 0.8)(B, H, Sk, Dh)),
            "v_cache": _w((lambda *s: torch.randn(*s, dtype=torch.bfloat16) * 0.8)(B, H, Sk, Dh)),
            "wq": _w((lambda *s: torch.randn(*s, dtype=torch.bfloat16) * 0.8)(D, H * Dh) * (D ** -0.5)),
            "wo": _w((lambda *s: torch.randn(*s, dtype=torch.bfloat16) * 0.8)(H * Dh, D) * ((H * Dh) ** -0.5)),
        }
    _A_in = _A_setup()

    def _B_setup():
        B, S, D, F = 1, 2048, 640, 1536
        return {
            "x":  _w((lambda *s: torch.randn(*s, dtype=torch.bfloat16) * 0.05)(B, S, D)),
            "w1": _w((lambda *s: torch.randn(*s, dtype=torch.bfloat16) * 3.2)(D, D) * (D ** -0.5)),
            "w2": _w((lambda *s: torch.randn(*s, dtype=torch.bfloat16) * 3.2)(D, D) * (D ** -0.5)),
            "w3": _w((lambda *s: torch.randn(*s, dtype=torch.bfloat16) * 3.2)(D, F) * (D ** -0.5)),
            "w4": _w((lambda *s: torch.randn(*s, dtype=torch.bfloat16) * 3.2)(F, D) * (F ** -0.5)),
        }
    _B_in = _B_setup()

    return {
        "A_x": _A_in["x"],
        "A_k_cache": _A_in["k_cache"],
        "A_v_cache": _A_in["v_cache"],
        "A_wq": _A_in["wq"],
        "A_wo": _A_in["wo"],
        "B_x": _B_in["x"],
        "B_w1": _B_in["w1"],
        "B_w2": _B_in["w2"],
        "B_w3": _B_in["w3"],
        "B_w4": _B_in["w4"],
    }

def reference(A_x, A_k_cache, A_v_cache, A_wq, A_wo, B_x, B_w1, B_w2, B_w3, B_w4):
    def _A_ref(x, k_cache, v_cache, wq, wo):
        B, Sq, D = x.shape
        H, Dh = 32, 192
        q = (lambda x, *d: x.permute(*d))((x @ wq).reshape(B, Sq, H, Dh), 0, 2, 1, 3)
        scores = torch.einsum("bhqd,bhkd->bhqk", q, k_cache) * (Dh ** -0.5)
        p = _softmax(scores, axis=-1)
        o = torch.einsum("bhqk,bhkd->bhqd", p, v_cache)
        return (lambda x, *d: x.permute(*d))(o, 0, 2, 1, 3).reshape(B, Sq, H * Dh) @ wo

    def _B_ref(x, w1, w2, w3, w4):
        B, S, D = x.shape
        h = _gelu(_layernorm(x, axis=-1) @ w1)
        c = D // 4
        g0 = _pad(h[:, :, 0*c:1*c], ((0, 0), (1, 0), (0, 0)))[:, :S, :]
        g1 = _pad(h[:, :, 1*c:2*c], ((0, 0), (0, 1), (0, 0)))[:, 1:, :]
        g2 = _pad(h[:, :, 2*c:3*c], ((0, 0), (2, 0), (0, 0)))[:, :S, :]
        g3 = _pad(h[:, :, 3*c:   ], ((0, 0), (0, 2), (0, 0)))[:, 2:, :]
        hs = torch.concatenate([g0, g1, g2, g3], axis=-1) @ w2
        x1 = x + hs
        h2 = _gelu(_layernorm(x1, axis=-1) @ w3) @ w4
        return x1 + h2

    x = A_x
    xn = _layernorm(x, axis=-1)
    s = _A_ref(xn, A_k_cache, A_v_cache, A_wq, A_wo)
    g = _silu(_B_ref(xn, B_w1, B_w2, B_w3, B_w4))
    return x + s * g
```

```asm
; @launch grid=(256,1,1) block=(256,1,1) lds=163840
.amdgcn_target "amdgcn-amd-amdhsa--gfx950"
.text
.globl recurrent_scan__mha_block_cached__mixer_s_mlp__prompt_kernel
.p2align 8
.type recurrent_scan__mha_block_cached__mixer_s_mlp__prompt_kernel,@function
recurrent_scan__mha_block_cached__mixer_s_mlp__prompt_kernel:
 s_cmp_ge_u32 s2,256
 s_cbranch_scc1 recurrent_scan__mha_block_cached__mixer_s_mlp__prompt_kernel_end
 s_load_dwordx16 s[64:79],s[0:1],0
 s_load_dwordx8 s[80:87],s[0:1],64
 s_load_dwordx2 s[88:89],s[0:1],96
 v_lshrrev_b32 v14,6,v0
 v_and_b32 v0,63,v0
 v_readfirstlane_b32 s32,v14
 s_lshr_b32 s50,s2,3
 s_getpc_b64 s[36:37]
recurrent_scan__mha_block_cached__mixer_s_mlp__prompt_kernel_pc:
 s_lshl_b32 s48,s50,2
 s_add_u32 s48,s48,s32
 v_min_u32 v14,4,v0
 s_mul_i32 s44,s48,5
 v_add_u32 v14,s44,v14
 v_min_u32 v14,(recurrent_scan__mha_block_cached__mixer_s_mlp__prompt_kernel_last-recurrent_scan__mha_block_cached__mixer_s_mlp__prompt_kernel_pc)/128,v14
 v_lshlrev_b32 v14,7,v14
 global_load_dword v62,v14,s[36:37]
 s_and_b32 s52,s2,7
 s_bfe_u32 s53,s2,0x20003
 s_lshr_b32 s34,s2,5
 v_lshrrev_b32 v14,3,v0
 v_and_b32 v15,6,v14
 v_xor_b32 v15,v15,v0
 v_lshlrev_b32 v15,4,v15
 v_mul_u32_u24 v14,1152,v14
 v_add_u32 v8,v14,v15
 s_lshl_b32 s33,s52,2
 s_add_u32 s33,s33,s53
 s_lshr_b32 s40,s2,6
 s_lshl_b32 s39,s40,2
 s_add_u32 s39,s39,s53
 s_lshl_b32 s54,s52,1
 s_and_b32 s41,s53,1
 s_add_u32 s54,s54,s41
 s_lshl_b32 s54,s54,2
 s_add_u32 s54,s54,s32
 s_lshl_b32 s54,s54,1
 s_mul_i32 s55,s32,5120
 s_mul_i32 s35,s32,6144
 s_lshl_b32 s46,s32,13
 s_add_u32 s46,s46,98304
 s_mul_i32 s63,s40,5
 s_add_u32 s63,s63,1
 s_lshr_b32 s63,s63,1
 s_mov_b32 s61,s63
 s_bitcmp1_b32 s34,0
 s_cbranch_scc0 recurrent_scan__mha_block_cached__mixer_s_mlp__prompt_kernel_hA
 v_add_u32 v14,0,v0
 v_mul_u32_u24 v14,2731,v14
 v_lshrrev_b32 v14,16,v14
 v_and_b32 v15,6,v14
 v_xor_b32 v15,v15,v0
 v_lshlrev_b32 v132,4,v15
 v_and_b32 v15,4,v14
 v_mul_u32_u24 v15,12288,v15
 v_mul_u32_u24 v14,11904,v14
 v_add3_u32 v10,v14,v15,v132
 v_add_u32 v14,64,v0
 v_mul_u32_u24 v14,2731,v14
 v_lshrrev_b32 v14,16,v14
 v_and_b32 v15,6,v14
 v_xor_b32 v15,v15,v0
 v_lshlrev_b32 v133,4,v15
 v_and_b32 v15,4,v14
 v_mul_u32_u24 v15,12288,v15
 v_mul_u32_u24 v14,11904,v14
 v_add3_u32 v11,v14,v15,v133
 v_add_u32 v14,128,v0
 v_mul_u32_u24 v14,2731,v14
 v_lshrrev_b32 v14,16,v14
 v_and_b32 v15,6,v14
 v_xor_b32 v15,v15,v0
 v_lshlrev_b32 v134,4,v15
 v_and_b32 v15,4,v14
 v_mul_u32_u24 v15,12288,v15
 v_mul_u32_u24 v14,11904,v14
 v_add3_u32 v12,v14,v15,v134
 s_waitcnt lgkmcnt(0)
 s_lshl_b32 s44,s39,2
 s_add_u32 s44,s44,s32
 s_mul_i32 s44,s44,6400
 v_min_u32 v15,49,v0
 v_lshlrev_b32 v15,7,v15
 v_add_u32 v15,s44,v15
 global_load_dword v61,v15,s[76:77]
 v_add_u32 v15,409600,v15
 global_load_dword v61,v15,s[76:77]
 s_lshr_b32 s41,s32,1
 s_lshl_b32 s41,s41,3
 s_and_b32 s42,s32,1
 s_add_u32 s41,s41,s42
 s_mul_i32 s41,s41,49152
 s_mul_i32 s42,s33,384
 s_add_u32 s41,s41,s42
 s_add_u32 s20,s70,s41
 s_addc_u32 s21,s71,0
 s_sub_u32 s22,7864320,s41
 s_mov_b32 s23,0x20000
 s_lshl_b32 s41,s34,2
 s_add_u32 s41,s41,s32
 s_mul_i32 s41,s41,81920
 s_add_u32 s24,s64,s41
 s_addc_u32 s25,s65,0
 s_mov_b32 s26,81920
 s_mov_b32 s27,0x20000
 s_add_u32 m0,s35,24576
 s_mul_i32 s44,s63,786432
 buffer_load_dwordx4 v10,s[20:23],s44 offen lds
 s_add_u32 m0,s35,24576
 s_add_u32 s63,s63,1
 buffer_load_dwordx4 v11,s[20:23],s44 offen offset:1024 lds
 s_add_u32 m0,s35,24576
 s_cmp_eq_u32 s63,10
 s_cselect_b32 s63,0,s63
 buffer_load_dwordx4 v12,s[20:23],s44 offen offset:2048 lds
 s_add_u32 m0,s35,27648
 s_add_u32 s44,s44,196608
 buffer_load_dwordx4 v10,s[20:23],s44 offen lds
 s_add_u32 m0,s35,27648
 s_nop 0
 buffer_load_dwordx4 v11,s[20:23],s44 offen offset:1024 lds
 s_add_u32 m0,s35,27648
 s_nop 0
 buffer_load_dwordx4 v12,s[20:23],s44 offen offset:2048 lds
 s_add_u32 m0,s46,32768
 s_lshl_b32 s45,s61,7
 buffer_load_dwordx4 v8,s[24:27],s45 offen lds
 s_add_u32 m0,s46,33792
 s_add_u32 s45,s45,10240
 s_add_u32 s61,s61,1
 buffer_load_dwordx4 v8,s[24:27],s45 offen lds
 s_add_u32 m0,s46,34816
 s_add_u32 s45,s45,10240
 s_cmp_eq_u32 s61,10
 s_cselect_b32 s61,0,s61
 buffer_load_dwordx4 v8,s[24:27],s45 offen lds
 s_add_u32 m0,s46,35840
 s_add_u32 s45,s45,10240
 buffer_load_dwordx4 v8,s[24:27],s45 offen lds
 s_add_u32 m0,s46,36864
 s_add_u32 s45,s45,10240
 buffer_load_dwordx4 v8,s[24:27],s45 offen lds
 s_add_u32 m0,s46,37888
 s_add_u32 s45,s45,10240
 buffer_load_dwordx4 v8,s[24:27],s45 offen lds
 s_add_u32 m0,s46,38912
 s_add_u32 s45,s45,10240
 buffer_load_dwordx4 v8,s[24:27],s45 offen lds
 s_add_u32 m0,s46,39936
 s_add_u32 s45,s45,10240
 buffer_load_dwordx4 v8,s[24:27],s45 offen lds
 s_add_u32 s92,s88,5701632
 s_addc_u32 s93,s89,0
 s_mov_b32 s94,16384
 s_mov_b32 s95,0x20000
 s_movk_i32 s41,8192
 buffer_load_dword v63,off,s[92:95],s41 sc1
 s_mov_b32 s28,s88
 s_mov_b32 s29,s89
 s_mov_b32 s30,60932096
 s_mov_b32 s31,0x20000
 s_lshl_b32 s90,s34,5
 s_add_u32 s90,s90,s33
 s_lshl_b32 s90,s90,2
 s_lshl_b32 s62,s52,4
 s_add_u32 s62,s62,s39
 s_lshl_b32 s62,s62,2
 v_and_b32 v14,15,v0
 v_and_b32 v16,6,v14
 v_lshrrev_b32 v17,4,v0
 v_xor_b32 v15,v16,v17
 v_lshlrev_b32 v15,4,v15
 v_lshlrev_b32 v18,7,v14
 v_lshlrev_b32 v13,3,v14
 v_add_u32 v14,v18,v15
 v_add_u32 v1,s46,v14
 v_xor_b32 v2,64,v1
 v_lshlrev_b32 v9,4,v0
 v_mov_b32 v14,0x3f803f80
 v_accvgpr_write_b32 a240,v14
 v_accvgpr_write_b32 a241,v14
 v_accvgpr_write_b32 a242,v14
 v_accvgpr_write_b32 a243,v14
 v_lshrrev_b32 v14,2,v0
 v_mul_u32_u24 v6,384,v14
 v_and_b32 v14,6,v14
 v_and_b32 v15,3,v0
 v_xor_b32 v14,v14,v15
 v_lshl_add_u32 v6,v14,4,v6
 v_add_u32 v6,24576,v6
 v_xor_b32 v7,64,v6
 v_accvgpr_write_b32 a244,0
 v_accvgpr_write_b32 a245,0
 v_accvgpr_write_b32 a246,0
 v_accvgpr_write_b32 a247,0
 v_accvgpr_write_b32 a248,0
 v_accvgpr_write_b32 a249,0
 v_accvgpr_write_b32 a250,0
 v_accvgpr_write_b32 a251,0
 v_accvgpr_write_b32 a252,0
 v_accvgpr_write_b32 a253,0
 v_accvgpr_write_b32 a254,0
 v_accvgpr_write_b32 a255,0
 s_add_u32 s41,s62,s32
 s_cmp_lt_u32 s41,480
 s_cselect_b32 s3,60932096,0
 s_cselect_b32 s6,39808,0
 s_cselect_b32 s41,s41,0
 s_mul_i32 s70,s41,6554
 s_lshr_b32 s70,s70,16
 s_mul_i32 s71,s70,10
 s_sub_u32 s71,s41,s71
 s_mul_i32 s41,s70,40960
 s_lshl_b32 s42,s71,7
 s_add_u32 s41,s41,s42
 s_add_u32 s4,s82,s41
 s_addc_u32 s5,s83,0
 s_lshl_b32 s71,s71,2
 s_mov_b32 s7,0x20000
 s_mov_b32 s8,s88
 s_mov_b32 s9,s89
 s_mov_b32 s10,s3
 s_mov_b32 s11,0x20000
 s_bitcmp0_b32 s40,0
 s_cselect_b32 s36,s32,7
 s_mov_b32 s74,s78
 s_mov_b32 s75,s79
 s_add_u32 m0,s35,49152
 s_mul_i32 s44,s63,786432
 buffer_load_dwordx4 v10,s[20:23],s44 offen lds
 s_add_u32 s63,s63,1
 buffer_load_dwordx4 v11,s[20:23],s44 offen offset:1024 lds
 s_cmp_eq_u32 s63,10
 s_cselect_b32 s63,0,s63
 buffer_load_dwordx4 v12,s[20:23],s44 offen offset:2048 lds
 s_waitcnt vmcnt(12)
 s_barrier
 s_add_u32 m0,s46,0
 s_lshl_b32 s45,s61,7
 buffer_load_dwordx4 v8,s[24:27],s45 offen lds
 ds_read_b64_tr_b16 v[16:17],v6
 ds_read_b64_tr_b16 v[18:19],v6 offset:6144
 ds_read_b64_tr_b16 v[20:21],v6 offset:12288
 ds_read_b64_tr_b16 v[22:23],v6 offset:18432
 s_add_u32 s45,s45,10240
 s_add_u32 m0,s46,1024
 s_add_u32 s61,s61,1
 buffer_load_dwordx4 v8,s[24:27],s45 offen lds
 ds_read_b64_tr_b16 v[24:25],v6 offset:8
 ds_read_b64_tr_b16 v[26:27],v6 offset:6152
 ds_read_b64_tr_b16 v[28:29],v6 offset:12296
 ds_read_b64_tr_b16 v[30:31],v6 offset:18440
 s_add_u32 s45,s45,10240
 s_cmp_eq_u32 s61,10
 s_cselect_b32 s61,0,s61
 s_add_u32 m0,s46,2048
 s_nop 0
 buffer_load_dwordx4 v8,s[24:27],s45 offen lds
 ds_read_b64_tr_b16 v[32:33],v7
 ds_read_b64_tr_b16 v[34:35],v7 offset:6144
 ds_read_b64_tr_b16 v[36:37],v7 offset:12288
 ds_read_b64_tr_b16 v[38:39],v7 offset:18432
 s_add_u32 m0,s35,52224
 s_add_u32 s44,s44,196608
 buffer_load_dwordx4 v10,s[20:23],s44 offen lds
 s_waitcnt vmcnt(8)
 ds_read_b128 a[0:3],v1 offset:32768
 ds_read_b128 a[16:19],v2 offset:32768
 ds_read_b128 a[4:7],v1 offset:34816
 s_add_u32 m0,s46,3072
 s_add_u32 s45,s45,10240
 buffer_load_dwordx4 v8,s[24:27],s45 offen lds
 ds_read_b128 a[20:23],v2 offset:34816
 ds_read_b128 a[8:11],v1 offset:36864
 ds_read_b128 a[24:27],v2 offset:36864
 ds_read_b128 a[12:15],v1 offset:38912
 s_add_u32 m0,s35,52224
 s_nop 0
 buffer_load_dwordx4 v11,s[20:23],s44 offen offset:1024 lds
 ds_read_b128 a[28:31],v2 offset:38912
 s_waitcnt vmcnt(9)
 v_readfirstlane_b32 s51,v63
 s_nop 0
 s_add_u32 m0,s46,4096
 s_add_u32 s45,s45,10240
 buffer_load_dwordx4 v8,s[24:27],s45 offen lds
 s_mul_i32 s51,s51,1664525
 s_add_u32 s51,s51,1013904223
 s_waitcnt lgkmcnt(0)
 v_mfma_f32_16x16x32_bf16 v[64:67],v[16:19],a[0:3],0
 ds_read_b64_tr_b16 v[40:41],v7 offset:8
 ds_read_b64_tr_b16 v[42:43],v7 offset:6152
 v_mfma_f32_16x16x32_bf16 v[64:67],v[20:23],a[16:19],v[64:67]
 s_add_u32 m0,s35,52224
 s_nop 0
 buffer_load_dwordx4 v12,s[20:23],s44 offen offset:2048 lds
 v_mfma_f32_16x16x32_bf16 v[68:71],v[20:23],a[20:23],0
 ds_read_b64_tr_b16 v[44:45],v7 offset:12296
 ds_read_b64_tr_b16 v[46:47],v7 offset:18440
 v_mfma_f32_16x16x32_bf16 v[68:71],v[16:19],a[4:7],v[68:71]
 s_add_u32 m0,s46,5120
 s_add_u32 s45,s45,10240
 buffer_load_dwordx4 v8,s[24:27],s45 offen lds
 v_mfma_f32_16x16x32_bf16 v[72:75],v[16:19],a[8:11],0
 ds_read_b64_tr_b16 v[48:49],v6 offset:128
 ds_read_b64_tr_b16 v[50:51],v6 offset:6272
 v_mfma_f32_16x16x32_bf16 v[72:75],v[20:23],a[24:27],v[72:75]
 s_add_u32 m0,s46,6144
 s_add_u32 s45,s45,10240
 buffer_load_dwordx4 v8,s[24:27],s45 offen lds
 v_mfma_f32_16x16x32_bf16 v[76:79],v[20:23],a[28:31],0
 ds_read_b64_tr_b16 v[52:53],v6 offset:12416
 ds_read_b64_tr_b16 v[54:55],v6 offset:18560
 v_mfma_f32_16x16x32_bf16 v[76:79],v[16:19],a[12:15],v[76:79]
 v_mfma_f32_16x16x32_bf16 v[80:83],v[24:27],a[0:3],0
 ds_read_b64_tr_b16 v[56:57],v6 offset:136
 ds_read_b64_tr_b16 v[58:59],v6 offset:6280
 v_mfma_f32_16x16x32_bf16 v[80:83],v[28:31],a[16:19],v[80:83]
 v_mfma_f32_16x16x32_bf16 v[84:87],v[28:31],a[20:23],0
 ds_read_b64_tr_b16 v[60:61],v6 offset:12424
 ds_read_b64_tr_b16 v[62:63],v6 offset:18568
 v_mfma_f32_16x16x32_bf16 v[84:87],v[24:27],a[4:7],v[84:87]
 s_add_u32 m0,s46,7168
 s_add_u32 s45,s45,10240
 buffer_load_dwordx4 v8,s[24:27],s45 offen lds
 v_mfma_f32_16x16x32_bf16 v[88:91],v[24:27],a[8:11],0
 v_mfma_f32_16x16x32_bf16 v[88:91],v[28:31],a[24:27],v[88:91]
 v_mfma_f32_16x16x32_bf16 v[92:95],v[28:31],a[28:31],0
 v_mfma_f32_16x16x32_bf16 v[92:95],v[24:27],a[12:15],v[92:95]
 v_mfma_f32_16x16x32_bf16 v[96:99],v[32:35],a[0:3],0
 v_mfma_f32_16x16x32_bf16 v[96:99],v[36:39],a[16:19],v[96:99]
 v_mfma_f32_16x16x32_bf16 v[100:103],v[36:39],a[20:23],0
 v_mfma_f32_16x16x32_bf16 v[100:103],v[32:35],a[4:7],v[100:103]
 v_mfma_f32_16x16x32_bf16 v[104:107],v[32:35],a[8:11],0
 v_mfma_f32_16x16x32_bf16 v[104:107],v[36:39],a[24:27],v[104:107]
 s_cmp_eq_u32 s32,0
 s_cbranch_scc0 Lc1
 v_mfma_f32_16x16x32_bf16 a[244:247],a[240:243],v[16:19],a[244:247]
 v_mfma_f32_16x16x32_bf16 a[244:247],a[240:243],v[20:23],a[244:247]
 v_mfma_f32_16x16x32_bf16 a[248:251],a[240:243],v[24:27],a[248:251]
 v_mfma_f32_16x16x32_bf16 a[248:251],a[240:243],v[28:31],a[248:251]
 v_mfma_f32_16x16x32_bf16 a[252:255],a[240:243],v[32:35],a[252:255]
 v_mfma_f32_16x16x32_bf16 a[252:255],a[240:243],v[36:39],a[252:255]
Lc1:
 v_mfma_f32_16x16x32_bf16 v[108:111],v[36:39],a[28:31],0
 v_mfma_f32_16x16x32_bf16 v[108:111],v[32:35],a[12:15],v[108:111]
 s_waitcnt lgkmcnt(0)
 v_mfma_f32_16x16x32_bf16 v[112:115],v[40:43],a[0:3],0
 ds_read_b64_tr_b16 v[16:17],v7 offset:128
 ds_read_b64_tr_b16 v[18:19],v7 offset:6272
 v_mfma_f32_16x16x32_bf16 v[112:115],v[44:47],a[16:19],v[112:115]
 v_mfma_f32_16x16x32_bf16 v[116:119],v[44:47],a[20:23],0
 ds_read_b64_tr_b16 v[20:21],v7 offset:12416
 ds_read_b64_tr_b16 v[22:23],v7 offset:18560
 v_mfma_f32_16x16x32_bf16 v[116:119],v[40:43],a[4:7],v[116:119]
 v_mfma_f32_16x16x32_bf16 v[120:123],v[40:43],a[8:11],0
 ds_read_b64_tr_b16 v[24:25],v7 offset:136
 ds_read_b64_tr_b16 v[26:27],v7 offset:6280
 v_mfma_f32_16x16x32_bf16 v[120:123],v[44:47],a[24:27],v[120:123]
 v_mfma_f32_16x16x32_bf16 v[124:127],v[44:47],a[28:31],0
 ds_read_b64_tr_b16 v[28:29],v7 offset:12424
 ds_read_b64_tr_b16 v[30:31],v7 offset:18568
 v_mfma_f32_16x16x32_bf16 v[124:127],v[40:43],a[12:15],v[124:127]
 v_mfma_f32_16x16x32_bf16 v[128:131],v[48:51],a[0:3],0
 ds_read_b64_tr_b16 v[32:33],v6 offset:256
 ds_read_b64_tr_b16 v[34:35],v6 offset:6400
 v_mfma_f32_16x16x32_bf16 v[128:131],v[52:55],a[16:19],v[128:131]
 v_mfma_f32_16x16x32_bf16 v[132:135],v[52:55],a[20:23],0
 ds_read_b64_tr_b16 v[36:37],v6 offset:12544
 ds_read_b64_tr_b16 v[38:39],v6 offset:18688
 v_mfma_f32_16x16x32_bf16 v[132:135],v[48:51],a[4:7],v[132:135]
 v_mfma_f32_16x16x32_bf16 v[136:139],v[48:51],a[8:11],0
 v_mfma_f32_16x16x32_bf16 v[136:139],v[52:55],a[24:27],v[136:139]
 v_mfma_f32_16x16x32_bf16 v[140:143],v[52:55],a[28:31],0
 v_mfma_f32_16x16x32_bf16 v[140:143],v[48:51],a[12:15],v[140:143]
 v_mfma_f32_16x16x32_bf16 v[144:147],v[56:59],a[0:3],0
 v_mfma_f32_16x16x32_bf16 v[144:147],v[60:63],a[16:19],v[144:147]
 v_mfma_f32_16x16x32_bf16 v[148:151],v[60:63],a[20:23],0
 v_mfma_f32_16x16x32_bf16 v[148:151],v[56:59],a[4:7],v[148:151]
 v_mfma_f32_16x16x32_bf16 v[152:155],v[56:59],a[8:11],0
 v_mfma_f32_16x16x32_bf16 v[152:155],v[60:63],a[24:27],v[152:155]
 s_cmp_eq_u32 s32,1
 s_cbranch_scc0 Lc2
 v_mfma_f32_16x16x32_bf16 a[244:247],a[240:243],v[40:43],a[244:247]
 v_mfma_f32_16x16x32_bf16 a[244:247],a[240:243],v[44:47],a[244:247]
 v_mfma_f32_16x16x32_bf16 a[248:251],a[240:243],v[48:51],a[248:251]
 v_mfma_f32_16x16x32_bf16 a[248:251],a[240:243],v[52:55],a[248:251]
 v_mfma_f32_16x16x32_bf16 a[252:255],a[240:243],v[56:59],a[252:255]
 v_mfma_f32_16x16x32_bf16 a[252:255],a[240:243],v[60:63],a[252:255]
Lc2:
 v_mfma_f32_16x16x32_bf16 v[156:159],v[60:63],a[28:31],0
 s_add_u32 m0,s35,73728
 s_mul_i32 s44,s63,786432
 buffer_load_dwordx4 v10,s[20:23],s44 offen lds
 v_mfma_f32_16x16x32_bf16 v[156:159],v[56:59],a[12:15],v[156:159]
 s_waitcnt lgkmcnt(0)
 v_mfma_f32_16x16x32_bf16 v[160:163],v[16:19],a[0:3],0
 ds_read_b64_tr_b16 v[40:41],v6 offset:264
 ds_read_b64_tr_b16 v[42:43],v6 offset:6408
 v_mfma_f32_16x16x32_bf16 v[160:163],v[20:23],a[16:19],v[160:163]
 v_mfma_f32_16x16x32_bf16 v[164:167],v[20:23],a[20:23],0
 ds_read_b64_tr_b16 v[44:45],v6 offset:12552
 ds_read_b64_tr_b16 v[46:47],v6 offset:18696
 v_mfma_f32_16x16x32_bf16 v[164:167],v[16:19],a[4:7],v[164:167]
 v_mfma_f32_16x16x32_bf16 v[168:171],v[16:19],a[8:11],0
 s_add_u32 s63,s63,1
 ds_read_b64_tr_b16 v[48:49],v7 offset:256
 ds_read_b64_tr_b16 v[50:51],v7 offset:6400
 v_mfma_f32_16x16x32_bf16 v[168:171],v[20:23],a[24:27],v[168:171]
 buffer_load_dwordx4 v11,s[20:23],s44 offen offset:1024 lds
 v_mfma_f32_16x16x32_bf16 v[172:175],v[20:23],a[28:31],0
 ds_read_b64_tr_b16 v[52:53],v7 offset:12544
 ds_read_b64_tr_b16 v[54:55],v7 offset:18688
 v_mfma_f32_16x16x32_bf16 v[172:175],v[16:19],a[12:15],v[172:175]
 v_mfma_f32_16x16x32_bf16 v[176:179],v[24:27],a[0:3],0
 ds_read_b64_tr_b16 v[56:57],v7 offset:264
 ds_read_b64_tr_b16 v[58:59],v7 offset:6408
 v_mfma_f32_16x16x32_bf16 v[176:179],v[28:31],a[16:19],v[176:179]
 v_mfma_f32_16x16x32_bf16 v[180:183],v[28:31],a[20:23],0
 ds_read_b64_tr_b16 v[60:61],v7 offset:12552
 ds_read_b64_tr_b16 v[62:63],v7 offset:18696
 v_mfma_f32_16x16x32_bf16 v[180:183],v[24:27],a[4:7],v[180:183]
 v_mfma_f32_16x16x32_bf16 v[184:187],v[24:27],a[8:11],0
 v_mfma_f32_16x16x32_bf16 v[184:187],v[28:31],a[24:27],v[184:187]
 s_cmp_eq_u32 s63,10
 s_cselect_b32 s63,0,s63
 v_mfma_f32_16x16x32_bf16 v[188:191],v[28:31],a[28:31],0
 buffer_load_dwordx4 v12,s[20:23],s44 offen offset:2048 lds
 v_mfma_f32_16x16x32_bf16 v[188:191],v[24:27],a[12:15],v[188:191]
 v_mfma_f32_16x16x32_bf16 v[192:195],v[32:35],a[0:3],0
 v_mfma_f32_16x16x32_bf16 v[192:195],v[36:39],a[16:19],v[192:195]
 v_mfma_f32_16x16x32_bf16 v[196:199],v[36:39],a[20:23],0
 v_mfma_f32_16x16x32_bf16 v[196:199],v[32:35],a[4:7],v[196:199]
 v_mfma_f32_16x16x32_bf16 v[200:203],v[32:35],a[8:11],0
 s_mov_b32 s50,24576
 v_add_u32 v6,s50,v6
 v_add_u32 v7,s50,v7
 v_mfma_f32_16x16x32_bf16 v[200:203],v[36:39],a[24:27],v[200:203]
 s_cmp_eq_u32 s32,2
 s_cbranch_scc0 Lc3
 v_mfma_f32_16x16x32_bf16 a[244:247],a[240:243],v[16:19],a[244:247]
 v_mfma_f32_16x16x32_bf16 a[244:247],a[240:243],v[20:23],a[244:247]
 v_mfma_f32_16x16x32_bf16 a[248:251],a[240:243],v[24:27],a[248:251]
 v_mfma_f32_16x16x32_bf16 a[248:251],a[240:243],v[28:31],a[248:251]
 v_mfma_f32_16x16x32_bf16 a[252:255],a[240:243],v[32:35],a[252:255]
 v_mfma_f32_16x16x32_bf16 a[252:255],a[240:243],v[36:39],a[252:255]
Lc3:
 v_mfma_f32_16x16x32_bf16 v[204:207],v[36:39],a[28:31],0
 s_add_u32 m0,s35,76800
 s_add_u32 s44,s44,196608
 buffer_load_dwordx4 v10,s[20:23],s44 offen lds
 v_mfma_f32_16x16x32_bf16 v[204:207],v[32:35],a[12:15],v[204:207]
 s_waitcnt vmcnt(7) lgkmcnt(0)
 s_barrier
 v_mfma_f32_16x16x32_bf16 v[208:211],v[40:43],a[0:3],0
 ds_read_b64_tr_b16 v[16:17],v6
 ds_read_b64_tr_b16 v[18:19],v6 offset:6144
 v_mfma_f32_16x16x32_bf16 v[208:211],v[44:47],a[16:19],v[208:211]
 buffer_load_dwordx4 v11,s[20:23],s44 offen offset:1024 lds
 v_mfma_f32_16x16x32_bf16 v[212:215],v[44:47],a[20:23],0
 ds_read_b64_tr_b16 v[20:21],v6 offset:12288
 ds_read_b64_tr_b16 v[22:23],v6 offset:18432
 v_mfma_f32_16x16x32_bf16 v[212:215],v[40:43],a[4:7],v[212:215]
 s_add_u32 m0,s46,32768
 s_lshl_b32 s45,s61,7
 buffer_load_dwordx4 v8,s[24:27],s45 offen lds
 v_mfma_f32_16x16x32_bf16 v[216:219],v[40:43],a[8:11],0
 ds_read_b64_tr_b16 v[24:25],v6 offset:8
 ds_read_b64_tr_b16 v[26:27],v6 offset:6152
 v_mfma_f32_16x16x32_bf16 v[216:219],v[44:47],a[24:27],v[216:219]
 v_mfma_f32_16x16x32_bf16 v[220:223],v[44:47],a[28:31],0
 ds_read_b64_tr_b16 v[28:29],v6 offset:12296
 ds_read_b64_tr_b16 v[30:31],v6 offset:18440
 v_mfma_f32_16x16x32_bf16 v[220:223],v[40:43],a[12:15],v[220:223]
 v_mfma_f32_16x16x32_bf16 v[224:227],v[48:51],a[0:3],0
 s_add_u32 s45,s45,10240
 ds_read_b64_tr_b16 v[32:33],v7
 ds_read_b64_tr_b16 v[34:35],v7 offset:6144
 v_mfma_f32_16x16x32_bf16 v[224:227],v[52:55],a[16:19],v[224:227]
 s_add_u32 m0,s46,33792
 s_add_u32 s61,s61,1
 buffer_load_dwordx4 v8,s[24:27],s45 offen lds
 v_mfma_f32_16x16x32_bf16 v[228:231],v[52:55],a[20:23],0
 ds_read_b64_tr_b16 v[36:37],v7 offset:12288
 ds_read_b64_tr_b16 v[38:39],v7 offset:18432
 v_mfma_f32_16x16x32_bf16 v[228:231],v[48:51],a[4:7],v[228:231]
 v_mfma_f32_16x16x32_bf16 v[232:235],v[48:51],a[8:11],0
 s_waitcnt vmcnt(7)
 ds_read_b128 a[32:35],v1
 ds_read_b128 a[48:51],v2
 v_mfma_f32_16x16x32_bf16 v[232:235],v[52:55],a[24:27],v[232:235]
 v_mfma_f32_16x16x32_bf16 v[236:239],v[52:55],a[28:31],0
 s_add_u32 s45,s45,10240
 ds_read_b128 a[36:39],v1 offset:2048
 ds_read_b128 a[52:55],v2 offset:2048
 v_mfma_f32_16x16x32_bf16 v[236:239],v[48:51],a[12:15],v[236:239]
 s_cmp_eq_u32 s61,10
 s_cselect_b32 s61,0,s61
 v_mfma_f32_16x16x32_bf16 v[240:243],v[56:59],a[0:3],0
 ds_read_b128 a[40:43],v1 offset:4096
 ds_read_b128 a[56:59],v2 offset:4096
 v_mfma_f32_16x16x32_bf16 v[240:243],v[60:63],a[16:19],v[240:243]
 s_add_u32 m0,s46,34816
 s_nop 0
 buffer_load_dwordx4 v8,s[24:27],s45 offen lds
 v_mfma_f32_16x16x32_bf16 v[244:247],v[60:63],a[20:23],0
 ds_read_b128 a[44:47],v1 offset:6144
 ds_read_b128 a[60:63],v2 offset:6144
 v_mfma_f32_16x16x32_bf16 v[244:247],v[56:59],a[4:7],v[244:247]
 v_mfma_f32_16x16x32_bf16 v[248:251],v[56:59],a[8:11],0
 v_mfma_f32_16x16x32_bf16 v[248:251],v[60:63],a[24:27],v[248:251]
 s_cmp_eq_u32 s32,3
 s_cbranch_scc0 Lc4
 v_mfma_f32_16x16x32_bf16 a[244:247],a[240:243],v[40:43],a[244:247]
 v_mfma_f32_16x16x32_bf16 a[244:247],a[240:243],v[44:47],a[244:247]
 v_mfma_f32_16x16x32_bf16 a[248:251],a[240:243],v[48:51],a[248:251]
 v_mfma_f32_16x16x32_bf16 a[248:251],a[240:243],v[52:55],a[248:251]
 v_mfma_f32_16x16x32_bf16 a[252:255],a[240:243],v[56:59],a[252:255]
 v_mfma_f32_16x16x32_bf16 a[252:255],a[240:243],v[60:63],a[252:255]
Lc4:
 v_mfma_f32_16x16x32_bf16 v[252:255],v[60:63],a[28:31],0
 s_add_u32 m0,s46,35840
 s_add_u32 s45,s45,10240
 buffer_load_dwordx4 v8,s[24:27],s45 offen lds
 s_add_u32 m0,s35,76800
 s_nop 0
 buffer_load_dwordx4 v12,s[20:23],s44 offen offset:2048 lds
 s_add_u32 m0,s35,0
 s_mul_i32 s44,s63,786432
 buffer_load_dwordx4 v10,s[20:23],s44 offen lds
 v_mfma_f32_16x16x32_bf16 v[252:255],v[56:59],a[12:15],v[252:255]
 s_waitcnt lgkmcnt(0)
 v_mfma_f32_16x16x32_bf16 v[64:67],v[16:19],a[32:35],v[64:67]
 ds_read_b64_tr_b16 v[40:41],v7 offset:8
 ds_read_b64_tr_b16 v[42:43],v7 offset:6152
 v_mfma_f32_16x16x32_bf16 v[64:67],v[20:23],a[48:51],v[64:67]
 s_add_u32 m0,s46,36864
 s_add_u32 s45,s45,10240
 buffer_load_dwordx4 v8,s[24:27],s45 offen lds
 s_mul_i32 s41,s33,786432
 s_add_u32 s41,s41,s35
 v_mfma_f32_16x16x32_bf16 v[68:71],v[20:23],a[52:55],v[68:71]
 ds_read_b64_tr_b16 v[44:45],v7 offset:12296
 ds_read_b64_tr_b16 v[46:47],v7 offset:18440
 v_mfma_f32_16x16x32_bf16 v[68:71],v[16:19],a[36:39],v[68:71]
 s_add_u32 s12,s66,s41
 s_addc_u32 s13,s67,0
 v_mfma_f32_16x16x32_bf16 v[72:75],v[16:19],a[40:43],v[72:75]
 ds_read_b64_tr_b16 v[48:49],v6 offset:128
 ds_read_b64_tr_b16 v[50:51],v6 offset:6272
 v_mfma_f32_16x16x32_bf16 v[72:75],v[20:23],a[56:59],v[72:75]
 s_sub_u32 s14,786432,s35
 s_mov_b32 s15,0x20000
 v_mfma_f32_16x16x32_bf16 v[76:79],v[20:23],a[60:63],v[76:79]
 s_add_u32 m0,s35,0
 s_add_u32 s63,s63,1
 buffer_load_dwordx4 v11,s[20:23],s44 offen offset:1024 lds
 ds_read_b64_tr_b16 v[52:53],v6 offset:12416
 ds_read_b64_tr_b16 v[54:55],v6 offset:18560
 v_mfma_f32_16x16x32_bf16 v[76:79],v[16:19],a[44:47],v[76:79]
 s_add_u32 s16,s68,s41
 s_addc_u32 s17,s69,0
 v_mfma_f32_16x16x32_bf16 v[80:83],v[24:27],a[32:35],v[80:83]
 ds_read_b64_tr_b16 v[56:57],v6 offset:136
 ds_read_b64_tr_b16 v[58:59],v6 offset:6280
 v_mfma_f32_16x16x32_bf16 v[80:83],v[28:31],a[48:51],v[80:83]
 s_sub_u32 s18,786432,s35
 s_mov_b32 s19,0x20000
 v_mfma_f32_16x16x32_bf16 v[84:87],v[28:31],a[52:55],v[84:87]
 ds_read_b64_tr_b16 v[60:61],v6 offset:12424
 ds_read_b64_tr_b16 v[62:63],v6 offset:18568
 v_mfma_f32_16x16x32_bf16 v[84:87],v[24:27],a[36:39],v[84:87]
 s_add_u32 m0,s46,37888
 s_add_u32 s45,s45,10240
 buffer_load_dwordx4 v8,s[24:27],s45 offen lds
 v_mfma_f32_16x16x32_bf16 v[88:91],v[24:27],a[40:43],v[88:91]
 s_cmp_eq_u32 s63,10
 s_cselect_b32 s63,0,s63
 s_add_u32 m0,s35,0
 s_nop 0
 buffer_load_dwordx4 v12,s[20:23],s44 offen offset:2048 lds
 v_mfma_f32_16x16x32_bf16 v[88:91],v[28:31],a[56:59],v[88:91]
 v_mfma_f32_16x16x32_bf16 v[92:95],v[28:31],a[60:63],v[92:95]
 v_mfma_f32_16x16x32_bf16 v[92:95],v[24:27],a[44:47],v[92:95]
 s_add_u32 m0,s46,38912
 s_add_u32 s45,s45,10240
 buffer_load_dwordx4 v8,s[24:27],s45 offen lds
 v_mfma_f32_16x16x32_bf16 v[96:99],v[32:35],a[32:35],v[96:99]
 v_mfma_f32_16x16x32_bf16 v[96:99],v[36:39],a[48:51],v[96:99]
 v_mfma_f32_16x16x32_bf16 v[100:103],v[36:39],a[52:55],v[100:103]
 v_mfma_f32_16x16x32_bf16 v[100:103],v[32:35],a[36:39],v[100:103]
 s_add_u32 m0,s35,3072
 s_add_u32 s44,s44,196608
 buffer_load_dwordx4 v10,s[20:23],s44 offen lds
 v_mfma_f32_16x16x32_bf16 v[104:107],v[32:35],a[40:43],v[104:107]
 v_mfma_f32_16x16x32_bf16 v[104:107],v[36:39],a[56:59],v[104:107]
 s_cmp_eq_u32 s32,0
 s_cbranch_scc0 Lc5
 v_mfma_f32_16x16x32_bf16 a[244:247],a[240:243],v[16:19],a[244:247]
 v_mfma_f32_16x16x32_bf16 a[244:247],a[240:243],v[20:23],a[244:247]
 v_mfma_f32_16x16x32_bf16 a[248:251],a[240:243],v[24:27],a[248:251]
 v_mfma_f32_16x16x32_bf16 a[248:251],a[240:243],v[28:31],a[248:251]
 v_mfma_f32_16x16x32_bf16 a[252:255],a[240:243],v[32:35],a[252:255]
 v_mfma_f32_16x16x32_bf16 a[252:255],a[240:243],v[36:39],a[252:255]
Lc5:
 v_mfma_f32_16x16x32_bf16 v[108:111],v[36:39],a[60:63],v[108:111]
 s_add_u32 m0,s46,39936
 s_add_u32 s45,s45,10240
 buffer_load_dwordx4 v8,s[24:27],s45 offen lds
 v_mfma_f32_16x16x32_bf16 v[108:111],v[32:35],a[44:47],v[108:111]
 s_waitcnt lgkmcnt(0)
 v_mfma_f32_16x16x32_bf16 v[112:115],v[40:43],a[32:35],v[112:115]
 ds_read_b64_tr_b16 v[16:17],v7 offset:128
 ds_read_b64_tr_b16 v[18:19],v7 offset:6272
 v_mfma_f32_16x16x32_bf16 v[112:115],v[44:47],a[48:51],v[112:115]
 s_add_u32 m0,s35,3072
 s_nop 0
 buffer_load_dwordx4 v11,s[20:23],s44 offen offset:1024 lds
 v_mfma_f32_16x16x32_bf16 v[116:119],v[44:47],a[52:55],v[116:119]
 ds_read_b64_tr_b16 v[20:21],v7 offset:12416
 ds_read_b64_tr_b16 v[22:23],v7 offset:18560
 v_mfma_f32_16x16x32_bf16 v[116:119],v[40:43],a[36:39],v[116:119]
 s_add_u32 m0,s46,0
 s_lshl_b32 s45,s61,7
 buffer_load_dwordx4 v8,s[24:27],s45 offen lds
 v_mfma_f32_16x16x32_bf16 v[120:123],v[40:43],a[40:43],v[120:123]
 ds_read_b64_tr_b16 v[24:25],v7 offset:136
 ds_read_b64_tr_b16 v[26:27],v7 offset:6280
 v_mfma_f32_16x16x32_bf16 v[120:123],v[44:47],a[56:59],v[120:123]
 v_mfma_f32_16x16x32_bf16 v[124:127],v[44:47],a[60:63],v[124:127]
 s_add_u32 s45,s45,10240
 ds_read_b64_tr_b16 v[28:29],v7 offset:12424
 ds_read_b64_tr_b16 v[30:31],v7 offset:18568
 v_mfma_f32_16x16x32_bf16 v[124:127],v[40:43],a[44:47],v[124:127]
 s_add_u32 m0,s46,1024
 s_add_u32 s61,s61,1
 buffer_load_dwordx4 v8,s[24:27],s45 offen lds
 v_mfma_f32_16x16x32_bf16 v[128:131],v[48:51],a[32:35],v[128:131]
 ds_read_b64_tr_b16 v[32:33],v6 offset:256
 ds_read_b64_tr_b16 v[34:35],v6 offset:6400
 v_mfma_f32_16x16x32_bf16 v[128:131],v[52:55],a[48:51],v[128:131]
 v_mfma_f32_16x16x32_bf16 v[132:135],v[52:55],a[52:55],v[132:135]
 s_add_u32 s45,s45,10240
 ds_read_b64_tr_b16 v[36:37],v6 offset:12544
 ds_read_b64_tr_b16 v[38:39],v6 offset:18688
 v_mfma_f32_16x16x32_bf16 v[132:135],v[48:51],a[36:39],v[132:135]
 s_cmp_eq_u32 s61,10
 s_cselect_b32 s61,0,s61
 v_mfma_f32_16x16x32_bf16 v[136:139],v[48:51],a[40:43],v[136:139]
 s_add_u32 m0,s46,2048
 s_nop 0
 buffer_load_dwordx4 v8,s[24:27],s45 offen lds
 v_mfma_f32_16x16x32_bf16 v[136:139],v[52:55],a[56:59],v[136:139]
 v_mfma_f32_16x16x32_bf16 v[140:143],v[52:55],a[60:63],v[140:143]
 v_mfma_f32_16x16x32_bf16 v[140:143],v[48:51],a[44:47],v[140:143]
 v_mfma_f32_16x16x32_bf16 v[144:147],v[56:59],a[32:35],v[144:147]
 v_mfma_f32_16x16x32_bf16 v[144:147],v[60:63],a[48:51],v[144:147]
 v_mfma_f32_16x16x32_bf16 v[148:151],v[60:63],a[52:55],v[148:151]
 s_add_u32 m0,s46,3072
 s_add_u32 s45,s45,10240
 buffer_load_dwordx4 v8,s[24:27],s45 offen lds
 v_mfma_f32_16x16x32_bf16 v[148:151],v[56:59],a[36:39],v[148:151]
 v_mfma_f32_16x16x32_bf16 v[152:155],v[56:59],a[40:43],v[152:155]
 v_mfma_f32_16x16x32_bf16 v[152:155],v[60:63],a[56:59],v[152:155]
 s_cmp_eq_u32 s32,1
 s_cbranch_scc0 Lc6
 v_mfma_f32_16x16x32_bf16 a[244:247],a[240:243],v[40:43],a[244:247]
 v_mfma_f32_16x16x32_bf16 a[244:247],a[240:243],v[44:47],a[244:247]
 v_mfma_f32_16x16x32_bf16 a[248:251],a[240:243],v[48:51],a[248:251]
 v_mfma_f32_16x16x32_bf16 a[248:251],a[240:243],v[52:55],a[248:251]
 v_mfma_f32_16x16x32_bf16 a[252:255],a[240:243],v[56:59],a[252:255]
 v_mfma_f32_16x16x32_bf16 a[252:255],a[240:243],v[60:63],a[252:255]
Lc6:
 v_mfma_f32_16x16x32_bf16 v[156:159],v[60:63],a[60:63],v[156:159]
 s_add_u32 m0,s46,4096
 s_add_u32 s45,s45,10240
 buffer_load_dwordx4 v8,s[24:27],s45 offen lds
 v_mfma_f32_16x16x32_bf16 v[156:159],v[56:59],a[44:47],v[156:159]
 s_waitcnt lgkmcnt(0)
 v_mfma_f32_16x16x32_bf16 v[160:163],v[16:19],a[32:35],v[160:163]
 ds_read_b64_tr_b16 v[40:41],v6 offset:264
 ds_read_b64_tr_b16 v[42:43],v6 offset:6408
 v_mfma_f32_16x16x32_bf16 v[160:163],v[20:23],a[48:51],v[160:163]
 s_add_u32 m0,s46,5120
 s_add_u32 s45,s45,10240
 buffer_load_dwordx4 v8,s[24:27],s45 offen lds
 v_mfma_f32_16x16x32_bf16 v[164:167],v[20:23],a[52:55],v[164:167]
 ds_read_b64_tr_b16 v[44:45],v6 offset:12552
 ds_read_b64_tr_b16 v[46:47],v6 offset:18696
 v_mfma_f32_16x16x32_bf16 v[164:167],v[16:19],a[36:39],v[164:167]
 v_mfma_f32_16x16x32_bf16 v[168:171],v[16:19],a[40:43],v[168:171]
 ds_read_b64_tr_b16 v[48:49],v7 offset:256
 ds_read_b64_tr_b16 v[50:51],v7 offset:6400
 v_mfma_f32_16x16x32_bf16 v[168:171],v[20:23],a[56:59],v[168:171]
 v_mfma_f32_16x16x32_bf16 v[172:175],v[20:23],a[60:63],v[172:175]
 ds_read_b64_tr_b16 v[52:53],v7 offset:12544
 ds_read_b64_tr_b16 v[54:55],v7 offset:18688
 v_mfma_f32_16x16x32_bf16 v[172:175],v[16:19],a[44:47],v[172:175]
 s_add_u32 m0,s46,6144
 s_add_u32 s45,s45,10240
 buffer_load_dwordx4 v8,s[24:27],s45 offen lds
 v_mfma_f32_16x16x32_bf16 v[176:179],v[24:27],a[32:35],v[176:179]
 ds_read_b64_tr_b16 v[56:57],v7 offset:264
 ds_read_b64_tr_b16 v[58:59],v7 offset:6408
 v_mfma_f32_16x16x32_bf16 v[176:179],v[28:31],a[48:51],v[176:179]
 v_mfma_f32_16x16x32_bf16 v[180:183],v[28:31],a[52:55],v[180:183]
 ds_read_b64_tr_b16 v[60:61],v7 offset:12552
 ds_read_b64_tr_b16 v[62:63],v7 offset:18696
 v_mfma_f32_16x16x32_bf16 v[180:183],v[24:27],a[36:39],v[180:183]
 v_mfma_f32_16x16x32_bf16 v[184:187],v[24:27],a[40:43],v[184:187]
 s_waitcnt vmcnt(8)
 ds_read_b128 a[64:67],v1 offset:32768
 ds_read_b128 a[80:83],v2 offset:32768
 v_mfma_f32_16x16x32_bf16 v[184:187],v[28:31],a[56:59],v[184:187]
 s_add_u32 m0,s46,7168
 s_add_u32 s45,s45,10240
 buffer_load_dwordx4 v8,s[24:27],s45 offen lds
 v_mfma_f32_16x16x32_bf16 v[188:191],v[28:31],a[60:63],v[188:191]
 ds_read_b128 a[68:71],v1 offset:34816
 ds_read_b128 a[84:87],v2 offset:34816
 v_mfma_f32_16x16x32_bf16 v[188:191],v[24:27],a[44:47],v[188:191]
 v_mfma_f32_16x16x32_bf16 v[192:195],v[32:35],a[32:35],v[192:195]
 ds_read_b128 a[72:75],v1 offset:36864
 ds_read_b128 a[88:91],v2 offset:36864
 v_mfma_f32_16x16x32_bf16 v[192:195],v[36:39],a[48:51],v[192:195]
 v_mfma_f32_16x16x32_bf16 v[196:199],v[36:39],a[52:55],v[196:199]
 ds_read_b128 a[76:79],v1 offset:38912
 ds_read_b128 a[92:95],v2 offset:38912
 v_mfma_f32_16x16x32_bf16 v[196:199],v[32:35],a[36:39],v[196:199]
 s_add_u32 m0,s35,3072
 s_nop 0
 buffer_load_dwordx4 v12,s[20:23],s44 offen offset:2048 lds
 v_mfma_f32_16x16x32_bf16 v[200:203],v[32:35],a[40:43],v[200:203]
 s_mov_b32 s50,24576
 v_add_u32 v6,s50,v6
 v_add_u32 v7,s50,v7
 v_mfma_f32_16x16x32_bf16 v[200:203],v[36:39],a[56:59],v[200:203]
 s_cmp_eq_u32 s32,2
 s_cbranch_scc0 Lc7
 v_mfma_f32_16x16x32_bf16 a[244:247],a[240:243],v[16:19],a[244:247]
 v_mfma_f32_16x16x32_bf16 a[244:247],a[240:243],v[20:23],a[244:247]
 v_mfma_f32_16x16x32_bf16 a[248:251],a[240:243],v[24:27],a[248:251]
 v_mfma_f32_16x16x32_bf16 a[248:251],a[240:243],v[28:31],a[248:251]
 v_mfma_f32_16x16x32_bf16 a[252:255],a[240:243],v[32:35],a[252:255]
 v_mfma_f32_16x16x32_bf16 a[252:255],a[240:243],v[36:39],a[252:255]
Lc7:
 v_mfma_f32_16x16x32_bf16 v[204:207],v[36:39],a[60:63],v[204:207]
 s_add_u32 m0,s35,24576
 s_mul_i32 s44,s63,786432
 buffer_load_dwordx4 v10,s[20:23],s44 offen lds
 v_mfma_f32_16x16x32_bf16 v[204:207],v[32:35],a[44:47],v[204:207]
 s_waitcnt vmcnt(19) lgkmcnt(0)
 s_barrier
 v_mfma_f32_16x16x32_bf16 v[208:211],v[40:43],a[32:35],v[208:211]
 s_add_u32 s63,s63,1
 ds_read_b64_tr_b16 v[16:17],v6
 ds_read_b64_tr_b16 v[18:19],v6 offset:6144
 v_mfma_f32_16x16x32_bf16 v[208:211],v[44:47],a[48:51],v[208:211]
 buffer_load_dwordx4 v11,s[20:23],s44 offen offset:1024 lds
 v_mfma_f32_16x16x32_bf16 v[212:215],v[44:47],a[52:55],v[212:215]
 ds_read_b64_tr_b16 v[20:21],v6 offset:12288
 ds_read_b64_tr_b16 v[22:23],v6 offset:18432
 v_mfma_f32_16x16x32_bf16 v[212:215],v[40:43],a[36:39],v[212:215]
 s_add_u32 m0,s46,32768
 s_lshl_b32 s45,s61,7
 buffer_load_dwordx4 v8,s[24:27],s45 offen lds
 v_mfma_f32_16x16x32_bf16 v[216:219],v[40:43],a[40:43],v[216:219]
 s_add_u32 s45,s45,10240
 ds_read_b64_tr_b16 v[24:25],v6 offset:8
 ds_read_b64_tr_b16 v[26:27],v6 offset:6152
 v_mfma_f32_16x16x32_bf16 v[216:219],v[44:47],a[56:59],v[216:219]
 s_add_u32 m0,s46,33792
 s_add_u32 s61,s61,1
 buffer_load_dwordx4 v8,s[24:27],s45 offen lds
 v_mfma_f32_16x16x32_bf16 v[220:223],v[44:47],a[60:63],v[220:223]
 ds_read_b64_tr_b16 v[28:29],v6 offset:12296
 ds_read_b64_tr_b16 v[30:31],v6 offset:18440
 v_mfma_f32_16x16x32_bf16 v[220:223],v[40:43],a[44:47],v[220:223]
 v_mfma_f32_16x16x32_bf16 v[224:227],v[48:51],a[32:35],v[224:227]
 s_add_u32 s45,s45,10240
 ds_read_b64_tr_b16 v[32:33],v7
 ds_read_b64_tr_b16 v[34:35],v7 offset:6144
 v_mfma_f32_16x16x32_bf16 v[224:227],v[52:55],a[48:51],v[224:227]
 s_cmp_eq_u32 s61,10
 s_cselect_b32 s61,0,s61
 v_mfma_f32_16x16x32_bf16 v[228:231],v[52:55],a[52:55],v[228:231]
 ds_read_b64_tr_b16 v[36:37],v7 offset:12288
 ds_read_b64_tr_b16 v[38:39],v7 offset:18432
 v_mfma_f32_16x16x32_bf16 v[228:231],v[48:51],a[36:39],v[228:231]
 s_add_u32 m0,s46,34816
 s_nop 0
 buffer_load_dwordx4 v8,s[24:27],s45 offen lds
 v_mfma_f32_16x16x32_bf16 v[232:235],v[48:51],a[40:43],v[232:235]
 v_mfma_f32_16x16x32_bf16 v[232:235],v[52:55],a[56:59],v[232:235]
 v_mfma_f32_16x16x32_bf16 v[236:239],v[52:55],a[60:63],v[236:239]
 v_mfma_f32_16x16x32_bf16 v[236:239],v[48:51],a[44:47],v[236:239]
 v_mfma_f32_16x16x32_bf16 v[240:243],v[56:59],a[32:35],v[240:243]
 s_add_u32 m0,s46,35840
 s_add_u32 s45,s45,10240
 buffer_load_dwordx4 v8,s[24:27],s45 offen lds
 v_mfma_f32_16x16x32_bf16 v[240:243],v[60:63],a[48:51],v[240:243]
 v_mfma_f32_16x16x32_bf16 v[244:247],v[60:63],a[52:55],v[244:247]
 v_mfma_f32_16x16x32_bf16 v[244:247],v[56:59],a[36:39],v[244:247]
 v_mfma_f32_16x16x32_bf16 v[248:251],v[56:59],a[40:43],v[248:251]
 v_mfma_f32_16x16x32_bf16 v[248:251],v[60:63],a[56:59],v[248:251]
 s_cmp_eq_u32 s32,3
 s_cbranch_scc0 Lc8
 v_mfma_f32_16x16x32_bf16 a[244:247],a[240:243],v[40:43],a[244:247]
 v_mfma_f32_16x16x32_bf16 a[244:247],a[240:243],v[44:47],a[244:247]
 v_mfma_f32_16x16x32_bf16 a[248:251],a[240:243],v[48:51],a[248:251]
 v_mfma_f32_16x16x32_bf16 a[248:251],a[240:243],v[52:55],a[248:251]
 v_mfma_f32_16x16x32_bf16 a[252:255],a[240:243],v[56:59],a[252:255]
 v_mfma_f32_16x16x32_bf16 a[252:255],a[240:243],v[60:63],a[252:255]
Lc8:
 v_mfma_f32_16x16x32_bf16 v[252:255],v[60:63],a[60:63],v[252:255]
 s_add_u32 m0,s46,36864
 s_add_u32 s45,s45,10240
 buffer_load_dwordx4 v8,s[24:27],s45 offen lds
 s_cmp_eq_u32 s63,10
 s_cselect_b32 s63,0,s63
 s_add_u32 m0,s35,24576
 s_nop 0
 buffer_load_dwordx4 v12,s[20:23],s44 offen offset:2048 lds
 v_mfma_f32_16x16x32_bf16 v[252:255],v[56:59],a[44:47],v[252:255]
 s_waitcnt lgkmcnt(0)
 v_mfma_f32_16x16x32_bf16 v[64:67],v[16:19],a[64:67],v[64:67]
 ds_read_b64_tr_b16 v[40:41],v7 offset:8
 ds_read_b64_tr_b16 v[42:43],v7 offset:6152
 v_mfma_f32_16x16x32_bf16 v[64:67],v[20:23],a[80:83],v[64:67]
 s_mul_i32 s76,s71,13108
 s_lshr_b32 s76,s76,16
 s_mul_i32 s41,s76,5
 v_mfma_f32_16x16x32_bf16 v[68:71],v[20:23],a[84:87],v[68:71]
 ds_read_b64_tr_b16 v[44:45],v7 offset:12296
 ds_read_b64_tr_b16 v[46:47],v7 offset:18440
 v_mfma_f32_16x16x32_bf16 v[68:71],v[16:19],a[68:71],v[68:71]
 s_add_u32 m0,s46,37888
 s_add_u32 s45,s45,10240
 buffer_load_dwordx4 v8,s[24:27],s45 offen lds
 s_sub_u32 s41,s71,s41
 s_and_b32 s42,s76,1
 v_mfma_f32_16x16x32_bf16 v[72:75],v[16:19],a[72:75],v[72:75]
 ds_read_b64_tr_b16 v[48:49],v6 offset:128
 ds_read_b64_tr_b16 v[50:51],v6 offset:6272
 v_mfma_f32_16x16x32_bf16 v[72:75],v[20:23],a[88:91],v[72:75]
 s_sub_u32 s41,s41,s42
 s_cselect_b32 s41,4,s41
 s_mul_i32 s76,s76,48
 v_mfma_f32_16x16x32_bf16 v[76:79],v[20:23],a[92:95],v[76:79]
 ds_read_b64_tr_b16 v[52:53],v6 offset:12416
 ds_read_b64_tr_b16 v[54:55],v6 offset:18560
 v_mfma_f32_16x16x32_bf16 v[76:79],v[16:19],a[76:79],v[76:79]
 s_add_u32 s76,s76,s70
 s_mul_i32 s76,s76,5
 s_add_u32 s76,s76,s41
 v_mfma_f32_16x16x32_bf16 v[80:83],v[24:27],a[64:67],v[80:83]
 ds_read_b64_tr_b16 v[56:57],v6 offset:136
 ds_read_b64_tr_b16 v[58:59],v6 offset:6280
 v_mfma_f32_16x16x32_bf16 v[80:83],v[28:31],a[80:83],v[80:83]
 s_add_u32 m0,s46,38912
 s_add_u32 s45,s45,10240
 buffer_load_dwordx4 v8,s[24:27],s45 offen lds
 s_lshl_b32 s76,s76,10
 s_add_u32 s76,s76,6537216
 s_add_u32 s71,s71,1
 v_mfma_f32_16x16x32_bf16 v[84:87],v[28:31],a[84:87],v[84:87]
 ds_read_b64_tr_b16 v[60:61],v6 offset:12424
 ds_read_b64_tr_b16 v[62:63],v6 offset:18568
 v_mfma_f32_16x16x32_bf16 v[84:87],v[24:27],a[68:71],v[84:87]
 s_mul_i32 s77,s71,13108
 s_lshr_b32 s77,s77,16
 s_mul_i32 s41,s77,5
 v_mfma_f32_16x16x32_bf16 v[88:91],v[24:27],a[72:75],v[88:91]
 s_sub_u32 s41,s71,s41
 s_and_b32 s42,s77,1
 v_mfma_f32_16x16x32_bf16 v[88:91],v[28:31],a[88:91],v[88:91]
 s_sub_u32 s41,s41,s42
 s_cselect_b32 s41,4,s41
 s_mul_i32 s77,s77,48
 v_mfma_f32_16x16x32_bf16 v[92:95],v[28:31],a[92:95],v[92:95]
 s_add_u32 s77,s77,s70
 s_mul_i32 s77,s77,5
 s_add_u32 s77,s77,s41
 v_mfma_f32_16x16x32_bf16 v[92:95],v[24:27],a[76:79],v[92:95]
 s_add_u32 m0,s46,39936
 s_add_u32 s45,s45,10240
 buffer_load_dwordx4 v8,s[24:27],s45 offen lds
 s_lshl_b32 s77,s77,10
 s_add_u32 s77,s77,6537216
 s_add_u32 s71,s71,1
 v_mfma_f32_16x16x32_bf16 v[96:99],v[32:35],a[64:67],v[96:99]
 s_mul_i32 s78,s71,13108
 s_lshr_b32 s78,s78,16
 s_mul_i32 s41,s78,5
 v_mfma_f32_16x16x32_bf16 v[96:99],v[36:39],a[80:83],v[96:99]
 s_sub_u32 s41,s71,s41
 s_and_b32 s42,s78,1
 v_mfma_f32_16x16x32_bf16 v[100:103],v[36:39],a[84:87],v[100:103]
 s_sub_u32 s41,s41,s42
 s_cselect_b32 s41,4,s41
 s_mul_i32 s78,s78,48
 v_mfma_f32_16x16x32_bf16 v[100:103],v[32:35],a[68:71],v[100:103]
 s_add_u32 s78,s78,s70
 s_mul_i32 s78,s78,5
 s_add_u32 s78,s78,s41
 v_mfma_f32_16x16x32_bf16 v[104:107],v[32:35],a[72:75],v[104:107]
 s_lshl_b32 s78,s78,10
 s_add_u32 s78,s78,6537216
 s_add_u32 s71,s71,1
 v_mfma_f32_16x16x32_bf16 v[104:107],v[36:39],a[88:91],v[104:107]
 s_add_u32 m0,s35,27648
 s_add_u32 s44,s44,196608
 buffer_load_dwordx4 v10,s[20:23],s44 offen lds
 s_cmp_eq_u32 s36,0
 s_cbranch_scc0 Lc9
 v_mfma_f32_16x16x32_bf16 a[244:247],a[240:243],v[16:19],a[244:247]
 v_mfma_f32_16x16x32_bf16 a[244:247],a[240:243],v[20:23],a[244:247]
 v_mfma_f32_16x16x32_bf16 a[248:251],a[240:243],v[24:27],a[248:251]
 v_mfma_f32_16x16x32_bf16 a[248:251],a[240:243],v[28:31],a[248:251]
 v_mfma_f32_16x16x32_bf16 a[252:255],a[240:243],v[32:35],a[252:255]
 v_mfma_f32_16x16x32_bf16 a[252:255],a[240:243],v[36:39],a[252:255]
Lc9:
 v_mfma_f32_16x16x32_bf16 v[108:111],v[36:39],a[92:95],v[108:111]
 buffer_load_dwordx4 v11,s[20:23],s44 offen offset:1024 lds
 s_mul_i32 s79,s71,13108
 s_lshr_b32 s79,s79,16
 s_mul_i32 s41,s79,5
 v_mfma_f32_16x16x32_bf16 v[108:111],v[32:35],a[76:79],v[108:111]
 buffer_load_dwordx4 v12,s[20:23],s44 offen offset:2048 lds
 s_waitcnt lgkmcnt(0)
 s_sub_u32 s41,s71,s41
 s_and_b32 s42,s79,1
 v_mfma_f32_16x16x32_bf16 v[112:115],v[40:43],a[64:67],v[112:115]
 ds_read_b64_tr_b16 v[16:17],v7 offset:128
 ds_read_b64_tr_b16 v[18:19],v7 offset:6272
 v_mfma_f32_16x16x32_bf16 v[112:115],v[44:47],a[80:83],v[112:115]
 s_sub_u32 s41,s41,s42
 s_cselect_b32 s41,4,s41
 s_mul_i32 s79,s79,48
 v_mfma_f32_16x16x32_bf16 v[116:119],v[44:47],a[84:87],v[116:119]
 ds_read_b64_tr_b16 v[20:21],v7 offset:12416
 ds_read_b64_tr_b16 v[22:23],v7 offset:18560
 v_mfma_f32_16x16x32_bf16 v[116:119],v[40:43],a[68:71],v[116:119]
 s_add_u32 m0,s35,49152
 s_mul_i32 s44,s63,786432
 buffer_load_dwordx4 v10,s[20:23],s44 offen lds
 s_add_u32 s79,s79,s70
 s_mul_i32 s79,s79,5
 s_add_u32 s79,s79,s41
 v_mfma_f32_16x16x32_bf16 v[120:123],v[40:43],a[72:75],v[120:123]
 ds_read_b64_tr_b16 v[24:25],v7 offset:136
 ds_read_b64_tr_b16 v[26:27],v7 offset:6280
 v_mfma_f32_16x16x32_bf16 v[120:123],v[44:47],a[88:91],v[120:123]
 s_lshl_b32 s79,s79,10
 s_add_u32 s79,s79,6537216
 s_add_u32 s71,s71,1
 v_mfma_f32_16x16x32_bf16 v[124:127],v[44:47],a[92:95],v[124:127]
 ds_read_b64_tr_b16 v[28:29],v7 offset:12424
 ds_read_b64_tr_b16 v[30:31],v7 offset:18568
 v_mfma_f32_16x16x32_bf16 v[124:127],v[40:43],a[76:79],v[124:127]
 s_lshl_b32 s49,s32,12
 s_add_u32 s49,s49,147456
 v_mfma_f32_16x16x32_bf16 v[128:131],v[48:51],a[64:67],v[128:131]
 s_add_u32 s63,s63,1
 ds_read_b64_tr_b16 v[32:33],v6 offset:256
 ds_read_b64_tr_b16 v[34:35],v6 offset:6400
 v_mfma_f32_16x16x32_bf16 v[128:131],v[52:55],a[80:83],v[128:131]
 buffer_load_dwordx4 v11,s[20:23],s44 offen offset:1024 lds
 v_mfma_f32_16x16x32_bf16 v[132:135],v[52:55],a[84:87],v[132:135]
 ds_read_b64_tr_b16 v[36:37],v6 offset:12544
 ds_read_b64_tr_b16 v[38:39],v6 offset:18688
 v_mfma_f32_16x16x32_bf16 v[132:135],v[48:51],a[68:71],v[132:135]
 s_cmp_eq_u32 s63,10
 s_cselect_b32 s63,0,s63
 buffer_load_dwordx4 v12,s[20:23],s44 offen offset:2048 lds
 v_mfma_f32_16x16x32_bf16 v[136:139],v[48:51],a[72:75],v[136:139]
 v_mfma_f32_16x16x32_bf16 v[136:139],v[52:55],a[88:91],v[136:139]
 v_mfma_f32_16x16x32_bf16 v[140:143],v[52:55],a[92:95],v[140:143]
 v_mfma_f32_16x16x32_bf16 v[140:143],v[48:51],a[76:79],v[140:143]
 s_add_u32 m0,s35,52224
 s_add_u32 s44,s44,196608
 buffer_load_dwordx4 v10,s[20:23],s44 offen lds
 v_mfma_f32_16x16x32_bf16 v[144:147],v[56:59],a[64:67],v[144:147]
 v_mfma_f32_16x16x32_bf16 v[144:147],v[60:63],a[80:83],v[144:147]
 v_mfma_f32_16x16x32_bf16 v[148:151],v[60:63],a[84:87],v[148:151]
 v_mfma_f32_16x16x32_bf16 v[148:151],v[56:59],a[68:71],v[148:151]
 buffer_load_dwordx4 v11,s[20:23],s44 offen offset:1024 lds
 v_mfma_f32_16x16x32_bf16 v[152:155],v[56:59],a[72:75],v[152:155]
 v_mfma_f32_16x16x32_bf16 v[152:155],v[60:63],a[88:91],v[152:155]
 s_cmp_eq_u32 s36,1
 s_cbranch_scc0 Lc10
 v_mfma_f32_16x16x32_bf16 a[244:247],a[240:243],v[40:43],a[244:247]
 v_mfma_f32_16x16x32_bf16 a[244:247],a[240:243],v[44:47],a[244:247]
 v_mfma_f32_16x16x32_bf16 a[248:251],a[240:243],v[48:51],a[248:251]
 v_mfma_f32_16x16x32_bf16 a[248:251],a[240:243],v[52:55],a[248:251]
 v_mfma_f32_16x16x32_bf16 a[252:255],a[240:243],v[56:59],a[252:255]
 v_mfma_f32_16x16x32_bf16 a[252:255],a[240:243],v[60:63],a[252:255]
Lc10:
 v_mfma_f32_16x16x32_bf16 v[156:159],v[60:63],a[92:95],v[156:159]
 buffer_load_dwordx4 v12,s[20:23],s44 offen offset:2048 lds
 v_mfma_f32_16x16x32_bf16 v[156:159],v[56:59],a[76:79],v[156:159]
 s_waitcnt lgkmcnt(0)
 v_mfma_f32_16x16x32_bf16 v[160:163],v[16:19],a[64:67],v[160:163]
 ds_read_b64_tr_b16 v[40:41],v6 offset:264
 ds_read_b64_tr_b16 v[42:43],v6 offset:6408
 v_mfma_f32_16x16x32_bf16 v[160:163],v[20:23],a[80:83],v[160:163]
 v_mfma_f32_16x16x32_bf16 v[164:167],v[20:23],a[84:87],v[164:167]
 ds_read_b64_tr_b16 v[44:45],v6 offset:12552
 ds_read_b64_tr_b16 v[46:47],v6 offset:18696
 v_mfma_f32_16x16x32_bf16 v[164:167],v[16:19],a[68:71],v[164:167]
 v_mfma_f32_16x16x32_bf16 v[168:171],v[16:19],a[72:75],v[168:171]
 ds_read_b64_tr_b16 v[48:49],v7 offset:256
 ds_read_b64_tr_b16 v[50:51],v7 offset:6400
 v_mfma_f32_16x16x32_bf16 v[168:171],v[20:23],a[88:91],v[168:171]
 v_mfma_f32_16x16x32_bf16 v[172:175],v[20:23],a[92:95],v[172:175]
 ds_read_b64_tr_b16 v[52:53],v7 offset:12544
 ds_read_b64_tr_b16 v[54:55],v7 offset:18688
 v_mfma_f32_16x16x32_bf16 v[172:175],v[16:19],a[76:79],v[172:175]
 v_mfma_f32_16x16x32_bf16 v[176:179],v[24:27],a[64:67],v[176:179]
 ds_read_b64_tr_b16 v[56:57],v7 offset:264
 ds_read_b64_tr_b16 v[58:59],v7 offset:6408
 v_mfma_f32_16x16x32_bf16 v[176:179],v[28:31],a[80:83],v[176:179]
 v_mfma_f32_16x16x32_bf16 v[180:183],v[28:31],a[84:87],v[180:183]
 ds_read_b64_tr_b16 v[60:61],v7 offset:12552
 ds_read_b64_tr_b16 v[62:63],v7 offset:18696
 v_mfma_f32_16x16x32_bf16 v[180:183],v[24:27],a[68:71],v[180:183]
 v_mfma_f32_16x16x32_bf16 v[184:187],v[24:27],a[72:75],v[184:187]
 s_waitcnt vmcnt(21)
 ds_read_b128 a[0:3],v1
 ds_read_b128 a[16:19],v2
 v_mfma_f32_16x16x32_bf16 v[184:187],v[28:31],a[88:91],v[184:187]
 v_mfma_f32_16x16x32_bf16 v[188:191],v[28:31],a[92:95],v[188:191]
 ds_read_b128 a[4:7],v1 offset:2048
 ds_read_b128 a[20:23],v2 offset:2048
 v_mfma_f32_16x16x32_bf16 v[188:191],v[24:27],a[76:79],v[188:191]
 v_mfma_f32_16x16x32_bf16 v[192:195],v[32:35],a[64:67],v[192:195]
 ds_read_b128 a[8:11],v1 offset:4096
 ds_read_b128 a[24:27],v2 offset:4096
 v_mfma_f32_16x16x32_bf16 v[192:195],v[36:39],a[80:83],v[192:195]
 v_mfma_f32_16x16x32_bf16 v[196:199],v[36:39],a[84:87],v[196:199]
 ds_read_b128 a[12:15],v1 offset:6144
 ds_read_b128 a[28:31],v2 offset:6144
 v_mfma_f32_16x16x32_bf16 v[196:199],v[32:35],a[68:71],v[196:199]
 v_mfma_f32_16x16x32_bf16 v[200:203],v[32:35],a[72:75],v[200:203]
 s_mov_b32 s50,-73728
 v_add_u32 v6,s50,v6
 v_add_u32 v7,s50,v7
 v_mfma_f32_16x16x32_bf16 v[200:203],v[36:39],a[88:91],v[200:203]
 s_cmp_eq_u32 s36,2
 s_cbranch_scc0 Lc11
 v_mfma_f32_16x16x32_bf16 a[244:247],a[240:243],v[16:19],a[244:247]
 v_mfma_f32_16x16x32_bf16 a[244:247],a[240:243],v[20:23],a[244:247]
 v_mfma_f32_16x16x32_bf16 a[248:251],a[240:243],v[24:27],a[248:251]
 v_mfma_f32_16x16x32_bf16 a[248:251],a[240:243],v[28:31],a[248:251]
 v_mfma_f32_16x16x32_bf16 a[252:255],a[240:243],v[32:35],a[252:255]
 v_mfma_f32_16x16x32_bf16 a[252:255],a[240:243],v[36:39],a[252:255]
Lc11:
 v_mfma_f32_16x16x32_bf16 v[204:207],v[36:39],a[92:95],v[204:207]
 v_mfma_f32_16x16x32_bf16 v[204:207],v[32:35],a[76:79],v[204:207]
 s_waitcnt vmcnt(20) lgkmcnt(0)
 s_barrier
 v_mfma_f32_16x16x32_bf16 v[208:211],v[40:43],a[64:67],v[208:211]
 ds_read_b64_tr_b16 v[16:17],v6
 ds_read_b64_tr_b16 v[18:19],v6 offset:6144
 v_mfma_f32_16x16x32_bf16 v[208:211],v[44:47],a[80:83],v[208:211]
 s_add_u32 m0,s35,73728
 s_mul_i32 s44,s63,786432
 buffer_load_dwordx4 v10,s[20:23],s44 offen lds
 v_mfma_f32_16x16x32_bf16 v[212:215],v[44:47],a[84:87],v[212:215]
 ds_read_b64_tr_b16 v[20:21],v6 offset:12288
 ds_read_b64_tr_b16 v[22:23],v6 offset:18432
 v_mfma_f32_16x16x32_bf16 v[212:215],v[40:43],a[68:71],v[212:215]
 s_add_u32 m0,s46,0
 s_lshl_b32 s45,s61,7
 buffer_load_dwordx4 v8,s[24:27],s45 offen lds
 v_mfma_f32_16x16x32_bf16 v[216:219],v[40:43],a[72:75],v[216:219]
 ds_read_b64_tr_b16 v[24:25],v6 offset:8
 ds_read_b64_tr_b16 v[26:27],v6 offset:6152
 v_mfma_f32_16x16x32_bf16 v[216:219],v[44:47],a[88:91],v[216:219]
 s_add_u32 m0,s35,73728
 s_add_u32 s63,s63,1
 buffer_load_dwordx4 v11,s[20:23],s44 offen offset:1024 lds
 v_mfma_f32_16x16x32_bf16 v[220:223],v[44:47],a[92:95],v[220:223]
 s_add_u32 s45,s45,10240
 ds_read_b64_tr_b16 v[28:29],v6 offset:12296
 ds_read_b64_tr_b16 v[30:31],v6 offset:18440
 v_mfma_f32_16x16x32_bf16 v[220:223],v[40:43],a[76:79],v[220:223]
 s_add_u32 m0,s46,1024
 s_add_u32 s61,s61,1
 buffer_load_dwordx4 v8,s[24:27],s45 offen lds
 v_mfma_f32_16x16x32_bf16 v[224:227],v[48:51],a[64:67],v[224:227]
 ds_read_b64_tr_b16 v[32:33],v7
 ds_read_b64_tr_b16 v[34:35],v7 offset:6144
 v_mfma_f32_16x16x32_bf16 v[224:227],v[52:55],a[80:83],v[224:227]
 v_mfma_f32_16x16x32_bf16 v[228:231],v[52:55],a[84:87],v[228:231]
 s_add_u32 s45,s45,10240
 ds_read_b64_tr_b16 v[36:37],v7 offset:12288
 ds_read_b64_tr_b16 v[38:39],v7 offset:18432
 v_mfma_f32_16x16x32_bf16 v[228:231],v[48:51],a[68:71],v[228:231]
 s_cmp_eq_u32 s61,10
 s_cselect_b32 s61,0,s61
 v_mfma_f32_16x16x32_bf16 v[232:235],v[48:51],a[72:75],v[232:235]
 s_add_u32 m0,s46,2048
 s_nop 0
 buffer_load_dwordx4 v8,s[24:27],s45 offen lds
 v_mfma_f32_16x16x32_bf16 v[232:235],v[52:55],a[88:91],v[232:235]
 v_mfma_f32_16x16x32_bf16 v[236:239],v[52:55],a[92:95],v[236:239]
 v_mfma_f32_16x16x32_bf16 v[236:239],v[48:51],a[76:79],v[236:239]
 v_mfma_f32_16x16x32_bf16 v[240:243],v[56:59],a[64:67],v[240:243]
 v_mfma_f32_16x16x32_bf16 v[240:243],v[60:63],a[80:83],v[240:243]
 v_mfma_f32_16x16x32_bf16 v[244:247],v[60:63],a[84:87],v[244:247]
 s_add_u32 m0,s46,3072
 s_add_u32 s45,s45,10240
 buffer_load_dwordx4 v8,s[24:27],s45 offen lds
 v_mfma_f32_16x16x32_bf16 v[244:247],v[56:59],a[68:71],v[244:247]
 v_mfma_f32_16x16x32_bf16 v[248:251],v[56:59],a[72:75],v[248:251]
 v_mfma_f32_16x16x32_bf16 v[248:251],v[60:63],a[88:91],v[248:251]
 s_cmp_eq_u32 s36,3
 s_cbranch_scc0 Lc12
 v_mfma_f32_16x16x32_bf16 a[244:247],a[240:243],v[40:43],a[244:247]
 v_mfma_f32_16x16x32_bf16 a[244:247],a[240:243],v[44:47],a[244:247]
 v_mfma_f32_16x16x32_bf16 a[248:251],a[240:243],v[48:51],a[248:251]
 v_mfma_f32_16x16x32_bf16 a[248:251],a[240:243],v[52:55],a[248:251]
 v_mfma_f32_16x16x32_bf16 a[252:255],a[240:243],v[56:59],a[252:255]
 v_mfma_f32_16x16x32_bf16 a[252:255],a[240:243],v[60:63],a[252:255]
Lc12:
 v_mfma_f32_16x16x32_bf16 v[252:255],v[60:63],a[92:95],v[252:255]
 s_add_u32 m0,s46,4096
 s_add_u32 s45,s45,10240
 buffer_load_dwordx4 v8,s[24:27],s45 offen lds
 v_mfma_f32_16x16x32_bf16 v[252:255],v[56:59],a[76:79],v[252:255]
 s_waitcnt lgkmcnt(0)
 v_mfma_f32_16x16x32_bf16 v[64:67],v[16:19],a[0:3],v[64:67]
 ds_read_b64_tr_b16 v[40:41],v7 offset:8
 ds_read_b64_tr_b16 v[42:43],v7 offset:6152
 v_mfma_f32_16x16x32_bf16 v[64:67],v[20:23],a[16:19],v[64:67]
 s_add_u32 m0,s46,5120
 s_add_u32 s45,s45,10240
 buffer_load_dwordx4 v8,s[24:27],s45 offen lds
 v_mfma_f32_16x16x32_bf16 v[68:71],v[20:23],a[20:23],v[68:71]
 ds_read_b64_tr_b16 v[44:45],v7 offset:12296
 ds_read_b64_tr_b16 v[46:47],v7 offset:18440
 v_mfma_f32_16x16x32_bf16 v[68:71],v[16:19],a[4:7],v[68:71]
 v_mfma_f32_16x16x32_bf16 v[72:75],v[16:19],a[8:11],v[72:75]
 ds_read_b64_tr_b16 v[48:49],v6 offset:128
 ds_read_b64_tr_b16 v[50:51],v6 offset:6272
 v_mfma_f32_16x16x32_bf16 v[72:75],v[20:23],a[24:27],v[72:75]
 v_mfma_f32_16x16x32_bf16 v[76:79],v[20:23],a[28:31],v[76:79]
 ds_read_b64_tr_b16 v[52:53],v6 offset:12416
 ds_read_b64_tr_b16 v[54:55],v6 offset:18560
 v_mfma_f32_16x16x32_bf16 v[76:79],v[16:19],a[12:15],v[76:79]
 s_add_u32 m0,s46,6144
 s_add_u32 s45,s45,10240
 buffer_load_dwordx4 v8,s[24:27],s45 offen lds
 v_mfma_f32_16x16x32_bf16 v[80:83],v[24:27],a[0:3],v[80:83]
 ds_read_b64_tr_b16 v[56:57],v6 offset:136
 ds_read_b64_tr_b16 v[58:59],v6 offset:6280
 v_mfma_f32_16x16x32_bf16 v[80:83],v[28:31],a[16:19],v[80:83]
 v_mfma_f32_16x16x32_bf16 v[84:87],v[28:31],a[20:23],v[84:87]
 ds_read_b64_tr_b16 v[60:61],v6 offset:12424
 ds_read_b64_tr_b16 v[62:63],v6 offset:18568
 v_mfma_f32_16x16x32_bf16 v[84:87],v[24:27],a[4:7],v[84:87]
 v_mfma_f32_16x16x32_bf16 v[88:91],v[24:27],a[8:11],v[88:91]
 s_mul_i32 s41,s33,3072
 s_mul_i32 s42,s32,768
 s_add_u32 s41,s41,s42
 v_mfma_f32_16x16x32_bf16 v[88:91],v[28:31],a[24:27],v[88:91]
 s_add_u32 m0,s46,7168
 s_add_u32 s45,s45,10240
 buffer_load_dwordx4 v8,s[24:27],s45 offen lds
 s_lshl_b32 s42,s40,2
 s_add_u32 s41,s41,s42
 s_add_u32 s41,s41,5505024
 v_mfma_f32_16x16x32_bf16 v[92:95],v[28:31],a[28:31],v[92:95]
 v_lshlrev_b32 v4,1,v13
 v_accvgpr_read_b32 v14,a244
 v_mfma_f32_16x16x32_bf16 v[92:95],v[24:27],a[12:15],v[92:95]
 v_cvt_pk_bf16_f32 v15,v14,v14
 v_lshlrev_b32 v15,16,v15
 v_mfma_f32_16x16x32_bf16 v[96:99],v[32:35],a[0:3],v[96:99]
 v_sub_f32 v14,v14,v15
 v_cvt_pk_bf16_f32 v5,v15,v14
 v_mfma_f32_16x16x32_bf16 v[96:99],v[36:39],a[16:19],v[96:99]
 buffer_store_dword v5,v4,s[28:31],s41 offen sc1
 v_accvgpr_read_b32 v14,a248
 v_mfma_f32_16x16x32_bf16 v[100:103],v[36:39],a[20:23],v[100:103]
 s_cmp_eq_u32 s63,10
 s_cselect_b32 s63,0,s63
 s_add_u32 m0,s35,73728
 s_nop 0
 buffer_load_dwordx4 v12,s[20:23],s44 offen offset:2048 lds
 v_cvt_pk_bf16_f32 v15,v14,v14
 v_lshlrev_b32 v15,16,v15
 v_mfma_f32_16x16x32_bf16 v[100:103],v[32:35],a[4:7],v[100:103]
 v_sub_f32 v14,v14,v15
 v_cvt_pk_bf16_f32 v5,v15,v14
 v_mfma_f32_16x16x32_bf16 v[104:107],v[32:35],a[8:11],v[104:107]
 buffer_store_dword v5,v4,s[28:31],s41 offen offset:256 sc1
 v_accvgpr_read_b32 v14,a252
 v_mfma_f32_16x16x32_bf16 v[104:107],v[36:39],a[24:27],v[104:107]
 v_cvt_pk_bf16_f32 v15,v14,v14
 v_lshlrev_b32 v15,16,v15
 v_mfma_f32_16x16x32_bf16 v[108:111],v[36:39],a[28:31],v[108:111]
 v_sub_f32 v14,v14,v15
 v_cvt_pk_bf16_f32 v5,v15,v14
 v_mfma_f32_16x16x32_bf16 v[108:111],v[32:35],a[12:15],v[108:111]
 s_waitcnt lgkmcnt(0)
 buffer_store_dword v5,v4,s[28:31],s41 offen offset:512 sc1
 v_mfma_f32_16x16x32_bf16 v[112:115],v[40:43],a[0:3],v[112:115]
 ds_read_b64_tr_b16 v[16:17],v7 offset:128
 ds_read_b64_tr_b16 v[18:19],v7 offset:6272
 v_mfma_f32_16x16x32_bf16 v[112:115],v[44:47],a[16:19],v[112:115]
 s_add_u32 m0,s35,76800
 s_add_u32 s44,s44,196608
 buffer_load_dwordx4 v10,s[20:23],s44 offen lds
 v_mfma_f32_16x16x32_bf16 v[116:119],v[44:47],a[20:23],v[116:119]
 ds_read_b64_tr_b16 v[20:21],v7 offset:12416
 ds_read_b64_tr_b16 v[22:23],v7 offset:18560
 v_mfma_f32_16x16x32_bf16 v[116:119],v[40:43],a[4:7],v[116:119]
 buffer_load_dwordx4 v11,s[20:23],s44 offen offset:1024 lds
 v_mfma_f32_16x16x32_bf16 v[120:123],v[40:43],a[8:11],v[120:123]
 ds_read_b64_tr_b16 v[24:25],v7 offset:136
 ds_read_b64_tr_b16 v[26:27],v7 offset:6280
 v_mfma_f32_16x16x32_bf16 v[120:123],v[44:47],a[24:27],v[120:123]
 v_mfma_f32_16x16x32_bf16 v[124:127],v[44:47],a[28:31],v[124:127]
 ds_read_b64_tr_b16 v[28:29],v7 offset:12424
 ds_read_b64_tr_b16 v[30:31],v7 offset:18568
 v_mfma_f32_16x16x32_bf16 v[124:127],v[40:43],a[12:15],v[124:127]
 buffer_load_dwordx4 v12,s[20:23],s44 offen offset:2048 lds
 v_mfma_f32_16x16x32_bf16 v[128:131],v[48:51],a[0:3],v[128:131]
 ds_read_b64_tr_b16 v[32:33],v6 offset:256
 ds_read_b64_tr_b16 v[34:35],v6 offset:6400
 v_mfma_f32_16x16x32_bf16 v[128:131],v[52:55],a[16:19],v[128:131]
 v_mfma_f32_16x16x32_bf16 v[132:135],v[52:55],a[20:23],v[132:135]
 ds_read_b64_tr_b16 v[36:37],v6 offset:12544
 ds_read_b64_tr_b16 v[38:39],v6 offset:18688
 v_mfma_f32_16x16x32_bf16 v[132:135],v[48:51],a[4:7],v[132:135]
 v_mfma_f32_16x16x32_bf16 v[136:139],v[48:51],a[8:11],v[136:139]
 s_waitcnt vmcnt(26)
 ds_read_b128 a[32:35],v1 offset:32768
 ds_read_b128 a[48:51],v2 offset:32768
 v_mfma_f32_16x16x32_bf16 v[136:139],v[52:55],a[24:27],v[136:139]
 v_mfma_f32_16x16x32_bf16 v[140:143],v[52:55],a[28:31],v[140:143]
 ds_read_b128 a[36:39],v1 offset:34816
 ds_read_b128 a[52:55],v2 offset:34816
 v_mfma_f32_16x16x32_bf16 v[140:143],v[48:51],a[12:15],v[140:143]
 v_mfma_f32_16x16x32_bf16 v[144:147],v[56:59],a[0:3],v[144:147]
 ds_read_b128 a[40:43],v1 offset:36864
 ds_read_b128 a[56:59],v2 offset:36864
 v_mfma_f32_16x16x32_bf16 v[144:147],v[60:63],a[16:19],v[144:147]
 v_mfma_f32_16x16x32_bf16 v[148:151],v[60:63],a[20:23],v[148:151]
 ds_read_b128 a[44:47],v1 offset:38912
 ds_read_b128 a[60:63],v2 offset:38912
 v_mfma_f32_16x16x32_bf16 v[148:151],v[56:59],a[4:7],v[148:151]
 v_mfma_f32_16x16x32_bf16 v[152:155],v[56:59],a[8:11],v[152:155]
 v_mfma_f32_16x16x32_bf16 v[152:155],v[60:63],a[24:27],v[152:155]
 v_mfma_f32_16x16x32_bf16 v[156:159],v[60:63],a[28:31],v[156:159]
 v_mfma_f32_16x16x32_bf16 v[156:159],v[56:59],a[12:15],v[156:159]
 s_waitcnt lgkmcnt(0)
 v_mfma_f32_16x16x32_bf16 v[160:163],v[16:19],a[0:3],v[160:163]
 ds_read_b64_tr_b16 v[40:41],v6 offset:264
 ds_read_b64_tr_b16 v[42:43],v6 offset:6408
 v_mfma_f32_16x16x32_bf16 v[160:163],v[20:23],a[16:19],v[160:163]
 s_add_u32 m0,s46,32768
 s_lshl_b32 s45,s61,7
 buffer_load_dwordx4 v8,s[24:27],s45 offen lds
 v_mfma_f32_16x16x32_bf16 v[164:167],v[20:23],a[20:23],v[164:167]
 s_add_u32 s45,s45,10240
 ds_read_b64_tr_b16 v[44:45],v6 offset:12552
 ds_read_b64_tr_b16 v[46:47],v6 offset:18696
 v_mfma_f32_16x16x32_bf16 v[164:167],v[16:19],a[4:7],v[164:167]
 s_add_u32 m0,s46,33792
 s_add_u32 s61,s61,1
 buffer_load_dwordx4 v8,s[24:27],s45 offen lds
 v_mfma_f32_16x16x32_bf16 v[168:171],v[16:19],a[8:11],v[168:171]
 s_add_u32 s45,s45,10240
 ds_read_b64_tr_b16 v[48:49],v7 offset:256
 ds_read_b64_tr_b16 v[50:51],v7 offset:6400
 v_mfma_f32_16x16x32_bf16 v[168:171],v[20:23],a[24:27],v[168:171]
 s_cmp_eq_u32 s61,10
 s_cselect_b32 s61,0,s61
 s_add_u32 m0,s46,34816
 s_nop 0
 buffer_load_dwordx4 v8,s[24:27],s45 offen lds
 v_mfma_f32_16x16x32_bf16 v[172:175],v[20:23],a[28:31],v[172:175]
 ds_read_b64_tr_b16 v[52:53],v7 offset:12544
 ds_read_b64_tr_b16 v[54:55],v7 offset:18688
 v_mfma_f32_16x16x32_bf16 v[172:175],v[16:19],a[12:15],v[172:175]
 v_mfma_f32_16x16x32_bf16 v[176:179],v[24:27],a[0:3],v[176:179]
 ds_read_b64_tr_b16 v[56:57],v7 offset:264
 ds_read_b64_tr_b16 v[58:59],v7 offset:6408
 v_mfma_f32_16x16x32_bf16 v[176:179],v[28:31],a[16:19],v[176:179]
 v_mfma_f32_16x16x32_bf16 v[180:183],v[28:31],a[20:23],v[180:183]
 ds_read_b64_tr_b16 v[60:61],v7 offset:12552
 ds_read_b64_tr_b16 v[62:63],v7 offset:18696
 v_mfma_f32_16x16x32_bf16 v[180:183],v[24:27],a[4:7],v[180:183]
 s_add_u32 m0,s46,35840
 s_add_u32 s45,s45,10240
 buffer_load_dwordx4 v8,s[24:27],s45 offen lds
 v_mfma_f32_16x16x32_bf16 v[184:187],v[24:27],a[8:11],v[184:187]
 v_mfma_f32_16x16x32_bf16 v[184:187],v[28:31],a[24:27],v[184:187]
 v_mfma_f32_16x16x32_bf16 v[188:191],v[28:31],a[28:31],v[188:191]
 v_mfma_f32_16x16x32_bf16 v[188:191],v[24:27],a[12:15],v[188:191]
 v_mfma_f32_16x16x32_bf16 v[192:195],v[32:35],a[0:3],v[192:195]
 s_add_u32 m0,s46,36864
 s_add_u32 s45,s45,10240
 buffer_load_dwordx4 v8,s[24:27],s45 offen lds
 v_mfma_f32_16x16x32_bf16 v[192:195],v[36:39],a[16:19],v[192:195]
 v_mfma_f32_16x16x32_bf16 v[196:199],v[36:39],a[20:23],v[196:199]
 v_mfma_f32_16x16x32_bf16 v[196:199],v[32:35],a[4:7],v[196:199]
 v_mfma_f32_16x16x32_bf16 v[200:203],v[32:35],a[8:11],v[200:203]
 s_mov_b32 s50,24576
 v_add_u32 v6,s50,v6
 v_add_u32 v7,s50,v7
 v_mfma_f32_16x16x32_bf16 v[200:203],v[36:39],a[24:27],v[200:203]
 v_mfma_f32_16x16x32_bf16 v[204:207],v[36:39],a[28:31],v[204:207]
 s_add_u32 m0,s46,37888
 s_add_u32 s45,s45,10240
 buffer_load_dwordx4 v8,s[24:27],s45 offen lds
 v_mfma_f32_16x16x32_bf16 v[204:207],v[32:35],a[12:15],v[204:207]
 s_waitcnt vmcnt(29) lgkmcnt(0)
 s_barrier
 v_mfma_f32_16x16x32_bf16 v[208:211],v[40:43],a[0:3],v[208:211]
 ds_read_b64_tr_b16 v[16:17],v6
 ds_read_b64_tr_b16 v[18:19],v6 offset:6144
 v_mfma_f32_16x16x32_bf16 v[208:211],v[44:47],a[16:19],v[208:211]
 v_mfma_f32_16x16x32_bf16 v[212:215],v[44:47],a[20:23],v[212:215]
 ds_read_b64_tr_b16 v[20:21],v6 offset:12288
 ds_read_b64_tr_b16 v[22:23],v6 offset:18432
 v_mfma_f32_16x16x32_bf16 v[212:215],v[40:43],a[4:7],v[212:215]
 s_add_u32 m0,s46,38912
 s_add_u32 s45,s45,10240
 buffer_load_dwordx4 v8,s[24:27],s45 offen lds
 v_mfma_f32_16x16x32_bf16 v[216:219],v[40:43],a[8:11],v[216:219]
 ds_read_b64_tr_b16 v[24:25],v6 offset:8
 ds_read_b64_tr_b16 v[26:27],v6 offset:6152
 v_mfma_f32_16x16x32_bf16 v[216:219],v[44:47],a[24:27],v[216:219]
 v_mfma_f32_16x16x32_bf16 v[220:223],v[44:47],a[28:31],v[220:223]
 ds_read_b64_tr_b16 v[28:29],v6 offset:12296
 ds_read_b64_tr_b16 v[30:31],v6 offset:18440
 v_mfma_f32_16x16x32_bf16 v[220:223],v[40:43],a[12:15],v[220:223]
 v_mfma_f32_16x16x32_bf16 v[224:227],v[48:51],a[0:3],v[224:227]
 ds_read_b64_tr_b16 v[32:33],v7
 ds_read_b64_tr_b16 v[34:35],v7 offset:6144
 v_mfma_f32_16x16x32_bf16 v[224:227],v[52:55],a[16:19],v[224:227]
 s_add_u32 m0,s46,39936
 s_add_u32 s45,s45,10240
 buffer_load_dwordx4 v8,s[24:27],s45 offen lds
 v_mfma_f32_16x16x32_bf16 v[228:231],v[52:55],a[20:23],v[228:231]
 ds_read_b64_tr_b16 v[36:37],v7 offset:12288
 ds_read_b64_tr_b16 v[38:39],v7 offset:18432
 v_mfma_f32_16x16x32_bf16 v[228:231],v[48:51],a[4:7],v[228:231]
 v_mfma_f32_16x16x32_bf16 v[232:235],v[48:51],a[8:11],v[232:235]
 v_mfma_f32_16x16x32_bf16 v[232:235],v[52:55],a[24:27],v[232:235]
 v_mfma_f32_16x16x32_bf16 v[236:239],v[52:55],a[28:31],v[236:239]
 s_add_u32 m0,s35,0
 s_mul_i32 s44,s63,786432
 buffer_load_dwordx4 v10,s[20:23],s44 offen lds
 v_mfma_f32_16x16x32_bf16 v[236:239],v[48:51],a[12:15],v[236:239]
 v_mfma_f32_16x16x32_bf16 v[240:243],v[56:59],a[0:3],v[240:243]
 v_mfma_f32_16x16x32_bf16 v[240:243],v[60:63],a[16:19],v[240:243]
 s_add_u32 s63,s63,1
 v_mfma_f32_16x16x32_bf16 v[244:247],v[60:63],a[20:23],v[244:247]
 buffer_load_dwordx4 v11,s[20:23],s44 offen offset:1024 lds
 v_mfma_f32_16x16x32_bf16 v[244:247],v[56:59],a[4:7],v[244:247]
 v_mfma_f32_16x16x32_bf16 v[248:251],v[56:59],a[8:11],v[248:251]
 v_mfma_f32_16x16x32_bf16 v[248:251],v[60:63],a[24:27],v[248:251]
 s_cmp_eq_u32 s63,10
 s_cselect_b32 s63,0,s63
 v_mfma_f32_16x16x32_bf16 v[252:255],v[60:63],a[28:31],v[252:255]
 buffer_load_dwordx4 v12,s[20:23],s44 offen offset:2048 lds
 v_mfma_f32_16x16x32_bf16 v[252:255],v[56:59],a[12:15],v[252:255]
 s_waitcnt lgkmcnt(0)
 v_mfma_f32_16x16x32_bf16 v[64:67],v[16:19],a[32:35],v[64:67]
 ds_read_b64_tr_b16 v[40:41],v7 offset:8
 ds_read_b64_tr_b16 v[42:43],v7 offset:6152
 v_mfma_f32_16x16x32_bf16 v[64:67],v[20:23],a[48:51],v[64:67]
 v_mfma_f32_16x16x32_bf16 v[68:71],v[20:23],a[52:55],v[68:71]
 ds_read_b64_tr_b16 v[44:45],v7 offset:12296
 ds_read_b64_tr_b16 v[46:47],v7 offset:18440
 v_mfma_f32_16x16x32_bf16 v[68:71],v[16:19],a[36:39],v[68:71]
 s_add_u32 m0,s35,3072
 s_add_u32 s44,s44,196608
 buffer_load_dwordx4 v10,s[20:23],s44 offen lds
 v_mfma_f32_16x16x32_bf16 v[72:75],v[16:19],a[40:43],v[72:75]
 ds_read_b64_tr_b16 v[48:49],v6 offset:128
 ds_read_b64_tr_b16 v[50:51],v6 offset:6272
 v_mfma_f32_16x16x32_bf16 v[72:75],v[20:23],a[56:59],v[72:75]
 v_mfma_f32_16x16x32_bf16 v[76:79],v[20:23],a[60:63],v[76:79]
 ds_read_b64_tr_b16 v[52:53],v6 offset:12416
 ds_read_b64_tr_b16 v[54:55],v6 offset:18560
 v_mfma_f32_16x16x32_bf16 v[76:79],v[16:19],a[44:47],v[76:79]
 buffer_load_dwordx4 v11,s[20:23],s44 offen offset:1024 lds
 v_mfma_f32_16x16x32_bf16 v[80:83],v[24:27],a[32:35],v[80:83]
 ds_read_b64_tr_b16 v[56:57],v6 offset:136
 ds_read_b64_tr_b16 v[58:59],v6 offset:6280
 v_mfma_f32_16x16x32_bf16 v[80:83],v[28:31],a[48:51],v[80:83]
 v_mfma_f32_16x16x32_bf16 v[84:87],v[28:31],a[52:55],v[84:87]
 ds_read_b64_tr_b16 v[60:61],v6 offset:12424
 ds_read_b64_tr_b16 v[62:63],v6 offset:18568
 v_mfma_f32_16x16x32_bf16 v[84:87],v[24:27],a[36:39],v[84:87]
 buffer_load_dwordx4 v12,s[20:23],s44 offen offset:2048 lds
 v_mfma_f32_16x16x32_bf16 v[88:91],v[24:27],a[40:43],v[88:91]
 s_waitcnt vmcnt(21)
 ds_read_b128 a[64:67],v1
 ds_read_b128 a[80:83],v2
 v_mfma_f32_16x16x32_bf16 v[88:91],v[28:31],a[56:59],v[88:91]
 v_mfma_f32_16x16x32_bf16 v[92:95],v[28:31],a[60:63],v[92:95]
 ds_read_b128 a[68:71],v1 offset:2048
 ds_read_b128 a[84:87],v2 offset:2048
 v_mfma_f32_16x16x32_bf16 v[92:95],v[24:27],a[44:47],v[92:95]
 v_mfma_f32_16x16x32_bf16 v[96:99],v[32:35],a[32:35],v[96:99]
 ds_read_b128 a[72:75],v1 offset:4096
 ds_read_b128 a[88:91],v2 offset:4096
 v_mfma_f32_16x16x32_bf16 v[96:99],v[36:39],a[48:51],v[96:99]
 v_mfma_f32_16x16x32_bf16 v[100:103],v[36:39],a[52:55],v[100:103]
 ds_read_b128 a[76:79],v1 offset:6144
 ds_read_b128 a[92:95],v2 offset:6144
 v_mfma_f32_16x16x32_bf16 v[100:103],v[32:35],a[36:39],v[100:103]
 v_mfma_f32_16x16x32_bf16 v[104:107],v[32:35],a[40:43],v[104:107]
 v_mfma_f32_16x16x32_bf16 v[104:107],v[36:39],a[56:59],v[104:107]
 v_mfma_f32_16x16x32_bf16 v[108:111],v[36:39],a[60:63],v[108:111]
 v_mfma_f32_16x16x32_bf16 v[108:111],v[32:35],a[44:47],v[108:111]
 s_waitcnt lgkmcnt(0)
 v_mfma_f32_16x16x32_bf16 v[112:115],v[40:43],a[32:35],v[112:115]
 ds_read_b64_tr_b16 v[16:17],v7 offset:128
 ds_read_b64_tr_b16 v[18:19],v7 offset:6272
 v_mfma_f32_16x16x32_bf16 v[112:115],v[44:47],a[48:51],v[112:115]
 s_add_u32 m0,s46,0
 s_lshl_b32 s45,s61,7
 buffer_load_dwordx4 v8,s[24:27],s45 offen lds
 v_mfma_f32_16x16x32_bf16 v[116:119],v[44:47],a[52:55],v[116:119]
 s_add_u32 s45,s45,10240
 ds_read_b64_tr_b16 v[20:21],v7 offset:12416
 ds_read_b64_tr_b16 v[22:23],v7 offset:18560
 v_mfma_f32_16x16x32_bf16 v[116:119],v[40:43],a[36:39],v[116:119]
 s_add_u32 m0,s46,1024
 s_add_u32 s61,s61,1
 buffer_load_dwordx4 v8,s[24:27],s45 offen lds
 v_mfma_f32_16x16x32_bf16 v[120:123],v[40:43],a[40:43],v[120:123]
 s_add_u32 s45,s45,10240
 ds_read_b64_tr_b16 v[24:25],v7 offset:136
 ds_read_b64_tr_b16 v[26:27],v7 offset:6280
 v_mfma_f32_16x16x32_bf16 v[120:123],v[44:47],a[56:59],v[120:123]
 s_cmp_eq_u32 s61,10
 s_cselect_b32 s61,0,s61
 s_add_u32 m0,s46,2048
 s_nop 0
 buffer_load_dwordx4 v8,s[24:27],s45 offen lds
 v_mfma_f32_16x16x32_bf16 v[124:127],v[44:47],a[60:63],v[124:127]
 ds_read_b64_tr_b16 v[28:29],v7 offset:12424
 ds_read_b64_tr_b16 v[30:31],v7 offset:18568
 v_mfma_f32_16x16x32_bf16 v[124:127],v[40:43],a[44:47],v[124:127]
 v_mfma_f32_16x16x32_bf16 v[128:131],v[48:51],a[32:35],v[128:131]
 ds_read_b64_tr_b16 v[32:33],v6 offset:256
 ds_read_b64_tr_b16 v[34:35],v6 offset:6400
 v_mfma_f32_16x16x32_bf16 v[128:131],v[52:55],a[48:51],v[128:131]
 v_mfma_f32_16x16x32_bf16 v[132:135],v[52:55],a[52:55],v[132:135]
 ds_read_b64_tr_b16 v[36:37],v6 offset:12544
 ds_read_b64_tr_b16 v[38:39],v6 offset:18688
 v_mfma_f32_16x16x32_bf16 v[132:135],v[48:51],a[36:39],v[132:135]
 s_add_u32 m0,s46,3072
 s_add_u32 s45,s45,10240
 buffer_load_dwordx4 v8,s[24:27],s45 offen lds
 v_mfma_f32_16x16x32_bf16 v[136:139],v[48:51],a[40:43],v[136:139]
 v_mfma_f32_16x16x32_bf16 v[136:139],v[52:55],a[56:59],v[136:139]
 v_mfma_f32_16x16x32_bf16 v[140:143],v[52:55],a[60:63],v[140:143]
 v_mfma_f32_16x16x32_bf16 v[140:143],v[48:51],a[44:47],v[140:143]
 v_mfma_f32_16x16x32_bf16 v[144:147],v[56:59],a[32:35],v[144:147]
 s_add_u32 m0,s46,4096
 s_add_u32 s45,s45,10240
 buffer_load_dwordx4 v8,s[24:27],s45 offen lds
 v_mfma_f32_16x16x32_bf16 v[144:147],v[60:63],a[48:51],v[144:147]
 v_mfma_f32_16x16x32_bf16 v[148:151],v[60:63],a[52:55],v[148:151]
 v_mfma_f32_16x16x32_bf16 v[148:151],v[56:59],a[36:39],v[148:151]
 v_mfma_f32_16x16x32_bf16 v[152:155],v[56:59],a[40:43],v[152:155]
 v_mfma_f32_16x16x32_bf16 v[152:155],v[60:63],a[56:59],v[152:155]
 v_mfma_f32_16x16x32_bf16 v[156:159],v[60:63],a[60:63],v[156:159]
 s_add_u32 m0,s46,5120
 s_add_u32 s45,s45,10240
 buffer_load_dwordx4 v8,s[24:27],s45 offen lds
 v_mfma_f32_16x16x32_bf16 v[156:159],v[56:59],a[44:47],v[156:159]
 s_waitcnt lgkmcnt(0)
 v_mfma_f32_16x16x32_bf16 v[160:163],v[16:19],a[32:35],v[160:163]
 ds_read_b64_tr_b16 v[40:41],v6 offset:264
 ds_read_b64_tr_b16 v[42:43],v6 offset:6408
 v_mfma_f32_16x16x32_bf16 v[160:163],v[20:23],a[48:51],v[160:163]
 v_mfma_f32_16x16x32_bf16 v[164:167],v[20:23],a[52:55],v[164:167]
 ds_read_b64_tr_b16 v[44:45],v6 offset:12552
 ds_read_b64_tr_b16 v[46:47],v6 offset:18696
 v_mfma_f32_16x16x32_bf16 v[164:167],v[16:19],a[36:39],v[164:167]
 v_mfma_f32_16x16x32_bf16 v[168:171],v[16:19],a[40:43],v[168:171]
 ds_read_b64_tr_b16 v[48:49],v7 offset:256
 ds_read_b64_tr_b16 v[50:51],v7 offset:6400
 v_mfma_f32_16x16x32_bf16 v[168:171],v[20:23],a[56:59],v[168:171]
 s_add_u32 m0,s46,6144
 s_add_u32 s45,s45,10240
 buffer_load_dwordx4 v8,s[24:27],s45 offen lds
 v_mfma_f32_16x16x32_bf16 v[172:175],v[20:23],a[60:63],v[172:175]
 ds_read_b64_tr_b16 v[52:53],v7 offset:12544
 ds_read_b64_tr_b16 v[54:55],v7 offset:18688
 v_mfma_f32_16x16x32_bf16 v[172:175],v[16:19],a[44:47],v[172:175]
 v_mfma_f32_16x16x32_bf16 v[176:179],v[24:27],a[32:35],v[176:179]
 ds_read_b64_tr_b16 v[56:57],v7 offset:264
 ds_read_b64_tr_b16 v[58:59],v7 offset:6408
 v_mfma_f32_16x16x32_bf16 v[176:179],v[28:31],a[48:51],v[176:179]
 v_mfma_f32_16x16x32_bf16 v[180:183],v[28:31],a[52:55],v[180:183]
 ds_read_b64_tr_b16 v[60:61],v7 offset:12552
 ds_read_b64_tr_b16 v[62:63],v7 offset:18696
 v_mfma_f32_16x16x32_bf16 v[180:183],v[24:27],a[36:39],v[180:183]
 s_add_u32 m0,s46,7168
 s_add_u32 s45,s45,10240
 buffer_load_dwordx4 v8,s[24:27],s45 offen lds
 v_mfma_f32_16x16x32_bf16 v[184:187],v[24:27],a[40:43],v[184:187]
 v_mfma_f32_16x16x32_bf16 v[184:187],v[28:31],a[56:59],v[184:187]
 v_mfma_f32_16x16x32_bf16 v[188:191],v[28:31],a[60:63],v[188:191]
 v_mfma_f32_16x16x32_bf16 v[188:191],v[24:27],a[44:47],v[188:191]
 v_mfma_f32_16x16x32_bf16 v[192:195],v[32:35],a[32:35],v[192:195]
 v_mfma_f32_16x16x32_bf16 v[192:195],v[36:39],a[48:51],v[192:195]
 v_mfma_f32_16x16x32_bf16 v[196:199],v[36:39],a[52:55],v[196:199]
 v_mfma_f32_16x16x32_bf16 v[196:199],v[32:35],a[36:39],v[196:199]
 v_mfma_f32_16x16x32_bf16 v[200:203],v[32:35],a[40:43],v[200:203]
 s_mov_b32 s50,24576
 v_add_u32 v6,s50,v6
 v_add_u32 v7,s50,v7
 v_mfma_f32_16x16x32_bf16 v[200:203],v[36:39],a[56:59],v[200:203]
 v_mfma_f32_16x16x32_bf16 v[204:207],v[36:39],a[60:63],v[204:207]
 v_mfma_f32_16x16x32_bf16 v[204:207],v[32:35],a[44:47],v[204:207]
 s_waitcnt vmcnt(25) lgkmcnt(0)
 s_barrier
 v_mfma_f32_16x16x32_bf16 v[208:211],v[40:43],a[32:35],v[208:211]
 ds_read_b64_tr_b16 v[16:17],v6
 ds_read_b64_tr_b16 v[18:19],v6 offset:6144
 v_mfma_f32_16x16x32_bf16 v[208:211],v[44:47],a[48:51],v[208:211]
 s_add_u32 m0,s35,24576
 s_mul_i32 s44,s63,786432
 buffer_load_dwordx4 v10,s[20:23],s44 offen lds
 v_mfma_f32_16x16x32_bf16 v[212:215],v[44:47],a[52:55],v[212:215]
 s_add_u32 s63,s63,1
 ds_read_b64_tr_b16 v[20:21],v6 offset:12288
 ds_read_b64_tr_b16 v[22:23],v6 offset:18432
 v_mfma_f32_16x16x32_bf16 v[212:215],v[40:43],a[36:39],v[212:215]
 buffer_load_dwordx4 v11,s[20:23],s44 offen offset:1024 lds
 s_cmp_eq_u32 s63,10
 s_cselect_b32 s63,0,s63
 buffer_load_dwordx4 v12,s[20:23],s44 offen offset:2048 lds
 v_mfma_f32_16x16x32_bf16 v[216:219],v[40:43],a[40:43],v[216:219]
 ds_read_b64_tr_b16 v[24:25],v6 offset:8
 ds_read_b64_tr_b16 v[26:27],v6 offset:6152
 v_mfma_f32_16x16x32_bf16 v[216:219],v[44:47],a[56:59],v[216:219]
 s_add_u32 m0,s35,27648
 s_add_u32 s44,s44,196608
 buffer_load_dwordx4 v10,s[20:23],s44 offen lds
 v_mfma_f32_16x16x32_bf16 v[220:223],v[44:47],a[60:63],v[220:223]
 ds_read_b64_tr_b16 v[28:29],v6 offset:12296
 ds_read_b64_tr_b16 v[30:31],v6 offset:18440
 v_mfma_f32_16x16x32_bf16 v[220:223],v[40:43],a[44:47],v[220:223]
 v_mfma_f32_16x16x32_bf16 v[224:227],v[48:51],a[32:35],v[224:227]
 ds_read_b64_tr_b16 v[32:33],v7
 ds_read_b64_tr_b16 v[34:35],v7 offset:6144
 v_mfma_f32_16x16x32_bf16 v[224:227],v[52:55],a[48:51],v[224:227]
 buffer_load_dwordx4 v11,s[20:23],s44 offen offset:1024 lds
 v_mfma_f32_16x16x32_bf16 v[228:231],v[52:55],a[52:55],v[228:231]
 ds_read_b64_tr_b16 v[36:37],v7 offset:12288
 ds_read_b64_tr_b16 v[38:39],v7 offset:18432
 v_mfma_f32_16x16x32_bf16 v[228:231],v[48:51],a[36:39],v[228:231]
 v_mfma_f32_16x16x32_bf16 v[232:235],v[48:51],a[40:43],v[232:235]
 s_waitcnt vmcnt(19)
 ds_read_b128 a[0:3],v1 offset:32768
 ds_read_b128 a[16:19],v2 offset:32768
 v_mfma_f32_16x16x32_bf16 v[232:235],v[52:55],a[56:59],v[232:235]
 buffer_load_dwordx4 v12,s[20:23],s44 offen offset:2048 lds
 s_cmp_lg_u32 s32,0
 s_cbranch_scc1 Lf13
 v_mov_b32 v14,s51
 s_mov_b64 exec,1
 s_add_u32 s91,s90,0
 buffer_store_dword v14,off,s[92:95],s91 sc1
 s_mov_b64 exec,-1
Lf13:
 v_mfma_f32_16x16x32_bf16 v[236:239],v[52:55],a[60:63],v[236:239]
 ds_read_b128 a[4:7],v1 offset:34816
 ds_read_b128 a[20:23],v2 offset:34816
 v_mfma_f32_16x16x32_bf16 v[236:239],v[48:51],a[44:47],v[236:239]
 v_mfma_f32_16x16x32_bf16 v[240:243],v[56:59],a[32:35],v[240:243]
 ds_read_b128 a[8:11],v1 offset:36864
 ds_read_b128 a[24:27],v2 offset:36864
 v_mfma_f32_16x16x32_bf16 v[240:243],v[60:63],a[48:51],v[240:243]
 v_mfma_f32_16x16x32_bf16 v[244:247],v[60:63],a[52:55],v[244:247]
 ds_read_b128 a[12:15],v1 offset:38912
 ds_read_b128 a[28:31],v2 offset:38912
 v_mfma_f32_16x16x32_bf16 v[244:247],v[56:59],a[36:39],v[244:247]
 v_mfma_f32_16x16x32_bf16 v[248:251],v[56:59],a[40:43],v[248:251]
 v_mfma_f32_16x16x32_bf16 v[248:251],v[60:63],a[56:59],v[248:251]
 v_mfma_f32_16x16x32_bf16 v[252:255],v[60:63],a[60:63],v[252:255]
 v_mfma_f32_16x16x32_bf16 v[252:255],v[56:59],a[44:47],v[252:255]
 s_waitcnt lgkmcnt(0)
 v_mfma_f32_16x16x32_bf16 v[64:67],v[16:19],a[64:67],v[64:67]
 ds_read_b64_tr_b16 v[40:41],v7 offset:8
 ds_read_b64_tr_b16 v[42:43],v7 offset:6152
 v_mfma_f32_16x16x32_bf16 v[64:67],v[20:23],a[80:83],v[64:67]
 s_add_u32 m0,s46,32768
 s_lshl_b32 s45,s61,7
 buffer_load_dwordx4 v8,s[24:27],s45 offen lds
 v_mfma_f32_16x16x32_bf16 v[68:71],v[20:23],a[84:87],v[68:71]
 s_add_u32 s45,s45,10240
 ds_read_b64_tr_b16 v[44:45],v7 offset:12296
 ds_read_b64_tr_b16 v[46:47],v7 offset:18440
 v_mfma_f32_16x16x32_bf16 v[68:71],v[16:19],a[68:71],v[68:71]
 s_add_u32 m0,s46,33792
 s_add_u32 s61,s61,1
 buffer_load_dwordx4 v8,s[24:27],s45 offen lds
 v_mfma_f32_16x16x32_bf16 v[72:75],v[16:19],a[72:75],v[72:75]
 s_add_u32 s45,s45,10240
 ds_read_b64_tr_b16 v[48:49],v6 offset:128
 ds_read_b64_tr_b16 v[50:51],v6 offset:6272
 v_mfma_f32_16x16x32_bf16 v[72:75],v[20:23],a[88:91],v[72:75]
 s_cmp_eq_u32 s61,10
 s_cselect_b32 s61,0,s61
 s_add_u32 m0,s46,34816
 s_nop 0
 buffer_load_dwordx4 v8,s[24:27],s45 offen lds
 v_mfma_f32_16x16x32_bf16 v[76:79],v[20:23],a[92:95],v[76:79]
 ds_read_b64_tr_b16 v[52:53],v6 offset:12416
 ds_read_b64_tr_b16 v[54:55],v6 offset:18560
 v_mfma_f32_16x16x32_bf16 v[76:79],v[16:19],a[76:79],v[76:79]
 v_mfma_f32_16x16x32_bf16 v[80:83],v[24:27],a[64:67],v[80:83]
 ds_read_b64_tr_b16 v[56:57],v6 offset:136
 ds_read_b64_tr_b16 v[58:59],v6 offset:6280
 v_mfma_f32_16x16x32_bf16 v[80:83],v[28:31],a[80:83],v[80:83]
 v_mfma_f32_16x16x32_bf16 v[84:87],v[28:31],a[84:87],v[84:87]
 ds_read_b64_tr_b16 v[60:61],v6 offset:12424
 ds_read_b64_tr_b16 v[62:63],v6 offset:18568
 v_mfma_f32_16x16x32_bf16 v[84:87],v[24:27],a[68:71],v[84:87]
 s_add_u32 m0,s46,35840
 s_add_u32 s45,s45,10240
 buffer_load_dwordx4 v8,s[24:27],s45 offen lds
 v_mfma_f32_16x16x32_bf16 v[88:91],v[24:27],a[72:75],v[88:91]
 v_mfma_f32_16x16x32_bf16 v[88:91],v[28:31],a[88:91],v[88:91]
 v_mfma_f32_16x16x32_bf16 v[92:95],v[28:31],a[92:95],v[92:95]
 v_mfma_f32_16x16x32_bf16 v[92:95],v[24:27],a[76:79],v[92:95]
 v_mfma_f32_16x16x32_bf16 v[96:99],v[32:35],a[64:67],v[96:99]
 s_add_u32 m0,s46,36864
 s_add_u32 s45,s45,10240
 buffer_load_dwordx4 v8,s[24:27],s45 offen lds
 v_mfma_f32_16x16x32_bf16 v[96:99],v[36:39],a[80:83],v[96:99]
 v_mfma_f32_16x16x32_bf16 v[100:103],v[36:39],a[84:87],v[100:103]
 v_mfma_f32_16x16x32_bf16 v[100:103],v[32:35],a[68:71],v[100:103]
 v_mfma_f32_16x16x32_bf16 v[104:107],v[32:35],a[72:75],v[104:107]
 v_mfma_f32_16x16x32_bf16 v[104:107],v[36:39],a[88:91],v[104:107]
 v_mfma_f32_16x16x32_bf16 v[108:111],v[36:39],a[92:95],v[108:111]
 s_add_u32 m0,s46,37888
 s_add_u32 s45,s45,10240
 buffer_load_dwordx4 v8,s[24:27],s45 offen lds
 v_mfma_f32_16x16x32_bf16 v[108:111],v[32:35],a[76:79],v[108:111]
 s_waitcnt lgkmcnt(0)
 v_mfma_f32_16x16x32_bf16 v[112:115],v[40:43],a[64:67],v[112:115]
 ds_read_b64_tr_b16 v[16:17],v7 offset:128
 ds_read_b64_tr_b16 v[18:19],v7 offset:6272
 v_mfma_f32_16x16x32_bf16 v[112:115],v[44:47],a[80:83],v[112:115]
 v_mfma_f32_16x16x32_bf16 v[116:119],v[44:47],a[84:87],v[116:119]
 ds_read_b64_tr_b16 v[20:21],v7 offset:12416
 ds_read_b64_tr_b16 v[22:23],v7 offset:18560
 v_mfma_f32_16x16x32_bf16 v[116:119],v[40:43],a[68:71],v[116:119]
 v_mfma_f32_16x16x32_bf16 v[120:123],v[40:43],a[72:75],v[120:123]
 ds_read_b64_tr_b16 v[24:25],v7 offset:136
 ds_read_b64_tr_b16 v[26:27],v7 offset:6280
 v_mfma_f32_16x16x32_bf16 v[120:123],v[44:47],a[88:91],v[120:123]
 s_add_u32 m0,s46,38912
 s_add_u32 s45,s45,10240
 buffer_load_dwordx4 v8,s[24:27],s45 offen lds
 v_mfma_f32_16x16x32_bf16 v[124:127],v[44:47],a[92:95],v[124:127]
 ds_read_b64_tr_b16 v[28:29],v7 offset:12424
 ds_read_b64_tr_b16 v[30:31],v7 offset:18568
 v_mfma_f32_16x16x32_bf16 v[124:127],v[40:43],a[76:79],v[124:127]
 v_mfma_f32_16x16x32_bf16 v[128:131],v[48:51],a[64:67],v[128:131]
 ds_read_b64_tr_b16 v[32:33],v6 offset:256
 ds_read_b64_tr_b16 v[34:35],v6 offset:6400
 v_mfma_f32_16x16x32_bf16 v[128:131],v[52:55],a[80:83],v[128:131]
 v_mfma_f32_16x16x32_bf16 v[132:135],v[52:55],a[84:87],v[132:135]
 ds_read_b64_tr_b16 v[36:37],v6 offset:12544
 ds_read_b64_tr_b16 v[38:39],v6 offset:18688
 v_mfma_f32_16x16x32_bf16 v[132:135],v[48:51],a[68:71],v[132:135]
 s_add_u32 m0,s46,39936
 s_add_u32 s45,s45,10240
 buffer_load_dwordx4 v8,s[24:27],s45 offen lds
 v_mfma_f32_16x16x32_bf16 v[136:139],v[48:51],a[72:75],v[136:139]
 v_mfma_f32_16x16x32_bf16 v[136:139],v[52:55],a[88:91],v[136:139]
 v_mfma_f32_16x16x32_bf16 v[140:143],v[52:55],a[92:95],v[140:143]
 v_mfma_f32_16x16x32_bf16 v[140:143],v[48:51],a[76:79],v[140:143]
 v_mfma_f32_16x16x32_bf16 v[144:147],v[56:59],a[64:67],v[144:147]
 v_mfma_f32_16x16x32_bf16 v[144:147],v[60:63],a[80:83],v[144:147]
 v_mfma_f32_16x16x32_bf16 v[148:151],v[60:63],a[84:87],v[148:151]
 v_mfma_f32_16x16x32_bf16 v[148:151],v[56:59],a[68:71],v[148:151]
 v_mfma_f32_16x16x32_bf16 v[152:155],v[56:59],a[72:75],v[152:155]
 v_mfma_f32_16x16x32_bf16 v[152:155],v[60:63],a[88:91],v[152:155]
 v_mfma_f32_16x16x32_bf16 v[156:159],v[60:63],a[92:95],v[156:159]
 v_mfma_f32_16x16x32_bf16 v[156:159],v[56:59],a[76:79],v[156:159]
 s_waitcnt lgkmcnt(0)
 v_mfma_f32_16x16x32_bf16 v[160:163],v[16:19],a[64:67],v[160:163]
 ds_read_b64_tr_b16 v[40:41],v6 offset:264
 ds_read_b64_tr_b16 v[42:43],v6 offset:6408
 v_mfma_f32_16x16x32_bf16 v[160:163],v[20:23],a[80:83],v[160:163]
 v_mfma_f32_16x16x32_bf16 v[164:167],v[20:23],a[84:87],v[164:167]
 ds_read_b64_tr_b16 v[44:45],v6 offset:12552
 ds_read_b64_tr_b16 v[46:47],v6 offset:18696
 v_mfma_f32_16x16x32_bf16 v[164:167],v[16:19],a[68:71],v[164:167]
 v_mfma_f32_16x16x32_bf16 v[168:171],v[16:19],a[72:75],v[168:171]
 ds_read_b64_tr_b16 v[48:49],v7 offset:256
 ds_read_b64_tr_b16 v[50:51],v7 offset:6400
 v_mfma_f32_16x16x32_bf16 v[168:171],v[20:23],a[88:91],v[168:171]
 v_mfma_f32_16x16x32_bf16 v[172:175],v[20:23],a[92:95],v[172:175]
 ds_read_b64_tr_b16 v[52:53],v7 offset:12544
 ds_read_b64_tr_b16 v[54:55],v7 offset:18688
 v_mfma_f32_16x16x32_bf16 v[172:175],v[16:19],a[76:79],v[172:175]
 v_mfma_f32_16x16x32_bf16 v[176:179],v[24:27],a[64:67],v[176:179]
 ds_read_b64_tr_b16 v[56:57],v7 offset:264
 ds_read_b64_tr_b16 v[58:59],v7 offset:6408
 v_mfma_f32_16x16x32_bf16 v[176:179],v[28:31],a[80:83],v[176:179]
 v_mfma_f32_16x16x32_bf16 v[180:183],v[28:31],a[84:87],v[180:183]
 ds_read_b64_tr_b16 v[60:61],v7 offset:12552
 ds_read_b64_tr_b16 v[62:63],v7 offset:18696
 v_mfma_f32_16x16x32_bf16 v[180:183],v[24:27],a[68:71],v[180:183]
 v_mfma_f32_16x16x32_bf16 v[184:187],v[24:27],a[72:75],v[184:187]
 s_waitcnt vmcnt(14)
 ds_read_b128 a[32:35],v1
 ds_read_b128 a[48:51],v2
 v_mfma_f32_16x16x32_bf16 v[184:187],v[28:31],a[88:91],v[184:187]
 v_mfma_f32_16x16x32_bf16 v[188:191],v[28:31],a[92:95],v[188:191]
 ds_read_b128 a[36:39],v1 offset:2048
 ds_read_b128 a[52:55],v2 offset:2048
 v_mfma_f32_16x16x32_bf16 v[188:191],v[24:27],a[76:79],v[188:191]
 v_mfma_f32_16x16x32_bf16 v[192:195],v[32:35],a[64:67],v[192:195]
 ds_read_b128 a[40:43],v1 offset:4096
 ds_read_b128 a[56:59],v2 offset:4096
 v_mfma_f32_16x16x32_bf16 v[192:195],v[36:39],a[80:83],v[192:195]
 v_mfma_f32_16x16x32_bf16 v[196:199],v[36:39],a[84:87],v[196:199]
 ds_read_b128 a[44:47],v1 offset:6144
 ds_read_b128 a[60:63],v2 offset:6144
 v_mfma_f32_16x16x32_bf16 v[196:199],v[32:35],a[68:71],v[196:199]
 v_mfma_f32_16x16x32_bf16 v[200:203],v[32:35],a[72:75],v[200:203]
 s_mov_b32 s50,24576
 v_add_u32 v6,s50,v6
 v_add_u32 v7,s50,v7
 v_mfma_f32_16x16x32_bf16 v[200:203],v[36:39],a[88:91],v[200:203]
 v_mfma_f32_16x16x32_bf16 v[204:207],v[36:39],a[92:95],v[204:207]
 v_mfma_f32_16x16x32_bf16 v[204:207],v[32:35],a[76:79],v[204:207]
 s_waitcnt vmcnt(36) lgkmcnt(0)
 s_barrier
 v_mfma_f32_16x16x32_bf16 v[208:211],v[40:43],a[64:67],v[208:211]
 ds_read_b64_tr_b16 v[16:17],v6
 ds_read_b64_tr_b16 v[18:19],v6 offset:6144
 v_mfma_f32_16x16x32_bf16 v[208:211],v[44:47],a[80:83],v[208:211]
 s_add_u32 m0,s35,49152
 s_mul_i32 s44,s63,786432
 buffer_load_dwordx4 v10,s[20:23],s44 offen lds
 v_mfma_f32_16x16x32_bf16 v[212:215],v[44:47],a[84:87],v[212:215]
 ds_read_b64_tr_b16 v[20:21],v6 offset:12288
 ds_read_b64_tr_b16 v[22:23],v6 offset:18432
 v_mfma_f32_16x16x32_bf16 v[212:215],v[40:43],a[68:71],v[212:215]
 s_add_u32 m0,s46,0
 s_lshl_b32 s45,s61,7
 buffer_load_dwordx4 v8,s[24:27],s45 offen lds
 v_mfma_f32_16x16x32_bf16 v[216:219],v[40:43],a[72:75],v[216:219]
 ds_read_b64_tr_b16 v[24:25],v6 offset:8
 ds_read_b64_tr_b16 v[26:27],v6 offset:6152
 v_mfma_f32_16x16x32_bf16 v[216:219],v[44:47],a[88:91],v[216:219]
 s_add_u32 m0,s35,49152
 s_add_u32 s63,s63,1
 buffer_load_dwordx4 v11,s[20:23],s44 offen offset:1024 lds
 v_mfma_f32_16x16x32_bf16 v[220:223],v[44:47],a[92:95],v[220:223]
 s_add_u32 s45,s45,10240
 ds_read_b64_tr_b16 v[28:29],v6 offset:12296
 ds_read_b64_tr_b16 v[30:31],v6 offset:18440
 v_mfma_f32_16x16x32_bf16 v[220:223],v[40:43],a[76:79],v[220:223]
 s_add_u32 m0,s46,1024
 s_add_u32 s61,s61,1
 buffer_load_dwordx4 v8,s[24:27],s45 offen lds
 v_mfma_f32_16x16x32_bf16 v[224:227],v[48:51],a[64:67],v[224:227]
 ds_read_b64_tr_b16 v[32:33],v7
 ds_read_b64_tr_b16 v[34:35],v7 offset:6144
 v_mfma_f32_16x16x32_bf16 v[224:227],v[52:55],a[80:83],v[224:227]
 v_mfma_f32_16x16x32_bf16 v[228:231],v[52:55],a[84:87],v[228:231]
 s_add_u32 s45,s45,10240
 ds_read_b64_tr_b16 v[36:37],v7 offset:12288
 ds_read_b64_tr_b16 v[38:39],v7 offset:18432
 v_mfma_f32_16x16x32_bf16 v[228:231],v[48:51],a[68:71],v[228:231]
 s_cmp_eq_u32 s61,10
 s_cselect_b32 s61,0,s61
 v_mfma_f32_16x16x32_bf16 v[232:235],v[48:51],a[72:75],v[232:235]
 s_add_u32 m0,s46,2048
 s_nop 0
 buffer_load_dwordx4 v8,s[24:27],s45 offen lds
 v_mfma_f32_16x16x32_bf16 v[232:235],v[52:55],a[88:91],v[232:235]
 v_mfma_f32_16x16x32_bf16 v[236:239],v[52:55],a[92:95],v[236:239]
 v_mfma_f32_16x16x32_bf16 v[236:239],v[48:51],a[76:79],v[236:239]
 v_mfma_f32_16x16x32_bf16 v[240:243],v[56:59],a[64:67],v[240:243]
 v_mfma_f32_16x16x32_bf16 v[240:243],v[60:63],a[80:83],v[240:243]
 v_mfma_f32_16x16x32_bf16 v[244:247],v[60:63],a[84:87],v[244:247]
 s_add_u32 m0,s46,3072
 s_add_u32 s45,s45,10240
 buffer_load_dwordx4 v8,s[24:27],s45 offen lds
 v_mfma_f32_16x16x32_bf16 v[244:247],v[56:59],a[68:71],v[244:247]
 v_mfma_f32_16x16x32_bf16 v[248:251],v[56:59],a[72:75],v[248:251]
 v_mfma_f32_16x16x32_bf16 v[248:251],v[60:63],a[88:91],v[248:251]
 v_mfma_f32_16x16x32_bf16 v[252:255],v[60:63],a[92:95],v[252:255]
 v_mfma_f32_16x16x32_bf16 v[252:255],v[56:59],a[76:79],v[252:255]
 s_waitcnt lgkmcnt(0)
 v_mfma_f32_16x16x32_bf16 v[64:67],v[16:19],a[0:3],v[64:67]
 ds_read_b64_tr_b16 v[40:41],v7 offset:8
 ds_read_b64_tr_b16 v[42:43],v7 offset:6152
 v_mfma_f32_16x16x32_bf16 v[64:67],v[20:23],a[16:19],v[64:67]
 s_add_u32 m0,s46,4096
 s_add_u32 s45,s45,10240
 buffer_load_dwordx4 v8,s[24:27],s45 offen lds
 v_mfma_f32_16x16x32_bf16 v[68:71],v[20:23],a[20:23],v[68:71]
 ds_read_b64_tr_b16 v[44:45],v7 offset:12296
 ds_read_b64_tr_b16 v[46:47],v7 offset:18440
 v_mfma_f32_16x16x32_bf16 v[68:71],v[16:19],a[4:7],v[68:71]
 v_mfma_f32_16x16x32_bf16 v[72:75],v[16:19],a[8:11],v[72:75]
 ds_read_b64_tr_b16 v[48:49],v6 offset:128
 ds_read_b64_tr_b16 v[50:51],v6 offset:6272
 v_mfma_f32_16x16x32_bf16 v[72:75],v[20:23],a[24:27],v[72:75]
 v_mfma_f32_16x16x32_bf16 v[76:79],v[20:23],a[28:31],v[76:79]
 ds_read_b64_tr_b16 v[52:53],v6 offset:12416
 ds_read_b64_tr_b16 v[54:55],v6 offset:18560
 v_mfma_f32_16x16x32_bf16 v[76:79],v[16:19],a[12:15],v[76:79]
 s_add_u32 m0,s46,5120
 s_add_u32 s45,s45,10240
 buffer_load_dwordx4 v8,s[24:27],s45 offen lds
 v_mfma_f32_16x16x32_bf16 v[80:83],v[24:27],a[0:3],v[80:83]
 ds_read_b64_tr_b16 v[56:57],v6 offset:136
 ds_read_b64_tr_b16 v[58:59],v6 offset:6280
 v_mfma_f32_16x16x32_bf16 v[80:83],v[28:31],a[16:19],v[80:83]
 v_mfma_f32_16x16x32_bf16 v[84:87],v[28:31],a[20:23],v[84:87]
 ds_read_b64_tr_b16 v[60:61],v6 offset:12424
 ds_read_b64_tr_b16 v[62:63],v6 offset:18568
 v_mfma_f32_16x16x32_bf16 v[84:87],v[24:27],a[4:7],v[84:87]
 v_mfma_f32_16x16x32_bf16 v[88:91],v[24:27],a[8:11],v[88:91]
 s_add_u32 m0,s46,6144
 s_add_u32 s45,s45,10240
 buffer_load_dwordx4 v8,s[24:27],s45 offen lds
 v_mfma_f32_16x16x32_bf16 v[88:91],v[28:31],a[24:27],v[88:91]
 v_mfma_f32_16x16x32_bf16 v[92:95],v[28:31],a[28:31],v[92:95]
 v_mfma_f32_16x16x32_bf16 v[92:95],v[24:27],a[12:15],v[92:95]
 v_mfma_f32_16x16x32_bf16 v[96:99],v[32:35],a[0:3],v[96:99]
 v_mfma_f32_16x16x32_bf16 v[96:99],v[36:39],a[16:19],v[96:99]
 v_mfma_f32_16x16x32_bf16 v[100:103],v[36:39],a[20:23],v[100:103]
 s_add_u32 m0,s46,7168
 s_add_u32 s45,s45,10240
 buffer_load_dwordx4 v8,s[24:27],s45 offen lds
 v_mfma_f32_16x16x32_bf16 v[100:103],v[32:35],a[4:7],v[100:103]
 v_mfma_f32_16x16x32_bf16 v[104:107],v[32:35],a[8:11],v[104:107]
 v_mfma_f32_16x16x32_bf16 v[104:107],v[36:39],a[24:27],v[104:107]
 v_mfma_f32_16x16x32_bf16 v[108:111],v[36:39],a[28:31],v[108:111]
 v_mfma_f32_16x16x32_bf16 v[108:111],v[32:35],a[12:15],v[108:111]
 s_cmp_eq_u32 s63,10
 s_cselect_b32 s63,0,s63
 s_waitcnt lgkmcnt(0)
 v_mfma_f32_16x16x32_bf16 v[112:115],v[40:43],a[0:3],v[112:115]
 ds_read_b64_tr_b16 v[16:17],v7 offset:128
 ds_read_b64_tr_b16 v[18:19],v7 offset:6272
 v_mfma_f32_16x16x32_bf16 v[112:115],v[44:47],a[16:19],v[112:115]
 s_add_u32 m0,s35,49152
 s_nop 0
 buffer_load_dwordx4 v12,s[20:23],s44 offen offset:2048 lds
 v_mfma_f32_16x16x32_bf16 v[116:119],v[44:47],a[20:23],v[116:119]
 ds_read_b64_tr_b16 v[20:21],v7 offset:12416
 ds_read_b64_tr_b16 v[22:23],v7 offset:18560
 v_mfma_f32_16x16x32_bf16 v[116:119],v[40:43],a[4:7],v[116:119]
 v_mfma_f32_16x16x32_bf16 v[120:123],v[40:43],a[8:11],v[120:123]
 ds_read_b64_tr_b16 v[24:25],v7 offset:136
 ds_read_b64_tr_b16 v[26:27],v7 offset:6280
 v_mfma_f32_16x16x32_bf16 v[120:123],v[44:47],a[24:27],v[120:123]
 s_add_u32 m0,s35,52224
 s_add_u32 s44,s44,196608
 buffer_load_dwordx4 v10,s[20:23],s44 offen lds
 v_mfma_f32_16x16x32_bf16 v[124:127],v[44:47],a[28:31],v[124:127]
 ds_read_b64_tr_b16 v[28:29],v7 offset:12424
 ds_read_b64_tr_b16 v[30:31],v7 offset:18568
 v_mfma_f32_16x16x32_bf16 v[124:127],v[40:43],a[12:15],v[124:127]
 v_and_b32 v4,1,v0
 v_lshlrev_b32 v4,2,v4
 v_mfma_f32_16x16x32_bf16 v[128:131],v[48:51],a[0:3],v[128:131]
 ds_read_b64_tr_b16 v[32:33],v6 offset:256
 ds_read_b64_tr_b16 v[34:35],v6 offset:6400
 v_mfma_f32_16x16x32_bf16 v[128:131],v[52:55],a[16:19],v[128:131]
 buffer_load_dwordx4 v11,s[20:23],s44 offen offset:1024 lds
 s_lshl_b32 s41,s34,6
 s_lshl_b32 s42,s52,3
 s_add_u32 s41,s41,s42
 v_mfma_f32_16x16x32_bf16 v[132:135],v[52:55],a[20:23],v[132:135]
 ds_read_b64_tr_b16 v[36:37],v6 offset:12544
 ds_read_b64_tr_b16 v[38:39],v6 offset:18688
 v_mfma_f32_16x16x32_bf16 v[132:135],v[48:51],a[4:7],v[132:135]
 s_add_u32 s41,s41,6144
 v_add_u32 v4,s41,v4
 v_lshlrev_b32 v5,8,v0
 v_mfma_f32_16x16x32_bf16 v[136:139],v[48:51],a[8:11],v[136:139]
 s_waitcnt vmcnt(13)
 ds_read_b128 a[64:67],v1 offset:32768
 ds_read_b128 a[80:83],v2 offset:32768
 v_mfma_f32_16x16x32_bf16 v[136:139],v[52:55],a[24:27],v[136:139]
 buffer_load_dwordx4 v12,s[20:23],s44 offen offset:2048 lds
 s_lshl_b32 s41,s33,2
 s_add_u32 s41,s41,128
 v_add_u32 v5,s41,v5
 v_mfma_f32_16x16x32_bf16 v[140:143],v[52:55],a[28:31],v[140:143]
 ds_read_b128 a[68:71],v1 offset:34816
 ds_read_b128 a[84:87],v2 offset:34816
 v_mfma_f32_16x16x32_bf16 v[140:143],v[48:51],a[12:15],v[140:143]
 v_cmp_gt_u32 vcc,4,v0
 s_nop 1
 v_cndmask_b32 v4,v4,v5,vcc
 v_mfma_f32_16x16x32_bf16 v[144:147],v[56:59],a[0:3],v[144:147]
 ds_read_b128 a[72:75],v1 offset:36864
 ds_read_b128 a[88:91],v2 offset:36864
 v_mfma_f32_16x16x32_bf16 v[144:147],v[60:63],a[16:19],v[144:147]
 buffer_load_dword v5,v4,s[92:95],0 offen sc1
 v_mfma_f32_16x16x32_bf16 v[148:151],v[60:63],a[20:23],v[148:151]
 ds_read_b128 a[76:79],v1 offset:38912
 ds_read_b128 a[92:95],v2 offset:38912
 v_mfma_f32_16x16x32_bf16 v[148:151],v[56:59],a[4:7],v[148:151]
 v_mfma_f32_16x16x32_bf16 v[152:155],v[56:59],a[8:11],v[152:155]
 v_mfma_f32_16x16x32_bf16 v[152:155],v[60:63],a[24:27],v[152:155]
 v_mfma_f32_16x16x32_bf16 v[156:159],v[60:63],a[28:31],v[156:159]
 v_mfma_f32_16x16x32_bf16 v[156:159],v[56:59],a[12:15],v[156:159]
 s_waitcnt lgkmcnt(0)
 v_mfma_f32_16x16x32_bf16 v[160:163],v[16:19],a[0:3],v[160:163]
 ds_read_b64_tr_b16 v[40:41],v6 offset:264
 ds_read_b64_tr_b16 v[42:43],v6 offset:6408
 v_mfma_f32_16x16x32_bf16 v[160:163],v[20:23],a[16:19],v[160:163]
 v_mfma_f32_16x16x32_bf16 v[164:167],v[20:23],a[20:23],v[164:167]
 ds_read_b64_tr_b16 v[44:45],v6 offset:12552
 ds_read_b64_tr_b16 v[46:47],v6 offset:18696
 v_mfma_f32_16x16x32_bf16 v[164:167],v[16:19],a[4:7],v[164:167]
 v_mfma_f32_16x16x32_bf16 v[168:171],v[16:19],a[8:11],v[168:171]
 ds_read_b64_tr_b16 v[48:49],v7 offset:256
 ds_read_b64_tr_b16 v[50:51],v7 offset:6400
 v_mfma_f32_16x16x32_bf16 v[168:171],v[20:23],a[24:27],v[168:171]
 v_mfma_f32_16x16x32_bf16 v[172:175],v[20:23],a[28:31],v[172:175]
 ds_read_b64_tr_b16 v[52:53],v7 offset:12544
 ds_read_b64_tr_b16 v[54:55],v7 offset:18688
 v_mfma_f32_16x16x32_bf16 v[172:175],v[16:19],a[12:15],v[172:175]
 v_mfma_f32_16x16x32_bf16 v[176:179],v[24:27],a[0:3],v[176:179]
 ds_read_b64_tr_b16 v[56:57],v7 offset:264
 ds_read_b64_tr_b16 v[58:59],v7 offset:6408
 v_mfma_f32_16x16x32_bf16 v[176:179],v[28:31],a[16:19],v[176:179]
 v_mfma_f32_16x16x32_bf16 v[180:183],v[28:31],a[20:23],v[180:183]
 ds_read_b64_tr_b16 v[60:61],v7 offset:12552
 ds_read_b64_tr_b16 v[62:63],v7 offset:18696
 v_mfma_f32_16x16x32_bf16 v[180:183],v[24:27],a[4:7],v[180:183]
 v_mfma_f32_16x16x32_bf16 v[184:187],v[24:27],a[8:11],v[184:187]
 v_mfma_f32_16x16x32_bf16 v[184:187],v[28:31],a[24:27],v[184:187]
 v_mfma_f32_16x16x32_bf16 v[188:191],v[28:31],a[28:31],v[188:191]
 v_mfma_f32_16x16x32_bf16 v[188:191],v[24:27],a[12:15],v[188:191]
 v_mfma_f32_16x16x32_bf16 v[192:195],v[32:35],a[0:3],v[192:195]
 v_mfma_f32_16x16x32_bf16 v[192:195],v[36:39],a[16:19],v[192:195]
 v_mfma_f32_16x16x32_bf16 v[196:199],v[36:39],a[20:23],v[196:199]
 v_mfma_f32_16x16x32_bf16 v[196:199],v[32:35],a[4:7],v[196:199]
 v_mfma_f32_16x16x32_bf16 v[200:203],v[32:35],a[8:11],v[200:203]
 s_mov_b32 s50,-73728
 v_add_u32 v6,s50,v6
 v_add_u32 v7,s50,v7
 v_mfma_f32_16x16x32_bf16 v[200:203],v[36:39],a[24:27],v[200:203]
 v_min_u32 v15,12,v0
 v_lshlrev_b32 v15,7,v15
 v_mfma_f32_16x16x32_bf16 v[204:207],v[36:39],a[28:31],v[204:207]
 s_add_u32 s41,s62,s32
 s_mul_i32 s41,s41,1600
 v_add_u32 v15,s41,v15
 v_mfma_f32_16x16x32_bf16 v[204:207],v[32:35],a[12:15],v[204:207]
 s_waitcnt vmcnt(37) lgkmcnt(0)
 s_barrier
 v_mfma_f32_16x16x32_bf16 v[208:211],v[40:43],a[0:3],v[208:211]
 ds_read_b64_tr_b16 v[16:17],v6
 ds_read_b64_tr_b16 v[18:19],v6 offset:6144
 v_mfma_f32_16x16x32_bf16 v[208:211],v[44:47],a[16:19],v[208:211]
 s_add_u32 m0,s49,0
 s_movk_i32 s45,0
 buffer_load_dwordx4 v8,s[4:7],s45 offen lds
 v_mfma_f32_16x16x32_bf16 v[212:215],v[44:47],a[20:23],v[212:215]
 ds_read_b64_tr_b16 v[20:21],v6 offset:12288
 ds_read_b64_tr_b16 v[22:23],v6 offset:18432
 v_mfma_f32_16x16x32_bf16 v[212:215],v[40:43],a[4:7],v[212:215]
 global_load_dword a108,v15,s[74:75]
 v_mfma_f32_16x16x32_bf16 v[216:219],v[40:43],a[8:11],v[216:219]
 ds_read_b64_tr_b16 v[24:25],v6 offset:8
 ds_read_b64_tr_b16 v[26:27],v6 offset:6152
 v_mfma_f32_16x16x32_bf16 v[216:219],v[44:47],a[24:27],v[216:219]
 s_add_u32 m0,s49,1024
 s_movk_i32 s45,10240
 buffer_load_dwordx4 v8,s[4:7],s45 offen lds
 v_mfma_f32_16x16x32_bf16 v[220:223],v[44:47],a[28:31],v[220:223]
 ds_read_b64_tr_b16 v[28:29],v6 offset:12296
 ds_read_b64_tr_b16 v[30:31],v6 offset:18440
 v_mfma_f32_16x16x32_bf16 v[220:223],v[40:43],a[12:15],v[220:223]
 v_mfma_f32_16x16x32_bf16 v[224:227],v[48:51],a[0:3],v[224:227]
 ds_read_b64_tr_b16 v[32:33],v7
 ds_read_b64_tr_b16 v[34:35],v7 offset:6144
 v_mfma_f32_16x16x32_bf16 v[224:227],v[52:55],a[16:19],v[224:227]
 v_mfma_f32_16x16x32_bf16 v[228:231],v[52:55],a[20:23],v[228:231]
 ds_read_b64_tr_b16 v[36:37],v7 offset:12288
 ds_read_b64_tr_b16 v[38:39],v7 offset:18432
 v_mfma_f32_16x16x32_bf16 v[228:231],v[48:51],a[4:7],v[228:231]
 s_add_u32 m0,s49,2048
 s_movk_i32 s45,20480
 buffer_load_dwordx4 v8,s[4:7],s45 offen lds
 v_mfma_f32_16x16x32_bf16 v[232:235],v[48:51],a[8:11],v[232:235]
 v_mfma_f32_16x16x32_bf16 v[232:235],v[52:55],a[24:27],v[232:235]
 v_mfma_f32_16x16x32_bf16 v[236:239],v[52:55],a[28:31],v[236:239]
 v_mfma_f32_16x16x32_bf16 v[236:239],v[48:51],a[12:15],v[236:239]
 v_mfma_f32_16x16x32_bf16 v[240:243],v[56:59],a[0:3],v[240:243]
 v_mfma_f32_16x16x32_bf16 v[240:243],v[60:63],a[16:19],v[240:243]
 v_mfma_f32_16x16x32_bf16 v[244:247],v[60:63],a[20:23],v[244:247]
 v_mfma_f32_16x16x32_bf16 v[244:247],v[56:59],a[4:7],v[244:247]
 v_mfma_f32_16x16x32_bf16 v[248:251],v[56:59],a[8:11],v[248:251]
 v_mfma_f32_16x16x32_bf16 v[248:251],v[60:63],a[24:27],v[248:251]
 s_add_u32 m0,s49,3072
 s_movk_i32 s45,30720
 buffer_load_dwordx4 v8,s[4:7],s45 offen lds
 v_mfma_f32_16x16x32_bf16 v[252:255],v[60:63],a[28:31],v[252:255]
 v_mfma_f32_16x16x32_bf16 v[252:255],v[56:59],a[12:15],v[252:255]
 s_waitcnt lgkmcnt(0)
 v_mfma_f32_16x16x32_bf16 v[64:67],v[16:19],a[32:35],v[64:67]
 ds_read_b64_tr_b16 v[40:41],v7 offset:8
 ds_read_b64_tr_b16 v[42:43],v7 offset:6152
 v_mfma_f32_16x16x32_bf16 v[64:67],v[20:23],a[48:51],v[64:67]
 s_waitcnt vmcnt(5)
 v_cmp_ne_u32 vcc,s51,v5
 s_nop 1
 s_cbranch_vccnz Lp14_spin
Lp14_ok:
 v_mfma_f32_16x16x32_bf16 v[68:71],v[20:23],a[52:55],v[68:71]
 ds_read_b64_tr_b16 v[44:45],v7 offset:12296
 ds_read_b64_tr_b16 v[46:47],v7 offset:18440
 v_mfma_f32_16x16x32_bf16 v[68:71],v[16:19],a[36:39],v[68:71]
 v_lshlrev_b32 v4,1,v13
 v_mfma_f32_16x16x32_bf16 v[72:75],v[16:19],a[40:43],v[72:75]
 s_mul_i32 s1,s33,3072
 s_add_u32 s1,s1,5505024
 ds_read_b64_tr_b16 v[48:49],v6 offset:128
 ds_read_b64_tr_b16 v[50:51],v6 offset:6272
 v_mfma_f32_16x16x32_bf16 v[72:75],v[20:23],a[56:59],v[72:75]
 buffer_load_dwordx4 a[192:195],v4,s[28:31],s1 offen sc1
 buffer_load_dwordx4 a[196:199],v4,s[28:31],s1 offen offset:256 sc1
 v_mfma_f32_16x16x32_bf16 v[76:79],v[20:23],a[60:63],v[76:79]
 ds_read_b64_tr_b16 v[52:53],v6 offset:12416
 ds_read_b64_tr_b16 v[54:55],v6 offset:18560
 v_mfma_f32_16x16x32_bf16 v[76:79],v[16:19],a[44:47],v[76:79]
 buffer_load_dwordx4 a[200:203],v4,s[28:31],s1 offen offset:512 sc1
 buffer_load_dwordx4 a[204:207],v4,s[28:31],s1 offen offset:768 sc1
 v_mfma_f32_16x16x32_bf16 v[80:83],v[24:27],a[32:35],v[80:83]
 ds_read_b64_tr_b16 v[56:57],v6 offset:136
 ds_read_b64_tr_b16 v[58:59],v6 offset:6280
 v_mfma_f32_16x16x32_bf16 v[80:83],v[28:31],a[48:51],v[80:83]
 v_mfma_f32_16x16x32_bf16 v[84:87],v[28:31],a[52:55],v[84:87]
 ds_read_b64_tr_b16 v[60:61],v6 offset:12424
 ds_read_b64_tr_b16 v[62:63],v6 offset:18568
 v_mfma_f32_16x16x32_bf16 v[84:87],v[24:27],a[36:39],v[84:87]
 buffer_load_dwordx4 a[208:211],v4,s[28:31],s1 offen offset:1024 sc1
 v_mfma_f32_16x16x32_bf16 v[88:91],v[24:27],a[40:43],v[88:91]
 s_waitcnt vmcnt(15)
 ds_read_b128 a[0:3],v1
 ds_read_b128 a[16:19],v2
 v_mfma_f32_16x16x32_bf16 v[88:91],v[28:31],a[56:59],v[88:91]
 v_mfma_f32_16x16x32_bf16 v[92:95],v[28:31],a[60:63],v[92:95]
 ds_read_b128 a[4:7],v1 offset:2048
 ds_read_b128 a[20:23],v2 offset:2048
 v_mfma_f32_16x16x32_bf16 v[92:95],v[24:27],a[44:47],v[92:95]
 buffer_load_dwordx4 a[212:215],v4,s[28:31],s1 offen offset:1280 sc1
 v_mfma_f32_16x16x32_bf16 v[96:99],v[32:35],a[32:35],v[96:99]
 ds_read_b128 a[8:11],v1 offset:4096
 ds_read_b128 a[24:27],v2 offset:4096
 v_mfma_f32_16x16x32_bf16 v[96:99],v[36:39],a[48:51],v[96:99]
 v_mfma_f32_16x16x32_bf16 v[100:103],v[36:39],a[52:55],v[100:103]
 ds_read_b128 a[12:15],v1 offset:6144
 ds_read_b128 a[28:31],v2 offset:6144
 v_mfma_f32_16x16x32_bf16 v[100:103],v[32:35],a[36:39],v[100:103]
 buffer_load_dwordx4 a[216:219],v4,s[28:31],s1 offen offset:1536 sc1
 v_mfma_f32_16x16x32_bf16 v[104:107],v[32:35],a[40:43],v[104:107]
 v_mfma_f32_16x16x32_bf16 v[104:107],v[36:39],a[56:59],v[104:107]
 v_mfma_f32_16x16x32_bf16 v[108:111],v[36:39],a[60:63],v[108:111]
 buffer_load_dwordx4 a[220:223],v4,s[28:31],s1 offen offset:1792 sc1
 v_mfma_f32_16x16x32_bf16 v[108:111],v[32:35],a[44:47],v[108:111]
 s_waitcnt lgkmcnt(0)
 v_mfma_f32_16x16x32_bf16 v[112:115],v[40:43],a[32:35],v[112:115]
 ds_read_b64_tr_b16 v[16:17],v7 offset:128
 ds_read_b64_tr_b16 v[18:19],v7 offset:6272
 v_mfma_f32_16x16x32_bf16 v[112:115],v[44:47],a[48:51],v[112:115]
 v_add_u32 v14,0,v0
 v_mul_u32_u24 v14,2731,v14
 v_mfma_f32_16x16x32_bf16 v[116:119],v[44:47],a[52:55],v[116:119]
 ds_read_b64_tr_b16 v[20:21],v7 offset:12416
 ds_read_b64_tr_b16 v[22:23],v7 offset:18560
 v_mfma_f32_16x16x32_bf16 v[116:119],v[40:43],a[36:39],v[116:119]
 buffer_load_dwordx4 a[224:227],v4,s[28:31],s1 offen offset:2048 sc1
 v_lshrrev_b32 v14,16,v14
 v_and_b32 v15,6,v14
 v_mfma_f32_16x16x32_bf16 v[120:123],v[40:43],a[40:43],v[120:123]
 ds_read_b64_tr_b16 v[24:25],v7 offset:136
 ds_read_b64_tr_b16 v[26:27],v7 offset:6280
 v_mfma_f32_16x16x32_bf16 v[120:123],v[44:47],a[56:59],v[120:123]
 v_xor_b32 v15,v15,v0
 v_lshlrev_b32 v1,4,v15
 v_mfma_f32_16x16x32_bf16 v[124:127],v[44:47],a[60:63],v[124:127]
 buffer_load_dwordx4 a[228:231],v4,s[28:31],s1 offen offset:2304 sc1
 ds_read_b64_tr_b16 v[28:29],v7 offset:12424
 ds_read_b64_tr_b16 v[30:31],v7 offset:18568
 v_mfma_f32_16x16x32_bf16 v[124:127],v[40:43],a[44:47],v[124:127]
 v_add_u32 v14,64,v0
 v_mul_u32_u24 v14,2731,v14
 v_mfma_f32_16x16x32_bf16 v[128:131],v[48:51],a[32:35],v[128:131]
 ds_read_b64_tr_b16 v[32:33],v6 offset:256
 ds_read_b64_tr_b16 v[34:35],v6 offset:6400
 v_mfma_f32_16x16x32_bf16 v[128:131],v[52:55],a[48:51],v[128:131]
 v_lshrrev_b32 v14,16,v14
 v_and_b32 v15,6,v14
 v_mfma_f32_16x16x32_bf16 v[132:135],v[52:55],a[52:55],v[132:135]
 buffer_load_dwordx4 a[232:235],v4,s[28:31],s1 offen offset:2560 sc1
 ds_read_b64_tr_b16 v[36:37],v6 offset:12544
 ds_read_b64_tr_b16 v[38:39],v6 offset:18688
 v_mfma_f32_16x16x32_bf16 v[132:135],v[48:51],a[36:39],v[132:135]
 v_xor_b32 v15,v15,v0
 v_lshlrev_b32 v2,4,v15
 v_mfma_f32_16x16x32_bf16 v[136:139],v[48:51],a[40:43],v[136:139]
 v_add_u32 v14,128,v0
 v_mul_u32_u24 v14,2731,v14
 v_mfma_f32_16x16x32_bf16 v[136:139],v[52:55],a[56:59],v[136:139]
 v_lshrrev_b32 v14,16,v14
 v_and_b32 v15,6,v14
 v_mfma_f32_16x16x32_bf16 v[140:143],v[52:55],a[60:63],v[140:143]
 v_xor_b32 v15,v15,v0
 v_lshlrev_b32 v3,4,v15
 v_mfma_f32_16x16x32_bf16 v[140:143],v[48:51],a[44:47],v[140:143]
 buffer_load_dwordx4 a[236:239],v4,s[28:31],s1 offen offset:2816 sc1
 v_mfma_f32_16x16x32_bf16 v[144:147],v[56:59],a[32:35],v[144:147]
 s_add_u32 m0,s35,73728
 s_mov_b32 s44,24576
 buffer_load_dwordx4 v1,s[12:15],s44 offen lds
 v_mfma_f32_16x16x32_bf16 v[144:147],v[60:63],a[48:51],v[144:147]
 buffer_load_dwordx4 v2,s[12:15],s44 offen offset:1024 lds
 v_mfma_f32_16x16x32_bf16 v[148:151],v[60:63],a[52:55],v[148:151]
 buffer_load_dwordx4 v3,s[12:15],s44 offen offset:2048 lds
 s_lshl_b32 s1,s52,3
 v_mfma_f32_16x16x32_bf16 v[148:151],v[56:59],a[36:39],v[148:151]
 s_add_u32 m0,s35,76800
 s_add_u32 s44,s44,3072
 buffer_load_dwordx4 v1,s[12:15],s44 offen lds
 v_mfma_f32_16x16x32_bf16 v[152:155],v[56:59],a[40:43],v[152:155]
 s_add_u32 s1,s1,s34
 v_mfma_f32_16x16x32_bf16 v[152:155],v[60:63],a[56:59],v[152:155]
 s_lshl_b32 s1,s1,2
 v_mfma_f32_16x16x32_bf16 v[156:159],v[60:63],a[60:63],v[156:159]
 s_add_u32 s1,s1,s32
 v_mfma_f32_16x16x32_bf16 v[156:159],v[56:59],a[44:47],v[156:159]
 s_lshl_b32 s1,s1,9
 s_waitcnt lgkmcnt(0)
 v_mfma_f32_16x16x32_bf16 v[160:163],v[16:19],a[32:35],v[160:163]
 s_add_u32 s1,s1,5373952
 ds_read_b64_tr_b16 v[40:41],v6 offset:264
 ds_read_b64_tr_b16 v[42:43],v6 offset:6408
 v_mfma_f32_16x16x32_bf16 v[160:163],v[20:23],a[48:51],v[160:163]
 buffer_load_dwordx2 a[240:241],v13,s[28:31],s1 offen sc1
 v_mfma_f32_16x16x32_bf16 v[164:167],v[20:23],a[52:55],v[164:167]
 ds_read_b64_tr_b16 v[44:45],v6 offset:12552
 ds_read_b64_tr_b16 v[46:47],v6 offset:18696
 v_mfma_f32_16x16x32_bf16 v[164:167],v[16:19],a[36:39],v[164:167]
 buffer_load_dwordx2 a[244:245],v13,s[28:31],s1 offen offset:128 sc1
 v_mfma_f32_16x16x32_bf16 v[168:171],v[16:19],a[40:43],v[168:171]
 ds_read_b64_tr_b16 v[48:49],v7 offset:256
 ds_read_b64_tr_b16 v[50:51],v7 offset:6400
 v_mfma_f32_16x16x32_bf16 v[168:171],v[20:23],a[56:59],v[168:171]
 buffer_load_dwordx4 v2,s[12:15],s44 offen offset:1024 lds
 v_mfma_f32_16x16x32_bf16 v[172:175],v[20:23],a[60:63],v[172:175]
 ds_read_b64_tr_b16 v[52:53],v7 offset:12544
 ds_read_b64_tr_b16 v[54:55],v7 offset:18688
 v_mfma_f32_16x16x32_bf16 v[172:175],v[16:19],a[44:47],v[172:175]
 v_mfma_f32_16x16x32_bf16 v[176:179],v[24:27],a[32:35],v[176:179]
 ds_read_b64_tr_b16 v[56:57],v7 offset:264
 ds_read_b64_tr_b16 v[58:59],v7 offset:6408
 v_mfma_f32_16x16x32_bf16 v[176:179],v[28:31],a[48:51],v[176:179]
 buffer_load_dwordx2 a[248:249],v13,s[28:31],s1 offen offset:256 sc1
 v_mfma_f32_16x16x32_bf16 v[180:183],v[28:31],a[52:55],v[180:183]
 ds_read_b64_tr_b16 v[60:61],v7 offset:12552
 ds_read_b64_tr_b16 v[62:63],v7 offset:18696
 v_mfma_f32_16x16x32_bf16 v[180:183],v[24:27],a[36:39],v[180:183]
 buffer_load_dwordx2 a[252:253],v13,s[28:31],s1 offen offset:384 sc1
 v_mfma_f32_16x16x32_bf16 v[184:187],v[24:27],a[40:43],v[184:187]
 buffer_load_dwordx4 v3,s[12:15],s44 offen offset:2048 lds
 v_mfma_f32_16x16x32_bf16 v[184:187],v[28:31],a[56:59],v[184:187]
 v_mfma_f32_16x16x32_bf16 v[188:191],v[28:31],a[60:63],v[188:191]
 v_mfma_f32_16x16x32_bf16 v[188:191],v[24:27],a[44:47],v[188:191]
 v_mfma_f32_16x16x32_bf16 v[192:195],v[32:35],a[32:35],v[192:195]
 v_mfma_f32_16x16x32_bf16 v[192:195],v[36:39],a[48:51],v[192:195]
 v_mfma_f32_16x16x32_bf16 v[196:199],v[36:39],a[52:55],v[196:199]
 v_mfma_f32_16x16x32_bf16 v[196:199],v[32:35],a[36:39],v[196:199]
 v_mfma_f32_16x16x32_bf16 v[200:203],v[32:35],a[40:43],v[200:203]
 s_mov_b32 s50,24576
 v_add_u32 v6,s50,v6
 v_add_u32 v7,s50,v7
 v_mfma_f32_16x16x32_bf16 v[200:203],v[36:39],a[56:59],v[200:203]
 v_mfma_f32_16x16x32_bf16 v[204:207],v[36:39],a[60:63],v[204:207]
 v_mfma_f32_16x16x32_bf16 v[204:207],v[32:35],a[44:47],v[204:207]
 s_waitcnt vmcnt(50) lgkmcnt(0)
 s_barrier
 v_mfma_f32_16x16x32_bf16 v[208:211],v[40:43],a[32:35],v[208:211]
 ds_read_b64_tr_b16 v[16:17],v6
 ds_read_b64_tr_b16 v[18:19],v6 offset:6144
 v_mfma_f32_16x16x32_bf16 v[208:211],v[44:47],a[48:51],v[208:211]
 s_add_u32 m0,s35,98304
 s_mov_b32 s44,0
 buffer_load_dwordx4 v1,s[16:19],s44 offen lds
 v_mfma_f32_16x16x32_bf16 v[212:215],v[44:47],a[52:55],v[212:215]
 ds_read_b64_tr_b16 v[20:21],v6 offset:12288
 ds_read_b64_tr_b16 v[22:23],v6 offset:18432
 v_mfma_f32_16x16x32_bf16 v[212:215],v[40:43],a[36:39],v[212:215]
 buffer_load_dwordx4 v2,s[16:19],s44 offen offset:1024 lds
 v_mfma_f32_16x16x32_bf16 v[216:219],v[40:43],a[40:43],v[216:219]
 ds_read_b64_tr_b16 v[24:25],v6 offset:8
 ds_read_b64_tr_b16 v[26:27],v6 offset:6152
 v_mfma_f32_16x16x32_bf16 v[216:219],v[44:47],a[56:59],v[216:219]
 v_mfma_f32_16x16x32_bf16 v[220:223],v[44:47],a[60:63],v[220:223]
 ds_read_b64_tr_b16 v[28:29],v6 offset:12296
 ds_read_b64_tr_b16 v[30:31],v6 offset:18440
 v_mfma_f32_16x16x32_bf16 v[220:223],v[40:43],a[44:47],v[220:223]
 v_mfma_f32_16x16x32_bf16 v[224:227],v[48:51],a[32:35],v[224:227]
 ds_read_b64_tr_b16 v[32:33],v7
 ds_read_b64_tr_b16 v[34:35],v7 offset:6144
 v_mfma_f32_16x16x32_bf16 v[224:227],v[52:55],a[48:51],v[224:227]
 buffer_load_dwordx4 v3,s[16:19],s44 offen offset:2048 lds
 v_mfma_f32_16x16x32_bf16 v[228:231],v[52:55],a[52:55],v[228:231]
 ds_read_b64_tr_b16 v[36:37],v7 offset:12288
 ds_read_b64_tr_b16 v[38:39],v7 offset:18432
 v_mfma_f32_16x16x32_bf16 v[228:231],v[48:51],a[36:39],v[228:231]
 v_mfma_f32_16x16x32_bf16 v[232:235],v[48:51],a[40:43],v[232:235]
 v_mfma_f32_16x16x32_bf16 v[232:235],v[52:55],a[56:59],v[232:235]
 v_mfma_f32_16x16x32_bf16 v[236:239],v[52:55],a[60:63],v[236:239]
 v_mfma_f32_16x16x32_bf16 v[236:239],v[48:51],a[44:47],v[236:239]
 v_mfma_f32_16x16x32_bf16 v[240:243],v[56:59],a[32:35],v[240:243]
 v_mfma_f32_16x16x32_bf16 v[240:243],v[60:63],a[48:51],v[240:243]
 s_add_u32 m0,s35,101376
 s_add_u32 s44,s44,3072
 buffer_load_dwordx4 v1,s[16:19],s44 offen lds
 v_mfma_f32_16x16x32_bf16 v[244:247],v[60:63],a[52:55],v[244:247]
 v_mfma_f32_16x16x32_bf16 v[244:247],v[56:59],a[36:39],v[244:247]
 v_mfma_f32_16x16x32_bf16 v[248:251],v[56:59],a[40:43],v[248:251]
 v_mfma_f32_16x16x32_bf16 v[248:251],v[60:63],a[56:59],v[248:251]
 v_mfma_f32_16x16x32_bf16 v[252:255],v[60:63],a[60:63],v[252:255]
 v_mfma_f32_16x16x32_bf16 v[252:255],v[56:59],a[44:47],v[252:255]
 s_waitcnt lgkmcnt(0)
 v_mfma_f32_16x16x32_bf16 v[64:67],v[16:19],a[64:67],v[64:67]
 ds_read_b64_tr_b16 v[40:41],v7 offset:8
 ds_read_b64_tr_b16 v[42:43],v7 offset:6152
 v_mfma_f32_16x16x32_bf16 v[64:67],v[20:23],a[80:83],v[64:67]
 v_mfma_f32_16x16x32_bf16 v[68:71],v[20:23],a[84:87],v[68:71]
 ds_read_b64_tr_b16 v[44:45],v7 offset:12296
 ds_read_b64_tr_b16 v[46:47],v7 offset:18440
 v_mfma_f32_16x16x32_bf16 v[68:71],v[16:19],a[68:71],v[68:71]
 buffer_load_dwordx4 v2,s[16:19],s44 offen offset:1024 lds
 v_mfma_f32_16x16x32_bf16 v[72:75],v[16:19],a[72:75],v[72:75]
 ds_read_b64_tr_b16 v[48:49],v6 offset:128
 ds_read_b64_tr_b16 v[50:51],v6 offset:6272
 v_mfma_f32_16x16x32_bf16 v[72:75],v[20:23],a[88:91],v[72:75]
 v_mfma_f32_16x16x32_bf16 v[76:79],v[20:23],a[92:95],v[76:79]
 ds_read_b64_tr_b16 v[52:53],v6 offset:12416
 ds_read_b64_tr_b16 v[54:55],v6 offset:18560
 v_mfma_f32_16x16x32_bf16 v[76:79],v[16:19],a[76:79],v[76:79]
 v_mfma_f32_16x16x32_bf16 v[80:83],v[24:27],a[64:67],v[80:83]
 ds_read_b64_tr_b16 v[56:57],v6 offset:136
 ds_read_b64_tr_b16 v[58:59],v6 offset:6280
 v_mfma_f32_16x16x32_bf16 v[80:83],v[28:31],a[80:83],v[80:83]
 buffer_load_dwordx4 v3,s[16:19],s44 offen offset:2048 lds
 v_mfma_f32_16x16x32_bf16 v[84:87],v[28:31],a[84:87],v[84:87]
 ds_read_b64_tr_b16 v[60:61],v6 offset:12424
 ds_read_b64_tr_b16 v[62:63],v6 offset:18568
 v_mfma_f32_16x16x32_bf16 v[84:87],v[24:27],a[68:71],v[84:87]
 v_mfma_f32_16x16x32_bf16 v[88:91],v[24:27],a[72:75],v[88:91]
 v_mfma_f32_16x16x32_bf16 v[88:91],v[28:31],a[88:91],v[88:91]
 v_mfma_f32_16x16x32_bf16 v[92:95],v[28:31],a[92:95],v[92:95]
 v_mfma_f32_16x16x32_bf16 v[92:95],v[24:27],a[76:79],v[92:95]
 v_mfma_f32_16x16x32_bf16 v[96:99],v[32:35],a[64:67],v[96:99]
 v_mfma_f32_16x16x32_bf16 v[96:99],v[36:39],a[80:83],v[96:99]
 v_mfma_f32_16x16x32_bf16 v[100:103],v[36:39],a[84:87],v[100:103]
 v_mfma_f32_16x16x32_bf16 v[100:103],v[32:35],a[68:71],v[100:103]
 v_mfma_f32_16x16x32_bf16 v[104:107],v[32:35],a[72:75],v[104:107]
 v_mfma_f32_16x16x32_bf16 v[104:107],v[36:39],a[88:91],v[104:107]
 v_mfma_f32_16x16x32_bf16 v[108:111],v[36:39],a[92:95],v[108:111]
 v_mfma_f32_16x16x32_bf16 v[108:111],v[32:35],a[76:79],v[108:111]
 s_waitcnt lgkmcnt(0)
 v_mfma_f32_16x16x32_bf16 v[112:115],v[40:43],a[64:67],v[112:115]
 ds_read_b64_tr_b16 v[16:17],v7 offset:128
 ds_read_b64_tr_b16 v[18:19],v7 offset:6272
 v_mfma_f32_16x16x32_bf16 v[112:115],v[44:47],a[80:83],v[112:115]
 v_mfma_f32_16x16x32_bf16 v[116:119],v[44:47],a[84:87],v[116:119]
 ds_read_b64_tr_b16 v[20:21],v7 offset:12416
 ds_read_b64_tr_b16 v[22:23],v7 offset:18560
 v_mfma_f32_16x16x32_bf16 v[116:119],v[40:43],a[68:71],v[116:119]
 v_mfma_f32_16x16x32_bf16 v[120:123],v[40:43],a[72:75],v[120:123]
 ds_read_b64_tr_b16 v[24:25],v7 offset:136
 ds_read_b64_tr_b16 v[26:27],v7 offset:6280
 v_mfma_f32_16x16x32_bf16 v[120:123],v[44:47],a[88:91],v[120:123]
 v_mfma_f32_16x16x32_bf16 v[124:127],v[44:47],a[92:95],v[124:127]
 ds_read_b64_tr_b16 v[28:29],v7 offset:12424
 ds_read_b64_tr_b16 v[30:31],v7 offset:18568
 v_mfma_f32_16x16x32_bf16 v[124:127],v[40:43],a[76:79],v[124:127]
 v_mfma_f32_16x16x32_bf16 v[128:131],v[48:51],a[64:67],v[128:131]
 ds_read_b64_tr_b16 v[32:33],v6 offset:256
 ds_read_b64_tr_b16 v[34:35],v6 offset:6400
 v_mfma_f32_16x16x32_bf16 v[128:131],v[52:55],a[80:83],v[128:131]
 v_mfma_f32_16x16x32_bf16 v[132:135],v[52:55],a[84:87],v[132:135]
 ds_read_b64_tr_b16 v[36:37],v6 offset:12544
 ds_read_b64_tr_b16 v[38:39],v6 offset:18688
 v_mfma_f32_16x16x32_bf16 v[132:135],v[48:51],a[68:71],v[132:135]
 v_mfma_f32_16x16x32_bf16 v[136:139],v[48:51],a[72:75],v[136:139]
 v_mfma_f32_16x16x32_bf16 v[136:139],v[52:55],a[88:91],v[136:139]
 v_mfma_f32_16x16x32_bf16 v[140:143],v[52:55],a[92:95],v[140:143]
 v_mfma_f32_16x16x32_bf16 v[140:143],v[48:51],a[76:79],v[140:143]
 v_mfma_f32_16x16x32_bf16 v[144:147],v[56:59],a[64:67],v[144:147]
 s_waitcnt vmcnt(7)
 v_cmp_lt_u32 vcc,31,v0
 v_and_b32 v14,16,v0
 v_mfma_f32_16x16x32_bf16 v[144:147],v[60:63],a[80:83],v[144:147]
 v_cmp_eq_u32 s[38:39],0,v14
 v_accvgpr_read_b32 v14,a240
 v_mfma_f32_16x16x32_bf16 v[148:151],v[60:63],a[84:87],v[148:151]
 v_accvgpr_read_b32 v10,a241
 v_cvt_pk_bf16_f32 v15,v14,v14
 v_mfma_f32_16x16x32_bf16 v[148:151],v[56:59],a[68:71],v[148:151]
 v_lshlrev_b32 v4,16,v15
 v_sub_f32 v4,v14,v4
 v_mfma_f32_16x16x32_bf16 v[152:155],v[56:59],a[72:75],v[152:155]
 v_cvt_pk_bf16_f32 v4,v4,v4
 v_cndmask_b32 v15,v15,v4,vcc
 v_mfma_f32_16x16x32_bf16 v[152:155],v[60:63],a[88:91],v[152:155]
 v_cndmask_b32 v15,0,v15,s[38:39]
 v_accvgpr_write_b32 a240,v15
 v_mfma_f32_16x16x32_bf16 v[156:159],v[60:63],a[92:95],v[156:159]
 v_accvgpr_write_b32 a241,v15
 v_accvgpr_write_b32 a242,v15
 v_mfma_f32_16x16x32_bf16 v[156:159],v[56:59],a[76:79],v[156:159]
 s_waitcnt lgkmcnt(0)
 v_accvgpr_write_b32 a243,v15
 v_accvgpr_read_b32 v14,a244
 v_mfma_f32_16x16x32_bf16 v[160:163],v[16:19],a[64:67],v[160:163]
 ds_read_b64_tr_b16 v[40:41],v6 offset:264
 ds_read_b64_tr_b16 v[42:43],v6 offset:6408
 v_mfma_f32_16x16x32_bf16 v[160:163],v[20:23],a[80:83],v[160:163]
 v_accvgpr_read_b32 v11,a245
 v_cvt_pk_bf16_f32 v15,v14,v14
 v_mfma_f32_16x16x32_bf16 v[164:167],v[20:23],a[84:87],v[164:167]
 ds_read_b64_tr_b16 v[44:45],v6 offset:12552
 ds_read_b64_tr_b16 v[46:47],v6 offset:18696
 v_mfma_f32_16x16x32_bf16 v[164:167],v[16:19],a[68:71],v[164:167]
 v_lshlrev_b32 v4,16,v15
 v_sub_f32 v4,v14,v4
 v_mfma_f32_16x16x32_bf16 v[168:171],v[16:19],a[72:75],v[168:171]
 ds_read_b64_tr_b16 v[48:49],v7 offset:256
 ds_read_b64_tr_b16 v[50:51],v7 offset:6400
 v_mfma_f32_16x16x32_bf16 v[168:171],v[20:23],a[88:91],v[168:171]
 v_cvt_pk_bf16_f32 v4,v4,v4
 v_cndmask_b32 v15,v15,v4,vcc
 v_mfma_f32_16x16x32_bf16 v[172:175],v[20:23],a[92:95],v[172:175]
 ds_read_b64_tr_b16 v[52:53],v7 offset:12544
 ds_read_b64_tr_b16 v[54:55],v7 offset:18688
 v_mfma_f32_16x16x32_bf16 v[172:175],v[16:19],a[76:79],v[172:175]
 v_cndmask_b32 v15,0,v15,s[38:39]
 v_accvgpr_write_b32 a244,v15
 v_mfma_f32_16x16x32_bf16 v[176:179],v[24:27],a[64:67],v[176:179]
 ds_read_b64_tr_b16 v[56:57],v7 offset:264
 ds_read_b64_tr_b16 v[58:59],v7 offset:6408
 v_mfma_f32_16x16x32_bf16 v[176:179],v[28:31],a[80:83],v[176:179]
 v_accvgpr_write_b32 a245,v15
 v_accvgpr_write_b32 a246,v15
 v_mfma_f32_16x16x32_bf16 v[180:183],v[28:31],a[84:87],v[180:183]
 ds_read_b64_tr_b16 v[60:61],v7 offset:12552
 ds_read_b64_tr_b16 v[62:63],v7 offset:18696
 v_mfma_f32_16x16x32_bf16 v[180:183],v[24:27],a[68:71],v[180:183]
 v_accvgpr_write_b32 a247,v15
 v_accvgpr_read_b32 v14,a248
 v_mfma_f32_16x16x32_bf16 v[184:187],v[24:27],a[72:75],v[184:187]
 v_accvgpr_read_b32 v12,a249
 v_cvt_pk_bf16_f32 v15,v14,v14
 v_mfma_f32_16x16x32_bf16 v[184:187],v[28:31],a[88:91],v[184:187]
 v_lshlrev_b32 v4,16,v15
 v_sub_f32 v4,v14,v4
 v_mfma_f32_16x16x32_bf16 v[188:191],v[28:31],a[92:95],v[188:191]
 v_cvt_pk_bf16_f32 v4,v4,v4
 v_cndmask_b32 v15,v15,v4,vcc
 v_mfma_f32_16x16x32_bf16 v[188:191],v[24:27],a[76:79],v[188:191]
 v_cndmask_b32 v15,0,v15,s[38:39]
 v_accvgpr_write_b32 a248,v15
 v_mfma_f32_16x16x32_bf16 v[192:195],v[32:35],a[64:67],v[192:195]
 v_accvgpr_write_b32 a249,v15
 v_accvgpr_write_b32 a250,v15
 v_mfma_f32_16x16x32_bf16 v[192:195],v[36:39],a[80:83],v[192:195]
 v_accvgpr_write_b32 a251,v15
 v_accvgpr_read_b32 v14,a252
 v_mfma_f32_16x16x32_bf16 v[196:199],v[36:39],a[84:87],v[196:199]
 v_accvgpr_read_b32 v13,a253
 v_cvt_pk_bf16_f32 v15,v14,v14
 v_mfma_f32_16x16x32_bf16 v[196:199],v[32:35],a[68:71],v[196:199]
 v_lshlrev_b32 v4,16,v15
 v_sub_f32 v4,v14,v4
 v_mfma_f32_16x16x32_bf16 v[200:203],v[32:35],a[72:75],v[200:203]
 s_mov_b32 s50,24576
 v_add_u32 v6,s50,v6
 v_add_u32 v7,s50,v7
 v_mfma_f32_16x16x32_bf16 v[200:203],v[36:39],a[88:91],v[200:203]
 v_cvt_pk_bf16_f32 v4,v4,v4
 v_cndmask_b32 v15,v15,v4,vcc
 v_mfma_f32_16x16x32_bf16 v[204:207],v[36:39],a[92:95],v[204:207]
 v_cndmask_b32 v15,0,v15,s[38:39]
 v_accvgpr_write_b32 a252,v15
 v_mfma_f32_16x16x32_bf16 v[204:207],v[32:35],a[76:79],v[204:207]
 s_waitcnt vmcnt(34) lgkmcnt(0)
 s_barrier
 v_accvgpr_write_b32 a253,v15
 v_mfma_f32_16x16x32_bf16 v[208:211],v[40:43],a[64:67],v[208:211]
 ds_read_b64_tr_b16 v[16:17],v6
 ds_read_b64_tr_b16 v[18:19],v6 offset:6144
 v_mfma_f32_16x16x32_bf16 v[208:211],v[44:47],a[80:83],v[208:211]
 v_accvgpr_write_b32 a254,v15
 v_accvgpr_write_b32 a255,v15
 v_mfma_f32_16x16x32_bf16 v[212:215],v[44:47],a[84:87],v[212:215]
 ds_read_b64_tr_b16 v[20:21],v6 offset:12288
 ds_read_b64_tr_b16 v[22:23],v6 offset:18432
 v_mfma_f32_16x16x32_bf16 v[212:215],v[40:43],a[68:71],v[212:215]
 s_add_u32 m0,s35,24576
 s_mov_b32 s44,0
 buffer_load_dwordx4 v1,s[12:15],s44 offen lds
 v_mfma_f32_16x16x32_bf16 v[216:219],v[40:43],a[72:75],v[216:219]
 ds_read_b64_tr_b16 v[24:25],v6 offset:8
 ds_read_b64_tr_b16 v[26:27],v6 offset:6152
 v_mfma_f32_16x16x32_bf16 v[216:219],v[44:47],a[88:91],v[216:219]
 buffer_load_dwordx4 v2,s[12:15],s44 offen offset:1024 lds
 buffer_load_dwordx4 v3,s[12:15],s44 offen offset:2048 lds
 v_mfma_f32_16x16x32_bf16 v[220:223],v[44:47],a[92:95],v[220:223]
 ds_read_b64_tr_b16 v[28:29],v6 offset:12296
 ds_read_b64_tr_b16 v[30:31],v6 offset:18440
 v_mfma_f32_16x16x32_bf16 v[220:223],v[40:43],a[76:79],v[220:223]
 s_add_u32 m0,s35,27648
 s_add_u32 s44,s44,3072
 buffer_load_dwordx4 v1,s[12:15],s44 offen lds
 v_mfma_f32_16x16x32_bf16 v[224:227],v[48:51],a[64:67],v[224:227]
 ds_read_b64_tr_b16 v[32:33],v7
 ds_read_b64_tr_b16 v[34:35],v7 offset:6144
 v_mfma_f32_16x16x32_bf16 v[224:227],v[52:55],a[80:83],v[224:227]
 buffer_load_dwordx4 v2,s[12:15],s44 offen offset:1024 lds
 v_mfma_f32_16x16x32_bf16 v[228:231],v[52:55],a[84:87],v[228:231]
 ds_read_b64_tr_b16 v[36:37],v7 offset:12288
 ds_read_b64_tr_b16 v[38:39],v7 offset:18432
 v_mfma_f32_16x16x32_bf16 v[228:231],v[48:51],a[68:71],v[228:231]
 buffer_load_dwordx4 v3,s[12:15],s44 offen offset:2048 lds
 v_mfma_f32_16x16x32_bf16 v[232:235],v[48:51],a[72:75],v[232:235]
 v_mfma_f32_16x16x32_bf16 v[232:235],v[52:55],a[88:91],v[232:235]
 v_mfma_f32_16x16x32_bf16 v[236:239],v[52:55],a[92:95],v[236:239]
 v_mfma_f32_16x16x32_bf16 v[236:239],v[48:51],a[76:79],v[236:239]
 v_mfma_f32_16x16x32_bf16 v[240:243],v[56:59],a[64:67],v[240:243]
 v_mfma_f32_16x16x32_bf16 v[240:243],v[60:63],a[80:83],v[240:243]
 v_mfma_f32_16x16x32_bf16 v[244:247],v[60:63],a[84:87],v[244:247]
 v_mfma_f32_16x16x32_bf16 v[244:247],v[56:59],a[68:71],v[244:247]
 v_mfma_f32_16x16x32_bf16 v[248:251],v[56:59],a[72:75],v[248:251]
 v_mfma_f32_16x16x32_bf16 v[248:251],v[60:63],a[88:91],v[248:251]
 v_mfma_f32_16x16x32_bf16 v[252:255],v[60:63],a[92:95],v[252:255]
 v_mfma_f32_16x16x32_bf16 v[252:255],v[56:59],a[76:79],v[252:255]
 s_waitcnt lgkmcnt(0)
 v_mfma_f32_16x16x32_bf16 v[64:67],a[192:195],a[240:243],v[64:67]
 v_mfma_f32_16x16x32_bf16 v[68:71],a[192:195],a[244:247],v[68:71]
 v_mfma_f32_16x16x32_bf16 v[72:75],a[192:195],a[248:251],v[72:75]
 v_mfma_f32_16x16x32_bf16 v[76:79],a[192:195],a[252:255],v[76:79]
 v_mfma_f32_16x16x32_bf16 v[80:83],a[196:199],a[240:243],v[80:83]
 s_waitcnt vmcnt(34)
 v_lshrrev_b32 v14,2,v0
 v_and_b32 v15,6,v14
 v_mfma_f32_16x16x32_bf16 v[84:87],a[196:199],a[244:247],v[84:87]
 v_lshlrev_b32 v15,4,v15
 v_lshl_add_u32 v8,v14,7,v15
 v_mfma_f32_16x16x32_bf16 v[88:91],a[196:199],a[248:251],v[88:91]
 v_and_b32 v15,3,v0
 v_lshl_add_u32 v8,v15,3,v8
 v_mfma_f32_16x16x32_bf16 v[92:95],a[196:199],a[252:255],v[92:95]
 v_add_u32 v8,s49,v8
 ds_read_b64_tr_b16 a[112:113],v8
 v_mfma_f32_16x16x32_bf16 v[96:99],a[200:203],a[240:243],v[96:99]
 ds_read_b64_tr_b16 a[114:115],v8 offset:2048
 v_xor_b32 v8,32,v8
 v_mfma_f32_16x16x32_bf16 v[100:103],a[200:203],a[244:247],v[100:103]
 ds_read_b64_tr_b16 a[116:117],v8
 ds_read_b64_tr_b16 a[118:119],v8 offset:2048
 v_mfma_f32_16x16x32_bf16 v[104:107],a[200:203],a[248:251],v[104:107]
 v_xor_b32 v8,96,v8
 ds_read_b64_tr_b16 a[120:121],v8
 v_mfma_f32_16x16x32_bf16 v[108:111],a[200:203],a[252:255],v[108:111]
 ds_read_b64_tr_b16 a[122:123],v8 offset:2048
 v_xor_b32 v8,32,v8
 v_mfma_f32_16x16x32_bf16 v[112:115],a[204:207],a[240:243],v[112:115]
 ds_read_b64_tr_b16 a[124:125],v8
 ds_read_b64_tr_b16 a[126:127],v8 offset:2048
 v_mfma_f32_16x16x32_bf16 v[116:119],a[204:207],a[244:247],v[116:119]
 v_and_b32 v14,15,v0
 v_mul_u32_u24 v4,384,v14
 v_mfma_f32_16x16x32_bf16 v[120:123],a[204:207],a[248:251],v[120:123]
 v_and_b32 v14,6,v14
 v_lshrrev_b32 v15,4,v0
 v_mfma_f32_16x16x32_bf16 v[124:127],a[204:207],a[252:255],v[124:127]
 v_xor_b32 v14,v14,v15
 v_lshl_add_u32 v4,v14,4,v4
 v_mfma_f32_16x16x32_bf16 v[128:131],a[208:211],a[240:243],v[128:131]
 v_add_u32 v4,24576,v4
 v_xor_b32 v5,64,v4
 v_mfma_f32_16x16x32_bf16 v[132:135],a[208:211],a[244:247],v[132:135]
 s_add_u32 m0,s35,122880
 s_mov_b32 s44,49152
 buffer_load_dwordx4 v1,s[12:15],s44 offen lds
 v_mfma_f32_16x16x32_bf16 v[136:139],a[208:211],a[248:251],v[136:139]
 v_mfma_f32_16x16x32_bf16 v[140:143],a[208:211],a[252:255],v[140:143]
 v_mfma_f32_16x16x32_bf16 v[144:147],a[212:215],a[240:243],v[144:147]
 v_mfma_f32_16x16x32_bf16 v[148:151],a[212:215],a[244:247],v[148:151]
 v_mfma_f32_16x16x32_bf16 v[152:155],a[212:215],a[248:251],v[152:155]
 buffer_load_dwordx4 v2,s[12:15],s44 offen offset:1024 lds
 v_mfma_f32_16x16x32_bf16 v[156:159],a[212:215],a[252:255],v[156:159]
 v_mfma_f32_16x16x32_bf16 v[160:163],a[216:219],a[240:243],v[160:163]
 v_mfma_f32_16x16x32_bf16 v[164:167],a[216:219],a[244:247],v[164:167]
 v_mfma_f32_16x16x32_bf16 v[168:171],a[216:219],a[248:251],v[168:171]
 v_mfma_f32_16x16x32_bf16 v[172:175],a[216:219],a[252:255],v[172:175]
 v_mfma_f32_16x16x32_bf16 v[176:179],a[220:223],a[240:243],v[176:179]
 v_mfma_f32_16x16x32_bf16 v[180:183],a[220:223],a[244:247],v[180:183]
 v_mfma_f32_16x16x32_bf16 v[184:187],a[220:223],a[248:251],v[184:187]
 buffer_load_dwordx4 v3,s[12:15],s44 offen offset:2048 lds
 v_mfma_f32_16x16x32_bf16 v[188:191],a[220:223],a[252:255],v[188:191]
 v_mfma_f32_16x16x32_bf16 v[192:195],a[224:227],a[240:243],v[192:195]
 v_mfma_f32_16x16x32_bf16 v[196:199],a[224:227],a[244:247],v[196:199]
 v_mfma_f32_16x16x32_bf16 v[200:203],a[224:227],a[248:251],v[200:203]
 v_mfma_f32_16x16x32_bf16 v[204:207],a[224:227],a[252:255],v[204:207]
 v_mfma_f32_16x16x32_bf16 v[208:211],a[228:231],a[240:243],v[208:211]
 v_mfma_f32_16x16x32_bf16 v[212:215],a[228:231],a[244:247],v[212:215]
 v_mfma_f32_16x16x32_bf16 v[216:219],a[228:231],a[248:251],v[216:219]
 s_add_u32 m0,s35,125952
 s_add_u32 s44,s44,3072
 buffer_load_dwordx4 v1,s[12:15],s44 offen lds
 v_mfma_f32_16x16x32_bf16 v[220:223],a[228:231],a[252:255],v[220:223]
 v_mfma_f32_16x16x32_bf16 v[224:227],a[232:235],a[240:243],v[224:227]
 v_mfma_f32_16x16x32_bf16 v[228:231],a[232:235],a[244:247],v[228:231]
 v_mfma_f32_16x16x32_bf16 v[232:235],a[232:235],a[248:251],v[232:235]
 v_mfma_f32_16x16x32_bf16 v[236:239],a[232:235],a[252:255],v[236:239]
 v_mfma_f32_16x16x32_bf16 v[240:243],a[236:239],a[240:243],v[240:243]
 v_mfma_f32_16x16x32_bf16 v[244:247],a[236:239],a[244:247],v[244:247]
 v_mfma_f32_16x16x32_bf16 v[248:251],a[236:239],a[248:251],v[248:251]
 buffer_load_dwordx4 v2,s[12:15],s44 offen offset:1024 lds
 v_mfma_f32_16x16x32_bf16 v[252:255],a[236:239],a[252:255],v[252:255]
 v_mfma_f32_16x16x32_bf16 v[64:67],v[16:19],a[0:3],v[64:67]
 ds_read_b64_tr_b16 v[40:41],v7 offset:8
 ds_read_b64_tr_b16 v[42:43],v7 offset:6152
 v_mfma_f32_16x16x32_bf16 v[64:67],v[20:23],a[16:19],v[64:67]
 v_mfma_f32_16x16x32_bf16 v[68:71],v[20:23],a[20:23],v[68:71]
 ds_read_b64_tr_b16 v[44:45],v7 offset:12296
 ds_read_b64_tr_b16 v[46:47],v7 offset:18440
 v_mfma_f32_16x16x32_bf16 v[68:71],v[16:19],a[4:7],v[68:71]
 v_mfma_f32_16x16x32_bf16 v[72:75],v[16:19],a[8:11],v[72:75]
 ds_read_b64_tr_b16 v[48:49],v6 offset:128
 ds_read_b64_tr_b16 v[50:51],v6 offset:6272
 v_mfma_f32_16x16x32_bf16 v[72:75],v[20:23],a[24:27],v[72:75]
 v_mfma_f32_16x16x32_bf16 v[76:79],v[20:23],a[28:31],v[76:79]
 ds_read_b64_tr_b16 v[52:53],v6 offset:12416
 ds_read_b64_tr_b16 v[54:55],v6 offset:18560
 v_mfma_f32_16x16x32_bf16 v[76:79],v[16:19],a[12:15],v[76:79]
 buffer_load_dwordx4 v3,s[12:15],s44 offen offset:2048 lds
 v_mfma_f32_16x16x32_bf16 v[80:83],v[24:27],a[0:3],v[80:83]
 ds_read_b64_tr_b16 v[56:57],v6 offset:136
 ds_read_b64_tr_b16 v[58:59],v6 offset:6280
 v_mfma_f32_16x16x32_bf16 v[80:83],v[28:31],a[16:19],v[80:83]
 v_mfma_f32_16x16x32_bf16 v[84:87],v[28:31],a[20:23],v[84:87]
 ds_read_b64_tr_b16 v[60:61],v6 offset:12424
 ds_read_b64_tr_b16 v[62:63],v6 offset:18568
 v_mfma_f32_16x16x32_bf16 v[84:87],v[24:27],a[4:7],v[84:87]
 v_mfma_f32_16x16x32_bf16 v[88:91],v[24:27],a[8:11],v[88:91]
 v_mfma_f32_16x16x32_bf16 v[88:91],v[28:31],a[24:27],v[88:91]
 v_mul_f32 v64,v64,v10
 v_mul_f32 v65,v65,v10
 v_mfma_f32_16x16x32_bf16 v[92:95],v[28:31],a[28:31],v[92:95]
 v_mul_f32 v66,v66,v10
 v_mul_f32 v67,v67,v10
 v_mfma_f32_16x16x32_bf16 v[92:95],v[24:27],a[12:15],v[92:95]
 s_add_u32 m0,s35,0
 s_mov_b32 s44,24576
 buffer_load_dwordx4 v1,s[16:19],s44 offen lds
 v_cvt_pk_bf16_f32 v64,v64,v65
 v_cvt_pk_bf16_f32 v65,v66,v67
 v_mfma_f32_16x16x32_bf16 v[96:99],v[32:35],a[0:3],v[96:99]
 v_accvgpr_write_b32 a192,v64
 v_accvgpr_write_b32 a193,v65
 v_mfma_f32_16x16x32_bf16 v[96:99],v[36:39],a[16:19],v[96:99]
 v_mul_f32 v68,v68,v11
 v_mul_f32 v69,v69,v11
 v_mfma_f32_16x16x32_bf16 v[100:103],v[36:39],a[20:23],v[100:103]
 v_mul_f32 v70,v70,v11
 v_mul_f32 v71,v71,v11
 v_mfma_f32_16x16x32_bf16 v[100:103],v[32:35],a[4:7],v[100:103]
 v_cvt_pk_bf16_f32 v68,v68,v69
 v_cvt_pk_bf16_f32 v69,v70,v71
 v_mfma_f32_16x16x32_bf16 v[104:107],v[32:35],a[8:11],v[104:107]
 v_accvgpr_write_b32 a196,v68
 v_accvgpr_write_b32 a197,v69
 v_mfma_f32_16x16x32_bf16 v[104:107],v[36:39],a[24:27],v[104:107]
 v_mul_f32 v72,v72,v12
 v_mul_f32 v73,v73,v12
 v_mfma_f32_16x16x32_bf16 v[108:111],v[36:39],a[28:31],v[108:111]
 v_mul_f32 v74,v74,v12
 v_mul_f32 v75,v75,v12
 v_mfma_f32_16x16x32_bf16 v[108:111],v[32:35],a[12:15],v[108:111]
 s_waitcnt lgkmcnt(0)
 v_cvt_pk_bf16_f32 v72,v72,v73
 v_cvt_pk_bf16_f32 v73,v74,v75
 v_mfma_f32_16x16x32_bf16 v[112:115],v[40:43],a[0:3],v[112:115]
 buffer_load_dwordx4 v2,s[16:19],s44 offen offset:1024 lds
 ds_read_b64_tr_b16 v[16:17],v7 offset:128
 ds_read_b64_tr_b16 v[18:19],v7 offset:6272
 v_mfma_f32_16x16x32_bf16 v[112:115],v[44:47],a[16:19],v[112:115]
 v_accvgpr_write_b32 a200,v72
 v_accvgpr_write_b32 a201,v73
 v_mfma_f32_16x16x32_bf16 v[116:119],v[44:47],a[20:23],v[116:119]
 ds_read_b64_tr_b16 v[20:21],v7 offset:12416
 ds_read_b64_tr_b16 v[22:23],v7 offset:18560
 v_mfma_f32_16x16x32_bf16 v[116:119],v[40:43],a[4:7],v[116:119]
 v_mul_f32 v76,v76,v13
 v_mul_f32 v77,v77,v13
 v_mfma_f32_16x16x32_bf16 v[120:123],v[40:43],a[8:11],v[120:123]
 ds_read_b64_tr_b16 v[24:25],v7 offset:136
 ds_read_b64_tr_b16 v[26:27],v7 offset:6280
 v_mfma_f32_16x16x32_bf16 v[120:123],v[44:47],a[24:27],v[120:123]
 v_mul_f32 v78,v78,v13
 v_mul_f32 v79,v79,v13
 v_mfma_f32_16x16x32_bf16 v[124:127],v[44:47],a[28:31],v[124:127]
 ds_read_b64_tr_b16 v[28:29],v7 offset:12424
 ds_read_b64_tr_b16 v[30:31],v7 offset:18568
 v_mfma_f32_16x16x32_bf16 v[124:127],v[40:43],a[12:15],v[124:127]
 v_cvt_pk_bf16_f32 v76,v76,v77
 v_cvt_pk_bf16_f32 v77,v78,v79
 v_mfma_f32_16x16x32_bf16 v[128:131],v[48:51],a[0:3],v[128:131]
 buffer_load_dwordx4 v3,s[16:19],s44 offen offset:2048 lds
 ds_read_b64_tr_b16 v[32:33],v6 offset:256
 ds_read_b64_tr_b16 v[34:35],v6 offset:6400
 v_mfma_f32_16x16x32_bf16 v[128:131],v[52:55],a[16:19],v[128:131]
 v_accvgpr_write_b32 a204,v76
 v_accvgpr_write_b32 a205,v77
 v_mfma_f32_16x16x32_bf16 v[132:135],v[52:55],a[20:23],v[132:135]
 ds_read_b64_tr_b16 v[36:37],v6 offset:12544
 ds_read_b64_tr_b16 v[38:39],v6 offset:18688
 v_mfma_f32_16x16x32_bf16 v[132:135],v[48:51],a[4:7],v[132:135]
 v_mul_f32 v80,v80,v10
 v_mul_f32 v81,v81,v10
 v_mfma_f32_16x16x32_bf16 v[136:139],v[48:51],a[8:11],v[136:139]
 v_mul_f32 v82,v82,v10
 v_mul_f32 v83,v83,v10
 v_mfma_f32_16x16x32_bf16 v[136:139],v[52:55],a[24:27],v[136:139]
 v_cvt_pk_bf16_f32 v80,v80,v81
 v_cvt_pk_bf16_f32 v81,v82,v83
 v_mfma_f32_16x16x32_bf16 v[140:143],v[52:55],a[28:31],v[140:143]
 v_accvgpr_write_b32 a194,v80
 v_accvgpr_write_b32 a195,v81
 v_mfma_f32_16x16x32_bf16 v[140:143],v[48:51],a[12:15],v[140:143]
 v_mul_f32 v84,v84,v11
 v_mul_f32 v85,v85,v11
 v_mfma_f32_16x16x32_bf16 v[144:147],v[56:59],a[0:3],v[144:147]
 s_add_u32 m0,s35,3072
 s_add_u32 s44,s44,3072
 buffer_load_dwordx4 v1,s[16:19],s44 offen lds
 v_mul_f32 v86,v86,v11
 v_mul_f32 v87,v87,v11
 v_mfma_f32_16x16x32_bf16 v[144:147],v[60:63],a[16:19],v[144:147]
 v_cvt_pk_bf16_f32 v84,v84,v85
 v_cvt_pk_bf16_f32 v85,v86,v87
 v_mfma_f32_16x16x32_bf16 v[148:151],v[60:63],a[20:23],v[148:151]
 v_accvgpr_write_b32 a198,v84
 v_accvgpr_write_b32 a199,v85
 v_mfma_f32_16x16x32_bf16 v[148:151],v[56:59],a[4:7],v[148:151]
 v_mul_f32 v88,v88,v12
 v_mul_f32 v89,v89,v12
 v_mfma_f32_16x16x32_bf16 v[152:155],v[56:59],a[8:11],v[152:155]
 v_mul_f32 v90,v90,v12
 v_mul_f32 v91,v91,v12
 v_mfma_f32_16x16x32_bf16 v[152:155],v[60:63],a[24:27],v[152:155]
 v_cvt_pk_bf16_f32 v88,v88,v89
 v_cvt_pk_bf16_f32 v89,v90,v91
 v_mfma_f32_16x16x32_bf16 v[156:159],v[60:63],a[28:31],v[156:159]
 v_accvgpr_write_b32 a202,v88
 v_accvgpr_write_b32 a203,v89
 v_mfma_f32_16x16x32_bf16 v[156:159],v[56:59],a[12:15],v[156:159]
 s_waitcnt lgkmcnt(0)
 v_mul_f32 v92,v92,v13
 v_mul_f32 v93,v93,v13
 v_mfma_f32_16x16x32_bf16 v[160:163],v[16:19],a[0:3],v[160:163]
 buffer_load_dwordx4 v2,s[16:19],s44 offen offset:1024 lds
 ds_read_b64_tr_b16 v[40:41],v6 offset:264
 ds_read_b64_tr_b16 v[42:43],v6 offset:6408
 v_mfma_f32_16x16x32_bf16 v[160:163],v[20:23],a[16:19],v[160:163]
 v_mul_f32 v94,v94,v13
 v_mul_f32 v95,v95,v13
 v_mfma_f32_16x16x32_bf16 v[164:167],v[20:23],a[20:23],v[164:167]
 ds_read_b64_tr_b16 v[44:45],v6 offset:12552
 ds_read_b64_tr_b16 v[46:47],v6 offset:18696
 v_mfma_f32_16x16x32_bf16 v[164:167],v[16:19],a[4:7],v[164:167]
 v_cvt_pk_bf16_f32 v92,v92,v93
 v_cvt_pk_bf16_f32 v93,v94,v95
 v_mfma_f32_16x16x32_bf16 v[168:171],v[16:19],a[8:11],v[168:171]
 ds_read_b64_tr_b16 v[48:49],v7 offset:256
 ds_read_b64_tr_b16 v[50:51],v7 offset:6400
 v_mfma_f32_16x16x32_bf16 v[168:171],v[20:23],a[24:27],v[168:171]
 v_accvgpr_write_b32 a206,v92
 v_accvgpr_write_b32 a207,v93
 v_mfma_f32_16x16x32_bf16 v[172:175],v[20:23],a[28:31],v[172:175]
 ds_read_b64_tr_b16 v[52:53],v7 offset:12544
 ds_read_b64_tr_b16 v[54:55],v7 offset:18688
 v_mfma_f32_16x16x32_bf16 v[172:175],v[16:19],a[12:15],v[172:175]
 v_mul_f32 v96,v96,v10
 v_mul_f32 v97,v97,v10
 v_mfma_f32_16x16x32_bf16 v[176:179],v[24:27],a[0:3],v[176:179]
 ds_read_b64_tr_b16 v[56:57],v7 offset:264
 ds_read_b64_tr_b16 v[58:59],v7 offset:6408
 v_mfma_f32_16x16x32_bf16 v[176:179],v[28:31],a[16:19],v[176:179]
 buffer_load_dwordx4 v3,s[16:19],s44 offen offset:2048 lds
 v_mul_f32 v98,v98,v10
 v_mul_f32 v99,v99,v10
 v_mfma_f32_16x16x32_bf16 v[180:183],v[28:31],a[20:23],v[180:183]
 ds_read_b64_tr_b16 v[60:61],v7 offset:12552
 ds_read_b64_tr_b16 v[62:63],v7 offset:18696
 v_mfma_f32_16x16x32_bf16 v[180:183],v[24:27],a[4:7],v[180:183]
 v_cvt_pk_bf16_f32 v96,v96,v97
 v_cvt_pk_bf16_f32 v97,v98,v99
 v_mfma_f32_16x16x32_bf16 v[184:187],v[24:27],a[8:11],v[184:187]
 v_accvgpr_write_b32 a208,v96
 v_accvgpr_write_b32 a209,v97
 v_mfma_f32_16x16x32_bf16 v[184:187],v[28:31],a[24:27],v[184:187]
 v_mul_f32 v100,v100,v11
 v_mul_f32 v101,v101,v11
 v_mfma_f32_16x16x32_bf16 v[188:191],v[28:31],a[28:31],v[188:191]
 v_mul_f32 v102,v102,v11
 v_mul_f32 v103,v103,v11
 v_mfma_f32_16x16x32_bf16 v[188:191],v[24:27],a[12:15],v[188:191]
 v_cvt_pk_bf16_f32 v100,v100,v101
 v_cvt_pk_bf16_f32 v101,v102,v103
 v_mfma_f32_16x16x32_bf16 v[192:195],v[32:35],a[0:3],v[192:195]
 v_accvgpr_write_b32 a212,v100
 v_accvgpr_write_b32 a213,v101
 v_mfma_f32_16x16x32_bf16 v[192:195],v[36:39],a[16:19],v[192:195]
 buffer_store_dwordx4 a[112:115],v9,s[8:11],s76 offen sc1
 v_mul_f32 v104,v104,v12
 v_mul_f32 v105,v105,v12
 v_mfma_f32_16x16x32_bf16 v[196:199],v[36:39],a[20:23],v[196:199]
 v_mul_f32 v106,v106,v12
 v_mul_f32 v107,v107,v12
 v_mfma_f32_16x16x32_bf16 v[196:199],v[32:35],a[4:7],v[196:199]
 v_cvt_pk_bf16_f32 v104,v104,v105
 v_cvt_pk_bf16_f32 v105,v106,v107
 v_mfma_f32_16x16x32_bf16 v[200:203],v[32:35],a[8:11],v[200:203]
 v_accvgpr_write_b32 a216,v104
 v_accvgpr_write_b32 a217,v105
 v_mfma_f32_16x16x32_bf16 v[200:203],v[36:39],a[24:27],v[200:203]
 v_mul_f32 v108,v108,v13
 v_mul_f32 v109,v109,v13
 v_mfma_f32_16x16x32_bf16 v[204:207],v[36:39],a[28:31],v[204:207]
 v_mul_f32 v110,v110,v13
 v_mul_f32 v111,v111,v13
 v_mfma_f32_16x16x32_bf16 v[204:207],v[32:35],a[12:15],v[204:207]
 s_waitcnt vmcnt(13) lgkmcnt(0)
 s_barrier
 v_cvt_pk_bf16_f32 v108,v108,v109
 v_mfma_f32_16x16x32_bf16 v[208:211],v[40:43],a[0:3],v[208:211]
 ds_read_b128 v[16:19],v4
 ds_read_b128 v[20:23],v5
 v_mfma_f32_16x16x32_bf16 v[208:211],v[44:47],a[16:19],v[208:211]
 v_cvt_pk_bf16_f32 v109,v110,v111
 v_accvgpr_write_b32 a220,v108
 v_mfma_f32_16x16x32_bf16 v[212:215],v[44:47],a[20:23],v[212:215]
 ds_read_b128 v[24:27],v4 offset:128
 ds_read_b128 v[28:31],v5 offset:128
 v_mfma_f32_16x16x32_bf16 v[212:215],v[40:43],a[4:7],v[212:215]
 v_accvgpr_write_b32 a221,v109
 v_mul_f32 v112,v112,v10
 v_mfma_f32_16x16x32_bf16 v[216:219],v[40:43],a[8:11],v[216:219]
 ds_read_b128 v[32:35],v4 offset:256
 ds_read_b128 v[36:39],v5 offset:256
 v_mfma_f32_16x16x32_bf16 v[216:219],v[44:47],a[24:27],v[216:219]
 v_mul_f32 v113,v113,v10
 v_mul_f32 v114,v114,v10
 v_mfma_f32_16x16x32_bf16 v[220:223],v[44:47],a[28:31],v[220:223]
 v_mul_f32 v115,v115,v10
 v_cvt_pk_bf16_f32 v112,v112,v113
 v_mfma_f32_16x16x32_bf16 v[220:223],v[40:43],a[12:15],v[220:223]
 buffer_store_dwordx4 a[116:119],v9,s[8:11],s77 offen sc1
 v_cvt_pk_bf16_f32 v113,v114,v115
 v_accvgpr_write_b32 a210,v112
 v_mfma_f32_16x16x32_bf16 v[224:227],v[48:51],a[0:3],v[224:227]
 v_accvgpr_write_b32 a211,v113
 v_mul_f32 v116,v116,v11
 v_mfma_f32_16x16x32_bf16 v[224:227],v[52:55],a[16:19],v[224:227]
 v_mul_f32 v117,v117,v11
 v_mul_f32 v118,v118,v11
 v_mfma_f32_16x16x32_bf16 v[228:231],v[52:55],a[20:23],v[228:231]
 v_mul_f32 v119,v119,v11
 v_cvt_pk_bf16_f32 v116,v116,v117
 v_mfma_f32_16x16x32_bf16 v[228:231],v[48:51],a[4:7],v[228:231]
 v_cvt_pk_bf16_f32 v117,v118,v119
 v_accvgpr_write_b32 a214,v116
 v_mfma_f32_16x16x32_bf16 v[232:235],v[48:51],a[8:11],v[232:235]
 v_accvgpr_write_b32 a215,v117
 v_mul_f32 v120,v120,v12
 v_mfma_f32_16x16x32_bf16 v[232:235],v[52:55],a[24:27],v[232:235]
 v_mul_f32 v121,v121,v12
 v_mul_f32 v122,v122,v12
 v_mfma_f32_16x16x32_bf16 v[236:239],v[52:55],a[28:31],v[236:239]
 v_mul_f32 v123,v123,v12
 v_cvt_pk_bf16_f32 v120,v120,v121
 v_mfma_f32_16x16x32_bf16 v[236:239],v[48:51],a[12:15],v[236:239]
 v_cvt_pk_bf16_f32 v121,v122,v123
 v_accvgpr_write_b32 a218,v120
 v_mfma_f32_16x16x32_bf16 v[240:243],v[56:59],a[0:3],v[240:243]
 v_accvgpr_write_b32 a219,v121
 v_mul_f32 v124,v124,v13
 v_mfma_f32_16x16x32_bf16 v[240:243],v[60:63],a[16:19],v[240:243]
 v_mul_f32 v125,v125,v13
 v_mul_f32 v126,v126,v13
 v_mfma_f32_16x16x32_bf16 v[244:247],v[60:63],a[20:23],v[244:247]
 v_mul_f32 v127,v127,v13
 v_cvt_pk_bf16_f32 v124,v124,v125
 v_mfma_f32_16x16x32_bf16 v[244:247],v[56:59],a[4:7],v[244:247]
 v_cvt_pk_bf16_f32 v125,v126,v127
 v_accvgpr_write_b32 a222,v124
 v_mfma_f32_16x16x32_bf16 v[248:251],v[56:59],a[8:11],v[248:251]
 v_accvgpr_write_b32 a223,v125
 v_mul_f32 v128,v128,v10
 v_mfma_f32_16x16x32_bf16 v[248:251],v[60:63],a[24:27],v[248:251]
 v_mul_f32 v129,v129,v10
 v_mul_f32 v130,v130,v10
 v_mfma_f32_16x16x32_bf16 v[252:255],v[60:63],a[28:31],v[252:255]
 v_mul_f32 v131,v131,v10
 v_cvt_pk_bf16_f32 v128,v128,v129
 v_mfma_f32_16x16x32_bf16 v[252:255],v[56:59],a[12:15],v[252:255]
 buffer_store_dwordx4 a[120:123],v9,s[8:11],s78 offen sc1
 v_cvt_pk_bf16_f32 v129,v130,v131
 v_accvgpr_write_b32 a224,v128
 v_accvgpr_write_b32 a225,v129
 v_pk_mul_f32 v[132:133],v[132:133],v[10:11] op_sel:[0,1] op_sel_hi:[1,1]
 v_pk_mul_f32 v[134:135],v[134:135],v[10:11] op_sel:[0,1] op_sel_hi:[1,1]
 v_cvt_pk_bf16_f32 v132,v132,v133
 v_cvt_pk_bf16_f32 v133,v134,v135
 v_accvgpr_write_b32 a228,v132
 v_accvgpr_write_b32 a229,v133
 v_pk_mul_f32 v[136:137],v[136:137],v[12:13] op_sel_hi:[1,0]
 v_pk_mul_f32 v[138:139],v[138:139],v[12:13] op_sel_hi:[1,0]
 v_cvt_pk_bf16_f32 v136,v136,v137
 v_cvt_pk_bf16_f32 v137,v138,v139
 v_accvgpr_write_b32 a232,v136
 v_accvgpr_write_b32 a233,v137
 v_pk_mul_f32 v[140:141],v[140:141],v[12:13] op_sel:[0,1] op_sel_hi:[1,1]
 v_pk_mul_f32 v[142:143],v[142:143],v[12:13] op_sel:[0,1] op_sel_hi:[1,1]
 v_cvt_pk_bf16_f32 v140,v140,v141
 v_cvt_pk_bf16_f32 v141,v142,v143
 v_accvgpr_write_b32 a236,v140
 v_accvgpr_write_b32 a237,v141
 v_pk_mul_f32 v[144:145],v[144:145],v[10:11] op_sel_hi:[1,0]
 v_pk_mul_f32 v[146:147],v[146:147],v[10:11] op_sel_hi:[1,0]
 v_cvt_pk_bf16_f32 v144,v144,v145
 v_cvt_pk_bf16_f32 v145,v146,v147
 v_accvgpr_write_b32 a226,v144
 v_accvgpr_write_b32 a227,v145
 v_pk_mul_f32 v[148:149],v[148:149],v[10:11] op_sel:[0,1] op_sel_hi:[1,1]
 v_pk_mul_f32 v[150:151],v[150:151],v[10:11] op_sel:[0,1] op_sel_hi:[1,1]
 v_cvt_pk_bf16_f32 v148,v148,v149
 v_cvt_pk_bf16_f32 v149,v150,v151
 v_accvgpr_write_b32 a230,v148
 v_accvgpr_write_b32 a231,v149
 v_pk_mul_f32 v[152:153],v[152:153],v[12:13] op_sel_hi:[1,0]
 v_pk_mul_f32 v[154:155],v[154:155],v[12:13] op_sel_hi:[1,0]
 v_cvt_pk_bf16_f32 v152,v152,v153
 v_cvt_pk_bf16_f32 v153,v154,v155
 v_accvgpr_write_b32 a234,v152
 v_accvgpr_write_b32 a235,v153
 v_pk_mul_f32 v[156:157],v[156:157],v[12:13] op_sel:[0,1] op_sel_hi:[1,1]
 v_pk_mul_f32 v[158:159],v[158:159],v[12:13] op_sel:[0,1] op_sel_hi:[1,1]
 v_cvt_pk_bf16_f32 v156,v156,v157
 v_cvt_pk_bf16_f32 v157,v158,v159
 v_accvgpr_write_b32 a238,v156
 v_accvgpr_write_b32 a239,v157
 v_pk_mul_f32 v[160:161],v[160:161],v[10:11] op_sel_hi:[1,0]
 v_pk_mul_f32 v[162:163],v[162:163],v[10:11] op_sel_hi:[1,0]
 v_cvt_pk_bf16_f32 v160,v160,v161
 v_cvt_pk_bf16_f32 v161,v162,v163
 v_accvgpr_write_b32 a240,v160
 v_accvgpr_write_b32 a241,v161
 v_pk_mul_f32 v[164:165],v[164:165],v[10:11] op_sel:[0,1] op_sel_hi:[1,1]
 v_pk_mul_f32 v[166:167],v[166:167],v[10:11] op_sel:[0,1] op_sel_hi:[1,1]
 v_cvt_pk_bf16_f32 v164,v164,v165
 v_cvt_pk_bf16_f32 v165,v166,v167
 v_accvgpr_write_b32 a244,v164
 v_accvgpr_write_b32 a245,v165
 v_pk_mul_f32 v[168:169],v[168:169],v[12:13] op_sel_hi:[1,0]
 v_pk_mul_f32 v[170:171],v[170:171],v[12:13] op_sel_hi:[1,0]
 v_cvt_pk_bf16_f32 v168,v168,v169
 v_cvt_pk_bf16_f32 v169,v170,v171
 v_accvgpr_write_b32 a248,v168
 v_accvgpr_write_b32 a249,v169
 buffer_store_dwordx4 a[124:127],v9,s[8:11],s79 offen sc1
 v_pk_mul_f32 v[172:173],v[172:173],v[12:13] op_sel:[0,1] op_sel_hi:[1,1]
 v_pk_mul_f32 v[174:175],v[174:175],v[12:13] op_sel:[0,1] op_sel_hi:[1,1]
 v_cvt_pk_bf16_f32 v172,v172,v173
 v_cvt_pk_bf16_f32 v173,v174,v175
 v_accvgpr_write_b32 a252,v172
 v_accvgpr_write_b32 a253,v173
 v_pk_mul_f32 v[176:177],v[176:177],v[10:11] op_sel_hi:[1,0]
 v_pk_mul_f32 v[178:179],v[178:179],v[10:11] op_sel_hi:[1,0]
 v_cvt_pk_bf16_f32 v176,v176,v177
 v_cvt_pk_bf16_f32 v177,v178,v179
 v_accvgpr_write_b32 a242,v176
 v_accvgpr_write_b32 a243,v177
 v_pk_mul_f32 v[180:181],v[180:181],v[10:11] op_sel:[0,1] op_sel_hi:[1,1]
 v_pk_mul_f32 v[182:183],v[182:183],v[10:11] op_sel:[0,1] op_sel_hi:[1,1]
 v_cvt_pk_bf16_f32 v180,v180,v181
 v_cvt_pk_bf16_f32 v181,v182,v183
 v_accvgpr_write_b32 a246,v180
 v_accvgpr_write_b32 a247,v181
 v_pk_mul_f32 v[184:185],v[184:185],v[12:13] op_sel_hi:[1,0]
 v_pk_mul_f32 v[186:187],v[186:187],v[12:13] op_sel_hi:[1,0]
 v_cvt_pk_bf16_f32 v184,v184,v185
 v_cvt_pk_bf16_f32 v185,v186,v187
 v_accvgpr_write_b32 a250,v184
 v_accvgpr_write_b32 a251,v185
 v_pk_mul_f32 v[188:189],v[188:189],v[12:13] op_sel:[0,1] op_sel_hi:[1,1]
 v_pk_mul_f32 v[190:191],v[190:191],v[12:13] op_sel:[0,1] op_sel_hi:[1,1]
 v_cvt_pk_bf16_f32 v188,v188,v189
 v_cvt_pk_bf16_f32 v189,v190,v191
 v_accvgpr_write_b32 a254,v188
 v_accvgpr_write_b32 a255,v189
 v_pk_mul_f32 v[192:193],v[192:193],v[10:11] op_sel_hi:[1,0]
 v_pk_mul_f32 v[194:195],v[194:195],v[10:11] op_sel_hi:[1,0]
 v_cvt_pk_bf16_f32 v64,v192,v193
 v_cvt_pk_bf16_f32 v65,v194,v195
 v_pk_mul_f32 v[196:197],v[196:197],v[10:11] op_sel:[0,1] op_sel_hi:[1,1]
 v_pk_mul_f32 v[198:199],v[198:199],v[10:11] op_sel:[0,1] op_sel_hi:[1,1]
 v_cvt_pk_bf16_f32 v68,v196,v197
 v_cvt_pk_bf16_f32 v69,v198,v199
 v_pk_mul_f32 v[200:201],v[200:201],v[12:13] op_sel_hi:[1,0]
 v_pk_mul_f32 v[202:203],v[202:203],v[12:13] op_sel_hi:[1,0]
 v_cvt_pk_bf16_f32 v72,v200,v201
 v_cvt_pk_bf16_f32 v73,v202,v203
 v_pk_mul_f32 v[204:205],v[204:205],v[12:13] op_sel:[0,1] op_sel_hi:[1,1]
 v_pk_mul_f32 v[206:207],v[206:207],v[12:13] op_sel:[0,1] op_sel_hi:[1,1]
 v_cvt_pk_bf16_f32 v76,v204,v205
 v_cvt_pk_bf16_f32 v77,v206,v207
 v_pk_mul_f32 v[208:209],v[208:209],v[10:11] op_sel_hi:[1,0]
 v_pk_mul_f32 v[210:211],v[210:211],v[10:11] op_sel_hi:[1,0]
 v_cvt_pk_bf16_f32 v66,v208,v209
 v_cvt_pk_bf16_f32 v67,v210,v211
 v_pk_mul_f32 v[212:213],v[212:213],v[10:11] op_sel:[0,1] op_sel_hi:[1,1]
 v_pk_mul_f32 v[214:215],v[214:215],v[10:11] op_sel:[0,1] op_sel_hi:[1,1]
 v_cvt_pk_bf16_f32 v70,v212,v213
 v_cvt_pk_bf16_f32 v71,v214,v215
 v_pk_mul_f32 v[216:217],v[216:217],v[12:13] op_sel_hi:[1,0]
 v_pk_mul_f32 v[218:219],v[218:219],v[12:13] op_sel_hi:[1,0]
 v_cvt_pk_bf16_f32 v74,v216,v217
 v_cvt_pk_bf16_f32 v75,v218,v219
 v_pk_mul_f32 v[220:221],v[220:221],v[12:13] op_sel:[0,1] op_sel_hi:[1,1]
 v_pk_mul_f32 v[222:223],v[222:223],v[12:13] op_sel:[0,1] op_sel_hi:[1,1]
 v_cvt_pk_bf16_f32 v78,v220,v221
 v_cvt_pk_bf16_f32 v79,v222,v223
 v_pk_mul_f32 v[224:225],v[224:225],v[10:11] op_sel_hi:[1,0]
 v_pk_mul_f32 v[226:227],v[226:227],v[10:11] op_sel_hi:[1,0]
 v_cvt_pk_bf16_f32 v80,v224,v225
 v_cvt_pk_bf16_f32 v81,v226,v227
 v_pk_mul_f32 v[228:229],v[228:229],v[10:11] op_sel:[0,1] op_sel_hi:[1,1]
 v_pk_mul_f32 v[230:231],v[230:231],v[10:11] op_sel:[0,1] op_sel_hi:[1,1]
 v_cvt_pk_bf16_f32 v84,v228,v229
 v_cvt_pk_bf16_f32 v85,v230,v231
 v_pk_mul_f32 v[232:233],v[232:233],v[12:13] op_sel_hi:[1,0]
 v_pk_mul_f32 v[234:235],v[234:235],v[12:13] op_sel_hi:[1,0]
 v_cvt_pk_bf16_f32 v88,v232,v233
 v_cvt_pk_bf16_f32 v89,v234,v235
 v_pk_mul_f32 v[236:237],v[236:237],v[12:13] op_sel:[0,1] op_sel_hi:[1,1]
 v_pk_mul_f32 v[238:239],v[238:239],v[12:13] op_sel:[0,1] op_sel_hi:[1,1]
 v_cvt_pk_bf16_f32 v92,v236,v237
 v_cvt_pk_bf16_f32 v93,v238,v239
 v_pk_mul_f32 v[240:241],v[240:241],v[10:11] op_sel_hi:[1,0]
 v_pk_mul_f32 v[242:243],v[242:243],v[10:11] op_sel_hi:[1,0]
 v_cvt_pk_bf16_f32 v82,v240,v241
 v_cvt_pk_bf16_f32 v83,v242,v243
 v_pk_mul_f32 v[244:245],v[244:245],v[10:11] op_sel:[0,1] op_sel_hi:[1,1]
 v_pk_mul_f32 v[246:247],v[246:247],v[10:11] op_sel:[0,1] op_sel_hi:[1,1]
 v_cvt_pk_bf16_f32 v86,v244,v245
 v_cvt_pk_bf16_f32 v87,v246,v247
 v_pk_mul_f32 v[248:249],v[248:249],v[12:13] op_sel_hi:[1,0]
 v_pk_mul_f32 v[250:251],v[250:251],v[12:13] op_sel_hi:[1,0]
 v_cvt_pk_bf16_f32 v90,v248,v249
 v_cvt_pk_bf16_f32 v91,v250,v251
 v_pk_mul_f32 v[252:253],v[252:253],v[12:13] op_sel:[0,1] op_sel_hi:[1,1]
 v_pk_mul_f32 v[254:255],v[254:255],v[12:13] op_sel:[0,1] op_sel_hi:[1,1]
 v_cvt_pk_bf16_f32 v94,v252,v253
 v_cvt_pk_bf16_f32 v95,v254,v255
 v_mov_b32 v254,0
 s_cmp_lg_u32 s32,0
 s_cbranch_scc1 Le15
 v_mov_b32 v14,0
 v_mov_b32 v15,1
 s_mov_b64 exec,1
 global_atomic_add v254,v14,v15,s[86:87] sc0 sc1
 s_mov_b64 exec,-1
Le15:
 v_mov_b32 v160,0
 v_mov_b32 v161,0
 v_mov_b32 v162,0
 v_mov_b32 v163,0
 s_waitcnt lgkmcnt(0)
 v_mfma_f32_16x16x32_bf16 v[192:195],v[16:19],a[192:195],0
 ds_read_b128 v[40:43],v4 offset:6144
 ds_read_b128 v[44:47],v5 offset:6144
 v_mfma_f32_16x16x32_bf16 v[192:195],v[20:23],a[208:211],v[192:195]
 ds_read_b128 v[48:51],v4 offset:6272
 ds_read_b128 v[52:55],v5 offset:6272
 v_mfma_f32_16x16x32_bf16 v[192:195],v[24:27],a[224:227],v[192:195]
 ds_read_b128 v[56:59],v4 offset:6400
 ds_read_b128 v[60:63],v5 offset:6400
 v_mfma_f32_16x16x32_bf16 v[192:195],v[28:31],a[240:243],v[192:195]
 v_mov_b32 v10,0
 v_mov_b32 v11,0
 v_mfma_f32_16x16x32_bf16 v[192:195],v[32:35],v[64:67],v[192:195]
 v_mov_b32 v12,0
 v_mov_b32 v13,0
 v_mfma_f32_16x16x32_bf16 v[192:195],v[36:39],v[80:83],v[192:195]
 v_mov_b32 v248,v1
 v_mov_b32 v249,v2
 v_mfma_f32_16x16x32_bf16 v[196:199],v[16:19],a[196:199],0
 v_mov_b32 v250,v3
 v_lshrrev_b32 v14,2,v0
 v_mfma_f32_16x16x32_bf16 v[196:199],v[20:23],a[212:215],v[196:199]
 v_mul_u32_u24 v6,384,v14
 v_and_b32 v14,6,v14
 v_mfma_f32_16x16x32_bf16 v[196:199],v[24:27],a[228:231],v[196:199]
 v_lshl_add_u32 v6,v14,4,v6
 v_and_b32 v15,3,v0
 v_mfma_f32_16x16x32_bf16 v[196:199],v[28:31],a[244:247],v[196:199]
 v_lshl_add_u32 v6,v15,3,v6
 v_add_u32 v6,98304,v6
 v_mfma_f32_16x16x32_bf16 v[196:199],v[32:35],v[68:71],v[196:199]
 v_xor_b32 v7,32,v6
 v_xor_b32 v8,64,v6
 v_mfma_f32_16x16x32_bf16 v[196:199],v[36:39],v[84:87],v[196:199]
 v_xor_b32 v9,0x60,v6
 v_max3_f32 v240,v192,v193,v194
 v_mfma_f32_16x16x32_bf16 v[200:203],v[16:19],a[200:203],0
 v_max_f32 v240,v240,v195
 v_mfma_f32_16x16x32_bf16 v[200:203],v[20:23],a[216:219],v[200:203]
 v_mfma_f32_16x16x32_bf16 v[200:203],v[24:27],a[232:235],v[200:203]
 v_mfma_f32_16x16x32_bf16 v[200:203],v[28:31],a[248:251],v[200:203]
 v_mfma_f32_16x16x32_bf16 v[200:203],v[32:35],v[72:75],v[200:203]
 v_mfma_f32_16x16x32_bf16 v[200:203],v[36:39],v[88:91],v[200:203]
 v_max3_f32 v241,v196,v197,v198
 v_max_f32 v241,v241,v199
 v_mfma_f32_16x16x32_bf16 v[204:207],v[16:19],a[204:207],0
 v_mfma_f32_16x16x32_bf16 v[204:207],v[20:23],a[220:223],v[204:207]
 v_mfma_f32_16x16x32_bf16 v[204:207],v[24:27],a[236:239],v[204:207]
 v_mfma_f32_16x16x32_bf16 v[204:207],v[28:31],a[252:255],v[204:207]
 v_mfma_f32_16x16x32_bf16 v[204:207],v[32:35],v[76:79],v[204:207]
 v_mfma_f32_16x16x32_bf16 v[204:207],v[36:39],v[92:95],v[204:207]
 v_max3_f32 v242,v200,v201,v202
 v_max_f32 v242,v242,v203
 v_mfma_f32_16x16x32_bf16 a[0:3],v[160:163],v[160:163],0
 ds_read_b128 v[16:19],v4 offset:12288
 ds_read_b128 v[20:23],v5 offset:12288
 v_mfma_f32_16x16x32_bf16 a[4:7],v[160:163],v[160:163],0
 ds_read_b128 v[24:27],v4 offset:12416
 ds_read_b128 v[28:31],v5 offset:12416
 v_mfma_f32_16x16x32_bf16 a[8:11],v[160:163],v[160:163],0
 ds_read_b128 v[32:35],v4 offset:12544
 ds_read_b128 v[36:39],v5 offset:12544
 v_mfma_f32_16x16x32_bf16 a[12:15],v[160:163],v[160:163],0
 v_mfma_f32_16x16x32_bf16 a[16:19],v[160:163],v[160:163],0
 s_sub_u32 s20,s12,s35
 v_mfma_f32_16x16x32_bf16 a[20:23],v[160:163],v[160:163],0
 s_subb_u32 s21,s13,0
 v_max3_f32 v243,v204,v205,v206
 v_max_f32 v243,v243,v207
 v_mfma_f32_16x16x32_bf16 a[24:27],v[160:163],v[160:163],0
 s_mov_b32 s22,786432
 v_mov_b32 v244,v240
 v_mov_b32 v245,v241
 v_mfma_f32_16x16x32_bf16 a[28:31],v[160:163],v[160:163],0
 s_sub_u32 s24,s16,s35
 v_mov_b32 v246,v242
 v_mov_b32 v247,v243
 v_mfma_f32_16x16x32_bf16 a[32:35],v[160:163],v[160:163],0
 s_subb_u32 s25,s17,0
 v_permlane32_swap_b32 v240,v244
 v_permlane32_swap_b32 v241,v245
 v_mfma_f32_16x16x32_bf16 a[36:39],v[160:163],v[160:163],0
 s_mov_b32 s26,786432
 v_permlane32_swap_b32 v242,v246
 v_permlane32_swap_b32 v243,v247
 v_mfma_f32_16x16x32_bf16 a[40:43],v[160:163],v[160:163],0
 s_movk_i32 s66,3072
 v_max_f32 v240,v240,v244
 v_max_f32 v241,v241,v245
 v_mfma_f32_16x16x32_bf16 a[44:47],v[160:163],v[160:163],0
 s_movk_i32 s68,3072
 v_max_f32 v242,v242,v246
 v_max_f32 v243,v243,v247
 v_mfma_f32_16x16x32_bf16 a[48:51],v[160:163],v[160:163],0
 s_movk_i32 s67,24576
 v_mov_b32 v244,v240
 v_mov_b32 v245,v241
 v_mfma_f32_16x16x32_bf16 a[52:55],v[160:163],v[160:163],0
 s_movk_i32 s69,24576
 v_mov_b32 v246,v242
 v_mov_b32 v247,v243
 v_mfma_f32_16x16x32_bf16 a[56:59],v[160:163],v[160:163],0
 s_mul_i32 s41,s52,48
 v_permlane16_swap_b32 v240,v244
 v_permlane16_swap_b32 v241,v245
 v_mfma_f32_16x16x32_bf16 a[60:63],v[160:163],v[160:163],0
 s_add_u32 s41,s41,s32
 v_permlane16_swap_b32 v242,v246
 v_permlane16_swap_b32 v243,v247
 v_mfma_f32_16x16x32_bf16 a[64:67],v[160:163],v[160:163],0
 s_mul_i32 s41,s41,20480
 v_max_f32 v240,v240,v244
 v_max_f32 v241,v241,v245
 v_mfma_f32_16x16x32_bf16 a[68:71],v[160:163],v[160:163],0
 s_mul_i32 s42,s53,320
 v_max_f32 v242,v242,v246
 v_max_f32 v243,v243,v247
 v_mfma_f32_16x16x32_bf16 a[72:75],v[160:163],v[160:163],0
 s_andn2_b32 s42,s42,127
 v_sub_f32 v112,0,v240
 v_sub_f32 v113,0,v240
 v_mfma_f32_16x16x32_bf16 a[76:79],v[160:163],v[160:163],0
 s_add_u32 s41,s41,s42
 v_sub_f32 v114,0,v240
 v_sub_f32 v115,0,v240
 v_mfma_f32_16x16x32_bf16 a[80:83],v[160:163],v[160:163],0
 s_add_u32 s56,s72,s41
 v_sub_f32 v116,0,v241
 v_sub_f32 v117,0,v241
 v_mfma_f32_16x16x32_bf16 a[84:87],v[160:163],v[160:163],0
 s_addc_u32 s57,s73,0
 v_sub_f32 v118,0,v241
 v_sub_f32 v119,0,v241
 v_mfma_f32_16x16x32_bf16 a[88:91],v[160:163],v[160:163],0
 s_sub_u32 s58,7864320,s41
 v_sub_f32 v120,0,v242
 v_sub_f32 v121,0,v242
 v_mfma_f32_16x16x32_bf16 a[92:95],v[160:163],v[160:163],0
 s_mul_i32 s70,s53,245760
 v_sub_f32 v122,0,v242
 v_sub_f32 v123,0,v242
 v_mfma_f32_16x16x32_bf16 a[96:99],v[160:163],v[160:163],0
 s_sub_u32 s70,s70,81920
 v_sub_f32 v124,0,v243
 v_sub_f32 v125,0,v243
 v_mfma_f32_16x16x32_bf16 a[100:103],v[160:163],v[160:163],0
 s_bfe_u32 s41,s62,0x30003
 v_sub_f32 v126,0,v243
 v_sub_f32 v127,0,v243
 v_mfma_f32_16x16x32_bf16 a[104:107],v[160:163],v[160:163],0
 s_mul_i32 s41,s41,384
 v_sub_f32 v192,v192,v240
 v_sub_f32 v193,v193,v240
 v_mfma_f32_16x16x32_bf16 a[108:111],v[160:163],v[160:163],0
 s_mul_i32 s42,s32,98304
 v_sub_f32 v194,v194,v240
 v_sub_f32 v195,v195,v240
 v_mfma_f32_16x16x32_bf16 a[112:115],v[160:163],v[160:163],0
 s_add_u32 s41,s41,s42
 v_sub_f32 v196,v196,v241
 v_sub_f32 v197,v197,v241
 v_mfma_f32_16x16x32_bf16 a[116:119],v[160:163],v[160:163],0
 s_add_u32 s59,s80,s41
 v_sub_f32 v198,v198,v241
 v_sub_f32 v199,v199,v241
 v_mfma_f32_16x16x32_bf16 a[120:123],v[160:163],v[160:163],0
 s_addc_u32 s60,s81,0
 v_sub_f32 v200,v200,v242
 v_sub_f32 v201,v201,v242
 v_mfma_f32_16x16x32_bf16 a[124:127],v[160:163],v[160:163],0
 s_sub_u32 s61,1966080,s41
 v_sub_f32 v202,v202,v242
 v_sub_f32 v203,v203,v242
 v_mfma_f32_16x16x32_bf16 a[128:131],v[160:163],v[160:163],0
 s_mov_b32 s76,49152
 v_sub_f32 v204,v204,v243
 v_sub_f32 v205,v205,v243
 v_mfma_f32_16x16x32_bf16 a[132:135],v[160:163],v[160:163],0
 s_mov_b32 s77,393216
 v_sub_f32 v206,v206,v243
 v_sub_f32 v207,v207,v243
 v_mfma_f32_16x16x32_bf16 a[136:139],v[160:163],v[160:163],0
 s_mov_b32 s78,4294574080
 v_exp_f32 v192,v192
 v_mfma_f32_16x16x32_bf16 a[140:143],v[160:163],v[160:163],0
 s_movk_i32 s79,5462
 v_exp_f32 v193,v193
 v_mfma_f32_16x16x32_bf16 a[144:147],v[160:163],v[160:163],0
 s_movk_i32 s75,2880
 v_exp_f32 v194,v194
 v_mfma_f32_16x16x32_bf16 a[148:151],v[160:163],v[160:163],0
 s_mov_b32 s74,1
 v_add_f32 v10,v10,v192
 v_cvt_pk_bf16_f32 v128,v192,v193
 v_mfma_f32_16x16x32_bf16 a[152:155],v[160:163],v[160:163],0
 s_mov_b32 s71,2
 v_exp_f32 v195,v195
 v_mfma_f32_16x16x32_bf16 a[156:159],v[160:163],v[160:163],0
 s_and_b32 s48,s62,63
 v_add_f32 v10,v10,v193
 v_add_f32 v10,v10,v194
 v_mfma_f32_16x16x32_bf16 a[160:163],v[160:163],v[160:163],0
 s_add_u32 s48,s48,s32
 v_cvt_pk_bf16_f32 v129,v194,v195
 v_add_f32 v10,v10,v195
 v_mfma_f32_16x16x32_bf16 a[164:167],v[160:163],v[160:163],0
 v_exp_f32 v196,v196
 v_mfma_f32_16x16x32_bf16 a[168:171],v[160:163],v[160:163],0
 v_exp_f32 v197,v197
 v_mfma_f32_16x16x32_bf16 a[172:175],v[160:163],v[160:163],0
 v_exp_f32 v198,v198
 v_mfma_f32_16x16x32_bf16 a[176:179],v[160:163],v[160:163],0
 v_add_f32 v11,v11,v196
 v_cvt_pk_bf16_f32 v136,v196,v197
 v_mfma_f32_16x16x32_bf16 a[180:183],v[160:163],v[160:163],0
 v_exp_f32 v199,v199
 v_mfma_f32_16x16x32_bf16 a[184:187],v[160:163],v[160:163],0
 v_add_f32 v11,v11,v197
 v_add_f32 v11,v11,v198
 v_mfma_f32_16x16x32_bf16 a[188:191],v[160:163],v[160:163],0
 s_waitcnt lgkmcnt(0)
 v_cvt_pk_bf16_f32 v137,v198,v199
 v_add_f32 v11,v11,v199
 v_mfma_f32_16x16x32_bf16 v[208:211],v[40:43],a[192:195],v[112:115]
 v_exp_f32 v200,v200
 v_mfma_f32_16x16x32_bf16 v[208:211],v[44:47],a[208:211],v[208:211]
 v_exp_f32 v201,v201
 v_mfma_f32_16x16x32_bf16 v[208:211],v[48:51],a[224:227],v[208:211]
 v_exp_f32 v202,v202
 v_mfma_f32_16x16x32_bf16 v[208:211],v[52:55],a[240:243],v[208:211]
 v_add_f32 v12,v12,v200
 v_cvt_pk_bf16_f32 v144,v200,v201
 v_mfma_f32_16x16x32_bf16 v[208:211],v[56:59],v[64:67],v[208:211]
 v_exp_f32 v203,v203
 v_mfma_f32_16x16x32_bf16 v[208:211],v[60:63],v[80:83],v[208:211]
 v_add_f32 v12,v12,v201
 v_add_f32 v12,v12,v202
 v_mfma_f32_16x16x32_bf16 v[212:215],v[40:43],a[196:199],v[116:119]
 v_cvt_pk_bf16_f32 v145,v202,v203
 v_add_f32 v12,v12,v203
 v_mfma_f32_16x16x32_bf16 v[212:215],v[44:47],a[212:215],v[212:215]
 v_exp_f32 v204,v204
 v_mfma_f32_16x16x32_bf16 v[212:215],v[48:51],a[228:231],v[212:215]
 v_exp_f32 v205,v205
 v_mfma_f32_16x16x32_bf16 v[212:215],v[52:55],a[244:247],v[212:215]
 v_exp_f32 v206,v206
 v_mfma_f32_16x16x32_bf16 v[212:215],v[56:59],v[68:71],v[212:215]
 v_add_f32 v13,v13,v204
 v_cvt_pk_bf16_f32 v152,v204,v205
 v_mfma_f32_16x16x32_bf16 v[212:215],v[60:63],v[84:87],v[212:215]
 v_exp_f32 v207,v207
 v_mfma_f32_16x16x32_bf16 v[216:219],v[40:43],a[200:203],v[120:123]
 v_add_f32 v13,v13,v205
 v_add_f32 v13,v13,v206
 v_mfma_f32_16x16x32_bf16 v[216:219],v[44:47],a[216:219],v[216:219]
 v_cvt_pk_bf16_f32 v153,v206,v207
 v_add_f32 v13,v13,v207
 v_mfma_f32_16x16x32_bf16 v[216:219],v[48:51],a[232:235],v[216:219]
 v_exp_f32 v208,v208
 v_mfma_f32_16x16x32_bf16 v[216:219],v[52:55],a[248:251],v[216:219]
 v_exp_f32 v209,v209
 v_mfma_f32_16x16x32_bf16 v[216:219],v[56:59],v[72:75],v[216:219]
 v_exp_f32 v210,v210
 v_mfma_f32_16x16x32_bf16 v[216:219],v[60:63],v[88:91],v[216:219]
 v_add_f32 v10,v10,v208
 v_cvt_pk_bf16_f32 v130,v208,v209
 v_mfma_f32_16x16x32_bf16 v[220:223],v[40:43],a[204:207],v[124:127]
 v_exp_f32 v211,v211
 v_mfma_f32_16x16x32_bf16 v[220:223],v[44:47],a[220:223],v[220:223]
 v_add_f32 v10,v10,v209
 v_add_f32 v10,v10,v210
 v_mfma_f32_16x16x32_bf16 v[220:223],v[48:51],a[236:239],v[220:223]
 v_cvt_pk_bf16_f32 v131,v210,v211
 v_add_f32 v10,v10,v211
 v_mfma_f32_16x16x32_bf16 v[220:223],v[52:55],a[252:255],v[220:223]
 v_exp_f32 v212,v212
 v_mfma_f32_16x16x32_bf16 v[220:223],v[56:59],v[76:79],v[220:223]
 v_exp_f32 v213,v213
 v_mfma_f32_16x16x32_bf16 v[220:223],v[60:63],v[92:95],v[220:223]
 v_exp_f32 v214,v214
 v_mfma_f32_16x16x32_bf16 v[224:227],v[16:19],a[192:195],v[112:115]
 ds_read_b128 v[40:43],v4 offset:18432
 ds_read_b128 v[44:47],v5 offset:18432
 v_mfma_f32_16x16x32_bf16 v[224:227],v[20:23],a[208:211],v[224:227]
 ds_read_b128 v[48:51],v4 offset:18560
 ds_read_b128 v[52:55],v5 offset:18560
 v_mfma_f32_16x16x32_bf16 v[224:227],v[24:27],a[224:227],v[224:227]
 ds_read_b128 v[56:59],v4 offset:18688
 ds_read_b128 v[60:63],v5 offset:18688
 v_mfma_f32_16x16x32_bf16 v[224:227],v[28:31],a[240:243],v[224:227]
 v_add_f32 v11,v11,v212
 v_cvt_pk_bf16_f32 v138,v212,v213
 v_mfma_f32_16x16x32_bf16 v[224:227],v[32:35],v[64:67],v[224:227]
 v_add_u32 v4,49152,v4
 v_add_u32 v5,49152,v5
 v_mfma_f32_16x16x32_bf16 v[224:227],v[36:39],v[80:83],v[224:227]
 v_exp_f32 v215,v215
 v_mfma_f32_16x16x32_bf16 v[228:231],v[16:19],a[196:199],v[116:119]
 v_add_f32 v11,v11,v213
 v_add_f32 v11,v11,v214
 v_mfma_f32_16x16x32_bf16 v[228:231],v[20:23],a[212:215],v[228:231]
 v_cvt_pk_bf16_f32 v139,v214,v215
 v_add_f32 v11,v11,v215
 v_mfma_f32_16x16x32_bf16 v[228:231],v[24:27],a[228:231],v[228:231]
 v_exp_f32 v216,v216
 v_mfma_f32_16x16x32_bf16 v[228:231],v[28:31],a[244:247],v[228:231]
 v_exp_f32 v217,v217
 v_mfma_f32_16x16x32_bf16 v[228:231],v[32:35],v[68:71],v[228:231]
 v_exp_f32 v218,v218
 v_mfma_f32_16x16x32_bf16 v[228:231],v[36:39],v[84:87],v[228:231]
 v_add_f32 v12,v12,v216
 v_cvt_pk_bf16_f32 v146,v216,v217
 v_mfma_f32_16x16x32_bf16 v[232:235],v[16:19],a[200:203],v[120:123]
 v_exp_f32 v219,v219
 v_mfma_f32_16x16x32_bf16 v[232:235],v[20:23],a[216:219],v[232:235]
 v_add_f32 v12,v12,v217
 v_add_f32 v12,v12,v218
 v_mfma_f32_16x16x32_bf16 v[232:235],v[24:27],a[232:235],v[232:235]
 v_cvt_pk_bf16_f32 v147,v218,v219
 v_add_f32 v12,v12,v219
 v_mfma_f32_16x16x32_bf16 v[232:235],v[28:31],a[248:251],v[232:235]
 v_exp_f32 v220,v220
 v_mfma_f32_16x16x32_bf16 v[232:235],v[32:35],v[72:75],v[232:235]
 v_exp_f32 v221,v221
 v_mfma_f32_16x16x32_bf16 v[232:235],v[36:39],v[88:91],v[232:235]
 v_exp_f32 v222,v222
 v_mfma_f32_16x16x32_bf16 v[236:239],v[16:19],a[204:207],v[124:127]
 v_add_f32 v13,v13,v220
 v_cvt_pk_bf16_f32 v154,v220,v221
 v_mfma_f32_16x16x32_bf16 v[236:239],v[20:23],a[220:223],v[236:239]
 v_exp_f32 v223,v223
 v_mfma_f32_16x16x32_bf16 v[236:239],v[24:27],a[236:239],v[236:239]
 v_add_f32 v13,v13,v221
 v_add_f32 v13,v13,v222
 v_mfma_f32_16x16x32_bf16 v[236:239],v[28:31],a[252:255],v[236:239]
 v_cvt_pk_bf16_f32 v155,v222,v223
 v_add_f32 v13,v13,v223
 v_mfma_f32_16x16x32_bf16 v[236:239],v[32:35],v[76:79],v[236:239]
 v_mfma_f32_16x16x32_bf16 v[236:239],v[36:39],v[92:95],v[236:239]
 s_waitcnt vmcnt(22) lgkmcnt(0)
 s_barrier
 v_exp_f32 v224,v224
 v_mfma_f32_16x16x32_bf16 v[96:99],v[40:43],a[192:195],v[112:115]
 ds_read_b128 v[16:19],v4
 ds_read_b128 v[20:23],v5
 v_mfma_f32_16x16x32_bf16 v[96:99],v[44:47],a[208:211],v[96:99]
 s_mov_b32 s36,0
 ds_read_b128 v[24:27],v4 offset:128
 ds_read_b128 v[28:31],v5 offset:128
 v_mfma_f32_16x16x32_bf16 v[96:99],v[48:51],a[224:227],v[96:99]
 s_mov_b32 s37,49152
 ds_read_b128 v[32:35],v4 offset:256
 ds_read_b128 v[36:39],v5 offset:256
 v_mfma_f32_16x16x32_bf16 v[96:99],v[52:55],a[240:243],v[96:99]
 s_mov_b32 s38,98304
 v_exp_f32 v225,v225
 v_mfma_f32_16x16x32_bf16 v[96:99],v[56:59],v[64:67],v[96:99]
 s_mov_b32 s39,73728
 v_exp_f32 v226,v226
 v_mfma_f32_16x16x32_bf16 v[96:99],v[60:63],v[80:83],v[96:99]
 s_mov_b32 s40,49152
 v_add_f32 v10,v10,v224
 v_cvt_pk_bf16_f32 v132,v224,v225
 v_mfma_f32_16x16x32_bf16 v[100:103],v[40:43],a[196:199],v[116:119]
 s_add_u32 m0,s35,24576
 v_exp_f32 v227,v227
 v_mfma_f32_16x16x32_bf16 v[100:103],v[44:47],a[212:215],v[100:103]
 s_mov_b32 s43,0
 v_add_f32 v10,v10,v225
 v_add_f32 v10,v10,v226
 v_mfma_f32_16x16x32_bf16 v[100:103],v[48:51],a[228:231],v[100:103]
 buffer_load_dwordx4 v1,s[12:15],s39 offen lds
 v_cvt_pk_bf16_f32 v133,v226,v227
 v_mfma_f32_16x16x32_bf16 v[100:103],v[52:55],a[244:247],v[100:103]
 v_add_f32 v10,v10,v227
 v_mfma_f32_16x16x32_bf16 v[100:103],v[56:59],v[68:71],v[100:103]
 buffer_load_dwordx4 v2,s[12:15],s39 offen offset:1024 lds
 v_mfma_f32_16x16x32_bf16 v[100:103],v[60:63],v[84:87],v[100:103]
 v_exp_f32 v228,v228
 v_mfma_f32_16x16x32_bf16 v[104:107],v[40:43],a[200:203],v[120:123]
 buffer_load_dwordx4 v3,s[12:15],s39 offen offset:2048 lds
 v_mfma_f32_16x16x32_bf16 v[104:107],v[44:47],a[216:219],v[104:107]
 v_exp_f32 v229,v229
 v_mfma_f32_16x16x32_bf16 v[104:107],v[48:51],a[232:235],v[104:107]
 v_exp_f32 v230,v230
 v_mfma_f32_16x16x32_bf16 v[104:107],v[52:55],a[248:251],v[104:107]
 v_add_f32 v11,v11,v228
 v_cvt_pk_bf16_f32 v140,v228,v229
 v_mfma_f32_16x16x32_bf16 v[104:107],v[56:59],v[72:75],v[104:107]
 v_exp_f32 v231,v231
 v_mfma_f32_16x16x32_bf16 v[104:107],v[60:63],v[88:91],v[104:107]
 v_add_f32 v11,v11,v229
 v_add_f32 v11,v11,v230
 v_mfma_f32_16x16x32_bf16 v[108:111],v[40:43],a[204:207],v[124:127]
 v_cvt_pk_bf16_f32 v141,v230,v231
 v_add_f32 v11,v11,v231
 v_mfma_f32_16x16x32_bf16 v[108:111],v[44:47],a[220:223],v[108:111]
 v_exp_f32 v232,v232
 v_mfma_f32_16x16x32_bf16 v[108:111],v[48:51],a[236:239],v[108:111]
 v_exp_f32 v233,v233
 v_mfma_f32_16x16x32_bf16 v[108:111],v[52:55],a[252:255],v[108:111]
 v_exp_f32 v234,v234
 v_mfma_f32_16x16x32_bf16 v[108:111],v[56:59],v[76:79],v[108:111]
 v_add_f32 v12,v12,v232
 v_cvt_pk_bf16_f32 v148,v232,v233
 v_mfma_f32_16x16x32_bf16 v[108:111],v[60:63],v[92:95],v[108:111]
 v_exp_f32 v235,v235
 v_add_f32 v12,v12,v233
 v_add_f32 v12,v12,v234
 v_cvt_pk_bf16_f32 v149,v234,v235
 v_add_f32 v12,v12,v235
 v_exp_f32 v236,v236
 v_exp_f32 v237,v237
 v_exp_f32 v238,v238
 v_add_f32 v13,v13,v236
 v_cvt_pk_bf16_f32 v156,v236,v237
 v_exp_f32 v239,v239
 v_add_f32 v13,v13,v237
 v_add_f32 v13,v13,v238
 v_cvt_pk_bf16_f32 v157,v238,v239
 v_add_f32 v13,v13,v239
 v_exp_f32 v96,v96
 v_exp_f32 v97,v97
 v_exp_f32 v98,v98
 v_add_f32 v10,v10,v96
 v_cvt_pk_bf16_f32 v134,v96,v97
 v_exp_f32 v99,v99
 v_add_f32 v10,v10,v97
 v_add_f32 v10,v10,v98
 v_cvt_pk_bf16_f32 v135,v98,v99
 v_add_f32 v10,v10,v99
 v_exp_f32 v100,v100
 v_exp_f32 v101,v101
 v_exp_f32 v102,v102
 v_add_f32 v11,v11,v100
 v_cvt_pk_bf16_f32 v142,v100,v101
 v_exp_f32 v103,v103
 v_add_f32 v11,v11,v101
 v_add_f32 v11,v11,v102
 v_cvt_pk_bf16_f32 v143,v102,v103
 v_add_f32 v11,v11,v103
 v_exp_f32 v104,v104
 v_exp_f32 v105,v105
 v_exp_f32 v106,v106
 v_add_f32 v12,v12,v104
 v_cvt_pk_bf16_f32 v150,v104,v105
 v_exp_f32 v107,v107
 v_add_f32 v12,v12,v105
 v_add_f32 v12,v12,v106
 v_cvt_pk_bf16_f32 v151,v106,v107
 v_add_f32 v12,v12,v107
 v_exp_f32 v108,v108
 v_mov_b32 v236,s80
 v_mov_b32 v237,s81
 v_mov_b32 v238,0
 v_mov_b32 v239,0
 s_waitcnt lgkmcnt(0)
 s_nop 7
 s_branch recurrent_scan__mha_block_cached__mixer_s_mlp__prompt_kernel_loop
Lp14_spin:
 s_mov_b32 s91,0
Lp14_again:
 s_sleep 6
 buffer_load_dword v5,v4,s[92:95],0 offen sc1
 s_add_u32 s91,s91,1
 s_cmp_gt_u32 s91,0x40000
 s_waitcnt vmcnt(0)
 s_cbranch_scc1 Lp14_ok
 v_cmp_ne_u32 vcc,s51,v5
 s_nop 1
 s_cbranch_vccnz Lp14_again
 s_branch Lp14_ok
recurrent_scan__mha_block_cached__mixer_s_mlp__prompt_kernel_hA:
 v_add_u32 v14,0,v0
 v_mul_u32_u24 v15,5462,v14
 v_lshrrev_b32 v15,16,v15
 v_lshrrev_b32 v14,1,v15
 v_and_b32 v14,2,v14
 v_xor_b32 v14,v14,v0
 v_mul_u32_u24 v56,1088,v15
 v_lshl_add_u32 v56,v14,4,v56
 v_and_b32 v15,12,v15
 v_mul_u32_u24 v15,1280,v15
 v_add_u32 v56,v56,v15
 v_add_u32 v14,64,v0
 v_mul_u32_u24 v15,5462,v14
 v_lshrrev_b32 v15,16,v15
 v_lshrrev_b32 v14,1,v15
 v_and_b32 v14,2,v14
 v_xor_b32 v14,v14,v0
 v_mul_u32_u24 v57,1088,v15
 v_lshl_add_u32 v57,v14,4,v57
 v_and_b32 v15,12,v15
 v_mul_u32_u24 v15,1280,v15
 v_add_u32 v57,v57,v15
 v_add_u32 v14,128,v0
 v_mul_u32_u24 v15,5462,v14
 v_lshrrev_b32 v15,16,v15
 v_lshrrev_b32 v14,1,v15
 v_and_b32 v14,2,v14
 v_xor_b32 v14,v14,v0
 v_mul_u32_u24 v58,1088,v15
 v_lshl_add_u32 v58,v14,4,v58
 v_and_b32 v15,12,v15
 v_mul_u32_u24 v15,1280,v15
 v_add_u32 v58,v58,v15
 s_waitcnt lgkmcnt(0)
 s_lshr_b32 s74,s39,1
 s_mul_i32 s40,s74,5
 s_lshr_b32 s40,s40,3
 s_lshl_b32 s47,s40,8
 s_mul_i32 s49,s40,163840
 s_mul_i32 s36,s54,20480
 s_add_u32 s8,s64,s36
 s_addc_u32 s9,s65,0
 s_mov_b32 s10,40960
 s_mov_b32 s11,0x20000
 s_mul_i32 s41,s74,160
 s_and_b32 s42,s74,1
 s_lshl_b32 s42,s42,5
 s_sub_u32 s41,s41,s42
 s_mul_i32 s42,s32,40960
 s_add_u32 s41,s41,s42
 s_add_u32 s4,s76,s41
 s_addc_u32 s5,s77,0
 s_sub_u32 s6,819200,s41
 s_mov_b32 s7,0x20000
 s_lshl_b32 s44,s39,2
 s_add_u32 s44,s44,s32
 s_lshl_b32 s45,s52,6
 s_add_u32 s45,s45,s44
 s_mul_i32 s45,s45,5120
 v_min_u32 v14,39,v0
 v_lshlrev_b32 v14,7,v14
 v_add_u32 v14,s45,v14
 global_load_dword v61,v14,s[64:65]
 s_add_u32 m0,s46,0
 s_add_u32 s45,s47,0
 buffer_load_dwordx4 v8,s[8:11],s45 offen lds
 s_add_u32 m0,s46,1024
 s_add_u32 s45,s47,10240
 buffer_load_dwordx4 v8,s[8:11],s45 offen lds
 s_add_u32 m0,s46,2048
 s_add_u32 s45,s47,20480
 buffer_load_dwordx4 v8,s[8:11],s45 offen lds
 s_add_u32 m0,s46,3072
 s_add_u32 s45,s47,30720
 buffer_load_dwordx4 v8,s[8:11],s45 offen lds
 s_add_u32 m0,s46,4096
 s_add_u32 s45,s47,128
 buffer_load_dwordx4 v8,s[8:11],s45 offen lds
 s_add_u32 m0,s46,5120
 s_add_u32 s45,s47,10368
 buffer_load_dwordx4 v8,s[8:11],s45 offen lds
 s_add_u32 m0,s46,6144
 s_add_u32 s45,s47,20608
 buffer_load_dwordx4 v8,s[8:11],s45 offen lds
 s_add_u32 m0,s46,7168
 s_add_u32 s45,s47,30848
 s_add_u32 s47,s47,256
 s_cmp_eq_u32 s47,1280
 s_cselect_b32 s47,0,s47
 buffer_load_dwordx4 v8,s[8:11],s45 offen lds
 s_add_u32 m0,s35,0
 s_mov_b32 s44,s49
 buffer_load_dwordx4 v56,s[4:7],s44 offen lds
 s_add_u32 m0,s35,0
 s_add_u32 s49,s49,163840
 buffer_load_dwordx4 v57,s[4:7],s44 offen offset:1024 lds
 s_add_u32 m0,s35,0
 s_cmp_eq_u32 s49,819200
 s_cselect_b32 s49,0,s49
 buffer_load_dwordx4 v58,s[4:7],s44 offen offset:2048 lds
 s_add_u32 m0,s35,3072
 s_add_u32 s44,s44,5120
 buffer_load_dwordx4 v56,s[4:7],s44 offen lds
 s_add_u32 m0,s35,3072
 s_nop 0
 buffer_load_dwordx4 v57,s[4:7],s44 offen offset:1024 lds
 s_add_u32 m0,s35,3072
 s_nop 0
 buffer_load_dwordx4 v58,s[4:7],s44 offen offset:2048 lds
 s_add_u32 s92,s88,5701632
 s_addc_u32 s93,s89,0
 s_mov_b32 s94,16384
 s_mov_b32 s95,0x20000
 s_movk_i32 s41,8192
 buffer_load_dword v63,off,s[92:95],s41 sc1
 s_mov_b32 s28,s88
 s_mov_b32 s29,s89
 s_mov_b32 s30,60932096
 s_mov_b32 s31,0x20000
 s_lshl_b32 s90,s34,5
 s_add_u32 s90,s90,s33
 s_lshl_b32 s90,s90,2
 s_lshl_b32 s62,s52,4
 s_add_u32 s62,s62,s39
 s_lshl_b32 s62,s62,2
 v_and_b32 v14,15,v0
 v_and_b32 v16,6,v14
 v_lshrrev_b32 v17,4,v0
 v_xor_b32 v15,v16,v17
 v_lshlrev_b32 v15,4,v15
 v_lshlrev_b32 v18,7,v14
 v_lshlrev_b32 v13,3,v14
 v_add_u32 v14,v18,v15
 v_add_u32 v1,s46,v14
 v_xor_b32 v2,64,v1
 v_lshlrev_b32 v9,4,v0
 v_mov_b32 v14,0x3f803f80
 v_accvgpr_write_b32 a240,v14
 v_accvgpr_write_b32 a241,v14
 v_accvgpr_write_b32 a242,v14
 v_accvgpr_write_b32 a243,v14
 s_and_b32 s42,s74,1
 s_mul_i32 s41,s74,160
 s_lshl_b32 s40,s40,8
 s_sub_u32 s41,s41,s40
 v_lshl_add_u32 v17,v17,3,s41
 v_lshlrev_b32 v16,4,v16
 v_add_u32 v18,s46,v18
 s_lshl_b32 s44,s42,5
 s_lshl_b32 s45,s42,7
 s_sub_u32 s45,128,s45
 v_add_u32 v14,s44,v17
 v_bfe_u32 v15,v14,7,1
 v_lshl_add_u32 v15,v15,12,v18
 v_lshrrev_b32 v19,8,v14
 v_lshl_add_u32 v15,v19,15,v15
 v_and_b32 v14,127,v14
 v_xor_b32 v14,v14,v16
 v_add_u32 v126,v14,v15
 s_add_u32 s44,s44,32
 v_add_u32 v14,s44,v17
 v_bfe_u32 v15,v14,7,1
 v_lshl_add_u32 v15,v15,12,v18
 v_lshrrev_b32 v19,8,v14
 v_lshl_add_u32 v15,v19,15,v15
 v_and_b32 v14,127,v14
 v_xor_b32 v14,v14,v16
 v_add_u32 v127,v14,v15
 s_add_u32 s44,s44,32
 v_add_u32 v14,s44,v17
 v_bfe_u32 v15,v14,7,1
 v_lshl_add_u32 v15,v15,12,v18
 v_lshrrev_b32 v19,8,v14
 v_lshl_add_u32 v15,v19,15,v15
 v_and_b32 v14,127,v14
 v_xor_b32 v14,v14,v16
 v_add_u32 v128,v14,v15
 s_add_u32 s44,s44,32
 v_add_u32 v14,s44,v17
 v_bfe_u32 v15,v14,7,1
 v_lshl_add_u32 v15,v15,12,v18
 v_lshrrev_b32 v19,8,v14
 v_lshl_add_u32 v15,v19,15,v15
 v_and_b32 v14,127,v14
 v_xor_b32 v14,v14,v16
 v_add_u32 v129,v14,v15
 v_add_u32 v14,s45,v17
 v_bfe_u32 v15,v14,7,1
 v_lshl_add_u32 v15,v15,12,v18
 v_lshrrev_b32 v19,8,v14
 v_lshl_add_u32 v15,v19,15,v15
 v_and_b32 v14,127,v14
 v_xor_b32 v14,v14,v16
 v_add_u32 v130,v14,v15
 v_lshrrev_b32 v14,2,v0
 v_mul_u32_u24 v118,192,v14
 v_and_b32 v15,3,v0
 v_lshl_add_u32 v118,v15,3,v118
 v_and_b32 v14,4,v14
 v_lshl_add_u32 v118,v14,3,v118
 s_and_b32 s41,s74,1
 s_lshl_b32 s41,s41,6
 s_add_u32 s42,s41,0
 v_add_u32 v116,s42,v118
 v_xor_b32 v117,32,v116
 s_lshr_b32 s42,s41,1
 v_xor_b32 v118,s42,v118
 s_lshl_b32 s41,s41,1
 s_sub_u32 s41,128,s41
 v_add_u32 v118,s41,v118
 v_add_u32 v119,49152,v116
 v_add_u32 v120,49152,v117
 v_add_u32 v121,49152,v118
 s_lshr_b32 s41,s32,1
 s_lshl_b32 s41,s41,3
 s_and_b32 s42,s32,1
 s_add_u32 s41,s41,s42
 s_mul_i32 s41,s41,49152
 s_mul_i32 s42,s33,384
 s_add_u32 s41,s41,s42
 s_add_u32 s20,s70,s41
 s_addc_u32 s21,s71,0
 s_sub_u32 s22,7864320,s41
 s_mov_b32 s23,0x20000
 s_lshl_b32 s41,s34,2
 s_add_u32 s41,s41,s32
 s_mul_i32 s41,s41,81920
 s_add_u32 s24,s64,s41
 s_addc_u32 s25,s65,0
 s_mov_b32 s26,81920
 s_mov_b32 s27,0x20000
 s_add_u32 m0,s35,24576
 s_mov_b32 s44,s49
 buffer_load_dwordx4 v56,s[4:7],s44 offen lds
 s_add_u32 s49,s49,163840
 buffer_load_dwordx4 v57,s[4:7],s44 offen offset:1024 lds
 s_waitcnt vmcnt(9)
 ds_read_b128 a[32:35],v1
 ds_read_b128 a[36:39],v1 offset:2048
 ds_read_b128 a[40:43],v2
 s_add_u32 m0,s46,32768
 s_add_u32 s45,s47,0
 buffer_load_dwordx4 v8,s[8:11],s45 offen lds
 ds_read_b128 a[44:47],v2 offset:2048
 ds_read_b128 a[48:51],v1 offset:4096
 ds_read_b128 a[52:55],v1 offset:6144
 ds_read_b128 a[56:59],v2 offset:4096
 s_add_u32 m0,s46,33792
 s_add_u32 s45,s47,10240
 buffer_load_dwordx4 v8,s[8:11],s45 offen lds
 ds_read_b128 a[60:63],v2 offset:6144
 s_waitcnt vmcnt(5)
 s_barrier
 s_add_u32 m0,s46,34816
 s_add_u32 s45,s47,20480
 buffer_load_dwordx4 v8,s[8:11],s45 offen lds
 ds_read_b64_tr_b16 v[16:17],v116
 ds_read_b64_tr_b16 v[18:19],v116 offset:3072
 ds_read_b64_tr_b16 v[20:21],v116 offset:6144
 ds_read_b64_tr_b16 v[22:23],v116 offset:9216
 s_add_u32 m0,s46,35840
 s_add_u32 s45,s47,30720
 buffer_load_dwordx4 v8,s[8:11],s45 offen lds
 ds_read_b64_tr_b16 v[24:25],v117
 ds_read_b64_tr_b16 v[26:27],v117 offset:3072
 ds_read_b64_tr_b16 v[28:29],v117 offset:6144
 ds_read_b64_tr_b16 v[30:31],v117 offset:9216
 s_add_u32 m0,s46,36864
 s_add_u32 s45,s47,128
 buffer_load_dwordx4 v8,s[8:11],s45 offen lds
 ds_read_b64_tr_b16 v[32:33],v116 offset:64
 ds_read_b64_tr_b16 v[34:35],v116 offset:3136
 ds_read_b64_tr_b16 v[36:37],v116 offset:6208
 ds_read_b64_tr_b16 v[38:39],v116 offset:9280
 s_add_u32 m0,s46,37888
 s_add_u32 s45,s47,10368
 buffer_load_dwordx4 v8,s[8:11],s45 offen lds
 s_waitcnt lgkmcnt(12)
 v_mfma_f32_16x16x32_bf16 v[64:67],a[240:243],a[32:35],0
 v_add_u32 v14,0,v0
 v_mul_u32_u24 v14,2731,v14
 v_mfma_f32_16x16x32_bf16 v[64:67],a[240:243],a[40:43],v[64:67]
 s_add_u32 m0,s46,38912
 s_add_u32 s45,s47,20608
 buffer_load_dwordx4 v8,s[8:11],s45 offen lds
 v_lshrrev_b32 v14,16,v14
 v_and_b32 v15,6,v14
 v_mfma_f32_16x16x32_bf16 v[64:67],a[240:243],a[48:51],v[64:67]
 s_cmp_eq_u32 s49,819200
 s_cselect_b32 s49,0,s49
 s_add_u32 m0,s35,24576
 s_nop 0
 buffer_load_dwordx4 v58,s[4:7],s44 offen offset:2048 lds
 v_xor_b32 v15,v15,v0
 v_lshlrev_b32 v132,4,v15
 v_mfma_f32_16x16x32_bf16 v[64:67],a[240:243],a[56:59],v[64:67]
 s_add_u32 s45,s47,30848
 s_add_u32 s47,s47,256
 s_cmp_eq_u32 s47,1280
 s_cselect_b32 s47,0,s47
 s_add_u32 m0,s46,39936
 s_nop 0
 buffer_load_dwordx4 v8,s[8:11],s45 offen lds
 v_and_b32 v15,4,v14
 v_mul_u32_u24 v15,12288,v15
 v_mfma_f32_16x16x32_bf16 v[68:71],a[32:35],a[32:35],0
 s_add_u32 m0,s35,27648
 s_add_u32 s44,s44,5120
 buffer_load_dwordx4 v56,s[4:7],s44 offen lds
 v_mul_u32_u24 v14,11904,v14
 v_add3_u32 v10,v14,v15,v132
 v_mfma_f32_16x16x32_bf16 v[68:71],a[40:43],a[40:43],v[68:71]
 buffer_load_dwordx4 v57,s[4:7],s44 offen offset:1024 lds
 v_add_u32 v14,64,v0
 v_mul_u32_u24 v14,2731,v14
 v_mfma_f32_16x16x32_bf16 v[68:71],a[48:51],a[48:51],v[68:71]
 buffer_load_dwordx4 v58,s[4:7],s44 offen offset:2048 lds
 v_lshrrev_b32 v14,16,v14
 v_and_b32 v15,6,v14
 v_mfma_f32_16x16x32_bf16 v[68:71],a[56:59],a[56:59],v[68:71]
 v_xor_b32 v15,v15,v0
 v_lshlrev_b32 v133,4,v15
 v_mfma_f32_16x16x32_bf16 v[80:83],a[240:243],a[36:39],0
 v_and_b32 v15,4,v14
 v_mul_u32_u24 v15,12288,v15
 v_mfma_f32_16x16x32_bf16 v[80:83],a[240:243],a[44:47],v[80:83]
 v_mul_u32_u24 v14,11904,v14
 v_add3_u32 v11,v14,v15,v133
 v_mfma_f32_16x16x32_bf16 v[80:83],a[240:243],a[52:55],v[80:83]
 v_add_u32 v14,128,v0
 v_mul_u32_u24 v14,2731,v14
 v_mfma_f32_16x16x32_bf16 v[80:83],a[240:243],a[60:63],v[80:83]
 v_lshrrev_b32 v14,16,v14
 v_and_b32 v15,6,v14
 v_mfma_f32_16x16x32_bf16 v[84:87],a[36:39],a[36:39],0
 s_add_u32 m0,s35,49152
 s_mov_b32 s44,s49
 buffer_load_dwordx4 v56,s[4:7],s44 offen lds
 v_xor_b32 v15,v15,v0
 v_lshlrev_b32 v134,4,v15
 v_mfma_f32_16x16x32_bf16 v[84:87],a[44:47],a[44:47],v[84:87]
 v_and_b32 v15,4,v14
 v_mul_u32_u24 v15,12288,v15
 v_mfma_f32_16x16x32_bf16 v[84:87],a[52:55],a[52:55],v[84:87]
 v_mul_u32_u24 v14,11904,v14
 v_add3_u32 v12,v14,v15,v134
 v_mfma_f32_16x16x32_bf16 v[84:87],a[60:63],a[60:63],v[84:87]
 s_waitcnt lgkmcnt(8)
 v_lshrrev_b32 v14,2,v0
 v_mul_u32_u24 v6,384,v14
 v_mfma_f32_16x16x32_bf16 v[212:215],v[16:19],a[32:35],0
 v_and_b32 v14,6,v14
 v_and_b32 v15,3,v0
 v_mfma_f32_16x16x32_bf16 v[212:215],v[20:23],a[40:43],v[212:215]
 s_add_u32 s49,s49,163840
 ds_read_b64_tr_b16 v[40:41],v117 offset:64
 ds_read_b64_tr_b16 v[42:43],v117 offset:3136
 v_mfma_f32_16x16x32_bf16 v[232:235],v[20:23],a[44:47],0
 buffer_load_dwordx4 v57,s[4:7],s44 offen offset:1024 lds
 v_xor_b32 v14,v14,v15
 v_lshl_add_u32 v6,v14,4,v6
 v_mfma_f32_16x16x32_bf16 v[232:235],v[16:19],a[36:39],v[232:235]
 ds_read_b64_tr_b16 v[44:45],v117 offset:6208
 ds_read_b64_tr_b16 v[46:47],v117 offset:9280
 v_mfma_f32_16x16x32_bf16 v[192:195],v[16:19],a[240:243],0
 v_add_u32 v6,24576,v6
 v_xor_b32 v7,64,v6
 v_mfma_f32_16x16x32_bf16 v[192:195],v[20:23],a[240:243],v[192:195]
 s_waitcnt lgkmcnt(8)
 v_and_b32 v14,3,v0
 v_cmp_eq_u32 s[36:37],1,v14
 v_mfma_f32_16x16x32_bf16 v[216:219],v[24:27],a[32:35],0
 v_cmp_eq_u32 s[38:39],2,v14
 v_cmp_eq_u32 s[0:1],3,v14
 v_mfma_f32_16x16x32_bf16 v[216:219],v[28:31],a[40:43],v[216:219]
 ds_read_b64_tr_b16 v[48:49],v118
 ds_read_b64_tr_b16 v[50:51],v118 offset:3072
 v_mfma_f32_16x16x32_bf16 v[236:239],v[28:31],a[44:47],0
 v_bfe_u32 v14,v0,2,2
 v_lshrrev_b32 v15,4,v0
 v_mfma_f32_16x16x32_bf16 v[236:239],v[24:27],a[36:39],v[236:239]
 ds_read_b64_tr_b16 v[52:53],v118 offset:6144
 ds_read_b64_tr_b16 v[54:55],v118 offset:9216
 v_mfma_f32_16x16x32_bf16 v[196:199],v[24:27],a[240:243],0
 s_cmp_eq_u32 s49,819200
 s_cselect_b32 s49,0,s49
 buffer_load_dwordx4 v58,s[4:7],s44 offen offset:2048 lds
 v_cmp_eq_u32 s[70:71],v14,v15
 v_mfma_f32_16x16x32_bf16 v[196:199],v[28:31],a[240:243],v[196:199]
 s_waitcnt lgkmcnt(8)
 v_mfma_f32_16x16x32_bf16 v[220:223],v[32:35],a[32:35],0
 s_lshr_b32 s41,s74,2
 s_add_u32 s41,s41,1
 s_sub_u32 s42,0,s41
 v_mfma_f32_16x16x32_bf16 v[220:223],v[36:39],a[40:43],v[220:223]
 ds_read_b64_tr_b16 v[16:17],v116 offset:12288
 ds_read_b64_tr_b16 v[18:19],v116 offset:15360
 v_mfma_f32_16x16x32_bf16 v[240:243],v[36:39],a[44:47],0
 s_bitcmp1_b32 s74,1
 s_cselect_b32 s41,s42,s41
 s_lshl_b32 s42,s54,4
 v_mfma_f32_16x16x32_bf16 v[240:243],v[32:35],a[36:39],v[240:243]
 s_add_u32 m0,s35,52224
 s_add_u32 s44,s44,5120
 buffer_load_dwordx4 v56,s[4:7],s44 offen lds
 ds_read_b64_tr_b16 v[20:21],v116 offset:18432
 ds_read_b64_tr_b16 v[22:23],v116 offset:21504
 v_mfma_f32_16x16x32_bf16 v[200:203],v[32:35],a[240:243],0
 s_add_u32 s41,s41,s42
 s_movk_i32 s42,0x800
 v_and_b32 v14,15,v0
 v_mfma_f32_16x16x32_bf16 v[200:203],v[36:39],a[240:243],v[200:203]
 s_waitcnt lgkmcnt(8)
 v_add3_u32 v14,v14,s41,0
 v_cmp_gt_u32 vcc,s42,v14
 v_mfma_f32_16x16x32_bf16 v[224:227],v[40:43],a[32:35],0
 v_and_b32 v14,2047,v14
 v_lshrrev_b32 v15,4,v14
 v_mfma_f32_16x16x32_bf16 v[224:227],v[44:47],a[40:43],v[224:227]
 ds_read_b64_tr_b16 v[24:25],v117 offset:12288
 ds_read_b64_tr_b16 v[26:27],v117 offset:15360
 v_mfma_f32_16x16x32_bf16 v[244:247],v[44:47],a[44:47],0
 buffer_load_dwordx4 v57,s[4:7],s44 offen offset:1024 lds
 v_mul_u32_u24 v253,20480,v15
 v_and_b32 v14,15,v14
 v_mfma_f32_16x16x32_bf16 v[244:247],v[40:43],a[36:39],v[244:247]
 ds_read_b64_tr_b16 v[28:29],v117 offset:18432
 ds_read_b64_tr_b16 v[30:31],v117 offset:21504
 v_mfma_f32_16x16x32_bf16 v[204:207],v[40:43],a[240:243],0
 v_and_b32 v15,48,v0
 v_add_u32 v14,v14,v15
 v_mfma_f32_16x16x32_bf16 v[204:207],v[44:47],a[240:243],v[204:207]
 s_waitcnt lgkmcnt(8)
 v_lshl_add_u32 v252,v14,4,v253
 v_lshl_add_u32 v253,v14,3,v253
 v_mfma_f32_16x16x32_bf16 v[228:231],v[48:51],a[32:35],0
 s_waitcnt vmcnt(8)
 ds_read_b128 a[64:67],v1 offset:32768
 ds_read_b128 a[68:71],v1 offset:34816
 v_mfma_f32_16x16x32_bf16 v[228:231],v[52:55],a[40:43],v[228:231]
 ds_read_b64_tr_b16 v[32:33],v116 offset:12352
 ds_read_b64_tr_b16 v[34:35],v116 offset:15424
 v_mfma_f32_16x16x32_bf16 v[248:251],v[52:55],a[44:47],0
 buffer_load_dwordx4 v58,s[4:7],s44 offen offset:2048 lds
 ds_read_b128 a[72:75],v2 offset:32768
 ds_read_b128 a[76:79],v2 offset:34816
 v_mfma_f32_16x16x32_bf16 v[248:251],v[48:51],a[36:39],v[248:251]
 ds_read_b64_tr_b16 v[36:37],v116 offset:18496
 ds_read_b64_tr_b16 v[38:39],v116 offset:21568
 v_mfma_f32_16x16x32_bf16 v[208:211],v[48:51],a[240:243],0
 ds_read_b128 a[80:83],v1 offset:36864
 ds_read_b128 a[84:87],v1 offset:38912
 v_mfma_f32_16x16x32_bf16 v[208:211],v[52:55],a[240:243],v[208:211]
 s_waitcnt lgkmcnt(14)
 v_and_b32 v14,15,v0
 v_add3_u32 v14,v14,s41,16
 v_mfma_f32_16x16x32_bf16 v[212:215],v[16:19],a[48:51],v[212:215]
 ds_read_b128 a[88:91],v2 offset:36864
 ds_read_b128 a[92:95],v2 offset:38912
 v_mfma_f32_16x16x32_bf16 v[212:215],v[20:23],a[56:59],v[212:215]
 ds_read_b64_tr_b16 v[40:41],v117 offset:12352
 ds_read_b64_tr_b16 v[42:43],v117 offset:15424
 v_mfma_f32_16x16x32_bf16 v[232:235],v[20:23],a[60:63],v[232:235]
 s_add_u32 m0,s35,73728
 s_mov_b32 s44,s49
 buffer_load_dwordx4 v56,s[4:7],s44 offen lds
 ds_read_b64 a[96:97],v126
 ds_read_b64 a[98:99],v127
 v_mfma_f32_16x16x32_bf16 v[232:235],v[16:19],a[52:55],v[232:235]
 ds_read_b64_tr_b16 v[44:45],v117 offset:18496
 ds_read_b64_tr_b16 v[46:47],v117 offset:21568
 v_mfma_f32_16x16x32_bf16 v[192:195],v[16:19],a[240:243],v[192:195]
 ds_read_b64 a[100:101],v128
 ds_read_b64 a[102:103],v129
 v_mfma_f32_16x16x32_bf16 v[192:195],v[20:23],a[240:243],v[192:195]
 s_waitcnt lgkmcnt(15)
 v_cmp_gt_u32 s[58:59],s42,v14
 v_and_b32 v14,2047,v14
 v_mfma_f32_16x16x32_bf16 v[216:219],v[24:27],a[48:51],v[216:219]
 ds_read_b64 a[104:105],v130
 ds_read_b64 a[108:109],v126 offset:2048
 v_mfma_f32_16x16x32_bf16 v[216:219],v[28:31],a[56:59],v[216:219]
 s_add_u32 s49,s49,163840
 ds_read_b64_tr_b16 v[48:49],v118 offset:12288
 ds_read_b64_tr_b16 v[50:51],v118 offset:15360
 v_mfma_f32_16x16x32_bf16 v[236:239],v[28:31],a[60:63],v[236:239]
 buffer_load_dwordx4 v57,s[4:7],s44 offen offset:1024 lds
 ds_read_b64 a[110:111],v127 offset:2048
 ds_read_b64 a[112:113],v128 offset:2048
 v_mfma_f32_16x16x32_bf16 v[236:239],v[24:27],a[52:55],v[236:239]
 ds_read_b64_tr_b16 v[52:53],v118 offset:18432
 ds_read_b64_tr_b16 v[54:55],v118 offset:21504
 v_mfma_f32_16x16x32_bf16 v[196:199],v[24:27],a[240:243],v[196:199]
 ds_read_b64 a[114:115],v129 offset:2048
 ds_read_b64 a[116:117],v130 offset:2048
 v_mfma_f32_16x16x32_bf16 v[196:199],v[28:31],a[240:243],v[196:199]
 s_waitcnt lgkmcnt(15)
 v_lshrrev_b32 v15,4,v14
 v_mul_u32_u24 v255,20480,v15
 v_mfma_f32_16x16x32_bf16 v[220:223],v[32:35],a[48:51],v[220:223]
 s_waitcnt vmcnt(8)
 s_barrier
 v_and_b32 v14,15,v14
 v_mfma_f32_16x16x32_bf16 v[220:223],v[36:39],a[56:59],v[220:223]
 s_cmp_eq_u32 s49,819200
 s_cselect_b32 s49,0,s49
 buffer_load_dwordx4 v58,s[4:7],s44 offen offset:2048 lds
 ds_read_b64_tr_b16 v[16:17],v116 offset:24576
 ds_read_b64_tr_b16 v[18:19],v116 offset:27648
 v_mfma_f32_16x16x32_bf16 v[240:243],v[36:39],a[60:63],v[240:243]
 v_and_b32 v15,48,v0
 v_add_u32 v14,v14,v15
 v_mfma_f32_16x16x32_bf16 v[240:243],v[32:35],a[52:55],v[240:243]
 ds_read_b64_tr_b16 v[20:21],v116 offset:30720
 ds_read_b64_tr_b16 v[22:23],v116 offset:33792
 v_mfma_f32_16x16x32_bf16 v[200:203],v[32:35],a[240:243],v[200:203]
 v_lshl_add_u32 v254,v14,4,v255
 v_lshl_add_u32 v255,v14,3,v255
 v_mfma_f32_16x16x32_bf16 v[200:203],v[36:39],a[240:243],v[200:203]
 s_waitcnt lgkmcnt(15)
 s_and_b32 s57,s74,1
 s_mul_i32 s56,s74,5
 v_mfma_f32_16x16x32_bf16 v[224:227],v[40:43],a[48:51],v[224:227]
 s_add_u32 s56,s56,s57
 s_lshl_b32 s56,s56,9
 s_add_u32 s56,s56,0
 v_mfma_f32_16x16x32_bf16 v[224:227],v[44:47],a[56:59],v[224:227]
 s_add_u32 m0,s35,76800
 s_add_u32 s44,s44,5120
 buffer_load_dwordx4 v56,s[4:7],s44 offen lds
 ds_read_b64_tr_b16 v[24:25],v117 offset:24576
 ds_read_b64_tr_b16 v[26:27],v117 offset:27648
 v_mfma_f32_16x16x32_bf16 v[244:247],v[44:47],a[60:63],v[244:247]
 s_mul_i32 s57,s57,2560
 s_sub_u32 s57,s56,s57
 s_add_u32 s57,s57,2048
 v_mfma_f32_16x16x32_bf16 v[244:247],v[40:43],a[52:55],v[244:247]
 ds_read_b64_tr_b16 v[28:29],v117 offset:30720
 ds_read_b64_tr_b16 v[30:31],v117 offset:33792
 v_mfma_f32_16x16x32_bf16 v[204:207],v[40:43],a[240:243],v[204:207]
 s_waitcnt vmcnt(24)
 v_readfirstlane_b32 s51,v63
 v_mfma_f32_16x16x32_bf16 v[204:207],v[44:47],a[240:243],v[204:207]
 s_waitcnt lgkmcnt(8)
 v_mfma_f32_16x16x32_bf16 v[228:231],v[48:51],a[48:51],v[228:231]
 s_add_u32 m0,s46,0
 s_add_u32 s45,s47,0
 buffer_load_dwordx4 v8,s[8:11],s45 offen lds
 s_nop 0
 s_mul_i32 s51,s51,1664525
 s_add_u32 s51,s51,1013904223
 v_mfma_f32_16x16x32_bf16 v[228:231],v[52:55],a[56:59],v[228:231]
 s_add_u32 m0,s46,1024
 s_add_u32 s45,s47,10240
 buffer_load_dwordx4 v8,s[8:11],s45 offen lds
 ds_read_b64_tr_b16 v[32:33],v116 offset:24640
 ds_read_b64_tr_b16 v[34:35],v116 offset:27712
 v_mfma_f32_16x16x32_bf16 v[248:251],v[52:55],a[60:63],v[248:251]
 s_lshl_b32 s41,s74,14
 s_lshl_b32 s42,s54,7
 v_mfma_f32_16x16x32_bf16 v[248:251],v[48:51],a[52:55],v[248:251]
 s_add_u32 m0,s46,2048
 s_add_u32 s45,s47,20480
 buffer_load_dwordx4 v8,s[8:11],s45 offen lds
 ds_read_b64_tr_b16 v[36:37],v116 offset:30784
 ds_read_b64_tr_b16 v[38:39],v116 offset:33856
 v_mfma_f32_16x16x32_bf16 v[208:211],v[48:51],a[240:243],v[208:211]
 s_add_u32 s41,s41,s42
 s_add_u32 s40,s41,5373952
 v_mfma_f32_16x16x32_bf16 v[208:211],v[52:55],a[240:243],v[208:211]
 s_waitcnt lgkmcnt(8)
 v_mfma_f32_16x16x32_bf16 v[64:67],a[240:243],a[64:67],v[64:67]
 s_add_u32 m0,s46,3072
 s_add_u32 s45,s47,30720
 buffer_load_dwordx4 v8,s[8:11],s45 offen lds
 v_mfma_f32_16x16x32_bf16 v[64:67],a[240:243],a[72:75],v[64:67]
 s_add_u32 m0,s46,4096
 s_add_u32 s45,s47,128
 buffer_load_dwordx4 v8,s[8:11],s45 offen lds
 v_mfma_f32_16x16x32_bf16 v[64:67],a[240:243],a[80:83],v[64:67]
 s_add_u32 m0,s46,5120
 s_add_u32 s45,s47,10368
 buffer_load_dwordx4 v8,s[8:11],s45 offen lds
 v_mfma_f32_16x16x32_bf16 v[64:67],a[240:243],a[88:91],v[64:67]
 s_add_u32 m0,s46,6144
 s_add_u32 s45,s47,20608
 buffer_load_dwordx4 v8,s[8:11],s45 offen lds
 v_mfma_f32_16x16x32_bf16 v[68:71],a[64:67],a[64:67],v[68:71]
 s_add_u32 s45,s47,30848
 s_add_u32 s47,s47,256
 s_cmp_eq_u32 s47,1280
 s_cselect_b32 s47,0,s47
 s_add_u32 m0,s46,7168
 s_nop 0
 buffer_load_dwordx4 v8,s[8:11],s45 offen lds
 v_mfma_f32_16x16x32_bf16 v[68:71],a[72:75],a[72:75],v[68:71]
 s_add_u32 m0,s46,32768
 s_add_u32 s45,s47,0
 buffer_load_dwordx4 v8,s[8:11],s45 offen lds
 v_mfma_f32_16x16x32_bf16 v[68:71],a[80:83],a[80:83],v[68:71]
 v_mfma_f32_16x16x32_bf16 v[68:71],a[88:91],a[88:91],v[68:71]
 v_mfma_f32_16x16x32_bf16 v[80:83],a[240:243],a[68:71],v[80:83]
 s_add_u32 m0,s46,33792
 s_add_u32 s45,s47,10240
 buffer_load_dwordx4 v8,s[8:11],s45 offen lds
 v_mfma_f32_16x16x32_bf16 v[80:83],a[240:243],a[76:79],v[80:83]
 v_mfma_f32_16x16x32_bf16 v[80:83],a[240:243],a[84:87],v[80:83]
 v_mfma_f32_16x16x32_bf16 v[80:83],a[240:243],a[92:95],v[80:83]
 v_mfma_f32_16x16x32_bf16 v[84:87],a[68:71],a[68:71],v[84:87]
 s_add_u32 m0,s46,34816
 s_add_u32 s45,s47,20480
 buffer_load_dwordx4 v8,s[8:11],s45 offen lds
 v_mfma_f32_16x16x32_bf16 v[84:87],a[76:79],a[76:79],v[84:87]
 v_mfma_f32_16x16x32_bf16 v[84:87],a[84:87],a[84:87],v[84:87]
 v_mfma_f32_16x16x32_bf16 v[84:87],a[92:95],a[92:95],v[84:87]
 v_mfma_f32_16x16x32_bf16 v[212:215],v[16:19],a[64:67],v[212:215]
 v_mfma_f32_16x16x32_bf16 v[212:215],v[20:23],a[72:75],v[212:215]
 ds_read_b64_tr_b16 v[40:41],v117 offset:24640
 ds_read_b64_tr_b16 v[42:43],v117 offset:27712
 v_mfma_f32_16x16x32_bf16 v[232:235],v[20:23],a[76:79],v[232:235]
 s_add_u32 m0,s46,35840
 s_add_u32 s45,s47,30720
 buffer_load_dwordx4 v8,s[8:11],s45 offen lds
 v_mfma_f32_16x16x32_bf16 v[232:235],v[16:19],a[68:71],v[232:235]
 ds_read_b64_tr_b16 v[44:45],v117 offset:30784
 ds_read_b64_tr_b16 v[46:47],v117 offset:33856
 v_mfma_f32_16x16x32_bf16 v[192:195],v[16:19],a[240:243],v[192:195]
 v_mfma_f32_16x16x32_bf16 v[192:195],v[20:23],a[240:243],v[192:195]
 s_waitcnt lgkmcnt(8)
 v_mfma_f32_16x16x32_bf16 v[216:219],v[24:27],a[64:67],v[216:219]
 s_add_u32 m0,s46,36864
 s_add_u32 s45,s47,128
 buffer_load_dwordx4 v8,s[8:11],s45 offen lds
 v_mfma_f32_16x16x32_bf16 v[216:219],v[28:31],a[72:75],v[216:219]
 ds_read_b64_tr_b16 v[48:49],v118 offset:24576
 ds_read_b64_tr_b16 v[50:51],v118 offset:27648
 v_mfma_f32_16x16x32_bf16 v[236:239],v[28:31],a[76:79],v[236:239]
 v_mfma_f32_16x16x32_bf16 v[236:239],v[24:27],a[68:71],v[236:239]
 ds_read_b64_tr_b16 v[52:53],v118 offset:30720
 ds_read_b64_tr_b16 v[54:55],v118 offset:33792
 v_mfma_f32_16x16x32_bf16 v[196:199],v[24:27],a[240:243],v[196:199]
 v_mfma_f32_16x16x32_bf16 v[196:199],v[28:31],a[240:243],v[196:199]
 s_waitcnt lgkmcnt(8)
 v_mfma_f32_16x16x32_bf16 v[220:223],v[32:35],a[64:67],v[220:223]
 s_add_u32 m0,s46,37888
 s_add_u32 s45,s47,10368
 buffer_load_dwordx4 v8,s[8:11],s45 offen lds
 v_mfma_f32_16x16x32_bf16 v[220:223],v[36:39],a[72:75],v[220:223]
 ds_read_b64_tr_b16 v[16:17],v116 offset:36864
 ds_read_b64_tr_b16 v[18:19],v116 offset:39936
 v_mfma_f32_16x16x32_bf16 v[240:243],v[36:39],a[76:79],v[240:243]
 v_mfma_f32_16x16x32_bf16 v[240:243],v[32:35],a[68:71],v[240:243]
 ds_read_b64_tr_b16 v[20:21],v116 offset:43008
 ds_read_b64_tr_b16 v[22:23],v116 offset:46080
 v_mfma_f32_16x16x32_bf16 v[200:203],v[32:35],a[240:243],v[200:203]
 s_add_u32 m0,s46,38912
 s_add_u32 s45,s47,20608
 buffer_load_dwordx4 v8,s[8:11],s45 offen lds
 v_mfma_f32_16x16x32_bf16 v[200:203],v[36:39],a[240:243],v[200:203]
 s_add_u32 s45,s47,30848
 s_add_u32 s47,s47,256
 s_waitcnt lgkmcnt(8)
 v_mfma_f32_16x16x32_bf16 v[224:227],v[40:43],a[64:67],v[224:227]
 s_cmp_eq_u32 s47,1280
 s_cselect_b32 s47,0,s47
 v_mfma_f32_16x16x32_bf16 v[224:227],v[44:47],a[72:75],v[224:227]
 ds_read_b64_tr_b16 v[24:25],v117 offset:36864
 ds_read_b64_tr_b16 v[26:27],v117 offset:39936
 v_mfma_f32_16x16x32_bf16 v[244:247],v[44:47],a[76:79],v[244:247]
 s_add_u32 m0,s46,39936
 s_nop 0
 buffer_load_dwordx4 v8,s[8:11],s45 offen lds
 v_mfma_f32_16x16x32_bf16 v[244:247],v[40:43],a[68:71],v[244:247]
 ds_read_b64_tr_b16 v[28:29],v117 offset:43008
 ds_read_b64_tr_b16 v[30:31],v117 offset:46080
 v_mfma_f32_16x16x32_bf16 v[204:207],v[40:43],a[240:243],v[204:207]
 v_mfma_f32_16x16x32_bf16 v[204:207],v[44:47],a[240:243],v[204:207]
 s_waitcnt lgkmcnt(8)
 v_mfma_f32_16x16x32_bf16 v[228:231],v[48:51],a[64:67],v[228:231]
 s_waitcnt vmcnt(8)
 ds_read_b128 a[0:3],v1
 ds_read_b128 a[4:7],v1 offset:2048
 v_mfma_f32_16x16x32_bf16 v[228:231],v[52:55],a[72:75],v[228:231]
 s_add_u32 m0,s35,76800
 s_nop 0
 buffer_load_dwordx4 v57,s[4:7],s44 offen offset:1024 lds
 ds_read_b64_tr_b16 v[32:33],v116 offset:36928
 ds_read_b64_tr_b16 v[34:35],v116 offset:40000
 v_mfma_f32_16x16x32_bf16 v[248:251],v[52:55],a[76:79],v[248:251]
 ds_read_b128 a[8:11],v2
 ds_read_b128 a[12:15],v2 offset:2048
 v_mfma_f32_16x16x32_bf16 v[248:251],v[48:51],a[68:71],v[248:251]
 ds_read_b64_tr_b16 v[36:37],v116 offset:43072
 ds_read_b64_tr_b16 v[38:39],v116 offset:46144
 v_mfma_f32_16x16x32_bf16 v[208:211],v[48:51],a[240:243],v[208:211]
 ds_read_b128 a[16:19],v1 offset:4096
 ds_read_b128 a[20:23],v1 offset:6144
 v_mfma_f32_16x16x32_bf16 v[208:211],v[52:55],a[240:243],v[208:211]
 s_waitcnt lgkmcnt(14)
 v_mfma_f32_16x16x32_bf16 v[212:215],v[16:19],a[80:83],v[212:215]
 ds_read_b128 a[24:27],v2 offset:4096
 ds_read_b128 a[28:31],v2 offset:6144
 v_mfma_f32_16x16x32_bf16 v[212:215],v[20:23],a[88:91],v[212:215]
 ds_read_b64_tr_b16 v[40:41],v117 offset:36928
 ds_read_b64_tr_b16 v[42:43],v117 offset:40000
 v_mfma_f32_16x16x32_bf16 v[232:235],v[20:23],a[92:95],v[232:235]
 buffer_load_dwordx4 v58,s[4:7],s44 offen offset:2048 lds
 v_mfma_f32_16x16x32_bf16 v[232:235],v[16:19],a[84:87],v[232:235]
 ds_read_b64_tr_b16 v[44:45],v117 offset:43072
 ds_read_b64_tr_b16 v[46:47],v117 offset:46144
 v_mfma_f32_16x16x32_bf16 v[192:195],v[16:19],a[240:243],v[192:195]
 v_mfma_f32_16x16x32_bf16 v[192:195],v[20:23],a[240:243],v[192:195]
 s_waitcnt lgkmcnt(15)
 v_mfma_f32_16x16x32_bf16 v[216:219],v[24:27],a[80:83],v[216:219]
 v_mfma_f32_16x16x32_bf16 v[216:219],v[28:31],a[88:91],v[216:219]
 ds_read_b64_tr_b16 v[48:49],v118 offset:36864
 ds_read_b64_tr_b16 v[50:51],v118 offset:39936
 v_mfma_f32_16x16x32_bf16 v[236:239],v[28:31],a[92:95],v[236:239]
 v_mfma_f32_16x16x32_bf16 v[236:239],v[24:27],a[84:87],v[236:239]
 ds_read_b64_tr_b16 v[52:53],v118 offset:43008
 ds_read_b64_tr_b16 v[54:55],v118 offset:46080
 v_mfma_f32_16x16x32_bf16 v[196:199],v[24:27],a[240:243],v[196:199]
 v_mfma_f32_16x16x32_bf16 v[196:199],v[28:31],a[240:243],v[196:199]
 s_waitcnt lgkmcnt(12)
 v_mfma_f32_16x16x32_bf16 v[220:223],v[32:35],a[80:83],v[220:223]
 s_waitcnt vmcnt(22)
 s_barrier
 v_mfma_f32_16x16x32_bf16 v[220:223],v[36:39],a[88:91],v[220:223]
 ds_read_b64_tr_b16 v[16:17],v119
 ds_read_b64_tr_b16 v[18:19],v119 offset:3072
 v_mfma_f32_16x16x32_bf16 v[240:243],v[36:39],a[92:95],v[240:243]
 s_add_u32 m0,s35,0
 s_mov_b32 s44,s49
 buffer_load_dwordx4 v56,s[4:7],s44 offen lds
 v_mfma_f32_16x16x32_bf16 v[240:243],v[32:35],a[84:87],v[240:243]
 s_add_u32 s49,s49,163840
 ds_read_b64_tr_b16 v[20:21],v119 offset:6144
 ds_read_b64_tr_b16 v[22:23],v119 offset:9216
 v_mfma_f32_16x16x32_bf16 v[200:203],v[32:35],a[240:243],v[200:203]
 buffer_load_dwordx4 v57,s[4:7],s44 offen offset:1024 lds
 v_mfma_f32_16x16x32_bf16 v[200:203],v[36:39],a[240:243],v[200:203]
 s_cmp_eq_u32 s49,819200
 s_cselect_b32 s49,0,s49
 s_waitcnt lgkmcnt(8)
 v_mfma_f32_16x16x32_bf16 v[224:227],v[40:43],a[80:83],v[224:227]
 buffer_load_dwordx4 v58,s[4:7],s44 offen offset:2048 lds
 v_mfma_f32_16x16x32_bf16 v[224:227],v[44:47],a[88:91],v[224:227]
 ds_read_b64_tr_b16 v[24:25],v120
 ds_read_b64_tr_b16 v[26:27],v120 offset:3072
 v_mfma_f32_16x16x32_bf16 v[244:247],v[44:47],a[92:95],v[244:247]
 v_mfma_f32_16x16x32_bf16 v[244:247],v[40:43],a[84:87],v[244:247]
 ds_read_b64_tr_b16 v[28:29],v120 offset:6144
 ds_read_b64_tr_b16 v[30:31],v120 offset:9216
 v_mfma_f32_16x16x32_bf16 v[204:207],v[40:43],a[240:243],v[204:207]
 v_mfma_f32_16x16x32_bf16 v[204:207],v[44:47],a[240:243],v[204:207]
 s_waitcnt lgkmcnt(8)
 v_mfma_f32_16x16x32_bf16 v[228:231],v[48:51],a[80:83],v[228:231]
 s_add_u32 m0,s35,3072
 s_add_u32 s44,s44,5120
 buffer_load_dwordx4 v56,s[4:7],s44 offen lds
 v_mfma_f32_16x16x32_bf16 v[228:231],v[52:55],a[88:91],v[228:231]
 ds_read_b64_tr_b16 v[32:33],v119 offset:64
 ds_read_b64_tr_b16 v[34:35],v119 offset:3136
 v_mfma_f32_16x16x32_bf16 v[248:251],v[52:55],a[92:95],v[248:251]
 v_mfma_f32_16x16x32_bf16 v[248:251],v[48:51],a[84:87],v[248:251]
 ds_read_b64_tr_b16 v[36:37],v119 offset:6208
 ds_read_b64_tr_b16 v[38:39],v119 offset:9280
 v_mfma_f32_16x16x32_bf16 v[208:211],v[48:51],a[240:243],v[208:211]
 v_mfma_f32_16x16x32_bf16 v[208:211],v[52:55],a[240:243],v[208:211]
 s_waitcnt lgkmcnt(8)
 v_mfma_f32_16x16x32_bf16 v[64:67],a[240:243],a[0:3],v[64:67]
 s_add_u32 m0,s46,0
 s_add_u32 s45,s47,0
 buffer_load_dwordx4 v8,s[8:11],s45 offen lds
 v_mfma_f32_16x16x32_bf16 v[64:67],a[240:243],a[8:11],v[64:67]
 v_mfma_f32_16x16x32_bf16 v[64:67],a[240:243],a[16:19],v[64:67]
 v_mfma_f32_16x16x32_bf16 v[64:67],a[240:243],a[24:27],v[64:67]
 v_mfma_f32_16x16x32_bf16 v[68:71],a[0:3],a[0:3],v[68:71]
 s_add_u32 m0,s46,1024
 s_add_u32 s45,s47,10240
 buffer_load_dwordx4 v8,s[8:11],s45 offen lds
 v_mfma_f32_16x16x32_bf16 v[68:71],a[8:11],a[8:11],v[68:71]
 v_mfma_f32_16x16x32_bf16 v[68:71],a[16:19],a[16:19],v[68:71]
 v_mfma_f32_16x16x32_bf16 v[68:71],a[24:27],a[24:27],v[68:71]
 v_mfma_f32_16x16x32_bf16 v[80:83],a[240:243],a[4:7],v[80:83]
 v_mfma_f32_16x16x32_bf16 v[80:83],a[240:243],a[12:15],v[80:83]
 s_add_u32 m0,s46,2048
 s_add_u32 s45,s47,20480
 buffer_load_dwordx4 v8,s[8:11],s45 offen lds
 v_mfma_f32_16x16x32_bf16 v[80:83],a[240:243],a[20:23],v[80:83]
 v_mfma_f32_16x16x32_bf16 v[80:83],a[240:243],a[28:31],v[80:83]
 v_mfma_f32_16x16x32_bf16 v[84:87],a[4:7],a[4:7],v[84:87]
 v_mfma_f32_16x16x32_bf16 v[84:87],a[12:15],a[12:15],v[84:87]
 s_add_u32 m0,s46,3072
 s_add_u32 s45,s47,30720
 buffer_load_dwordx4 v8,s[8:11],s45 offen lds
 v_mfma_f32_16x16x32_bf16 v[84:87],a[20:23],a[20:23],v[84:87]
 v_mfma_f32_16x16x32_bf16 v[84:87],a[28:31],a[28:31],v[84:87]
 v_mfma_f32_16x16x32_bf16 v[212:215],v[16:19],a[0:3],v[212:215]
 v_mfma_f32_16x16x32_bf16 v[212:215],v[20:23],a[8:11],v[212:215]
 ds_read_b64_tr_b16 v[40:41],v120 offset:64
 ds_read_b64_tr_b16 v[42:43],v120 offset:3136
 v_mfma_f32_16x16x32_bf16 v[232:235],v[20:23],a[12:15],v[232:235]
 s_add_u32 m0,s46,4096
 s_add_u32 s45,s47,128
 buffer_load_dwordx4 v8,s[8:11],s45 offen lds
 v_mfma_f32_16x16x32_bf16 v[232:235],v[16:19],a[4:7],v[232:235]
 ds_read_b64_tr_b16 v[44:45],v120 offset:6208
 ds_read_b64_tr_b16 v[46:47],v120 offset:9280
 v_mfma_f32_16x16x32_bf16 v[192:195],v[16:19],a[240:243],v[192:195]
 v_mfma_f32_16x16x32_bf16 v[192:195],v[20:23],a[240:243],v[192:195]
 s_waitcnt lgkmcnt(8)
 v_mfma_f32_16x16x32_bf16 v[216:219],v[24:27],a[0:3],v[216:219]
 v_mfma_f32_16x16x32_bf16 v[216:219],v[28:31],a[8:11],v[216:219]
 ds_read_b64_tr_b16 v[48:49],v121
 ds_read_b64_tr_b16 v[50:51],v121 offset:3072
 v_mfma_f32_16x16x32_bf16 v[236:239],v[28:31],a[12:15],v[236:239]
 s_add_u32 m0,s46,5120
 s_add_u32 s45,s47,10368
 buffer_load_dwordx4 v8,s[8:11],s45 offen lds
 v_mfma_f32_16x16x32_bf16 v[236:239],v[24:27],a[4:7],v[236:239]
 ds_read_b64_tr_b16 v[52:53],v121 offset:6144
 ds_read_b64_tr_b16 v[54:55],v121 offset:9216
 v_mfma_f32_16x16x32_bf16 v[196:199],v[24:27],a[240:243],v[196:199]
 v_mfma_f32_16x16x32_bf16 v[196:199],v[28:31],a[240:243],v[196:199]
 s_waitcnt lgkmcnt(8)
 v_mfma_f32_16x16x32_bf16 v[220:223],v[32:35],a[0:3],v[220:223]
 s_add_u32 m0,s46,6144
 s_add_u32 s45,s47,20608
 buffer_load_dwordx4 v8,s[8:11],s45 offen lds
 v_mfma_f32_16x16x32_bf16 v[220:223],v[36:39],a[8:11],v[220:223]
 s_add_u32 s45,s47,30848
 s_add_u32 s47,s47,256
 ds_read_b64_tr_b16 v[16:17],v119 offset:12288
 ds_read_b64_tr_b16 v[18:19],v119 offset:15360
 v_mfma_f32_16x16x32_bf16 v[240:243],v[36:39],a[12:15],v[240:243]
 s_cmp_eq_u32 s47,1280
 s_cselect_b32 s47,0,s47
 v_mfma_f32_16x16x32_bf16 v[240:243],v[32:35],a[4:7],v[240:243]
 ds_read_b64_tr_b16 v[20:21],v119 offset:18432
 ds_read_b64_tr_b16 v[22:23],v119 offset:21504
 v_mfma_f32_16x16x32_bf16 v[200:203],v[32:35],a[240:243],v[200:203]
 s_add_u32 m0,s46,7168
 s_nop 0
 buffer_load_dwordx4 v8,s[8:11],s45 offen lds
 v_mfma_f32_16x16x32_bf16 v[200:203],v[36:39],a[240:243],v[200:203]
 s_waitcnt lgkmcnt(8)
 v_mfma_f32_16x16x32_bf16 v[224:227],v[40:43],a[0:3],v[224:227]
 v_mfma_f32_16x16x32_bf16 v[224:227],v[44:47],a[8:11],v[224:227]
 ds_read_b64_tr_b16 v[24:25],v120 offset:12288
 ds_read_b64_tr_b16 v[26:27],v120 offset:15360
 v_mfma_f32_16x16x32_bf16 v[244:247],v[44:47],a[12:15],v[244:247]
 v_mfma_f32_16x16x32_bf16 v[244:247],v[40:43],a[4:7],v[244:247]
 ds_read_b64_tr_b16 v[28:29],v120 offset:18432
 ds_read_b64_tr_b16 v[30:31],v120 offset:21504
 v_mfma_f32_16x16x32_bf16 v[204:207],v[40:43],a[240:243],v[204:207]
 s_add_u32 m0,s35,3072
 s_nop 0
 buffer_load_dwordx4 v57,s[4:7],s44 offen offset:1024 lds
 v_mfma_f32_16x16x32_bf16 v[204:207],v[44:47],a[240:243],v[204:207]
 s_waitcnt lgkmcnt(8)
 v_mfma_f32_16x16x32_bf16 v[228:231],v[48:51],a[0:3],v[228:231]
 s_waitcnt vmcnt(15)
 ds_read_b128 a[32:35],v1 offset:32768
 ds_read_b128 a[36:39],v1 offset:34816
 v_mfma_f32_16x16x32_bf16 v[228:231],v[52:55],a[8:11],v[228:231]
 ds_read_b64_tr_b16 v[32:33],v119 offset:12352
 ds_read_b64_tr_b16 v[34:35],v119 offset:15424
 v_mfma_f32_16x16x32_bf16 v[248:251],v[52:55],a[12:15],v[248:251]
 ds_read_b128 a[40:43],v2 offset:32768
 ds_read_b128 a[44:47],v2 offset:34816
 v_mfma_f32_16x16x32_bf16 v[248:251],v[48:51],a[4:7],v[248:251]
 ds_read_b64_tr_b16 v[36:37],v119 offset:18496
 ds_read_b64_tr_b16 v[38:39],v119 offset:21568
 v_mfma_f32_16x16x32_bf16 v[208:211],v[48:51],a[240:243],v[208:211]
 ds_read_b128 a[48:51],v1 offset:36864
 ds_read_b128 a[52:55],v1 offset:38912
 v_mfma_f32_16x16x32_bf16 v[208:211],v[52:55],a[240:243],v[208:211]
 buffer_load_dwordx4 v58,s[4:7],s44 offen offset:2048 lds
 s_waitcnt lgkmcnt(14)
 v_mfma_f32_16x16x32_bf16 v[212:215],v[16:19],a[16:19],v[212:215]
 ds_read_b128 a[56:59],v2 offset:36864
 ds_read_b128 a[60:63],v2 offset:38912
 v_mfma_f32_16x16x32_bf16 v[212:215],v[20:23],a[24:27],v[212:215]
 ds_read_b64_tr_b16 v[40:41],v120 offset:12352
 ds_read_b64_tr_b16 v[42:43],v120 offset:15424
 v_mfma_f32_16x16x32_bf16 v[232:235],v[20:23],a[28:31],v[232:235]
 v_mfma_f32_16x16x32_bf16 v[232:235],v[16:19],a[20:23],v[232:235]
 ds_read_b64_tr_b16 v[44:45],v120 offset:18496
 ds_read_b64_tr_b16 v[46:47],v120 offset:21568
 v_mfma_f32_16x16x32_bf16 v[192:195],v[16:19],a[240:243],v[192:195]
 v_mfma_f32_16x16x32_bf16 v[192:195],v[20:23],a[240:243],v[192:195]
 s_waitcnt lgkmcnt(15)
 v_mfma_f32_16x16x32_bf16 v[216:219],v[24:27],a[16:19],v[216:219]
 v_mfma_f32_16x16x32_bf16 v[216:219],v[28:31],a[24:27],v[216:219]
 ds_read_b64_tr_b16 v[48:49],v121 offset:12288
 ds_read_b64_tr_b16 v[50:51],v121 offset:15360
 v_mfma_f32_16x16x32_bf16 v[236:239],v[28:31],a[28:31],v[236:239]
 v_mfma_f32_16x16x32_bf16 v[236:239],v[24:27],a[20:23],v[236:239]
 ds_read_b64_tr_b16 v[52:53],v121 offset:18432
 ds_read_b64_tr_b16 v[54:55],v121 offset:21504
 v_mfma_f32_16x16x32_bf16 v[196:199],v[24:27],a[240:243],v[196:199]
 v_mfma_f32_16x16x32_bf16 v[196:199],v[28:31],a[240:243],v[196:199]
 s_waitcnt lgkmcnt(12)
 v_mfma_f32_16x16x32_bf16 v[220:223],v[32:35],a[16:19],v[220:223]
 s_waitcnt vmcnt(14)
 s_barrier
 v_mfma_f32_16x16x32_bf16 v[220:223],v[36:39],a[24:27],v[220:223]
 ds_read_b64_tr_b16 v[16:17],v119 offset:24576
 ds_read_b64_tr_b16 v[18:19],v119 offset:27648
 v_mfma_f32_16x16x32_bf16 v[240:243],v[36:39],a[28:31],v[240:243]
 s_add_u32 m0,s35,24576
 s_mul_i32 s44,s63,786432
 buffer_load_dwordx4 v10,s[20:23],s44 offen lds
 v_mfma_f32_16x16x32_bf16 v[240:243],v[32:35],a[20:23],v[240:243]
 s_add_u32 s63,s63,1
 ds_read_b64_tr_b16 v[20:21],v119 offset:30720
 ds_read_b64_tr_b16 v[22:23],v119 offset:33792
 v_mfma_f32_16x16x32_bf16 v[200:203],v[32:35],a[240:243],v[200:203]
 buffer_load_dwordx4 v11,s[20:23],s44 offen offset:1024 lds
 s_cmp_eq_u32 s63,10
 s_cselect_b32 s63,0,s63
 buffer_load_dwordx4 v12,s[20:23],s44 offen offset:2048 lds
 v_mfma_f32_16x16x32_bf16 v[200:203],v[36:39],a[240:243],v[200:203]
 s_waitcnt lgkmcnt(8)
 v_mfma_f32_16x16x32_bf16 v[224:227],v[40:43],a[16:19],v[224:227]
 s_add_u32 m0,s35,27648
 s_add_u32 s44,s44,196608
 buffer_load_dwordx4 v10,s[20:23],s44 offen lds
 v_mfma_f32_16x16x32_bf16 v[224:227],v[44:47],a[24:27],v[224:227]
 ds_read_b64_tr_b16 v[24:25],v120 offset:24576
 ds_read_b64_tr_b16 v[26:27],v120 offset:27648
 v_mfma_f32_16x16x32_bf16 v[244:247],v[44:47],a[28:31],v[244:247]
 v_mfma_f32_16x16x32_bf16 v[244:247],v[40:43],a[20:23],v[244:247]
 ds_read_b64_tr_b16 v[28:29],v120 offset:30720
 ds_read_b64_tr_b16 v[30:31],v120 offset:33792
 v_mfma_f32_16x16x32_bf16 v[204:207],v[40:43],a[240:243],v[204:207]
 buffer_load_dwordx4 v11,s[20:23],s44 offen offset:1024 lds
 v_mfma_f32_16x16x32_bf16 v[204:207],v[44:47],a[240:243],v[204:207]
 s_waitcnt lgkmcnt(8)
 v_mfma_f32_16x16x32_bf16 v[228:231],v[48:51],a[16:19],v[228:231]
 v_mfma_f32_16x16x32_bf16 v[228:231],v[52:55],a[24:27],v[228:231]
 ds_read_b64_tr_b16 v[32:33],v119 offset:24640
 ds_read_b64_tr_b16 v[34:35],v119 offset:27712
 v_mfma_f32_16x16x32_bf16 v[248:251],v[52:55],a[28:31],v[248:251]
 s_add_u32 m0,s46,32768
 s_lshl_b32 s45,s61,7
 buffer_load_dwordx4 v8,s[24:27],s45 offen lds
 v_mfma_f32_16x16x32_bf16 v[248:251],v[48:51],a[20:23],v[248:251]
 ds_read_b64_tr_b16 v[36:37],v119 offset:30784
 ds_read_b64_tr_b16 v[38:39],v119 offset:33856
 v_mfma_f32_16x16x32_bf16 v[208:211],v[48:51],a[240:243],v[208:211]
 v_mfma_f32_16x16x32_bf16 v[208:211],v[52:55],a[240:243],v[208:211]
 s_add_u32 s45,s45,10240
 s_waitcnt lgkmcnt(8)
 v_mfma_f32_16x16x32_bf16 v[64:67],a[240:243],a[32:35],v[64:67]
 s_add_u32 m0,s46,33792
 s_add_u32 s61,s61,1
 buffer_load_dwordx4 v8,s[24:27],s45 offen lds
 v_mfma_f32_16x16x32_bf16 v[64:67],a[240:243],a[40:43],v[64:67]
 v_mfma_f32_16x16x32_bf16 v[64:67],a[240:243],a[48:51],v[64:67]
 v_mfma_f32_16x16x32_bf16 v[64:67],a[240:243],a[56:59],v[64:67]
 s_add_u32 s45,s45,10240
 v_mfma_f32_16x16x32_bf16 v[68:71],a[32:35],a[32:35],v[68:71]
 s_cmp_eq_u32 s61,10
 s_cselect_b32 s61,0,s61
 v_mfma_f32_16x16x32_bf16 v[68:71],a[40:43],a[40:43],v[68:71]
 s_add_u32 m0,s46,34816
 s_nop 0
 buffer_load_dwordx4 v8,s[24:27],s45 offen lds
 v_mfma_f32_16x16x32_bf16 v[68:71],a[48:51],a[48:51],v[68:71]
 v_mfma_f32_16x16x32_bf16 v[68:71],a[56:59],a[56:59],v[68:71]
 v_mfma_f32_16x16x32_bf16 v[80:83],a[240:243],a[36:39],v[80:83]
 v_mfma_f32_16x16x32_bf16 v[80:83],a[240:243],a[44:47],v[80:83]
 v_mfma_f32_16x16x32_bf16 v[80:83],a[240:243],a[52:55],v[80:83]
 s_add_u32 m0,s46,35840
 s_add_u32 s45,s45,10240
 buffer_load_dwordx4 v8,s[24:27],s45 offen lds
 v_mfma_f32_16x16x32_bf16 v[80:83],a[240:243],a[60:63],v[80:83]
 v_mfma_f32_16x16x32_bf16 v[84:87],a[36:39],a[36:39],v[84:87]
 v_mfma_f32_16x16x32_bf16 v[84:87],a[44:47],a[44:47],v[84:87]
 v_mfma_f32_16x16x32_bf16 v[84:87],a[52:55],a[52:55],v[84:87]
 v_mfma_f32_16x16x32_bf16 v[84:87],a[60:63],a[60:63],v[84:87]
 s_add_u32 m0,s46,36864
 s_add_u32 s45,s45,10240
 buffer_load_dwordx4 v8,s[24:27],s45 offen lds
 v_mfma_f32_16x16x32_bf16 v[212:215],v[16:19],a[32:35],v[212:215]
 v_mfma_f32_16x16x32_bf16 v[212:215],v[20:23],a[40:43],v[212:215]
 ds_read_b64_tr_b16 v[40:41],v120 offset:24640
 ds_read_b64_tr_b16 v[42:43],v120 offset:27712
 v_mfma_f32_16x16x32_bf16 v[232:235],v[20:23],a[44:47],v[232:235]
 v_mfma_f32_16x16x32_bf16 v[232:235],v[16:19],a[36:39],v[232:235]
 ds_read_b64_tr_b16 v[44:45],v120 offset:30784
 ds_read_b64_tr_b16 v[46:47],v120 offset:33856
 v_mfma_f32_16x16x32_bf16 v[192:195],v[16:19],a[240:243],v[192:195]
 s_add_u32 m0,s46,37888
 s_add_u32 s45,s45,10240
 buffer_load_dwordx4 v8,s[24:27],s45 offen lds
 v_mfma_f32_16x16x32_bf16 v[192:195],v[20:23],a[240:243],v[192:195]
 s_waitcnt lgkmcnt(8)
 v_mfma_f32_16x16x32_bf16 v[216:219],v[24:27],a[32:35],v[216:219]
 v_mfma_f32_16x16x32_bf16 v[216:219],v[28:31],a[40:43],v[216:219]
 ds_read_b64_tr_b16 v[48:49],v121 offset:24576
 ds_read_b64_tr_b16 v[50:51],v121 offset:27648
 v_mfma_f32_16x16x32_bf16 v[236:239],v[28:31],a[44:47],v[236:239]
 s_add_u32 m0,s46,38912
 s_add_u32 s45,s45,10240
 buffer_load_dwordx4 v8,s[24:27],s45 offen lds
 v_mfma_f32_16x16x32_bf16 v[236:239],v[24:27],a[36:39],v[236:239]
 ds_read_b64_tr_b16 v[52:53],v121 offset:30720
 ds_read_b64_tr_b16 v[54:55],v121 offset:33792
 v_mfma_f32_16x16x32_bf16 v[196:199],v[24:27],a[240:243],v[196:199]
 v_mfma_f32_16x16x32_bf16 v[196:199],v[28:31],a[240:243],v[196:199]
 s_waitcnt lgkmcnt(8)
 v_mfma_f32_16x16x32_bf16 v[220:223],v[32:35],a[32:35],v[220:223]
 v_mfma_f32_16x16x32_bf16 v[220:223],v[36:39],a[40:43],v[220:223]
 ds_read_b64_tr_b16 v[16:17],v119 offset:36864
 ds_read_b64_tr_b16 v[18:19],v119 offset:39936
 v_mfma_f32_16x16x32_bf16 v[240:243],v[36:39],a[44:47],v[240:243]
 s_add_u32 m0,s46,39936
 s_add_u32 s45,s45,10240
 buffer_load_dwordx4 v8,s[24:27],s45 offen lds
 v_mfma_f32_16x16x32_bf16 v[240:243],v[32:35],a[36:39],v[240:243]
 ds_read_b64_tr_b16 v[20:21],v119 offset:43008
 ds_read_b64_tr_b16 v[22:23],v119 offset:46080
 v_mfma_f32_16x16x32_bf16 v[200:203],v[32:35],a[240:243],v[200:203]
 v_mfma_f32_16x16x32_bf16 v[200:203],v[36:39],a[240:243],v[200:203]
 s_waitcnt lgkmcnt(8)
 v_mfma_f32_16x16x32_bf16 v[224:227],v[40:43],a[32:35],v[224:227]
 s_add_u32 m0,s35,27648
 s_nop 0
 buffer_load_dwordx4 v12,s[20:23],s44 offen offset:2048 lds
 v_mfma_f32_16x16x32_bf16 v[224:227],v[44:47],a[40:43],v[224:227]
 ds_read_b64_tr_b16 v[24:25],v120 offset:36864
 ds_read_b64_tr_b16 v[26:27],v120 offset:39936
 v_mfma_f32_16x16x32_bf16 v[244:247],v[44:47],a[44:47],v[244:247]
 v_mfma_f32_16x16x32_bf16 v[244:247],v[40:43],a[36:39],v[244:247]
 ds_read_b64_tr_b16 v[28:29],v120 offset:43008
 ds_read_b64_tr_b16 v[30:31],v120 offset:46080
 v_mfma_f32_16x16x32_bf16 v[204:207],v[40:43],a[240:243],v[204:207]
 v_mfma_f32_16x16x32_bf16 v[204:207],v[44:47],a[240:243],v[204:207]
 s_waitcnt lgkmcnt(8)
 v_mfma_f32_16x16x32_bf16 v[228:231],v[48:51],a[32:35],v[228:231]
 s_waitcnt vmcnt(16)
 ds_read_b128 a[64:67],v1
 ds_read_b128 a[68:71],v1 offset:2048
 v_mfma_f32_16x16x32_bf16 v[228:231],v[52:55],a[40:43],v[228:231]
 ds_read_b64_tr_b16 v[32:33],v119 offset:36928
 ds_read_b64_tr_b16 v[34:35],v119 offset:40000
 v_mfma_f32_16x16x32_bf16 v[248:251],v[52:55],a[44:47],v[248:251]
 ds_read_b128 a[72:75],v2
 ds_read_b128 a[76:79],v2 offset:2048
 v_mfma_f32_16x16x32_bf16 v[248:251],v[48:51],a[36:39],v[248:251]
 ds_read_b64_tr_b16 v[36:37],v119 offset:43072
 ds_read_b64_tr_b16 v[38:39],v119 offset:46144
 v_mfma_f32_16x16x32_bf16 v[208:211],v[48:51],a[240:243],v[208:211]
 ds_read_b128 a[80:83],v1 offset:4096
 ds_read_b128 a[84:87],v1 offset:6144
 v_mfma_f32_16x16x32_bf16 v[208:211],v[52:55],a[240:243],v[208:211]
 s_waitcnt lgkmcnt(14)
 v_mfma_f32_16x16x32_bf16 v[212:215],v[16:19],a[48:51],v[212:215]
 ds_read_b128 a[88:91],v2 offset:4096
 ds_read_b128 a[92:95],v2 offset:6144
 v_mfma_f32_16x16x32_bf16 v[212:215],v[20:23],a[56:59],v[212:215]
 ds_read_b64_tr_b16 v[40:41],v120 offset:36928
 ds_read_b64_tr_b16 v[42:43],v120 offset:40000
 v_mfma_f32_16x16x32_bf16 v[232:235],v[20:23],a[60:63],v[232:235]
 v_mfma_f32_16x16x32_bf16 v[232:235],v[16:19],a[52:55],v[232:235]
 ds_read_b64_tr_b16 v[44:45],v120 offset:43072
 ds_read_b64_tr_b16 v[46:47],v120 offset:46144
 v_mfma_f32_16x16x32_bf16 v[192:195],v[16:19],a[240:243],v[192:195]
 v_mfma_f32_16x16x32_bf16 v[192:195],v[20:23],a[240:243],v[192:195]
 s_waitcnt lgkmcnt(15)
 v_mfma_f32_16x16x32_bf16 v[216:219],v[24:27],a[48:51],v[216:219]
 v_mfma_f32_16x16x32_bf16 v[216:219],v[28:31],a[56:59],v[216:219]
 ds_read_b64_tr_b16 v[48:49],v121 offset:36864
 ds_read_b64_tr_b16 v[50:51],v121 offset:39936
 v_mfma_f32_16x16x32_bf16 v[236:239],v[28:31],a[60:63],v[236:239]
 v_mfma_f32_16x16x32_bf16 v[236:239],v[24:27],a[52:55],v[236:239]
 ds_read_b64_tr_b16 v[52:53],v121 offset:43008
 ds_read_b64_tr_b16 v[54:55],v121 offset:46080
 v_mfma_f32_16x16x32_bf16 v[196:199],v[24:27],a[240:243],v[196:199]
 v_mfma_f32_16x16x32_bf16 v[196:199],v[28:31],a[240:243],v[196:199]
 s_waitcnt lgkmcnt(12)
 v_mfma_f32_16x16x32_bf16 v[220:223],v[32:35],a[48:51],v[220:223]
 s_waitcnt vmcnt(14)
 s_barrier
 v_mfma_f32_16x16x32_bf16 v[220:223],v[36:39],a[56:59],v[220:223]
 ds_read_b64_tr_b16 v[16:17],v116
 ds_read_b64_tr_b16 v[18:19],v116 offset:3072
 v_mfma_f32_16x16x32_bf16 v[240:243],v[36:39],a[60:63],v[240:243]
 s_add_u32 m0,s35,49152
 s_mul_i32 s44,s63,786432
 buffer_load_dwordx4 v10,s[20:23],s44 offen lds
 v_mfma_f32_16x16x32_bf16 v[240:243],v[32:35],a[52:55],v[240:243]
 s_add_u32 s63,s63,1
 ds_read_b64_tr_b16 v[20:21],v116 offset:6144
 ds_read_b64_tr_b16 v[22:23],v116 offset:9216
 v_mfma_f32_16x16x32_bf16 v[200:203],v[32:35],a[240:243],v[200:203]
 buffer_load_dwordx4 v11,s[20:23],s44 offen offset:1024 lds
 s_cmp_eq_u32 s63,10
 s_cselect_b32 s63,0,s63
 buffer_load_dwordx4 v12,s[20:23],s44 offen offset:2048 lds
 v_mfma_f32_16x16x32_bf16 v[200:203],v[36:39],a[240:243],v[200:203]
 s_waitcnt lgkmcnt(8)
 v_mfma_f32_16x16x32_bf16 v[224:227],v[40:43],a[48:51],v[224:227]
 s_add_u32 m0,s35,52224
 s_add_u32 s44,s44,196608
 buffer_load_dwordx4 v10,s[20:23],s44 offen lds
 v_mfma_f32_16x16x32_bf16 v[224:227],v[44:47],a[56:59],v[224:227]
 ds_read_b64_tr_b16 v[24:25],v117
 ds_read_b64_tr_b16 v[26:27],v117 offset:3072
 v_mfma_f32_16x16x32_bf16 v[244:247],v[44:47],a[60:63],v[244:247]
 v_mfma_f32_16x16x32_bf16 v[244:247],v[40:43],a[52:55],v[244:247]
 ds_read_b64_tr_b16 v[28:29],v117 offset:6144
 ds_read_b64_tr_b16 v[30:31],v117 offset:9216
 v_mfma_f32_16x16x32_bf16 v[204:207],v[40:43],a[240:243],v[204:207]
 buffer_load_dwordx4 v11,s[20:23],s44 offen offset:1024 lds
 v_mfma_f32_16x16x32_bf16 v[204:207],v[44:47],a[240:243],v[204:207]
 s_waitcnt lgkmcnt(8)
 v_mfma_f32_16x16x32_bf16 v[228:231],v[48:51],a[48:51],v[228:231]
 v_mfma_f32_16x16x32_bf16 v[228:231],v[52:55],a[56:59],v[228:231]
 ds_read_b64_tr_b16 v[32:33],v116 offset:64
 ds_read_b64_tr_b16 v[34:35],v116 offset:3136
 v_mfma_f32_16x16x32_bf16 v[248:251],v[52:55],a[60:63],v[248:251]
 s_add_u32 m0,s46,0
 s_lshl_b32 s45,s61,7
 buffer_load_dwordx4 v8,s[24:27],s45 offen lds
 v_mfma_f32_16x16x32_bf16 v[248:251],v[48:51],a[52:55],v[248:251]
 ds_read_b64_tr_b16 v[36:37],v116 offset:6208
 ds_read_b64_tr_b16 v[38:39],v116 offset:9280
 v_mfma_f32_16x16x32_bf16 v[208:211],v[48:51],a[240:243],v[208:211]
 v_mfma_f32_16x16x32_bf16 v[208:211],v[52:55],a[240:243],v[208:211]
 s_add_u32 s45,s45,10240
 s_waitcnt lgkmcnt(8)
 v_mfma_f32_16x16x32_bf16 v[64:67],a[240:243],a[64:67],v[64:67]
 s_add_u32 m0,s46,1024
 s_add_u32 s61,s61,1
 buffer_load_dwordx4 v8,s[24:27],s45 offen lds
 v_mfma_f32_16x16x32_bf16 v[64:67],a[240:243],a[72:75],v[64:67]
 v_mfma_f32_16x16x32_bf16 v[64:67],a[240:243],a[80:83],v[64:67]
 v_mfma_f32_16x16x32_bf16 v[64:67],a[240:243],a[88:91],v[64:67]
 s_add_u32 s45,s45,10240
 v_mfma_f32_16x16x32_bf16 v[68:71],a[64:67],a[64:67],v[68:71]
 s_cmp_eq_u32 s61,10
 s_cselect_b32 s61,0,s61
 v_mfma_f32_16x16x32_bf16 v[68:71],a[72:75],a[72:75],v[68:71]
 s_add_u32 m0,s46,2048
 s_nop 0
 buffer_load_dwordx4 v8,s[24:27],s45 offen lds
 v_mfma_f32_16x16x32_bf16 v[68:71],a[80:83],a[80:83],v[68:71]
 v_mfma_f32_16x16x32_bf16 v[68:71],a[88:91],a[88:91],v[68:71]
 v_mfma_f32_16x16x32_bf16 v[80:83],a[240:243],a[68:71],v[80:83]
 v_mfma_f32_16x16x32_bf16 v[80:83],a[240:243],a[76:79],v[80:83]
 v_mfma_f32_16x16x32_bf16 v[80:83],a[240:243],a[84:87],v[80:83]
 s_add_u32 m0,s46,3072
 s_add_u32 s45,s45,10240
 buffer_load_dwordx4 v8,s[24:27],s45 offen lds
 v_mfma_f32_16x16x32_bf16 v[80:83],a[240:243],a[92:95],v[80:83]
 v_mfma_f32_16x16x32_bf16 v[84:87],a[68:71],a[68:71],v[84:87]
 v_mfma_f32_16x16x32_bf16 v[84:87],a[76:79],a[76:79],v[84:87]
 v_mfma_f32_16x16x32_bf16 v[84:87],a[84:87],a[84:87],v[84:87]
 v_mfma_f32_16x16x32_bf16 v[84:87],a[92:95],a[92:95],v[84:87]
 s_add_u32 m0,s46,4096
 s_add_u32 s45,s45,10240
 buffer_load_dwordx4 v8,s[24:27],s45 offen lds
 v_mfma_f32_16x16x32_bf16 v[212:215],v[16:19],a[64:67],v[212:215]
 v_mfma_f32_16x16x32_bf16 v[212:215],v[20:23],a[72:75],v[212:215]
 ds_read_b64_tr_b16 v[40:41],v117 offset:64
 ds_read_b64_tr_b16 v[42:43],v117 offset:3136
 v_mfma_f32_16x16x32_bf16 v[232:235],v[20:23],a[76:79],v[232:235]
 v_mfma_f32_16x16x32_bf16 v[232:235],v[16:19],a[68:71],v[232:235]
 ds_read_b64_tr_b16 v[44:45],v117 offset:6208
 ds_read_b64_tr_b16 v[46:47],v117 offset:9280
 v_mfma_f32_16x16x32_bf16 v[192:195],v[16:19],a[240:243],v[192:195]
 s_add_u32 m0,s46,5120
 s_add_u32 s45,s45,10240
 buffer_load_dwordx4 v8,s[24:27],s45 offen lds
 v_mfma_f32_16x16x32_bf16 v[192:195],v[20:23],a[240:243],v[192:195]
 s_waitcnt lgkmcnt(8)
 v_cndmask_b32 v68,v68,v69,s[36:37]
 v_cndmask_b32 v68,v68,v70,s[38:39]
 v_mfma_f32_16x16x32_bf16 v[216:219],v[24:27],a[64:67],v[216:219]
 v_cndmask_b32 v68,v68,v71,s[0:1]
 v_cndmask_b32 v68,0,v68,s[70:71]
 v_mfma_f32_16x16x32_bf16 v[216:219],v[28:31],a[72:75],v[216:219]
 ds_read_b64_tr_b16 v[48:49],v118
 ds_read_b64_tr_b16 v[50:51],v118 offset:3072
 v_mfma_f32_16x16x32_bf16 v[236:239],v[28:31],a[76:79],v[236:239]
 v_cndmask_b32 v84,v84,v85,s[36:37]
 v_cndmask_b32 v84,v84,v86,s[38:39]
 v_mfma_f32_16x16x32_bf16 v[236:239],v[24:27],a[68:71],v[236:239]
 s_add_u32 m0,s46,6144
 s_add_u32 s45,s45,10240
 buffer_load_dwordx4 v8,s[24:27],s45 offen lds
 ds_read_b64_tr_b16 v[52:53],v118 offset:6144
 ds_read_b64_tr_b16 v[54:55],v118 offset:9216
 v_mfma_f32_16x16x32_bf16 v[196:199],v[24:27],a[240:243],v[196:199]
 v_cndmask_b32 v84,v84,v87,s[0:1]
 v_cndmask_b32 v84,0,v84,s[70:71]
 v_mfma_f32_16x16x32_bf16 v[196:199],v[28:31],a[240:243],v[196:199]
 s_waitcnt lgkmcnt(8)
 v_mov_b32 v69,v68
 v_mov_b32 v85,v84
 v_mfma_f32_16x16x32_bf16 v[220:223],v[32:35],a[64:67],v[220:223]
 v_permlane32_swap_b32 v68,v69
 v_permlane32_swap_b32 v84,v85
 v_mfma_f32_16x16x32_bf16 v[220:223],v[36:39],a[72:75],v[220:223]
 s_add_u32 m0,s46,7168
 s_add_u32 s45,s45,10240
 buffer_load_dwordx4 v8,s[24:27],s45 offen lds
 ds_read_b64_tr_b16 v[16:17],v116 offset:12288
 ds_read_b64_tr_b16 v[18:19],v116 offset:15360
 v_mfma_f32_16x16x32_bf16 v[240:243],v[36:39],a[76:79],v[240:243]
 v_add_f32 v68,v68,v69
 v_add_f32 v84,v84,v85
 v_mfma_f32_16x16x32_bf16 v[240:243],v[32:35],a[68:71],v[240:243]
 ds_read_b64_tr_b16 v[20:21],v116 offset:18432
 ds_read_b64_tr_b16 v[22:23],v116 offset:21504
 v_mfma_f32_16x16x32_bf16 v[200:203],v[32:35],a[240:243],v[200:203]
 v_mov_b32 v69,v68
 v_mov_b32 v85,v84
 v_mfma_f32_16x16x32_bf16 v[200:203],v[36:39],a[240:243],v[200:203]
 s_waitcnt lgkmcnt(8)
 v_permlane16_swap_b32 v68,v69
 v_permlane16_swap_b32 v84,v85
 v_mfma_f32_16x16x32_bf16 v[224:227],v[40:43],a[64:67],v[224:227]
 s_add_u32 m0,s35,52224
 s_nop 0
 buffer_load_dwordx4 v12,s[20:23],s44 offen offset:2048 lds
 v_add_f32 v68,v68,v69
 v_add_f32 v84,v84,v85
 v_mfma_f32_16x16x32_bf16 v[224:227],v[44:47],a[72:75],v[224:227]
 ds_read_b64_tr_b16 v[24:25],v117 offset:12288
 ds_read_b64_tr_b16 v[26:27],v117 offset:15360
 v_mfma_f32_16x16x32_bf16 v[244:247],v[44:47],a[76:79],v[244:247]
 v_mul_f32 v72,0xbacccccd,v64
 v_mul_f32 v68,0x3acccccd,v68
 v_mfma_f32_16x16x32_bf16 v[244:247],v[40:43],a[68:71],v[244:247]
 ds_read_b64_tr_b16 v[28:29],v117 offset:18432
 ds_read_b64_tr_b16 v[30:31],v117 offset:21504
 v_mfma_f32_16x16x32_bf16 v[204:207],v[40:43],a[240:243],v[204:207]
 v_fma_f32 v68,-v72,v72,v68
 v_max_f32 v68,0,v68
 v_mfma_f32_16x16x32_bf16 v[204:207],v[44:47],a[240:243],v[204:207]
 s_waitcnt lgkmcnt(8)
 v_add_f32 v69,0x3727c5ac,v68
 v_mfma_f32_16x16x32_bf16 v[228:231],v[48:51],a[64:67],v[228:231]
 v_rsq_f32 v69,v69
 v_mfma_f32_16x16x32_bf16 v[228:231],v[52:55],a[72:75],v[228:231]
 ds_read_b64_tr_b16 v[32:33],v116 offset:12352
 ds_read_b64_tr_b16 v[34:35],v116 offset:15424
 v_mfma_f32_16x16x32_bf16 v[248:251],v[52:55],a[76:79],v[248:251]
 v_mul_f32 v70,v69,v69
 v_mul_f32 v70,v70,v68
 v_mfma_f32_16x16x32_bf16 v[248:251],v[48:51],a[68:71],v[248:251]
 ds_read_b64_tr_b16 v[36:37],v116 offset:18496
 ds_read_b64_tr_b16 v[38:39],v116 offset:21568
 v_mfma_f32_16x16x32_bf16 v[208:211],v[48:51],a[240:243],v[208:211]
 v_add_f32 v70,0x3727c5ac,v70
 v_mfma_f32_16x16x32_bf16 v[208:211],v[52:55],a[240:243],v[208:211]
 s_waitcnt lgkmcnt(8)
 v_rsq_f32 v70,v70
 v_mfma_f32_16x16x32_bf16 v[212:215],v[16:19],a[80:83],v[212:215]
 v_mul_f32 v73,0x3dd53b95,v69
 v_mul_f32 v74,v69,v70
 v_mfma_f32_16x16x32_bf16 v[212:215],v[20:23],a[88:91],v[212:215]
 ds_read_b64_tr_b16 v[40:41],v117 offset:12352
 ds_read_b64_tr_b16 v[42:43],v117 offset:15424
 v_mfma_f32_16x16x32_bf16 v[232:235],v[20:23],a[92:95],v[232:235]
 v_accvgpr_write_b32 a106,v72
 v_accvgpr_write_b32 a107,v69
 v_mfma_f32_16x16x32_bf16 v[232:235],v[16:19],a[84:87],v[232:235]
 ds_read_b64_tr_b16 v[44:45],v117 offset:18496
 ds_read_b64_tr_b16 v[46:47],v117 offset:21568
 v_mfma_f32_16x16x32_bf16 v[192:195],v[16:19],a[240:243],v[192:195]
 v_mul_f32 v76,0xc0135761,v74
 v_mul_f32 v75,v74,v74
 v_mfma_f32_16x16x32_bf16 v[192:195],v[20:23],a[240:243],v[192:195]
 s_waitcnt lgkmcnt(8)
 v_mul_f32 v75,v75,v76
 v_mul_f32 v75,0x3d372713,v75
 v_mfma_f32_16x16x32_bf16 v[216:219],v[24:27],a[80:83],v[216:219]
 s_waitcnt vmcnt(15)
 v_rcp_f32 v77,v74
 v_mfma_f32_16x16x32_bf16 v[216:219],v[28:31],a[88:91],v[216:219]
 ds_read_b64_tr_b16 v[48:49],v118 offset:12288
 ds_read_b64_tr_b16 v[50:51],v118 offset:15360
 v_mfma_f32_16x16x32_bf16 v[236:239],v[28:31],a[92:95],v[236:239]
 v_mul_f32 v88,0xbacccccd,v80
 v_mul_f32 v84,0x3acccccd,v84
 v_mfma_f32_16x16x32_bf16 v[236:239],v[24:27],a[84:87],v[236:239]
 ds_read_b64_tr_b16 v[52:53],v118 offset:18432
 ds_read_b64_tr_b16 v[54:55],v118 offset:21504
 v_mfma_f32_16x16x32_bf16 v[196:199],v[24:27],a[240:243],v[196:199]
 ds_read_b128 a[0:3],v1 offset:32768
 ds_read_b128 a[16:19],v2 offset:32768
 v_mfma_f32_16x16x32_bf16 v[196:199],v[28:31],a[240:243],v[196:199]
 s_waitcnt lgkmcnt(10)
 v_fma_f32 v84,-v88,v88,v84
 v_max_f32 v84,0,v84
 v_mfma_f32_16x16x32_bf16 v[220:223],v[32:35],a[80:83],v[220:223]
 v_add_f32 v85,0x3727c5ac,v84
 v_mfma_f32_16x16x32_bf16 v[220:223],v[36:39],a[88:91],v[220:223]
 v_rsq_f32 v85,v85
 v_mfma_f32_16x16x32_bf16 v[240:243],v[36:39],a[92:95],v[240:243]
 v_mul_f32 v86,v85,v85
 v_mul_f32 v86,v86,v84
 v_mfma_f32_16x16x32_bf16 v[240:243],v[32:35],a[84:87],v[240:243]
 v_add_f32 v86,0x3727c5ac,v86
 v_mfma_f32_16x16x32_bf16 v[200:203],v[32:35],a[240:243],v[200:203]
 ds_read_b128 a[4:7],v1 offset:34816
 ds_read_b128 a[20:23],v2 offset:34816
 v_mfma_f32_16x16x32_bf16 v[200:203],v[36:39],a[240:243],v[200:203]
 s_waitcnt lgkmcnt(8)
 v_rsq_f32 v86,v86
 v_mfma_f32_16x16x32_bf16 v[224:227],v[40:43],a[80:83],v[224:227]
 v_mul_f32 v89,0x3dd53b95,v85
 v_mul_f32 v90,v85,v86
 v_mfma_f32_16x16x32_bf16 v[224:227],v[44:47],a[88:91],v[224:227]
 v_accvgpr_write_b32 a118,v88
 v_accvgpr_write_b32 a119,v85
 v_mfma_f32_16x16x32_bf16 v[244:247],v[44:47],a[92:95],v[244:247]
 v_mul_f32 v92,0xc0135761,v90
 v_mul_f32 v91,v90,v90
 v_mfma_f32_16x16x32_bf16 v[244:247],v[40:43],a[84:87],v[244:247]
 v_mul_f32 v91,v91,v92
 v_mul_f32 v91,0x3d372713,v91
 v_mfma_f32_16x16x32_bf16 v[204:207],v[40:43],a[240:243],v[204:207]
 ds_read_b128 a[8:11],v1 offset:36864
 ds_read_b128 a[24:27],v2 offset:36864
 v_mfma_f32_16x16x32_bf16 v[204:207],v[44:47],a[240:243],v[204:207]
 s_waitcnt lgkmcnt(6)
 v_rcp_f32 v93,v90
 v_mfma_f32_16x16x32_bf16 v[228:231],v[48:51],a[80:83],v[228:231]
 v_mfma_f32_16x16x32_bf16 v[228:231],v[52:55],a[88:91],v[228:231]
 v_mfma_f32_16x16x32_bf16 v[248:251],v[52:55],a[92:95],v[248:251]
 v_mfma_f32_16x16x32_bf16 v[248:251],v[48:51],a[84:87],v[248:251]
 v_mfma_f32_16x16x32_bf16 v[208:211],v[48:51],a[240:243],v[208:211]
 ds_read_b128 a[12:15],v1 offset:38912
 ds_read_b128 a[28:31],v2 offset:38912
 v_mfma_f32_16x16x32_bf16 v[208:211],v[52:55],a[240:243],v[208:211]
 s_waitcnt lgkmcnt(0)
 s_barrier
 s_add_u32 m0,s35,73728
 s_mul_i32 s44,s63,786432
 buffer_load_dwordx4 v10,s[20:23],s44 offen lds
 s_add_u32 s63,s63,1
 buffer_load_dwordx4 v11,s[20:23],s44 offen offset:1024 lds
 s_cmp_eq_u32 s63,10
 s_cselect_b32 s63,0,s63
 buffer_load_dwordx4 v12,s[20:23],s44 offen offset:2048 lds
 v_fmac_f32 v212,v192,v72
 v_fmac_f32 v213,v193,v72
 v_fmac_f32 v214,v194,v72
 v_fmac_f32 v215,v195,v72
 buffer_store_dwordx2 v[72:73],v13,s[28:31],s40 offen sc1
 v_fmac_f32 v216,v196,v72
 v_fmac_f32 v217,v197,v72
 v_fmac_f32 v218,v198,v72
 v_fmac_f32 v219,v199,v72
 buffer_store_dwordx2 v[88:89],v13,s[28:31],s40 offen offset:128 sc1
 v_fmac_f32 v220,v200,v72
 v_fmac_f32 v221,v201,v72
 v_fmac_f32 v222,v202,v72
 v_fmac_f32 v223,v203,v72
 v_fmac_f32 v224,v204,v72
 v_fmac_f32 v225,v205,v72
 v_fmac_f32 v226,v206,v72
 v_fmac_f32 v227,v207,v72
 v_fmac_f32 v228,v208,v72
 v_fmac_f32 v229,v209,v72
 v_fmac_f32 v230,v210,v72
 v_fmac_f32 v231,v211,v72
 v_fmac_f32 v232,v192,v88
 s_add_u32 m0,s46,32768
 s_lshl_b32 s45,s61,7
 buffer_load_dwordx4 v8,s[24:27],s45 offen lds
 v_fmac_f32 v233,v193,v88
 v_fmac_f32 v234,v194,v88
 v_fmac_f32 v235,v195,v88
 v_fmac_f32 v236,v196,v88
 v_fmac_f32 v237,v197,v88
 v_fmac_f32 v238,v198,v88
 v_fmac_f32 v239,v199,v88
 v_fmac_f32 v240,v200,v88
 v_fmac_f32 v241,v201,v88
 v_fmac_f32 v242,v202,v88
 v_fmac_f32 v243,v203,v88
 v_fmac_f32 v244,v204,v88
 v_fmac_f32 v245,v205,v88
 v_fmac_f32 v246,v206,v88
 v_fmac_f32 v247,v207,v88
 v_fmac_f32 v248,v208,v88
 v_fmac_f32 v249,v209,v88
 v_fmac_f32 v250,v210,v88
 v_fmac_f32 v251,v211,v88
 s_add_u32 s45,s45,10240
 s_add_u32 m0,s46,33792
 s_add_u32 s61,s61,1
 buffer_load_dwordx4 v8,s[24:27],s45 offen lds
 v_mul_f32 v152,v212,v212
 v_mul_f32 v153,v213,v213
 v_mul_f32 v154,v214,v214
 v_mul_f32 v155,v215,v215
 v_mul_f32 v156,v216,v216
 v_mul_f32 v157,v217,v217
 v_mul_f32 v158,v218,v218
 v_mul_f32 v159,v219,v219
 v_mul_f32 v160,v220,v220
 v_mul_f32 v161,v221,v221
 v_mul_f32 v162,v222,v222
 v_mul_f32 v163,v223,v223
 v_mul_f32 v164,v224,v224
 v_mul_f32 v165,v225,v225
 v_mul_f32 v166,v226,v226
 v_mul_f32 v167,v227,v227
 v_mul_f32 v168,v228,v228
 v_mul_f32 v169,v229,v229
 v_mul_f32 v170,v230,v230
 s_add_u32 s45,s45,10240
 s_cmp_eq_u32 s61,10
 s_cselect_b32 s61,0,s61
 s_add_u32 m0,s46,34816
 s_nop 0
 buffer_load_dwordx4 v8,s[24:27],s45 offen lds
 v_mul_f32 v171,v231,v231
 v_fma_f32 v152,v152,v75,v76
 v_fma_f32 v153,v153,v75,v76
 v_fma_f32 v154,v154,v75,v76
 v_fma_f32 v155,v155,v75,v76
 v_fma_f32 v156,v156,v75,v76
 v_fma_f32 v157,v157,v75,v76
 v_fma_f32 v158,v158,v75,v76
 v_fma_f32 v159,v159,v75,v76
 v_fma_f32 v160,v160,v75,v76
 v_fma_f32 v161,v161,v75,v76
 v_fma_f32 v162,v162,v75,v76
 v_fma_f32 v163,v163,v75,v76
 v_fma_f32 v164,v164,v75,v76
 v_fma_f32 v165,v165,v75,v76
 v_fma_f32 v166,v166,v75,v76
 v_fma_f32 v167,v167,v75,v76
 v_fma_f32 v168,v168,v75,v76
 v_fma_f32 v169,v169,v75,v76
 s_add_u32 m0,s46,35840
 s_add_u32 s45,s45,10240
 buffer_load_dwordx4 v8,s[24:27],s45 offen lds
 v_fma_f32 v170,v170,v75,v76
 v_fma_f32 v171,v171,v75,v76
 v_mul_f32 v152,v152,v212
 v_mul_f32 v153,v153,v213
 v_mul_f32 v154,v154,v214
 v_mul_f32 v155,v155,v215
 v_mul_f32 v156,v156,v216
 v_mul_f32 v157,v157,v217
 v_mul_f32 v158,v158,v218
 v_mul_f32 v159,v159,v219
 v_mul_f32 v160,v160,v220
 v_mul_f32 v161,v161,v221
 v_mul_f32 v162,v162,v222
 v_mul_f32 v163,v163,v223
 v_mul_f32 v164,v164,v224
 v_mul_f32 v165,v165,v225
 v_mul_f32 v166,v166,v226
 v_mul_f32 v167,v167,v227
 v_mul_f32 v168,v168,v228
 s_add_u32 m0,s46,36864
 s_add_u32 s45,s45,10240
 buffer_load_dwordx4 v8,s[24:27],s45 offen lds
 v_mul_f32 v169,v169,v229
 v_mul_f32 v170,v170,v230
 v_mul_f32 v171,v171,v231
 v_exp_f32 v152,v152
 v_exp_f32 v153,v153
 v_exp_f32 v154,v154
 v_exp_f32 v155,v155
 v_exp_f32 v156,v156
 v_exp_f32 v157,v157
 v_exp_f32 v158,v158
 v_exp_f32 v159,v159
 s_add_u32 m0,s46,37888
 s_add_u32 s45,s45,10240
 buffer_load_dwordx4 v8,s[24:27],s45 offen lds
 v_exp_f32 v160,v160
 v_exp_f32 v161,v161
 v_exp_f32 v162,v162
 v_exp_f32 v163,v163
 v_exp_f32 v164,v164
 v_exp_f32 v165,v165
 v_exp_f32 v166,v166
 v_exp_f32 v167,v167
 v_exp_f32 v168,v168
 v_exp_f32 v169,v169
 s_add_u32 m0,s46,38912
 s_add_u32 s45,s45,10240
 buffer_load_dwordx4 v8,s[24:27],s45 offen lds
 v_exp_f32 v170,v170
 v_exp_f32 v171,v171
 v_fma_f32 v152,v152,v77,v77
 v_fma_f32 v153,v153,v77,v77
 v_fma_f32 v154,v154,v77,v77
 v_fma_f32 v155,v155,v77,v77
 v_fma_f32 v156,v156,v77,v77
 v_fma_f32 v157,v157,v77,v77
 v_fma_f32 v158,v158,v77,v77
 v_fma_f32 v159,v159,v77,v77
 v_fma_f32 v160,v160,v77,v77
 v_fma_f32 v161,v161,v77,v77
 v_fma_f32 v162,v162,v77,v77
 v_fma_f32 v163,v163,v77,v77
 v_fma_f32 v164,v164,v77,v77
 v_fma_f32 v165,v165,v77,v77
 s_add_u32 m0,s46,39936
 s_add_u32 s45,s45,10240
 buffer_load_dwordx4 v8,s[24:27],s45 offen lds
 v_fma_f32 v166,v166,v77,v77
 v_fma_f32 v167,v167,v77,v77
 v_fma_f32 v168,v168,v77,v77
 v_fma_f32 v169,v169,v77,v77
 v_fma_f32 v170,v170,v77,v77
 v_fma_f32 v171,v171,v77,v77
 v_rcp_f32 v152,v152
 v_rcp_f32 v153,v153
 v_rcp_f32 v154,v154
 v_rcp_f32 v155,v155
 v_rcp_f32 v156,v156
 v_rcp_f32 v157,v157
 v_rcp_f32 v158,v158
 s_add_u32 m0,s35,76800
 s_add_u32 s44,s44,196608
 buffer_load_dwordx4 v10,s[20:23],s44 offen lds
 v_rcp_f32 v159,v159
 v_rcp_f32 v160,v160
 v_rcp_f32 v161,v161
 v_rcp_f32 v162,v162
 v_rcp_f32 v163,v163
 v_rcp_f32 v164,v164
 v_rcp_f32 v165,v165
 v_rcp_f32 v166,v166
 buffer_load_dwordx4 v11,s[20:23],s44 offen offset:1024 lds
 v_rcp_f32 v167,v167
 v_rcp_f32 v168,v168
 v_rcp_f32 v169,v169
 v_rcp_f32 v170,v170
 v_rcp_f32 v171,v171
 v_mul_f32 v212,v212,v152
 v_mul_f32 v213,v213,v153
 v_mul_f32 v214,v214,v154
 v_mul_f32 v215,v215,v155
 v_mul_f32 v216,v216,v156
 v_mul_f32 v217,v217,v157
 buffer_load_dwordx4 v12,s[20:23],s44 offen offset:2048 lds
 v_mul_f32 v218,v218,v158
 v_mul_f32 v219,v219,v159
 v_mul_f32 v220,v220,v160
 v_mul_f32 v221,v221,v161
 v_mul_f32 v222,v222,v162
 v_mul_f32 v223,v223,v163
 v_mul_f32 v224,v224,v164
 v_mul_f32 v225,v225,v165
 v_mul_f32 v226,v226,v166
 v_mul_f32 v227,v227,v167
 v_mul_f32 v228,v228,v168
 v_mul_f32 v229,v229,v169
 v_mul_f32 v230,v230,v170
 v_mul_f32 v231,v231,v171
 v_cvt_pk_bf16_f32 v192,v212,v213
 v_cvt_pk_bf16_f32 v193,v214,v215
 s_add_u32 m0,s35,0
 s_mul_i32 s44,s63,786432
 buffer_load_dwordx4 v10,s[20:23],s44 offen lds
 v_cvt_pk_bf16_f32 v194,v216,v217
 v_cvt_pk_bf16_f32 v195,v218,v219
 v_cvt_pk_bf16_f32 v196,v220,v221
 v_cvt_pk_bf16_f32 v197,v222,v223
 v_cvt_pk_bf16_f32 v198,v224,v225
 v_cvt_pk_bf16_f32 v199,v226,v227
 v_cvt_pk_bf16_f32 v200,v228,v229
 v_cvt_pk_bf16_f32 v201,v230,v231
 v_cndmask_b32 v192,0,v192,vcc
 v_cndmask_b32 v193,0,v193,vcc
 v_cndmask_b32 v194,0,v194,vcc
 v_cndmask_b32 v195,0,v195,vcc
 v_cndmask_b32 v196,0,v196,vcc
 v_cndmask_b32 v197,0,v197,vcc
 v_cndmask_b32 v198,0,v198,vcc
 v_cndmask_b32 v199,0,v199,vcc
 v_cndmask_b32 v200,0,v200,vcc
 s_add_u32 s63,s63,1
 buffer_load_dwordx4 v11,s[20:23],s44 offen offset:1024 lds
 v_cndmask_b32 v201,0,v201,vcc
 v_mul_f32 v152,v232,v232
 v_mul_f32 v153,v233,v233
 v_mul_f32 v154,v234,v234
 v_mul_f32 v155,v235,v235
 v_mul_f32 v156,v236,v236
 v_mul_f32 v157,v237,v237
 v_mul_f32 v158,v238,v238
 v_mul_f32 v159,v239,v239
 v_mul_f32 v160,v240,v240
 v_mul_f32 v161,v241,v241
 v_mul_f32 v162,v242,v242
 v_mul_f32 v163,v243,v243
 v_mul_f32 v164,v244,v244
 v_mul_f32 v165,v245,v245
 v_mul_f32 v166,v246,v246
 buffer_store_dwordx4 v[192:195],v252,s[28:31],s56 offen sc1
 v_mul_f32 v167,v247,v247
 v_mul_f32 v168,v248,v248
 v_mul_f32 v169,v249,v249
 v_mul_f32 v170,v250,v250
 v_mul_f32 v171,v251,v251
 v_fma_f32 v152,v152,v91,v92
 v_fma_f32 v153,v153,v91,v92
 v_fma_f32 v154,v154,v91,v92
 v_fma_f32 v155,v155,v91,v92
 v_fma_f32 v156,v156,v91,v92
 v_fma_f32 v157,v157,v91,v92
 v_fma_f32 v158,v158,v91,v92
 v_fma_f32 v159,v159,v91,v92
 v_fma_f32 v160,v160,v91,v92
 v_fma_f32 v161,v161,v91,v92
 v_fma_f32 v162,v162,v91,v92
 v_fma_f32 v163,v163,v91,v92
 v_fma_f32 v164,v164,v91,v92
 v_fma_f32 v165,v165,v91,v92
 v_fma_f32 v166,v166,v91,v92
 v_fma_f32 v167,v167,v91,v92
 v_fma_f32 v168,v168,v91,v92
 v_fma_f32 v169,v169,v91,v92
 v_fma_f32 v170,v170,v91,v92
 v_fma_f32 v171,v171,v91,v92
 v_mul_f32 v152,v152,v232
 v_mul_f32 v153,v153,v233
 v_mul_f32 v154,v154,v234
 v_mul_f32 v155,v155,v235
 v_mul_f32 v156,v156,v236
 v_mul_f32 v157,v157,v237
 v_mul_f32 v158,v158,v238
 v_mul_f32 v159,v159,v239
 v_mul_f32 v160,v160,v240
 v_mul_f32 v161,v161,v241
 buffer_store_dwordx4 v[196:199],v252,s[28:31],s56 offen offset:1024 sc1
 v_mul_f32 v162,v162,v242
 v_mul_f32 v163,v163,v243
 v_mul_f32 v164,v164,v244
 v_mul_f32 v165,v165,v245
 v_mul_f32 v166,v166,v246
 v_mul_f32 v167,v167,v247
 v_mul_f32 v168,v168,v248
 v_mul_f32 v169,v169,v249
 v_mul_f32 v170,v170,v250
 v_mul_f32 v171,v171,v251
 v_exp_f32 v152,v152
 v_exp_f32 v153,v153
 v_exp_f32 v154,v154
 v_exp_f32 v155,v155
 v_exp_f32 v156,v156
 v_exp_f32 v157,v157
 v_exp_f32 v158,v158
 v_exp_f32 v159,v159
 v_exp_f32 v160,v160
 v_exp_f32 v161,v161
 v_exp_f32 v162,v162
 v_exp_f32 v163,v163
 v_exp_f32 v164,v164
 s_cmp_eq_u32 s63,10
 s_cselect_b32 s63,0,s63
 buffer_load_dwordx4 v12,s[20:23],s44 offen offset:2048 lds
 v_exp_f32 v165,v165
 v_exp_f32 v166,v166
 v_exp_f32 v167,v167
 v_exp_f32 v168,v168
 v_exp_f32 v169,v169
 v_exp_f32 v170,v170
 v_exp_f32 v171,v171
 v_fma_f32 v152,v152,v93,v93
 v_fma_f32 v153,v153,v93,v93
 s_add_u32 m0,s35,3072
 s_add_u32 s44,s44,196608
 buffer_load_dwordx4 v10,s[20:23],s44 offen lds
 v_fma_f32 v154,v154,v93,v93
 v_fma_f32 v155,v155,v93,v93
 v_fma_f32 v156,v156,v93,v93
 v_fma_f32 v157,v157,v93,v93
 v_fma_f32 v158,v158,v93,v93
 v_fma_f32 v159,v159,v93,v93
 v_fma_f32 v160,v160,v93,v93
 v_fma_f32 v161,v161,v93,v93
 v_fma_f32 v162,v162,v93,v93
 v_fma_f32 v163,v163,v93,v93
 v_fma_f32 v164,v164,v93,v93
 v_fma_f32 v165,v165,v93,v93
 v_fma_f32 v166,v166,v93,v93
 v_fma_f32 v167,v167,v93,v93
 v_fma_f32 v168,v168,v93,v93
 v_fma_f32 v169,v169,v93,v93
 buffer_store_dwordx2 v[200:201],v253,s[28:31],s57 offen sc1
 v_fma_f32 v170,v170,v93,v93
 v_fma_f32 v171,v171,v93,v93
 s_waitcnt vmcnt(18)
 s_barrier
 s_cmp_lg_u32 s32,0
 s_cbranch_scc1 Lf16
 v_mov_b32 v14,s51
 s_mov_b64 exec,1
 s_add_u32 s91,s62,6144
 buffer_store_dword v14,off,s[92:95],s91 sc1
 s_mov_b64 exec,-1
Lf16:
 buffer_load_dwordx4 v11,s[20:23],s44 offen offset:1024 lds
 ds_read_b64_tr_b16 v[16:17],v6
 ds_read_b64_tr_b16 v[18:19],v6 offset:6144
 ds_read_b64_tr_b16 v[20:21],v6 offset:12288
 ds_read_b64_tr_b16 v[22:23],v6 offset:18432
 ds_read_b64_tr_b16 v[24:25],v6 offset:8
 ds_read_b64_tr_b16 v[26:27],v6 offset:6152
 ds_read_b64_tr_b16 v[28:29],v6 offset:12296
 ds_read_b64_tr_b16 v[30:31],v6 offset:18440
 ds_read_b64_tr_b16 v[32:33],v7
 ds_read_b64_tr_b16 v[34:35],v7 offset:6144
 ds_read_b64_tr_b16 v[36:37],v7 offset:12288
 ds_read_b64_tr_b16 v[38:39],v7 offset:18432
 v_rcp_f32 v152,v152
 v_rcp_f32 v153,v153
 buffer_load_dwordx4 v12,s[20:23],s44 offen offset:2048 lds
 v_rcp_f32 v154,v154
 v_rcp_f32 v155,v155
 v_rcp_f32 v156,v156
 v_rcp_f32 v157,v157
 v_rcp_f32 v158,v158
 v_rcp_f32 v159,v159
 v_rcp_f32 v160,v160
 v_rcp_f32 v161,v161
 v_rcp_f32 v162,v162
 v_rcp_f32 v163,v163
 v_rcp_f32 v164,v164
 v_rcp_f32 v165,v165
 v_rcp_f32 v166,v166
 v_rcp_f32 v167,v167
 v_rcp_f32 v168,v168
 v_rcp_f32 v169,v169
 v_rcp_f32 v170,v170
 v_rcp_f32 v171,v171
 v_mul_f32 v232,v232,v152
 v_mul_f32 v233,v233,v153
 v_mul_f32 v234,v234,v154
 v_mul_f32 v235,v235,v155
 v_mul_f32 v236,v236,v156
 v_mul_f32 v237,v237,v157
 v_mul_f32 v238,v238,v158
 v_mul_f32 v239,v239,v159
 v_mul_f32 v240,v240,v160
 v_mul_f32 v241,v241,v161
 v_mul_f32 v242,v242,v162
 v_mul_f32 v243,v243,v163
 v_mul_f32 v244,v244,v164
 v_mul_f32 v245,v245,v165
 v_mul_f32 v246,v246,v166
 v_mul_f32 v247,v247,v167
 v_mul_f32 v248,v248,v168
 v_mul_f32 v249,v249,v169
 v_mul_f32 v250,v250,v170
 v_mul_f32 v251,v251,v171
 v_cvt_pk_bf16_f32 v202,v232,v233
 v_cvt_pk_bf16_f32 v203,v234,v235
 v_cvt_pk_bf16_f32 v204,v236,v237
 v_cvt_pk_bf16_f32 v205,v238,v239
 v_cvt_pk_bf16_f32 v206,v240,v241
 v_cvt_pk_bf16_f32 v207,v242,v243
 v_cvt_pk_bf16_f32 v208,v244,v245
 v_cvt_pk_bf16_f32 v209,v246,v247
 v_cvt_pk_bf16_f32 v210,v248,v249
 v_cvt_pk_bf16_f32 v211,v250,v251
 v_cndmask_b32 v202,0,v202,s[58:59]
 v_cndmask_b32 v203,0,v203,s[58:59]
 v_cndmask_b32 v204,0,v204,s[58:59]
 v_cndmask_b32 v205,0,v205,s[58:59]
 v_cndmask_b32 v206,0,v206,s[58:59]
 v_cndmask_b32 v207,0,v207,s[58:59]
 v_cndmask_b32 v208,0,v208,s[58:59]
 v_cndmask_b32 v209,0,v209,s[58:59]
 v_cndmask_b32 v210,0,v210,s[58:59]
 v_cndmask_b32 v211,0,v211,s[58:59]
 buffer_store_dwordx4 v[202:205],v254,s[28:31],s56 offen sc1
 s_waitcnt lgkmcnt(0)
 v_mfma_f32_16x16x32_bf16 v[64:67],v[16:19],a[0:3],0
 ds_read_b64_tr_b16 v[40:41],v7 offset:8
 ds_read_b64_tr_b16 v[42:43],v7 offset:6152
 v_mfma_f32_16x16x32_bf16 v[64:67],v[20:23],a[16:19],v[64:67]
 v_mfma_f32_16x16x32_bf16 v[68:71],v[20:23],a[20:23],0
 ds_read_b64_tr_b16 v[44:45],v7 offset:12296
 ds_read_b64_tr_b16 v[46:47],v7 offset:18440
 v_mfma_f32_16x16x32_bf16 v[68:71],v[16:19],a[4:7],v[68:71]
 v_mfma_f32_16x16x32_bf16 v[72:75],v[16:19],a[8:11],0
 ds_read_b64_tr_b16 v[48:49],v6 offset:128
 ds_read_b64_tr_b16 v[50:51],v6 offset:6272
 v_mfma_f32_16x16x32_bf16 v[72:75],v[20:23],a[24:27],v[72:75]
 v_mfma_f32_16x16x32_bf16 v[76:79],v[20:23],a[28:31],0
 ds_read_b64_tr_b16 v[52:53],v6 offset:12416
 ds_read_b64_tr_b16 v[54:55],v6 offset:18560
 v_mfma_f32_16x16x32_bf16 v[76:79],v[16:19],a[12:15],v[76:79]
 buffer_store_dwordx4 v[206:209],v254,s[28:31],s56 offen offset:1024 sc1
 v_mfma_f32_16x16x32_bf16 v[80:83],v[24:27],a[0:3],0
 ds_read_b64_tr_b16 v[56:57],v6 offset:136
 ds_read_b64_tr_b16 v[58:59],v6 offset:6280
 v_mfma_f32_16x16x32_bf16 v[80:83],v[28:31],a[16:19],v[80:83]
 v_mfma_f32_16x16x32_bf16 v[84:87],v[28:31],a[20:23],0
 ds_read_b64_tr_b16 v[60:61],v6 offset:12424
 ds_read_b64_tr_b16 v[62:63],v6 offset:18568
 v_mfma_f32_16x16x32_bf16 v[84:87],v[24:27],a[4:7],v[84:87]
 v_mfma_f32_16x16x32_bf16 v[88:91],v[24:27],a[8:11],0
 s_waitcnt vmcnt(28)
 ds_read_b128 a[32:35],v1
 ds_read_b128 a[48:51],v2
 v_mfma_f32_16x16x32_bf16 v[88:91],v[28:31],a[24:27],v[88:91]
 v_mfma_f32_16x16x32_bf16 v[92:95],v[28:31],a[28:31],0
 ds_read_b128 a[36:39],v1 offset:2048
 ds_read_b128 a[52:55],v2 offset:2048
 v_mfma_f32_16x16x32_bf16 v[92:95],v[24:27],a[12:15],v[92:95]
 v_mfma_f32_16x16x32_bf16 v[96:99],v[32:35],a[0:3],0
 ds_read_b128 a[40:43],v1 offset:4096
 ds_read_b128 a[56:59],v2 offset:4096
 v_mfma_f32_16x16x32_bf16 v[96:99],v[36:39],a[16:19],v[96:99]
 v_mfma_f32_16x16x32_bf16 v[100:103],v[36:39],a[20:23],0
 ds_read_b128 a[44:47],v1 offset:6144
 ds_read_b128 a[60:63],v2 offset:6144
 v_mfma_f32_16x16x32_bf16 v[100:103],v[32:35],a[4:7],v[100:103]
 v_mfma_f32_16x16x32_bf16 v[104:107],v[32:35],a[8:11],0
 v_mfma_f32_16x16x32_bf16 v[104:107],v[36:39],a[24:27],v[104:107]
 v_mfma_f32_16x16x32_bf16 v[108:111],v[36:39],a[28:31],0
 buffer_store_dwordx2 v[210:211],v255,s[28:31],s57 offen sc1
 v_mfma_f32_16x16x32_bf16 v[108:111],v[32:35],a[12:15],v[108:111]
 s_waitcnt lgkmcnt(0)
 v_mfma_f32_16x16x32_bf16 v[112:115],v[40:43],a[0:3],0
 ds_read_b64_tr_b16 v[16:17],v7 offset:128
 ds_read_b64_tr_b16 v[18:19],v7 offset:6272
 v_mfma_f32_16x16x32_bf16 v[112:115],v[44:47],a[16:19],v[112:115]
 s_add_u32 m0,s46,0
 s_lshl_b32 s45,s61,7
 buffer_load_dwordx4 v8,s[24:27],s45 offen lds
 v_mfma_f32_16x16x32_bf16 v[116:119],v[44:47],a[20:23],0
 s_add_u32 s45,s45,10240
 ds_read_b64_tr_b16 v[20:21],v7 offset:12416
 ds_read_b64_tr_b16 v[22:23],v7 offset:18560
 v_mfma_f32_16x16x32_bf16 v[116:119],v[40:43],a[4:7],v[116:119]
 s_add_u32 m0,s46,1024
 s_add_u32 s61,s61,1
 buffer_load_dwordx4 v8,s[24:27],s45 offen lds
 v_mfma_f32_16x16x32_bf16 v[120:123],v[40:43],a[8:11],0
 s_add_u32 s45,s45,10240
 ds_read_b64_tr_b16 v[24:25],v7 offset:136
 ds_read_b64_tr_b16 v[26:27],v7 offset:6280
 v_mfma_f32_16x16x32_bf16 v[120:123],v[44:47],a[24:27],v[120:123]
 s_cmp_eq_u32 s61,10
 s_cselect_b32 s61,0,s61
 s_add_u32 m0,s46,2048
 s_nop 0
 buffer_load_dwordx4 v8,s[24:27],s45 offen lds
 v_mfma_f32_16x16x32_bf16 v[124:127],v[44:47],a[28:31],0
 ds_read_b64_tr_b16 v[28:29],v7 offset:12424
 ds_read_b64_tr_b16 v[30:31],v7 offset:18568
 v_mfma_f32_16x16x32_bf16 v[124:127],v[40:43],a[12:15],v[124:127]
 v_mfma_f32_16x16x32_bf16 v[128:131],v[48:51],a[0:3],0
 ds_read_b64_tr_b16 v[32:33],v6 offset:256
 ds_read_b64_tr_b16 v[34:35],v6 offset:6400
 v_mfma_f32_16x16x32_bf16 v[128:131],v[52:55],a[16:19],v[128:131]
 s_add_u32 m0,s46,3072
 s_add_u32 s45,s45,10240
 buffer_load_dwordx4 v8,s[24:27],s45 offen lds
 v_mfma_f32_16x16x32_bf16 v[132:135],v[52:55],a[20:23],0
 ds_read_b64_tr_b16 v[36:37],v6 offset:12544
 ds_read_b64_tr_b16 v[38:39],v6 offset:18688
 v_mfma_f32_16x16x32_bf16 v[132:135],v[48:51],a[4:7],v[132:135]
 v_mfma_f32_16x16x32_bf16 v[136:139],v[48:51],a[8:11],0
 s_add_u32 m0,s46,4096
 s_add_u32 s45,s45,10240
 buffer_load_dwordx4 v8,s[24:27],s45 offen lds
 v_mfma_f32_16x16x32_bf16 v[136:139],v[52:55],a[24:27],v[136:139]
 v_mfma_f32_16x16x32_bf16 v[140:143],v[52:55],a[28:31],0
 v_mfma_f32_16x16x32_bf16 v[140:143],v[48:51],a[12:15],v[140:143]
 v_mfma_f32_16x16x32_bf16 v[144:147],v[56:59],a[0:3],0
 v_mfma_f32_16x16x32_bf16 v[144:147],v[60:63],a[16:19],v[144:147]
 s_add_u32 m0,s46,5120
 s_add_u32 s45,s45,10240
 buffer_load_dwordx4 v8,s[24:27],s45 offen lds
 v_mfma_f32_16x16x32_bf16 v[148:151],v[60:63],a[20:23],0
 v_mfma_f32_16x16x32_bf16 v[148:151],v[56:59],a[4:7],v[148:151]
 v_mfma_f32_16x16x32_bf16 v[152:155],v[56:59],a[8:11],0
 v_mfma_f32_16x16x32_bf16 v[152:155],v[60:63],a[24:27],v[152:155]
 v_mfma_f32_16x16x32_bf16 v[156:159],v[60:63],a[28:31],0
 s_add_u32 m0,s46,6144
 s_add_u32 s45,s45,10240
 buffer_load_dwordx4 v8,s[24:27],s45 offen lds
 v_mfma_f32_16x16x32_bf16 v[156:159],v[56:59],a[12:15],v[156:159]
 s_waitcnt lgkmcnt(0)
 v_mfma_f32_16x16x32_bf16 v[160:163],v[16:19],a[0:3],0
 ds_read_b64_tr_b16 v[40:41],v6 offset:264
 ds_read_b64_tr_b16 v[42:43],v6 offset:6408
 v_mfma_f32_16x16x32_bf16 v[160:163],v[20:23],a[16:19],v[160:163]
 v_mfma_f32_16x16x32_bf16 v[164:167],v[20:23],a[20:23],0
 ds_read_b64_tr_b16 v[44:45],v6 offset:12552
 ds_read_b64_tr_b16 v[46:47],v6 offset:18696
 v_mfma_f32_16x16x32_bf16 v[164:167],v[16:19],a[4:7],v[164:167]
 s_add_u32 m0,s46,7168
 s_add_u32 s45,s45,10240
 buffer_load_dwordx4 v8,s[24:27],s45 offen lds
 v_mfma_f32_16x16x32_bf16 v[168:171],v[16:19],a[8:11],0
 ds_read_b64_tr_b16 v[48:49],v7 offset:256
 ds_read_b64_tr_b16 v[50:51],v7 offset:6400
 v_mfma_f32_16x16x32_bf16 v[168:171],v[20:23],a[24:27],v[168:171]
 v_mfma_f32_16x16x32_bf16 v[172:175],v[20:23],a[28:31],0
 ds_read_b64_tr_b16 v[52:53],v7 offset:12544
 ds_read_b64_tr_b16 v[54:55],v7 offset:18688
 v_mfma_f32_16x16x32_bf16 v[172:175],v[16:19],a[12:15],v[172:175]
 v_mfma_f32_16x16x32_bf16 v[176:179],v[24:27],a[0:3],0
 ds_read_b64_tr_b16 v[56:57],v7 offset:264
 ds_read_b64_tr_b16 v[58:59],v7 offset:6408
 v_mfma_f32_16x16x32_bf16 v[176:179],v[28:31],a[16:19],v[176:179]
 v_mfma_f32_16x16x32_bf16 v[180:183],v[28:31],a[20:23],0
 ds_read_b64_tr_b16 v[60:61],v7 offset:12552
 ds_read_b64_tr_b16 v[62:63],v7 offset:18696
 v_mfma_f32_16x16x32_bf16 v[180:183],v[24:27],a[4:7],v[180:183]
 v_mfma_f32_16x16x32_bf16 v[184:187],v[24:27],a[8:11],0
 v_mfma_f32_16x16x32_bf16 v[184:187],v[28:31],a[24:27],v[184:187]
 v_mfma_f32_16x16x32_bf16 v[188:191],v[28:31],a[28:31],0
 v_mfma_f32_16x16x32_bf16 v[188:191],v[24:27],a[12:15],v[188:191]
 v_mfma_f32_16x16x32_bf16 v[192:195],v[32:35],a[0:3],0
 v_mfma_f32_16x16x32_bf16 v[192:195],v[36:39],a[16:19],v[192:195]
 v_mfma_f32_16x16x32_bf16 v[196:199],v[36:39],a[20:23],0
 v_mfma_f32_16x16x32_bf16 v[196:199],v[32:35],a[4:7],v[196:199]
 v_mfma_f32_16x16x32_bf16 v[200:203],v[32:35],a[8:11],0
 s_mov_b32 s50,24576
 v_add_u32 v6,s50,v6
 v_add_u32 v7,s50,v7
 v_mfma_f32_16x16x32_bf16 v[200:203],v[36:39],a[24:27],v[200:203]
 v_mfma_f32_16x16x32_bf16 v[204:207],v[36:39],a[28:31],0
 v_mfma_f32_16x16x32_bf16 v[204:207],v[32:35],a[12:15],v[204:207]
 s_waitcnt vmcnt(36) lgkmcnt(0)
 s_barrier
 v_mfma_f32_16x16x32_bf16 v[208:211],v[40:43],a[0:3],0
 ds_read_b64_tr_b16 v[16:17],v6
 ds_read_b64_tr_b16 v[18:19],v6 offset:6144
 v_mfma_f32_16x16x32_bf16 v[208:211],v[44:47],a[16:19],v[208:211]
 s_add_u32 m0,s35,24576
 s_mul_i32 s44,s63,786432
 buffer_load_dwordx4 v10,s[20:23],s44 offen lds
 v_mfma_f32_16x16x32_bf16 v[212:215],v[44:47],a[20:23],0
 s_add_u32 s63,s63,1
 ds_read_b64_tr_b16 v[20:21],v6 offset:12288
 ds_read_b64_tr_b16 v[22:23],v6 offset:18432
 v_mfma_f32_16x16x32_bf16 v[212:215],v[40:43],a[4:7],v[212:215]
 buffer_load_dwordx4 v11,s[20:23],s44 offen offset:1024 lds
 s_cmp_eq_u32 s63,10
 s_cselect_b32 s63,0,s63
 buffer_load_dwordx4 v12,s[20:23],s44 offen offset:2048 lds
 v_mfma_f32_16x16x32_bf16 v[216:219],v[40:43],a[8:11],0
 ds_read_b64_tr_b16 v[24:25],v6 offset:8
 ds_read_b64_tr_b16 v[26:27],v6 offset:6152
 v_mfma_f32_16x16x32_bf16 v[216:219],v[44:47],a[24:27],v[216:219]
 s_add_u32 m0,s35,27648
 s_add_u32 s44,s44,196608
 buffer_load_dwordx4 v10,s[20:23],s44 offen lds
 v_mfma_f32_16x16x32_bf16 v[220:223],v[44:47],a[28:31],0
 ds_read_b64_tr_b16 v[28:29],v6 offset:12296
 ds_read_b64_tr_b16 v[30:31],v6 offset:18440
 v_mfma_f32_16x16x32_bf16 v[220:223],v[40:43],a[12:15],v[220:223]
 v_mfma_f32_16x16x32_bf16 v[224:227],v[48:51],a[0:3],0
 ds_read_b64_tr_b16 v[32:33],v7
 ds_read_b64_tr_b16 v[34:35],v7 offset:6144
 v_mfma_f32_16x16x32_bf16 v[224:227],v[52:55],a[16:19],v[224:227]
 buffer_load_dwordx4 v11,s[20:23],s44 offen offset:1024 lds
 v_mfma_f32_16x16x32_bf16 v[228:231],v[52:55],a[20:23],0
 ds_read_b64_tr_b16 v[36:37],v7 offset:12288
 ds_read_b64_tr_b16 v[38:39],v7 offset:18432
 v_mfma_f32_16x16x32_bf16 v[228:231],v[48:51],a[4:7],v[228:231]
 v_mfma_f32_16x16x32_bf16 v[232:235],v[48:51],a[8:11],0
 s_waitcnt vmcnt(28)
 ds_read_b128 a[64:67],v1 offset:32768
 ds_read_b128 a[80:83],v2 offset:32768
 v_mfma_f32_16x16x32_bf16 v[232:235],v[52:55],a[24:27],v[232:235]
 buffer_load_dwordx4 v12,s[20:23],s44 offen offset:2048 lds
 v_mfma_f32_16x16x32_bf16 v[236:239],v[52:55],a[28:31],0
 ds_read_b128 a[68:71],v1 offset:34816
 ds_read_b128 a[84:87],v2 offset:34816
 v_mfma_f32_16x16x32_bf16 v[236:239],v[48:51],a[12:15],v[236:239]
 v_mfma_f32_16x16x32_bf16 v[240:243],v[56:59],a[0:3],0
 ds_read_b128 a[72:75],v1 offset:36864
 ds_read_b128 a[88:91],v2 offset:36864
 v_mfma_f32_16x16x32_bf16 v[240:243],v[60:63],a[16:19],v[240:243]
 v_mfma_f32_16x16x32_bf16 v[244:247],v[60:63],a[20:23],0
 ds_read_b128 a[76:79],v1 offset:38912
 ds_read_b128 a[92:95],v2 offset:38912
 v_mfma_f32_16x16x32_bf16 v[244:247],v[56:59],a[4:7],v[244:247]
 v_mfma_f32_16x16x32_bf16 v[248:251],v[56:59],a[8:11],0
 v_mfma_f32_16x16x32_bf16 v[248:251],v[60:63],a[24:27],v[248:251]
 v_mfma_f32_16x16x32_bf16 v[252:255],v[60:63],a[28:31],0
 v_mfma_f32_16x16x32_bf16 v[252:255],v[56:59],a[12:15],v[252:255]
 s_waitcnt lgkmcnt(0)
 v_mfma_f32_16x16x32_bf16 v[64:67],v[16:19],a[32:35],v[64:67]
 s_add_u32 m0,s46,32768
 s_lshl_b32 s45,s61,7
 buffer_load_dwordx4 v8,s[24:27],s45 offen lds
 s_add_u32 s45,s45,10240
 s_add_u32 m0,s46,33792
 s_add_u32 s61,s61,1
 buffer_load_dwordx4 v8,s[24:27],s45 offen lds
 ds_read_b64_tr_b16 v[40:41],v7 offset:8
 ds_read_b64_tr_b16 v[42:43],v7 offset:6152
 v_mfma_f32_16x16x32_bf16 v[64:67],v[20:23],a[48:51],v[64:67]
 s_mul_i32 s41,s33,786432
 s_add_u32 s41,s41,s35
 v_mfma_f32_16x16x32_bf16 v[68:71],v[20:23],a[52:55],v[68:71]
 s_add_u32 s45,s45,10240
 ds_read_b64_tr_b16 v[44:45],v7 offset:12296
 ds_read_b64_tr_b16 v[46:47],v7 offset:18440
 v_mfma_f32_16x16x32_bf16 v[68:71],v[16:19],a[36:39],v[68:71]
 s_cmp_eq_u32 s61,10
 s_cselect_b32 s61,0,s61
 s_add_u32 m0,s46,34816
 s_nop 0
 buffer_load_dwordx4 v8,s[24:27],s45 offen lds
 s_add_u32 s12,s66,s41
 s_addc_u32 s13,s67,0
 v_mfma_f32_16x16x32_bf16 v[72:75],v[16:19],a[40:43],v[72:75]
 ds_read_b64_tr_b16 v[48:49],v6 offset:128
 ds_read_b64_tr_b16 v[50:51],v6 offset:6272
 v_mfma_f32_16x16x32_bf16 v[72:75],v[20:23],a[56:59],v[72:75]
 s_sub_u32 s14,786432,s35
 s_mov_b32 s15,0x20000
 v_mfma_f32_16x16x32_bf16 v[76:79],v[20:23],a[60:63],v[76:79]
 ds_read_b64_tr_b16 v[52:53],v6 offset:12416
 ds_read_b64_tr_b16 v[54:55],v6 offset:18560
 v_mfma_f32_16x16x32_bf16 v[76:79],v[16:19],a[44:47],v[76:79]
 s_add_u32 s16,s68,s41
 s_addc_u32 s17,s69,0
 v_mfma_f32_16x16x32_bf16 v[80:83],v[24:27],a[32:35],v[80:83]
 ds_read_b64_tr_b16 v[56:57],v6 offset:136
 ds_read_b64_tr_b16 v[58:59],v6 offset:6280
 v_mfma_f32_16x16x32_bf16 v[80:83],v[28:31],a[48:51],v[80:83]
 s_sub_u32 s18,786432,s35
 s_mov_b32 s19,0x20000
 v_mfma_f32_16x16x32_bf16 v[84:87],v[28:31],a[52:55],v[84:87]
 ds_read_b64_tr_b16 v[60:61],v6 offset:12424
 ds_read_b64_tr_b16 v[62:63],v6 offset:18568
 v_mfma_f32_16x16x32_bf16 v[84:87],v[24:27],a[36:39],v[84:87]
 s_add_u32 m0,s46,35840
 s_add_u32 s45,s45,10240
 buffer_load_dwordx4 v8,s[24:27],s45 offen lds
 v_mfma_f32_16x16x32_bf16 v[88:91],v[24:27],a[40:43],v[88:91]
 s_add_u32 m0,s46,36864
 s_add_u32 s45,s45,10240
 buffer_load_dwordx4 v8,s[24:27],s45 offen lds
 v_mfma_f32_16x16x32_bf16 v[88:91],v[28:31],a[56:59],v[88:91]
 v_mfma_f32_16x16x32_bf16 v[92:95],v[28:31],a[60:63],v[92:95]
 v_mfma_f32_16x16x32_bf16 v[92:95],v[24:27],a[44:47],v[92:95]
 v_mfma_f32_16x16x32_bf16 v[96:99],v[32:35],a[32:35],v[96:99]
 v_mfma_f32_16x16x32_bf16 v[96:99],v[36:39],a[48:51],v[96:99]
 s_add_u32 m0,s46,37888
 s_add_u32 s45,s45,10240
 buffer_load_dwordx4 v8,s[24:27],s45 offen lds
 v_mfma_f32_16x16x32_bf16 v[100:103],v[36:39],a[52:55],v[100:103]
 v_mfma_f32_16x16x32_bf16 v[100:103],v[32:35],a[36:39],v[100:103]
 v_mfma_f32_16x16x32_bf16 v[104:107],v[32:35],a[40:43],v[104:107]
 v_mfma_f32_16x16x32_bf16 v[104:107],v[36:39],a[56:59],v[104:107]
 s_add_u32 m0,s46,38912
 s_add_u32 s45,s45,10240
 buffer_load_dwordx4 v8,s[24:27],s45 offen lds
 v_mfma_f32_16x16x32_bf16 v[108:111],v[36:39],a[60:63],v[108:111]
 v_mfma_f32_16x16x32_bf16 v[108:111],v[32:35],a[44:47],v[108:111]
 s_waitcnt lgkmcnt(0)
 v_mfma_f32_16x16x32_bf16 v[112:115],v[40:43],a[32:35],v[112:115]
 ds_read_b64_tr_b16 v[16:17],v7 offset:128
 ds_read_b64_tr_b16 v[18:19],v7 offset:6272
 v_mfma_f32_16x16x32_bf16 v[112:115],v[44:47],a[48:51],v[112:115]
 v_mfma_f32_16x16x32_bf16 v[116:119],v[44:47],a[52:55],v[116:119]
 ds_read_b64_tr_b16 v[20:21],v7 offset:12416
 ds_read_b64_tr_b16 v[22:23],v7 offset:18560
 v_mfma_f32_16x16x32_bf16 v[116:119],v[40:43],a[36:39],v[116:119]
 s_add_u32 m0,s46,39936
 s_add_u32 s45,s45,10240
 buffer_load_dwordx4 v8,s[24:27],s45 offen lds
 v_mfma_f32_16x16x32_bf16 v[120:123],v[40:43],a[40:43],v[120:123]
 ds_read_b64_tr_b16 v[24:25],v7 offset:136
 ds_read_b64_tr_b16 v[26:27],v7 offset:6280
 v_mfma_f32_16x16x32_bf16 v[120:123],v[44:47],a[56:59],v[120:123]
 v_mfma_f32_16x16x32_bf16 v[124:127],v[44:47],a[60:63],v[124:127]
 ds_read_b64_tr_b16 v[28:29],v7 offset:12424
 ds_read_b64_tr_b16 v[30:31],v7 offset:18568
 v_mfma_f32_16x16x32_bf16 v[124:127],v[40:43],a[44:47],v[124:127]
 v_mfma_f32_16x16x32_bf16 v[128:131],v[48:51],a[32:35],v[128:131]
 ds_read_b64_tr_b16 v[32:33],v6 offset:256
 ds_read_b64_tr_b16 v[34:35],v6 offset:6400
 v_mfma_f32_16x16x32_bf16 v[128:131],v[52:55],a[48:51],v[128:131]
 v_mfma_f32_16x16x32_bf16 v[132:135],v[52:55],a[52:55],v[132:135]
 ds_read_b64_tr_b16 v[36:37],v6 offset:12544
 ds_read_b64_tr_b16 v[38:39],v6 offset:18688
 v_mfma_f32_16x16x32_bf16 v[132:135],v[48:51],a[36:39],v[132:135]
 v_mfma_f32_16x16x32_bf16 v[136:139],v[48:51],a[40:43],v[136:139]
 v_mfma_f32_16x16x32_bf16 v[136:139],v[52:55],a[56:59],v[136:139]
 v_mfma_f32_16x16x32_bf16 v[140:143],v[52:55],a[60:63],v[140:143]
 v_mfma_f32_16x16x32_bf16 v[140:143],v[48:51],a[44:47],v[140:143]
 v_mfma_f32_16x16x32_bf16 v[144:147],v[56:59],a[32:35],v[144:147]
 v_mfma_f32_16x16x32_bf16 v[144:147],v[60:63],a[48:51],v[144:147]
 v_mfma_f32_16x16x32_bf16 v[148:151],v[60:63],a[52:55],v[148:151]
 v_mfma_f32_16x16x32_bf16 v[148:151],v[56:59],a[36:39],v[148:151]
 v_mfma_f32_16x16x32_bf16 v[152:155],v[56:59],a[40:43],v[152:155]
 v_mfma_f32_16x16x32_bf16 v[152:155],v[60:63],a[56:59],v[152:155]
 v_mfma_f32_16x16x32_bf16 v[156:159],v[60:63],a[60:63],v[156:159]
 v_mfma_f32_16x16x32_bf16 v[156:159],v[56:59],a[44:47],v[156:159]
 s_waitcnt lgkmcnt(0)
 v_mfma_f32_16x16x32_bf16 v[160:163],v[16:19],a[32:35],v[160:163]
 ds_read_b64_tr_b16 v[40:41],v6 offset:264
 ds_read_b64_tr_b16 v[42:43],v6 offset:6408
 v_mfma_f32_16x16x32_bf16 v[160:163],v[20:23],a[48:51],v[160:163]
 v_mfma_f32_16x16x32_bf16 v[164:167],v[20:23],a[52:55],v[164:167]
 ds_read_b64_tr_b16 v[44:45],v6 offset:12552
 ds_read_b64_tr_b16 v[46:47],v6 offset:18696
 v_mfma_f32_16x16x32_bf16 v[164:167],v[16:19],a[36:39],v[164:167]
 v_mfma_f32_16x16x32_bf16 v[168:171],v[16:19],a[40:43],v[168:171]
 ds_read_b64_tr_b16 v[48:49],v7 offset:256
 ds_read_b64_tr_b16 v[50:51],v7 offset:6400
 v_mfma_f32_16x16x32_bf16 v[168:171],v[20:23],a[56:59],v[168:171]
 v_mfma_f32_16x16x32_bf16 v[172:175],v[20:23],a[60:63],v[172:175]
 ds_read_b64_tr_b16 v[52:53],v7 offset:12544
 ds_read_b64_tr_b16 v[54:55],v7 offset:18688
 v_mfma_f32_16x16x32_bf16 v[172:175],v[16:19],a[44:47],v[172:175]
 v_mfma_f32_16x16x32_bf16 v[176:179],v[24:27],a[32:35],v[176:179]
 ds_read_b64_tr_b16 v[56:57],v7 offset:264
 ds_read_b64_tr_b16 v[58:59],v7 offset:6408
 v_mfma_f32_16x16x32_bf16 v[176:179],v[28:31],a[48:51],v[176:179]
 v_mfma_f32_16x16x32_bf16 v[180:183],v[28:31],a[52:55],v[180:183]
 ds_read_b64_tr_b16 v[60:61],v7 offset:12552
 ds_read_b64_tr_b16 v[62:63],v7 offset:18696
 v_mfma_f32_16x16x32_bf16 v[180:183],v[24:27],a[36:39],v[180:183]
 v_mfma_f32_16x16x32_bf16 v[184:187],v[24:27],a[40:43],v[184:187]
 s_waitcnt vmcnt(14)
 ds_read_b128 a[0:3],v1
 ds_read_b128 a[16:19],v2
 v_mfma_f32_16x16x32_bf16 v[184:187],v[28:31],a[56:59],v[184:187]
 v_mfma_f32_16x16x32_bf16 v[188:191],v[28:31],a[60:63],v[188:191]
 ds_read_b128 a[4:7],v1 offset:2048
 ds_read_b128 a[20:23],v2 offset:2048
 v_mfma_f32_16x16x32_bf16 v[188:191],v[24:27],a[44:47],v[188:191]
 v_mfma_f32_16x16x32_bf16 v[192:195],v[32:35],a[32:35],v[192:195]
 ds_read_b128 a[8:11],v1 offset:4096
 ds_read_b128 a[24:27],v2 offset:4096
 v_mfma_f32_16x16x32_bf16 v[192:195],v[36:39],a[48:51],v[192:195]
 v_mfma_f32_16x16x32_bf16 v[196:199],v[36:39],a[52:55],v[196:199]
 ds_read_b128 a[12:15],v1 offset:6144
 ds_read_b128 a[28:31],v2 offset:6144
 v_mfma_f32_16x16x32_bf16 v[196:199],v[32:35],a[36:39],v[196:199]
 v_mfma_f32_16x16x32_bf16 v[200:203],v[32:35],a[40:43],v[200:203]
 s_mov_b32 s50,24576
 v_add_u32 v6,s50,v6
 v_add_u32 v7,s50,v7
 v_mfma_f32_16x16x32_bf16 v[200:203],v[36:39],a[56:59],v[200:203]
 v_mfma_f32_16x16x32_bf16 v[204:207],v[36:39],a[60:63],v[204:207]
 v_mfma_f32_16x16x32_bf16 v[204:207],v[32:35],a[44:47],v[204:207]
 s_waitcnt vmcnt(34) lgkmcnt(0)
 s_barrier
 v_mfma_f32_16x16x32_bf16 v[208:211],v[40:43],a[32:35],v[208:211]
 ds_read_b64_tr_b16 v[16:17],v6
 ds_read_b64_tr_b16 v[18:19],v6 offset:6144
 v_mfma_f32_16x16x32_bf16 v[208:211],v[44:47],a[48:51],v[208:211]
 s_add_u32 m0,s35,49152
 s_mul_i32 s44,s63,786432
 buffer_load_dwordx4 v10,s[20:23],s44 offen lds
 v_mfma_f32_16x16x32_bf16 v[212:215],v[44:47],a[52:55],v[212:215]
 ds_read_b64_tr_b16 v[20:21],v6 offset:12288
 ds_read_b64_tr_b16 v[22:23],v6 offset:18432
 v_mfma_f32_16x16x32_bf16 v[212:215],v[40:43],a[36:39],v[212:215]
 s_add_u32 m0,s46,0
 s_lshl_b32 s45,s61,7
 buffer_load_dwordx4 v8,s[24:27],s45 offen lds
 v_mfma_f32_16x16x32_bf16 v[216:219],v[40:43],a[40:43],v[216:219]
 ds_read_b64_tr_b16 v[24:25],v6 offset:8
 ds_read_b64_tr_b16 v[26:27],v6 offset:6152
 v_mfma_f32_16x16x32_bf16 v[216:219],v[44:47],a[56:59],v[216:219]
 s_add_u32 m0,s35,49152
 s_add_u32 s63,s63,1
 buffer_load_dwordx4 v11,s[20:23],s44 offen offset:1024 lds
 v_mfma_f32_16x16x32_bf16 v[220:223],v[44:47],a[60:63],v[220:223]
 s_add_u32 s45,s45,10240
 ds_read_b64_tr_b16 v[28:29],v6 offset:12296
 ds_read_b64_tr_b16 v[30:31],v6 offset:18440
 v_mfma_f32_16x16x32_bf16 v[220:223],v[40:43],a[44:47],v[220:223]
 s_add_u32 m0,s46,1024
 s_add_u32 s61,s61,1
 buffer_load_dwordx4 v8,s[24:27],s45 offen lds
 v_mfma_f32_16x16x32_bf16 v[224:227],v[48:51],a[32:35],v[224:227]
 s_add_u32 s45,s45,10240
 ds_read_b64_tr_b16 v[32:33],v7
 ds_read_b64_tr_b16 v[34:35],v7 offset:6144
 v_mfma_f32_16x16x32_bf16 v[224:227],v[52:55],a[48:51],v[224:227]
 s_cmp_eq_u32 s61,10
 s_cselect_b32 s61,0,s61
 v_mfma_f32_16x16x32_bf16 v[228:231],v[52:55],a[52:55],v[228:231]
 ds_read_b64_tr_b16 v[36:37],v7 offset:12288
 ds_read_b64_tr_b16 v[38:39],v7 offset:18432
 v_mfma_f32_16x16x32_bf16 v[228:231],v[48:51],a[36:39],v[228:231]
 s_add_u32 m0,s46,2048
 s_nop 0
 buffer_load_dwordx4 v8,s[24:27],s45 offen lds
 v_mfma_f32_16x16x32_bf16 v[232:235],v[48:51],a[40:43],v[232:235]
 v_mfma_f32_16x16x32_bf16 v[232:235],v[52:55],a[56:59],v[232:235]
 v_mfma_f32_16x16x32_bf16 v[236:239],v[52:55],a[60:63],v[236:239]
 v_mfma_f32_16x16x32_bf16 v[236:239],v[48:51],a[44:47],v[236:239]
 s_add_u32 m0,s46,3072
 s_add_u32 s45,s45,10240
 buffer_load_dwordx4 v8,s[24:27],s45 offen lds
 v_mfma_f32_16x16x32_bf16 v[240:243],v[56:59],a[32:35],v[240:243]
 v_mfma_f32_16x16x32_bf16 v[240:243],v[60:63],a[48:51],v[240:243]
 v_mfma_f32_16x16x32_bf16 v[244:247],v[60:63],a[52:55],v[244:247]
 v_mfma_f32_16x16x32_bf16 v[244:247],v[56:59],a[36:39],v[244:247]
 s_add_u32 m0,s46,4096
 s_add_u32 s45,s45,10240
 buffer_load_dwordx4 v8,s[24:27],s45 offen lds
 v_mfma_f32_16x16x32_bf16 v[248:251],v[56:59],a[40:43],v[248:251]
 v_mfma_f32_16x16x32_bf16 v[248:251],v[60:63],a[56:59],v[248:251]
 v_mfma_f32_16x16x32_bf16 v[252:255],v[60:63],a[60:63],v[252:255]
 v_mfma_f32_16x16x32_bf16 v[252:255],v[56:59],a[44:47],v[252:255]
 s_waitcnt lgkmcnt(0)
 v_mfma_f32_16x16x32_bf16 v[64:67],v[16:19],a[64:67],v[64:67]
 ds_read_b64_tr_b16 v[40:41],v7 offset:8
 ds_read_b64_tr_b16 v[42:43],v7 offset:6152
 v_mfma_f32_16x16x32_bf16 v[64:67],v[20:23],a[80:83],v[64:67]
 s_add_u32 m0,s46,5120
 s_add_u32 s45,s45,10240
 buffer_load_dwordx4 v8,s[24:27],s45 offen lds
 s_mul_i32 s41,s74,160
 s_and_b32 s42,s74,1
 s_lshl_b32 s42,s42,5
 v_mfma_f32_16x16x32_bf16 v[68:71],v[20:23],a[84:87],v[68:71]
 ds_read_b64_tr_b16 v[44:45],v7 offset:12296
 ds_read_b64_tr_b16 v[46:47],v7 offset:18440
 v_mfma_f32_16x16x32_bf16 v[68:71],v[16:19],a[68:71],v[68:71]
 s_sub_u32 s41,s41,s42
 s_mul_i32 s42,s32,40960
 s_add_u32 s41,s41,s42
 v_mfma_f32_16x16x32_bf16 v[72:75],v[16:19],a[72:75],v[72:75]
 ds_read_b64_tr_b16 v[48:49],v6 offset:128
 ds_read_b64_tr_b16 v[50:51],v6 offset:6272
 v_mfma_f32_16x16x32_bf16 v[72:75],v[20:23],a[88:91],v[72:75]
 s_add_u32 s4,s78,s41
 s_addc_u32 s5,s79,0
 v_mfma_f32_16x16x32_bf16 v[76:79],v[20:23],a[92:95],v[76:79]
 ds_read_b64_tr_b16 v[52:53],v6 offset:12416
 ds_read_b64_tr_b16 v[54:55],v6 offset:18560
 v_mfma_f32_16x16x32_bf16 v[76:79],v[16:19],a[76:79],v[76:79]
 s_sub_u32 s6,819200,s41
 s_mov_b32 s7,0x20000
 v_mfma_f32_16x16x32_bf16 v[80:83],v[24:27],a[64:67],v[80:83]
 ds_read_b64_tr_b16 v[56:57],v6 offset:136
 ds_read_b64_tr_b16 v[58:59],v6 offset:6280
 v_mfma_f32_16x16x32_bf16 v[80:83],v[28:31],a[80:83],v[80:83]
 s_add_u32 m0,s46,6144
 s_add_u32 s45,s45,10240
 buffer_load_dwordx4 v8,s[24:27],s45 offen lds
 v_mfma_f32_16x16x32_bf16 v[84:87],v[28:31],a[84:87],v[84:87]
 ds_read_b64_tr_b16 v[60:61],v6 offset:12424
 ds_read_b64_tr_b16 v[62:63],v6 offset:18568
 v_mfma_f32_16x16x32_bf16 v[84:87],v[24:27],a[68:71],v[84:87]
 s_add_u32 m0,s46,7168
 s_add_u32 s45,s45,10240
 buffer_load_dwordx4 v8,s[24:27],s45 offen lds
 v_mfma_f32_16x16x32_bf16 v[88:91],v[24:27],a[72:75],v[88:91]
 v_mfma_f32_16x16x32_bf16 v[88:91],v[28:31],a[88:91],v[88:91]
 s_cmp_eq_u32 s63,10
 s_cselect_b32 s63,0,s63
 v_mfma_f32_16x16x32_bf16 v[92:95],v[28:31],a[92:95],v[92:95]
 s_add_u32 m0,s35,49152
 s_nop 0
 buffer_load_dwordx4 v12,s[20:23],s44 offen offset:2048 lds
 v_mfma_f32_16x16x32_bf16 v[92:95],v[24:27],a[76:79],v[92:95]
 v_mfma_f32_16x16x32_bf16 v[96:99],v[32:35],a[64:67],v[96:99]
 v_mfma_f32_16x16x32_bf16 v[96:99],v[36:39],a[80:83],v[96:99]
 v_mfma_f32_16x16x32_bf16 v[100:103],v[36:39],a[84:87],v[100:103]
 s_add_u32 m0,s35,52224
 s_add_u32 s44,s44,196608
 buffer_load_dwordx4 v10,s[20:23],s44 offen lds
 v_mfma_f32_16x16x32_bf16 v[100:103],v[32:35],a[68:71],v[100:103]
 v_mfma_f32_16x16x32_bf16 v[104:107],v[32:35],a[72:75],v[104:107]
 v_mfma_f32_16x16x32_bf16 v[104:107],v[36:39],a[88:91],v[104:107]
 v_mfma_f32_16x16x32_bf16 v[108:111],v[36:39],a[92:95],v[108:111]
 v_mfma_f32_16x16x32_bf16 v[108:111],v[32:35],a[76:79],v[108:111]
 buffer_load_dwordx4 v11,s[20:23],s44 offen offset:1024 lds
 s_waitcnt lgkmcnt(0)
 v_mfma_f32_16x16x32_bf16 v[112:115],v[40:43],a[64:67],v[112:115]
 ds_read_b64_tr_b16 v[16:17],v7 offset:128
 ds_read_b64_tr_b16 v[18:19],v7 offset:6272
 v_mfma_f32_16x16x32_bf16 v[112:115],v[44:47],a[80:83],v[112:115]
 v_mfma_f32_16x16x32_bf16 v[116:119],v[44:47],a[84:87],v[116:119]
 ds_read_b64_tr_b16 v[20:21],v7 offset:12416
 ds_read_b64_tr_b16 v[22:23],v7 offset:18560
 v_mfma_f32_16x16x32_bf16 v[116:119],v[40:43],a[68:71],v[116:119]
 buffer_load_dwordx4 v12,s[20:23],s44 offen offset:2048 lds
 v_mfma_f32_16x16x32_bf16 v[120:123],v[40:43],a[72:75],v[120:123]
 ds_read_b64_tr_b16 v[24:25],v7 offset:136
 ds_read_b64_tr_b16 v[26:27],v7 offset:6280
 v_mfma_f32_16x16x32_bf16 v[120:123],v[44:47],a[88:91],v[120:123]
 v_mfma_f32_16x16x32_bf16 v[124:127],v[44:47],a[92:95],v[124:127]
 ds_read_b64_tr_b16 v[28:29],v7 offset:12424
 ds_read_b64_tr_b16 v[30:31],v7 offset:18568
 v_mfma_f32_16x16x32_bf16 v[124:127],v[40:43],a[76:79],v[124:127]
 v_mfma_f32_16x16x32_bf16 v[128:131],v[48:51],a[64:67],v[128:131]
 ds_read_b64_tr_b16 v[32:33],v6 offset:256
 ds_read_b64_tr_b16 v[34:35],v6 offset:6400
 v_mfma_f32_16x16x32_bf16 v[128:131],v[52:55],a[80:83],v[128:131]
 v_mfma_f32_16x16x32_bf16 v[132:135],v[52:55],a[84:87],v[132:135]
 ds_read_b64_tr_b16 v[36:37],v6 offset:12544
 ds_read_b64_tr_b16 v[38:39],v6 offset:18688
 v_mfma_f32_16x16x32_bf16 v[132:135],v[48:51],a[68:71],v[132:135]
 v_mfma_f32_16x16x32_bf16 v[136:139],v[48:51],a[72:75],v[136:139]
 s_waitcnt vmcnt(14)
 ds_read_b128 a[32:35],v1 offset:32768
 ds_read_b128 a[48:51],v2 offset:32768
 v_mfma_f32_16x16x32_bf16 v[136:139],v[52:55],a[88:91],v[136:139]
 v_mfma_f32_16x16x32_bf16 v[140:143],v[52:55],a[92:95],v[140:143]
 ds_read_b128 a[36:39],v1 offset:34816
 ds_read_b128 a[52:55],v2 offset:34816
 v_mfma_f32_16x16x32_bf16 v[140:143],v[48:51],a[76:79],v[140:143]
 v_mfma_f32_16x16x32_bf16 v[144:147],v[56:59],a[64:67],v[144:147]
 ds_read_b128 a[40:43],v1 offset:36864
 ds_read_b128 a[56:59],v2 offset:36864
 v_mfma_f32_16x16x32_bf16 v[144:147],v[60:63],a[80:83],v[144:147]
 v_mfma_f32_16x16x32_bf16 v[148:151],v[60:63],a[84:87],v[148:151]
 ds_read_b128 a[44:47],v1 offset:38912
 ds_read_b128 a[60:63],v2 offset:38912
 v_mfma_f32_16x16x32_bf16 v[148:151],v[56:59],a[68:71],v[148:151]
 v_mfma_f32_16x16x32_bf16 v[152:155],v[56:59],a[72:75],v[152:155]
 v_mfma_f32_16x16x32_bf16 v[152:155],v[60:63],a[88:91],v[152:155]
 v_mfma_f32_16x16x32_bf16 v[156:159],v[60:63],a[92:95],v[156:159]
 v_mfma_f32_16x16x32_bf16 v[156:159],v[56:59],a[76:79],v[156:159]
 s_waitcnt lgkmcnt(0)
 v_mfma_f32_16x16x32_bf16 v[160:163],v[16:19],a[64:67],v[160:163]
 ds_read_b64_tr_b16 v[40:41],v6 offset:264
 ds_read_b64_tr_b16 v[42:43],v6 offset:6408
 v_mfma_f32_16x16x32_bf16 v[160:163],v[20:23],a[80:83],v[160:163]
 s_add_u32 m0,s46,32768
 s_lshl_b32 s45,s61,7
 buffer_load_dwordx4 v8,s[24:27],s45 offen lds
 v_mfma_f32_16x16x32_bf16 v[164:167],v[20:23],a[84:87],v[164:167]
 s_add_u32 s45,s45,10240
 ds_read_b64_tr_b16 v[44:45],v6 offset:12552
 ds_read_b64_tr_b16 v[46:47],v6 offset:18696
 v_mfma_f32_16x16x32_bf16 v[164:167],v[16:19],a[68:71],v[164:167]
 s_add_u32 m0,s46,33792
 s_add_u32 s61,s61,1
 buffer_load_dwordx4 v8,s[24:27],s45 offen lds
 v_mfma_f32_16x16x32_bf16 v[168:171],v[16:19],a[72:75],v[168:171]
 s_add_u32 s45,s45,10240
 ds_read_b64_tr_b16 v[48:49],v7 offset:256
 ds_read_b64_tr_b16 v[50:51],v7 offset:6400
 v_mfma_f32_16x16x32_bf16 v[168:171],v[20:23],a[88:91],v[168:171]
 s_cmp_eq_u32 s61,10
 s_cselect_b32 s61,0,s61
 s_add_u32 m0,s46,34816
 s_nop 0
 buffer_load_dwordx4 v8,s[24:27],s45 offen lds
 v_mfma_f32_16x16x32_bf16 v[172:175],v[20:23],a[92:95],v[172:175]
 ds_read_b64_tr_b16 v[52:53],v7 offset:12544
 ds_read_b64_tr_b16 v[54:55],v7 offset:18688
 v_mfma_f32_16x16x32_bf16 v[172:175],v[16:19],a[76:79],v[172:175]
 s_add_u32 m0,s46,35840
 s_add_u32 s45,s45,10240
 buffer_load_dwordx4 v8,s[24:27],s45 offen lds
 v_mfma_f32_16x16x32_bf16 v[176:179],v[24:27],a[64:67],v[176:179]
 ds_read_b64_tr_b16 v[56:57],v7 offset:264
 ds_read_b64_tr_b16 v[58:59],v7 offset:6408
 v_mfma_f32_16x16x32_bf16 v[176:179],v[28:31],a[80:83],v[176:179]
 v_mfma_f32_16x16x32_bf16 v[180:183],v[28:31],a[84:87],v[180:183]
 ds_read_b64_tr_b16 v[60:61],v7 offset:12552
 ds_read_b64_tr_b16 v[62:63],v7 offset:18696
 v_mfma_f32_16x16x32_bf16 v[180:183],v[24:27],a[68:71],v[180:183]
 s_add_u32 m0,s46,36864
 s_add_u32 s45,s45,10240
 buffer_load_dwordx4 v8,s[24:27],s45 offen lds
 v_mfma_f32_16x16x32_bf16 v[184:187],v[24:27],a[72:75],v[184:187]
 v_mfma_f32_16x16x32_bf16 v[184:187],v[28:31],a[88:91],v[184:187]
 v_mfma_f32_16x16x32_bf16 v[188:191],v[28:31],a[92:95],v[188:191]
 v_mfma_f32_16x16x32_bf16 v[188:191],v[24:27],a[76:79],v[188:191]
 v_mfma_f32_16x16x32_bf16 v[192:195],v[32:35],a[64:67],v[192:195]
 s_add_u32 m0,s46,37888
 s_add_u32 s45,s45,10240
 buffer_load_dwordx4 v8,s[24:27],s45 offen lds
 v_mfma_f32_16x16x32_bf16 v[192:195],v[36:39],a[80:83],v[192:195]
 v_mfma_f32_16x16x32_bf16 v[196:199],v[36:39],a[84:87],v[196:199]
 v_mfma_f32_16x16x32_bf16 v[196:199],v[32:35],a[68:71],v[196:199]
 v_mfma_f32_16x16x32_bf16 v[200:203],v[32:35],a[72:75],v[200:203]
 s_mov_b32 s50,-73728
 v_add_u32 v6,s50,v6
 v_add_u32 v7,s50,v7
 v_mfma_f32_16x16x32_bf16 v[200:203],v[36:39],a[88:91],v[200:203]
 s_add_u32 m0,s46,38912
 s_add_u32 s45,s45,10240
 buffer_load_dwordx4 v8,s[24:27],s45 offen lds
 v_mfma_f32_16x16x32_bf16 v[204:207],v[36:39],a[92:95],v[204:207]
 v_mfma_f32_16x16x32_bf16 v[204:207],v[32:35],a[76:79],v[204:207]
 s_waitcnt vmcnt(43) lgkmcnt(0)
 s_barrier
 v_mfma_f32_16x16x32_bf16 v[208:211],v[40:43],a[64:67],v[208:211]
 ds_read_b64_tr_b16 v[16:17],v6
 ds_read_b64_tr_b16 v[18:19],v6 offset:6144
 v_mfma_f32_16x16x32_bf16 v[208:211],v[44:47],a[80:83],v[208:211]
 s_add_u32 m0,s46,39936
 s_add_u32 s45,s45,10240
 buffer_load_dwordx4 v8,s[24:27],s45 offen lds
 v_mfma_f32_16x16x32_bf16 v[212:215],v[44:47],a[84:87],v[212:215]
 ds_read_b64_tr_b16 v[20:21],v6 offset:12288
 ds_read_b64_tr_b16 v[22:23],v6 offset:18432
 v_mfma_f32_16x16x32_bf16 v[212:215],v[40:43],a[68:71],v[212:215]
 v_mfma_f32_16x16x32_bf16 v[216:219],v[40:43],a[72:75],v[216:219]
 ds_read_b64_tr_b16 v[24:25],v6 offset:8
 ds_read_b64_tr_b16 v[26:27],v6 offset:6152
 v_mfma_f32_16x16x32_bf16 v[216:219],v[44:47],a[88:91],v[216:219]
 s_add_u32 m0,s35,73728
 s_mul_i32 s44,s63,786432
 buffer_load_dwordx4 v10,s[20:23],s44 offen lds
 v_mfma_f32_16x16x32_bf16 v[220:223],v[44:47],a[92:95],v[220:223]
 ds_read_b64_tr_b16 v[28:29],v6 offset:12296
 ds_read_b64_tr_b16 v[30:31],v6 offset:18440
 v_mfma_f32_16x16x32_bf16 v[220:223],v[40:43],a[76:79],v[220:223]
 v_mfma_f32_16x16x32_bf16 v[224:227],v[48:51],a[64:67],v[224:227]
 s_add_u32 s63,s63,1
 ds_read_b64_tr_b16 v[32:33],v7
 ds_read_b64_tr_b16 v[34:35],v7 offset:6144
 v_mfma_f32_16x16x32_bf16 v[224:227],v[52:55],a[80:83],v[224:227]
 buffer_load_dwordx4 v11,s[20:23],s44 offen offset:1024 lds
 v_mfma_f32_16x16x32_bf16 v[228:231],v[52:55],a[84:87],v[228:231]
 ds_read_b64_tr_b16 v[36:37],v7 offset:12288
 ds_read_b64_tr_b16 v[38:39],v7 offset:18432
 v_mfma_f32_16x16x32_bf16 v[228:231],v[48:51],a[68:71],v[228:231]
 v_mfma_f32_16x16x32_bf16 v[232:235],v[48:51],a[72:75],v[232:235]
 s_cmp_eq_u32 s63,10
 s_cselect_b32 s63,0,s63
 v_mfma_f32_16x16x32_bf16 v[232:235],v[52:55],a[88:91],v[232:235]
 buffer_load_dwordx4 v12,s[20:23],s44 offen offset:2048 lds
 s_cmp_lg_u32 s32,0
 s_cbranch_scc1 Lf17
 v_mov_b32 v14,s51
 s_mov_b64 exec,1
 s_add_u32 s91,s62,1024
 buffer_store_dword v14,off,s[92:95],s91 sc1
 s_mov_b64 exec,-1
Lf17:
 v_mfma_f32_16x16x32_bf16 v[236:239],v[52:55],a[92:95],v[236:239]
 v_mfma_f32_16x16x32_bf16 v[236:239],v[48:51],a[76:79],v[236:239]
 v_mfma_f32_16x16x32_bf16 v[240:243],v[56:59],a[64:67],v[240:243]
 s_add_u32 m0,s35,76800
 s_add_u32 s44,s44,196608
 buffer_load_dwordx4 v10,s[20:23],s44 offen lds
 v_mfma_f32_16x16x32_bf16 v[240:243],v[60:63],a[80:83],v[240:243]
 v_mfma_f32_16x16x32_bf16 v[244:247],v[60:63],a[84:87],v[244:247]
 v_mfma_f32_16x16x32_bf16 v[244:247],v[56:59],a[68:71],v[244:247]
 v_mfma_f32_16x16x32_bf16 v[248:251],v[56:59],a[72:75],v[248:251]
 buffer_load_dwordx4 v11,s[20:23],s44 offen offset:1024 lds
 v_mfma_f32_16x16x32_bf16 v[248:251],v[60:63],a[88:91],v[248:251]
 v_mfma_f32_16x16x32_bf16 v[252:255],v[60:63],a[92:95],v[252:255]
 v_mfma_f32_16x16x32_bf16 v[252:255],v[56:59],a[76:79],v[252:255]
 s_waitcnt lgkmcnt(0)
 v_mfma_f32_16x16x32_bf16 v[64:67],v[16:19],a[0:3],v[64:67]
 ds_read_b64_tr_b16 v[40:41],v7 offset:8
 ds_read_b64_tr_b16 v[42:43],v7 offset:6152
 v_mfma_f32_16x16x32_bf16 v[64:67],v[20:23],a[16:19],v[64:67]
 buffer_load_dwordx4 v12,s[20:23],s44 offen offset:2048 lds
 v_mfma_f32_16x16x32_bf16 v[68:71],v[20:23],a[20:23],v[68:71]
 ds_read_b64_tr_b16 v[44:45],v7 offset:12296
 ds_read_b64_tr_b16 v[46:47],v7 offset:18440
 v_mfma_f32_16x16x32_bf16 v[68:71],v[16:19],a[4:7],v[68:71]
 v_mfma_f32_16x16x32_bf16 v[72:75],v[16:19],a[8:11],v[72:75]
 ds_read_b64_tr_b16 v[48:49],v6 offset:128
 ds_read_b64_tr_b16 v[50:51],v6 offset:6272
 v_mfma_f32_16x16x32_bf16 v[72:75],v[20:23],a[24:27],v[72:75]
 v_mfma_f32_16x16x32_bf16 v[76:79],v[20:23],a[28:31],v[76:79]
 ds_read_b64_tr_b16 v[52:53],v6 offset:12416
 ds_read_b64_tr_b16 v[54:55],v6 offset:18560
 v_mfma_f32_16x16x32_bf16 v[76:79],v[16:19],a[12:15],v[76:79]
 v_mfma_f32_16x16x32_bf16 v[80:83],v[24:27],a[0:3],v[80:83]
 ds_read_b64_tr_b16 v[56:57],v6 offset:136
 ds_read_b64_tr_b16 v[58:59],v6 offset:6280
 v_mfma_f32_16x16x32_bf16 v[80:83],v[28:31],a[16:19],v[80:83]
 v_mfma_f32_16x16x32_bf16 v[84:87],v[28:31],a[20:23],v[84:87]
 ds_read_b64_tr_b16 v[60:61],v6 offset:12424
 ds_read_b64_tr_b16 v[62:63],v6 offset:18568
 v_mfma_f32_16x16x32_bf16 v[84:87],v[24:27],a[4:7],v[84:87]
 v_mfma_f32_16x16x32_bf16 v[88:91],v[24:27],a[8:11],v[88:91]
 s_waitcnt vmcnt(18)
 ds_read_b128 a[64:67],v1
 ds_read_b128 a[80:83],v2
 v_mfma_f32_16x16x32_bf16 v[88:91],v[28:31],a[24:27],v[88:91]
 v_mfma_f32_16x16x32_bf16 v[92:95],v[28:31],a[28:31],v[92:95]
 ds_read_b128 a[68:71],v1 offset:2048
 ds_read_b128 a[84:87],v2 offset:2048
 v_mfma_f32_16x16x32_bf16 v[92:95],v[24:27],a[12:15],v[92:95]
 v_mfma_f32_16x16x32_bf16 v[96:99],v[32:35],a[0:3],v[96:99]
 ds_read_b128 a[72:75],v1 offset:4096
 ds_read_b128 a[88:91],v2 offset:4096
 v_mfma_f32_16x16x32_bf16 v[96:99],v[36:39],a[16:19],v[96:99]
 v_mfma_f32_16x16x32_bf16 v[100:103],v[36:39],a[20:23],v[100:103]
 ds_read_b128 a[76:79],v1 offset:6144
 ds_read_b128 a[92:95],v2 offset:6144
 v_mfma_f32_16x16x32_bf16 v[100:103],v[32:35],a[4:7],v[100:103]
 v_mfma_f32_16x16x32_bf16 v[104:107],v[32:35],a[8:11],v[104:107]
 v_mfma_f32_16x16x32_bf16 v[104:107],v[36:39],a[24:27],v[104:107]
 v_mfma_f32_16x16x32_bf16 v[108:111],v[36:39],a[28:31],v[108:111]
 v_mfma_f32_16x16x32_bf16 v[108:111],v[32:35],a[12:15],v[108:111]
 s_waitcnt lgkmcnt(0)
 v_mfma_f32_16x16x32_bf16 v[112:115],v[40:43],a[0:3],v[112:115]
 ds_read_b64_tr_b16 v[16:17],v7 offset:128
 ds_read_b64_tr_b16 v[18:19],v7 offset:6272
 v_mfma_f32_16x16x32_bf16 v[112:115],v[44:47],a[16:19],v[112:115]
 s_add_u32 m0,s46,0
 s_lshl_b32 s45,s61,7
 buffer_load_dwordx4 v8,s[24:27],s45 offen lds
 v_mfma_f32_16x16x32_bf16 v[116:119],v[44:47],a[20:23],v[116:119]
 s_add_u32 s45,s45,10240
 ds_read_b64_tr_b16 v[20:21],v7 offset:12416
 ds_read_b64_tr_b16 v[22:23],v7 offset:18560
 v_mfma_f32_16x16x32_bf16 v[116:119],v[40:43],a[4:7],v[116:119]
 s_add_u32 m0,s46,1024
 s_add_u32 s61,s61,1
 buffer_load_dwordx4 v8,s[24:27],s45 offen lds
 v_mfma_f32_16x16x32_bf16 v[120:123],v[40:43],a[8:11],v[120:123]
 s_add_u32 s45,s45,10240
 ds_read_b64_tr_b16 v[24:25],v7 offset:136
 ds_read_b64_tr_b16 v[26:27],v7 offset:6280
 v_mfma_f32_16x16x32_bf16 v[120:123],v[44:47],a[24:27],v[120:123]
 s_cmp_eq_u32 s61,10
 s_cselect_b32 s61,0,s61
 s_add_u32 m0,s46,2048
 s_nop 0
 buffer_load_dwordx4 v8,s[24:27],s45 offen lds
 v_mfma_f32_16x16x32_bf16 v[124:127],v[44:47],a[28:31],v[124:127]
 ds_read_b64_tr_b16 v[28:29],v7 offset:12424
 ds_read_b64_tr_b16 v[30:31],v7 offset:18568
 v_mfma_f32_16x16x32_bf16 v[124:127],v[40:43],a[12:15],v[124:127]
 s_add_u32 m0,s46,3072
 s_add_u32 s45,s45,10240
 buffer_load_dwordx4 v8,s[24:27],s45 offen lds
 v_and_b32 v4,1,v0
 v_lshlrev_b32 v4,2,v4
 v_mfma_f32_16x16x32_bf16 v[128:131],v[48:51],a[0:3],v[128:131]
 ds_read_b64_tr_b16 v[32:33],v6 offset:256
 ds_read_b64_tr_b16 v[34:35],v6 offset:6400
 v_mfma_f32_16x16x32_bf16 v[128:131],v[52:55],a[16:19],v[128:131]
 s_lshl_b32 s41,s34,6
 s_lshl_b32 s42,s52,3
 s_add_u32 s41,s41,s42
 v_mfma_f32_16x16x32_bf16 v[132:135],v[52:55],a[20:23],v[132:135]
 ds_read_b64_tr_b16 v[36:37],v6 offset:12544
 ds_read_b64_tr_b16 v[38:39],v6 offset:18688
 v_mfma_f32_16x16x32_bf16 v[132:135],v[48:51],a[4:7],v[132:135]
 s_add_u32 s41,s41,6144
 v_add_u32 v4,s41,v4
 v_lshlrev_b32 v5,8,v0
 v_mfma_f32_16x16x32_bf16 v[136:139],v[48:51],a[8:11],v[136:139]
 s_lshl_b32 s41,s33,2
 s_add_u32 s41,s41,128
 v_add_u32 v5,s41,v5
 v_mfma_f32_16x16x32_bf16 v[136:139],v[52:55],a[24:27],v[136:139]
 v_cmp_gt_u32 vcc,4,v0
 s_nop 1
 v_cndmask_b32 v4,v4,v5,vcc
 v_mfma_f32_16x16x32_bf16 v[140:143],v[52:55],a[28:31],v[140:143]
 buffer_load_dword v5,v4,s[92:95],0 offen sc1
 v_mfma_f32_16x16x32_bf16 v[140:143],v[48:51],a[12:15],v[140:143]
 s_add_u32 m0,s46,4096
 s_add_u32 s45,s45,10240
 buffer_load_dwordx4 v8,s[24:27],s45 offen lds
 v_mfma_f32_16x16x32_bf16 v[144:147],v[56:59],a[0:3],v[144:147]
 s_add_u32 m0,s46,5120
 s_add_u32 s45,s45,10240
 buffer_load_dwordx4 v8,s[24:27],s45 offen lds
 v_mfma_f32_16x16x32_bf16 v[144:147],v[60:63],a[16:19],v[144:147]
 v_mfma_f32_16x16x32_bf16 v[148:151],v[60:63],a[20:23],v[148:151]
 v_mfma_f32_16x16x32_bf16 v[148:151],v[56:59],a[4:7],v[148:151]
 v_mfma_f32_16x16x32_bf16 v[152:155],v[56:59],a[8:11],v[152:155]
 v_mfma_f32_16x16x32_bf16 v[152:155],v[60:63],a[24:27],v[152:155]
 s_add_u32 m0,s46,6144
 s_add_u32 s45,s45,10240
 buffer_load_dwordx4 v8,s[24:27],s45 offen lds
 v_mfma_f32_16x16x32_bf16 v[156:159],v[60:63],a[28:31],v[156:159]
 v_mfma_f32_16x16x32_bf16 v[156:159],v[56:59],a[12:15],v[156:159]
 s_waitcnt lgkmcnt(0)
 v_mfma_f32_16x16x32_bf16 v[160:163],v[16:19],a[0:3],v[160:163]
 ds_read_b64_tr_b16 v[40:41],v6 offset:264
 ds_read_b64_tr_b16 v[42:43],v6 offset:6408
 v_mfma_f32_16x16x32_bf16 v[160:163],v[20:23],a[16:19],v[160:163]
 s_add_u32 m0,s46,7168
 s_add_u32 s45,s45,10240
 buffer_load_dwordx4 v8,s[24:27],s45 offen lds
 v_mfma_f32_16x16x32_bf16 v[164:167],v[20:23],a[20:23],v[164:167]
 ds_read_b64_tr_b16 v[44:45],v6 offset:12552
 ds_read_b64_tr_b16 v[46:47],v6 offset:18696
 v_mfma_f32_16x16x32_bf16 v[164:167],v[16:19],a[4:7],v[164:167]
 v_mfma_f32_16x16x32_bf16 v[168:171],v[16:19],a[8:11],v[168:171]
 ds_read_b64_tr_b16 v[48:49],v7 offset:256
 ds_read_b64_tr_b16 v[50:51],v7 offset:6400
 v_mfma_f32_16x16x32_bf16 v[168:171],v[20:23],a[24:27],v[168:171]
 v_mfma_f32_16x16x32_bf16 v[172:175],v[20:23],a[28:31],v[172:175]
 ds_read_b64_tr_b16 v[52:53],v7 offset:12544
 ds_read_b64_tr_b16 v[54:55],v7 offset:18688
 v_mfma_f32_16x16x32_bf16 v[172:175],v[16:19],a[12:15],v[172:175]
 v_mfma_f32_16x16x32_bf16 v[176:179],v[24:27],a[0:3],v[176:179]
 ds_read_b64_tr_b16 v[56:57],v7 offset:264
 ds_read_b64_tr_b16 v[58:59],v7 offset:6408
 v_mfma_f32_16x16x32_bf16 v[176:179],v[28:31],a[16:19],v[176:179]
 v_mfma_f32_16x16x32_bf16 v[180:183],v[28:31],a[20:23],v[180:183]
 ds_read_b64_tr_b16 v[60:61],v7 offset:12552
 ds_read_b64_tr_b16 v[62:63],v7 offset:18696
 v_mfma_f32_16x16x32_bf16 v[180:183],v[24:27],a[4:7],v[180:183]
 v_mfma_f32_16x16x32_bf16 v[184:187],v[24:27],a[8:11],v[184:187]
 v_mfma_f32_16x16x32_bf16 v[184:187],v[28:31],a[24:27],v[184:187]
 v_mfma_f32_16x16x32_bf16 v[188:191],v[28:31],a[28:31],v[188:191]
 v_mfma_f32_16x16x32_bf16 v[188:191],v[24:27],a[12:15],v[188:191]
 v_mfma_f32_16x16x32_bf16 v[192:195],v[32:35],a[0:3],v[192:195]
 v_mfma_f32_16x16x32_bf16 v[192:195],v[36:39],a[16:19],v[192:195]
 v_mfma_f32_16x16x32_bf16 v[196:199],v[36:39],a[20:23],v[196:199]
 v_mfma_f32_16x16x32_bf16 v[196:199],v[32:35],a[4:7],v[196:199]
 v_mfma_f32_16x16x32_bf16 v[200:203],v[32:35],a[8:11],v[200:203]
 s_mov_b32 s50,24576
 v_add_u32 v6,s50,v6
 v_add_u32 v7,s50,v7
 v_mfma_f32_16x16x32_bf16 v[200:203],v[36:39],a[24:27],v[200:203]
 v_mfma_f32_16x16x32_bf16 v[204:207],v[36:39],a[28:31],v[204:207]
 v_mfma_f32_16x16x32_bf16 v[204:207],v[32:35],a[12:15],v[204:207]
 s_waitcnt vmcnt(45) lgkmcnt(0)
 s_barrier
 v_mfma_f32_16x16x32_bf16 v[208:211],v[40:43],a[0:3],v[208:211]
 ds_read_b64_tr_b16 v[16:17],v6
 ds_read_b64_tr_b16 v[18:19],v6 offset:6144
 v_mfma_f32_16x16x32_bf16 v[208:211],v[44:47],a[16:19],v[208:211]
 s_add_u32 m0,s35,0
 s_mul_i32 s44,s63,786432
 buffer_load_dwordx4 v10,s[20:23],s44 offen lds
 v_mfma_f32_16x16x32_bf16 v[212:215],v[44:47],a[20:23],v[212:215]
 s_add_u32 s63,s63,1
 ds_read_b64_tr_b16 v[20:21],v6 offset:12288
 ds_read_b64_tr_b16 v[22:23],v6 offset:18432
 v_mfma_f32_16x16x32_bf16 v[212:215],v[40:43],a[4:7],v[212:215]
 buffer_load_dwordx4 v11,s[20:23],s44 offen offset:1024 lds
 s_cmp_eq_u32 s63,10
 s_cselect_b32 s63,0,s63
 buffer_load_dwordx4 v12,s[20:23],s44 offen offset:2048 lds
 v_mfma_f32_16x16x32_bf16 v[216:219],v[40:43],a[8:11],v[216:219]
 ds_read_b64_tr_b16 v[24:25],v6 offset:8
 ds_read_b64_tr_b16 v[26:27],v6 offset:6152
 v_mfma_f32_16x16x32_bf16 v[216:219],v[44:47],a[24:27],v[216:219]
 s_add_u32 m0,s35,3072
 s_add_u32 s44,s44,196608
 buffer_load_dwordx4 v10,s[20:23],s44 offen lds
 v_mfma_f32_16x16x32_bf16 v[220:223],v[44:47],a[28:31],v[220:223]
 ds_read_b64_tr_b16 v[28:29],v6 offset:12296
 ds_read_b64_tr_b16 v[30:31],v6 offset:18440
 v_mfma_f32_16x16x32_bf16 v[220:223],v[40:43],a[12:15],v[220:223]
 v_mfma_f32_16x16x32_bf16 v[224:227],v[48:51],a[0:3],v[224:227]
 ds_read_b64_tr_b16 v[32:33],v7
 ds_read_b64_tr_b16 v[34:35],v7 offset:6144
 v_mfma_f32_16x16x32_bf16 v[224:227],v[52:55],a[16:19],v[224:227]
 buffer_load_dwordx4 v11,s[20:23],s44 offen offset:1024 lds
 v_mfma_f32_16x16x32_bf16 v[228:231],v[52:55],a[20:23],v[228:231]
 ds_read_b64_tr_b16 v[36:37],v7 offset:12288
 ds_read_b64_tr_b16 v[38:39],v7 offset:18432
 v_mfma_f32_16x16x32_bf16 v[228:231],v[48:51],a[4:7],v[228:231]
 v_mfma_f32_16x16x32_bf16 v[232:235],v[48:51],a[8:11],v[232:235]
 v_mfma_f32_16x16x32_bf16 v[232:235],v[52:55],a[24:27],v[232:235]
 buffer_load_dwordx4 v12,s[20:23],s44 offen offset:2048 lds
 v_mfma_f32_16x16x32_bf16 v[236:239],v[52:55],a[28:31],v[236:239]
 v_mfma_f32_16x16x32_bf16 v[236:239],v[48:51],a[12:15],v[236:239]
 v_mfma_f32_16x16x32_bf16 v[240:243],v[56:59],a[0:3],v[240:243]
 v_mfma_f32_16x16x32_bf16 v[240:243],v[60:63],a[16:19],v[240:243]
 v_mfma_f32_16x16x32_bf16 v[244:247],v[60:63],a[20:23],v[244:247]
 v_mfma_f32_16x16x32_bf16 v[244:247],v[56:59],a[4:7],v[244:247]
 v_mfma_f32_16x16x32_bf16 v[248:251],v[56:59],a[8:11],v[248:251]
 v_mfma_f32_16x16x32_bf16 v[248:251],v[60:63],a[24:27],v[248:251]
 v_mfma_f32_16x16x32_bf16 v[252:255],v[60:63],a[28:31],v[252:255]
 v_mfma_f32_16x16x32_bf16 v[252:255],v[56:59],a[12:15],v[252:255]
 s_waitcnt lgkmcnt(0)
 v_mfma_f32_16x16x32_bf16 v[64:67],v[16:19],a[32:35],v[64:67]
 ds_read_b64_tr_b16 v[40:41],v7 offset:8
 ds_read_b64_tr_b16 v[42:43],v7 offset:6152
 v_mfma_f32_16x16x32_bf16 v[64:67],v[20:23],a[48:51],v[64:67]
 s_waitcnt vmcnt(10)
 v_cmp_ne_u32 vcc,s51,v5
 s_nop 1
 s_cbranch_vccnz Lp18_spin
Lp18_ok:
 v_mfma_f32_16x16x32_bf16 v[68:71],v[20:23],a[52:55],v[68:71]
 ds_read_b64_tr_b16 v[44:45],v7 offset:12296
 ds_read_b64_tr_b16 v[46:47],v7 offset:18440
 v_mfma_f32_16x16x32_bf16 v[68:71],v[16:19],a[36:39],v[68:71]
 v_lshlrev_b32 v3,1,v13
 v_mfma_f32_16x16x32_bf16 v[72:75],v[16:19],a[40:43],v[72:75]
 s_mul_i32 s1,s33,3072
 s_add_u32 s1,s1,5505024
 ds_read_b64_tr_b16 v[48:49],v6 offset:128
 ds_read_b64_tr_b16 v[50:51],v6 offset:6272
 v_mfma_f32_16x16x32_bf16 v[72:75],v[20:23],a[56:59],v[72:75]
 buffer_load_dwordx4 a[192:195],v3,s[28:31],s1 offen sc1
 buffer_load_dwordx4 a[196:199],v3,s[28:31],s1 offen offset:256 sc1
 v_mfma_f32_16x16x32_bf16 v[76:79],v[20:23],a[60:63],v[76:79]
 ds_read_b64_tr_b16 v[52:53],v6 offset:12416
 ds_read_b64_tr_b16 v[54:55],v6 offset:18560
 v_mfma_f32_16x16x32_bf16 v[76:79],v[16:19],a[44:47],v[76:79]
 buffer_load_dwordx4 a[200:203],v3,s[28:31],s1 offen offset:512 sc1
 buffer_load_dwordx4 a[204:207],v3,s[28:31],s1 offen offset:768 sc1
 v_mfma_f32_16x16x32_bf16 v[80:83],v[24:27],a[32:35],v[80:83]
 ds_read_b64_tr_b16 v[56:57],v6 offset:136
 ds_read_b64_tr_b16 v[58:59],v6 offset:6280
 v_mfma_f32_16x16x32_bf16 v[80:83],v[28:31],a[48:51],v[80:83]
 v_mfma_f32_16x16x32_bf16 v[84:87],v[28:31],a[52:55],v[84:87]
 ds_read_b64_tr_b16 v[60:61],v6 offset:12424
 ds_read_b64_tr_b16 v[62:63],v6 offset:18568
 v_mfma_f32_16x16x32_bf16 v[84:87],v[24:27],a[36:39],v[84:87]
 buffer_load_dwordx4 a[208:211],v3,s[28:31],s1 offen offset:1024 sc1
 v_mfma_f32_16x16x32_bf16 v[88:91],v[24:27],a[40:43],v[88:91]
 s_waitcnt vmcnt(26)
 ds_read_b128 a[0:3],v1 offset:32768
 ds_read_b128 a[16:19],v2 offset:32768
 v_mfma_f32_16x16x32_bf16 v[88:91],v[28:31],a[56:59],v[88:91]
 v_mfma_f32_16x16x32_bf16 v[92:95],v[28:31],a[60:63],v[92:95]
 ds_read_b128 a[4:7],v1 offset:34816
 ds_read_b128 a[20:23],v2 offset:34816
 v_mfma_f32_16x16x32_bf16 v[92:95],v[24:27],a[44:47],v[92:95]
 buffer_load_dwordx4 a[212:215],v3,s[28:31],s1 offen offset:1280 sc1
 v_mfma_f32_16x16x32_bf16 v[96:99],v[32:35],a[32:35],v[96:99]
 ds_read_b128 a[8:11],v1 offset:36864
 ds_read_b128 a[24:27],v2 offset:36864
 v_mfma_f32_16x16x32_bf16 v[96:99],v[36:39],a[48:51],v[96:99]
 v_mfma_f32_16x16x32_bf16 v[100:103],v[36:39],a[52:55],v[100:103]
 ds_read_b128 a[12:15],v1 offset:38912
 ds_read_b128 a[28:31],v2 offset:38912
 v_mfma_f32_16x16x32_bf16 v[100:103],v[32:35],a[36:39],v[100:103]
 buffer_load_dwordx4 a[216:219],v3,s[28:31],s1 offen offset:1536 sc1
 v_mfma_f32_16x16x32_bf16 v[104:107],v[32:35],a[40:43],v[104:107]
 v_mfma_f32_16x16x32_bf16 v[104:107],v[36:39],a[56:59],v[104:107]
 v_mfma_f32_16x16x32_bf16 v[108:111],v[36:39],a[60:63],v[108:111]
 buffer_load_dwordx4 a[220:223],v3,s[28:31],s1 offen offset:1792 sc1
 v_mfma_f32_16x16x32_bf16 v[108:111],v[32:35],a[44:47],v[108:111]
 s_waitcnt lgkmcnt(0)
 v_mfma_f32_16x16x32_bf16 v[112:115],v[40:43],a[32:35],v[112:115]
 ds_read_b64_tr_b16 v[16:17],v7 offset:128
 ds_read_b64_tr_b16 v[18:19],v7 offset:6272
 v_mfma_f32_16x16x32_bf16 v[112:115],v[44:47],a[48:51],v[112:115]
 v_mfma_f32_16x16x32_bf16 v[116:119],v[44:47],a[52:55],v[116:119]
 ds_read_b64_tr_b16 v[20:21],v7 offset:12416
 ds_read_b64_tr_b16 v[22:23],v7 offset:18560
 v_mfma_f32_16x16x32_bf16 v[116:119],v[40:43],a[36:39],v[116:119]
 s_add_u32 m0,s46,32768
 s_lshl_b32 s45,s61,7
 buffer_load_dwordx4 v8,s[24:27],s45 offen lds
 v_mfma_f32_16x16x32_bf16 v[120:123],v[40:43],a[40:43],v[120:123]
 ds_read_b64_tr_b16 v[24:25],v7 offset:136
 ds_read_b64_tr_b16 v[26:27],v7 offset:6280
 v_mfma_f32_16x16x32_bf16 v[120:123],v[44:47],a[56:59],v[120:123]
 v_mfma_f32_16x16x32_bf16 v[124:127],v[44:47],a[60:63],v[124:127]
 s_add_u32 s45,s45,10240
 ds_read_b64_tr_b16 v[28:29],v7 offset:12424
 ds_read_b64_tr_b16 v[30:31],v7 offset:18568
 v_mfma_f32_16x16x32_bf16 v[124:127],v[40:43],a[44:47],v[124:127]
 s_add_u32 m0,s46,33792
 s_add_u32 s61,s61,1
 buffer_load_dwordx4 v8,s[24:27],s45 offen lds
 v_mfma_f32_16x16x32_bf16 v[128:131],v[48:51],a[32:35],v[128:131]
 ds_read_b64_tr_b16 v[32:33],v6 offset:256
 ds_read_b64_tr_b16 v[34:35],v6 offset:6400
 v_mfma_f32_16x16x32_bf16 v[128:131],v[52:55],a[48:51],v[128:131]
 v_mfma_f32_16x16x32_bf16 v[132:135],v[52:55],a[52:55],v[132:135]
 s_add_u32 s45,s45,10240
 ds_read_b64_tr_b16 v[36:37],v6 offset:12544
 ds_read_b64_tr_b16 v[38:39],v6 offset:18688
 v_mfma_f32_16x16x32_bf16 v[132:135],v[48:51],a[36:39],v[132:135]
 s_cmp_eq_u32 s61,10
 s_cselect_b32 s61,0,s61
 v_mfma_f32_16x16x32_bf16 v[136:139],v[48:51],a[40:43],v[136:139]
 s_add_u32 m0,s46,34816
 s_nop 0
 buffer_load_dwordx4 v8,s[24:27],s45 offen lds
 v_mfma_f32_16x16x32_bf16 v[136:139],v[52:55],a[56:59],v[136:139]
 v_mfma_f32_16x16x32_bf16 v[140:143],v[52:55],a[60:63],v[140:143]
 v_mfma_f32_16x16x32_bf16 v[140:143],v[48:51],a[44:47],v[140:143]
 v_mfma_f32_16x16x32_bf16 v[144:147],v[56:59],a[32:35],v[144:147]
 s_add_u32 m0,s46,35840
 s_add_u32 s45,s45,10240
 buffer_load_dwordx4 v8,s[24:27],s45 offen lds
 v_mfma_f32_16x16x32_bf16 v[144:147],v[60:63],a[48:51],v[144:147]
 v_mfma_f32_16x16x32_bf16 v[148:151],v[60:63],a[52:55],v[148:151]
 v_mfma_f32_16x16x32_bf16 v[148:151],v[56:59],a[36:39],v[148:151]
 v_mfma_f32_16x16x32_bf16 v[152:155],v[56:59],a[40:43],v[152:155]
 v_mfma_f32_16x16x32_bf16 v[152:155],v[60:63],a[56:59],v[152:155]
 s_add_u32 m0,s46,36864
 s_add_u32 s45,s45,10240
 buffer_load_dwordx4 v8,s[24:27],s45 offen lds
 v_mfma_f32_16x16x32_bf16 v[156:159],v[60:63],a[60:63],v[156:159]
 v_mfma_f32_16x16x32_bf16 v[156:159],v[56:59],a[44:47],v[156:159]
 s_waitcnt lgkmcnt(0)
 v_mfma_f32_16x16x32_bf16 v[160:163],v[16:19],a[32:35],v[160:163]
 ds_read_b64_tr_b16 v[40:41],v6 offset:264
 ds_read_b64_tr_b16 v[42:43],v6 offset:6408
 v_mfma_f32_16x16x32_bf16 v[160:163],v[20:23],a[48:51],v[160:163]
 v_mfma_f32_16x16x32_bf16 v[164:167],v[20:23],a[52:55],v[164:167]
 ds_read_b64_tr_b16 v[44:45],v6 offset:12552
 ds_read_b64_tr_b16 v[46:47],v6 offset:18696
 v_mfma_f32_16x16x32_bf16 v[164:167],v[16:19],a[36:39],v[164:167]
 s_add_u32 m0,s46,37888
 s_add_u32 s45,s45,10240
 buffer_load_dwordx4 v8,s[24:27],s45 offen lds
 v_mfma_f32_16x16x32_bf16 v[168:171],v[16:19],a[40:43],v[168:171]
 ds_read_b64_tr_b16 v[48:49],v7 offset:256
 ds_read_b64_tr_b16 v[50:51],v7 offset:6400
 v_mfma_f32_16x16x32_bf16 v[168:171],v[20:23],a[56:59],v[168:171]
 v_mfma_f32_16x16x32_bf16 v[172:175],v[20:23],a[60:63],v[172:175]
 ds_read_b64_tr_b16 v[52:53],v7 offset:12544
 ds_read_b64_tr_b16 v[54:55],v7 offset:18688
 v_mfma_f32_16x16x32_bf16 v[172:175],v[16:19],a[44:47],v[172:175]
 s_add_u32 m0,s46,38912
 s_add_u32 s45,s45,10240
 buffer_load_dwordx4 v8,s[24:27],s45 offen lds
 v_mfma_f32_16x16x32_bf16 v[176:179],v[24:27],a[32:35],v[176:179]
 ds_read_b64_tr_b16 v[56:57],v7 offset:264
 ds_read_b64_tr_b16 v[58:59],v7 offset:6408
 v_mfma_f32_16x16x32_bf16 v[176:179],v[28:31],a[48:51],v[176:179]
 v_mfma_f32_16x16x32_bf16 v[180:183],v[28:31],a[52:55],v[180:183]
 ds_read_b64_tr_b16 v[60:61],v7 offset:12552
 ds_read_b64_tr_b16 v[62:63],v7 offset:18696
 v_mfma_f32_16x16x32_bf16 v[180:183],v[24:27],a[36:39],v[180:183]
 s_add_u32 m0,s46,39936
 s_add_u32 s45,s45,10240
 buffer_load_dwordx4 v8,s[24:27],s45 offen lds
 v_mfma_f32_16x16x32_bf16 v[184:187],v[24:27],a[40:43],v[184:187]
 v_mfma_f32_16x16x32_bf16 v[184:187],v[28:31],a[56:59],v[184:187]
 v_mfma_f32_16x16x32_bf16 v[188:191],v[28:31],a[60:63],v[188:191]
 v_mfma_f32_16x16x32_bf16 v[188:191],v[24:27],a[44:47],v[188:191]
 v_mfma_f32_16x16x32_bf16 v[192:195],v[32:35],a[32:35],v[192:195]
 buffer_load_dwordx4 a[224:227],v3,s[28:31],s1 offen offset:2048 sc1
 v_mfma_f32_16x16x32_bf16 v[192:195],v[36:39],a[48:51],v[192:195]
 v_mfma_f32_16x16x32_bf16 v[196:199],v[36:39],a[52:55],v[196:199]
 v_mfma_f32_16x16x32_bf16 v[196:199],v[32:35],a[36:39],v[196:199]
 v_mfma_f32_16x16x32_bf16 v[200:203],v[32:35],a[40:43],v[200:203]
 s_mov_b32 s50,24576
 v_add_u32 v6,s50,v6
 v_add_u32 v7,s50,v7
 v_mfma_f32_16x16x32_bf16 v[200:203],v[36:39],a[56:59],v[200:203]
 buffer_load_dwordx4 a[228:231],v3,s[28:31],s1 offen offset:2304 sc1
 v_mfma_f32_16x16x32_bf16 v[204:207],v[36:39],a[60:63],v[204:207]
 s_and_b32 s41,s32,1
 s_lshl_b32 s41,s41,8
 v_lshlrev_b32 v4,2,v0
 v_mfma_f32_16x16x32_bf16 v[204:207],v[32:35],a[44:47],v[204:207]
 s_waitcnt vmcnt(47) lgkmcnt(0)
 s_barrier
 v_mfma_f32_16x16x32_bf16 v[208:211],v[40:43],a[32:35],v[208:211]
 ds_read_b64_tr_b16 v[16:17],v6
 ds_read_b64_tr_b16 v[18:19],v6 offset:6144
 v_mfma_f32_16x16x32_bf16 v[208:211],v[44:47],a[48:51],v[208:211]
 s_add_u32 s41,s41,1024
 v_add_u32 v4,s41,v4
 v_mfma_f32_16x16x32_bf16 v[212:215],v[44:47],a[52:55],v[212:215]
 ds_read_b64_tr_b16 v[20:21],v6 offset:12288
 ds_read_b64_tr_b16 v[22:23],v6 offset:18432
 v_mfma_f32_16x16x32_bf16 v[212:215],v[40:43],a[36:39],v[212:215]
 buffer_load_dwordx4 a[232:235],v3,s[28:31],s1 offen offset:2560 sc1
 v_mfma_f32_16x16x32_bf16 v[216:219],v[40:43],a[40:43],v[216:219]
 ds_read_b64_tr_b16 v[24:25],v6 offset:8
 ds_read_b64_tr_b16 v[26:27],v6 offset:6152
 v_mfma_f32_16x16x32_bf16 v[216:219],v[44:47],a[56:59],v[216:219]
 s_add_u32 m0,s35,24576
 s_mul_i32 s44,s63,786432
 buffer_load_dwordx4 v10,s[20:23],s44 offen lds
 v_mfma_f32_16x16x32_bf16 v[220:223],v[44:47],a[60:63],v[220:223]
 s_add_u32 s63,s63,1
 ds_read_b64_tr_b16 v[28:29],v6 offset:12296
 ds_read_b64_tr_b16 v[30:31],v6 offset:18440
 v_mfma_f32_16x16x32_bf16 v[220:223],v[40:43],a[44:47],v[220:223]
 buffer_load_dwordx4 v11,s[20:23],s44 offen offset:1024 lds
 v_mfma_f32_16x16x32_bf16 v[224:227],v[48:51],a[32:35],v[224:227]
 ds_read_b64_tr_b16 v[32:33],v7
 ds_read_b64_tr_b16 v[34:35],v7 offset:6144
 v_mfma_f32_16x16x32_bf16 v[224:227],v[52:55],a[48:51],v[224:227]
 s_cmp_eq_u32 s63,10
 s_cselect_b32 s63,0,s63
 v_mfma_f32_16x16x32_bf16 v[228:231],v[52:55],a[52:55],v[228:231]
 ds_read_b64_tr_b16 v[36:37],v7 offset:12288
 ds_read_b64_tr_b16 v[38:39],v7 offset:18432
 v_mfma_f32_16x16x32_bf16 v[228:231],v[48:51],a[36:39],v[228:231]
 buffer_load_dwordx4 v12,s[20:23],s44 offen offset:2048 lds
 v_mfma_f32_16x16x32_bf16 v[232:235],v[48:51],a[40:43],v[232:235]
 v_mfma_f32_16x16x32_bf16 v[232:235],v[52:55],a[56:59],v[232:235]
 v_mfma_f32_16x16x32_bf16 v[236:239],v[52:55],a[60:63],v[236:239]
 s_add_u32 m0,s35,27648
 s_add_u32 s44,s44,196608
 buffer_load_dwordx4 v10,s[20:23],s44 offen lds
 v_mfma_f32_16x16x32_bf16 v[236:239],v[48:51],a[44:47],v[236:239]
 v_mfma_f32_16x16x32_bf16 v[240:243],v[56:59],a[32:35],v[240:243]
 v_mfma_f32_16x16x32_bf16 v[240:243],v[60:63],a[48:51],v[240:243]
 v_mfma_f32_16x16x32_bf16 v[244:247],v[60:63],a[52:55],v[244:247]
 buffer_load_dwordx4 v11,s[20:23],s44 offen offset:1024 lds
 v_mfma_f32_16x16x32_bf16 v[244:247],v[56:59],a[36:39],v[244:247]
 v_mfma_f32_16x16x32_bf16 v[248:251],v[56:59],a[40:43],v[248:251]
 v_mfma_f32_16x16x32_bf16 v[248:251],v[60:63],a[56:59],v[248:251]
 v_mfma_f32_16x16x32_bf16 v[252:255],v[60:63],a[60:63],v[252:255]
 buffer_load_dwordx4 v12,s[20:23],s44 offen offset:2048 lds
 v_mfma_f32_16x16x32_bf16 v[252:255],v[56:59],a[44:47],v[252:255]
 s_waitcnt lgkmcnt(0)
 v_mfma_f32_16x16x32_bf16 v[64:67],v[16:19],a[64:67],v[64:67]
 ds_read_b64_tr_b16 v[40:41],v7 offset:8
 ds_read_b64_tr_b16 v[42:43],v7 offset:6152
 v_mfma_f32_16x16x32_bf16 v[64:67],v[20:23],a[80:83],v[64:67]
 v_mfma_f32_16x16x32_bf16 v[68:71],v[20:23],a[84:87],v[68:71]
 ds_read_b64_tr_b16 v[44:45],v7 offset:12296
 ds_read_b64_tr_b16 v[46:47],v7 offset:18440
 v_mfma_f32_16x16x32_bf16 v[68:71],v[16:19],a[68:71],v[68:71]
 buffer_load_dwordx4 a[236:239],v3,s[28:31],s1 offen offset:2816 sc1
 v_mfma_f32_16x16x32_bf16 v[72:75],v[16:19],a[72:75],v[72:75]
 s_lshl_b32 s1,s52,3
 s_add_u32 s1,s1,s34
 s_lshl_b32 s1,s1,2
 s_add_u32 s1,s1,s32
 ds_read_b64_tr_b16 v[48:49],v6 offset:128
 ds_read_b64_tr_b16 v[50:51],v6 offset:6272
 v_mfma_f32_16x16x32_bf16 v[72:75],v[20:23],a[88:91],v[72:75]
 s_lshl_b32 s1,s1,9
 v_mfma_f32_16x16x32_bf16 v[76:79],v[20:23],a[92:95],v[76:79]
 s_add_u32 s1,s1,5373952
 ds_read_b64_tr_b16 v[52:53],v6 offset:12416
 ds_read_b64_tr_b16 v[54:55],v6 offset:18560
 v_mfma_f32_16x16x32_bf16 v[76:79],v[16:19],a[76:79],v[76:79]
 buffer_load_dwordx2 a[240:241],v13,s[28:31],s1 offen sc1
 v_mfma_f32_16x16x32_bf16 v[80:83],v[24:27],a[64:67],v[80:83]
 ds_read_b64_tr_b16 v[56:57],v6 offset:136
 ds_read_b64_tr_b16 v[58:59],v6 offset:6280
 v_mfma_f32_16x16x32_bf16 v[80:83],v[28:31],a[80:83],v[80:83]
 buffer_load_dwordx2 a[244:245],v13,s[28:31],s1 offen offset:128 sc1
 buffer_load_dword v5,v4,s[92:95],0 offen sc1
 v_mfma_f32_16x16x32_bf16 v[84:87],v[28:31],a[84:87],v[84:87]
 ds_read_b64_tr_b16 v[60:61],v6 offset:12424
 ds_read_b64_tr_b16 v[62:63],v6 offset:18568
 v_mfma_f32_16x16x32_bf16 v[84:87],v[24:27],a[68:71],v[84:87]
 buffer_load_dwordx2 a[248:249],v13,s[28:31],s1 offen offset:256 sc1
 v_mfma_f32_16x16x32_bf16 v[88:91],v[24:27],a[72:75],v[88:91]
 s_waitcnt vmcnt(36)
 ds_read_b128 a[32:35],v1
 ds_read_b128 a[48:51],v2
 v_mfma_f32_16x16x32_bf16 v[88:91],v[28:31],a[88:91],v[88:91]
 buffer_load_dwordx2 a[252:253],v13,s[28:31],s1 offen offset:384 sc1
 v_mfma_f32_16x16x32_bf16 v[92:95],v[28:31],a[92:95],v[92:95]
 ds_read_b128 a[36:39],v1 offset:2048
 ds_read_b128 a[52:55],v2 offset:2048
 v_mfma_f32_16x16x32_bf16 v[92:95],v[24:27],a[76:79],v[92:95]
 v_mfma_f32_16x16x32_bf16 v[96:99],v[32:35],a[64:67],v[96:99]
 ds_read_b128 a[40:43],v1 offset:4096
 ds_read_b128 a[56:59],v2 offset:4096
 v_mfma_f32_16x16x32_bf16 v[96:99],v[36:39],a[80:83],v[96:99]
 v_mfma_f32_16x16x32_bf16 v[100:103],v[36:39],a[84:87],v[100:103]
 ds_read_b128 a[44:47],v1 offset:6144
 ds_read_b128 a[60:63],v2 offset:6144
 v_mfma_f32_16x16x32_bf16 v[100:103],v[32:35],a[68:71],v[100:103]
 v_mfma_f32_16x16x32_bf16 v[104:107],v[32:35],a[72:75],v[104:107]
 v_mfma_f32_16x16x32_bf16 v[104:107],v[36:39],a[88:91],v[104:107]
 v_mfma_f32_16x16x32_bf16 v[108:111],v[36:39],a[92:95],v[108:111]
 v_mfma_f32_16x16x32_bf16 v[108:111],v[32:35],a[76:79],v[108:111]
 s_waitcnt lgkmcnt(0)
 v_mfma_f32_16x16x32_bf16 v[112:115],v[40:43],a[64:67],v[112:115]
 ds_read_b64_tr_b16 v[16:17],v7 offset:128
 ds_read_b64_tr_b16 v[18:19],v7 offset:6272
 v_mfma_f32_16x16x32_bf16 v[112:115],v[44:47],a[80:83],v[112:115]
 s_add_u32 m0,s46,0
 s_lshl_b32 s45,s61,7
 buffer_load_dwordx4 v8,s[24:27],s45 offen lds
 v_mfma_f32_16x16x32_bf16 v[116:119],v[44:47],a[84:87],v[116:119]
 s_add_u32 s45,s45,10240
 ds_read_b64_tr_b16 v[20:21],v7 offset:12416
 ds_read_b64_tr_b16 v[22:23],v7 offset:18560
 v_mfma_f32_16x16x32_bf16 v[116:119],v[40:43],a[68:71],v[116:119]
 s_add_u32 m0,s46,1024
 s_add_u32 s61,s61,1
 buffer_load_dwordx4 v8,s[24:27],s45 offen lds
 v_mfma_f32_16x16x32_bf16 v[120:123],v[40:43],a[72:75],v[120:123]
 s_add_u32 s45,s45,10240
 ds_read_b64_tr_b16 v[24:25],v7 offset:136
 ds_read_b64_tr_b16 v[26:27],v7 offset:6280
 v_mfma_f32_16x16x32_bf16 v[120:123],v[44:47],a[88:91],v[120:123]
 s_cmp_eq_u32 s61,10
 s_cselect_b32 s61,0,s61
 s_add_u32 m0,s46,2048
 s_nop 0
 buffer_load_dwordx4 v8,s[24:27],s45 offen lds
 v_mfma_f32_16x16x32_bf16 v[124:127],v[44:47],a[92:95],v[124:127]
 ds_read_b64_tr_b16 v[28:29],v7 offset:12424
 ds_read_b64_tr_b16 v[30:31],v7 offset:18568
 v_mfma_f32_16x16x32_bf16 v[124:127],v[40:43],a[76:79],v[124:127]
 s_add_u32 m0,s46,3072
 s_add_u32 s45,s45,10240
 buffer_load_dwordx4 v8,s[24:27],s45 offen lds
 v_mfma_f32_16x16x32_bf16 v[128:131],v[48:51],a[64:67],v[128:131]
 ds_read_b64_tr_b16 v[32:33],v6 offset:256
 ds_read_b64_tr_b16 v[34:35],v6 offset:6400
 v_mfma_f32_16x16x32_bf16 v[128:131],v[52:55],a[80:83],v[128:131]
 s_add_u32 m0,s46,4096
 s_add_u32 s45,s45,10240
 buffer_load_dwordx4 v8,s[24:27],s45 offen lds
 v_mfma_f32_16x16x32_bf16 v[132:135],v[52:55],a[84:87],v[132:135]
 ds_read_b64_tr_b16 v[36:37],v6 offset:12544
 ds_read_b64_tr_b16 v[38:39],v6 offset:18688
 v_mfma_f32_16x16x32_bf16 v[132:135],v[48:51],a[68:71],v[132:135]
 s_add_u32 m0,s46,5120
 s_add_u32 s45,s45,10240
 buffer_load_dwordx4 v8,s[24:27],s45 offen lds
 v_mfma_f32_16x16x32_bf16 v[136:139],v[48:51],a[72:75],v[136:139]
 v_mfma_f32_16x16x32_bf16 v[136:139],v[52:55],a[88:91],v[136:139]
 v_mfma_f32_16x16x32_bf16 v[140:143],v[52:55],a[92:95],v[140:143]
 s_add_u32 m0,s46,6144
 s_add_u32 s45,s45,10240
 buffer_load_dwordx4 v8,s[24:27],s45 offen lds
 v_mfma_f32_16x16x32_bf16 v[140:143],v[48:51],a[76:79],v[140:143]
 v_mfma_f32_16x16x32_bf16 v[144:147],v[56:59],a[64:67],v[144:147]
 v_mfma_f32_16x16x32_bf16 v[144:147],v[60:63],a[80:83],v[144:147]
 v_mfma_f32_16x16x32_bf16 v[148:151],v[60:63],a[84:87],v[148:151]
 v_mfma_f32_16x16x32_bf16 v[148:151],v[56:59],a[68:71],v[148:151]
 s_add_u32 m0,s46,7168
 s_add_u32 s45,s45,10240
 buffer_load_dwordx4 v8,s[24:27],s45 offen lds
 v_mfma_f32_16x16x32_bf16 v[152:155],v[56:59],a[72:75],v[152:155]
 v_mfma_f32_16x16x32_bf16 v[152:155],v[60:63],a[88:91],v[152:155]
 v_mfma_f32_16x16x32_bf16 v[156:159],v[60:63],a[92:95],v[156:159]
 v_mfma_f32_16x16x32_bf16 v[156:159],v[56:59],a[76:79],v[156:159]
 s_waitcnt lgkmcnt(0)
 v_mfma_f32_16x16x32_bf16 v[160:163],v[16:19],a[64:67],v[160:163]
 ds_read_b64_tr_b16 v[40:41],v6 offset:264
 ds_read_b64_tr_b16 v[42:43],v6 offset:6408
 v_mfma_f32_16x16x32_bf16 v[160:163],v[20:23],a[80:83],v[160:163]
 v_mfma_f32_16x16x32_bf16 v[164:167],v[20:23],a[84:87],v[164:167]
 ds_read_b64_tr_b16 v[44:45],v6 offset:12552
 ds_read_b64_tr_b16 v[46:47],v6 offset:18696
 v_mfma_f32_16x16x32_bf16 v[164:167],v[16:19],a[68:71],v[164:167]
 v_mfma_f32_16x16x32_bf16 v[168:171],v[16:19],a[72:75],v[168:171]
 ds_read_b64_tr_b16 v[48:49],v7 offset:256
 ds_read_b64_tr_b16 v[50:51],v7 offset:6400
 v_mfma_f32_16x16x32_bf16 v[168:171],v[20:23],a[88:91],v[168:171]
 v_mfma_f32_16x16x32_bf16 v[172:175],v[20:23],a[92:95],v[172:175]
 ds_read_b64_tr_b16 v[52:53],v7 offset:12544
 ds_read_b64_tr_b16 v[54:55],v7 offset:18688
 v_mfma_f32_16x16x32_bf16 v[172:175],v[16:19],a[76:79],v[172:175]
 v_mfma_f32_16x16x32_bf16 v[176:179],v[24:27],a[64:67],v[176:179]
 ds_read_b64_tr_b16 v[56:57],v7 offset:264
 ds_read_b64_tr_b16 v[58:59],v7 offset:6408
 v_mfma_f32_16x16x32_bf16 v[176:179],v[28:31],a[80:83],v[176:179]
 v_mfma_f32_16x16x32_bf16 v[180:183],v[28:31],a[84:87],v[180:183]
 ds_read_b64_tr_b16 v[60:61],v7 offset:12552
 ds_read_b64_tr_b16 v[62:63],v7 offset:18696
 v_mfma_f32_16x16x32_bf16 v[180:183],v[24:27],a[68:71],v[180:183]
 v_mfma_f32_16x16x32_bf16 v[184:187],v[24:27],a[72:75],v[184:187]
 v_mfma_f32_16x16x32_bf16 v[184:187],v[28:31],a[88:91],v[184:187]
 v_mfma_f32_16x16x32_bf16 v[188:191],v[28:31],a[92:95],v[188:191]
 v_mfma_f32_16x16x32_bf16 v[188:191],v[24:27],a[76:79],v[188:191]
 v_mfma_f32_16x16x32_bf16 v[192:195],v[32:35],a[64:67],v[192:195]
 v_mfma_f32_16x16x32_bf16 v[192:195],v[36:39],a[80:83],v[192:195]
 v_mfma_f32_16x16x32_bf16 v[196:199],v[36:39],a[84:87],v[196:199]
 s_waitcnt vmcnt(10)
 v_cmp_ne_u32 vcc,s51,v5
 s_nop 1
 s_cbranch_vccnz Lp19_spin
Lp19_ok:
 v_mfma_f32_16x16x32_bf16 v[196:199],v[32:35],a[68:71],v[196:199]
 v_mfma_f32_16x16x32_bf16 v[200:203],v[32:35],a[72:75],v[200:203]
 s_mov_b32 s50,24576
 v_add_u32 v6,s50,v6
 v_add_u32 v7,s50,v7
 v_mfma_f32_16x16x32_bf16 v[200:203],v[36:39],a[88:91],v[200:203]
 v_mfma_f32_16x16x32_bf16 v[204:207],v[36:39],a[92:95],v[204:207]
 v_mfma_f32_16x16x32_bf16 v[204:207],v[32:35],a[76:79],v[204:207]
 s_waitcnt vmcnt(54) lgkmcnt(0)
 s_barrier
 v_mfma_f32_16x16x32_bf16 v[208:211],v[40:43],a[64:67],v[208:211]
 ds_read_b64_tr_b16 v[16:17],v6
 ds_read_b64_tr_b16 v[18:19],v6 offset:6144
 v_mfma_f32_16x16x32_bf16 v[208:211],v[44:47],a[80:83],v[208:211]
 s_add_u32 m0,s35,49152
 s_mul_i32 s44,s63,786432
 buffer_load_dwordx4 v10,s[20:23],s44 offen lds
 v_mfma_f32_16x16x32_bf16 v[212:215],v[44:47],a[84:87],v[212:215]
 s_add_u32 s63,s63,1
 ds_read_b64_tr_b16 v[20:21],v6 offset:12288
 ds_read_b64_tr_b16 v[22:23],v6 offset:18432
 v_mfma_f32_16x16x32_bf16 v[212:215],v[40:43],a[68:71],v[212:215]
 buffer_load_dwordx4 v11,s[20:23],s44 offen offset:1024 lds
 s_cmp_eq_u32 s63,10
 s_cselect_b32 s63,0,s63
 buffer_load_dwordx4 v12,s[20:23],s44 offen offset:2048 lds
 v_mfma_f32_16x16x32_bf16 v[216:219],v[40:43],a[72:75],v[216:219]
 ds_read_b64_tr_b16 v[24:25],v6 offset:8
 ds_read_b64_tr_b16 v[26:27],v6 offset:6152
 v_mfma_f32_16x16x32_bf16 v[216:219],v[44:47],a[88:91],v[216:219]
 s_add_u32 m0,s35,52224
 s_add_u32 s44,s44,196608
 buffer_load_dwordx4 v10,s[20:23],s44 offen lds
 v_mfma_f32_16x16x32_bf16 v[220:223],v[44:47],a[92:95],v[220:223]
 ds_read_b64_tr_b16 v[28:29],v6 offset:12296
 ds_read_b64_tr_b16 v[30:31],v6 offset:18440
 v_mfma_f32_16x16x32_bf16 v[220:223],v[40:43],a[76:79],v[220:223]
 v_mfma_f32_16x16x32_bf16 v[224:227],v[48:51],a[64:67],v[224:227]
 ds_read_b64_tr_b16 v[32:33],v7
 ds_read_b64_tr_b16 v[34:35],v7 offset:6144
 v_mfma_f32_16x16x32_bf16 v[224:227],v[52:55],a[80:83],v[224:227]
 buffer_load_dwordx4 v11,s[20:23],s44 offen offset:1024 lds
 v_mfma_f32_16x16x32_bf16 v[228:231],v[52:55],a[84:87],v[228:231]
 ds_read_b64_tr_b16 v[36:37],v7 offset:12288
 ds_read_b64_tr_b16 v[38:39],v7 offset:18432
 v_mfma_f32_16x16x32_bf16 v[228:231],v[48:51],a[68:71],v[228:231]
 v_mfma_f32_16x16x32_bf16 v[232:235],v[48:51],a[72:75],v[232:235]
 v_mfma_f32_16x16x32_bf16 v[232:235],v[52:55],a[88:91],v[232:235]
 buffer_load_dwordx4 v12,s[20:23],s44 offen offset:2048 lds
 v_mfma_f32_16x16x32_bf16 v[236:239],v[52:55],a[92:95],v[236:239]
 v_mfma_f32_16x16x32_bf16 v[236:239],v[48:51],a[76:79],v[236:239]
 v_mfma_f32_16x16x32_bf16 v[240:243],v[56:59],a[64:67],v[240:243]
 v_mfma_f32_16x16x32_bf16 v[240:243],v[60:63],a[80:83],v[240:243]
 v_mfma_f32_16x16x32_bf16 v[244:247],v[60:63],a[84:87],v[244:247]
 v_mfma_f32_16x16x32_bf16 v[244:247],v[56:59],a[68:71],v[244:247]
 v_mfma_f32_16x16x32_bf16 v[248:251],v[56:59],a[72:75],v[248:251]
 v_mfma_f32_16x16x32_bf16 v[248:251],v[60:63],a[88:91],v[248:251]
 v_mfma_f32_16x16x32_bf16 v[252:255],v[60:63],a[92:95],v[252:255]
 v_mfma_f32_16x16x32_bf16 v[252:255],v[56:59],a[76:79],v[252:255]
 s_waitcnt lgkmcnt(0)
 v_mfma_f32_16x16x32_bf16 v[64:67],v[16:19],a[0:3],v[64:67]
 ds_read_b64_tr_b16 v[40:41],v7 offset:8
 ds_read_b64_tr_b16 v[42:43],v7 offset:6152
 v_mfma_f32_16x16x32_bf16 v[64:67],v[20:23],a[16:19],v[64:67]
 v_lshlrev_b32 v8,3,v0
 v_mfma_f32_16x16x32_bf16 v[68:71],v[20:23],a[20:23],v[68:71]
 s_mul_i32 s75,s54,20480
 s_add_u32 s0,s75,0
 ds_read_b64_tr_b16 v[44:45],v7 offset:12296
 ds_read_b64_tr_b16 v[46:47],v7 offset:18440
 v_mfma_f32_16x16x32_bf16 v[68:71],v[16:19],a[4:7],v[68:71]
 buffer_load_dwordx4 a[120:123],v9,s[28:31],s0 offen sc1
 s_add_u32 s0,s75,20480
 buffer_load_dwordx4 a[124:127],v9,s[28:31],s0 offen sc1
 v_mfma_f32_16x16x32_bf16 v[72:75],v[16:19],a[8:11],v[72:75]
 ds_read_b64_tr_b16 v[48:49],v6 offset:128
 ds_read_b64_tr_b16 v[50:51],v6 offset:6272
 v_mfma_f32_16x16x32_bf16 v[72:75],v[20:23],a[24:27],v[72:75]
 v_mfma_f32_16x16x32_bf16 v[76:79],v[20:23],a[28:31],v[76:79]
 s_add_u32 s0,s75,1024
 ds_read_b64_tr_b16 v[52:53],v6 offset:12416
 ds_read_b64_tr_b16 v[54:55],v6 offset:18560
 v_mfma_f32_16x16x32_bf16 v[76:79],v[16:19],a[12:15],v[76:79]
 buffer_load_dwordx4 a[128:131],v9,s[28:31],s0 offen sc1
 v_mfma_f32_16x16x32_bf16 v[80:83],v[24:27],a[0:3],v[80:83]
 ds_read_b64_tr_b16 v[56:57],v6 offset:136
 ds_read_b64_tr_b16 v[58:59],v6 offset:6280
 v_mfma_f32_16x16x32_bf16 v[80:83],v[28:31],a[16:19],v[80:83]
 v_mfma_f32_16x16x32_bf16 v[84:87],v[28:31],a[20:23],v[84:87]
 ds_read_b64_tr_b16 v[60:61],v6 offset:12424
 ds_read_b64_tr_b16 v[62:63],v6 offset:18568
 v_mfma_f32_16x16x32_bf16 v[84:87],v[24:27],a[4:7],v[84:87]
 s_add_u32 s0,s75,21504
 v_mfma_f32_16x16x32_bf16 v[88:91],v[24:27],a[8:11],v[88:91]
 s_waitcnt vmcnt(32)
 ds_read_b128 a[64:67],v1 offset:32768
 ds_read_b128 a[80:83],v2 offset:32768
 v_mfma_f32_16x16x32_bf16 v[88:91],v[28:31],a[24:27],v[88:91]
 buffer_load_dwordx4 a[132:135],v9,s[28:31],s0 offen sc1
 v_mfma_f32_16x16x32_bf16 v[92:95],v[28:31],a[28:31],v[92:95]
 ds_read_b128 a[68:71],v1 offset:34816
 ds_read_b128 a[84:87],v2 offset:34816
 v_mfma_f32_16x16x32_bf16 v[92:95],v[24:27],a[12:15],v[92:95]
 v_mfma_f32_16x16x32_bf16 v[96:99],v[32:35],a[0:3],v[96:99]
 ds_read_b128 a[72:75],v1 offset:36864
 ds_read_b128 a[88:91],v2 offset:36864
 v_mfma_f32_16x16x32_bf16 v[96:99],v[36:39],a[16:19],v[96:99]
 v_mfma_f32_16x16x32_bf16 v[100:103],v[36:39],a[20:23],v[100:103]
 s_add_u32 s0,s75,2048
 ds_read_b128 a[76:79],v1 offset:38912
 ds_read_b128 a[92:95],v2 offset:38912
 v_mfma_f32_16x16x32_bf16 v[100:103],v[32:35],a[4:7],v[100:103]
 buffer_load_dwordx2 a[136:137],v8,s[28:31],s0 offen sc1
 v_mfma_f32_16x16x32_bf16 v[104:107],v[32:35],a[8:11],v[104:107]
 v_mfma_f32_16x16x32_bf16 v[104:107],v[36:39],a[24:27],v[104:107]
 v_mfma_f32_16x16x32_bf16 v[108:111],v[36:39],a[28:31],v[108:111]
 buffer_load_dwordx2 a[138:139],v8,s[28:31],s0 offen offset:512 sc1
 v_mfma_f32_16x16x32_bf16 v[108:111],v[32:35],a[12:15],v[108:111]
 s_waitcnt lgkmcnt(0)
 v_mfma_f32_16x16x32_bf16 v[112:115],v[40:43],a[0:3],v[112:115]
 s_add_u32 s0,s75,22528
 ds_read_b64_tr_b16 v[16:17],v7 offset:128
 ds_read_b64_tr_b16 v[18:19],v7 offset:6272
 v_mfma_f32_16x16x32_bf16 v[112:115],v[44:47],a[16:19],v[112:115]
 buffer_load_dwordx2 a[140:141],v8,s[28:31],s0 offen sc1
 v_mfma_f32_16x16x32_bf16 v[116:119],v[44:47],a[20:23],v[116:119]
 ds_read_b64_tr_b16 v[20:21],v7 offset:12416
 ds_read_b64_tr_b16 v[22:23],v7 offset:18560
 v_mfma_f32_16x16x32_bf16 v[116:119],v[40:43],a[4:7],v[116:119]
 v_mfma_f32_16x16x32_bf16 v[120:123],v[40:43],a[8:11],v[120:123]
 ds_read_b64_tr_b16 v[24:25],v7 offset:136
 ds_read_b64_tr_b16 v[26:27],v7 offset:6280
 v_mfma_f32_16x16x32_bf16 v[120:123],v[44:47],a[24:27],v[120:123]
 buffer_load_dwordx2 a[142:143],v8,s[28:31],s0 offen offset:512 sc1
 v_mfma_f32_16x16x32_bf16 v[124:127],v[44:47],a[28:31],v[124:127]
 ds_read_b64_tr_b16 v[28:29],v7 offset:12424
 ds_read_b64_tr_b16 v[30:31],v7 offset:18568
 v_mfma_f32_16x16x32_bf16 v[124:127],v[40:43],a[12:15],v[124:127]
 v_mfma_f32_16x16x32_bf16 v[128:131],v[48:51],a[0:3],v[128:131]
 s_add_u32 s0,s75,3072
 ds_read_b64_tr_b16 v[32:33],v6 offset:256
 ds_read_b64_tr_b16 v[34:35],v6 offset:6400
 v_mfma_f32_16x16x32_bf16 v[128:131],v[52:55],a[16:19],v[128:131]
 buffer_load_dwordx4 a[144:147],v9,s[28:31],s0 offen sc1
 v_mfma_f32_16x16x32_bf16 v[132:135],v[52:55],a[20:23],v[132:135]
 ds_read_b64_tr_b16 v[36:37],v6 offset:12544
 ds_read_b64_tr_b16 v[38:39],v6 offset:18688
 v_mfma_f32_16x16x32_bf16 v[132:135],v[48:51],a[4:7],v[132:135]
 v_mfma_f32_16x16x32_bf16 v[136:139],v[48:51],a[8:11],v[136:139]
 v_mfma_f32_16x16x32_bf16 v[136:139],v[52:55],a[24:27],v[136:139]
 s_add_u32 s0,s75,23552
 v_mfma_f32_16x16x32_bf16 v[140:143],v[52:55],a[28:31],v[140:143]
 buffer_load_dwordx4 a[148:151],v9,s[28:31],s0 offen sc1
 v_mfma_f32_16x16x32_bf16 v[140:143],v[48:51],a[12:15],v[140:143]
 v_mfma_f32_16x16x32_bf16 v[144:147],v[56:59],a[0:3],v[144:147]
 v_mfma_f32_16x16x32_bf16 v[144:147],v[60:63],a[16:19],v[144:147]
 v_mfma_f32_16x16x32_bf16 v[148:151],v[60:63],a[20:23],v[148:151]
 v_mfma_f32_16x16x32_bf16 v[148:151],v[56:59],a[4:7],v[148:151]
 s_add_u32 s0,s75,4096
 v_mfma_f32_16x16x32_bf16 v[152:155],v[56:59],a[8:11],v[152:155]
 buffer_load_dwordx4 a[152:155],v9,s[28:31],s0 offen sc1
 v_mfma_f32_16x16x32_bf16 v[152:155],v[60:63],a[24:27],v[152:155]
 v_mfma_f32_16x16x32_bf16 v[156:159],v[60:63],a[28:31],v[156:159]
 v_mfma_f32_16x16x32_bf16 v[156:159],v[56:59],a[12:15],v[156:159]
 s_waitcnt lgkmcnt(0)
 v_mfma_f32_16x16x32_bf16 v[160:163],v[16:19],a[0:3],v[160:163]
 ds_read_b64_tr_b16 v[40:41],v6 offset:264
 ds_read_b64_tr_b16 v[42:43],v6 offset:6408
 v_mfma_f32_16x16x32_bf16 v[160:163],v[20:23],a[16:19],v[160:163]
 v_mfma_f32_16x16x32_bf16 v[164:167],v[20:23],a[20:23],v[164:167]
 s_add_u32 s0,s75,24576
 ds_read_b64_tr_b16 v[44:45],v6 offset:12552
 ds_read_b64_tr_b16 v[46:47],v6 offset:18696
 v_mfma_f32_16x16x32_bf16 v[164:167],v[16:19],a[4:7],v[164:167]
 buffer_load_dwordx4 a[156:159],v9,s[28:31],s0 offen sc1
 v_mfma_f32_16x16x32_bf16 v[168:171],v[16:19],a[8:11],v[168:171]
 ds_read_b64_tr_b16 v[48:49],v7 offset:256
 ds_read_b64_tr_b16 v[50:51],v7 offset:6400
 v_mfma_f32_16x16x32_bf16 v[168:171],v[20:23],a[24:27],v[168:171]
 v_mfma_f32_16x16x32_bf16 v[172:175],v[20:23],a[28:31],v[172:175]
 ds_read_b64_tr_b16 v[52:53],v7 offset:12544
 ds_read_b64_tr_b16 v[54:55],v7 offset:18688
 v_mfma_f32_16x16x32_bf16 v[172:175],v[16:19],a[12:15],v[172:175]
 v_mfma_f32_16x16x32_bf16 v[176:179],v[24:27],a[0:3],v[176:179]
 s_add_u32 s0,s75,5120
 ds_read_b64_tr_b16 v[56:57],v7 offset:264
 ds_read_b64_tr_b16 v[58:59],v7 offset:6408
 v_mfma_f32_16x16x32_bf16 v[176:179],v[28:31],a[16:19],v[176:179]
 buffer_load_dwordx4 a[160:163],v9,s[28:31],s0 offen sc1
 v_mfma_f32_16x16x32_bf16 v[180:183],v[28:31],a[20:23],v[180:183]
 ds_read_b64_tr_b16 v[60:61],v7 offset:12552
 ds_read_b64_tr_b16 v[62:63],v7 offset:18696
 v_mfma_f32_16x16x32_bf16 v[180:183],v[24:27],a[4:7],v[180:183]
 v_mfma_f32_16x16x32_bf16 v[184:187],v[24:27],a[8:11],v[184:187]
 v_mfma_f32_16x16x32_bf16 v[184:187],v[28:31],a[24:27],v[184:187]
 v_mfma_f32_16x16x32_bf16 v[188:191],v[28:31],a[28:31],v[188:191]
 s_add_u32 s0,s75,25600
 v_mfma_f32_16x16x32_bf16 v[188:191],v[24:27],a[12:15],v[188:191]
 buffer_load_dwordx4 a[164:167],v9,s[28:31],s0 offen sc1
 v_mfma_f32_16x16x32_bf16 v[192:195],v[32:35],a[0:3],v[192:195]
 v_mfma_f32_16x16x32_bf16 v[192:195],v[36:39],a[16:19],v[192:195]
 v_mfma_f32_16x16x32_bf16 v[196:199],v[36:39],a[20:23],v[196:199]
 v_mfma_f32_16x16x32_bf16 v[196:199],v[32:35],a[4:7],v[196:199]
 s_add_u32 s0,s75,6144
 v_mfma_f32_16x16x32_bf16 v[200:203],v[32:35],a[8:11],v[200:203]
 s_mov_b32 s50,-73728
 v_add_u32 v6,s50,v6
 v_add_u32 v7,s50,v7
 v_mfma_f32_16x16x32_bf16 v[200:203],v[36:39],a[24:27],v[200:203]
 buffer_load_dwordx4 a[168:171],v9,s[28:31],s0 offen sc1
 v_mfma_f32_16x16x32_bf16 v[204:207],v[36:39],a[28:31],v[204:207]
 v_mfma_f32_16x16x32_bf16 v[204:207],v[32:35],a[12:15],v[204:207]
 s_waitcnt vmcnt(60) lgkmcnt(0)
 s_barrier
 v_mfma_f32_16x16x32_bf16 v[208:211],v[40:43],a[0:3],v[208:211]
 ds_read_b64_tr_b16 v[16:17],v6
 ds_read_b64_tr_b16 v[18:19],v6 offset:6144
 v_mfma_f32_16x16x32_bf16 v[208:211],v[44:47],a[16:19],v[208:211]
 v_mfma_f32_16x16x32_bf16 v[212:215],v[44:47],a[20:23],v[212:215]
 s_add_u32 s0,s75,26624
 ds_read_b64_tr_b16 v[20:21],v6 offset:12288
 ds_read_b64_tr_b16 v[22:23],v6 offset:18432
 v_mfma_f32_16x16x32_bf16 v[212:215],v[40:43],a[4:7],v[212:215]
 buffer_load_dwordx4 a[172:175],v9,s[28:31],s0 offen sc1
 v_mfma_f32_16x16x32_bf16 v[216:219],v[40:43],a[8:11],v[216:219]
 ds_read_b64_tr_b16 v[24:25],v6 offset:8
 ds_read_b64_tr_b16 v[26:27],v6 offset:6152
 v_mfma_f32_16x16x32_bf16 v[216:219],v[44:47],a[24:27],v[216:219]
 v_mfma_f32_16x16x32_bf16 v[220:223],v[44:47],a[28:31],v[220:223]
 ds_read_b64_tr_b16 v[28:29],v6 offset:12296
 ds_read_b64_tr_b16 v[30:31],v6 offset:18440
 v_mfma_f32_16x16x32_bf16 v[220:223],v[40:43],a[12:15],v[220:223]
 v_mfma_f32_16x16x32_bf16 v[224:227],v[48:51],a[0:3],v[224:227]
 s_add_u32 s0,s75,7168
 ds_read_b64_tr_b16 v[32:33],v7
 ds_read_b64_tr_b16 v[34:35],v7 offset:6144
 v_mfma_f32_16x16x32_bf16 v[224:227],v[52:55],a[16:19],v[224:227]
 buffer_load_dwordx2 a[176:177],v8,s[28:31],s0 offen sc1
 v_mfma_f32_16x16x32_bf16 v[228:231],v[52:55],a[20:23],v[228:231]
 ds_read_b64_tr_b16 v[36:37],v7 offset:12288
 ds_read_b64_tr_b16 v[38:39],v7 offset:18432
 v_mfma_f32_16x16x32_bf16 v[228:231],v[48:51],a[4:7],v[228:231]
 buffer_load_dwordx2 a[178:179],v8,s[28:31],s0 offen offset:512 sc1
 v_mfma_f32_16x16x32_bf16 v[232:235],v[48:51],a[8:11],v[232:235]
 v_mfma_f32_16x16x32_bf16 v[232:235],v[52:55],a[24:27],v[232:235]
 s_add_u32 s0,s75,27648
 v_mfma_f32_16x16x32_bf16 v[236:239],v[52:55],a[28:31],v[236:239]
 buffer_load_dwordx2 a[180:181],v8,s[28:31],s0 offen sc1
 v_mfma_f32_16x16x32_bf16 v[236:239],v[48:51],a[12:15],v[236:239]
 v_mfma_f32_16x16x32_bf16 v[240:243],v[56:59],a[0:3],v[240:243]
 v_mfma_f32_16x16x32_bf16 v[240:243],v[60:63],a[16:19],v[240:243]
 buffer_load_dwordx2 a[182:183],v8,s[28:31],s0 offen offset:512 sc1
 v_mfma_f32_16x16x32_bf16 v[244:247],v[60:63],a[20:23],v[244:247]
 v_mfma_f32_16x16x32_bf16 v[244:247],v[56:59],a[4:7],v[244:247]
 s_add_u32 s0,s75,8192
 v_mfma_f32_16x16x32_bf16 v[248:251],v[56:59],a[8:11],v[248:251]
 buffer_load_dwordx4 a[184:187],v9,s[28:31],s0 offen sc1
 v_mfma_f32_16x16x32_bf16 v[248:251],v[60:63],a[24:27],v[248:251]
 v_mfma_f32_16x16x32_bf16 v[252:255],v[60:63],a[28:31],v[252:255]
 v_mfma_f32_16x16x32_bf16 v[252:255],v[56:59],a[12:15],v[252:255]
 s_waitcnt lgkmcnt(0)
 v_mfma_f32_16x16x32_bf16 v[64:67],v[16:19],a[32:35],v[64:67]
 ds_read_b64_tr_b16 v[40:41],v7 offset:8
 ds_read_b64_tr_b16 v[42:43],v7 offset:6152
 v_mfma_f32_16x16x32_bf16 v[64:67],v[20:23],a[48:51],v[64:67]
 v_mfma_f32_16x16x32_bf16 v[68:71],v[20:23],a[52:55],v[68:71]
 s_add_u32 s0,s75,28672
 ds_read_b64_tr_b16 v[44:45],v7 offset:12296
 ds_read_b64_tr_b16 v[46:47],v7 offset:18440
 v_mfma_f32_16x16x32_bf16 v[68:71],v[16:19],a[36:39],v[68:71]
 buffer_load_dwordx4 a[188:191],v9,s[28:31],s0 offen sc1
 v_mfma_f32_16x16x32_bf16 v[72:75],v[16:19],a[40:43],v[72:75]
 ds_read_b64_tr_b16 v[48:49],v6 offset:128
 ds_read_b64_tr_b16 v[50:51],v6 offset:6272
 v_mfma_f32_16x16x32_bf16 v[72:75],v[20:23],a[56:59],v[72:75]
 v_mfma_f32_16x16x32_bf16 v[76:79],v[20:23],a[60:63],v[76:79]
 ds_read_b64_tr_b16 v[52:53],v6 offset:12416
 ds_read_b64_tr_b16 v[54:55],v6 offset:18560
 v_mfma_f32_16x16x32_bf16 v[76:79],v[16:19],a[44:47],v[76:79]
 v_mfma_f32_16x16x32_bf16 v[80:83],v[24:27],a[32:35],v[80:83]
 ds_read_b64_tr_b16 v[56:57],v6 offset:136
 ds_read_b64_tr_b16 v[58:59],v6 offset:6280
 v_mfma_f32_16x16x32_bf16 v[80:83],v[28:31],a[48:51],v[80:83]
 v_mfma_f32_16x16x32_bf16 v[84:87],v[28:31],a[52:55],v[84:87]
 ds_read_b64_tr_b16 v[60:61],v6 offset:12424
 ds_read_b64_tr_b16 v[62:63],v6 offset:18568
 v_mfma_f32_16x16x32_bf16 v[84:87],v[24:27],a[36:39],v[84:87]
 v_mfma_f32_16x16x32_bf16 v[88:91],v[24:27],a[40:43],v[88:91]
 s_waitcnt vmcnt(28)
 ds_read_b128 a[0:3],v1
 ds_read_b128 a[16:19],v2
 v_mfma_f32_16x16x32_bf16 v[88:91],v[28:31],a[56:59],v[88:91]
 v_mfma_f32_16x16x32_bf16 v[92:95],v[28:31],a[60:63],v[92:95]
 ds_read_b128 a[4:7],v1 offset:2048
 ds_read_b128 a[20:23],v2 offset:2048
 v_mfma_f32_16x16x32_bf16 v[92:95],v[24:27],a[44:47],v[92:95]
 v_mfma_f32_16x16x32_bf16 v[96:99],v[32:35],a[32:35],v[96:99]
 ds_read_b128 a[8:11],v1 offset:4096
 ds_read_b128 a[24:27],v2 offset:4096
 v_mfma_f32_16x16x32_bf16 v[96:99],v[36:39],a[48:51],v[96:99]
 v_mfma_f32_16x16x32_bf16 v[100:103],v[36:39],a[52:55],v[100:103]
 ds_read_b128 a[12:15],v1 offset:6144
 ds_read_b128 a[28:31],v2 offset:6144
 v_mfma_f32_16x16x32_bf16 v[100:103],v[32:35],a[36:39],v[100:103]
 v_mfma_f32_16x16x32_bf16 v[104:107],v[32:35],a[40:43],v[104:107]
 v_mfma_f32_16x16x32_bf16 v[104:107],v[36:39],a[56:59],v[104:107]
 v_mfma_f32_16x16x32_bf16 v[108:111],v[36:39],a[60:63],v[108:111]
 v_mfma_f32_16x16x32_bf16 v[108:111],v[32:35],a[44:47],v[108:111]
 s_waitcnt lgkmcnt(0)
 v_mfma_f32_16x16x32_bf16 v[112:115],v[40:43],a[32:35],v[112:115]
 ds_read_b64_tr_b16 v[16:17],v7 offset:128
 ds_read_b64_tr_b16 v[18:19],v7 offset:6272
 v_mfma_f32_16x16x32_bf16 v[112:115],v[44:47],a[48:51],v[112:115]
 v_add_u32 v14,0,v0
 v_mul_u32_u24 v15,5462,v14
 v_mfma_f32_16x16x32_bf16 v[116:119],v[44:47],a[52:55],v[116:119]
 ds_read_b64_tr_b16 v[20:21],v7 offset:12416
 ds_read_b64_tr_b16 v[22:23],v7 offset:18560
 v_mfma_f32_16x16x32_bf16 v[116:119],v[40:43],a[36:39],v[116:119]
 v_lshrrev_b32 v15,16,v15
 v_lshrrev_b32 v14,1,v15
 v_mfma_f32_16x16x32_bf16 v[120:123],v[40:43],a[40:43],v[120:123]
 ds_read_b64_tr_b16 v[24:25],v7 offset:136
 ds_read_b64_tr_b16 v[26:27],v7 offset:6280
 v_mfma_f32_16x16x32_bf16 v[120:123],v[44:47],a[56:59],v[120:123]
 v_and_b32 v14,2,v14
 v_xor_b32 v14,v14,v0
 v_mfma_f32_16x16x32_bf16 v[124:127],v[44:47],a[60:63],v[124:127]
 ds_read_b64_tr_b16 v[28:29],v7 offset:12424
 ds_read_b64_tr_b16 v[30:31],v7 offset:18568
 v_mfma_f32_16x16x32_bf16 v[124:127],v[40:43],a[44:47],v[124:127]
 v_mul_u32_u24 v1,1088,v15
 v_lshl_add_u32 v1,v14,4,v1
 v_mfma_f32_16x16x32_bf16 v[128:131],v[48:51],a[32:35],v[128:131]
 ds_read_b64_tr_b16 v[32:33],v6 offset:256
 ds_read_b64_tr_b16 v[34:35],v6 offset:6400
 v_mfma_f32_16x16x32_bf16 v[128:131],v[52:55],a[48:51],v[128:131]
 v_add_u32 v14,64,v0
 v_mul_u32_u24 v15,5462,v14
 v_mfma_f32_16x16x32_bf16 v[132:135],v[52:55],a[52:55],v[132:135]
 ds_read_b64_tr_b16 v[36:37],v6 offset:12544
 ds_read_b64_tr_b16 v[38:39],v6 offset:18688
 v_mfma_f32_16x16x32_bf16 v[132:135],v[48:51],a[36:39],v[132:135]
 v_lshrrev_b32 v15,16,v15
 v_lshrrev_b32 v14,1,v15
 v_mfma_f32_16x16x32_bf16 v[136:139],v[48:51],a[40:43],v[136:139]
 v_and_b32 v14,2,v14
 v_xor_b32 v14,v14,v0
 v_mfma_f32_16x16x32_bf16 v[136:139],v[52:55],a[56:59],v[136:139]
 v_mul_u32_u24 v2,1088,v15
 v_lshl_add_u32 v2,v14,4,v2
 v_mfma_f32_16x16x32_bf16 v[140:143],v[52:55],a[60:63],v[140:143]
 v_add_u32 v14,128,v0
 v_mul_u32_u24 v15,5462,v14
 v_mfma_f32_16x16x32_bf16 v[140:143],v[48:51],a[44:47],v[140:143]
 v_lshrrev_b32 v15,16,v15
 v_lshrrev_b32 v14,1,v15
 v_mfma_f32_16x16x32_bf16 v[144:147],v[56:59],a[32:35],v[144:147]
 v_and_b32 v14,2,v14
 v_xor_b32 v14,v14,v0
 v_mfma_f32_16x16x32_bf16 v[144:147],v[60:63],a[48:51],v[144:147]
 v_mul_u32_u24 v3,1088,v15
 v_lshl_add_u32 v3,v14,4,v3
 v_mfma_f32_16x16x32_bf16 v[148:151],v[60:63],a[52:55],v[148:151]
 s_add_u32 m0,s35,73728
 s_mov_b32 s44,0
 buffer_load_dwordx4 v1,s[4:7],s44 offen lds
 v_mfma_f32_16x16x32_bf16 v[148:151],v[56:59],a[36:39],v[148:151]
 buffer_load_dwordx4 v2,s[4:7],s44 offen offset:1024 lds
 buffer_load_dwordx4 v3,s[4:7],s44 offen offset:2048 lds
 v_mfma_f32_16x16x32_bf16 v[152:155],v[56:59],a[40:43],v[152:155]
 v_mfma_f32_16x16x32_bf16 v[152:155],v[60:63],a[56:59],v[152:155]
 v_mfma_f32_16x16x32_bf16 v[156:159],v[60:63],a[60:63],v[156:159]
 v_mfma_f32_16x16x32_bf16 v[156:159],v[56:59],a[44:47],v[156:159]
 s_waitcnt lgkmcnt(0)
 v_mfma_f32_16x16x32_bf16 v[160:163],v[16:19],a[32:35],v[160:163]
 ds_read_b64_tr_b16 v[40:41],v6 offset:264
 ds_read_b64_tr_b16 v[42:43],v6 offset:6408
 v_mfma_f32_16x16x32_bf16 v[160:163],v[20:23],a[48:51],v[160:163]
 s_add_u32 m0,s35,76800
 s_add_u32 s44,s44,20480
 buffer_load_dwordx4 v1,s[4:7],s44 offen lds
 v_mfma_f32_16x16x32_bf16 v[164:167],v[20:23],a[52:55],v[164:167]
 ds_read_b64_tr_b16 v[44:45],v6 offset:12552
 ds_read_b64_tr_b16 v[46:47],v6 offset:18696
 v_mfma_f32_16x16x32_bf16 v[164:167],v[16:19],a[36:39],v[164:167]
 v_mfma_f32_16x16x32_bf16 v[168:171],v[16:19],a[40:43],v[168:171]
 ds_read_b64_tr_b16 v[48:49],v7 offset:256
 ds_read_b64_tr_b16 v[50:51],v7 offset:6400
 v_mfma_f32_16x16x32_bf16 v[168:171],v[20:23],a[56:59],v[168:171]
 v_mfma_f32_16x16x32_bf16 v[172:175],v[20:23],a[60:63],v[172:175]
 ds_read_b64_tr_b16 v[52:53],v7 offset:12544
 ds_read_b64_tr_b16 v[54:55],v7 offset:18688
 v_mfma_f32_16x16x32_bf16 v[172:175],v[16:19],a[44:47],v[172:175]
 v_mfma_f32_16x16x32_bf16 v[176:179],v[24:27],a[32:35],v[176:179]
 ds_read_b64_tr_b16 v[56:57],v7 offset:264
 ds_read_b64_tr_b16 v[58:59],v7 offset:6408
 v_mfma_f32_16x16x32_bf16 v[176:179],v[28:31],a[48:51],v[176:179]
 v_mfma_f32_16x16x32_bf16 v[180:183],v[28:31],a[52:55],v[180:183]
 ds_read_b64_tr_b16 v[60:61],v7 offset:12552
 ds_read_b64_tr_b16 v[62:63],v7 offset:18696
 v_mfma_f32_16x16x32_bf16 v[180:183],v[24:27],a[36:39],v[180:183]
 buffer_load_dwordx4 v2,s[4:7],s44 offen offset:1024 lds
 v_mfma_f32_16x16x32_bf16 v[184:187],v[24:27],a[40:43],v[184:187]
 v_mfma_f32_16x16x32_bf16 v[184:187],v[28:31],a[56:59],v[184:187]
 v_mfma_f32_16x16x32_bf16 v[188:191],v[28:31],a[60:63],v[188:191]
 v_mfma_f32_16x16x32_bf16 v[188:191],v[24:27],a[44:47],v[188:191]
 v_mfma_f32_16x16x32_bf16 v[192:195],v[32:35],a[32:35],v[192:195]
 v_mfma_f32_16x16x32_bf16 v[192:195],v[36:39],a[48:51],v[192:195]
 v_mfma_f32_16x16x32_bf16 v[196:199],v[36:39],a[52:55],v[196:199]
 v_mfma_f32_16x16x32_bf16 v[196:199],v[32:35],a[36:39],v[196:199]
 buffer_load_dwordx4 v3,s[4:7],s44 offen offset:2048 lds
 v_mfma_f32_16x16x32_bf16 v[200:203],v[32:35],a[40:43],v[200:203]
 s_mov_b32 s50,24576
 v_add_u32 v6,s50,v6
 v_add_u32 v7,s50,v7
 v_mfma_f32_16x16x32_bf16 v[200:203],v[36:39],a[56:59],v[200:203]
 v_mfma_f32_16x16x32_bf16 v[204:207],v[36:39],a[60:63],v[204:207]
 v_mfma_f32_16x16x32_bf16 v[204:207],v[32:35],a[44:47],v[204:207]
 s_waitcnt vmcnt(48) lgkmcnt(0)
 s_barrier
 v_mfma_f32_16x16x32_bf16 v[208:211],v[40:43],a[32:35],v[208:211]
 ds_read_b64_tr_b16 v[16:17],v6
 ds_read_b64_tr_b16 v[18:19],v6 offset:6144
 v_mfma_f32_16x16x32_bf16 v[208:211],v[44:47],a[48:51],v[208:211]
 v_mfma_f32_16x16x32_bf16 v[212:215],v[44:47],a[52:55],v[212:215]
 ds_read_b64_tr_b16 v[20:21],v6 offset:12288
 ds_read_b64_tr_b16 v[22:23],v6 offset:18432
 v_mfma_f32_16x16x32_bf16 v[212:215],v[40:43],a[36:39],v[212:215]
 s_add_u32 m0,s35,98304
 s_mov_b32 s44,163840
 buffer_load_dwordx4 v1,s[4:7],s44 offen lds
 v_mfma_f32_16x16x32_bf16 v[216:219],v[40:43],a[40:43],v[216:219]
 ds_read_b64_tr_b16 v[24:25],v6 offset:8
 ds_read_b64_tr_b16 v[26:27],v6 offset:6152
 v_mfma_f32_16x16x32_bf16 v[216:219],v[44:47],a[56:59],v[216:219]
 v_mfma_f32_16x16x32_bf16 v[220:223],v[44:47],a[60:63],v[220:223]
 ds_read_b64_tr_b16 v[28:29],v6 offset:12296
 ds_read_b64_tr_b16 v[30:31],v6 offset:18440
 v_mfma_f32_16x16x32_bf16 v[220:223],v[40:43],a[44:47],v[220:223]
 v_mfma_f32_16x16x32_bf16 v[224:227],v[48:51],a[32:35],v[224:227]
 ds_read_b64_tr_b16 v[32:33],v7
 ds_read_b64_tr_b16 v[34:35],v7 offset:6144
 v_mfma_f32_16x16x32_bf16 v[224:227],v[52:55],a[48:51],v[224:227]
 v_mfma_f32_16x16x32_bf16 v[228:231],v[52:55],a[52:55],v[228:231]
 ds_read_b64_tr_b16 v[36:37],v7 offset:12288
 ds_read_b64_tr_b16 v[38:39],v7 offset:18432
 v_mfma_f32_16x16x32_bf16 v[228:231],v[48:51],a[36:39],v[228:231]
 v_mfma_f32_16x16x32_bf16 v[232:235],v[48:51],a[40:43],v[232:235]
 buffer_load_dwordx4 v2,s[4:7],s44 offen offset:1024 lds
 v_mfma_f32_16x16x32_bf16 v[232:235],v[52:55],a[56:59],v[232:235]
 v_mfma_f32_16x16x32_bf16 v[236:239],v[52:55],a[60:63],v[236:239]
 v_mfma_f32_16x16x32_bf16 v[236:239],v[48:51],a[44:47],v[236:239]
 v_mfma_f32_16x16x32_bf16 v[240:243],v[56:59],a[32:35],v[240:243]
 v_mfma_f32_16x16x32_bf16 v[240:243],v[60:63],a[48:51],v[240:243]
 v_mfma_f32_16x16x32_bf16 v[244:247],v[60:63],a[52:55],v[244:247]
 v_mfma_f32_16x16x32_bf16 v[244:247],v[56:59],a[36:39],v[244:247]
 v_mfma_f32_16x16x32_bf16 v[248:251],v[56:59],a[40:43],v[248:251]
 v_mfma_f32_16x16x32_bf16 v[248:251],v[60:63],a[56:59],v[248:251]
 buffer_load_dwordx4 v3,s[4:7],s44 offen offset:2048 lds
 v_mfma_f32_16x16x32_bf16 v[252:255],v[60:63],a[60:63],v[252:255]
 v_mfma_f32_16x16x32_bf16 v[252:255],v[56:59],a[44:47],v[252:255]
 s_waitcnt lgkmcnt(0)
 v_mfma_f32_16x16x32_bf16 v[64:67],v[16:19],a[64:67],v[64:67]
 ds_read_b64_tr_b16 v[40:41],v7 offset:8
 ds_read_b64_tr_b16 v[42:43],v7 offset:6152
 v_mfma_f32_16x16x32_bf16 v[64:67],v[20:23],a[80:83],v[64:67]
 v_mfma_f32_16x16x32_bf16 v[68:71],v[20:23],a[84:87],v[68:71]
 s_add_u32 s0,s75,9216
 ds_read_b64_tr_b16 v[44:45],v7 offset:12296
 ds_read_b64_tr_b16 v[46:47],v7 offset:18440
 v_mfma_f32_16x16x32_bf16 v[68:71],v[16:19],a[68:71],v[68:71]
 buffer_load_dwordx4 a[32:35],v9,s[28:31],s0 offen sc1
 s_add_u32 s0,s75,29696
 buffer_load_dwordx4 a[36:39],v9,s[28:31],s0 offen sc1
 v_mfma_f32_16x16x32_bf16 v[72:75],v[16:19],a[72:75],v[72:75]
 ds_read_b64_tr_b16 v[48:49],v6 offset:128
 ds_read_b64_tr_b16 v[50:51],v6 offset:6272
 v_mfma_f32_16x16x32_bf16 v[72:75],v[20:23],a[88:91],v[72:75]
 v_mfma_f32_16x16x32_bf16 v[76:79],v[20:23],a[92:95],v[76:79]
 ds_read_b64_tr_b16 v[52:53],v6 offset:12416
 ds_read_b64_tr_b16 v[54:55],v6 offset:18560
 v_mfma_f32_16x16x32_bf16 v[76:79],v[16:19],a[76:79],v[76:79]
 s_add_u32 m0,s35,101376
 s_add_u32 s44,s44,20480
 buffer_load_dwordx4 v1,s[4:7],s44 offen lds
 v_mfma_f32_16x16x32_bf16 v[80:83],v[24:27],a[64:67],v[80:83]
 ds_read_b64_tr_b16 v[56:57],v6 offset:136
 ds_read_b64_tr_b16 v[58:59],v6 offset:6280
 v_mfma_f32_16x16x32_bf16 v[80:83],v[28:31],a[80:83],v[80:83]
 v_mfma_f32_16x16x32_bf16 v[84:87],v[28:31],a[84:87],v[84:87]
 s_add_u32 s0,s75,10240
 ds_read_b64_tr_b16 v[60:61],v6 offset:12424
 ds_read_b64_tr_b16 v[62:63],v6 offset:18568
 v_mfma_f32_16x16x32_bf16 v[84:87],v[24:27],a[68:71],v[84:87]
 buffer_load_dwordx4 a[40:43],v9,s[28:31],s0 offen sc1
 v_mfma_f32_16x16x32_bf16 v[88:91],v[24:27],a[72:75],v[88:91]
 v_mfma_f32_16x16x32_bf16 v[88:91],v[28:31],a[88:91],v[88:91]
 v_mfma_f32_16x16x32_bf16 v[92:95],v[28:31],a[92:95],v[92:95]
 v_mfma_f32_16x16x32_bf16 v[92:95],v[24:27],a[76:79],v[92:95]
 buffer_load_dwordx4 v2,s[4:7],s44 offen offset:1024 lds
 v_mfma_f32_16x16x32_bf16 v[96:99],v[32:35],a[64:67],v[96:99]
 v_mfma_f32_16x16x32_bf16 v[96:99],v[36:39],a[80:83],v[96:99]
 v_mfma_f32_16x16x32_bf16 v[100:103],v[36:39],a[84:87],v[100:103]
 s_add_u32 s0,s75,30720
 v_mfma_f32_16x16x32_bf16 v[100:103],v[32:35],a[68:71],v[100:103]
 buffer_load_dwordx4 a[44:47],v9,s[28:31],s0 offen sc1
 v_mfma_f32_16x16x32_bf16 v[104:107],v[32:35],a[72:75],v[104:107]
 v_mfma_f32_16x16x32_bf16 v[104:107],v[36:39],a[88:91],v[104:107]
 v_mfma_f32_16x16x32_bf16 v[108:111],v[36:39],a[92:95],v[108:111]
 v_mfma_f32_16x16x32_bf16 v[108:111],v[32:35],a[76:79],v[108:111]
 s_waitcnt lgkmcnt(0)
 v_mfma_f32_16x16x32_bf16 v[112:115],v[40:43],a[64:67],v[112:115]
 ds_read_b64_tr_b16 v[16:17],v7 offset:128
 ds_read_b64_tr_b16 v[18:19],v7 offset:6272
 v_mfma_f32_16x16x32_bf16 v[112:115],v[44:47],a[80:83],v[112:115]
 buffer_load_dwordx4 v3,s[4:7],s44 offen offset:2048 lds
 v_mfma_f32_16x16x32_bf16 v[116:119],v[44:47],a[84:87],v[116:119]
 ds_read_b64_tr_b16 v[20:21],v7 offset:12416
 ds_read_b64_tr_b16 v[22:23],v7 offset:18560
 v_mfma_f32_16x16x32_bf16 v[116:119],v[40:43],a[68:71],v[116:119]
 v_mfma_f32_16x16x32_bf16 v[120:123],v[40:43],a[72:75],v[120:123]
 s_add_u32 s0,s75,11264
 ds_read_b64_tr_b16 v[24:25],v7 offset:136
 ds_read_b64_tr_b16 v[26:27],v7 offset:6280
 v_mfma_f32_16x16x32_bf16 v[120:123],v[44:47],a[88:91],v[120:123]
 buffer_load_dwordx4 a[48:51],v9,s[28:31],s0 offen sc1
 v_mfma_f32_16x16x32_bf16 v[124:127],v[44:47],a[92:95],v[124:127]
 ds_read_b64_tr_b16 v[28:29],v7 offset:12424
 ds_read_b64_tr_b16 v[30:31],v7 offset:18568
 v_mfma_f32_16x16x32_bf16 v[124:127],v[40:43],a[76:79],v[124:127]
 v_mfma_f32_16x16x32_bf16 v[128:131],v[48:51],a[64:67],v[128:131]
 ds_read_b64_tr_b16 v[32:33],v6 offset:256
 ds_read_b64_tr_b16 v[34:35],v6 offset:6400
 v_mfma_f32_16x16x32_bf16 v[128:131],v[52:55],a[80:83],v[128:131]
 s_add_u32 m0,s35,122880
 s_mov_b32 s44,327680
 buffer_load_dwordx4 v1,s[4:7],s44 offen lds
 v_mfma_f32_16x16x32_bf16 v[132:135],v[52:55],a[84:87],v[132:135]
 ds_read_b64_tr_b16 v[36:37],v6 offset:12544
 ds_read_b64_tr_b16 v[38:39],v6 offset:18688
 v_mfma_f32_16x16x32_bf16 v[132:135],v[48:51],a[68:71],v[132:135]
 v_mfma_f32_16x16x32_bf16 v[136:139],v[48:51],a[72:75],v[136:139]
 s_add_u32 s0,s75,31744
 v_mfma_f32_16x16x32_bf16 v[136:139],v[52:55],a[88:91],v[136:139]
 buffer_load_dwordx4 a[52:55],v9,s[28:31],s0 offen sc1
 v_mfma_f32_16x16x32_bf16 v[140:143],v[52:55],a[92:95],v[140:143]
 v_mfma_f32_16x16x32_bf16 v[140:143],v[48:51],a[76:79],v[140:143]
 v_mfma_f32_16x16x32_bf16 v[144:147],v[56:59],a[64:67],v[144:147]
 s_waitcnt vmcnt(55)
 v_cmp_lt_u32 vcc,31,v0
 v_and_b32 v14,16,v0
 v_mfma_f32_16x16x32_bf16 v[144:147],v[60:63],a[80:83],v[144:147]
 v_cmp_eq_u32 s[38:39],0,v14
 v_accvgpr_read_b32 v14,a240
 v_mfma_f32_16x16x32_bf16 v[148:151],v[60:63],a[84:87],v[148:151]
 buffer_load_dwordx4 v2,s[4:7],s44 offen offset:1024 lds
 v_accvgpr_read_b32 v10,a241
 v_cvt_pk_bf16_f32 v15,v14,v14
 v_mfma_f32_16x16x32_bf16 v[148:151],v[56:59],a[68:71],v[148:151]
 v_lshlrev_b32 v4,16,v15
 v_sub_f32 v4,v14,v4
 v_mfma_f32_16x16x32_bf16 v[152:155],v[56:59],a[72:75],v[152:155]
 v_cvt_pk_bf16_f32 v4,v4,v4
 v_cndmask_b32 v15,v15,v4,vcc
 v_mfma_f32_16x16x32_bf16 v[152:155],v[60:63],a[88:91],v[152:155]
 v_cndmask_b32 v15,0,v15,s[38:39]
 v_accvgpr_write_b32 a240,v15
 v_mfma_f32_16x16x32_bf16 v[156:159],v[60:63],a[92:95],v[156:159]
 s_add_u32 s0,s75,12288
 v_accvgpr_write_b32 a241,v15
 v_accvgpr_write_b32 a242,v15
 v_mfma_f32_16x16x32_bf16 v[156:159],v[56:59],a[76:79],v[156:159]
 buffer_load_dwordx2 a[56:57],v8,s[28:31],s0 offen sc1
 s_waitcnt lgkmcnt(0)
 v_accvgpr_write_b32 a243,v15
 v_accvgpr_read_b32 v14,a244
 v_mfma_f32_16x16x32_bf16 v[160:163],v[16:19],a[64:67],v[160:163]
 ds_read_b64_tr_b16 v[40:41],v6 offset:264
 ds_read_b64_tr_b16 v[42:43],v6 offset:6408
 v_mfma_f32_16x16x32_bf16 v[160:163],v[20:23],a[80:83],v[160:163]
 v_accvgpr_read_b32 v11,a245
 v_cvt_pk_bf16_f32 v15,v14,v14
 v_mfma_f32_16x16x32_bf16 v[164:167],v[20:23],a[84:87],v[164:167]
 buffer_load_dwordx2 a[58:59],v8,s[28:31],s0 offen offset:512 sc1
 ds_read_b64_tr_b16 v[44:45],v6 offset:12552
 ds_read_b64_tr_b16 v[46:47],v6 offset:18696
 v_mfma_f32_16x16x32_bf16 v[164:167],v[16:19],a[68:71],v[164:167]
 buffer_load_dwordx4 v3,s[4:7],s44 offen offset:2048 lds
 v_lshlrev_b32 v4,16,v15
 v_sub_f32 v4,v14,v4
 v_mfma_f32_16x16x32_bf16 v[168:171],v[16:19],a[72:75],v[168:171]
 ds_read_b64_tr_b16 v[48:49],v7 offset:256
 ds_read_b64_tr_b16 v[50:51],v7 offset:6400
 v_mfma_f32_16x16x32_bf16 v[168:171],v[20:23],a[88:91],v[168:171]
 v_cvt_pk_bf16_f32 v4,v4,v4
 v_cndmask_b32 v15,v15,v4,vcc
 v_mfma_f32_16x16x32_bf16 v[172:175],v[20:23],a[92:95],v[172:175]
 ds_read_b64_tr_b16 v[52:53],v7 offset:12544
 ds_read_b64_tr_b16 v[54:55],v7 offset:18688
 v_mfma_f32_16x16x32_bf16 v[172:175],v[16:19],a[76:79],v[172:175]
 s_add_u32 s0,s75,32768
 v_cndmask_b32 v15,0,v15,s[38:39]
 v_accvgpr_write_b32 a244,v15
 v_mfma_f32_16x16x32_bf16 v[176:179],v[24:27],a[64:67],v[176:179]
 buffer_load_dwordx2 a[60:61],v8,s[28:31],s0 offen sc1
 ds_read_b64_tr_b16 v[56:57],v7 offset:264
 ds_read_b64_tr_b16 v[58:59],v7 offset:6408
 v_mfma_f32_16x16x32_bf16 v[176:179],v[28:31],a[80:83],v[176:179]
 v_accvgpr_write_b32 a245,v15
 v_accvgpr_write_b32 a246,v15
 v_mfma_f32_16x16x32_bf16 v[180:183],v[28:31],a[84:87],v[180:183]
 ds_read_b64_tr_b16 v[60:61],v7 offset:12552
 ds_read_b64_tr_b16 v[62:63],v7 offset:18696
 v_mfma_f32_16x16x32_bf16 v[180:183],v[24:27],a[68:71],v[180:183]
 buffer_load_dwordx2 a[62:63],v8,s[28:31],s0 offen offset:512 sc1
 v_accvgpr_write_b32 a247,v15
 v_accvgpr_read_b32 v14,a248
 v_mfma_f32_16x16x32_bf16 v[184:187],v[24:27],a[72:75],v[184:187]
 s_add_u32 m0,s35,125952
 s_add_u32 s44,s44,20480
 buffer_load_dwordx4 v1,s[4:7],s44 offen lds
 v_accvgpr_read_b32 v12,a249
 v_cvt_pk_bf16_f32 v15,v14,v14
 v_mfma_f32_16x16x32_bf16 v[184:187],v[28:31],a[88:91],v[184:187]
 v_lshlrev_b32 v4,16,v15
 v_sub_f32 v4,v14,v4
 v_mfma_f32_16x16x32_bf16 v[188:191],v[28:31],a[92:95],v[188:191]
 v_cvt_pk_bf16_f32 v4,v4,v4
 v_cndmask_b32 v15,v15,v4,vcc
 v_mfma_f32_16x16x32_bf16 v[188:191],v[24:27],a[76:79],v[188:191]
 v_cndmask_b32 v15,0,v15,s[38:39]
 v_accvgpr_write_b32 a248,v15
 v_mfma_f32_16x16x32_bf16 v[192:195],v[32:35],a[64:67],v[192:195]
 v_accvgpr_write_b32 a249,v15
 v_accvgpr_write_b32 a250,v15
 v_mfma_f32_16x16x32_bf16 v[192:195],v[36:39],a[80:83],v[192:195]
 v_accvgpr_write_b32 a251,v15
 v_accvgpr_read_b32 v14,a252
 v_mfma_f32_16x16x32_bf16 v[196:199],v[36:39],a[84:87],v[196:199]
 v_accvgpr_read_b32 v13,a253
 v_cvt_pk_bf16_f32 v15,v14,v14
 v_mfma_f32_16x16x32_bf16 v[196:199],v[32:35],a[68:71],v[196:199]
 v_lshlrev_b32 v4,16,v15
 v_sub_f32 v4,v14,v4
 v_mfma_f32_16x16x32_bf16 v[200:203],v[32:35],a[72:75],v[200:203]
 s_mov_b32 s50,24576
 v_add_u32 v6,s50,v6
 v_add_u32 v7,s50,v7
 v_mfma_f32_16x16x32_bf16 v[200:203],v[36:39],a[88:91],v[200:203]
 buffer_load_dwordx4 v2,s[4:7],s44 offen offset:1024 lds
 v_cvt_pk_bf16_f32 v4,v4,v4
 v_cndmask_b32 v15,v15,v4,vcc
 v_mfma_f32_16x16x32_bf16 v[204:207],v[36:39],a[92:95],v[204:207]
 v_cndmask_b32 v15,0,v15,s[38:39]
 v_accvgpr_write_b32 a252,v15
 v_mfma_f32_16x16x32_bf16 v[204:207],v[32:35],a[76:79],v[204:207]
 s_waitcnt vmcnt(49) lgkmcnt(0)
 s_barrier
 v_accvgpr_write_b32 a253,v15
 v_mfma_f32_16x16x32_bf16 v[208:211],v[40:43],a[64:67],v[208:211]
 ds_read_b64_tr_b16 v[16:17],v6
 ds_read_b64_tr_b16 v[18:19],v6 offset:6144
 v_mfma_f32_16x16x32_bf16 v[208:211],v[44:47],a[80:83],v[208:211]
 v_accvgpr_write_b32 a254,v15
 v_accvgpr_write_b32 a255,v15
 v_mfma_f32_16x16x32_bf16 v[212:215],v[44:47],a[84:87],v[212:215]
 ds_read_b64_tr_b16 v[20:21],v6 offset:12288
 ds_read_b64_tr_b16 v[22:23],v6 offset:18432
 v_mfma_f32_16x16x32_bf16 v[212:215],v[40:43],a[68:71],v[212:215]
 buffer_load_dwordx4 v3,s[4:7],s44 offen offset:2048 lds
 v_mfma_f32_16x16x32_bf16 v[216:219],v[40:43],a[72:75],v[216:219]
 ds_read_b64_tr_b16 v[24:25],v6 offset:8
 ds_read_b64_tr_b16 v[26:27],v6 offset:6152
 v_mfma_f32_16x16x32_bf16 v[216:219],v[44:47],a[88:91],v[216:219]
 v_mfma_f32_16x16x32_bf16 v[220:223],v[44:47],a[92:95],v[220:223]
 ds_read_b64_tr_b16 v[28:29],v6 offset:12296
 ds_read_b64_tr_b16 v[30:31],v6 offset:18440
 v_mfma_f32_16x16x32_bf16 v[220:223],v[40:43],a[76:79],v[220:223]
 v_mfma_f32_16x16x32_bf16 v[224:227],v[48:51],a[64:67],v[224:227]
 ds_read_b64_tr_b16 v[32:33],v7
 ds_read_b64_tr_b16 v[34:35],v7 offset:6144
 v_mfma_f32_16x16x32_bf16 v[224:227],v[52:55],a[80:83],v[224:227]
 v_mfma_f32_16x16x32_bf16 v[228:231],v[52:55],a[84:87],v[228:231]
 ds_read_b64_tr_b16 v[36:37],v7 offset:12288
 ds_read_b64_tr_b16 v[38:39],v7 offset:18432
 v_mfma_f32_16x16x32_bf16 v[228:231],v[48:51],a[68:71],v[228:231]
 v_mfma_f32_16x16x32_bf16 v[232:235],v[48:51],a[72:75],v[232:235]
 s_add_u32 m0,s35,0
 s_mov_b32 s44,491520
 buffer_load_dwordx4 v1,s[4:7],s44 offen lds
 v_mfma_f32_16x16x32_bf16 v[232:235],v[52:55],a[88:91],v[232:235]
 v_mfma_f32_16x16x32_bf16 v[236:239],v[52:55],a[92:95],v[236:239]
 v_mfma_f32_16x16x32_bf16 v[236:239],v[48:51],a[76:79],v[236:239]
 v_mfma_f32_16x16x32_bf16 v[240:243],v[56:59],a[64:67],v[240:243]
 v_mfma_f32_16x16x32_bf16 v[240:243],v[60:63],a[80:83],v[240:243]
 v_mfma_f32_16x16x32_bf16 v[244:247],v[60:63],a[84:87],v[244:247]
 v_mfma_f32_16x16x32_bf16 v[244:247],v[56:59],a[68:71],v[244:247]
 v_mfma_f32_16x16x32_bf16 v[248:251],v[56:59],a[72:75],v[248:251]
 v_mfma_f32_16x16x32_bf16 v[248:251],v[60:63],a[88:91],v[248:251]
 buffer_load_dwordx4 v2,s[4:7],s44 offen offset:1024 lds
 v_mfma_f32_16x16x32_bf16 v[252:255],v[60:63],a[92:95],v[252:255]
 v_mfma_f32_16x16x32_bf16 v[252:255],v[56:59],a[76:79],v[252:255]
 s_waitcnt lgkmcnt(0)
 v_mfma_f32_16x16x32_bf16 v[64:67],a[192:195],a[240:243],v[64:67]
 v_mfma_f32_16x16x32_bf16 v[68:71],a[192:195],a[244:247],v[68:71]
 v_mfma_f32_16x16x32_bf16 v[72:75],a[192:195],a[248:251],v[72:75]
 s_add_u32 s0,s75,13312
 buffer_load_dwordx4 a[64:67],v9,s[28:31],s0 offen sc1
 s_add_u32 s0,s75,33792
 buffer_load_dwordx4 a[68:71],v9,s[28:31],s0 offen sc1
 v_mfma_f32_16x16x32_bf16 v[76:79],a[192:195],a[252:255],v[76:79]
 v_mfma_f32_16x16x32_bf16 v[80:83],a[196:199],a[240:243],v[80:83]
 v_mfma_f32_16x16x32_bf16 v[84:87],a[196:199],a[244:247],v[84:87]
 s_add_u32 s0,s75,14336
 v_mfma_f32_16x16x32_bf16 v[88:91],a[196:199],a[248:251],v[88:91]
 buffer_load_dwordx4 a[72:75],v9,s[28:31],s0 offen sc1
 v_mfma_f32_16x16x32_bf16 v[92:95],a[196:199],a[252:255],v[92:95]
 buffer_load_dwordx4 v3,s[4:7],s44 offen offset:2048 lds
 v_mfma_f32_16x16x32_bf16 v[96:99],a[200:203],a[240:243],v[96:99]
 v_mfma_f32_16x16x32_bf16 v[100:103],a[200:203],a[244:247],v[100:103]
 v_mfma_f32_16x16x32_bf16 v[104:107],a[200:203],a[248:251],v[104:107]
 v_mfma_f32_16x16x32_bf16 v[108:111],a[200:203],a[252:255],v[108:111]
 v_mfma_f32_16x16x32_bf16 v[112:115],a[204:207],a[240:243],v[112:115]
 s_add_u32 m0,s35,3072
 s_add_u32 s44,s44,20480
 buffer_load_dwordx4 v1,s[4:7],s44 offen lds
 v_mfma_f32_16x16x32_bf16 v[116:119],a[204:207],a[244:247],v[116:119]
 v_mfma_f32_16x16x32_bf16 v[120:123],a[204:207],a[248:251],v[120:123]
 v_mfma_f32_16x16x32_bf16 v[124:127],a[204:207],a[252:255],v[124:127]
 s_add_u32 s0,s75,34816
 v_mfma_f32_16x16x32_bf16 v[128:131],a[208:211],a[240:243],v[128:131]
 buffer_load_dwordx4 a[76:79],v9,s[28:31],s0 offen sc1
 v_mfma_f32_16x16x32_bf16 v[132:135],a[208:211],a[244:247],v[132:135]
 v_mfma_f32_16x16x32_bf16 v[136:139],a[208:211],a[248:251],v[136:139]
 v_mfma_f32_16x16x32_bf16 v[140:143],a[208:211],a[252:255],v[140:143]
 v_mfma_f32_16x16x32_bf16 v[144:147],a[212:215],a[240:243],v[144:147]
 v_mfma_f32_16x16x32_bf16 v[148:151],a[212:215],a[244:247],v[148:151]
 v_mfma_f32_16x16x32_bf16 v[152:155],a[212:215],a[248:251],v[152:155]
 v_mfma_f32_16x16x32_bf16 v[156:159],a[212:215],a[252:255],v[156:159]
 buffer_load_dwordx4 v2,s[4:7],s44 offen offset:1024 lds
 v_mfma_f32_16x16x32_bf16 v[160:163],a[216:219],a[240:243],v[160:163]
 v_mfma_f32_16x16x32_bf16 v[164:167],a[216:219],a[244:247],v[164:167]
 v_mfma_f32_16x16x32_bf16 v[168:171],a[216:219],a[248:251],v[168:171]
 s_add_u32 s0,s75,15360
 v_mfma_f32_16x16x32_bf16 v[172:175],a[216:219],a[252:255],v[172:175]
 buffer_load_dwordx4 a[80:83],v9,s[28:31],s0 offen sc1
 v_mfma_f32_16x16x32_bf16 v[176:179],a[220:223],a[240:243],v[176:179]
 v_mfma_f32_16x16x32_bf16 v[180:183],a[220:223],a[244:247],v[180:183]
 v_mfma_f32_16x16x32_bf16 v[184:187],a[220:223],a[248:251],v[184:187]
 v_mfma_f32_16x16x32_bf16 v[188:191],a[220:223],a[252:255],v[188:191]
 v_mfma_f32_16x16x32_bf16 v[192:195],a[224:227],a[240:243],v[192:195]
 v_mfma_f32_16x16x32_bf16 v[196:199],a[224:227],a[244:247],v[196:199]
 buffer_load_dwordx4 v3,s[4:7],s44 offen offset:2048 lds
 v_mfma_f32_16x16x32_bf16 v[200:203],a[224:227],a[248:251],v[200:203]
 v_mfma_f32_16x16x32_bf16 v[204:207],a[224:227],a[252:255],v[204:207]
 v_mfma_f32_16x16x32_bf16 v[208:211],a[228:231],a[240:243],v[208:211]
 v_mfma_f32_16x16x32_bf16 v[212:215],a[228:231],a[244:247],v[212:215]
 s_add_u32 s0,s75,35840
 v_mfma_f32_16x16x32_bf16 v[216:219],a[228:231],a[248:251],v[216:219]
 buffer_load_dwordx4 a[84:87],v9,s[28:31],s0 offen sc1
 v_mfma_f32_16x16x32_bf16 v[220:223],a[228:231],a[252:255],v[220:223]
 v_mfma_f32_16x16x32_bf16 v[224:227],a[232:235],a[240:243],v[224:227]
 v_mfma_f32_16x16x32_bf16 v[228:231],a[232:235],a[244:247],v[228:231]
 v_mfma_f32_16x16x32_bf16 v[232:235],a[232:235],a[248:251],v[232:235]
 v_mfma_f32_16x16x32_bf16 v[236:239],a[232:235],a[252:255],v[236:239]
 s_add_u32 m0,s35,24576
 s_mov_b32 s44,655360
 buffer_load_dwordx4 v1,s[4:7],s44 offen lds
 v_mfma_f32_16x16x32_bf16 v[240:243],a[236:239],a[240:243],v[240:243]
 v_mfma_f32_16x16x32_bf16 v[244:247],a[236:239],a[244:247],v[244:247]
 v_mfma_f32_16x16x32_bf16 v[248:251],a[236:239],a[248:251],v[248:251]
 v_mfma_f32_16x16x32_bf16 v[252:255],a[236:239],a[252:255],v[252:255]
 v_mfma_f32_16x16x32_bf16 v[64:67],v[16:19],a[0:3],v[64:67]
 ds_read_b64_tr_b16 v[40:41],v7 offset:8
 ds_read_b64_tr_b16 v[42:43],v7 offset:6152
 v_mfma_f32_16x16x32_bf16 v[64:67],v[20:23],a[16:19],v[64:67]
 buffer_load_dwordx4 v2,s[4:7],s44 offen offset:1024 lds
 v_mfma_f32_16x16x32_bf16 v[68:71],v[20:23],a[20:23],v[68:71]
 ds_read_b64_tr_b16 v[44:45],v7 offset:12296
 ds_read_b64_tr_b16 v[46:47],v7 offset:18440
 v_mfma_f32_16x16x32_bf16 v[68:71],v[16:19],a[4:7],v[68:71]
 v_mfma_f32_16x16x32_bf16 v[72:75],v[16:19],a[8:11],v[72:75]
 s_add_u32 s0,s75,16384
 ds_read_b64_tr_b16 v[48:49],v6 offset:128
 ds_read_b64_tr_b16 v[50:51],v6 offset:6272
 v_mfma_f32_16x16x32_bf16 v[72:75],v[20:23],a[24:27],v[72:75]
 buffer_load_dwordx4 a[88:91],v9,s[28:31],s0 offen sc1
 v_mfma_f32_16x16x32_bf16 v[76:79],v[20:23],a[28:31],v[76:79]
 ds_read_b64_tr_b16 v[52:53],v6 offset:12416
 ds_read_b64_tr_b16 v[54:55],v6 offset:18560
 v_mfma_f32_16x16x32_bf16 v[76:79],v[16:19],a[12:15],v[76:79]
 v_mfma_f32_16x16x32_bf16 v[80:83],v[24:27],a[0:3],v[80:83]
 ds_read_b64_tr_b16 v[56:57],v6 offset:136
 ds_read_b64_tr_b16 v[58:59],v6 offset:6280
 v_mfma_f32_16x16x32_bf16 v[80:83],v[28:31],a[16:19],v[80:83]
 v_mfma_f32_16x16x32_bf16 v[84:87],v[28:31],a[20:23],v[84:87]
 ds_read_b64_tr_b16 v[60:61],v6 offset:12424
 ds_read_b64_tr_b16 v[62:63],v6 offset:18568
 v_mfma_f32_16x16x32_bf16 v[84:87],v[24:27],a[4:7],v[84:87]
 buffer_load_dwordx4 v3,s[4:7],s44 offen offset:2048 lds
 v_mfma_f32_16x16x32_bf16 v[88:91],v[24:27],a[8:11],v[88:91]
 v_mfma_f32_16x16x32_bf16 v[88:91],v[28:31],a[24:27],v[88:91]
 v_mul_f32 v64,v64,v10
 v_mul_f32 v65,v65,v10
 v_mfma_f32_16x16x32_bf16 v[92:95],v[28:31],a[28:31],v[92:95]
 s_add_u32 s0,s75,36864
 v_mul_f32 v66,v66,v10
 v_mul_f32 v67,v67,v10
 v_mfma_f32_16x16x32_bf16 v[92:95],v[24:27],a[12:15],v[92:95]
 buffer_load_dwordx4 a[92:95],v9,s[28:31],s0 offen sc1
 v_cvt_pk_bf16_f32 v64,v64,v65
 v_cvt_pk_bf16_f32 v65,v66,v67
 v_mfma_f32_16x16x32_bf16 v[96:99],v[32:35],a[0:3],v[96:99]
 v_accvgpr_write_b32 a192,v64
 v_accvgpr_write_b32 a193,v65
 v_mfma_f32_16x16x32_bf16 v[96:99],v[36:39],a[16:19],v[96:99]
 v_mul_f32 v68,v68,v11
 v_mul_f32 v69,v69,v11
 v_mfma_f32_16x16x32_bf16 v[100:103],v[36:39],a[20:23],v[100:103]
 v_mul_f32 v70,v70,v11
 v_mul_f32 v71,v71,v11
 v_mfma_f32_16x16x32_bf16 v[100:103],v[32:35],a[4:7],v[100:103]
 v_cvt_pk_bf16_f32 v68,v68,v69
 v_cvt_pk_bf16_f32 v69,v70,v71
 v_mfma_f32_16x16x32_bf16 v[104:107],v[32:35],a[8:11],v[104:107]
 v_accvgpr_write_b32 a196,v68
 v_accvgpr_write_b32 a197,v69
 v_mfma_f32_16x16x32_bf16 v[104:107],v[36:39],a[24:27],v[104:107]
 s_add_u32 m0,s35,27648
 s_add_u32 s44,s44,20480
 buffer_load_dwordx4 v1,s[4:7],s44 offen lds
 v_mul_f32 v72,v72,v12
 v_mul_f32 v73,v73,v12
 v_mfma_f32_16x16x32_bf16 v[108:111],v[36:39],a[28:31],v[108:111]
 v_mul_f32 v74,v74,v12
 v_mul_f32 v75,v75,v12
 v_mfma_f32_16x16x32_bf16 v[108:111],v[32:35],a[12:15],v[108:111]
 s_waitcnt lgkmcnt(0)
 v_cvt_pk_bf16_f32 v72,v72,v73
 v_cvt_pk_bf16_f32 v73,v74,v75
 v_mfma_f32_16x16x32_bf16 v[112:115],v[40:43],a[0:3],v[112:115]
 ds_read_b64_tr_b16 v[16:17],v7 offset:128
 ds_read_b64_tr_b16 v[18:19],v7 offset:6272
 v_mfma_f32_16x16x32_bf16 v[112:115],v[44:47],a[16:19],v[112:115]
 v_accvgpr_write_b32 a200,v72
 v_accvgpr_write_b32 a201,v73
 v_mfma_f32_16x16x32_bf16 v[116:119],v[44:47],a[20:23],v[116:119]
 buffer_load_dwordx4 v2,s[4:7],s44 offen offset:1024 lds
 ds_read_b64_tr_b16 v[20:21],v7 offset:12416
 ds_read_b64_tr_b16 v[22:23],v7 offset:18560
 v_mfma_f32_16x16x32_bf16 v[116:119],v[40:43],a[4:7],v[116:119]
 v_mul_f32 v76,v76,v13
 v_mul_f32 v77,v77,v13
 v_mfma_f32_16x16x32_bf16 v[120:123],v[40:43],a[8:11],v[120:123]
 ds_read_b64_tr_b16 v[24:25],v7 offset:136
 ds_read_b64_tr_b16 v[26:27],v7 offset:6280
 v_mfma_f32_16x16x32_bf16 v[120:123],v[44:47],a[24:27],v[120:123]
 v_mul_f32 v78,v78,v13
 v_mul_f32 v79,v79,v13
 v_mfma_f32_16x16x32_bf16 v[124:127],v[44:47],a[28:31],v[124:127]
 ds_read_b64_tr_b16 v[28:29],v7 offset:12424
 ds_read_b64_tr_b16 v[30:31],v7 offset:18568
 v_mfma_f32_16x16x32_bf16 v[124:127],v[40:43],a[12:15],v[124:127]
 v_cvt_pk_bf16_f32 v76,v76,v77
 v_cvt_pk_bf16_f32 v77,v78,v79
 v_mfma_f32_16x16x32_bf16 v[128:131],v[48:51],a[0:3],v[128:131]
 ds_read_b64_tr_b16 v[32:33],v6 offset:256
 ds_read_b64_tr_b16 v[34:35],v6 offset:6400
 v_mfma_f32_16x16x32_bf16 v[128:131],v[52:55],a[16:19],v[128:131]
 v_accvgpr_write_b32 a204,v76
 v_accvgpr_write_b32 a205,v77
 v_mfma_f32_16x16x32_bf16 v[132:135],v[52:55],a[20:23],v[132:135]
 buffer_load_dwordx4 v3,s[4:7],s44 offen offset:2048 lds
 ds_read_b64_tr_b16 v[36:37],v6 offset:12544
 ds_read_b64_tr_b16 v[38:39],v6 offset:18688
 v_mfma_f32_16x16x32_bf16 v[132:135],v[48:51],a[4:7],v[132:135]
 v_mul_f32 v80,v80,v10
 v_mul_f32 v81,v81,v10
 v_mfma_f32_16x16x32_bf16 v[136:139],v[48:51],a[8:11],v[136:139]
 v_mul_f32 v82,v82,v10
 v_mul_f32 v83,v83,v10
 v_mfma_f32_16x16x32_bf16 v[136:139],v[52:55],a[24:27],v[136:139]
 v_cvt_pk_bf16_f32 v80,v80,v81
 v_cvt_pk_bf16_f32 v81,v82,v83
 v_mfma_f32_16x16x32_bf16 v[140:143],v[52:55],a[28:31],v[140:143]
 v_accvgpr_write_b32 a194,v80
 v_accvgpr_write_b32 a195,v81
 v_mfma_f32_16x16x32_bf16 v[140:143],v[48:51],a[12:15],v[140:143]
 v_mul_f32 v84,v84,v11
 v_mul_f32 v85,v85,v11
 v_mfma_f32_16x16x32_bf16 v[144:147],v[56:59],a[0:3],v[144:147]
 v_add_u32 v14,0,v0
 v_mul_u32_u24 v14,2731,v14
 v_mfma_f32_16x16x32_bf16 v[144:147],v[60:63],a[16:19],v[144:147]
 v_lshrrev_b32 v14,16,v14
 v_and_b32 v15,6,v14
 v_mfma_f32_16x16x32_bf16 v[148:151],v[60:63],a[20:23],v[148:151]
 v_xor_b32 v15,v15,v0
 v_lshlrev_b32 v1,4,v15
 v_mfma_f32_16x16x32_bf16 v[148:151],v[56:59],a[4:7],v[148:151]
 v_add_u32 v14,64,v0
 v_mul_u32_u24 v14,2731,v14
 v_mfma_f32_16x16x32_bf16 v[152:155],v[56:59],a[8:11],v[152:155]
 v_lshrrev_b32 v14,16,v14
 v_and_b32 v15,6,v14
 v_mfma_f32_16x16x32_bf16 v[152:155],v[60:63],a[24:27],v[152:155]
 v_xor_b32 v15,v15,v0
 v_lshlrev_b32 v2,4,v15
 v_mfma_f32_16x16x32_bf16 v[156:159],v[60:63],a[28:31],v[156:159]
 v_add_u32 v14,128,v0
 v_mul_u32_u24 v14,2731,v14
 v_mfma_f32_16x16x32_bf16 v[156:159],v[56:59],a[12:15],v[156:159]
 s_waitcnt lgkmcnt(0)
 v_lshrrev_b32 v14,16,v14
 v_and_b32 v15,6,v14
 v_mfma_f32_16x16x32_bf16 v[160:163],v[16:19],a[0:3],v[160:163]
 ds_read_b64_tr_b16 v[40:41],v6 offset:264
 ds_read_b64_tr_b16 v[42:43],v6 offset:6408
 v_mfma_f32_16x16x32_bf16 v[160:163],v[20:23],a[16:19],v[160:163]
 v_xor_b32 v15,v15,v0
 v_lshlrev_b32 v3,4,v15
 v_mfma_f32_16x16x32_bf16 v[164:167],v[20:23],a[20:23],v[164:167]
 ds_read_b64_tr_b16 v[44:45],v6 offset:12552
 ds_read_b64_tr_b16 v[46:47],v6 offset:18696
 v_mfma_f32_16x16x32_bf16 v[164:167],v[16:19],a[4:7],v[164:167]
 v_mul_f32 v86,v86,v11
 v_mul_f32 v87,v87,v11
 v_mfma_f32_16x16x32_bf16 v[168:171],v[16:19],a[8:11],v[168:171]
 ds_read_b64_tr_b16 v[48:49],v7 offset:256
 ds_read_b64_tr_b16 v[50:51],v7 offset:6400
 v_mfma_f32_16x16x32_bf16 v[168:171],v[20:23],a[24:27],v[168:171]
 v_cvt_pk_bf16_f32 v84,v84,v85
 v_cvt_pk_bf16_f32 v85,v86,v87
 v_mfma_f32_16x16x32_bf16 v[172:175],v[20:23],a[28:31],v[172:175]
 ds_read_b64_tr_b16 v[52:53],v7 offset:12544
 ds_read_b64_tr_b16 v[54:55],v7 offset:18688
 v_mfma_f32_16x16x32_bf16 v[172:175],v[16:19],a[12:15],v[172:175]
 v_accvgpr_write_b32 a198,v84
 v_accvgpr_write_b32 a199,v85
 v_mfma_f32_16x16x32_bf16 v[176:179],v[24:27],a[0:3],v[176:179]
 ds_read_b64_tr_b16 v[56:57],v7 offset:264
 ds_read_b64_tr_b16 v[58:59],v7 offset:6408
 v_mfma_f32_16x16x32_bf16 v[176:179],v[28:31],a[16:19],v[176:179]
 v_mul_f32 v88,v88,v12
 v_mul_f32 v89,v89,v12
 v_mfma_f32_16x16x32_bf16 v[180:183],v[28:31],a[20:23],v[180:183]
 ds_read_b64_tr_b16 v[60:61],v7 offset:12552
 ds_read_b64_tr_b16 v[62:63],v7 offset:18696
 v_mfma_f32_16x16x32_bf16 v[180:183],v[24:27],a[4:7],v[180:183]
 v_mul_f32 v90,v90,v12
 v_mul_f32 v91,v91,v12
 v_mfma_f32_16x16x32_bf16 v[184:187],v[24:27],a[8:11],v[184:187]
 v_lshrrev_b32 v14,2,v0
 v_mul_u32_u24 v6,192,v14
 v_mfma_f32_16x16x32_bf16 v[184:187],v[28:31],a[24:27],v[184:187]
 v_and_b32 v15,3,v0
 v_lshl_add_u32 v6,v15,3,v6
 v_mfma_f32_16x16x32_bf16 v[188:191],v[28:31],a[28:31],v[188:191]
 v_and_b32 v14,4,v14
 v_lshl_add_u32 v6,v14,3,v6
 v_mfma_f32_16x16x32_bf16 v[188:191],v[24:27],a[12:15],v[188:191]
 s_and_b32 s41,s74,1
 s_lshl_b32 s41,s41,6
 s_add_u32 s42,s41,73728
 v_mfma_f32_16x16x32_bf16 v[192:195],v[32:35],a[0:3],v[192:195]
 v_add_u32 v4,s42,v6
 v_xor_b32 v5,32,v4
 v_mfma_f32_16x16x32_bf16 v[192:195],v[36:39],a[16:19],v[192:195]
 s_lshr_b32 s42,s41,1
 v_xor_b32 v6,s42,v6
 v_cvt_pk_bf16_f32 v88,v88,v89
 v_mfma_f32_16x16x32_bf16 v[196:199],v[36:39],a[20:23],v[196:199]
 s_lshl_b32 s41,s41,1
 s_sub_u32 s41,73856,s41
 v_add_u32 v6,s41,v6
 v_mfma_f32_16x16x32_bf16 v[196:199],v[32:35],a[4:7],v[196:199]
 v_cvt_pk_bf16_f32 v89,v90,v91
 v_accvgpr_write_b32 a202,v88
 v_mfma_f32_16x16x32_bf16 v[200:203],v[32:35],a[8:11],v[200:203]
 v_accvgpr_write_b32 a203,v89
 v_mul_f32 v92,v92,v13
 v_mfma_f32_16x16x32_bf16 v[200:203],v[36:39],a[24:27],v[200:203]
 v_mul_f32 v93,v93,v13
 v_mul_f32 v94,v94,v13
 v_mfma_f32_16x16x32_bf16 v[204:207],v[36:39],a[28:31],v[204:207]
 v_mul_f32 v95,v95,v13
 v_cvt_pk_bf16_f32 v92,v92,v93
 v_mfma_f32_16x16x32_bf16 v[204:207],v[32:35],a[12:15],v[204:207]
 s_waitcnt vmcnt(42) lgkmcnt(0)
 s_barrier
 v_cvt_pk_bf16_f32 v93,v94,v95
 v_mfma_f32_16x16x32_bf16 v[208:211],v[40:43],a[0:3],v[208:211]
 s_add_u32 m0,s35,49152
 s_mov_b32 s44,0
 buffer_load_dwordx4 v1,s[12:15],s44 offen lds
 buffer_load_dwordx4 v2,s[12:15],s44 offen offset:1024 lds
 ds_read_b64_tr_b16 v[16:17],v4
 ds_read_b64_tr_b16 v[18:19],v4 offset:3072
 v_mfma_f32_16x16x32_bf16 v[208:211],v[44:47],a[16:19],v[208:211]
 v_accvgpr_write_b32 a206,v92
 v_accvgpr_write_b32 a207,v93
 v_mfma_f32_16x16x32_bf16 v[212:215],v[44:47],a[20:23],v[212:215]
 ds_read_b64_tr_b16 v[20:21],v4 offset:6144
 ds_read_b64_tr_b16 v[22:23],v4 offset:9216
 v_mfma_f32_16x16x32_bf16 v[212:215],v[40:43],a[4:7],v[212:215]
 buffer_load_dwordx4 v3,s[12:15],s44 offen offset:2048 lds
 v_mul_f32 v96,v96,v10
 v_mul_f32 v97,v97,v10
 v_mfma_f32_16x16x32_bf16 v[216:219],v[40:43],a[8:11],v[216:219]
 ds_read_b64_tr_b16 v[24:25],v5
 ds_read_b64_tr_b16 v[26:27],v5 offset:3072
 v_mfma_f32_16x16x32_bf16 v[216:219],v[44:47],a[24:27],v[216:219]
 v_mul_f32 v98,v98,v10
 v_mul_f32 v99,v99,v10
 v_mfma_f32_16x16x32_bf16 v[220:223],v[44:47],a[28:31],v[220:223]
 ds_read_b64_tr_b16 v[28:29],v5 offset:6144
 ds_read_b64_tr_b16 v[30:31],v5 offset:9216
 v_mfma_f32_16x16x32_bf16 v[220:223],v[40:43],a[12:15],v[220:223]
 v_cvt_pk_bf16_f32 v96,v96,v97
 v_cvt_pk_bf16_f32 v97,v98,v99
 v_mfma_f32_16x16x32_bf16 v[224:227],v[48:51],a[0:3],v[224:227]
 ds_read_b64_tr_b16 v[32:33],v4 offset:64
 ds_read_b64_tr_b16 v[34:35],v4 offset:3136
 v_mfma_f32_16x16x32_bf16 v[224:227],v[52:55],a[16:19],v[224:227]
 v_accvgpr_write_b32 a208,v96
 v_accvgpr_write_b32 a209,v97
 v_mfma_f32_16x16x32_bf16 v[228:231],v[52:55],a[20:23],v[228:231]
 s_add_u32 m0,s35,52224
 s_add_u32 s44,s44,3072
 buffer_load_dwordx4 v1,s[12:15],s44 offen lds
 ds_read_b64_tr_b16 v[36:37],v4 offset:6208
 ds_read_b64_tr_b16 v[38:39],v4 offset:9280
 v_mfma_f32_16x16x32_bf16 v[228:231],v[48:51],a[4:7],v[228:231]
 v_mul_f32 v100,v100,v11
 v_mul_f32 v101,v101,v11
 v_mfma_f32_16x16x32_bf16 v[232:235],v[48:51],a[8:11],v[232:235]
 v_mul_f32 v102,v102,v11
 v_mul_f32 v103,v103,v11
 v_mfma_f32_16x16x32_bf16 v[232:235],v[52:55],a[24:27],v[232:235]
 v_cvt_pk_bf16_f32 v100,v100,v101
 v_cvt_pk_bf16_f32 v101,v102,v103
 v_mfma_f32_16x16x32_bf16 v[236:239],v[52:55],a[28:31],v[236:239]
 v_accvgpr_write_b32 a212,v100
 v_accvgpr_write_b32 a213,v101
 v_mfma_f32_16x16x32_bf16 v[236:239],v[48:51],a[12:15],v[236:239]
 v_mul_f32 v104,v104,v12
 v_mul_f32 v105,v105,v12
 v_mfma_f32_16x16x32_bf16 v[240:243],v[56:59],a[0:3],v[240:243]
 buffer_load_dwordx4 v2,s[12:15],s44 offen offset:1024 lds
 v_mul_f32 v106,v106,v12
 v_mul_f32 v107,v107,v12
 v_mfma_f32_16x16x32_bf16 v[240:243],v[60:63],a[16:19],v[240:243]
 v_cvt_pk_bf16_f32 v104,v104,v105
 v_cvt_pk_bf16_f32 v105,v106,v107
 v_mfma_f32_16x16x32_bf16 v[244:247],v[60:63],a[20:23],v[244:247]
 v_accvgpr_write_b32 a216,v104
 v_accvgpr_write_b32 a217,v105
 v_mfma_f32_16x16x32_bf16 v[244:247],v[56:59],a[4:7],v[244:247]
 v_mul_f32 v108,v108,v13
 v_mul_f32 v109,v109,v13
 v_mfma_f32_16x16x32_bf16 v[248:251],v[56:59],a[8:11],v[248:251]
 v_mul_f32 v110,v110,v13
 v_mul_f32 v111,v111,v13
 v_mfma_f32_16x16x32_bf16 v[248:251],v[60:63],a[24:27],v[248:251]
 v_cvt_pk_bf16_f32 v108,v108,v109
 v_cvt_pk_bf16_f32 v109,v110,v111
 v_mfma_f32_16x16x32_bf16 v[252:255],v[60:63],a[28:31],v[252:255]
 v_accvgpr_write_b32 a220,v108
 v_accvgpr_write_b32 a221,v109
 v_mfma_f32_16x16x32_bf16 v[252:255],v[56:59],a[12:15],v[252:255]
 buffer_load_dwordx4 v3,s[12:15],s44 offen offset:2048 lds
 v_mul_f32 v112,v112,v10
 v_mul_f32 v113,v113,v10
 v_mul_f32 v114,v114,v10
 v_mul_f32 v115,v115,v10
 v_cvt_pk_bf16_f32 v112,v112,v113
 v_cvt_pk_bf16_f32 v113,v114,v115
 v_accvgpr_write_b32 a210,v112
 v_accvgpr_write_b32 a211,v113
 v_mul_f32 v116,v116,v11
 v_mul_f32 v117,v117,v11
 v_mul_f32 v118,v118,v11
 v_mul_f32 v119,v119,v11
 v_cvt_pk_bf16_f32 v116,v116,v117
 v_cvt_pk_bf16_f32 v117,v118,v119
 v_accvgpr_write_b32 a214,v116
 v_accvgpr_write_b32 a215,v117
 v_mul_f32 v120,v120,v12
 v_mul_f32 v121,v121,v12
 v_mul_f32 v122,v122,v12
 s_add_u32 s0,s75,17408
 buffer_load_dwordx2 a[0:1],v8,s[28:31],s0 offen sc1
 v_mul_f32 v123,v123,v12
 v_cvt_pk_bf16_f32 v120,v120,v121
 v_cvt_pk_bf16_f32 v121,v122,v123
 v_accvgpr_write_b32 a218,v120
 v_accvgpr_write_b32 a219,v121
 v_mul_f32 v124,v124,v13
 v_mul_f32 v125,v125,v13
 v_mul_f32 v126,v126,v13
 v_mul_f32 v127,v127,v13
 v_cvt_pk_bf16_f32 v124,v124,v125
 v_cvt_pk_bf16_f32 v125,v126,v127
 v_accvgpr_write_b32 a222,v124
 v_accvgpr_write_b32 a223,v125
 buffer_load_dwordx2 a[2:3],v8,s[28:31],s0 offen offset:512 sc1
 v_mul_f32 v128,v128,v10
 v_mul_f32 v129,v129,v10
 v_mul_f32 v130,v130,v10
 v_mul_f32 v131,v131,v10
 v_cvt_pk_bf16_f32 v128,v128,v129
 v_cvt_pk_bf16_f32 v129,v130,v131
 v_accvgpr_write_b32 a224,v128
 v_accvgpr_write_b32 a225,v129
 v_mul_f32 v132,v132,v11
 v_mul_f32 v133,v133,v11
 v_mul_f32 v134,v134,v11
 v_mul_f32 v135,v135,v11
 s_add_u32 s0,s75,37888
 buffer_load_dwordx2 a[4:5],v8,s[28:31],s0 offen sc1
 v_cvt_pk_bf16_f32 v132,v132,v133
 v_cvt_pk_bf16_f32 v133,v134,v135
 v_accvgpr_write_b32 a228,v132
 v_accvgpr_write_b32 a229,v133
 s_waitcnt lgkmcnt(8)
 v_mfma_f32_16x16x32_bf16 v[96:99],v[16:19],a[120:123],0
 ds_read_b64_tr_b16 v[40:41],v5 offset:64
 ds_read_b64_tr_b16 v[42:43],v5 offset:3136
 v_mfma_f32_16x16x32_bf16 v[96:99],v[20:23],a[128:131],v[96:99]
 v_mul_f32 v136,v136,v12
 v_mul_f32 v137,v137,v12
 v_mfma_f32_16x16x32_bf16 v[116:119],v[20:23],a[132:135],0
 buffer_load_dwordx2 a[6:7],v8,s[28:31],s0 offen offset:512 sc1
 ds_read_b64_tr_b16 v[44:45],v5 offset:6208
 ds_read_b64_tr_b16 v[46:47],v5 offset:9280
 v_mfma_f32_16x16x32_bf16 v[116:119],v[16:19],a[124:127],v[116:119]
 s_waitcnt lgkmcnt(8)
 v_mul_f32 v138,v138,v12
 v_mul_f32 v139,v139,v12
 v_mfma_f32_16x16x32_bf16 v[100:103],v[24:27],a[120:123],0
 s_add_u32 s0,s75,18432
 ds_read_b64_tr_b16 v[48:49],v6
 ds_read_b64_tr_b16 v[50:51],v6 offset:3072
 v_mfma_f32_16x16x32_bf16 v[100:103],v[28:31],a[128:131],v[100:103]
 buffer_load_dwordx4 a[8:11],v9,s[28:31],s0 offen sc1
 v_cvt_pk_bf16_f32 v136,v136,v137
 v_cvt_pk_bf16_f32 v137,v138,v139
 v_mfma_f32_16x16x32_bf16 v[120:123],v[28:31],a[132:135],0
 ds_read_b64_tr_b16 v[52:53],v6 offset:6144
 ds_read_b64_tr_b16 v[54:55],v6 offset:9216
 v_mfma_f32_16x16x32_bf16 v[120:123],v[24:27],a[124:127],v[120:123]
 s_waitcnt lgkmcnt(8)
 v_accvgpr_write_b32 a232,v136
 v_accvgpr_write_b32 a233,v137
 v_mfma_f32_16x16x32_bf16 v[104:107],v[32:35],a[120:123],0
 ds_read_b64_tr_b16 v[56:57],v4 offset:12288
 ds_read_b64_tr_b16 v[58:59],v4 offset:15360
 v_mfma_f32_16x16x32_bf16 v[104:107],v[36:39],a[128:131],v[104:107]
 v_mul_f32 v140,v140,v13
 v_mul_f32 v141,v141,v13
 v_mfma_f32_16x16x32_bf16 v[124:127],v[36:39],a[132:135],0
 s_add_u32 s0,s75,38912
 ds_read_b64_tr_b16 v[60:61],v4 offset:18432
 ds_read_b64_tr_b16 v[62:63],v4 offset:21504
 v_mfma_f32_16x16x32_bf16 v[124:127],v[32:35],a[124:127],v[124:127]
 buffer_load_dwordx4 a[12:15],v9,s[28:31],s0 offen sc1
 s_waitcnt lgkmcnt(8)
 v_mul_f32 v142,v142,v13
 v_mul_f32 v143,v143,v13
 v_mfma_f32_16x16x32_bf16 v[108:111],v[40:43],a[120:123],0
 ds_read_b64_tr_b16 v[16:17],v5 offset:12288
 ds_read_b64_tr_b16 v[18:19],v5 offset:15360
 v_mfma_f32_16x16x32_bf16 v[108:111],v[44:47],a[128:131],v[108:111]
 v_cvt_pk_bf16_f32 v140,v140,v141
 v_cvt_pk_bf16_f32 v141,v142,v143
 v_mfma_f32_16x16x32_bf16 v[128:131],v[44:47],a[132:135],0
 ds_read_b64_tr_b16 v[20:21],v5 offset:18432
 ds_read_b64_tr_b16 v[22:23],v5 offset:21504
 v_mfma_f32_16x16x32_bf16 v[128:131],v[40:43],a[124:127],v[128:131]
 s_waitcnt lgkmcnt(8)
 v_accvgpr_write_b32 a236,v140
 v_accvgpr_write_b32 a237,v141
 v_mfma_f32_16x16x32_bf16 v[112:115],v[48:51],a[120:123],0
 s_add_u32 s0,s75,19456
 ds_read_b64_tr_b16 v[24:25],v4 offset:12352
 ds_read_b64_tr_b16 v[26:27],v4 offset:15424
 v_mfma_f32_16x16x32_bf16 v[112:115],v[52:55],a[128:131],v[112:115]
 buffer_load_dwordx4 a[16:19],v9,s[28:31],s0 offen sc1
 v_mul_f32 v144,v144,v10
 v_mul_f32 v145,v145,v10
 v_mfma_f32_16x16x32_bf16 v[132:135],v[52:55],a[132:135],0
 ds_read_b64_tr_b16 v[28:29],v4 offset:18496
 ds_read_b64_tr_b16 v[30:31],v4 offset:21568
 v_mfma_f32_16x16x32_bf16 v[132:135],v[48:51],a[124:127],v[132:135]
 s_waitcnt lgkmcnt(8)
 v_mul_f32 v146,v146,v10
 v_mul_f32 v147,v147,v10
 v_mfma_f32_16x16x32_bf16 v[96:99],v[56:59],a[136:139],v[96:99]
 ds_read_b64_tr_b16 v[32:33],v5 offset:12352
 ds_read_b64_tr_b16 v[34:35],v5 offset:15424
 v_mfma_f32_16x16x32_bf16 v[96:99],v[60:63],a[144:147],v[96:99]
 v_cvt_pk_bf16_f32 v144,v144,v145
 v_cvt_pk_bf16_f32 v145,v146,v147
 v_mfma_f32_16x16x32_bf16 v[116:119],v[60:63],a[148:151],v[116:119]
 s_add_u32 s0,s75,39936
 ds_read_b64_tr_b16 v[36:37],v5 offset:18496
 ds_read_b64_tr_b16 v[38:39],v5 offset:21568
 v_mfma_f32_16x16x32_bf16 v[116:119],v[56:59],a[140:143],v[116:119]
 s_waitcnt lgkmcnt(8)
 v_accvgpr_write_b32 a226,v144
 v_accvgpr_write_b32 a227,v145
 v_mfma_f32_16x16x32_bf16 v[100:103],v[16:19],a[136:139],v[100:103]
 buffer_load_dwordx4 a[20:23],v9,s[28:31],s0 offen sc1
 ds_read_b64_tr_b16 v[40:41],v6 offset:12288
 ds_read_b64_tr_b16 v[42:43],v6 offset:15360
 v_mfma_f32_16x16x32_bf16 v[100:103],v[20:23],a[144:147],v[100:103]
 v_mul_f32 v148,v148,v11
 v_mul_f32 v149,v149,v11
 v_mfma_f32_16x16x32_bf16 v[120:123],v[20:23],a[148:151],v[120:123]
 ds_read_b64_tr_b16 v[44:45],v6 offset:18432
 ds_read_b64_tr_b16 v[46:47],v6 offset:21504
 v_mfma_f32_16x16x32_bf16 v[120:123],v[16:19],a[140:143],v[120:123]
 s_waitcnt lgkmcnt(8)
 v_mul_f32 v150,v150,v11
 v_mul_f32 v151,v151,v11
 v_mfma_f32_16x16x32_bf16 v[104:107],v[24:27],a[136:139],v[104:107]
 s_waitcnt vmcnt(46)
 s_barrier
 ds_read_b64_tr_b16 v[48:49],v4 offset:24576
 ds_read_b64_tr_b16 v[50:51],v4 offset:27648
 v_mfma_f32_16x16x32_bf16 v[104:107],v[28:31],a[144:147],v[104:107]
 v_cvt_pk_bf16_f32 v148,v148,v149
 v_cvt_pk_bf16_f32 v149,v150,v151
 v_mfma_f32_16x16x32_bf16 v[124:127],v[28:31],a[148:151],v[124:127]
 ds_read_b64_tr_b16 v[52:53],v4 offset:30720
 ds_read_b64_tr_b16 v[54:55],v4 offset:33792
 v_mfma_f32_16x16x32_bf16 v[124:127],v[24:27],a[140:143],v[124:127]
 s_waitcnt lgkmcnt(8)
 v_accvgpr_write_b32 a230,v148
 v_accvgpr_write_b32 a231,v149
 v_mfma_f32_16x16x32_bf16 v[108:111],v[32:35],a[136:139],v[108:111]
 ds_read_b64_tr_b16 v[56:57],v5 offset:24576
 ds_read_b64_tr_b16 v[58:59],v5 offset:27648
 v_mfma_f32_16x16x32_bf16 v[108:111],v[36:39],a[144:147],v[108:111]
 v_mul_f32 v152,v152,v12
 v_mul_f32 v153,v153,v12
 v_mfma_f32_16x16x32_bf16 v[128:131],v[36:39],a[148:151],v[128:131]
 ds_read_b64_tr_b16 v[60:61],v5 offset:30720
 ds_read_b64_tr_b16 v[62:63],v5 offset:33792
 v_mfma_f32_16x16x32_bf16 v[128:131],v[32:35],a[140:143],v[128:131]
 s_waitcnt lgkmcnt(8)
 v_mul_f32 v154,v154,v12
 v_mul_f32 v155,v155,v12
 v_mfma_f32_16x16x32_bf16 v[112:115],v[40:43],a[136:139],v[112:115]
 ds_read_b64_tr_b16 v[16:17],v4 offset:24640
 ds_read_b64_tr_b16 v[18:19],v4 offset:27712
 v_mfma_f32_16x16x32_bf16 v[112:115],v[44:47],a[144:147],v[112:115]
 v_cvt_pk_bf16_f32 v152,v152,v153
 v_cvt_pk_bf16_f32 v153,v154,v155
 v_mfma_f32_16x16x32_bf16 v[132:135],v[44:47],a[148:151],v[132:135]
 ds_read_b64_tr_b16 v[20:21],v4 offset:30784
 ds_read_b64_tr_b16 v[22:23],v4 offset:33856
 v_mfma_f32_16x16x32_bf16 v[132:135],v[40:43],a[140:143],v[132:135]
 s_waitcnt vmcnt(63) lgkmcnt(8)
 v_accvgpr_write_b32 a234,v152
 v_accvgpr_write_b32 a235,v153
 v_mfma_f32_16x16x32_bf16 v[96:99],v[48:51],a[152:155],v[96:99]
 ds_read_b64_tr_b16 v[24:25],v5 offset:24640
 ds_read_b64_tr_b16 v[26:27],v5 offset:27712
 v_mfma_f32_16x16x32_bf16 v[96:99],v[52:55],a[160:163],v[96:99]
 v_mul_f32 v156,v156,v13
 v_mul_f32 v157,v157,v13
 v_mfma_f32_16x16x32_bf16 v[116:119],v[52:55],a[164:167],v[116:119]
 ds_read_b64_tr_b16 v[28:29],v5 offset:30784
 ds_read_b64_tr_b16 v[30:31],v5 offset:33856
 v_mfma_f32_16x16x32_bf16 v[116:119],v[48:51],a[156:159],v[116:119]
 s_waitcnt lgkmcnt(8)
 v_mul_f32 v158,v158,v13
 v_mul_f32 v159,v159,v13
 v_mfma_f32_16x16x32_bf16 v[100:103],v[56:59],a[152:155],v[100:103]
 ds_read_b64_tr_b16 v[32:33],v6 offset:24576
 ds_read_b64_tr_b16 v[34:35],v6 offset:27648
 v_mfma_f32_16x16x32_bf16 v[100:103],v[60:63],a[160:163],v[100:103]
 v_cvt_pk_bf16_f32 v156,v156,v157
 v_cvt_pk_bf16_f32 v157,v158,v159
 v_mfma_f32_16x16x32_bf16 v[120:123],v[60:63],a[164:167],v[120:123]
 ds_read_b64_tr_b16 v[36:37],v6 offset:30720
 ds_read_b64_tr_b16 v[38:39],v6 offset:33792
 v_mfma_f32_16x16x32_bf16 v[120:123],v[56:59],a[156:159],v[120:123]
 s_waitcnt lgkmcnt(8)
 v_accvgpr_write_b32 a238,v156
 v_accvgpr_write_b32 a239,v157
 v_mfma_f32_16x16x32_bf16 v[104:107],v[16:19],a[152:155],v[104:107]
 ds_read_b64_tr_b16 v[40:41],v4 offset:36864
 ds_read_b64_tr_b16 v[42:43],v4 offset:39936
 v_mfma_f32_16x16x32_bf16 v[104:107],v[20:23],a[160:163],v[104:107]
 v_mul_f32 v160,v160,v10
 v_mul_f32 v161,v161,v10
 v_mfma_f32_16x16x32_bf16 v[124:127],v[20:23],a[164:167],v[124:127]
 ds_read_b64_tr_b16 v[44:45],v4 offset:43008
 ds_read_b64_tr_b16 v[46:47],v4 offset:46080
 v_mfma_f32_16x16x32_bf16 v[124:127],v[16:19],a[156:159],v[124:127]
 s_waitcnt lgkmcnt(8)
 v_mul_f32 v162,v162,v10
 v_mul_f32 v163,v163,v10
 v_mfma_f32_16x16x32_bf16 v[108:111],v[24:27],a[152:155],v[108:111]
 ds_read_b64_tr_b16 v[48:49],v5 offset:36864
 ds_read_b64_tr_b16 v[50:51],v5 offset:39936
 v_mfma_f32_16x16x32_bf16 v[108:111],v[28:31],a[160:163],v[108:111]
 v_cvt_pk_bf16_f32 v160,v160,v161
 v_cvt_pk_bf16_f32 v161,v162,v163
 v_mfma_f32_16x16x32_bf16 v[128:131],v[28:31],a[164:167],v[128:131]
 ds_read_b64_tr_b16 v[52:53],v5 offset:43008
 ds_read_b64_tr_b16 v[54:55],v5 offset:46080
 v_mfma_f32_16x16x32_bf16 v[128:131],v[24:27],a[156:159],v[128:131]
 s_waitcnt lgkmcnt(8)
 v_accvgpr_write_b32 a240,v160
 v_accvgpr_write_b32 a241,v161
 v_mfma_f32_16x16x32_bf16 v[112:115],v[32:35],a[152:155],v[112:115]
 ds_read_b64_tr_b16 v[56:57],v4 offset:36928
 ds_read_b64_tr_b16 v[58:59],v4 offset:40000
 v_mfma_f32_16x16x32_bf16 v[112:115],v[36:39],a[160:163],v[112:115]
 v_mul_f32 v164,v164,v11
 v_mul_f32 v165,v165,v11
 v_mfma_f32_16x16x32_bf16 v[132:135],v[36:39],a[164:167],v[132:135]
 ds_read_b64_tr_b16 v[60:61],v4 offset:43072
 ds_read_b64_tr_b16 v[62:63],v4 offset:46144
 v_mfma_f32_16x16x32_bf16 v[132:135],v[32:35],a[156:159],v[132:135]
 s_waitcnt lgkmcnt(8)
 v_mul_f32 v166,v166,v11
 v_mul_f32 v167,v167,v11
 v_mfma_f32_16x16x32_bf16 v[96:99],v[40:43],a[168:171],v[96:99]
 ds_read_b64_tr_b16 v[16:17],v5 offset:36928
 ds_read_b64_tr_b16 v[18:19],v5 offset:40000
 v_mfma_f32_16x16x32_bf16 v[96:99],v[44:47],a[176:179],v[96:99]
 v_cvt_pk_bf16_f32 v164,v164,v165
 v_cvt_pk_bf16_f32 v165,v166,v167
 v_mfma_f32_16x16x32_bf16 v[116:119],v[44:47],a[180:183],v[116:119]
 ds_read_b64_tr_b16 v[20:21],v5 offset:43072
 ds_read_b64_tr_b16 v[22:23],v5 offset:46144
 v_mfma_f32_16x16x32_bf16 v[116:119],v[40:43],a[172:175],v[116:119]
 s_waitcnt lgkmcnt(8)
 v_accvgpr_write_b32 a244,v164
 v_accvgpr_write_b32 a245,v165
 v_mfma_f32_16x16x32_bf16 v[100:103],v[48:51],a[168:171],v[100:103]
 ds_read_b64_tr_b16 v[24:25],v6 offset:36864
 ds_read_b64_tr_b16 v[26:27],v6 offset:39936
 v_mfma_f32_16x16x32_bf16 v[100:103],v[52:55],a[176:179],v[100:103]
 v_mul_f32 v168,v168,v12
 v_mul_f32 v169,v169,v12
 v_mfma_f32_16x16x32_bf16 v[120:123],v[52:55],a[180:183],v[120:123]
 ds_read_b64_tr_b16 v[28:29],v6 offset:43008
 ds_read_b64_tr_b16 v[30:31],v6 offset:46080
 v_mfma_f32_16x16x32_bf16 v[120:123],v[48:51],a[172:175],v[120:123]
 s_waitcnt lgkmcnt(8)
 v_mul_f32 v170,v170,v12
 v_mul_f32 v171,v171,v12
 v_mfma_f32_16x16x32_bf16 v[104:107],v[56:59],a[168:171],v[104:107]
 s_waitcnt vmcnt(34)
 s_barrier
 v_add_u32 v4,49152,v4
 v_add_u32 v5,49152,v5
 v_add_u32 v6,49152,v6
 ds_read_b64_tr_b16 v[32:33],v4
 ds_read_b64_tr_b16 v[34:35],v4 offset:3072
 s_add_u32 m0,s35,73728
 s_mov_b32 s44,24576
 buffer_load_dwordx4 v1,s[12:15],s44 offen lds
 buffer_load_dwordx4 v2,s[12:15],s44 offen offset:1024 lds
 buffer_load_dwordx4 v3,s[12:15],s44 offen offset:2048 lds
 v_mfma_f32_16x16x32_bf16 v[104:107],v[60:63],a[176:179],v[104:107]
 v_cvt_pk_bf16_f32 v168,v168,v169
 v_cvt_pk_bf16_f32 v169,v170,v171
 v_mfma_f32_16x16x32_bf16 v[124:127],v[60:63],a[180:183],v[124:127]
 ds_read_b64_tr_b16 v[36:37],v4 offset:6144
 ds_read_b64_tr_b16 v[38:39],v4 offset:9216
 v_mfma_f32_16x16x32_bf16 v[124:127],v[56:59],a[172:175],v[124:127]
 s_waitcnt lgkmcnt(8)
 v_accvgpr_write_b32 a248,v168
 v_accvgpr_write_b32 a249,v169
 v_mfma_f32_16x16x32_bf16 v[108:111],v[16:19],a[168:171],v[108:111]
 s_add_u32 m0,s35,76800
 s_add_u32 s44,s44,3072
 buffer_load_dwordx4 v1,s[12:15],s44 offen lds
 ds_read_b64_tr_b16 v[40:41],v5
 ds_read_b64_tr_b16 v[42:43],v5 offset:3072
 v_mfma_f32_16x16x32_bf16 v[108:111],v[20:23],a[176:179],v[108:111]
 v_mul_f32 v172,v172,v13
 v_mul_f32 v173,v173,v13
 v_mfma_f32_16x16x32_bf16 v[128:131],v[20:23],a[180:183],v[128:131]
 ds_read_b64_tr_b16 v[44:45],v5 offset:6144
 ds_read_b64_tr_b16 v[46:47],v5 offset:9216
 v_mfma_f32_16x16x32_bf16 v[128:131],v[16:19],a[172:175],v[128:131]
 s_waitcnt lgkmcnt(8)
 v_mul_f32 v174,v174,v13
 v_mul_f32 v175,v175,v13
 v_mfma_f32_16x16x32_bf16 v[112:115],v[24:27],a[168:171],v[112:115]
 buffer_load_dwordx4 v2,s[12:15],s44 offen offset:1024 lds
 ds_read_b64_tr_b16 v[48:49],v4 offset:64
 ds_read_b64_tr_b16 v[50:51],v4 offset:3136
 v_mfma_f32_16x16x32_bf16 v[112:115],v[28:31],a[176:179],v[112:115]
 v_cvt_pk_bf16_f32 v172,v172,v173
 v_cvt_pk_bf16_f32 v173,v174,v175
 v_mfma_f32_16x16x32_bf16 v[132:135],v[28:31],a[180:183],v[132:135]
 ds_read_b64_tr_b16 v[52:53],v4 offset:6208
 ds_read_b64_tr_b16 v[54:55],v4 offset:9280
 v_mfma_f32_16x16x32_bf16 v[132:135],v[24:27],a[172:175],v[132:135]
 s_waitcnt vmcnt(48) lgkmcnt(8)
 v_accvgpr_write_b32 a252,v172
 v_accvgpr_write_b32 a253,v173
 v_mfma_f32_16x16x32_bf16 v[96:99],v[32:35],a[184:187],v[96:99]
 buffer_load_dwordx4 v3,s[12:15],s44 offen offset:2048 lds
 ds_read_b64_tr_b16 v[56:57],v5 offset:64
 ds_read_b64_tr_b16 v[58:59],v5 offset:3136
 v_mfma_f32_16x16x32_bf16 v[96:99],v[36:39],a[32:35],v[96:99]
 v_mul_f32 v176,v176,v10
 v_mul_f32 v177,v177,v10
 v_mfma_f32_16x16x32_bf16 v[116:119],v[36:39],a[36:39],v[116:119]
 ds_read_b64_tr_b16 v[60:61],v5 offset:6208
 ds_read_b64_tr_b16 v[62:63],v5 offset:9280
 v_mfma_f32_16x16x32_bf16 v[116:119],v[32:35],a[188:191],v[116:119]
 s_waitcnt lgkmcnt(8)
 v_mul_f32 v178,v178,v10
 v_mul_f32 v179,v179,v10
 v_mfma_f32_16x16x32_bf16 v[100:103],v[40:43],a[184:187],v[100:103]
 ds_read_b64_tr_b16 v[16:17],v6
 ds_read_b64_tr_b16 v[18:19],v6 offset:3072
 v_mfma_f32_16x16x32_bf16 v[100:103],v[44:47],a[32:35],v[100:103]
 v_cvt_pk_bf16_f32 v176,v176,v177
 v_cvt_pk_bf16_f32 v177,v178,v179
 v_mfma_f32_16x16x32_bf16 v[120:123],v[44:47],a[36:39],v[120:123]
 ds_read_b64_tr_b16 v[20:21],v6 offset:6144
 ds_read_b64_tr_b16 v[22:23],v6 offset:9216
 v_mfma_f32_16x16x32_bf16 v[120:123],v[40:43],a[188:191],v[120:123]
 s_waitcnt lgkmcnt(8)
 v_accvgpr_write_b32 a242,v176
 v_accvgpr_write_b32 a243,v177
 v_mfma_f32_16x16x32_bf16 v[104:107],v[48:51],a[184:187],v[104:107]
 ds_read_b64_tr_b16 v[24:25],v4 offset:12288
 ds_read_b64_tr_b16 v[26:27],v4 offset:15360
 v_mfma_f32_16x16x32_bf16 v[104:107],v[52:55],a[32:35],v[104:107]
 v_mul_f32 v180,v180,v11
 v_mul_f32 v181,v181,v11
 v_mfma_f32_16x16x32_bf16 v[124:127],v[52:55],a[36:39],v[124:127]
 ds_read_b64_tr_b16 v[28:29],v4 offset:18432
 ds_read_b64_tr_b16 v[30:31],v4 offset:21504
 v_mfma_f32_16x16x32_bf16 v[124:127],v[48:51],a[188:191],v[124:127]
 s_waitcnt lgkmcnt(8)
 v_mul_f32 v182,v182,v11
 v_mul_f32 v183,v183,v11
 v_mfma_f32_16x16x32_bf16 v[108:111],v[56:59],a[184:187],v[108:111]
 ds_read_b64_tr_b16 v[32:33],v5 offset:12288
 ds_read_b64_tr_b16 v[34:35],v5 offset:15360
 v_mfma_f32_16x16x32_bf16 v[108:111],v[60:63],a[32:35],v[108:111]
 v_cvt_pk_bf16_f32 v180,v180,v181
 v_cvt_pk_bf16_f32 v181,v182,v183
 v_mfma_f32_16x16x32_bf16 v[128:131],v[60:63],a[36:39],v[128:131]
 ds_read_b64_tr_b16 v[36:37],v5 offset:18432
 ds_read_b64_tr_b16 v[38:39],v5 offset:21504
 v_mfma_f32_16x16x32_bf16 v[128:131],v[56:59],a[188:191],v[128:131]
 s_waitcnt lgkmcnt(8)
 v_accvgpr_write_b32 a246,v180
 v_accvgpr_write_b32 a247,v181
 v_mfma_f32_16x16x32_bf16 v[112:115],v[16:19],a[184:187],v[112:115]
 ds_read_b64_tr_b16 v[40:41],v4 offset:12352
 ds_read_b64_tr_b16 v[42:43],v4 offset:15424
 v_mfma_f32_16x16x32_bf16 v[112:115],v[20:23],a[32:35],v[112:115]
 v_mul_f32 v184,v184,v12
 v_mul_f32 v185,v185,v12
 v_mfma_f32_16x16x32_bf16 v[132:135],v[20:23],a[36:39],v[132:135]
 ds_read_b64_tr_b16 v[44:45],v4 offset:18496
 ds_read_b64_tr_b16 v[46:47],v4 offset:21568
 v_mfma_f32_16x16x32_bf16 v[132:135],v[16:19],a[188:191],v[132:135]
 s_waitcnt lgkmcnt(8)
 v_mul_f32 v186,v186,v12
 v_mul_f32 v187,v187,v12
 v_mfma_f32_16x16x32_bf16 v[96:99],v[24:27],a[40:43],v[96:99]
 ds_read_b64_tr_b16 v[48:49],v5 offset:12352
 ds_read_b64_tr_b16 v[50:51],v5 offset:15424
 v_mfma_f32_16x16x32_bf16 v[96:99],v[28:31],a[48:51],v[96:99]
 v_cvt_pk_bf16_f32 v184,v184,v185
 v_cvt_pk_bf16_f32 v185,v186,v187
 v_mfma_f32_16x16x32_bf16 v[116:119],v[28:31],a[52:55],v[116:119]
 ds_read_b64_tr_b16 v[52:53],v5 offset:18496
 ds_read_b64_tr_b16 v[54:55],v5 offset:21568
 v_mfma_f32_16x16x32_bf16 v[116:119],v[24:27],a[44:47],v[116:119]
 s_waitcnt lgkmcnt(8)
 v_accvgpr_write_b32 a250,v184
 v_accvgpr_write_b32 a251,v185
 v_mfma_f32_16x16x32_bf16 v[100:103],v[32:35],a[40:43],v[100:103]
 ds_read_b64_tr_b16 v[56:57],v6 offset:12288
 ds_read_b64_tr_b16 v[58:59],v6 offset:15360
 v_mfma_f32_16x16x32_bf16 v[100:103],v[36:39],a[48:51],v[100:103]
 v_mul_f32 v188,v188,v13
 v_mul_f32 v189,v189,v13
 v_mfma_f32_16x16x32_bf16 v[120:123],v[36:39],a[52:55],v[120:123]
 ds_read_b64_tr_b16 v[60:61],v6 offset:18432
 ds_read_b64_tr_b16 v[62:63],v6 offset:21504
 v_mfma_f32_16x16x32_bf16 v[120:123],v[32:35],a[44:47],v[120:123]
 s_waitcnt lgkmcnt(8)
 v_mul_f32 v190,v190,v13
 v_mul_f32 v191,v191,v13
 v_mfma_f32_16x16x32_bf16 v[104:107],v[40:43],a[40:43],v[104:107]
 s_waitcnt vmcnt(29)
 s_barrier
 v_add_u32 v4,4294844416,v4
 v_add_u32 v5,4294844416,v5
 v_add_u32 v6,4294844416,v6
 ds_read_b64_tr_b16 v[16:17],v4
 ds_read_b64_tr_b16 v[18:19],v4 offset:3072
 s_add_u32 m0,s35,98304
 s_mov_b32 s44,0
 buffer_load_dwordx4 v1,s[16:19],s44 offen lds
 buffer_load_dwordx4 v2,s[16:19],s44 offen offset:1024 lds
 buffer_load_dwordx4 v3,s[16:19],s44 offen offset:2048 lds
 v_mfma_f32_16x16x32_bf16 v[104:107],v[44:47],a[48:51],v[104:107]
 v_cvt_pk_bf16_f32 v188,v188,v189
 v_cvt_pk_bf16_f32 v189,v190,v191
 v_mfma_f32_16x16x32_bf16 v[124:127],v[44:47],a[52:55],v[124:127]
 ds_read_b64_tr_b16 v[20:21],v4 offset:6144
 ds_read_b64_tr_b16 v[22:23],v4 offset:9216
 v_mfma_f32_16x16x32_bf16 v[124:127],v[40:43],a[44:47],v[124:127]
 s_waitcnt lgkmcnt(8)
 v_accvgpr_write_b32 a254,v188
 v_accvgpr_write_b32 a255,v189
 v_mfma_f32_16x16x32_bf16 v[108:111],v[48:51],a[40:43],v[108:111]
 s_add_u32 m0,s35,101376
 s_add_u32 s44,s44,3072
 buffer_load_dwordx4 v1,s[16:19],s44 offen lds
 ds_read_b64_tr_b16 v[24:25],v5
 ds_read_b64_tr_b16 v[26:27],v5 offset:3072
 v_mfma_f32_16x16x32_bf16 v[108:111],v[52:55],a[48:51],v[108:111]
 v_mul_f32 v192,v192,v10
 v_mul_f32 v193,v193,v10
 v_mfma_f32_16x16x32_bf16 v[128:131],v[52:55],a[52:55],v[128:131]
 ds_read_b64_tr_b16 v[28:29],v5 offset:6144
 ds_read_b64_tr_b16 v[30:31],v5 offset:9216
 v_mfma_f32_16x16x32_bf16 v[128:131],v[48:51],a[44:47],v[128:131]
 s_waitcnt lgkmcnt(8)
 v_mul_f32 v194,v194,v10
 v_mul_f32 v195,v195,v10
 v_mfma_f32_16x16x32_bf16 v[112:115],v[56:59],a[40:43],v[112:115]
 buffer_load_dwordx4 v2,s[16:19],s44 offen offset:1024 lds
 ds_read_b64_tr_b16 v[32:33],v4 offset:64
 ds_read_b64_tr_b16 v[34:35],v4 offset:3136
 v_mfma_f32_16x16x32_bf16 v[112:115],v[60:63],a[48:51],v[112:115]
 v_cvt_pk_bf16_f32 v64,v192,v193
 v_cvt_pk_bf16_f32 v65,v194,v195
 v_mfma_f32_16x16x32_bf16 v[132:135],v[60:63],a[52:55],v[132:135]
 ds_read_b64_tr_b16 v[36:37],v4 offset:6208
 ds_read_b64_tr_b16 v[38:39],v4 offset:9280
 v_mfma_f32_16x16x32_bf16 v[132:135],v[56:59],a[44:47],v[132:135]
 s_waitcnt vmcnt(33) lgkmcnt(8)
 v_mul_f32 v196,v196,v11
 v_mul_f32 v197,v197,v11
 v_mfma_f32_16x16x32_bf16 v[96:99],v[16:19],a[56:59],v[96:99]
 buffer_load_dwordx4 v3,s[16:19],s44 offen offset:2048 lds
 ds_read_b64_tr_b16 v[40:41],v5 offset:64
 ds_read_b64_tr_b16 v[42:43],v5 offset:3136
 v_mfma_f32_16x16x32_bf16 v[96:99],v[20:23],a[64:67],v[96:99]
 v_mul_f32 v198,v198,v11
 v_mul_f32 v199,v199,v11
 v_mfma_f32_16x16x32_bf16 v[116:119],v[20:23],a[68:71],v[116:119]
 ds_read_b64_tr_b16 v[44:45],v5 offset:6208
 ds_read_b64_tr_b16 v[46:47],v5 offset:9280
 v_mfma_f32_16x16x32_bf16 v[116:119],v[16:19],a[60:63],v[116:119]
 s_waitcnt lgkmcnt(8)
 v_cvt_pk_bf16_f32 v68,v196,v197
 v_cvt_pk_bf16_f32 v69,v198,v199
 v_mfma_f32_16x16x32_bf16 v[100:103],v[24:27],a[56:59],v[100:103]
 ds_read_b64_tr_b16 v[48:49],v6
 ds_read_b64_tr_b16 v[50:51],v6 offset:3072
 v_mfma_f32_16x16x32_bf16 v[100:103],v[28:31],a[64:67],v[100:103]
 v_mul_f32 v200,v200,v12
 v_mul_f32 v201,v201,v12
 v_mfma_f32_16x16x32_bf16 v[120:123],v[28:31],a[68:71],v[120:123]
 ds_read_b64_tr_b16 v[52:53],v6 offset:6144
 ds_read_b64_tr_b16 v[54:55],v6 offset:9216
 v_mfma_f32_16x16x32_bf16 v[120:123],v[24:27],a[60:63],v[120:123]
 s_waitcnt lgkmcnt(8)
 v_mul_f32 v202,v202,v12
 v_mul_f32 v203,v203,v12
 v_mfma_f32_16x16x32_bf16 v[104:107],v[32:35],a[56:59],v[104:107]
 ds_read_b64_tr_b16 v[56:57],v4 offset:12288
 ds_read_b64_tr_b16 v[58:59],v4 offset:15360
 v_mfma_f32_16x16x32_bf16 v[104:107],v[36:39],a[64:67],v[104:107]
 v_cvt_pk_bf16_f32 v72,v200,v201
 v_cvt_pk_bf16_f32 v73,v202,v203
 v_mfma_f32_16x16x32_bf16 v[124:127],v[36:39],a[68:71],v[124:127]
 ds_read_b64_tr_b16 v[60:61],v4 offset:18432
 ds_read_b64_tr_b16 v[62:63],v4 offset:21504
 v_mfma_f32_16x16x32_bf16 v[124:127],v[32:35],a[60:63],v[124:127]
 s_waitcnt lgkmcnt(8)
 v_mul_f32 v204,v204,v13
 v_mul_f32 v205,v205,v13
 v_mfma_f32_16x16x32_bf16 v[108:111],v[40:43],a[56:59],v[108:111]
 ds_read_b64_tr_b16 v[16:17],v5 offset:12288
 ds_read_b64_tr_b16 v[18:19],v5 offset:15360
 v_mfma_f32_16x16x32_bf16 v[108:111],v[44:47],a[64:67],v[108:111]
 v_mul_f32 v206,v206,v13
 v_mul_f32 v207,v207,v13
 v_mfma_f32_16x16x32_bf16 v[128:131],v[44:47],a[68:71],v[128:131]
 ds_read_b64_tr_b16 v[20:21],v5 offset:18432
 ds_read_b64_tr_b16 v[22:23],v5 offset:21504
 v_mfma_f32_16x16x32_bf16 v[128:131],v[40:43],a[60:63],v[128:131]
 s_waitcnt lgkmcnt(8)
 v_cvt_pk_bf16_f32 v76,v204,v205
 v_cvt_pk_bf16_f32 v77,v206,v207
 v_mfma_f32_16x16x32_bf16 v[112:115],v[48:51],a[56:59],v[112:115]
 ds_read_b64_tr_b16 v[24:25],v4 offset:12352
 ds_read_b64_tr_b16 v[26:27],v4 offset:15424
 v_mfma_f32_16x16x32_bf16 v[112:115],v[52:55],a[64:67],v[112:115]
 v_mul_f32 v208,v208,v10
 v_mul_f32 v209,v209,v10
 v_mfma_f32_16x16x32_bf16 v[132:135],v[52:55],a[68:71],v[132:135]
 ds_read_b64_tr_b16 v[28:29],v4 offset:18496
 ds_read_b64_tr_b16 v[30:31],v4 offset:21568
 v_mfma_f32_16x16x32_bf16 v[132:135],v[48:51],a[60:63],v[132:135]
 s_waitcnt lgkmcnt(8)
 v_mul_f32 v210,v210,v10
 v_mul_f32 v211,v211,v10
 v_mfma_f32_16x16x32_bf16 v[96:99],v[56:59],a[72:75],v[96:99]
 ds_read_b64_tr_b16 v[32:33],v5 offset:12352
 ds_read_b64_tr_b16 v[34:35],v5 offset:15424
 v_mfma_f32_16x16x32_bf16 v[96:99],v[60:63],a[80:83],v[96:99]
 v_cvt_pk_bf16_f32 v66,v208,v209
 v_cvt_pk_bf16_f32 v67,v210,v211
 v_mfma_f32_16x16x32_bf16 v[116:119],v[60:63],a[84:87],v[116:119]
 ds_read_b64_tr_b16 v[36:37],v5 offset:18496
 ds_read_b64_tr_b16 v[38:39],v5 offset:21568
 v_mfma_f32_16x16x32_bf16 v[116:119],v[56:59],a[76:79],v[116:119]
 s_waitcnt lgkmcnt(8)
 v_mul_f32 v212,v212,v11
 v_mul_f32 v213,v213,v11
 v_mfma_f32_16x16x32_bf16 v[100:103],v[16:19],a[72:75],v[100:103]
 ds_read_b64_tr_b16 v[40:41],v6 offset:12288
 ds_read_b64_tr_b16 v[42:43],v6 offset:15360
 v_mfma_f32_16x16x32_bf16 v[100:103],v[20:23],a[80:83],v[100:103]
 v_mul_f32 v214,v214,v11
 v_mul_f32 v215,v215,v11
 v_mfma_f32_16x16x32_bf16 v[120:123],v[20:23],a[84:87],v[120:123]
 ds_read_b64_tr_b16 v[44:45],v6 offset:18432
 ds_read_b64_tr_b16 v[46:47],v6 offset:21504
 v_mfma_f32_16x16x32_bf16 v[120:123],v[16:19],a[76:79],v[120:123]
 s_waitcnt lgkmcnt(8)
 v_cvt_pk_bf16_f32 v70,v212,v213
 v_cvt_pk_bf16_f32 v71,v214,v215
 v_mfma_f32_16x16x32_bf16 v[104:107],v[24:27],a[72:75],v[104:107]
 s_waitcnt vmcnt(26)
 s_barrier
 ds_read_b64_tr_b16 v[48:49],v4 offset:24576
 ds_read_b64_tr_b16 v[50:51],v4 offset:27648
 v_mfma_f32_16x16x32_bf16 v[104:107],v[28:31],a[80:83],v[104:107]
 s_add_u32 m0,s35,122880
 s_mov_b32 s44,49152
 buffer_load_dwordx4 v1,s[12:15],s44 offen lds
 buffer_load_dwordx4 v2,s[12:15],s44 offen offset:1024 lds
 buffer_load_dwordx4 v3,s[12:15],s44 offen offset:2048 lds
 v_mul_f32 v216,v216,v12
 v_mul_f32 v217,v217,v12
 v_mfma_f32_16x16x32_bf16 v[124:127],v[28:31],a[84:87],v[124:127]
 ds_read_b64_tr_b16 v[52:53],v4 offset:30720
 ds_read_b64_tr_b16 v[54:55],v4 offset:33792
 v_mfma_f32_16x16x32_bf16 v[124:127],v[24:27],a[76:79],v[124:127]
 s_waitcnt lgkmcnt(8)
 v_mul_f32 v218,v218,v12
 v_mul_f32 v219,v219,v12
 v_mfma_f32_16x16x32_bf16 v[108:111],v[32:35],a[72:75],v[108:111]
 s_add_u32 m0,s35,125952
 s_add_u32 s44,s44,3072
 buffer_load_dwordx4 v1,s[12:15],s44 offen lds
 ds_read_b64_tr_b16 v[56:57],v5 offset:24576
 ds_read_b64_tr_b16 v[58:59],v5 offset:27648
 v_mfma_f32_16x16x32_bf16 v[108:111],v[36:39],a[80:83],v[108:111]
 v_cvt_pk_bf16_f32 v74,v216,v217
 v_cvt_pk_bf16_f32 v75,v218,v219
 v_mfma_f32_16x16x32_bf16 v[128:131],v[36:39],a[84:87],v[128:131]
 ds_read_b64_tr_b16 v[60:61],v5 offset:30720
 ds_read_b64_tr_b16 v[62:63],v5 offset:33792
 v_mfma_f32_16x16x32_bf16 v[128:131],v[32:35],a[76:79],v[128:131]
 s_waitcnt lgkmcnt(8)
 v_mul_f32 v220,v220,v13
 v_mul_f32 v221,v221,v13
 v_mfma_f32_16x16x32_bf16 v[112:115],v[40:43],a[72:75],v[112:115]
 ds_read_b64_tr_b16 v[16:17],v4 offset:24640
 ds_read_b64_tr_b16 v[18:19],v4 offset:27712
 v_mfma_f32_16x16x32_bf16 v[112:115],v[44:47],a[80:83],v[112:115]
 buffer_load_dwordx4 v2,s[12:15],s44 offen offset:1024 lds
 v_mul_f32 v222,v222,v13
 v_mul_f32 v223,v223,v13
 v_mfma_f32_16x16x32_bf16 v[132:135],v[44:47],a[84:87],v[132:135]
 ds_read_b64_tr_b16 v[20:21],v4 offset:30784
 ds_read_b64_tr_b16 v[22:23],v4 offset:33856
 v_mfma_f32_16x16x32_bf16 v[132:135],v[40:43],a[76:79],v[132:135]
 s_waitcnt vmcnt(17) lgkmcnt(8)
 v_cvt_pk_bf16_f32 v78,v220,v221
 v_cvt_pk_bf16_f32 v79,v222,v223
 v_mfma_f32_16x16x32_bf16 v[96:99],v[48:51],a[88:91],v[96:99]
 ds_read_b64_tr_b16 v[24:25],v5 offset:24640
 ds_read_b64_tr_b16 v[26:27],v5 offset:27712
 v_mfma_f32_16x16x32_bf16 v[96:99],v[52:55],a[0:3],v[96:99]
 buffer_load_dwordx4 v3,s[12:15],s44 offen offset:2048 lds
 v_mul_f32 v224,v224,v10
 v_mul_f32 v225,v225,v10
 v_mfma_f32_16x16x32_bf16 v[116:119],v[52:55],a[4:7],v[116:119]
 ds_read_b64_tr_b16 v[28:29],v5 offset:30784
 ds_read_b64_tr_b16 v[30:31],v5 offset:33856
 v_mfma_f32_16x16x32_bf16 v[116:119],v[48:51],a[92:95],v[116:119]
 s_waitcnt lgkmcnt(8)
 v_mul_f32 v226,v226,v10
 v_mul_f32 v227,v227,v10
 v_mfma_f32_16x16x32_bf16 v[100:103],v[56:59],a[88:91],v[100:103]
 ds_read_b64_tr_b16 v[32:33],v6 offset:24576
 ds_read_b64_tr_b16 v[34:35],v6 offset:27648
 v_mfma_f32_16x16x32_bf16 v[100:103],v[60:63],a[0:3],v[100:103]
 v_cvt_pk_bf16_f32 v80,v224,v225
 v_cvt_pk_bf16_f32 v81,v226,v227
 v_mfma_f32_16x16x32_bf16 v[120:123],v[60:63],a[4:7],v[120:123]
 ds_read_b64_tr_b16 v[36:37],v6 offset:30720
 ds_read_b64_tr_b16 v[38:39],v6 offset:33792
 v_mfma_f32_16x16x32_bf16 v[120:123],v[56:59],a[92:95],v[120:123]
 s_waitcnt lgkmcnt(8)
 v_mul_f32 v228,v228,v11
 v_mul_f32 v229,v229,v11
 v_mfma_f32_16x16x32_bf16 v[104:107],v[16:19],a[88:91],v[104:107]
 ds_read_b64_tr_b16 v[40:41],v4 offset:36864
 ds_read_b64_tr_b16 v[42:43],v4 offset:39936
 v_mfma_f32_16x16x32_bf16 v[104:107],v[20:23],a[0:3],v[104:107]
 v_mul_f32 v230,v230,v11
 v_mul_f32 v231,v231,v11
 v_mfma_f32_16x16x32_bf16 v[124:127],v[20:23],a[4:7],v[124:127]
 ds_read_b64_tr_b16 v[44:45],v4 offset:43008
 ds_read_b64_tr_b16 v[46:47],v4 offset:46080
 v_mfma_f32_16x16x32_bf16 v[124:127],v[16:19],a[92:95],v[124:127]
 s_waitcnt lgkmcnt(8)
 v_cvt_pk_bf16_f32 v84,v228,v229
 v_cvt_pk_bf16_f32 v85,v230,v231
 v_mfma_f32_16x16x32_bf16 v[108:111],v[24:27],a[88:91],v[108:111]
 ds_read_b64_tr_b16 v[48:49],v5 offset:36864
 ds_read_b64_tr_b16 v[50:51],v5 offset:39936
 v_mfma_f32_16x16x32_bf16 v[108:111],v[28:31],a[0:3],v[108:111]
 v_mul_f32 v232,v232,v12
 v_mul_f32 v233,v233,v12
 v_mfma_f32_16x16x32_bf16 v[128:131],v[28:31],a[4:7],v[128:131]
 ds_read_b64_tr_b16 v[52:53],v5 offset:43008
 ds_read_b64_tr_b16 v[54:55],v5 offset:46080
 v_mfma_f32_16x16x32_bf16 v[128:131],v[24:27],a[92:95],v[128:131]
 s_waitcnt lgkmcnt(8)
 v_mul_f32 v234,v234,v12
 v_mul_f32 v235,v235,v12
 v_mfma_f32_16x16x32_bf16 v[112:115],v[32:35],a[88:91],v[112:115]
 ds_read_b64_tr_b16 v[56:57],v4 offset:36928
 ds_read_b64_tr_b16 v[58:59],v4 offset:40000
 v_mfma_f32_16x16x32_bf16 v[112:115],v[36:39],a[0:3],v[112:115]
 v_cvt_pk_bf16_f32 v88,v232,v233
 v_cvt_pk_bf16_f32 v89,v234,v235
 v_mfma_f32_16x16x32_bf16 v[132:135],v[36:39],a[4:7],v[132:135]
 ds_read_b64_tr_b16 v[60:61],v4 offset:43072
 ds_read_b64_tr_b16 v[62:63],v4 offset:46144
 v_mfma_f32_16x16x32_bf16 v[132:135],v[32:35],a[92:95],v[132:135]
 s_waitcnt lgkmcnt(8)
 v_mul_f32 v236,v236,v13
 v_mul_f32 v237,v237,v13
 v_mfma_f32_16x16x32_bf16 v[96:99],v[40:43],a[8:11],v[96:99]
 ds_read_b64_tr_b16 v[16:17],v5 offset:36928
 ds_read_b64_tr_b16 v[18:19],v5 offset:40000
 v_mfma_f32_16x16x32_bf16 v[96:99],v[44:47],a[16:19],v[96:99]
 v_mul_f32 v238,v238,v13
 v_mul_f32 v239,v239,v13
 v_mfma_f32_16x16x32_bf16 v[116:119],v[44:47],a[20:23],v[116:119]
 ds_read_b64_tr_b16 v[20:21],v5 offset:43072
 ds_read_b64_tr_b16 v[22:23],v5 offset:46144
 v_mfma_f32_16x16x32_bf16 v[116:119],v[40:43],a[12:15],v[116:119]
 s_waitcnt lgkmcnt(8)
 v_cvt_pk_bf16_f32 v92,v236,v237
 v_cvt_pk_bf16_f32 v93,v238,v239
 v_mfma_f32_16x16x32_bf16 v[100:103],v[48:51],a[8:11],v[100:103]
 ds_read_b64_tr_b16 v[24:25],v6 offset:36864
 ds_read_b64_tr_b16 v[26:27],v6 offset:39936
 v_mfma_f32_16x16x32_bf16 v[100:103],v[52:55],a[16:19],v[100:103]
 v_mul_f32 v240,v240,v10
 v_mul_f32 v241,v241,v10
 v_mfma_f32_16x16x32_bf16 v[120:123],v[52:55],a[20:23],v[120:123]
 ds_read_b64_tr_b16 v[28:29],v6 offset:43008
 ds_read_b64_tr_b16 v[30:31],v6 offset:46080
 v_mfma_f32_16x16x32_bf16 v[120:123],v[48:51],a[12:15],v[120:123]
 s_waitcnt lgkmcnt(8)
 v_mul_f32 v242,v242,v10
 v_mul_f32 v243,v243,v10
 v_mfma_f32_16x16x32_bf16 v[104:107],v[56:59],a[8:11],v[104:107]
 v_cvt_pk_bf16_f32 v82,v240,v241
 v_cvt_pk_bf16_f32 v83,v242,v243
 v_mfma_f32_16x16x32_bf16 v[104:107],v[60:63],a[16:19],v[104:107]
 v_mul_f32 v244,v244,v11
 v_mul_f32 v245,v245,v11
 v_mfma_f32_16x16x32_bf16 v[124:127],v[60:63],a[20:23],v[124:127]
 v_mul_f32 v246,v246,v11
 v_mul_f32 v247,v247,v11
 v_mfma_f32_16x16x32_bf16 v[124:127],v[56:59],a[12:15],v[124:127]
 s_waitcnt lgkmcnt(4)
 v_cvt_pk_bf16_f32 v86,v244,v245
 v_cvt_pk_bf16_f32 v87,v246,v247
 v_mfma_f32_16x16x32_bf16 v[108:111],v[16:19],a[8:11],v[108:111]
 v_mul_f32 v248,v248,v12
 v_mul_f32 v249,v249,v12
 v_mfma_f32_16x16x32_bf16 v[108:111],v[20:23],a[16:19],v[108:111]
 v_mul_f32 v250,v250,v12
 v_mul_f32 v251,v251,v12
 v_mfma_f32_16x16x32_bf16 v[128:131],v[20:23],a[20:23],v[128:131]
 v_cvt_pk_bf16_f32 v90,v248,v249
 v_cvt_pk_bf16_f32 v91,v250,v251
 v_mfma_f32_16x16x32_bf16 v[128:131],v[16:19],a[12:15],v[128:131]
 s_waitcnt lgkmcnt(0)
 v_mul_f32 v252,v252,v13
 v_mul_f32 v253,v253,v13
 v_mfma_f32_16x16x32_bf16 v[112:115],v[24:27],a[8:11],v[112:115]
 v_mul_f32 v254,v254,v13
 v_mul_f32 v255,v255,v13
 v_mfma_f32_16x16x32_bf16 v[112:115],v[28:31],a[16:19],v[112:115]
 v_cvt_pk_bf16_f32 v94,v252,v253
 v_cvt_pk_bf16_f32 v95,v254,v255
 v_mfma_f32_16x16x32_bf16 v[132:135],v[28:31],a[20:23],v[132:135]
 v_accvgpr_read_b32 v176,a96
 v_accvgpr_read_b32 v177,a97
 v_mfma_f32_16x16x32_bf16 v[132:135],v[24:27],a[12:15],v[132:135]
 v_accvgpr_read_b32 v178,a98
 v_accvgpr_read_b32 v179,a99
 v_and_b32 v14,15,v0
 v_mul_u32_u24 v4,384,v14
 v_and_b32 v14,6,v14
 v_lshrrev_b32 v15,4,v0
 v_xor_b32 v14,v14,v15
 v_lshl_add_u32 v4,v14,4,v4
 v_add_u32 v4,49152,v4
 v_xor_b32 v5,64,v4
 s_barrier
 s_add_u32 m0,s35,0
 s_mov_b32 s44,24576
 buffer_load_dwordx4 v1,s[16:19],s44 offen lds
 buffer_load_dwordx4 v2,s[16:19],s44 offen offset:1024 lds
 buffer_load_dwordx4 v3,s[16:19],s44 offen offset:2048 lds
 v_accvgpr_read_b32 v180,a100
 v_accvgpr_read_b32 v181,a101
 v_accvgpr_read_b32 v182,a102
 v_accvgpr_read_b32 v183,a103
 v_accvgpr_read_b32 v184,a104
 v_accvgpr_read_b32 v185,a105
 v_accvgpr_read_b32 v186,a106
 v_accvgpr_read_b32 v187,a107
 v_lshlrev_b32 v136,16,v176
 v_and_b32 v137,0xffff0000,v176
 v_lshlrev_b32 v138,16,v177
 v_and_b32 v139,0xffff0000,v177
 s_add_u32 m0,s35,3072
 s_add_u32 s44,s44,3072
 buffer_load_dwordx4 v1,s[16:19],s44 offen lds
 v_lshlrev_b32 v140,16,v178
 v_and_b32 v141,0xffff0000,v178
 v_lshlrev_b32 v142,16,v179
 v_and_b32 v143,0xffff0000,v179
 v_lshlrev_b32 v144,16,v180
 v_and_b32 v145,0xffff0000,v180
 v_lshlrev_b32 v146,16,v181
 v_and_b32 v147,0xffff0000,v181
 v_lshlrev_b32 v148,16,v182
 v_and_b32 v149,0xffff0000,v182
 v_lshlrev_b32 v150,16,v183
 v_and_b32 v151,0xffff0000,v183
 v_lshlrev_b32 v152,16,v184
 v_and_b32 v153,0xffff0000,v184
 v_lshlrev_b32 v154,16,v185
 v_and_b32 v155,0xffff0000,v185
 v_add_f32 v136,v136,v186
 buffer_load_dwordx4 v2,s[16:19],s44 offen offset:1024 lds
 v_add_f32 v137,v137,v186
 v_add_f32 v138,v138,v186
 v_add_f32 v139,v139,v186
 v_add_f32 v140,v140,v186
 v_add_f32 v141,v141,v186
 v_add_f32 v142,v142,v186
 v_add_f32 v143,v143,v186
 v_add_f32 v144,v144,v186
 v_add_f32 v145,v145,v186
 v_add_f32 v146,v146,v186
 v_add_f32 v147,v147,v186
 v_add_f32 v148,v148,v186
 v_add_f32 v149,v149,v186
 v_add_f32 v150,v150,v186
 v_add_f32 v151,v151,v186
 v_add_f32 v152,v152,v186
 buffer_load_dwordx4 v3,s[16:19],s44 offen offset:2048 lds
 v_add_f32 v153,v153,v186
 v_add_f32 v154,v154,v186
 v_add_f32 v155,v155,v186
 v_accvgpr_read_b32 v188,a108
 v_accvgpr_read_b32 v189,a109
 v_accvgpr_read_b32 v190,a110
 v_accvgpr_read_b32 v191,a111
 v_accvgpr_read_b32 v192,a112
 v_accvgpr_read_b32 v193,a113
 v_accvgpr_read_b32 v194,a114
 v_accvgpr_read_b32 v195,a115
 v_accvgpr_read_b32 v196,a116
 v_accvgpr_read_b32 v197,a117
 v_accvgpr_read_b32 v198,a118
 v_accvgpr_read_b32 v199,a119
 v_lshlrev_b32 v156,16,v188
 v_and_b32 v157,0xffff0000,v188
 v_lshlrev_b32 v158,16,v189
 v_and_b32 v159,0xffff0000,v189
 v_lshlrev_b32 v160,16,v190
 v_and_b32 v161,0xffff0000,v190
 v_lshlrev_b32 v162,16,v191
 v_and_b32 v163,0xffff0000,v191
 v_lshlrev_b32 v164,16,v192
 v_and_b32 v165,0xffff0000,v192
 v_lshlrev_b32 v166,16,v193
 v_and_b32 v167,0xffff0000,v193
 v_lshlrev_b32 v168,16,v194
 v_and_b32 v169,0xffff0000,v194
 v_lshlrev_b32 v170,16,v195
 v_and_b32 v171,0xffff0000,v195
 v_lshlrev_b32 v172,16,v196
 v_and_b32 v173,0xffff0000,v196
 v_lshlrev_b32 v174,16,v197
 v_and_b32 v175,0xffff0000,v197
 v_add_f32 v156,v156,v198
 v_add_f32 v157,v157,v198
 v_add_f32 v158,v158,v198
 v_add_f32 v159,v159,v198
 v_add_f32 v160,v160,v198
 v_add_f32 v161,v161,v198
 v_add_f32 v162,v162,v198
 v_add_f32 v163,v163,v198
 v_add_f32 v164,v164,v198
 v_add_f32 v165,v165,v198
 v_add_f32 v166,v166,v198
 v_add_f32 v167,v167,v198
 v_add_f32 v168,v168,v198
 v_add_f32 v169,v169,v198
 v_add_f32 v170,v170,v198
 v_add_f32 v171,v171,v198
 v_add_f32 v172,v172,v198
 v_add_f32 v173,v173,v198
 v_add_f32 v174,v174,v198
 v_add_f32 v175,v175,v198
 s_mul_i32 s41,s54,20480
 s_add_u32 s41,s41,2621440
 s_add_u32 s56,s56,s41
 s_add_u32 s57,s57,s41
 s_add_u32 s58,s56,20480
 s_add_u32 s59,s57,20480
 v_fmac_f32 v96,v136,v187
 v_fmac_f32 v97,v137,v187
 v_fmac_f32 v98,v138,v187
 v_fmac_f32 v99,v139,v187
 v_fmac_f32 v100,v140,v187
 v_fmac_f32 v101,v141,v187
 v_fmac_f32 v102,v142,v187
 v_fmac_f32 v103,v143,v187
 v_fmac_f32 v104,v144,v187
 v_fmac_f32 v105,v145,v187
 v_fmac_f32 v106,v146,v187
 v_fmac_f32 v107,v147,v187
 v_fmac_f32 v108,v148,v187
 v_fmac_f32 v109,v149,v187
 v_fmac_f32 v110,v150,v187
 v_fmac_f32 v111,v151,v187
 v_fmac_f32 v112,v152,v187
 v_fmac_f32 v113,v153,v187
 v_fmac_f32 v114,v154,v187
 v_fmac_f32 v115,v155,v187
 v_cvt_pk_bf16_f32 v176,v96,v97
 v_cvt_pk_bf16_f32 v177,v98,v99
 v_cvt_pk_bf16_f32 v178,v100,v101
 v_cvt_pk_bf16_f32 v179,v102,v103
 v_cvt_pk_bf16_f32 v180,v104,v105
 v_cvt_pk_bf16_f32 v181,v106,v107
 v_cvt_pk_bf16_f32 v182,v108,v109
 v_cvt_pk_bf16_f32 v183,v110,v111
 v_cvt_pk_bf16_f32 v184,v112,v113
 v_cvt_pk_bf16_f32 v185,v114,v115
 v_mov_b32 v186,0
 v_mov_b32 v187,0
 buffer_store_dwordx4 v[176:179],v9,s[28:31],s56 offen sc1
 buffer_store_dwordx4 v[180:183],v9,s[28:31],s56 offen offset:1024 sc1
 v_fmac_f32 v116,v156,v199
 v_fmac_f32 v117,v157,v199
 v_fmac_f32 v118,v158,v199
 v_fmac_f32 v119,v159,v199
 v_fmac_f32 v120,v160,v199
 v_fmac_f32 v121,v161,v199
 v_fmac_f32 v122,v162,v199
 v_fmac_f32 v123,v163,v199
 v_fmac_f32 v124,v164,v199
 v_fmac_f32 v125,v165,v199
 v_fmac_f32 v126,v166,v199
 v_fmac_f32 v127,v167,v199
 v_fmac_f32 v128,v168,v199
 v_fmac_f32 v129,v169,v199
 v_fmac_f32 v130,v170,v199
 v_fmac_f32 v131,v171,v199
 v_fmac_f32 v132,v172,v199
 v_fmac_f32 v133,v173,v199
 v_fmac_f32 v134,v174,v199
 v_fmac_f32 v135,v175,v199
 v_cvt_pk_bf16_f32 v188,v116,v117
 buffer_store_dwordx2 v[184:185],v8,s[28:31],s57 offen sc1
 v_cvt_pk_bf16_f32 v189,v118,v119
 v_cvt_pk_bf16_f32 v190,v120,v121
 v_cvt_pk_bf16_f32 v191,v122,v123
 v_cvt_pk_bf16_f32 v192,v124,v125
 v_cvt_pk_bf16_f32 v193,v126,v127
 v_cvt_pk_bf16_f32 v194,v128,v129
 v_cvt_pk_bf16_f32 v195,v130,v131
 v_cvt_pk_bf16_f32 v196,v132,v133
 v_cvt_pk_bf16_f32 v197,v134,v135
 v_mov_b32 v198,0
 v_mov_b32 v199,0
 v_mov_b32 v200,0x3f803f80
 v_mov_b32 v201,0x3f803f80
 v_mov_b32 v202,0x3f803f80
 v_mov_b32 v203,0x3f803f80
 s_nop 1
 v_mfma_f32_16x16x32_bf16 v[204:207],v[200:203],v[176:179],0
 v_and_b32 v14,3,v0
 v_cmp_eq_u32 s[36:37],1,v14
 v_mfma_f32_16x16x32_bf16 v[204:207],v[200:203],v[180:183],v[204:207]
 v_cmp_eq_u32 s[38:39],2,v14
 v_cmp_eq_u32 vcc,3,v14
 v_mfma_f32_16x16x32_bf16 v[204:207],v[200:203],v[184:187],v[204:207]
 buffer_store_dwordx4 v[188:191],v9,s[28:31],s58 offen sc1
 v_and_b32 v14,120,v8
 v_mfma_f32_16x16x32_bf16 v[208:211],v[176:179],v[176:179],0
 s_lshl_b32 s41,s54,10
 s_lshl_b32 s42,s74,7
 s_add_u32 s41,s41,s42
 v_mfma_f32_16x16x32_bf16 v[208:211],v[180:183],v[180:183],v[208:211]
 s_add_u32 s41,s41,5242880
 v_mfma_f32_16x16x32_bf16 v[208:211],v[184:187],v[184:187],v[208:211]
 v_mfma_f32_16x16x32_bf16 v[212:215],v[200:203],v[188:191],0
 v_mfma_f32_16x16x32_bf16 v[212:215],v[200:203],v[192:195],v[212:215]
 v_mfma_f32_16x16x32_bf16 v[212:215],v[200:203],v[196:199],v[212:215]
 v_mfma_f32_16x16x32_bf16 v[216:219],v[188:191],v[188:191],0
 v_mfma_f32_16x16x32_bf16 v[216:219],v[192:195],v[192:195],v[216:219]
 buffer_store_dwordx4 v[192:195],v9,s[28:31],s58 offen offset:1024 sc1
 v_mfma_f32_16x16x32_bf16 v[216:219],v[196:199],v[196:199],v[216:219]
 s_waitcnt vmcnt(37)
 s_barrier
 ds_read_b128 v[16:19],v4
 ds_read_b128 v[20:23],v5
 ds_read_b128 v[24:27],v4 offset:128
 ds_read_b128 v[28:31],v5 offset:128
 ds_read_b128 v[32:35],v4 offset:256
 ds_read_b128 v[36:39],v5 offset:256
 v_cndmask_b32 v208,v208,v209,s[36:37]
 v_cndmask_b32 v208,v208,v210,s[38:39]
 v_cndmask_b32 v208,v208,v211,vcc
 v_cndmask_b32 v205,0,v208,s[70:71]
 v_cndmask_b32 v216,v216,v217,s[36:37]
 v_cndmask_b32 v216,v216,v218,s[38:39]
 v_cndmask_b32 v216,v216,v219,vcc
 v_cndmask_b32 v213,0,v216,s[70:71]
 v_mov_b32 v206,v205
 v_mov_b32 v214,v213
 s_nop 0
 v_permlane32_swap_b32 v205,v206
 v_permlane32_swap_b32 v213,v214
 v_add_f32 v205,v205,v206
 v_add_f32 v213,v213,v214
 v_mov_b32 v206,v205
 buffer_store_dwordx2 v[196:197],v8,s[28:31],s59 offen sc1
 v_mov_b32 v214,v213
 v_permlane16_swap_b32 v205,v206
 s_nop 0
 v_permlane16_swap_b32 v213,v214
 v_add_f32 v205,v205,v206
 v_add_f32 v213,v213,v214
 buffer_store_dwordx2 v[204:205],v14,s[28:31],s41 offen sc1
 buffer_store_dwordx2 v[212:213],v14,s[28:31],s41 offen offset:1024 sc1
 v_mov_b32 v254,0
 s_cmp_lg_u32 s32,0
 s_cbranch_scc1 Le20
 v_mov_b32 v14,0
 v_mov_b32 v15,1
 s_mov_b64 exec,1
 global_atomic_add v254,v14,v15,s[86:87] sc0 sc1
 s_mov_b64 exec,-1
Le20:
 v_mov_b32 v160,0
 v_mov_b32 v161,0
 v_mov_b32 v162,0
 v_mov_b32 v163,0
 s_waitcnt lgkmcnt(0)
 v_mfma_f32_16x16x32_bf16 v[192:195],v[16:19],a[192:195],0
 ds_read_b128 v[40:43],v4 offset:6144
 ds_read_b128 v[44:47],v5 offset:6144
 v_mfma_f32_16x16x32_bf16 v[192:195],v[20:23],a[208:211],v[192:195]
 ds_read_b128 v[48:51],v4 offset:6272
 ds_read_b128 v[52:55],v5 offset:6272
 v_mfma_f32_16x16x32_bf16 v[192:195],v[24:27],a[224:227],v[192:195]
 ds_read_b128 v[56:59],v4 offset:6400
 ds_read_b128 v[60:63],v5 offset:6400
 v_mfma_f32_16x16x32_bf16 v[192:195],v[28:31],a[240:243],v[192:195]
 v_mov_b32 v10,0
 v_mov_b32 v11,0
 v_mfma_f32_16x16x32_bf16 v[192:195],v[32:35],v[64:67],v[192:195]
 v_mov_b32 v12,0
 v_mov_b32 v13,0
 v_mfma_f32_16x16x32_bf16 v[192:195],v[36:39],v[80:83],v[192:195]
 v_mov_b32 v248,v1
 v_mov_b32 v249,v2
 v_mfma_f32_16x16x32_bf16 v[196:199],v[16:19],a[196:199],0
 v_mov_b32 v250,v3
 v_lshrrev_b32 v14,2,v0
 v_mfma_f32_16x16x32_bf16 v[196:199],v[20:23],a[212:215],v[196:199]
 v_mul_u32_u24 v6,384,v14
 v_and_b32 v14,6,v14
 v_mfma_f32_16x16x32_bf16 v[196:199],v[24:27],a[228:231],v[196:199]
 v_lshl_add_u32 v6,v14,4,v6
 v_and_b32 v15,3,v0
 v_mfma_f32_16x16x32_bf16 v[196:199],v[28:31],a[244:247],v[196:199]
 v_lshl_add_u32 v6,v15,3,v6
 v_add_u32 v6,98304,v6
 v_mfma_f32_16x16x32_bf16 v[196:199],v[32:35],v[68:71],v[196:199]
 v_xor_b32 v7,32,v6
 v_xor_b32 v8,64,v6
 v_mfma_f32_16x16x32_bf16 v[196:199],v[36:39],v[84:87],v[196:199]
 v_xor_b32 v9,0x60,v6
 v_max3_f32 v240,v192,v193,v194
 v_mfma_f32_16x16x32_bf16 v[200:203],v[16:19],a[200:203],0
 v_max_f32 v240,v240,v195
 v_mfma_f32_16x16x32_bf16 v[200:203],v[20:23],a[216:219],v[200:203]
 v_mfma_f32_16x16x32_bf16 v[200:203],v[24:27],a[232:235],v[200:203]
 v_mfma_f32_16x16x32_bf16 v[200:203],v[28:31],a[248:251],v[200:203]
 v_mfma_f32_16x16x32_bf16 v[200:203],v[32:35],v[72:75],v[200:203]
 v_mfma_f32_16x16x32_bf16 v[200:203],v[36:39],v[88:91],v[200:203]
 v_max3_f32 v241,v196,v197,v198
 v_max_f32 v241,v241,v199
 v_mfma_f32_16x16x32_bf16 v[204:207],v[16:19],a[204:207],0
 v_mfma_f32_16x16x32_bf16 v[204:207],v[20:23],a[220:223],v[204:207]
 v_mfma_f32_16x16x32_bf16 v[204:207],v[24:27],a[236:239],v[204:207]
 v_mfma_f32_16x16x32_bf16 v[204:207],v[28:31],a[252:255],v[204:207]
 v_mfma_f32_16x16x32_bf16 v[204:207],v[32:35],v[76:79],v[204:207]
 v_mfma_f32_16x16x32_bf16 v[204:207],v[36:39],v[92:95],v[204:207]
 v_max3_f32 v242,v200,v201,v202
 v_max_f32 v242,v242,v203
 v_mfma_f32_16x16x32_bf16 a[0:3],v[160:163],v[160:163],0
 ds_read_b128 v[16:19],v4 offset:12288
 ds_read_b128 v[20:23],v5 offset:12288
 v_mfma_f32_16x16x32_bf16 a[4:7],v[160:163],v[160:163],0
 ds_read_b128 v[24:27],v4 offset:12416
 ds_read_b128 v[28:31],v5 offset:12416
 v_mfma_f32_16x16x32_bf16 a[8:11],v[160:163],v[160:163],0
 ds_read_b128 v[32:35],v4 offset:12544
 ds_read_b128 v[36:39],v5 offset:12544
 v_mfma_f32_16x16x32_bf16 a[12:15],v[160:163],v[160:163],0
 v_mfma_f32_16x16x32_bf16 a[16:19],v[160:163],v[160:163],0
 s_sub_u32 s20,s12,s35
 v_mfma_f32_16x16x32_bf16 a[20:23],v[160:163],v[160:163],0
 s_subb_u32 s21,s13,0
 v_max3_f32 v243,v204,v205,v206
 v_max_f32 v243,v243,v207
 v_mfma_f32_16x16x32_bf16 a[24:27],v[160:163],v[160:163],0
 s_mov_b32 s22,786432
 v_mov_b32 v244,v240
 v_mov_b32 v245,v241
 v_mfma_f32_16x16x32_bf16 a[28:31],v[160:163],v[160:163],0
 s_sub_u32 s24,s16,s35
 v_mov_b32 v246,v242
 v_mov_b32 v247,v243
 v_mfma_f32_16x16x32_bf16 a[32:35],v[160:163],v[160:163],0
 s_subb_u32 s25,s17,0
 v_permlane32_swap_b32 v240,v244
 v_permlane32_swap_b32 v241,v245
 v_mfma_f32_16x16x32_bf16 a[36:39],v[160:163],v[160:163],0
 s_mov_b32 s26,786432
 v_permlane32_swap_b32 v242,v246
 v_permlane32_swap_b32 v243,v247
 v_mfma_f32_16x16x32_bf16 a[40:43],v[160:163],v[160:163],0
 s_movk_i32 s66,3072
 v_max_f32 v240,v240,v244
 v_max_f32 v241,v241,v245
 v_mfma_f32_16x16x32_bf16 a[44:47],v[160:163],v[160:163],0
 s_movk_i32 s68,3072
 v_max_f32 v242,v242,v246
 v_max_f32 v243,v243,v247
 v_mfma_f32_16x16x32_bf16 a[48:51],v[160:163],v[160:163],0
 s_movk_i32 s67,24576
 v_mov_b32 v244,v240
 v_mov_b32 v245,v241
 v_mfma_f32_16x16x32_bf16 a[52:55],v[160:163],v[160:163],0
 s_movk_i32 s69,24576
 v_mov_b32 v246,v242
 v_mov_b32 v247,v243
 v_mfma_f32_16x16x32_bf16 a[56:59],v[160:163],v[160:163],0
 s_mul_i32 s41,s52,48
 v_permlane16_swap_b32 v240,v244
 v_permlane16_swap_b32 v241,v245
 v_mfma_f32_16x16x32_bf16 a[60:63],v[160:163],v[160:163],0
 s_add_u32 s41,s41,s32
 v_permlane16_swap_b32 v242,v246
 v_permlane16_swap_b32 v243,v247
 v_mfma_f32_16x16x32_bf16 a[64:67],v[160:163],v[160:163],0
 s_mul_i32 s41,s41,20480
 v_max_f32 v240,v240,v244
 v_max_f32 v241,v241,v245
 v_mfma_f32_16x16x32_bf16 a[68:71],v[160:163],v[160:163],0
 s_mul_i32 s42,s53,320
 v_max_f32 v242,v242,v246
 v_max_f32 v243,v243,v247
 v_mfma_f32_16x16x32_bf16 a[72:75],v[160:163],v[160:163],0
 s_andn2_b32 s42,s42,127
 v_sub_f32 v112,0,v240
 v_sub_f32 v113,0,v240
 v_mfma_f32_16x16x32_bf16 a[76:79],v[160:163],v[160:163],0
 s_add_u32 s41,s41,s42
 v_sub_f32 v114,0,v240
 v_sub_f32 v115,0,v240
 v_mfma_f32_16x16x32_bf16 a[80:83],v[160:163],v[160:163],0
 s_add_u32 s56,s72,s41
 v_sub_f32 v116,0,v241
 v_sub_f32 v117,0,v241
 v_mfma_f32_16x16x32_bf16 a[84:87],v[160:163],v[160:163],0
 s_addc_u32 s57,s73,0
 v_sub_f32 v118,0,v241
 v_sub_f32 v119,0,v241
 v_mfma_f32_16x16x32_bf16 a[88:91],v[160:163],v[160:163],0
 s_sub_u32 s58,7864320,s41
 v_sub_f32 v120,0,v242
 v_sub_f32 v121,0,v242
 v_mfma_f32_16x16x32_bf16 a[92:95],v[160:163],v[160:163],0
 s_mul_i32 s70,s53,245760
 v_sub_f32 v122,0,v242
 v_sub_f32 v123,0,v242
 v_mfma_f32_16x16x32_bf16 a[96:99],v[160:163],v[160:163],0
 s_sub_u32 s70,s70,81920
 v_sub_f32 v124,0,v243
 v_sub_f32 v125,0,v243
 v_mfma_f32_16x16x32_bf16 a[100:103],v[160:163],v[160:163],0
 s_mov_b32 s59,s56
 v_sub_f32 v126,0,v243
 v_sub_f32 v127,0,v243
 v_mfma_f32_16x16x32_bf16 a[104:107],v[160:163],v[160:163],0
 s_mov_b32 s60,s57
 v_sub_f32 v192,v192,v240
 v_sub_f32 v193,v193,v240
 v_mfma_f32_16x16x32_bf16 a[108:111],v[160:163],v[160:163],0
 s_mov_b32 s61,s58
 v_sub_f32 v194,v194,v240
 v_sub_f32 v195,v195,v240
 v_mfma_f32_16x16x32_bf16 a[112:115],v[160:163],v[160:163],0
 s_movk_i32 s76,10240
 v_sub_f32 v196,v196,v241
 v_sub_f32 v197,v197,v241
 v_mfma_f32_16x16x32_bf16 a[116:119],v[160:163],v[160:163],0
 s_mov_b32 s77,81920
 v_sub_f32 v198,v198,v241
 v_sub_f32 v199,v199,v241
 v_mfma_f32_16x16x32_bf16 a[120:123],v[160:163],v[160:163],0
 s_cmp_eq_u32 s53,0
 v_sub_f32 v200,v200,v242
 v_sub_f32 v201,v201,v242
 v_mfma_f32_16x16x32_bf16 a[124:127],v[160:163],v[160:163],0
 s_cselect_b32 s78,245760,0
 v_sub_f32 v202,v202,v242
 v_sub_f32 v203,v203,v242
 v_mfma_f32_16x16x32_bf16 a[128:131],v[160:163],v[160:163],0
 s_sub_u32 s78,s78,81920
 v_sub_f32 v204,v204,v243
 v_sub_f32 v205,v205,v243
 v_mfma_f32_16x16x32_bf16 a[132:135],v[160:163],v[160:163],0
 s_movk_i32 s79,2731
 v_sub_f32 v206,v206,v243
 v_sub_f32 v207,v207,v243
 v_mfma_f32_16x16x32_bf16 a[136:139],v[160:163],v[160:163],0
 s_movk_i32 s75,896
 v_exp_f32 v192,v192
 v_mfma_f32_16x16x32_bf16 a[140:143],v[160:163],v[160:163],0
 s_mov_b32 s74,0
 v_exp_f32 v193,v193
 v_mfma_f32_16x16x32_bf16 a[144:147],v[160:163],v[160:163],0
 s_mov_b32 s71,6
 v_exp_f32 v194,v194
 v_mfma_f32_16x16x32_bf16 a[148:151],v[160:163],v[160:163],0
 s_and_b32 s48,s62,63
 v_add_f32 v10,v10,v192
 v_cvt_pk_bf16_f32 v128,v192,v193
 v_mfma_f32_16x16x32_bf16 a[152:155],v[160:163],v[160:163],0
 s_add_u32 s48,s48,s32
 v_exp_f32 v195,v195
 v_mfma_f32_16x16x32_bf16 a[156:159],v[160:163],v[160:163],0
 v_add_f32 v10,v10,v193
 v_add_f32 v10,v10,v194
 v_mfma_f32_16x16x32_bf16 a[160:163],v[160:163],v[160:163],0
 v_cvt_pk_bf16_f32 v129,v194,v195
 v_add_f32 v10,v10,v195
 v_mfma_f32_16x16x32_bf16 a[164:167],v[160:163],v[160:163],0
 v_exp_f32 v196,v196
 v_mfma_f32_16x16x32_bf16 a[168:171],v[160:163],v[160:163],0
 v_exp_f32 v197,v197
 v_mfma_f32_16x16x32_bf16 a[172:175],v[160:163],v[160:163],0
 v_exp_f32 v198,v198
 v_mfma_f32_16x16x32_bf16 a[176:179],v[160:163],v[160:163],0
 v_add_f32 v11,v11,v196
 v_cvt_pk_bf16_f32 v136,v196,v197
 v_mfma_f32_16x16x32_bf16 a[180:183],v[160:163],v[160:163],0
 v_exp_f32 v199,v199
 v_mfma_f32_16x16x32_bf16 a[184:187],v[160:163],v[160:163],0
 v_add_f32 v11,v11,v197
 v_add_f32 v11,v11,v198
 v_mfma_f32_16x16x32_bf16 a[188:191],v[160:163],v[160:163],0
 s_waitcnt lgkmcnt(0)
 v_cvt_pk_bf16_f32 v137,v198,v199
 v_add_f32 v11,v11,v199
 v_mfma_f32_16x16x32_bf16 v[208:211],v[40:43],a[192:195],v[112:115]
 v_exp_f32 v200,v200
 v_mfma_f32_16x16x32_bf16 v[208:211],v[44:47],a[208:211],v[208:211]
 v_exp_f32 v201,v201
 v_mfma_f32_16x16x32_bf16 v[208:211],v[48:51],a[224:227],v[208:211]
 v_exp_f32 v202,v202
 v_mfma_f32_16x16x32_bf16 v[208:211],v[52:55],a[240:243],v[208:211]
 v_add_f32 v12,v12,v200
 v_cvt_pk_bf16_f32 v144,v200,v201
 v_mfma_f32_16x16x32_bf16 v[208:211],v[56:59],v[64:67],v[208:211]
 v_exp_f32 v203,v203
 v_mfma_f32_16x16x32_bf16 v[208:211],v[60:63],v[80:83],v[208:211]
 v_add_f32 v12,v12,v201
 v_add_f32 v12,v12,v202
 v_mfma_f32_16x16x32_bf16 v[212:215],v[40:43],a[196:199],v[116:119]
 v_cvt_pk_bf16_f32 v145,v202,v203
 v_add_f32 v12,v12,v203
 v_mfma_f32_16x16x32_bf16 v[212:215],v[44:47],a[212:215],v[212:215]
 v_exp_f32 v204,v204
 v_mfma_f32_16x16x32_bf16 v[212:215],v[48:51],a[228:231],v[212:215]
 v_exp_f32 v205,v205
 v_mfma_f32_16x16x32_bf16 v[212:215],v[52:55],a[244:247],v[212:215]
 v_exp_f32 v206,v206
 v_mfma_f32_16x16x32_bf16 v[212:215],v[56:59],v[68:71],v[212:215]
 v_add_f32 v13,v13,v204
 v_cvt_pk_bf16_f32 v152,v204,v205
 v_mfma_f32_16x16x32_bf16 v[212:215],v[60:63],v[84:87],v[212:215]
 v_exp_f32 v207,v207
 v_mfma_f32_16x16x32_bf16 v[216:219],v[40:43],a[200:203],v[120:123]
 v_add_f32 v13,v13,v205
 v_add_f32 v13,v13,v206
 v_mfma_f32_16x16x32_bf16 v[216:219],v[44:47],a[216:219],v[216:219]
 v_cvt_pk_bf16_f32 v153,v206,v207
 v_add_f32 v13,v13,v207
 v_mfma_f32_16x16x32_bf16 v[216:219],v[48:51],a[232:235],v[216:219]
 v_exp_f32 v208,v208
 v_mfma_f32_16x16x32_bf16 v[216:219],v[52:55],a[248:251],v[216:219]
 v_exp_f32 v209,v209
 v_mfma_f32_16x16x32_bf16 v[216:219],v[56:59],v[72:75],v[216:219]
 v_exp_f32 v210,v210
 v_mfma_f32_16x16x32_bf16 v[216:219],v[60:63],v[88:91],v[216:219]
 v_add_f32 v10,v10,v208
 v_cvt_pk_bf16_f32 v130,v208,v209
 v_mfma_f32_16x16x32_bf16 v[220:223],v[40:43],a[204:207],v[124:127]
 v_exp_f32 v211,v211
 v_mfma_f32_16x16x32_bf16 v[220:223],v[44:47],a[220:223],v[220:223]
 v_add_f32 v10,v10,v209
 v_add_f32 v10,v10,v210
 v_mfma_f32_16x16x32_bf16 v[220:223],v[48:51],a[236:239],v[220:223]
 v_cvt_pk_bf16_f32 v131,v210,v211
 v_add_f32 v10,v10,v211
 v_mfma_f32_16x16x32_bf16 v[220:223],v[52:55],a[252:255],v[220:223]
 v_exp_f32 v212,v212
 v_mfma_f32_16x16x32_bf16 v[220:223],v[56:59],v[76:79],v[220:223]
 v_exp_f32 v213,v213
 v_mfma_f32_16x16x32_bf16 v[220:223],v[60:63],v[92:95],v[220:223]
 v_exp_f32 v214,v214
 v_mfma_f32_16x16x32_bf16 v[224:227],v[16:19],a[192:195],v[112:115]
 ds_read_b128 v[40:43],v4 offset:18432
 ds_read_b128 v[44:47],v5 offset:18432
 v_mfma_f32_16x16x32_bf16 v[224:227],v[20:23],a[208:211],v[224:227]
 ds_read_b128 v[48:51],v4 offset:18560
 ds_read_b128 v[52:55],v5 offset:18560
 v_mfma_f32_16x16x32_bf16 v[224:227],v[24:27],a[224:227],v[224:227]
 ds_read_b128 v[56:59],v4 offset:18688
 ds_read_b128 v[60:63],v5 offset:18688
 v_mfma_f32_16x16x32_bf16 v[224:227],v[28:31],a[240:243],v[224:227]
 v_add_f32 v11,v11,v212
 v_cvt_pk_bf16_f32 v138,v212,v213
 v_mfma_f32_16x16x32_bf16 v[224:227],v[32:35],v[64:67],v[224:227]
 v_add_u32 v4,24576,v4
 v_add_u32 v5,24576,v5
 v_mfma_f32_16x16x32_bf16 v[224:227],v[36:39],v[80:83],v[224:227]
 v_exp_f32 v215,v215
 v_mfma_f32_16x16x32_bf16 v[228:231],v[16:19],a[196:199],v[116:119]
 v_add_f32 v11,v11,v213
 v_add_f32 v11,v11,v214
 v_mfma_f32_16x16x32_bf16 v[228:231],v[20:23],a[212:215],v[228:231]
 v_cvt_pk_bf16_f32 v139,v214,v215
 v_add_f32 v11,v11,v215
 v_mfma_f32_16x16x32_bf16 v[228:231],v[24:27],a[228:231],v[228:231]
 v_exp_f32 v216,v216
 v_mfma_f32_16x16x32_bf16 v[228:231],v[28:31],a[244:247],v[228:231]
 v_exp_f32 v217,v217
 v_mfma_f32_16x16x32_bf16 v[228:231],v[32:35],v[68:71],v[228:231]
 v_exp_f32 v218,v218
 v_mfma_f32_16x16x32_bf16 v[228:231],v[36:39],v[84:87],v[228:231]
 v_add_f32 v12,v12,v216
 v_cvt_pk_bf16_f32 v146,v216,v217
 v_mfma_f32_16x16x32_bf16 v[232:235],v[16:19],a[200:203],v[120:123]
 v_exp_f32 v219,v219
 v_mfma_f32_16x16x32_bf16 v[232:235],v[20:23],a[216:219],v[232:235]
 v_add_f32 v12,v12,v217
 v_add_f32 v12,v12,v218
 v_mfma_f32_16x16x32_bf16 v[232:235],v[24:27],a[232:235],v[232:235]
 v_cvt_pk_bf16_f32 v147,v218,v219
 v_add_f32 v12,v12,v219
 v_mfma_f32_16x16x32_bf16 v[232:235],v[28:31],a[248:251],v[232:235]
 v_exp_f32 v220,v220
 v_mfma_f32_16x16x32_bf16 v[232:235],v[32:35],v[72:75],v[232:235]
 v_exp_f32 v221,v221
 v_mfma_f32_16x16x32_bf16 v[232:235],v[36:39],v[88:91],v[232:235]
 v_exp_f32 v222,v222
 v_mfma_f32_16x16x32_bf16 v[236:239],v[16:19],a[204:207],v[124:127]
 v_add_f32 v13,v13,v220
 v_cvt_pk_bf16_f32 v154,v220,v221
 v_mfma_f32_16x16x32_bf16 v[236:239],v[20:23],a[220:223],v[236:239]
 v_exp_f32 v223,v223
 v_mfma_f32_16x16x32_bf16 v[236:239],v[24:27],a[236:239],v[236:239]
 v_add_f32 v13,v13,v221
 v_add_f32 v13,v13,v222
 v_mfma_f32_16x16x32_bf16 v[236:239],v[28:31],a[252:255],v[236:239]
 v_cvt_pk_bf16_f32 v155,v222,v223
 v_add_f32 v13,v13,v223
 v_mfma_f32_16x16x32_bf16 v[236:239],v[32:35],v[76:79],v[236:239]
 v_mfma_f32_16x16x32_bf16 v[236:239],v[36:39],v[92:95],v[236:239]
 s_waitcnt vmcnt(20) lgkmcnt(0)
 s_barrier
 v_exp_f32 v224,v224
 v_mfma_f32_16x16x32_bf16 v[96:99],v[40:43],a[192:195],v[112:115]
 ds_read_b128 v[16:19],v4
 ds_read_b128 v[20:23],v5
 v_mfma_f32_16x16x32_bf16 v[96:99],v[44:47],a[208:211],v[96:99]
 s_mov_b32 s36,0
 ds_read_b128 v[24:27],v4 offset:128
 ds_read_b128 v[28:31],v5 offset:128
 v_mfma_f32_16x16x32_bf16 v[96:99],v[48:51],a[224:227],v[96:99]
 s_mov_b32 s37,49152
 ds_read_b128 v[32:35],v4 offset:256
 ds_read_b128 v[36:39],v5 offset:256
 v_mfma_f32_16x16x32_bf16 v[96:99],v[52:55],a[240:243],v[96:99]
 s_mov_b32 s38,98304
 v_exp_f32 v225,v225
 v_mfma_f32_16x16x32_bf16 v[96:99],v[56:59],v[64:67],v[96:99]
 s_mov_b32 s39,73728
 v_exp_f32 v226,v226
 v_mfma_f32_16x16x32_bf16 v[96:99],v[60:63],v[80:83],v[96:99]
 s_mov_b32 s40,49152
 v_add_f32 v10,v10,v224
 v_cvt_pk_bf16_f32 v132,v224,v225
 v_mfma_f32_16x16x32_bf16 v[100:103],v[40:43],a[196:199],v[116:119]
 s_add_u32 m0,s35,24576
 v_exp_f32 v227,v227
 v_mfma_f32_16x16x32_bf16 v[100:103],v[44:47],a[212:215],v[100:103]
 s_mov_b32 s43,0
 v_add_f32 v10,v10,v225
 v_add_f32 v10,v10,v226
 v_mfma_f32_16x16x32_bf16 v[100:103],v[48:51],a[228:231],v[100:103]
 buffer_load_dwordx4 v1,s[12:15],s39 offen lds
 v_cvt_pk_bf16_f32 v133,v226,v227
 v_mfma_f32_16x16x32_bf16 v[100:103],v[52:55],a[244:247],v[100:103]
 v_add_f32 v10,v10,v227
 v_mfma_f32_16x16x32_bf16 v[100:103],v[56:59],v[68:71],v[100:103]
 buffer_load_dwordx4 v2,s[12:15],s39 offen offset:1024 lds
 v_mfma_f32_16x16x32_bf16 v[100:103],v[60:63],v[84:87],v[100:103]
 v_exp_f32 v228,v228
 v_mfma_f32_16x16x32_bf16 v[104:107],v[40:43],a[200:203],v[120:123]
 buffer_load_dwordx4 v3,s[12:15],s39 offen offset:2048 lds
 v_mfma_f32_16x16x32_bf16 v[104:107],v[44:47],a[216:219],v[104:107]
 v_exp_f32 v229,v229
 v_mfma_f32_16x16x32_bf16 v[104:107],v[48:51],a[232:235],v[104:107]
 v_exp_f32 v230,v230
 v_mfma_f32_16x16x32_bf16 v[104:107],v[52:55],a[248:251],v[104:107]
 v_add_f32 v11,v11,v228
 v_cvt_pk_bf16_f32 v140,v228,v229
 v_mfma_f32_16x16x32_bf16 v[104:107],v[56:59],v[72:75],v[104:107]
 v_exp_f32 v231,v231
 v_mfma_f32_16x16x32_bf16 v[104:107],v[60:63],v[88:91],v[104:107]
 v_add_f32 v11,v11,v229
 v_add_f32 v11,v11,v230
 v_mfma_f32_16x16x32_bf16 v[108:111],v[40:43],a[204:207],v[124:127]
 v_cvt_pk_bf16_f32 v141,v230,v231
 v_add_f32 v11,v11,v231
 v_mfma_f32_16x16x32_bf16 v[108:111],v[44:47],a[220:223],v[108:111]
 v_exp_f32 v232,v232
 v_mfma_f32_16x16x32_bf16 v[108:111],v[48:51],a[236:239],v[108:111]
 v_exp_f32 v233,v233
 v_mfma_f32_16x16x32_bf16 v[108:111],v[52:55],a[252:255],v[108:111]
 v_exp_f32 v234,v234
 v_mfma_f32_16x16x32_bf16 v[108:111],v[56:59],v[76:79],v[108:111]
 v_add_f32 v12,v12,v232
 v_cvt_pk_bf16_f32 v148,v232,v233
 v_mfma_f32_16x16x32_bf16 v[108:111],v[60:63],v[92:95],v[108:111]
 v_exp_f32 v235,v235
 v_add_f32 v12,v12,v233
 v_add_f32 v12,v12,v234
 v_cvt_pk_bf16_f32 v149,v234,v235
 v_add_f32 v12,v12,v235
 v_exp_f32 v236,v236
 v_exp_f32 v237,v237
 v_exp_f32 v238,v238
 v_add_f32 v13,v13,v236
 v_cvt_pk_bf16_f32 v156,v236,v237
 v_exp_f32 v239,v239
 v_add_f32 v13,v13,v237
 v_add_f32 v13,v13,v238
 v_cvt_pk_bf16_f32 v157,v238,v239
 v_add_f32 v13,v13,v239
 v_exp_f32 v96,v96
 v_exp_f32 v97,v97
 v_exp_f32 v98,v98
 v_add_f32 v10,v10,v96
 v_cvt_pk_bf16_f32 v134,v96,v97
 v_exp_f32 v99,v99
 v_add_f32 v10,v10,v97
 v_add_f32 v10,v10,v98
 v_cvt_pk_bf16_f32 v135,v98,v99
 v_add_f32 v10,v10,v99
 v_exp_f32 v100,v100
 v_exp_f32 v101,v101
 v_exp_f32 v102,v102
 v_add_f32 v11,v11,v100
 v_cvt_pk_bf16_f32 v142,v100,v101
 v_exp_f32 v103,v103
 v_add_f32 v11,v11,v101
 v_add_f32 v11,v11,v102
 v_cvt_pk_bf16_f32 v143,v102,v103
 v_add_f32 v11,v11,v103
 v_exp_f32 v104,v104
 v_exp_f32 v105,v105
 v_exp_f32 v106,v106
 v_add_f32 v12,v12,v104
 v_cvt_pk_bf16_f32 v150,v104,v105
 v_exp_f32 v107,v107
 v_add_f32 v12,v12,v105
 v_add_f32 v12,v12,v106
 v_cvt_pk_bf16_f32 v151,v106,v107
 v_add_f32 v12,v12,v107
 v_exp_f32 v108,v108
 v_mov_b32 v236,s80
 v_mov_b32 v237,s81
 v_mov_b32 v238,0
 v_mov_b32 v239,0
 s_waitcnt lgkmcnt(0)
.p2align 6
recurrent_scan__mha_block_cached__mixer_s_mlp__prompt_kernel_loop:
 v_mfma_f32_16x16x32_bf16 v[96:99],v[16:19],a[192:195],v[112:115]
 v_exp_f32 v109,v109
 v_mfma_f32_16x16x32_bf16 v[96:99],v[20:23],a[208:211],v[96:99]
 v_exp_f32 v110,v110
 v_mfma_f32_16x16x32_bf16 v[96:99],v[24:27],a[224:227],v[96:99]
 ds_read_b64_tr_b16 v[40:41],v6
 ds_read_b64_tr_b16 v[42:43],v6 offset:6144
 v_mfma_f32_16x16x32_bf16 v[96:99],v[28:31],a[240:243],v[96:99]
 v_add_f32 v13,v13,v108
 v_cvt_pk_bf16_f32 v158,v108,v109
 v_mfma_f32_16x16x32_bf16 v[96:99],v[32:35],v[64:67],v[96:99]
 ds_read_b64_tr_b16 v[44:45],v6 offset:12288
 ds_read_b64_tr_b16 v[46:47],v6 offset:18432
 v_mfma_f32_16x16x32_bf16 v[96:99],v[36:39],v[80:83],v[96:99]
 v_exp_f32 v111,v111
 v_mfma_f32_16x16x32_bf16 v[100:103],v[36:39],v[84:87],v[116:119]
 ds_read_b64_tr_b16 v[48:49],v7
 ds_read_b64_tr_b16 v[50:51],v7 offset:6144
 v_mfma_f32_16x16x32_bf16 v[100:103],v[32:35],v[68:71],v[100:103]
 v_add_f32 v13,v13,v109
 v_add_f32 v13,v13,v110
 v_mfma_f32_16x16x32_bf16 v[100:103],v[28:31],a[244:247],v[100:103]
 v_cvt_pk_bf16_f32 v159,v110,v111
 v_add_f32 v13,v13,v111
 v_mfma_f32_16x16x32_bf16 v[100:103],v[24:27],a[228:231],v[100:103]
 ds_read_b64_tr_b16 v[52:53],v7 offset:12288
 ds_read_b64_tr_b16 v[54:55],v7 offset:18432
 v_mfma_f32_16x16x32_bf16 v[100:103],v[20:23],a[212:215],v[100:103]
 v_exp_f32 v96,v96
 v_mfma_f32_16x16x32_bf16 v[100:103],v[16:19],a[196:199],v[100:103]
 ds_read_b64_tr_b16 v[56:57],v8
 ds_read_b64_tr_b16 v[58:59],v8 offset:6144
 v_mfma_f32_16x16x32_bf16 v[104:107],v[16:19],a[200:203],v[120:123]
 v_exp_f32 v97,v97
 v_mfma_f32_16x16x32_bf16 v[104:107],v[20:23],a[216:219],v[104:107]
 v_exp_f32 v98,v98
 v_mfma_f32_16x16x32_bf16 v[104:107],v[24:27],a[232:235],v[104:107]
 ds_read_b64_tr_b16 v[60:61],v8 offset:12288
 ds_read_b64_tr_b16 v[62:63],v8 offset:18432
 v_mfma_f32_16x16x32_bf16 v[104:107],v[28:31],a[248:251],v[104:107]
 v_add_f32 v10,v10,v96
 v_cvt_pk_bf16_f32 v160,v96,v97
 v_mfma_f32_16x16x32_bf16 v[104:107],v[32:35],v[72:75],v[104:107]
 global_load_dword v255,v[236:237],off
 v_mfma_f32_16x16x32_bf16 v[104:107],v[36:39],v[88:91],v[104:107]
 v_exp_f32 v99,v99
 v_mfma_f32_16x16x32_bf16 v[108:111],v[36:39],v[92:95],v[124:127]
 v_lshl_add_u64 v[236:237],v[238:239],0,v[236:237]
 v_mfma_f32_16x16x32_bf16 v[108:111],v[32:35],v[76:79],v[108:111]
 v_add_f32 v10,v10,v97
 v_add_f32 v10,v10,v98
 v_mfma_f32_16x16x32_bf16 v[108:111],v[28:31],a[252:255],v[108:111]
 v_cvt_pk_bf16_f32 v161,v98,v99
 v_add_f32 v10,v10,v99
 v_mfma_f32_16x16x32_bf16 v[108:111],v[24:27],a[236:239],v[108:111]
 v_mfma_f32_16x16x32_bf16 v[108:111],v[20:23],a[220:223],v[108:111]
 v_exp_f32 v100,v100
 v_mfma_f32_16x16x32_bf16 v[108:111],v[16:19],a[204:207],v[108:111]
 s_waitcnt lgkmcnt(0)
 v_mfma_f32_16x16x32_bf16 a[0:3],v[40:43],v[128:131],a[0:3]
 v_exp_f32 v101,v101
 v_mfma_f32_16x16x32_bf16 a[0:3],v[44:47],v[132:135],a[0:3]
 v_exp_f32 v102,v102
 v_mfma_f32_16x16x32_bf16 a[4:7],v[44:47],v[140:143],a[4:7]
 ds_read_b128 v[16:19],v4 offset:6144
 ds_read_b128 v[20:23],v5 offset:6144
 v_mfma_f32_16x16x32_bf16 a[4:7],v[40:43],v[136:139],a[4:7]
 v_add_f32 v11,v11,v100
 v_cvt_pk_bf16_f32 v168,v100,v101
 v_mfma_f32_16x16x32_bf16 a[8:11],v[40:43],v[144:147],a[8:11]
 ds_read_b128 v[24:27],v4 offset:6272
 ds_read_b128 v[28:31],v5 offset:6272
 v_mfma_f32_16x16x32_bf16 a[8:11],v[44:47],v[148:151],a[8:11]
 v_exp_f32 v103,v103
 v_mfma_f32_16x16x32_bf16 a[12:15],v[44:47],v[156:159],a[12:15]
 s_add_u32 s44,s39,s66
 ds_read_b128 v[32:35],v4 offset:6400
 ds_read_b128 v[36:39],v5 offset:6400
 v_mfma_f32_16x16x32_bf16 a[12:15],v[40:43],v[152:155],a[12:15]
 s_add_u32 s42,s36,s35
 v_add_f32 v11,v11,v101
 v_add_f32 v11,v11,v102
 v_mfma_f32_16x16x32_bf16 a[16:19],v[48:51],v[128:131],a[16:19]
 s_add_u32 m0,s42,27648
 v_cvt_pk_bf16_f32 v169,v102,v103
 v_add_f32 v11,v11,v103
 v_mfma_f32_16x16x32_bf16 a[16:19],v[52:55],v[132:135],a[16:19]
 buffer_load_dwordx4 v1,s[12:15],s44 offen lds
 v_mfma_f32_16x16x32_bf16 a[20:23],v[52:55],v[140:143],a[20:23]
 v_exp_f32 v104,v104
 v_mfma_f32_16x16x32_bf16 a[20:23],v[48:51],v[136:139],a[20:23]
 buffer_load_dwordx4 v2,s[12:15],s44 offen offset:1024 lds
 v_mfma_f32_16x16x32_bf16 a[24:27],v[48:51],v[144:147],a[24:27]
 v_exp_f32 v105,v105
 v_mfma_f32_16x16x32_bf16 a[24:27],v[52:55],v[148:151],a[24:27]
 v_exp_f32 v106,v106
 v_mfma_f32_16x16x32_bf16 a[28:31],v[52:55],v[156:159],a[28:31]
 buffer_load_dwordx4 v3,s[12:15],s44 offen offset:2048 lds
 v_mfma_f32_16x16x32_bf16 a[28:31],v[48:51],v[152:155],a[28:31]
 v_add_f32 v12,v12,v104
 v_cvt_pk_bf16_f32 v176,v104,v105
 v_mfma_f32_16x16x32_bf16 a[32:35],v[56:59],v[128:131],a[32:35]
 v_mfma_f32_16x16x32_bf16 a[32:35],v[60:63],v[132:135],a[32:35]
 v_exp_f32 v107,v107
 v_mfma_f32_16x16x32_bf16 a[36:39],v[60:63],v[140:143],a[36:39]
 v_mfma_f32_16x16x32_bf16 a[36:39],v[56:59],v[136:139],a[36:39]
 v_add_f32 v12,v12,v105
 v_add_f32 v12,v12,v106
 v_mfma_f32_16x16x32_bf16 a[40:43],v[56:59],v[144:147],a[40:43]
 v_cvt_pk_bf16_f32 v177,v106,v107
 v_add_f32 v12,v12,v107
 v_mfma_f32_16x16x32_bf16 a[40:43],v[60:63],v[148:151],a[40:43]
 v_mfma_f32_16x16x32_bf16 a[44:47],v[60:63],v[156:159],a[44:47]
 v_exp_f32 v108,v108
 v_mfma_f32_16x16x32_bf16 a[44:47],v[56:59],v[152:155],a[44:47]
 s_waitcnt lgkmcnt(0)
 v_mfma_f32_16x16x32_bf16 v[96:99],v[16:19],a[192:195],v[112:115]
 v_exp_f32 v109,v109
 v_mfma_f32_16x16x32_bf16 v[96:99],v[20:23],a[208:211],v[96:99]
 v_exp_f32 v110,v110
 v_mfma_f32_16x16x32_bf16 v[96:99],v[24:27],a[224:227],v[96:99]
 ds_read_b64_tr_b16 v[40:41],v9
 ds_read_b64_tr_b16 v[42:43],v9 offset:6144
 v_mfma_f32_16x16x32_bf16 v[96:99],v[28:31],a[240:243],v[96:99]
 v_add_f32 v13,v13,v108
 v_cvt_pk_bf16_f32 v184,v108,v109
 v_mfma_f32_16x16x32_bf16 v[96:99],v[32:35],v[64:67],v[96:99]
 ds_read_b64_tr_b16 v[44:45],v9 offset:12288
 ds_read_b64_tr_b16 v[46:47],v9 offset:18432
 v_mfma_f32_16x16x32_bf16 v[96:99],v[36:39],v[80:83],v[96:99]
 v_exp_f32 v111,v111
 v_mfma_f32_16x16x32_bf16 v[100:103],v[36:39],v[84:87],v[116:119]
 ds_read_b64_tr_b16 v[48:49],v6 offset:128
 ds_read_b64_tr_b16 v[50:51],v6 offset:6272
 v_mfma_f32_16x16x32_bf16 v[100:103],v[32:35],v[68:71],v[100:103]
 v_add_f32 v13,v13,v109
 v_add_f32 v13,v13,v110
 v_mfma_f32_16x16x32_bf16 v[100:103],v[28:31],a[244:247],v[100:103]
 v_cvt_pk_bf16_f32 v185,v110,v111
 v_add_f32 v13,v13,v111
 v_mfma_f32_16x16x32_bf16 v[100:103],v[24:27],a[228:231],v[100:103]
 ds_read_b64_tr_b16 v[52:53],v6 offset:12416
 ds_read_b64_tr_b16 v[54:55],v6 offset:18560
 v_mfma_f32_16x16x32_bf16 v[100:103],v[20:23],a[212:215],v[100:103]
 v_exp_f32 v96,v96
 v_mfma_f32_16x16x32_bf16 v[100:103],v[16:19],a[196:199],v[100:103]
 ds_read_b64_tr_b16 v[56:57],v7 offset:128
 ds_read_b64_tr_b16 v[58:59],v7 offset:6272
 v_mfma_f32_16x16x32_bf16 v[104:107],v[16:19],a[200:203],v[120:123]
 v_exp_f32 v97,v97
 v_mfma_f32_16x16x32_bf16 v[104:107],v[20:23],a[216:219],v[104:107]
 v_exp_f32 v98,v98
 v_mfma_f32_16x16x32_bf16 v[104:107],v[24:27],a[232:235],v[104:107]
 ds_read_b64_tr_b16 v[60:61],v7 offset:12416
 ds_read_b64_tr_b16 v[62:63],v7 offset:18560
 v_mfma_f32_16x16x32_bf16 v[104:107],v[28:31],a[248:251],v[104:107]
 v_add_f32 v10,v10,v96
 v_cvt_pk_bf16_f32 v162,v96,v97
 v_mfma_f32_16x16x32_bf16 v[104:107],v[32:35],v[72:75],v[104:107]
 v_mfma_f32_16x16x32_bf16 v[104:107],v[36:39],v[88:91],v[104:107]
 v_exp_f32 v99,v99
 v_mfma_f32_16x16x32_bf16 v[108:111],v[36:39],v[92:95],v[124:127]
 v_mfma_f32_16x16x32_bf16 v[108:111],v[32:35],v[76:79],v[108:111]
 v_add_f32 v10,v10,v97
 v_add_f32 v10,v10,v98
 v_mfma_f32_16x16x32_bf16 v[108:111],v[28:31],a[252:255],v[108:111]
 v_cvt_pk_bf16_f32 v163,v98,v99
 v_add_f32 v10,v10,v99
 v_mfma_f32_16x16x32_bf16 v[108:111],v[24:27],a[236:239],v[108:111]
 v_mfma_f32_16x16x32_bf16 v[108:111],v[20:23],a[220:223],v[108:111]
 v_exp_f32 v100,v100
 v_mfma_f32_16x16x32_bf16 v[108:111],v[16:19],a[204:207],v[108:111]
 s_waitcnt lgkmcnt(0)
 v_mfma_f32_16x16x32_bf16 a[48:51],v[40:43],v[128:131],a[48:51]
 v_exp_f32 v101,v101
 v_mfma_f32_16x16x32_bf16 a[48:51],v[44:47],v[132:135],a[48:51]
 v_exp_f32 v102,v102
 v_mfma_f32_16x16x32_bf16 a[52:55],v[44:47],v[140:143],a[52:55]
 ds_read_b128 v[16:19],v4 offset:12288
 ds_read_b128 v[20:23],v5 offset:12288
 v_mfma_f32_16x16x32_bf16 a[52:55],v[40:43],v[136:139],a[52:55]
 v_add_f32 v11,v11,v100
 v_cvt_pk_bf16_f32 v170,v100,v101
 v_mfma_f32_16x16x32_bf16 a[56:59],v[40:43],v[144:147],a[56:59]
 ds_read_b128 v[24:27],v4 offset:12416
 ds_read_b128 v[28:31],v5 offset:12416
 v_mfma_f32_16x16x32_bf16 a[56:59],v[44:47],v[148:151],a[56:59]
 v_exp_f32 v103,v103
 v_mfma_f32_16x16x32_bf16 a[60:63],v[44:47],v[156:159],a[60:63]
 ds_read_b128 v[32:35],v4 offset:12544
 ds_read_b128 v[36:39],v5 offset:12544
 v_mfma_f32_16x16x32_bf16 a[60:63],v[40:43],v[152:155],a[60:63]
 v_add_f32 v11,v11,v101
 v_add_f32 v11,v11,v102
 v_mfma_f32_16x16x32_bf16 a[64:67],v[48:51],v[128:131],a[64:67]
 s_add_u32 m0,s37,s35
 v_cvt_pk_bf16_f32 v171,v102,v103
 v_add_f32 v11,v11,v103
 v_mfma_f32_16x16x32_bf16 a[64:67],v[52:55],v[132:135],a[64:67]
 buffer_load_dwordx4 v248,s[16:19],s40 offen lds
 v_mfma_f32_16x16x32_bf16 a[68:71],v[52:55],v[140:143],a[68:71]
 v_exp_f32 v104,v104
 v_mfma_f32_16x16x32_bf16 a[68:71],v[48:51],v[136:139],a[68:71]
 buffer_load_dwordx4 v249,s[16:19],s40 offen offset:1024 lds
 v_mfma_f32_16x16x32_bf16 a[72:75],v[48:51],v[144:147],a[72:75]
 v_exp_f32 v105,v105
 v_mfma_f32_16x16x32_bf16 a[72:75],v[52:55],v[148:151],a[72:75]
 v_exp_f32 v106,v106
 v_mfma_f32_16x16x32_bf16 a[76:79],v[52:55],v[156:159],a[76:79]
 buffer_load_dwordx4 v250,s[16:19],s40 offen offset:2048 lds
 v_mfma_f32_16x16x32_bf16 a[76:79],v[48:51],v[152:155],a[76:79]
 v_add_f32 v12,v12,v104
 v_cvt_pk_bf16_f32 v178,v104,v105
 v_mfma_f32_16x16x32_bf16 a[80:83],v[56:59],v[128:131],a[80:83]
 v_mfma_f32_16x16x32_bf16 a[80:83],v[60:63],v[132:135],a[80:83]
 v_exp_f32 v107,v107
 v_mfma_f32_16x16x32_bf16 a[84:87],v[60:63],v[140:143],a[84:87]
 v_mfma_f32_16x16x32_bf16 a[84:87],v[56:59],v[136:139],a[84:87]
 v_add_f32 v12,v12,v105
 v_add_f32 v12,v12,v106
 v_mfma_f32_16x16x32_bf16 a[88:91],v[56:59],v[144:147],a[88:91]
 v_cvt_pk_bf16_f32 v179,v106,v107
 v_add_f32 v12,v12,v107
 v_mfma_f32_16x16x32_bf16 a[88:91],v[60:63],v[148:151],a[88:91]
 v_mfma_f32_16x16x32_bf16 a[92:95],v[60:63],v[156:159],a[92:95]
 v_exp_f32 v108,v108
 v_mfma_f32_16x16x32_bf16 a[92:95],v[56:59],v[152:155],a[92:95]
 s_waitcnt lgkmcnt(0)
 v_mfma_f32_16x16x32_bf16 v[96:99],v[16:19],a[192:195],v[112:115]
 v_exp_f32 v109,v109
 v_mfma_f32_16x16x32_bf16 v[96:99],v[20:23],a[208:211],v[96:99]
 s_cmp_eq_u32 s39,761856
 v_exp_f32 v110,v110
 v_mfma_f32_16x16x32_bf16 v[96:99],v[24:27],a[224:227],v[96:99]
 s_cselect_b64 vcc,-1,0
 ds_read_b64_tr_b16 v[40:41],v8 offset:128
 ds_read_b64_tr_b16 v[42:43],v8 offset:6272
 v_mfma_f32_16x16x32_bf16 v[96:99],v[28:31],a[240:243],v[96:99]
 s_cselect_b32 s12,s56,s12
 v_add_f32 v13,v13,v108
 v_cvt_pk_bf16_f32 v186,v108,v109
 v_mfma_f32_16x16x32_bf16 v[96:99],v[32:35],v[64:67],v[96:99]
 s_cselect_b32 s13,s57,s13
 ds_read_b64_tr_b16 v[44:45],v8 offset:12416
 ds_read_b64_tr_b16 v[46:47],v8 offset:18560
 v_mfma_f32_16x16x32_bf16 v[96:99],v[36:39],v[80:83],v[96:99]
 s_cselect_b32 s14,s58,s14
 v_exp_f32 v111,v111
 v_mfma_f32_16x16x32_bf16 v[100:103],v[36:39],v[84:87],v[116:119]
 s_cselect_b32 s66,10240,s66
 ds_read_b64_tr_b16 v[48:49],v9 offset:128
 ds_read_b64_tr_b16 v[50:51],v9 offset:6272
 v_mfma_f32_16x16x32_bf16 v[100:103],v[32:35],v[68:71],v[100:103]
 s_cselect_b32 s67,81920,s67
 v_add_f32 v13,v13,v109
 v_add_f32 v13,v13,v110
 v_mfma_f32_16x16x32_bf16 v[100:103],v[28:31],a[244:247],v[100:103]
 s_cselect_b32 s39,s70,s39
 v_cvt_pk_bf16_f32 v187,v110,v111
 v_add_f32 v13,v13,v111
 v_mfma_f32_16x16x32_bf16 v[100:103],v[24:27],a[228:231],v[100:103]
 ds_read_b64_tr_b16 v[52:53],v9 offset:12416
 ds_read_b64_tr_b16 v[54:55],v9 offset:18560
 v_mfma_f32_16x16x32_bf16 v[100:103],v[20:23],a[212:215],v[100:103]
 v_exp_f32 v96,v96
 v_mfma_f32_16x16x32_bf16 v[100:103],v[16:19],a[196:199],v[100:103]
 ds_read_b64_tr_b16 v[56:57],v6 offset:256
 ds_read_b64_tr_b16 v[58:59],v6 offset:6400
 v_mfma_f32_16x16x32_bf16 v[104:107],v[16:19],a[200:203],v[120:123]
 v_exp_f32 v97,v97
 v_mfma_f32_16x16x32_bf16 v[104:107],v[20:23],a[216:219],v[104:107]
 v_exp_f32 v98,v98
 v_mfma_f32_16x16x32_bf16 v[104:107],v[24:27],a[232:235],v[104:107]
 ds_read_b64_tr_b16 v[60:61],v6 offset:12544
 ds_read_b64_tr_b16 v[62:63],v6 offset:18688
 v_mfma_f32_16x16x32_bf16 v[104:107],v[28:31],a[248:251],v[104:107]
 v_add_f32 v10,v10,v96
 v_cvt_pk_bf16_f32 v164,v96,v97
 v_mfma_f32_16x16x32_bf16 v[104:107],v[32:35],v[72:75],v[104:107]
 v_cndmask_b32 v1,v1,v243,vcc
 v_cndmask_b32 v2,v2,v244,vcc
 v_mfma_f32_16x16x32_bf16 v[104:107],v[36:39],v[88:91],v[104:107]
 v_exp_f32 v99,v99
 v_mfma_f32_16x16x32_bf16 v[108:111],v[36:39],v[92:95],v[124:127]
 v_cndmask_b32 v3,v3,v245,vcc
 v_mfma_f32_16x16x32_bf16 v[108:111],v[32:35],v[76:79],v[108:111]
 v_add_f32 v10,v10,v97
 v_add_f32 v10,v10,v98
 v_mfma_f32_16x16x32_bf16 v[108:111],v[28:31],a[252:255],v[108:111]
 v_cvt_pk_bf16_f32 v165,v98,v99
 v_add_f32 v10,v10,v99
 v_mfma_f32_16x16x32_bf16 v[108:111],v[24:27],a[236:239],v[108:111]
 v_mfma_f32_16x16x32_bf16 v[108:111],v[20:23],a[220:223],v[108:111]
 v_exp_f32 v100,v100
 v_mfma_f32_16x16x32_bf16 v[108:111],v[16:19],a[204:207],v[108:111]
 s_waitcnt lgkmcnt(0)
 v_mfma_f32_16x16x32_bf16 a[96:99],v[40:43],v[128:131],a[96:99]
 v_exp_f32 v101,v101
 v_mfma_f32_16x16x32_bf16 a[96:99],v[44:47],v[132:135],a[96:99]
 v_exp_f32 v102,v102
 v_mfma_f32_16x16x32_bf16 a[100:103],v[44:47],v[140:143],a[100:103]
 ds_read_b128 v[16:19],v4 offset:18432
 ds_read_b128 v[20:23],v5 offset:18432
 v_mfma_f32_16x16x32_bf16 a[100:103],v[40:43],v[136:139],a[100:103]
 v_add_f32 v11,v11,v100
 v_cvt_pk_bf16_f32 v172,v100,v101
 v_mfma_f32_16x16x32_bf16 a[104:107],v[40:43],v[144:147],a[104:107]
 ds_read_b128 v[24:27],v4 offset:18560
 ds_read_b128 v[28:31],v5 offset:18560
 v_mfma_f32_16x16x32_bf16 a[104:107],v[44:47],v[148:151],a[104:107]
 v_exp_f32 v103,v103
 v_mfma_f32_16x16x32_bf16 a[108:111],v[44:47],v[156:159],a[108:111]
 s_add_u32 s44,s40,s68
 ds_read_b128 v[32:35],v4 offset:18688
 ds_read_b128 v[36:39],v5 offset:18688
 v_mfma_f32_16x16x32_bf16 a[108:111],v[40:43],v[152:155],a[108:111]
 s_add_u32 s42,s37,s35
 v_add_f32 v11,v11,v101
 v_add_f32 v11,v11,v102
 v_mfma_f32_16x16x32_bf16 a[112:115],v[48:51],v[128:131],a[112:115]
 s_add_u32 m0,s42,3072
 v_cvt_pk_bf16_f32 v173,v102,v103
 v_add_f32 v11,v11,v103
 v_mfma_f32_16x16x32_bf16 a[112:115],v[52:55],v[132:135],a[112:115]
 buffer_load_dwordx4 v248,s[16:19],s44 offen lds
 v_mfma_f32_16x16x32_bf16 a[116:119],v[52:55],v[140:143],a[116:119]
 v_exp_f32 v104,v104
 v_mfma_f32_16x16x32_bf16 a[116:119],v[48:51],v[136:139],a[116:119]
 buffer_load_dwordx4 v249,s[16:19],s44 offen offset:1024 lds
 v_mfma_f32_16x16x32_bf16 a[120:123],v[48:51],v[144:147],a[120:123]
 v_exp_f32 v105,v105
 v_mfma_f32_16x16x32_bf16 a[120:123],v[52:55],v[148:151],a[120:123]
 v_exp_f32 v106,v106
 v_mfma_f32_16x16x32_bf16 a[124:127],v[52:55],v[156:159],a[124:127]
 buffer_load_dwordx4 v250,s[16:19],s44 offen offset:2048 lds
 v_mfma_f32_16x16x32_bf16 a[124:127],v[48:51],v[152:155],a[124:127]
 v_add_f32 v12,v12,v104
 v_cvt_pk_bf16_f32 v180,v104,v105
 v_mfma_f32_16x16x32_bf16 a[128:131],v[56:59],v[128:131],a[128:131]
 v_mfma_f32_16x16x32_bf16 a[128:131],v[60:63],v[132:135],a[128:131]
 v_exp_f32 v107,v107
 v_mfma_f32_16x16x32_bf16 a[132:135],v[60:63],v[140:143],a[132:135]
 v_mfma_f32_16x16x32_bf16 a[132:135],v[56:59],v[136:139],a[132:135]
 v_add_f32 v12,v12,v105
 v_add_f32 v12,v12,v106
 v_mfma_f32_16x16x32_bf16 a[136:139],v[56:59],v[144:147],a[136:139]
 v_cvt_pk_bf16_f32 v181,v106,v107
 v_add_f32 v12,v12,v107
 v_mfma_f32_16x16x32_bf16 a[136:139],v[60:63],v[148:151],a[136:139]
 v_mfma_f32_16x16x32_bf16 a[140:143],v[60:63],v[156:159],a[140:143]
 v_exp_f32 v108,v108
 v_mfma_f32_16x16x32_bf16 a[140:143],v[56:59],v[152:155],a[140:143]
 s_waitcnt lgkmcnt(0)
 v_mfma_f32_16x16x32_bf16 v[96:99],v[16:19],a[192:195],v[112:115]
 v_exp_f32 v109,v109
 v_mfma_f32_16x16x32_bf16 v[96:99],v[20:23],a[208:211],v[96:99]
 v_exp_f32 v110,v110
 v_mfma_f32_16x16x32_bf16 v[96:99],v[24:27],a[224:227],v[96:99]
 ds_read_b64_tr_b16 v[40:41],v7 offset:256
 ds_read_b64_tr_b16 v[42:43],v7 offset:6400
 v_mfma_f32_16x16x32_bf16 v[96:99],v[28:31],a[240:243],v[96:99]
 v_add_f32 v13,v13,v108
 v_cvt_pk_bf16_f32 v188,v108,v109
 v_mfma_f32_16x16x32_bf16 v[96:99],v[32:35],v[64:67],v[96:99]
 ds_read_b64_tr_b16 v[44:45],v7 offset:12544
 ds_read_b64_tr_b16 v[46:47],v7 offset:18688
 v_mfma_f32_16x16x32_bf16 v[96:99],v[36:39],v[80:83],v[96:99]
 v_exp_f32 v111,v111
 v_mfma_f32_16x16x32_bf16 v[100:103],v[36:39],v[84:87],v[116:119]
 ds_read_b64_tr_b16 v[48:49],v8 offset:256
 ds_read_b64_tr_b16 v[50:51],v8 offset:6400
 v_mfma_f32_16x16x32_bf16 v[100:103],v[32:35],v[68:71],v[100:103]
 v_add_f32 v13,v13,v109
 v_add_f32 v13,v13,v110
 v_mfma_f32_16x16x32_bf16 v[100:103],v[28:31],a[244:247],v[100:103]
 v_cvt_pk_bf16_f32 v189,v110,v111
 v_add_f32 v13,v13,v111
 v_mfma_f32_16x16x32_bf16 v[100:103],v[24:27],a[228:231],v[100:103]
 ds_read_b64_tr_b16 v[52:53],v8 offset:12544
 ds_read_b64_tr_b16 v[54:55],v8 offset:18688
 v_mfma_f32_16x16x32_bf16 v[100:103],v[20:23],a[212:215],v[100:103]
 v_exp_f32 v96,v96
 v_mfma_f32_16x16x32_bf16 v[100:103],v[16:19],a[196:199],v[100:103]
 ds_read_b64_tr_b16 v[56:57],v9 offset:256
 ds_read_b64_tr_b16 v[58:59],v9 offset:6400
 v_mfma_f32_16x16x32_bf16 v[104:107],v[16:19],a[200:203],v[120:123]
 v_exp_f32 v97,v97
 v_mfma_f32_16x16x32_bf16 v[104:107],v[20:23],a[216:219],v[104:107]
 v_exp_f32 v98,v98
 v_mfma_f32_16x16x32_bf16 v[104:107],v[24:27],a[232:235],v[104:107]
 ds_read_b64_tr_b16 v[60:61],v9 offset:12544
 ds_read_b64_tr_b16 v[62:63],v9 offset:18688
 v_mfma_f32_16x16x32_bf16 v[104:107],v[28:31],a[248:251],v[104:107]
 v_add_f32 v10,v10,v96
 v_cvt_pk_bf16_f32 v166,v96,v97
 v_mfma_f32_16x16x32_bf16 v[104:107],v[32:35],v[72:75],v[104:107]
 s_sub_u32 s50,s38,s37
 v_add_u32 v4,s50,v4
 v_add_u32 v5,s50,v5
 v_mfma_f32_16x16x32_bf16 v[104:107],v[36:39],v[88:91],v[104:107]
 v_exp_f32 v99,v99
 v_mfma_f32_16x16x32_bf16 v[108:111],v[36:39],v[92:95],v[124:127]
 v_mfma_f32_16x16x32_bf16 v[108:111],v[32:35],v[76:79],v[108:111]
 v_add_f32 v10,v10,v97
 v_add_f32 v10,v10,v98
 v_mfma_f32_16x16x32_bf16 v[108:111],v[28:31],a[252:255],v[108:111]
 v_cvt_pk_bf16_f32 v167,v98,v99
 v_add_f32 v10,v10,v99
 v_mfma_f32_16x16x32_bf16 v[108:111],v[24:27],a[236:239],v[108:111]
 v_mfma_f32_16x16x32_bf16 v[108:111],v[20:23],a[220:223],v[108:111]
 v_exp_f32 v100,v100
 v_mfma_f32_16x16x32_bf16 v[108:111],v[16:19],a[204:207],v[108:111]
 s_waitcnt vmcnt(13) lgkmcnt(0)
 s_barrier
 v_mfma_f32_16x16x32_bf16 a[144:147],v[40:43],v[128:131],a[144:147]
 s_mov_b32 s41,s36
 v_exp_f32 v101,v101
 v_mfma_f32_16x16x32_bf16 a[144:147],v[44:47],v[132:135],a[144:147]
 s_mov_b32 s36,s37
 v_exp_f32 v102,v102
 v_mfma_f32_16x16x32_bf16 a[148:151],v[44:47],v[140:143],a[148:151]
 s_mov_b32 s37,s38
 ds_read_b128 v[16:19],v4
 ds_read_b128 v[20:23],v5
 v_mfma_f32_16x16x32_bf16 a[148:151],v[40:43],v[136:139],a[148:151]
 s_mov_b32 s38,s41
 v_add_f32 v11,v11,v100
 v_cvt_pk_bf16_f32 v174,v100,v101
 v_mfma_f32_16x16x32_bf16 a[152:155],v[40:43],v[144:147],a[152:155]
 s_add_u32 s39,s39,s67
 ds_read_b128 v[24:27],v4 offset:128
 ds_read_b128 v[28:31],v5 offset:128
 v_mfma_f32_16x16x32_bf16 a[152:155],v[44:47],v[148:151],a[152:155]
 s_add_u32 s40,s40,s69
 v_exp_f32 v103,v103
 v_mfma_f32_16x16x32_bf16 a[156:159],v[44:47],v[156:159],a[156:159]
 ds_read_b128 v[32:35],v4 offset:256
 ds_read_b128 v[36:39],v5 offset:256
 v_mfma_f32_16x16x32_bf16 a[156:159],v[40:43],v[152:155],a[156:159]
 s_add_u32 s42,s36,s35
 v_add_f32 v11,v11,v101
 v_add_f32 v11,v11,v102
 v_mfma_f32_16x16x32_bf16 a[160:163],v[48:51],v[128:131],a[160:163]
 s_add_u32 m0,s42,24576
 v_cvt_pk_bf16_f32 v175,v102,v103
 v_add_f32 v11,v11,v103
 v_mfma_f32_16x16x32_bf16 a[160:163],v[52:55],v[132:135],a[160:163]
 buffer_load_dwordx4 v1,s[12:15],s39 offen lds
 v_mfma_f32_16x16x32_bf16 a[164:167],v[52:55],v[140:143],a[164:167]
 v_exp_f32 v104,v104
 v_mfma_f32_16x16x32_bf16 a[164:167],v[48:51],v[136:139],a[164:167]
 buffer_load_dwordx4 v2,s[12:15],s39 offen offset:1024 lds
 v_mfma_f32_16x16x32_bf16 a[168:171],v[48:51],v[144:147],a[168:171]
 v_exp_f32 v105,v105
 v_mfma_f32_16x16x32_bf16 a[168:171],v[52:55],v[148:151],a[168:171]
 v_exp_f32 v106,v106
 v_mfma_f32_16x16x32_bf16 a[172:175],v[52:55],v[156:159],a[172:175]
 buffer_load_dwordx4 v3,s[12:15],s39 offen offset:2048 lds
 v_mfma_f32_16x16x32_bf16 a[172:175],v[48:51],v[152:155],a[172:175]
 s_sub_u32 s50,s38,s37
 v_add_f32 v12,v12,v104
 v_cvt_pk_bf16_f32 v182,v104,v105
 v_mfma_f32_16x16x32_bf16 a[176:179],v[56:59],v[128:131],a[176:179]
 v_add_u32 v6,s50,v6
 v_add_u32 v7,s50,v7
 v_mfma_f32_16x16x32_bf16 a[176:179],v[60:63],v[132:135],a[176:179]
 v_exp_f32 v107,v107
 v_mfma_f32_16x16x32_bf16 a[180:183],v[60:63],v[140:143],a[180:183]
 v_add_u32 v8,s50,v8
 v_add_u32 v9,s50,v9
 v_mfma_f32_16x16x32_bf16 a[180:183],v[56:59],v[136:139],a[180:183]
 v_add_f32 v12,v12,v105
 v_add_f32 v12,v12,v106
 v_mfma_f32_16x16x32_bf16 a[184:187],v[56:59],v[144:147],a[184:187]
 v_cvt_pk_bf16_f32 v183,v106,v107
 v_add_f32 v12,v12,v107
 v_mfma_f32_16x16x32_bf16 a[184:187],v[60:63],v[148:151],a[184:187]
 v_mfma_f32_16x16x32_bf16 a[188:191],v[60:63],v[156:159],a[188:191]
 s_cmp_eq_u32 s43,15
 v_exp_f32 v108,v108
 v_mfma_f32_16x16x32_bf16 a[188:191],v[56:59],v[152:155],a[188:191]
 s_waitcnt lgkmcnt(0)
 s_cbranch_scc1 recurrent_scan__mha_block_cached__mixer_s_mlp__prompt_kernel_last
 v_mfma_f32_16x16x32_bf16 v[96:99],v[16:19],a[192:195],v[112:115]
 v_exp_f32 v109,v109
 v_mfma_f32_16x16x32_bf16 v[96:99],v[20:23],a[208:211],v[96:99]
 v_exp_f32 v110,v110
 v_mfma_f32_16x16x32_bf16 v[96:99],v[24:27],a[224:227],v[96:99]
 ds_read_b64_tr_b16 v[40:41],v6
 ds_read_b64_tr_b16 v[42:43],v6 offset:6144
 v_mfma_f32_16x16x32_bf16 v[96:99],v[28:31],a[240:243],v[96:99]
 v_add_f32 v13,v13,v108
 v_cvt_pk_bf16_f32 v190,v108,v109
 v_mfma_f32_16x16x32_bf16 v[96:99],v[32:35],v[64:67],v[96:99]
 ds_read_b64_tr_b16 v[44:45],v6 offset:12288
 ds_read_b64_tr_b16 v[46:47],v6 offset:18432
 v_mfma_f32_16x16x32_bf16 v[96:99],v[36:39],v[80:83],v[96:99]
 v_exp_f32 v111,v111
 v_mfma_f32_16x16x32_bf16 v[100:103],v[36:39],v[84:87],v[116:119]
 ds_read_b64_tr_b16 v[48:49],v7
 ds_read_b64_tr_b16 v[50:51],v7 offset:6144
 v_mfma_f32_16x16x32_bf16 v[100:103],v[32:35],v[68:71],v[100:103]
 v_add_f32 v13,v13,v109
 v_add_f32 v13,v13,v110
 v_mfma_f32_16x16x32_bf16 v[100:103],v[28:31],a[244:247],v[100:103]
 v_cvt_pk_bf16_f32 v191,v110,v111
 v_add_f32 v13,v13,v111
 v_mfma_f32_16x16x32_bf16 v[100:103],v[24:27],a[228:231],v[100:103]
 ds_read_b64_tr_b16 v[52:53],v7 offset:12288
 ds_read_b64_tr_b16 v[54:55],v7 offset:18432
 v_mfma_f32_16x16x32_bf16 v[100:103],v[20:23],a[212:215],v[100:103]
 v_exp_f32 v96,v96
 v_mfma_f32_16x16x32_bf16 v[100:103],v[16:19],a[196:199],v[100:103]
 ds_read_b64_tr_b16 v[56:57],v8
 ds_read_b64_tr_b16 v[58:59],v8 offset:6144
 v_mfma_f32_16x16x32_bf16 v[104:107],v[16:19],a[200:203],v[120:123]
 v_exp_f32 v97,v97
 v_mfma_f32_16x16x32_bf16 v[104:107],v[20:23],a[216:219],v[104:107]
 v_exp_f32 v98,v98
 v_mfma_f32_16x16x32_bf16 v[104:107],v[24:27],a[232:235],v[104:107]
 ds_read_b64_tr_b16 v[60:61],v8 offset:12288
 ds_read_b64_tr_b16 v[62:63],v8 offset:18432
 v_mfma_f32_16x16x32_bf16 v[104:107],v[28:31],a[248:251],v[104:107]
 v_add_f32 v10,v10,v96
 v_cvt_pk_bf16_f32 v128,v96,v97
 v_mfma_f32_16x16x32_bf16 v[104:107],v[32:35],v[72:75],v[104:107]
 global_load_dword v255,v[236:237],off
 v_mfma_f32_16x16x32_bf16 v[104:107],v[36:39],v[88:91],v[104:107]
 v_exp_f32 v99,v99
 v_mfma_f32_16x16x32_bf16 v[108:111],v[36:39],v[92:95],v[124:127]
 v_lshl_add_u64 v[236:237],v[238:239],0,v[236:237]
 v_mfma_f32_16x16x32_bf16 v[108:111],v[32:35],v[76:79],v[108:111]
 v_add_f32 v10,v10,v97
 v_add_f32 v10,v10,v98
 v_mfma_f32_16x16x32_bf16 v[108:111],v[28:31],a[252:255],v[108:111]
 v_cvt_pk_bf16_f32 v129,v98,v99
 v_add_f32 v10,v10,v99
 v_mfma_f32_16x16x32_bf16 v[108:111],v[24:27],a[236:239],v[108:111]
 v_mfma_f32_16x16x32_bf16 v[108:111],v[20:23],a[220:223],v[108:111]
 v_exp_f32 v100,v100
 v_mfma_f32_16x16x32_bf16 v[108:111],v[16:19],a[204:207],v[108:111]
 s_waitcnt lgkmcnt(0)
 v_mfma_f32_16x16x32_bf16 a[0:3],v[40:43],v[160:163],a[0:3]
 v_exp_f32 v101,v101
 v_mfma_f32_16x16x32_bf16 a[0:3],v[44:47],v[164:167],a[0:3]
 v_exp_f32 v102,v102
 v_mfma_f32_16x16x32_bf16 a[4:7],v[44:47],v[172:175],a[4:7]
 ds_read_b128 v[16:19],v4 offset:6144
 ds_read_b128 v[20:23],v5 offset:6144
 v_mfma_f32_16x16x32_bf16 a[4:7],v[40:43],v[168:171],a[4:7]
 v_add_f32 v11,v11,v100
 v_cvt_pk_bf16_f32 v136,v100,v101
 v_mfma_f32_16x16x32_bf16 a[8:11],v[40:43],v[176:179],a[8:11]
 ds_read_b128 v[24:27],v4 offset:6272
 ds_read_b128 v[28:31],v5 offset:6272
 v_mfma_f32_16x16x32_bf16 a[8:11],v[44:47],v[180:183],a[8:11]
 v_exp_f32 v103,v103
 v_mfma_f32_16x16x32_bf16 a[12:15],v[44:47],v[188:191],a[12:15]
 s_add_u32 s44,s39,s66
 ds_read_b128 v[32:35],v4 offset:6400
 ds_read_b128 v[36:39],v5 offset:6400
 v_mfma_f32_16x16x32_bf16 a[12:15],v[40:43],v[184:187],a[12:15]
 s_add_u32 s42,s36,s35
 v_add_f32 v11,v11,v101
 v_add_f32 v11,v11,v102
 v_mfma_f32_16x16x32_bf16 a[16:19],v[48:51],v[160:163],a[16:19]
 s_add_u32 m0,s42,27648
 v_cvt_pk_bf16_f32 v137,v102,v103
 v_add_f32 v11,v11,v103
 v_mfma_f32_16x16x32_bf16 a[16:19],v[52:55],v[164:167],a[16:19]
 buffer_load_dwordx4 v1,s[12:15],s44 offen lds
 v_mfma_f32_16x16x32_bf16 a[20:23],v[52:55],v[172:175],a[20:23]
 v_exp_f32 v104,v104
 v_mfma_f32_16x16x32_bf16 a[20:23],v[48:51],v[168:171],a[20:23]
 buffer_load_dwordx4 v2,s[12:15],s44 offen offset:1024 lds
 v_mfma_f32_16x16x32_bf16 a[24:27],v[48:51],v[176:179],a[24:27]
 v_exp_f32 v105,v105
 v_mfma_f32_16x16x32_bf16 a[24:27],v[52:55],v[180:183],a[24:27]
 v_exp_f32 v106,v106
 v_mfma_f32_16x16x32_bf16 a[28:31],v[52:55],v[188:191],a[28:31]
 buffer_load_dwordx4 v3,s[12:15],s44 offen offset:2048 lds
 v_mfma_f32_16x16x32_bf16 a[28:31],v[48:51],v[184:187],a[28:31]
 v_add_f32 v12,v12,v104
 v_cvt_pk_bf16_f32 v144,v104,v105
 v_mfma_f32_16x16x32_bf16 a[32:35],v[56:59],v[160:163],a[32:35]
 v_mfma_f32_16x16x32_bf16 a[32:35],v[60:63],v[164:167],a[32:35]
 v_exp_f32 v107,v107
 v_mfma_f32_16x16x32_bf16 a[36:39],v[60:63],v[172:175],a[36:39]
 v_mfma_f32_16x16x32_bf16 a[36:39],v[56:59],v[168:171],a[36:39]
 v_add_f32 v12,v12,v105
 v_add_f32 v12,v12,v106
 v_mfma_f32_16x16x32_bf16 a[40:43],v[56:59],v[176:179],a[40:43]
 v_cvt_pk_bf16_f32 v145,v106,v107
 v_add_f32 v12,v12,v107
 v_mfma_f32_16x16x32_bf16 a[40:43],v[60:63],v[180:183],a[40:43]
 v_mfma_f32_16x16x32_bf16 a[44:47],v[60:63],v[188:191],a[44:47]
 v_exp_f32 v108,v108
 v_mfma_f32_16x16x32_bf16 a[44:47],v[56:59],v[184:187],a[44:47]
 s_waitcnt lgkmcnt(0)
 v_mfma_f32_16x16x32_bf16 v[96:99],v[16:19],a[192:195],v[112:115]
 v_exp_f32 v109,v109
 v_mfma_f32_16x16x32_bf16 v[96:99],v[20:23],a[208:211],v[96:99]
 v_exp_f32 v110,v110
 v_mfma_f32_16x16x32_bf16 v[96:99],v[24:27],a[224:227],v[96:99]
 ds_read_b64_tr_b16 v[40:41],v9
 ds_read_b64_tr_b16 v[42:43],v9 offset:6144
 v_mfma_f32_16x16x32_bf16 v[96:99],v[28:31],a[240:243],v[96:99]
 v_add_f32 v13,v13,v108
 v_cvt_pk_bf16_f32 v152,v108,v109
 v_mfma_f32_16x16x32_bf16 v[96:99],v[32:35],v[64:67],v[96:99]
 ds_read_b64_tr_b16 v[44:45],v9 offset:12288
 ds_read_b64_tr_b16 v[46:47],v9 offset:18432
 v_mfma_f32_16x16x32_bf16 v[96:99],v[36:39],v[80:83],v[96:99]
 v_exp_f32 v111,v111
 v_mfma_f32_16x16x32_bf16 v[100:103],v[36:39],v[84:87],v[116:119]
 ds_read_b64_tr_b16 v[48:49],v6 offset:128
 ds_read_b64_tr_b16 v[50:51],v6 offset:6272
 v_mfma_f32_16x16x32_bf16 v[100:103],v[32:35],v[68:71],v[100:103]
 v_add_f32 v13,v13,v109
 v_add_f32 v13,v13,v110
 v_mfma_f32_16x16x32_bf16 v[100:103],v[28:31],a[244:247],v[100:103]
 v_cvt_pk_bf16_f32 v153,v110,v111
 v_add_f32 v13,v13,v111
 v_mfma_f32_16x16x32_bf16 v[100:103],v[24:27],a[228:231],v[100:103]
 ds_read_b64_tr_b16 v[52:53],v6 offset:12416
 ds_read_b64_tr_b16 v[54:55],v6 offset:18560
 v_mfma_f32_16x16x32_bf16 v[100:103],v[20:23],a[212:215],v[100:103]
 v_exp_f32 v96,v96
 v_mfma_f32_16x16x32_bf16 v[100:103],v[16:19],a[196:199],v[100:103]
 ds_read_b64_tr_b16 v[56:57],v7 offset:128
 ds_read_b64_tr_b16 v[58:59],v7 offset:6272
 v_mfma_f32_16x16x32_bf16 v[104:107],v[16:19],a[200:203],v[120:123]
 v_exp_f32 v97,v97
 v_mfma_f32_16x16x32_bf16 v[104:107],v[20:23],a[216:219],v[104:107]
 v_exp_f32 v98,v98
 v_mfma_f32_16x16x32_bf16 v[104:107],v[24:27],a[232:235],v[104:107]
 ds_read_b64_tr_b16 v[60:61],v7 offset:12416
 ds_read_b64_tr_b16 v[62:63],v7 offset:18560
 v_mfma_f32_16x16x32_bf16 v[104:107],v[28:31],a[248:251],v[104:107]
 v_add_f32 v10,v10,v96
 v_cvt_pk_bf16_f32 v130,v96,v97
 v_mfma_f32_16x16x32_bf16 v[104:107],v[32:35],v[72:75],v[104:107]
 v_mfma_f32_16x16x32_bf16 v[104:107],v[36:39],v[88:91],v[104:107]
 v_exp_f32 v99,v99
 v_mfma_f32_16x16x32_bf16 v[108:111],v[36:39],v[92:95],v[124:127]
 v_mfma_f32_16x16x32_bf16 v[108:111],v[32:35],v[76:79],v[108:111]
 v_add_f32 v10,v10,v97
 v_add_f32 v10,v10,v98
 v_mfma_f32_16x16x32_bf16 v[108:111],v[28:31],a[252:255],v[108:111]
 v_cvt_pk_bf16_f32 v131,v98,v99
 v_add_f32 v10,v10,v99
 v_mfma_f32_16x16x32_bf16 v[108:111],v[24:27],a[236:239],v[108:111]
 v_mfma_f32_16x16x32_bf16 v[108:111],v[20:23],a[220:223],v[108:111]
 v_exp_f32 v100,v100
 v_mfma_f32_16x16x32_bf16 v[108:111],v[16:19],a[204:207],v[108:111]
 s_waitcnt lgkmcnt(0)
 v_mfma_f32_16x16x32_bf16 a[48:51],v[40:43],v[160:163],a[48:51]
 v_exp_f32 v101,v101
 v_mfma_f32_16x16x32_bf16 a[48:51],v[44:47],v[164:167],a[48:51]
 v_exp_f32 v102,v102
 v_mfma_f32_16x16x32_bf16 a[52:55],v[44:47],v[172:175],a[52:55]
 ds_read_b128 v[16:19],v4 offset:12288
 ds_read_b128 v[20:23],v5 offset:12288
 v_mfma_f32_16x16x32_bf16 a[52:55],v[40:43],v[168:171],a[52:55]
 v_add_f32 v11,v11,v100
 v_cvt_pk_bf16_f32 v138,v100,v101
 v_mfma_f32_16x16x32_bf16 a[56:59],v[40:43],v[176:179],a[56:59]
 ds_read_b128 v[24:27],v4 offset:12416
 ds_read_b128 v[28:31],v5 offset:12416
 v_mfma_f32_16x16x32_bf16 a[56:59],v[44:47],v[180:183],a[56:59]
 v_exp_f32 v103,v103
 v_mfma_f32_16x16x32_bf16 a[60:63],v[44:47],v[188:191],a[60:63]
 ds_read_b128 v[32:35],v4 offset:12544
 ds_read_b128 v[36:39],v5 offset:12544
 v_mfma_f32_16x16x32_bf16 a[60:63],v[40:43],v[184:187],a[60:63]
 v_add_f32 v11,v11,v101
 v_add_f32 v11,v11,v102
 v_mfma_f32_16x16x32_bf16 a[64:67],v[48:51],v[160:163],a[64:67]
 s_add_u32 m0,s37,s35
 v_cvt_pk_bf16_f32 v139,v102,v103
 v_add_f32 v11,v11,v103
 v_mfma_f32_16x16x32_bf16 a[64:67],v[52:55],v[164:167],a[64:67]
 buffer_load_dwordx4 v248,s[16:19],s40 offen lds
 v_mfma_f32_16x16x32_bf16 a[68:71],v[52:55],v[172:175],a[68:71]
 v_exp_f32 v104,v104
 v_mfma_f32_16x16x32_bf16 a[68:71],v[48:51],v[168:171],a[68:71]
 buffer_load_dwordx4 v249,s[16:19],s40 offen offset:1024 lds
 v_mfma_f32_16x16x32_bf16 a[72:75],v[48:51],v[176:179],a[72:75]
 v_exp_f32 v105,v105
 v_mfma_f32_16x16x32_bf16 a[72:75],v[52:55],v[180:183],a[72:75]
 v_exp_f32 v106,v106
 v_mfma_f32_16x16x32_bf16 a[76:79],v[52:55],v[188:191],a[76:79]
 buffer_load_dwordx4 v250,s[16:19],s40 offen offset:2048 lds
 v_mfma_f32_16x16x32_bf16 a[76:79],v[48:51],v[184:187],a[76:79]
 v_add_f32 v12,v12,v104
 v_cvt_pk_bf16_f32 v146,v104,v105
 v_mfma_f32_16x16x32_bf16 a[80:83],v[56:59],v[160:163],a[80:83]
 v_mfma_f32_16x16x32_bf16 a[80:83],v[60:63],v[164:167],a[80:83]
 v_exp_f32 v107,v107
 v_mfma_f32_16x16x32_bf16 a[84:87],v[60:63],v[172:175],a[84:87]
 v_mfma_f32_16x16x32_bf16 a[84:87],v[56:59],v[168:171],a[84:87]
 v_add_f32 v12,v12,v105
 v_add_f32 v12,v12,v106
 v_mfma_f32_16x16x32_bf16 a[88:91],v[56:59],v[176:179],a[88:91]
 v_cvt_pk_bf16_f32 v147,v106,v107
 v_add_f32 v12,v12,v107
 v_mfma_f32_16x16x32_bf16 a[88:91],v[60:63],v[180:183],a[88:91]
 v_mfma_f32_16x16x32_bf16 a[92:95],v[60:63],v[188:191],a[92:95]
 v_exp_f32 v108,v108
 v_mfma_f32_16x16x32_bf16 a[92:95],v[56:59],v[184:187],a[92:95]
 s_waitcnt lgkmcnt(0)
 v_mfma_f32_16x16x32_bf16 v[96:99],v[16:19],a[192:195],v[112:115]
 v_exp_f32 v109,v109
 v_mfma_f32_16x16x32_bf16 v[96:99],v[20:23],a[208:211],v[96:99]
 v_exp_f32 v110,v110
 v_mfma_f32_16x16x32_bf16 v[96:99],v[24:27],a[224:227],v[96:99]
 ds_read_b64_tr_b16 v[40:41],v8 offset:128
 ds_read_b64_tr_b16 v[42:43],v8 offset:6272
 v_mfma_f32_16x16x32_bf16 v[96:99],v[28:31],a[240:243],v[96:99]
 v_add_f32 v13,v13,v108
 v_cvt_pk_bf16_f32 v154,v108,v109
 v_mfma_f32_16x16x32_bf16 v[96:99],v[32:35],v[64:67],v[96:99]
 ds_read_b64_tr_b16 v[44:45],v8 offset:12416
 ds_read_b64_tr_b16 v[46:47],v8 offset:18560
 v_mfma_f32_16x16x32_bf16 v[96:99],v[36:39],v[80:83],v[96:99]
 v_exp_f32 v111,v111
 v_mfma_f32_16x16x32_bf16 v[100:103],v[36:39],v[84:87],v[116:119]
 ds_read_b64_tr_b16 v[48:49],v9 offset:128
 ds_read_b64_tr_b16 v[50:51],v9 offset:6272
 v_mfma_f32_16x16x32_bf16 v[100:103],v[32:35],v[68:71],v[100:103]
 v_add_f32 v13,v13,v109
 v_add_f32 v13,v13,v110
 v_mfma_f32_16x16x32_bf16 v[100:103],v[28:31],a[244:247],v[100:103]
 v_cvt_pk_bf16_f32 v155,v110,v111
 v_add_f32 v13,v13,v111
 v_mfma_f32_16x16x32_bf16 v[100:103],v[24:27],a[228:231],v[100:103]
 ds_read_b64_tr_b16 v[52:53],v9 offset:12416
 ds_read_b64_tr_b16 v[54:55],v9 offset:18560
 v_mfma_f32_16x16x32_bf16 v[100:103],v[20:23],a[212:215],v[100:103]
 v_exp_f32 v96,v96
 v_mfma_f32_16x16x32_bf16 v[100:103],v[16:19],a[196:199],v[100:103]
 ds_read_b64_tr_b16 v[56:57],v6 offset:256
 ds_read_b64_tr_b16 v[58:59],v6 offset:6400
 v_mfma_f32_16x16x32_bf16 v[104:107],v[16:19],a[200:203],v[120:123]
 v_exp_f32 v97,v97
 v_mfma_f32_16x16x32_bf16 v[104:107],v[20:23],a[216:219],v[104:107]
 v_exp_f32 v98,v98
 v_mfma_f32_16x16x32_bf16 v[104:107],v[24:27],a[232:235],v[104:107]
 ds_read_b64_tr_b16 v[60:61],v6 offset:12544
 ds_read_b64_tr_b16 v[62:63],v6 offset:18688
 v_mfma_f32_16x16x32_bf16 v[104:107],v[28:31],a[248:251],v[104:107]
 v_add_f32 v10,v10,v96
 v_cvt_pk_bf16_f32 v132,v96,v97
 v_mfma_f32_16x16x32_bf16 v[104:107],v[32:35],v[72:75],v[104:107]
 v_mfma_f32_16x16x32_bf16 v[104:107],v[36:39],v[88:91],v[104:107]
 v_exp_f32 v99,v99
 v_mfma_f32_16x16x32_bf16 v[108:111],v[36:39],v[92:95],v[124:127]
 v_mfma_f32_16x16x32_bf16 v[108:111],v[32:35],v[76:79],v[108:111]
 v_add_f32 v10,v10,v97
 v_add_f32 v10,v10,v98
 v_mfma_f32_16x16x32_bf16 v[108:111],v[28:31],a[252:255],v[108:111]
 v_cvt_pk_bf16_f32 v133,v98,v99
 v_add_f32 v10,v10,v99
 v_mfma_f32_16x16x32_bf16 v[108:111],v[24:27],a[236:239],v[108:111]
 v_mfma_f32_16x16x32_bf16 v[108:111],v[20:23],a[220:223],v[108:111]
 v_exp_f32 v100,v100
 v_mfma_f32_16x16x32_bf16 v[108:111],v[16:19],a[204:207],v[108:111]
 s_waitcnt lgkmcnt(0)
 v_mfma_f32_16x16x32_bf16 a[96:99],v[40:43],v[160:163],a[96:99]
 v_exp_f32 v101,v101
 v_mfma_f32_16x16x32_bf16 a[96:99],v[44:47],v[164:167],a[96:99]
 v_exp_f32 v102,v102
 v_mfma_f32_16x16x32_bf16 a[100:103],v[44:47],v[172:175],a[100:103]
 ds_read_b128 v[16:19],v4 offset:18432
 ds_read_b128 v[20:23],v5 offset:18432
 v_mfma_f32_16x16x32_bf16 a[100:103],v[40:43],v[168:171],a[100:103]
 v_add_f32 v11,v11,v100
 v_cvt_pk_bf16_f32 v140,v100,v101
 v_mfma_f32_16x16x32_bf16 a[104:107],v[40:43],v[176:179],a[104:107]
 ds_read_b128 v[24:27],v4 offset:18560
 ds_read_b128 v[28:31],v5 offset:18560
 v_mfma_f32_16x16x32_bf16 a[104:107],v[44:47],v[180:183],a[104:107]
 v_exp_f32 v103,v103
 v_mfma_f32_16x16x32_bf16 a[108:111],v[44:47],v[188:191],a[108:111]
 s_add_u32 s44,s40,s68
 ds_read_b128 v[32:35],v4 offset:18688
 ds_read_b128 v[36:39],v5 offset:18688
 v_mfma_f32_16x16x32_bf16 a[108:111],v[40:43],v[184:187],a[108:111]
 s_add_u32 s42,s37,s35
 v_add_f32 v11,v11,v101
 v_add_f32 v11,v11,v102
 v_mfma_f32_16x16x32_bf16 a[112:115],v[48:51],v[160:163],a[112:115]
 s_add_u32 m0,s42,3072
 v_cvt_pk_bf16_f32 v141,v102,v103
 v_add_f32 v11,v11,v103
 v_mfma_f32_16x16x32_bf16 a[112:115],v[52:55],v[164:167],a[112:115]
 buffer_load_dwordx4 v248,s[16:19],s44 offen lds
 v_mfma_f32_16x16x32_bf16 a[116:119],v[52:55],v[172:175],a[116:119]
 v_exp_f32 v104,v104
 v_mfma_f32_16x16x32_bf16 a[116:119],v[48:51],v[168:171],a[116:119]
 buffer_load_dwordx4 v249,s[16:19],s44 offen offset:1024 lds
 v_mfma_f32_16x16x32_bf16 a[120:123],v[48:51],v[176:179],a[120:123]
 v_exp_f32 v105,v105
 v_mfma_f32_16x16x32_bf16 a[120:123],v[52:55],v[180:183],a[120:123]
 v_exp_f32 v106,v106
 v_mfma_f32_16x16x32_bf16 a[124:127],v[52:55],v[188:191],a[124:127]
 buffer_load_dwordx4 v250,s[16:19],s44 offen offset:2048 lds
 v_mfma_f32_16x16x32_bf16 a[124:127],v[48:51],v[184:187],a[124:127]
 v_add_f32 v12,v12,v104
 v_cvt_pk_bf16_f32 v148,v104,v105
 v_mfma_f32_16x16x32_bf16 a[128:131],v[56:59],v[160:163],a[128:131]
 v_mfma_f32_16x16x32_bf16 a[128:131],v[60:63],v[164:167],a[128:131]
 v_exp_f32 v107,v107
 v_mfma_f32_16x16x32_bf16 a[132:135],v[60:63],v[172:175],a[132:135]
 v_mfma_f32_16x16x32_bf16 a[132:135],v[56:59],v[168:171],a[132:135]
 v_add_f32 v12,v12,v105
 v_add_f32 v12,v12,v106
 v_mfma_f32_16x16x32_bf16 a[136:139],v[56:59],v[176:179],a[136:139]
 v_cvt_pk_bf16_f32 v149,v106,v107
 v_add_f32 v12,v12,v107
 v_mfma_f32_16x16x32_bf16 a[136:139],v[60:63],v[180:183],a[136:139]
 v_mfma_f32_16x16x32_bf16 a[140:143],v[60:63],v[188:191],a[140:143]
 v_exp_f32 v108,v108
 v_mfma_f32_16x16x32_bf16 a[140:143],v[56:59],v[184:187],a[140:143]
 s_waitcnt lgkmcnt(0)
 v_mfma_f32_16x16x32_bf16 v[96:99],v[16:19],a[192:195],v[112:115]
 v_exp_f32 v109,v109
 v_mfma_f32_16x16x32_bf16 v[96:99],v[20:23],a[208:211],v[96:99]
 s_cmp_eq_u32 s40,761856
 v_exp_f32 v110,v110
 v_mfma_f32_16x16x32_bf16 v[96:99],v[24:27],a[224:227],v[96:99]
 s_cselect_b64 vcc,-1,0
 ds_read_b64_tr_b16 v[40:41],v7 offset:256
 ds_read_b64_tr_b16 v[42:43],v7 offset:6400
 v_mfma_f32_16x16x32_bf16 v[96:99],v[28:31],a[240:243],v[96:99]
 s_cselect_b32 s16,s59,s16
 v_add_f32 v13,v13,v108
 v_cvt_pk_bf16_f32 v156,v108,v109
 v_mfma_f32_16x16x32_bf16 v[96:99],v[32:35],v[64:67],v[96:99]
 s_cselect_b32 s17,s60,s17
 ds_read_b64_tr_b16 v[44:45],v7 offset:12544
 ds_read_b64_tr_b16 v[46:47],v7 offset:18688
 v_mfma_f32_16x16x32_bf16 v[96:99],v[36:39],v[80:83],v[96:99]
 s_cselect_b32 s18,s61,s18
 v_exp_f32 v111,v111
 v_mfma_f32_16x16x32_bf16 v[100:103],v[36:39],v[84:87],v[116:119]
 s_cselect_b32 s68,s76,s68
 ds_read_b64_tr_b16 v[48:49],v8 offset:256
 ds_read_b64_tr_b16 v[50:51],v8 offset:6400
 v_mfma_f32_16x16x32_bf16 v[100:103],v[32:35],v[68:71],v[100:103]
 s_cselect_b32 s69,s77,s69
 v_add_f32 v13,v13,v109
 v_add_f32 v13,v13,v110
 v_mfma_f32_16x16x32_bf16 v[100:103],v[28:31],a[244:247],v[100:103]
 s_cselect_b32 s40,s78,s40
 v_cvt_pk_bf16_f32 v157,v110,v111
 v_add_f32 v13,v13,v111
 v_mfma_f32_16x16x32_bf16 v[100:103],v[24:27],a[228:231],v[100:103]
 ds_read_b64_tr_b16 v[52:53],v8 offset:12544
 ds_read_b64_tr_b16 v[54:55],v8 offset:18688
 v_mfma_f32_16x16x32_bf16 v[100:103],v[20:23],a[212:215],v[100:103]
 v_exp_f32 v96,v96
 v_mfma_f32_16x16x32_bf16 v[100:103],v[16:19],a[196:199],v[100:103]
 ds_read_b64_tr_b16 v[56:57],v9 offset:256
 ds_read_b64_tr_b16 v[58:59],v9 offset:6400
 v_mfma_f32_16x16x32_bf16 v[104:107],v[16:19],a[200:203],v[120:123]
 v_exp_f32 v97,v97
 v_mfma_f32_16x16x32_bf16 v[104:107],v[20:23],a[216:219],v[104:107]
 v_exp_f32 v98,v98
 v_mfma_f32_16x16x32_bf16 v[104:107],v[24:27],a[232:235],v[104:107]
 ds_read_b64_tr_b16 v[60:61],v9 offset:12544
 ds_read_b64_tr_b16 v[62:63],v9 offset:18688
 v_mfma_f32_16x16x32_bf16 v[104:107],v[28:31],a[248:251],v[104:107]
 v_add_f32 v10,v10,v96
 v_cvt_pk_bf16_f32 v134,v96,v97
 v_mfma_f32_16x16x32_bf16 v[104:107],v[32:35],v[72:75],v[104:107]
 s_sub_u32 s50,s38,s37
 v_add_u32 v4,s50,v4
 v_add_u32 v5,s50,v5
 v_mfma_f32_16x16x32_bf16 v[104:107],v[36:39],v[88:91],v[104:107]
 v_exp_f32 v99,v99
 v_mfma_f32_16x16x32_bf16 v[108:111],v[36:39],v[92:95],v[124:127]
 v_cndmask_b32 v248,v248,v251,vcc
 v_cndmask_b32 v249,v249,v252,vcc
 v_mfma_f32_16x16x32_bf16 v[108:111],v[32:35],v[76:79],v[108:111]
 v_add_f32 v10,v10,v97
 v_add_f32 v10,v10,v98
 v_mfma_f32_16x16x32_bf16 v[108:111],v[28:31],a[252:255],v[108:111]
 v_cvt_pk_bf16_f32 v135,v98,v99
 v_add_f32 v10,v10,v99
 v_mfma_f32_16x16x32_bf16 v[108:111],v[24:27],a[236:239],v[108:111]
 v_cndmask_b32 v250,v250,v253,vcc
 v_mfma_f32_16x16x32_bf16 v[108:111],v[20:23],a[220:223],v[108:111]
 v_exp_f32 v100,v100
 v_mfma_f32_16x16x32_bf16 v[108:111],v[16:19],a[204:207],v[108:111]
 s_waitcnt vmcnt(13) lgkmcnt(0)
 s_barrier
 v_mfma_f32_16x16x32_bf16 a[144:147],v[40:43],v[160:163],a[144:147]
 s_mov_b32 s41,s36
 v_exp_f32 v101,v101
 v_mfma_f32_16x16x32_bf16 a[144:147],v[44:47],v[164:167],a[144:147]
 s_mov_b32 s36,s37
 v_exp_f32 v102,v102
 v_mfma_f32_16x16x32_bf16 a[148:151],v[44:47],v[172:175],a[148:151]
 s_mov_b32 s37,s38
 ds_read_b128 v[16:19],v4
 ds_read_b128 v[20:23],v5
 v_mfma_f32_16x16x32_bf16 a[148:151],v[40:43],v[168:171],a[148:151]
 s_mov_b32 s38,s41
 v_add_f32 v11,v11,v100
 v_cvt_pk_bf16_f32 v142,v100,v101
 v_mfma_f32_16x16x32_bf16 a[152:155],v[40:43],v[176:179],a[152:155]
 s_add_u32 s39,s39,s67
 ds_read_b128 v[24:27],v4 offset:128
 ds_read_b128 v[28:31],v5 offset:128
 v_mfma_f32_16x16x32_bf16 a[152:155],v[44:47],v[180:183],a[152:155]
 s_add_u32 s40,s40,s69
 v_exp_f32 v103,v103
 v_mfma_f32_16x16x32_bf16 a[156:159],v[44:47],v[188:191],a[156:159]
 ds_read_b128 v[32:35],v4 offset:256
 ds_read_b128 v[36:39],v5 offset:256
 v_mfma_f32_16x16x32_bf16 a[156:159],v[40:43],v[184:187],a[156:159]
 s_add_u32 s42,s36,s35
 v_add_f32 v11,v11,v101
 v_add_f32 v11,v11,v102
 v_mfma_f32_16x16x32_bf16 a[160:163],v[48:51],v[160:163],a[160:163]
 s_add_u32 m0,s42,24576
 v_cvt_pk_bf16_f32 v143,v102,v103
 v_add_f32 v11,v11,v103
 v_mfma_f32_16x16x32_bf16 a[160:163],v[52:55],v[164:167],a[160:163]
 buffer_load_dwordx4 v1,s[12:15],s39 offen lds
 v_mfma_f32_16x16x32_bf16 a[164:167],v[52:55],v[172:175],a[164:167]
 v_exp_f32 v104,v104
 v_mfma_f32_16x16x32_bf16 a[164:167],v[48:51],v[168:171],a[164:167]
 buffer_load_dwordx4 v2,s[12:15],s39 offen offset:1024 lds
 v_mfma_f32_16x16x32_bf16 a[168:171],v[48:51],v[176:179],a[168:171]
 v_exp_f32 v105,v105
 v_mfma_f32_16x16x32_bf16 a[168:171],v[52:55],v[180:183],a[168:171]
 v_exp_f32 v106,v106
 v_mfma_f32_16x16x32_bf16 a[172:175],v[52:55],v[188:191],a[172:175]
 buffer_load_dwordx4 v3,s[12:15],s39 offen offset:2048 lds
 v_mfma_f32_16x16x32_bf16 a[172:175],v[48:51],v[184:187],a[172:175]
 s_sub_u32 s50,s38,s37
 v_add_f32 v12,v12,v104
 v_cvt_pk_bf16_f32 v150,v104,v105
 v_mfma_f32_16x16x32_bf16 a[176:179],v[56:59],v[160:163],a[176:179]
 v_add_u32 v6,s50,v6
 v_add_u32 v7,s50,v7
 v_mfma_f32_16x16x32_bf16 a[176:179],v[60:63],v[164:167],a[176:179]
 v_exp_f32 v107,v107
 v_mfma_f32_16x16x32_bf16 a[180:183],v[60:63],v[172:175],a[180:183]
 v_add_u32 v8,s50,v8
 v_add_u32 v9,s50,v9
 v_mfma_f32_16x16x32_bf16 a[180:183],v[56:59],v[168:171],a[180:183]
 v_add_f32 v12,v12,v105
 v_add_f32 v12,v12,v106
 v_mfma_f32_16x16x32_bf16 a[184:187],v[56:59],v[176:179],a[184:187]
 v_cvt_pk_bf16_f32 v151,v106,v107
 v_add_f32 v12,v12,v107
 v_mfma_f32_16x16x32_bf16 a[184:187],v[60:63],v[180:183],a[184:187]
 s_add_u32 s43,s43,1
 v_mfma_f32_16x16x32_bf16 a[188:191],v[60:63],v[188:191],a[188:191]
 s_bitcmp1_b32 2178,s43
 v_exp_f32 v108,v108
 v_mfma_f32_16x16x32_bf16 a[188:191],v[56:59],v[184:187],a[188:191]
 s_waitcnt lgkmcnt(0)
 s_cbranch_scc0 recurrent_scan__mha_block_cached__mixer_s_mlp__prompt_kernel_loop
 s_cmp_eq_u32 s43,1
 s_cbranch_scc0 recurrent_scan__mha_block_cached__mixer_s_mlp__prompt_kernel_o1
 s_cmp_lg_u32 s32,0
 s_cbranch_scc1 Lf21
 v_mov_b32 v14,s51
 s_mov_b64 exec,1
 s_add_u32 s91,s90,2048
 buffer_store_dword v14,off,s[92:95],s91 sc1
 s_mov_b64 exec,-1
Lf21:
 v_add_u32 v14,0,v0
 v_mul_u32_u24 v15,2731,v14
 v_lshrrev_b32 v15,16,v15
 v_mul_u32_u24 v15,896,v15
 v_add_u32 v243,v15,v1
 v_mul_u32_u24 v15,s79,v14
 v_lshrrev_b32 v15,16,v15
 v_lshrrev_b32 v14,s74,v15
 v_and_b32 v14,s71,v14
 v_xor_b32 v14,v14,v0
 v_mul_u32_u24 v15,s75,v15
 v_lshl_add_u32 v251,v14,4,v15
 v_add_u32 v14,64,v0
 v_mul_u32_u24 v15,2731,v14
 v_lshrrev_b32 v15,16,v15
 v_mul_u32_u24 v15,896,v15
 v_add_u32 v244,v15,v2
 v_mul_u32_u24 v15,s79,v14
 v_lshrrev_b32 v15,16,v15
 v_lshrrev_b32 v14,s74,v15
 v_and_b32 v14,s71,v14
 v_xor_b32 v14,v14,v0
 v_mul_u32_u24 v15,s75,v15
 v_lshl_add_u32 v252,v14,4,v15
 v_add_u32 v14,128,v0
 v_mul_u32_u24 v15,2731,v14
 v_lshrrev_b32 v15,16,v15
 v_mul_u32_u24 v15,896,v15
 v_add_u32 v245,v15,v3
 v_mul_u32_u24 v15,s79,v14
 v_lshrrev_b32 v15,16,v15
 v_lshrrev_b32 v14,s74,v15
 v_and_b32 v14,s71,v14
 v_xor_b32 v14,v14,v0
 v_mul_u32_u24 v15,s75,v15
 v_lshl_add_u32 v253,v14,4,v15
 s_branch recurrent_scan__mha_block_cached__mixer_s_mlp__prompt_kernel_loop
recurrent_scan__mha_block_cached__mixer_s_mlp__prompt_kernel_o1:
 s_cmp_eq_u32 s43,7
 s_cbranch_scc0 recurrent_scan__mha_block_cached__mixer_s_mlp__prompt_kernel_o7
 v_lshlrev_b32 v240,2,v0
 s_lshl_b32 s41,s32,8
 s_add_u32 s41,s41,2048
 v_add_u32 v240,s41,v240
 buffer_load_dword v241,v240,s[92:95],0 offen sc1
 v_readfirstlane_b32 s41,v254
 s_nop 0
 s_cmp_eq_u32 s41,255
 s_cbranch_scc0 Lg22
 v_mov_b32 v14,s51
 s_movk_i32 s41,8192
 s_mov_b64 exec,1
 buffer_store_dword v14,off,s[92:95],s41 sc1
 s_mov_b64 exec,-1
Lg22:
 s_branch recurrent_scan__mha_block_cached__mixer_s_mlp__prompt_kernel_loop
recurrent_scan__mha_block_cached__mixer_s_mlp__prompt_kernel_o7:
 v_cmp_ne_u32 vcc,s51,v241
 s_nop 1
 s_cbranch_vccnz Lp23_spin
Lp23_ok:
 s_getpc_b64 s[4:5]
recurrent_scan__mha_block_cached__mixer_s_mlp__prompt_kernel_pc2:
 s_add_u32 s45,s62,s32
 s_mul_i32 s41,s48,1792
 s_mul_i32 s44,s52,983040
 s_add_u32 s41,s41,s44
 s_add_u32 s41,s72,s41
 s_addc_u32 s42,s73,0
 s_lshl_b64 exec,-1,0
 v_subrev_u32 v14,0,v0
 v_min_u32 v14,13,v14
 v_lshlrev_b32 v14,7,v14
 v_add_co_u32 v236,vcc,s41,v14
 v_mov_b32 v15,s42
 s_nop 0
 v_addc_co_u32 v237,vcc,0,v15,vcc
 v_mov_b32 v238,108544
 s_mul_i32 s41,s45,512
 s_add_u32 s41,s80,s41
 s_addc_u32 s42,s81,0
 s_lshl_b64 exec,-1,14
 v_subrev_u32 v14,14,v0
 v_min_u32 v14,3,v14
 v_lshlrev_b32 v14,7,v14
 v_add_co_u32 v236,vcc,s41,v14
 v_mov_b32 v15,s42
 s_nop 0
 v_addc_co_u32 v237,vcc,0,v15,vcc
 v_mov_b32 v238,212992
 s_mul_i32 s41,s48,256
 s_add_u32 s41,s4,s41
 s_addc_u32 s42,s5,0
 s_lshl_b64 exec,-1,18
 v_subrev_u32 v14,18,v0
 v_min_u32 v14,1,v14
 v_lshlrev_b32 v14,7,v14
 v_add_co_u32 v236,vcc,s41,v14
 v_mov_b32 v15,s42
 s_nop 0
 v_addc_co_u32 v237,vcc,0,v15,vcc
 v_mov_b32 v238,(((recurrent_scan__mha_block_cached__mixer_s_mlp__prompt_kernel_hot_end-recurrent_scan__mha_block_cached__mixer_s_mlp__prompt_kernel_pc2-16384)/8)/128+1)*128
 s_mov_b64 exec,-1
 s_branch recurrent_scan__mha_block_cached__mixer_s_mlp__prompt_kernel_loop
recurrent_scan__mha_block_cached__mixer_s_mlp__prompt_kernel_last:
 ds_read_b64_tr_b16 v[40:41],v6
 ds_read_b64_tr_b16 v[42:43],v6 offset:6144
 ds_read_b64_tr_b16 v[44:45],v6 offset:12288
 ds_read_b64_tr_b16 v[46:47],v6 offset:18432
 ds_read_b64_tr_b16 v[48:49],v7
 ds_read_b64_tr_b16 v[50:51],v7 offset:6144
 ds_read_b64_tr_b16 v[52:53],v7 offset:12288
 ds_read_b64_tr_b16 v[54:55],v7 offset:18432
 ds_read_b64_tr_b16 v[56:57],v8
 ds_read_b64_tr_b16 v[58:59],v8 offset:6144
 ds_read_b64_tr_b16 v[60:61],v8 offset:12288
 ds_read_b64_tr_b16 v[62:63],v8 offset:18432
 v_exp_f32 v109,v109
 v_exp_f32 v110,v110
 v_add_f32 v13,v13,v108
 v_cvt_pk_bf16_f32 v190,v108,v109
 v_exp_f32 v111,v111
 v_add_f32 v13,v13,v109
 v_add_f32 v13,v13,v110
 v_cvt_pk_bf16_f32 v191,v110,v111
 v_add_f32 v13,v13,v111
 v_mov_b32 v192,v10
 v_mov_b32 v193,v11
 v_mov_b32 v194,v12
 v_mov_b32 v195,v13
 v_permlane32_swap_b32 v10,v192
 v_permlane32_swap_b32 v11,v193
 v_permlane32_swap_b32 v12,v194
 v_permlane32_swap_b32 v13,v195
 v_add_f32 v10,v10,v192
 v_add_f32 v11,v11,v193
 v_add_f32 v12,v12,v194
 v_add_f32 v13,v13,v195
 v_mov_b32 v192,v10
 v_mov_b32 v193,v11
 v_mov_b32 v194,v12
 v_mov_b32 v195,v13
 v_permlane16_swap_b32 v10,v192
 v_permlane16_swap_b32 v11,v193
 v_permlane16_swap_b32 v12,v194
 v_permlane16_swap_b32 v13,v195
 v_add_f32 v10,v10,v192
 v_add_f32 v11,v11,v193
 v_add_f32 v12,v12,v194
 v_add_f32 v13,v13,v195
 v_add_f32 v14,v10,v11
 v_add_f32 v15,v12,v13
 v_add_f32 v14,v14,v15
 v_cmp_ngt_f32 vcc,0x53800000,v14
 s_nop 1
 s_cbranch_vccnz recurrent_scan__mha_block_cached__mixer_s_mlp__prompt_kernel_exact
recurrent_scan__mha_block_cached__mixer_s_mlp__prompt_kernel_back:
 v_rcp_f32 v10,v10
 v_rcp_f32 v11,v11
 v_rcp_f32 v12,v12
 v_rcp_f32 v13,v13
 s_bitcmp1_b32 s34,0
 s_cbranch_scc1 recurrent_scan__mha_block_cached__mixer_s_mlp__prompt_kernel_tB
 s_add_u32 m0,s35,76800
 s_add_u32 s44,s39,10240
 buffer_load_dwordx4 v1,s[12:15],s44 offen lds
 buffer_load_dwordx4 v2,s[12:15],s44 offen offset:1024 lds
 buffer_load_dwordx4 v3,s[12:15],s44 offen offset:2048 lds
 s_waitcnt lgkmcnt(0)
 v_mfma_f32_16x16x32_bf16 a[0:3],v[40:43],v[160:163],a[0:3]
 ds_read_b64_tr_b16 v[16:17],v9
 ds_read_b64_tr_b16 v[18:19],v9 offset:6144
 v_mfma_f32_16x16x32_bf16 a[0:3],v[44:47],v[164:167],a[0:3]
 v_lshlrev_b32 v4,4,v0
 v_lshlrev_b32 v5,3,v0
 v_mfma_f32_16x16x32_bf16 a[4:7],v[44:47],v[172:175],a[4:7]
 ds_read_b64_tr_b16 v[20:21],v9 offset:12288
 ds_read_b64_tr_b16 v[22:23],v9 offset:18432
 v_mfma_f32_16x16x32_bf16 a[4:7],v[40:43],v[168:171],a[4:7]
 s_lshl_b32 s41,s34,2
 s_add_u32 s41,s41,s32
 s_mul_i32 s41,s41,786432
 v_mfma_f32_16x16x32_bf16 a[8:11],v[40:43],v[176:179],a[8:11]
 s_add_u32 m0,s35,98304
 s_mov_b32 s39,s40
 buffer_load_dwordx4 v1,s[12:15],s39 offen lds
 ds_read_b64_tr_b16 v[24:25],v6 offset:128
 ds_read_b64_tr_b16 v[26:27],v6 offset:6272
 v_mfma_f32_16x16x32_bf16 a[8:11],v[44:47],v[180:183],a[8:11]
 s_mul_i32 s42,s52,24576
 s_add_u32 s41,s41,s42
 s_add_u32 s41,s41,14794752
 v_mfma_f32_16x16x32_bf16 a[12:15],v[44:47],v[188:191],a[12:15]
 ds_read_b64_tr_b16 v[28:29],v6 offset:12416
 ds_read_b64_tr_b16 v[30:31],v6 offset:18560
 v_mfma_f32_16x16x32_bf16 a[12:15],v[40:43],v[184:187],a[12:15]
 s_add_u32 s4,s88,s41
 s_addc_u32 s5,s89,0
 v_mfma_f32_16x16x32_bf16 a[16:19],v[48:51],v[160:163],a[16:19]
 buffer_load_dwordx4 v2,s[12:15],s39 offen offset:1024 lds
 ds_read_b64_tr_b16 v[32:33],v7 offset:128
 ds_read_b64_tr_b16 v[34:35],v7 offset:6272
 v_mfma_f32_16x16x32_bf16 a[16:19],v[52:55],v[164:167],a[16:19]
 s_mov_b32 s6,614400
 s_mov_b32 s7,0x20000
 s_mul_i32 s46,s53,6144
 v_mfma_f32_16x16x32_bf16 a[20:23],v[52:55],v[172:175],a[20:23]
 ds_read_b64_tr_b16 v[36:37],v7 offset:12416
 ds_read_b64_tr_b16 v[38:39],v7 offset:18560
 v_mfma_f32_16x16x32_bf16 a[20:23],v[48:51],v[168:171],a[20:23]
 s_and_b32 s41,s53,1
 s_lshl_b32 s41,s41,6
 v_mfma_f32_16x16x32_bf16 a[24:27],v[48:51],v[176:179],a[24:27]
 s_lshl_b32 s42,s41,1
 s_add_u32 s42,s42,122880
 v_xor_b32 v240,s41,v6
 v_mfma_f32_16x16x32_bf16 a[24:27],v[52:55],v[180:183],a[24:27]
 buffer_load_dwordx4 v3,s[12:15],s39 offen offset:2048 lds
 v_add_u32 v240,122880,v240
 v_subrev_u32 v236,98304,v240
 v_mfma_f32_16x16x32_bf16 a[28:31],v[52:55],v[188:191],a[28:31]
 v_xor_b32 v241,s41,v7
 v_add_u32 v241,122880,v241
 v_mfma_f32_16x16x32_bf16 a[28:31],v[48:51],v[184:187],a[28:31]
 v_subrev_u32 v237,98304,v241
 v_xor_b32 v242,s41,v8
 v_mfma_f32_16x16x32_bf16 a[32:35],v[56:59],v[160:163],a[32:35]
 v_add_u32 v242,s42,v242
 v_subrev_u32 v238,98304,v242
 v_mfma_f32_16x16x32_bf16 a[32:35],v[60:63],v[164:167],a[32:35]
 s_add_u32 m0,s35,101376
 s_add_u32 s44,s39,10240
 buffer_load_dwordx4 v1,s[12:15],s44 offen lds
 v_xor_b32 v243,s41,v9
 v_add_u32 v243,s42,v243
 v_mfma_f32_16x16x32_bf16 a[36:39],v[60:63],v[172:175],a[36:39]
 v_subrev_u32 v239,98304,v243
 v_accvgpr_read_b32 v224,a0
 v_mfma_f32_16x16x32_bf16 a[36:39],v[56:59],v[168:171],a[36:39]
 v_accvgpr_read_b32 v225,a1
 v_accvgpr_read_b32 v226,a2
 v_mfma_f32_16x16x32_bf16 a[40:43],v[56:59],v[176:179],a[40:43]
 v_accvgpr_read_b32 v227,a3
 v_accvgpr_read_b32 v228,a16
 v_mfma_f32_16x16x32_bf16 a[40:43],v[60:63],v[180:183],a[40:43]
 v_accvgpr_read_b32 v229,a17
 v_accvgpr_read_b32 v230,a18
 v_mfma_f32_16x16x32_bf16 a[44:47],v[60:63],v[188:191],a[44:47]
 buffer_load_dwordx4 v2,s[12:15],s44 offen offset:1024 lds
 v_accvgpr_read_b32 v231,a19
 v_mul_f32 v224,v224,v10
 v_mfma_f32_16x16x32_bf16 a[44:47],v[56:59],v[184:187],a[44:47]
 s_waitcnt lgkmcnt(0)
 v_mul_f32 v225,v225,v10
 v_mul_f32 v226,v226,v10
 v_mfma_f32_16x16x32_bf16 a[48:51],v[16:19],v[160:163],a[48:51]
 ds_read_b64_tr_b16 v[40:41],v8 offset:128
 ds_read_b64_tr_b16 v[42:43],v8 offset:6272
 v_mfma_f32_16x16x32_bf16 a[48:51],v[20:23],v[164:167],a[48:51]
 v_mul_f32 v227,v227,v10
 v_mul_f32 v228,v228,v10
 v_mfma_f32_16x16x32_bf16 a[52:55],v[20:23],v[172:175],a[52:55]
 buffer_load_dwordx4 v3,s[12:15],s44 offen offset:2048 lds
 ds_read_b64_tr_b16 v[44:45],v8 offset:12416
 ds_read_b64_tr_b16 v[46:47],v8 offset:18560
 v_mfma_f32_16x16x32_bf16 a[52:55],v[16:19],v[168:171],a[52:55]
 v_mul_f32 v229,v229,v10
 v_mul_f32 v230,v230,v10
 v_mfma_f32_16x16x32_bf16 a[56:59],v[16:19],v[176:179],a[56:59]
 ds_read_b64_tr_b16 v[48:49],v9 offset:128
 ds_read_b64_tr_b16 v[50:51],v9 offset:6272
 v_mfma_f32_16x16x32_bf16 a[56:59],v[20:23],v[180:183],a[56:59]
 v_mul_f32 v231,v231,v10
 v_cvt_pk_bf16_f32 v64,v224,v225
 v_mfma_f32_16x16x32_bf16 a[60:63],v[20:23],v[188:191],a[60:63]
 ds_read_b64_tr_b16 v[52:53],v9 offset:12416
 ds_read_b64_tr_b16 v[54:55],v9 offset:18560
 v_mfma_f32_16x16x32_bf16 a[60:63],v[16:19],v[184:187],a[60:63]
 v_cvt_pk_bf16_f32 v65,v226,v227
 v_cvt_pk_bf16_f32 v66,v228,v229
 v_mfma_f32_16x16x32_bf16 a[64:67],v[24:27],v[160:163],a[64:67]
 ds_read_b64_tr_b16 v[56:57],v6 offset:256
 ds_read_b64_tr_b16 v[58:59],v6 offset:6400
 v_mfma_f32_16x16x32_bf16 a[64:67],v[28:31],v[164:167],a[64:67]
 v_cvt_pk_bf16_f32 v67,v230,v231
 v_accvgpr_read_b32 v232,a4
 v_mfma_f32_16x16x32_bf16 a[68:71],v[28:31],v[172:175],a[68:71]
 s_add_u32 s47,s46,0
 buffer_store_dwordx4 v[64:67],v4,s[4:7],s47 offen sc1
 ds_read_b64_tr_b16 v[60:61],v6 offset:12544
 ds_read_b64_tr_b16 v[62:63],v6 offset:18688
 v_mfma_f32_16x16x32_bf16 a[68:71],v[24:27],v[168:171],a[68:71]
 v_accvgpr_read_b32 v233,a5
 v_accvgpr_read_b32 v234,a6
 v_mfma_f32_16x16x32_bf16 a[72:75],v[24:27],v[176:179],a[72:75]
 v_accvgpr_read_b32 v235,a7
 v_accvgpr_read_b32 v244,a20
 v_mfma_f32_16x16x32_bf16 a[72:75],v[28:31],v[180:183],a[72:75]
 v_accvgpr_read_b32 v245,a21
 v_accvgpr_read_b32 v246,a22
 v_mfma_f32_16x16x32_bf16 a[76:79],v[28:31],v[188:191],a[76:79]
 v_accvgpr_read_b32 v247,a23
 v_mul_f32 v232,v232,v11
 v_mfma_f32_16x16x32_bf16 a[76:79],v[24:27],v[184:187],a[76:79]
 v_mul_f32 v233,v233,v11
 v_mul_f32 v234,v234,v11
 v_mfma_f32_16x16x32_bf16 a[80:83],v[32:35],v[160:163],a[80:83]
 v_mul_f32 v235,v235,v11
 v_mul_f32 v244,v244,v11
 v_mfma_f32_16x16x32_bf16 a[80:83],v[36:39],v[164:167],a[80:83]
 v_mul_f32 v245,v245,v11
 v_mul_f32 v246,v246,v11
 v_mfma_f32_16x16x32_bf16 a[84:87],v[36:39],v[172:175],a[84:87]
 v_mul_f32 v247,v247,v11
 v_cvt_pk_bf16_f32 v68,v232,v233
 v_mfma_f32_16x16x32_bf16 a[84:87],v[32:35],v[168:171],a[84:87]
 v_cvt_pk_bf16_f32 v69,v234,v235
 v_cvt_pk_bf16_f32 v70,v244,v245
 v_mfma_f32_16x16x32_bf16 a[88:91],v[32:35],v[176:179],a[88:91]
 v_cvt_pk_bf16_f32 v71,v246,v247
 v_accvgpr_read_b32 v224,a8
 v_mfma_f32_16x16x32_bf16 a[88:91],v[36:39],v[180:183],a[88:91]
 s_add_u32 s47,s46,196608
 buffer_store_dwordx4 v[68:71],v4,s[4:7],s47 offen sc1
 v_accvgpr_read_b32 v225,a9
 v_accvgpr_read_b32 v226,a10
 v_mfma_f32_16x16x32_bf16 a[92:95],v[36:39],v[188:191],a[92:95]
 v_accvgpr_read_b32 v227,a11
 v_accvgpr_read_b32 v228,a24
 v_mfma_f32_16x16x32_bf16 a[92:95],v[32:35],v[184:187],a[92:95]
 s_waitcnt lgkmcnt(0)
 v_accvgpr_read_b32 v229,a25
 v_accvgpr_read_b32 v230,a26
 v_mfma_f32_16x16x32_bf16 a[96:99],v[40:43],v[160:163],a[96:99]
 ds_read_b64_tr_b16 v[16:17],v7 offset:256
 ds_read_b64_tr_b16 v[18:19],v7 offset:6400
 v_mfma_f32_16x16x32_bf16 a[96:99],v[44:47],v[164:167],a[96:99]
 v_accvgpr_read_b32 v231,a27
 v_mul_f32 v224,v224,v12
 v_mfma_f32_16x16x32_bf16 a[100:103],v[44:47],v[172:175],a[100:103]
 ds_read_b64_tr_b16 v[20:21],v7 offset:12544
 ds_read_b64_tr_b16 v[22:23],v7 offset:18688
 v_mfma_f32_16x16x32_bf16 a[100:103],v[40:43],v[168:171],a[100:103]
 v_mul_f32 v225,v225,v12
 v_mul_f32 v226,v226,v12
 v_mfma_f32_16x16x32_bf16 a[104:107],v[40:43],v[176:179],a[104:107]
 ds_read_b64_tr_b16 v[24:25],v8 offset:256
 ds_read_b64_tr_b16 v[26:27],v8 offset:6400
 v_mfma_f32_16x16x32_bf16 a[104:107],v[44:47],v[180:183],a[104:107]
 v_mul_f32 v227,v227,v12
 v_mul_f32 v228,v228,v12
 v_mfma_f32_16x16x32_bf16 a[108:111],v[44:47],v[188:191],a[108:111]
 ds_read_b64_tr_b16 v[28:29],v8 offset:12544
 ds_read_b64_tr_b16 v[30:31],v8 offset:18688
 v_mfma_f32_16x16x32_bf16 a[108:111],v[40:43],v[184:187],a[108:111]
 v_mul_f32 v229,v229,v12
 v_mul_f32 v230,v230,v12
 v_mfma_f32_16x16x32_bf16 a[112:115],v[48:51],v[160:163],a[112:115]
 ds_read_b64_tr_b16 v[32:33],v9 offset:256
 ds_read_b64_tr_b16 v[34:35],v9 offset:6400
 v_mfma_f32_16x16x32_bf16 a[112:115],v[52:55],v[164:167],a[112:115]
 v_mul_f32 v231,v231,v12
 v_cvt_pk_bf16_f32 v72,v224,v225
 v_mfma_f32_16x16x32_bf16 a[116:119],v[52:55],v[172:175],a[116:119]
 ds_read_b64_tr_b16 v[36:37],v9 offset:12544
 ds_read_b64_tr_b16 v[38:39],v9 offset:18688
 v_mfma_f32_16x16x32_bf16 a[116:119],v[48:51],v[168:171],a[116:119]
 v_cvt_pk_bf16_f32 v73,v226,v227
 v_cvt_pk_bf16_f32 v74,v228,v229
 v_mfma_f32_16x16x32_bf16 a[120:123],v[48:51],v[176:179],a[120:123]
 v_cvt_pk_bf16_f32 v75,v230,v231
 v_accvgpr_read_b32 v232,a12
 v_mfma_f32_16x16x32_bf16 a[120:123],v[52:55],v[180:183],a[120:123]
 s_add_u32 s47,s46,393216
 buffer_store_dwordx4 v[72:75],v4,s[4:7],s47 offen sc1
 v_accvgpr_read_b32 v233,a13
 v_accvgpr_read_b32 v234,a14
 v_mfma_f32_16x16x32_bf16 a[124:127],v[52:55],v[188:191],a[124:127]
 v_accvgpr_read_b32 v235,a15
 v_accvgpr_read_b32 v244,a28
 v_mfma_f32_16x16x32_bf16 a[124:127],v[48:51],v[184:187],a[124:127]
 v_accvgpr_read_b32 v245,a29
 v_accvgpr_read_b32 v246,a30
 v_mfma_f32_16x16x32_bf16 a[128:131],v[56:59],v[160:163],a[128:131]
 v_accvgpr_read_b32 v247,a31
 v_mul_f32 v232,v232,v13
 v_mfma_f32_16x16x32_bf16 a[128:131],v[60:63],v[164:167],a[128:131]
 v_mul_f32 v233,v233,v13
 v_mul_f32 v234,v234,v13
 v_mfma_f32_16x16x32_bf16 a[132:135],v[60:63],v[172:175],a[132:135]
 v_mul_f32 v235,v235,v13
 v_mul_f32 v244,v244,v13
 v_mfma_f32_16x16x32_bf16 a[132:135],v[56:59],v[168:171],a[132:135]
 v_mul_f32 v245,v245,v13
 v_mul_f32 v246,v246,v13
 v_mfma_f32_16x16x32_bf16 a[136:139],v[56:59],v[176:179],a[136:139]
 v_mul_f32 v247,v247,v13
 v_cvt_pk_bf16_f32 v76,v232,v233
 v_mfma_f32_16x16x32_bf16 a[136:139],v[60:63],v[180:183],a[136:139]
 v_cvt_pk_bf16_f32 v77,v234,v235
 v_cvt_pk_bf16_f32 v78,v244,v245
 v_mfma_f32_16x16x32_bf16 a[140:143],v[60:63],v[188:191],a[140:143]
 v_cvt_pk_bf16_f32 v79,v246,v247
 v_accvgpr_read_b32 v224,a32
 v_mfma_f32_16x16x32_bf16 a[140:143],v[56:59],v[184:187],a[140:143]
 s_add_u32 s47,s46,589824
 buffer_store_dwordx4 v[76:79],v4,s[4:7],s47 offen sc1
 s_waitcnt lgkmcnt(0)
 v_accvgpr_read_b32 v225,a33
 v_accvgpr_read_b32 v226,a34
 v_mfma_f32_16x16x32_bf16 a[144:147],v[16:19],v[160:163],a[144:147]
 s_waitcnt vmcnt(13)
 s_barrier
 v_accvgpr_read_b32 v227,a35
 v_mfma_f32_16x16x32_bf16 a[144:147],v[20:23],v[164:167],a[144:147]
 s_add_u32 m0,s35,0
 s_add_u32 s39,s39,81920
 buffer_load_dwordx4 v1,s[12:15],s39 offen lds
 buffer_load_dwordx4 v2,s[12:15],s39 offen offset:1024 lds
 v_accvgpr_read_b32 v228,a48
 v_accvgpr_read_b32 v229,a49
 v_mfma_f32_16x16x32_bf16 a[148:151],v[20:23],v[172:175],a[148:151]
 v_accvgpr_read_b32 v230,a50
 v_accvgpr_read_b32 v231,a51
 v_mfma_f32_16x16x32_bf16 a[148:151],v[16:19],v[168:171],a[148:151]
 v_mul_f32 v224,v224,v10
 v_mul_f32 v225,v225,v10
 v_mfma_f32_16x16x32_bf16 a[152:155],v[16:19],v[176:179],a[152:155]
 v_mul_f32 v226,v226,v10
 v_mul_f32 v227,v227,v10
 v_mfma_f32_16x16x32_bf16 a[152:155],v[20:23],v[180:183],a[152:155]
 v_mul_f32 v228,v228,v10
 v_mul_f32 v229,v229,v10
 v_mfma_f32_16x16x32_bf16 a[156:159],v[20:23],v[188:191],a[156:159]
 buffer_load_dwordx4 v3,s[12:15],s39 offen offset:2048 lds
 v_mul_f32 v230,v230,v10
 v_mul_f32 v231,v231,v10
 v_mfma_f32_16x16x32_bf16 a[156:159],v[16:19],v[184:187],a[156:159]
 v_cvt_pk_bf16_f32 v80,v224,v225
 v_cvt_pk_bf16_f32 v81,v226,v227
 v_mfma_f32_16x16x32_bf16 a[160:163],v[24:27],v[160:163],a[160:163]
 v_cvt_pk_bf16_f32 v82,v228,v229
 v_cvt_pk_bf16_f32 v83,v230,v231
 v_mfma_f32_16x16x32_bf16 a[160:163],v[28:31],v[164:167],a[160:163]
 s_add_u32 s47,s46,0
 buffer_store_dwordx4 v[80:83],v4,s[4:7],s47 offen offset:1024 sc1
 v_accvgpr_read_b32 v232,a36
 v_accvgpr_read_b32 v233,a37
 v_mfma_f32_16x16x32_bf16 a[164:167],v[28:31],v[172:175],a[164:167]
 v_accvgpr_read_b32 v234,a38
 v_accvgpr_read_b32 v235,a39
 v_mfma_f32_16x16x32_bf16 a[164:167],v[24:27],v[168:171],a[164:167]
 v_accvgpr_read_b32 v244,a52
 v_accvgpr_read_b32 v245,a53
 v_mfma_f32_16x16x32_bf16 a[168:171],v[24:27],v[176:179],a[168:171]
 v_accvgpr_read_b32 v246,a54
 v_accvgpr_read_b32 v247,a55
 v_mfma_f32_16x16x32_bf16 a[168:171],v[28:31],v[180:183],a[168:171]
 v_mul_f32 v232,v232,v11
 v_mul_f32 v233,v233,v11
 v_mfma_f32_16x16x32_bf16 a[172:175],v[28:31],v[188:191],a[172:175]
 v_mul_f32 v234,v234,v11
 v_mul_f32 v235,v235,v11
 v_mfma_f32_16x16x32_bf16 a[172:175],v[24:27],v[184:187],a[172:175]
 v_mul_f32 v244,v244,v11
 v_mul_f32 v245,v245,v11
 v_mfma_f32_16x16x32_bf16 a[176:179],v[32:35],v[160:163],a[176:179]
 s_add_u32 m0,s35,3072
 s_add_u32 s44,s39,10240
 buffer_load_dwordx4 v1,s[12:15],s44 offen lds
 v_mul_f32 v246,v246,v11
 v_mul_f32 v247,v247,v11
 v_mfma_f32_16x16x32_bf16 a[176:179],v[36:39],v[164:167],a[176:179]
 v_cvt_pk_bf16_f32 v84,v232,v233
 v_cvt_pk_bf16_f32 v85,v234,v235
 v_mfma_f32_16x16x32_bf16 a[180:183],v[36:39],v[172:175],a[180:183]
 v_cvt_pk_bf16_f32 v86,v244,v245
 v_cvt_pk_bf16_f32 v87,v246,v247
 v_mfma_f32_16x16x32_bf16 a[180:183],v[32:35],v[168:171],a[180:183]
 s_add_u32 s47,s46,196608
 buffer_store_dwordx4 v[84:87],v4,s[4:7],s47 offen offset:1024 sc1
 v_accvgpr_read_b32 v224,a40
 v_accvgpr_read_b32 v225,a41
 v_mfma_f32_16x16x32_bf16 a[184:187],v[32:35],v[176:179],a[184:187]
 v_accvgpr_read_b32 v226,a42
 v_accvgpr_read_b32 v227,a43
 v_mfma_f32_16x16x32_bf16 a[184:187],v[36:39],v[180:183],a[184:187]
 v_accvgpr_read_b32 v228,a56
 v_accvgpr_read_b32 v229,a57
 v_mfma_f32_16x16x32_bf16 a[188:191],v[36:39],v[188:191],a[188:191]
 v_accvgpr_read_b32 v230,a58
 v_accvgpr_read_b32 v231,a59
 v_mfma_f32_16x16x32_bf16 a[188:191],v[32:35],v[184:187],a[188:191]
 v_mul_f32 v224,v224,v12
 v_mul_f32 v225,v225,v12
 v_mul_f32 v226,v226,v12
 v_mul_f32 v227,v227,v12
 v_mul_f32 v228,v228,v12
 v_mul_f32 v229,v229,v12
 v_mul_f32 v230,v230,v12
 v_mul_f32 v231,v231,v12
 v_cvt_pk_bf16_f32 v88,v224,v225
 v_cvt_pk_bf16_f32 v89,v226,v227
 v_cvt_pk_bf16_f32 v90,v228,v229
 buffer_load_dwordx4 v2,s[12:15],s44 offen offset:1024 lds
 v_cvt_pk_bf16_f32 v91,v230,v231
 v_accvgpr_read_b32 v232,a44
 v_accvgpr_read_b32 v233,a45
 v_accvgpr_read_b32 v234,a46
 s_add_u32 s47,s46,393216
 buffer_store_dwordx4 v[88:91],v4,s[4:7],s47 offen offset:1024 sc1
 v_accvgpr_read_b32 v235,a47
 v_accvgpr_read_b32 v244,a60
 v_accvgpr_read_b32 v245,a61
 v_accvgpr_read_b32 v246,a62
 v_accvgpr_read_b32 v247,a63
 v_mul_f32 v232,v232,v13
 v_mul_f32 v233,v233,v13
 v_mul_f32 v234,v234,v13
 v_mul_f32 v235,v235,v13
 v_mul_f32 v244,v244,v13
 v_mul_f32 v245,v245,v13
 v_mul_f32 v246,v246,v13
 v_mul_f32 v247,v247,v13
 v_cvt_pk_bf16_f32 v92,v232,v233
 v_cvt_pk_bf16_f32 v93,v234,v235
 v_cvt_pk_bf16_f32 v94,v244,v245
 v_cvt_pk_bf16_f32 v95,v246,v247
 s_add_u32 s47,s46,589824
 buffer_store_dwordx4 v[92:95],v4,s[4:7],s47 offen offset:1024 sc1
 v_accvgpr_read_b32 v224,a64
 v_accvgpr_read_b32 v225,a65
 v_accvgpr_read_b32 v226,a66
 v_accvgpr_read_b32 v227,a67
 v_accvgpr_read_b32 v228,a80
 v_accvgpr_read_b32 v229,a81
 v_accvgpr_read_b32 v230,a82
 v_accvgpr_read_b32 v231,a83
 v_mul_f32 v224,v224,v10
 v_mul_f32 v225,v225,v10
 v_mul_f32 v226,v226,v10
 v_mul_f32 v227,v227,v10
 v_mul_f32 v228,v228,v10
 v_mul_f32 v229,v229,v10
 v_mul_f32 v230,v230,v10
 v_mul_f32 v231,v231,v10
 v_cvt_pk_bf16_f32 v96,v224,v225
 v_cvt_pk_bf16_f32 v97,v226,v227
 v_cvt_pk_bf16_f32 v98,v228,v229
 v_cvt_pk_bf16_f32 v99,v230,v231
 s_add_u32 s47,s46,0
 buffer_store_dwordx4 v[96:99],v4,s[4:7],s47 offen offset:2048 sc1
 v_accvgpr_read_b32 v232,a68
 v_accvgpr_read_b32 v233,a69
 v_accvgpr_read_b32 v234,a70
 v_accvgpr_read_b32 v235,a71
 v_accvgpr_read_b32 v244,a84
 v_accvgpr_read_b32 v245,a85
 v_accvgpr_read_b32 v246,a86
 v_accvgpr_read_b32 v247,a87
 v_mul_f32 v232,v232,v11
 v_mul_f32 v233,v233,v11
 v_mul_f32 v234,v234,v11
 v_mul_f32 v235,v235,v11
 v_mul_f32 v244,v244,v11
 v_mul_f32 v245,v245,v11
 v_mul_f32 v246,v246,v11
 v_mul_f32 v247,v247,v11
 v_cvt_pk_bf16_f32 v100,v232,v233
 v_cvt_pk_bf16_f32 v101,v234,v235
 v_cvt_pk_bf16_f32 v102,v244,v245
 buffer_load_dwordx4 v3,s[12:15],s44 offen offset:2048 lds
 v_cvt_pk_bf16_f32 v103,v246,v247
 v_accvgpr_read_b32 v224,a72
 v_accvgpr_read_b32 v225,a73
 v_accvgpr_read_b32 v226,a74
 s_add_u32 s47,s46,196608
 buffer_store_dwordx4 v[100:103],v4,s[4:7],s47 offen offset:2048 sc1
 v_accvgpr_read_b32 v227,a75
 v_accvgpr_read_b32 v228,a88
 v_accvgpr_read_b32 v229,a89
 v_accvgpr_read_b32 v230,a90
 v_accvgpr_read_b32 v231,a91
 v_mul_f32 v224,v224,v12
 v_mul_f32 v225,v225,v12
 v_mul_f32 v226,v226,v12
 v_mul_f32 v227,v227,v12
 v_mul_f32 v228,v228,v12
 v_mul_f32 v229,v229,v12
 v_mul_f32 v230,v230,v12
 v_mul_f32 v231,v231,v12
 v_cvt_pk_bf16_f32 v104,v224,v225
 v_cvt_pk_bf16_f32 v105,v226,v227
 v_cvt_pk_bf16_f32 v106,v228,v229
 v_cvt_pk_bf16_f32 v107,v230,v231
 s_add_u32 s47,s46,393216
 buffer_store_dwordx4 v[104:107],v4,s[4:7],s47 offen offset:2048 sc1
 v_accvgpr_read_b32 v232,a76
 v_accvgpr_read_b32 v233,a77
 v_accvgpr_read_b32 v234,a78
 v_accvgpr_read_b32 v235,a79
 v_accvgpr_read_b32 v244,a92
 v_accvgpr_read_b32 v245,a93
 v_accvgpr_read_b32 v246,a94
 v_accvgpr_read_b32 v247,a95
 v_mul_f32 v232,v232,v13
 v_mul_f32 v233,v233,v13
 v_mul_f32 v234,v234,v13
 v_mul_f32 v235,v235,v13
 v_mul_f32 v244,v244,v13
 v_mul_f32 v245,v245,v13
 v_mul_f32 v246,v246,v13
 v_mul_f32 v247,v247,v13
 v_cvt_pk_bf16_f32 v108,v232,v233
 v_cvt_pk_bf16_f32 v109,v234,v235
 v_cvt_pk_bf16_f32 v110,v244,v245
 v_cvt_pk_bf16_f32 v111,v246,v247
 s_add_u32 s47,s46,589824
 buffer_store_dwordx4 v[108:111],v4,s[4:7],s47 offen offset:2048 sc1
 v_accvgpr_read_b32 v224,a96
 v_accvgpr_read_b32 v225,a97
 v_accvgpr_read_b32 v226,a98
 v_accvgpr_read_b32 v227,a99
 v_accvgpr_read_b32 v228,a112
 v_accvgpr_read_b32 v229,a113
 v_accvgpr_read_b32 v230,a114
 v_accvgpr_read_b32 v231,a115
 v_mul_f32 v224,v224,v10
 v_mul_f32 v225,v225,v10
 v_mul_f32 v226,v226,v10
 v_mul_f32 v227,v227,v10
 v_mul_f32 v228,v228,v10
 v_mul_f32 v229,v229,v10
 v_mul_f32 v230,v230,v10
 v_mul_f32 v231,v231,v10
 v_cvt_pk_bf16_f32 v112,v224,v225
 v_cvt_pk_bf16_f32 v113,v226,v227
 v_cvt_pk_bf16_f32 v114,v228,v229
 v_cvt_pk_bf16_f32 v115,v230,v231
 s_add_u32 s47,s46,0
 buffer_store_dwordx4 v[112:115],v4,s[4:7],s47 offen offset:3072 sc1
 v_accvgpr_read_b32 v232,a100
 v_accvgpr_read_b32 v233,a101
 v_accvgpr_read_b32 v234,a102
 v_accvgpr_read_b32 v235,a103
 v_accvgpr_read_b32 v244,a116
 v_accvgpr_read_b32 v245,a117
 v_accvgpr_read_b32 v246,a118
 v_accvgpr_read_b32 v247,a119
 v_mul_f32 v232,v232,v11
 v_mul_f32 v233,v233,v11
 v_mul_f32 v234,v234,v11
 v_mul_f32 v235,v235,v11
 v_mul_f32 v244,v244,v11
 v_mul_f32 v245,v245,v11
 v_mul_f32 v246,v246,v11
 v_mul_f32 v247,v247,v11
 v_cvt_pk_bf16_f32 v116,v232,v233
 v_cvt_pk_bf16_f32 v117,v234,v235
 v_cvt_pk_bf16_f32 v118,v244,v245
 v_cvt_pk_bf16_f32 v119,v246,v247
 s_add_u32 s47,s46,196608
 buffer_store_dwordx4 v[116:119],v4,s[4:7],s47 offen offset:3072 sc1
 v_accvgpr_read_b32 v224,a104
 v_accvgpr_read_b32 v225,a105
 ds_read_b64_tr_b16 v[16:17],v240
 ds_read_b64_tr_b16 v[18:19],v240 offset:6144
 ds_read_b64_tr_b16 v[20:21],v240 offset:12288
 ds_read_b64_tr_b16 v[22:23],v240 offset:18432
 ds_read_b64_tr_b16 v[24:25],v241
 ds_read_b64_tr_b16 v[26:27],v241 offset:6144
 ds_read_b64_tr_b16 v[28:29],v241 offset:12288
 ds_read_b64_tr_b16 v[30:31],v241 offset:18432
 v_accvgpr_read_b32 v226,a106
 v_accvgpr_read_b32 v227,a107
 v_accvgpr_read_b32 v228,a120
 v_accvgpr_read_b32 v229,a121
 v_accvgpr_read_b32 v230,a122
 v_accvgpr_read_b32 v231,a123
 v_mul_f32 v224,v224,v12
 v_mul_f32 v225,v225,v12
 v_mul_f32 v226,v226,v12
 v_mul_f32 v227,v227,v12
 v_mul_f32 v228,v228,v12
 v_mul_f32 v229,v229,v12
 v_mul_f32 v230,v230,v12
 v_mul_f32 v231,v231,v12
 v_cvt_pk_bf16_f32 v120,v224,v225
 v_cvt_pk_bf16_f32 v121,v226,v227
 v_cvt_pk_bf16_f32 v122,v228,v229
 v_cvt_pk_bf16_f32 v123,v230,v231
 s_add_u32 s47,s46,393216
 buffer_store_dwordx4 v[120:123],v4,s[4:7],s47 offen offset:3072 sc1
 v_accvgpr_read_b32 v232,a108
 v_accvgpr_read_b32 v233,a109
 v_accvgpr_read_b32 v234,a110
 v_accvgpr_read_b32 v235,a111
 v_accvgpr_read_b32 v244,a124
 v_accvgpr_read_b32 v245,a125
 v_accvgpr_read_b32 v246,a126
 v_accvgpr_read_b32 v247,a127
 v_mul_f32 v232,v232,v13
 v_mul_f32 v233,v233,v13
 v_mul_f32 v234,v234,v13
 v_mul_f32 v235,v235,v13
 v_mul_f32 v244,v244,v13
 v_mul_f32 v245,v245,v13
 v_mul_f32 v246,v246,v13
 v_mul_f32 v247,v247,v13
 v_cvt_pk_bf16_f32 v124,v232,v233
 v_cvt_pk_bf16_f32 v125,v234,v235
 v_cvt_pk_bf16_f32 v126,v244,v245
 v_cvt_pk_bf16_f32 v127,v246,v247
 s_add_u32 s47,s46,589824
 buffer_store_dwordx4 v[124:127],v4,s[4:7],s47 offen offset:3072 sc1
 s_waitcnt lgkmcnt(4)
 v_mfma_f32_16x16x32_bf16 a[0:3],v[16:19],v[64:67],0
 ds_read_b64_tr_b16 v[32:33],v242
 ds_read_b64_tr_b16 v[34:35],v242 offset:6144
 v_mfma_f32_16x16x32_bf16 a[0:3],v[20:23],v[80:83],a[0:3]
 v_accvgpr_read_b32 v224,a128
 v_accvgpr_read_b32 v225,a129
 v_mfma_f32_16x16x32_bf16 a[4:7],v[20:23],v[84:87],0
 v_accvgpr_read_b32 v226,a130
 v_accvgpr_read_b32 v227,a131
 v_mfma_f32_16x16x32_bf16 a[4:7],v[16:19],v[68:71],a[4:7]
 ds_read_b64_tr_b16 v[36:37],v242 offset:12288
 ds_read_b64_tr_b16 v[38:39],v242 offset:18432
 v_mfma_f32_16x16x32_bf16 a[8:11],v[16:19],v[72:75],0
 v_accvgpr_read_b32 v228,a144
 v_accvgpr_read_b32 v229,a145
 v_mfma_f32_16x16x32_bf16 a[8:11],v[20:23],v[88:91],a[8:11]
 v_accvgpr_read_b32 v230,a146
 v_accvgpr_read_b32 v231,a147
 v_mfma_f32_16x16x32_bf16 a[12:15],v[20:23],v[92:95],0
 v_mul_f32 v224,v224,v10
 v_mul_f32 v225,v225,v10
 v_mfma_f32_16x16x32_bf16 a[12:15],v[16:19],v[76:79],a[12:15]
 s_waitcnt lgkmcnt(4)
 v_mul_f32 v226,v226,v10
 v_mul_f32 v227,v227,v10
 v_mfma_f32_16x16x32_bf16 a[16:19],v[24:27],v[64:67],0
 ds_read_b64_tr_b16 v[40:41],v243
 ds_read_b64_tr_b16 v[42:43],v243 offset:6144
 v_mfma_f32_16x16x32_bf16 a[16:19],v[28:31],v[80:83],a[16:19]
 v_mul_f32 v228,v228,v10
 v_mul_f32 v229,v229,v10
 v_mfma_f32_16x16x32_bf16 a[20:23],v[28:31],v[84:87],0
 v_mul_f32 v230,v230,v10
 v_mul_f32 v231,v231,v10
 v_mfma_f32_16x16x32_bf16 a[20:23],v[24:27],v[68:71],a[20:23]
 ds_read_b64_tr_b16 v[44:45],v243 offset:12288
 ds_read_b64_tr_b16 v[46:47],v243 offset:18432
 v_mfma_f32_16x16x32_bf16 a[24:27],v[24:27],v[72:75],0
 v_cvt_pk_bf16_f32 v128,v224,v225
 v_cvt_pk_bf16_f32 v129,v226,v227
 v_mfma_f32_16x16x32_bf16 a[24:27],v[28:31],v[88:91],a[24:27]
 v_cvt_pk_bf16_f32 v130,v228,v229
 v_cvt_pk_bf16_f32 v131,v230,v231
 v_mfma_f32_16x16x32_bf16 a[28:31],v[28:31],v[92:95],0
 s_add_u32 s47,s46,4096
 buffer_store_dwordx4 v[128:131],v4,s[4:7],s47 offen sc1
 v_accvgpr_read_b32 v232,a132
 v_accvgpr_read_b32 v233,a133
 v_mfma_f32_16x16x32_bf16 a[28:31],v[24:27],v[76:79],a[28:31]
 s_waitcnt lgkmcnt(4)
 v_accvgpr_read_b32 v234,a134
 v_accvgpr_read_b32 v235,a135
 v_mfma_f32_16x16x32_bf16 a[32:35],v[32:35],v[64:67],0
 ds_read_b64_tr_b16 v[16:17],v240 offset:128
 ds_read_b64_tr_b16 v[18:19],v240 offset:6272
 v_mfma_f32_16x16x32_bf16 a[32:35],v[36:39],v[80:83],a[32:35]
 v_accvgpr_read_b32 v244,a148
 v_accvgpr_read_b32 v245,a149
 v_mfma_f32_16x16x32_bf16 a[36:39],v[36:39],v[84:87],0
 v_accvgpr_read_b32 v246,a150
 v_accvgpr_read_b32 v247,a151
 v_mfma_f32_16x16x32_bf16 a[36:39],v[32:35],v[68:71],a[36:39]
 ds_read_b64_tr_b16 v[20:21],v240 offset:12416
 ds_read_b64_tr_b16 v[22:23],v240 offset:18560
 v_mfma_f32_16x16x32_bf16 a[40:43],v[32:35],v[72:75],0
 v_mul_f32 v232,v232,v11
 v_mul_f32 v233,v233,v11
 v_mfma_f32_16x16x32_bf16 a[40:43],v[36:39],v[88:91],a[40:43]
 v_mul_f32 v234,v234,v11
 v_mul_f32 v235,v235,v11
 v_mfma_f32_16x16x32_bf16 a[44:47],v[36:39],v[92:95],0
 v_mul_f32 v244,v244,v11
 v_mul_f32 v245,v245,v11
 v_mfma_f32_16x16x32_bf16 a[44:47],v[32:35],v[76:79],a[44:47]
 s_waitcnt lgkmcnt(4)
 v_mul_f32 v246,v246,v11
 v_mul_f32 v247,v247,v11
 v_mfma_f32_16x16x32_bf16 a[48:51],v[40:43],v[64:67],0
 ds_read_b64_tr_b16 v[24:25],v241 offset:128
 ds_read_b64_tr_b16 v[26:27],v241 offset:6272
 v_mfma_f32_16x16x32_bf16 a[48:51],v[44:47],v[80:83],a[48:51]
 v_cvt_pk_bf16_f32 v132,v232,v233
 v_cvt_pk_bf16_f32 v133,v234,v235
 v_mfma_f32_16x16x32_bf16 a[52:55],v[44:47],v[84:87],0
 v_cvt_pk_bf16_f32 v134,v244,v245
 v_cvt_pk_bf16_f32 v135,v246,v247
 v_mfma_f32_16x16x32_bf16 a[52:55],v[40:43],v[68:71],a[52:55]
 s_add_u32 s47,s46,200704
 buffer_store_dwordx4 v[132:135],v4,s[4:7],s47 offen sc1
 ds_read_b64_tr_b16 v[28:29],v241 offset:12416
 ds_read_b64_tr_b16 v[30:31],v241 offset:18560
 v_mfma_f32_16x16x32_bf16 a[56:59],v[40:43],v[72:75],0
 v_accvgpr_read_b32 v224,a136
 v_accvgpr_read_b32 v225,a137
 v_mfma_f32_16x16x32_bf16 a[56:59],v[44:47],v[88:91],a[56:59]
 v_accvgpr_read_b32 v226,a138
 v_accvgpr_read_b32 v227,a139
 v_mfma_f32_16x16x32_bf16 a[60:63],v[44:47],v[92:95],0
 v_accvgpr_read_b32 v228,a152
 v_accvgpr_read_b32 v229,a153
 v_mfma_f32_16x16x32_bf16 a[60:63],v[40:43],v[76:79],a[60:63]
 s_waitcnt lgkmcnt(4)
 v_accvgpr_read_b32 v230,a154
 v_accvgpr_read_b32 v231,a155
 v_mfma_f32_16x16x32_bf16 a[64:67],v[16:19],v[64:67],0
 ds_read_b64_tr_b16 v[32:33],v242 offset:128
 ds_read_b64_tr_b16 v[34:35],v242 offset:6272
 v_mfma_f32_16x16x32_bf16 a[64:67],v[20:23],v[80:83],a[64:67]
 v_mul_f32 v224,v224,v12
 v_mul_f32 v225,v225,v12
 v_mfma_f32_16x16x32_bf16 a[68:71],v[20:23],v[84:87],0
 v_mul_f32 v226,v226,v12
 v_mul_f32 v227,v227,v12
 v_mfma_f32_16x16x32_bf16 a[68:71],v[16:19],v[68:71],a[68:71]
 ds_read_b64_tr_b16 v[36:37],v242 offset:12416
 ds_read_b64_tr_b16 v[38:39],v242 offset:18560
 v_mfma_f32_16x16x32_bf16 a[72:75],v[16:19],v[72:75],0
 v_mul_f32 v228,v228,v12
 v_mul_f32 v229,v229,v12
 v_mfma_f32_16x16x32_bf16 a[72:75],v[20:23],v[88:91],a[72:75]
 v_mul_f32 v230,v230,v12
 v_mul_f32 v231,v231,v12
 v_mfma_f32_16x16x32_bf16 a[76:79],v[20:23],v[92:95],0
 v_cvt_pk_bf16_f32 v136,v224,v225
 v_cvt_pk_bf16_f32 v137,v226,v227
 v_mfma_f32_16x16x32_bf16 a[76:79],v[16:19],v[76:79],a[76:79]
 s_waitcnt lgkmcnt(4)
 v_cvt_pk_bf16_f32 v138,v228,v229
 v_cvt_pk_bf16_f32 v139,v230,v231
 v_mfma_f32_16x16x32_bf16 a[80:83],v[24:27],v[64:67],0
 s_add_u32 s47,s46,397312
 buffer_store_dwordx4 v[136:139],v4,s[4:7],s47 offen sc1
 ds_read_b64_tr_b16 v[40:41],v243 offset:128
 ds_read_b64_tr_b16 v[42:43],v243 offset:6272
 v_mfma_f32_16x16x32_bf16 a[80:83],v[28:31],v[80:83],a[80:83]
 v_accvgpr_read_b32 v232,a140
 v_accvgpr_read_b32 v233,a141
 v_mfma_f32_16x16x32_bf16 a[84:87],v[28:31],v[84:87],0
 v_accvgpr_read_b32 v234,a142
 v_accvgpr_read_b32 v235,a143
 v_mfma_f32_16x16x32_bf16 a[84:87],v[24:27],v[68:71],a[84:87]
 ds_read_b64_tr_b16 v[44:45],v243 offset:12416
 ds_read_b64_tr_b16 v[46:47],v243 offset:18560
 v_mfma_f32_16x16x32_bf16 a[88:91],v[24:27],v[72:75],0
 v_accvgpr_read_b32 v244,a156
 v_accvgpr_read_b32 v245,a157
 v_mfma_f32_16x16x32_bf16 a[88:91],v[28:31],v[88:91],a[88:91]
 v_accvgpr_read_b32 v246,a158
 v_accvgpr_read_b32 v247,a159
 v_mfma_f32_16x16x32_bf16 a[92:95],v[28:31],v[92:95],0
 v_mul_f32 v232,v232,v13
 v_mul_f32 v233,v233,v13
 v_mfma_f32_16x16x32_bf16 a[92:95],v[24:27],v[76:79],a[92:95]
 s_waitcnt lgkmcnt(4)
 v_mul_f32 v234,v234,v13
 v_mul_f32 v235,v235,v13
 v_mfma_f32_16x16x32_bf16 a[96:99],v[32:35],v[64:67],0
 ds_read_b64_tr_b16 v[16:17],v236
 ds_read_b64_tr_b16 v[18:19],v236 offset:6144
 v_mfma_f32_16x16x32_bf16 a[96:99],v[36:39],v[80:83],a[96:99]
 v_mul_f32 v244,v244,v13
 v_mul_f32 v245,v245,v13
 v_mfma_f32_16x16x32_bf16 a[100:103],v[36:39],v[84:87],0
 v_mul_f32 v246,v246,v13
 v_mul_f32 v247,v247,v13
 v_mfma_f32_16x16x32_bf16 a[100:103],v[32:35],v[68:71],a[100:103]
 ds_read_b64_tr_b16 v[20:21],v236 offset:12288
 ds_read_b64_tr_b16 v[22:23],v236 offset:18432
 v_mfma_f32_16x16x32_bf16 a[104:107],v[32:35],v[72:75],0
 v_cvt_pk_bf16_f32 v140,v232,v233
 v_cvt_pk_bf16_f32 v141,v234,v235
 v_mfma_f32_16x16x32_bf16 a[104:107],v[36:39],v[88:91],a[104:107]
 v_cvt_pk_bf16_f32 v142,v244,v245
 v_cvt_pk_bf16_f32 v143,v246,v247
 v_mfma_f32_16x16x32_bf16 a[108:111],v[36:39],v[92:95],0
 s_add_u32 s47,s46,593920
 buffer_store_dwordx4 v[140:143],v4,s[4:7],s47 offen sc1
 v_accvgpr_read_b32 v224,a160
 v_accvgpr_read_b32 v225,a161
 v_mfma_f32_16x16x32_bf16 a[108:111],v[32:35],v[76:79],a[108:111]
 s_waitcnt lgkmcnt(4)
 v_accvgpr_read_b32 v226,a162
 v_accvgpr_read_b32 v227,a163
 v_mfma_f32_16x16x32_bf16 a[112:115],v[40:43],v[64:67],0
 ds_read_b64_tr_b16 v[24:25],v237
 ds_read_b64_tr_b16 v[26:27],v237 offset:6144
 v_mfma_f32_16x16x32_bf16 a[112:115],v[44:47],v[80:83],a[112:115]
 v_accvgpr_read_b32 v228,a176
 v_accvgpr_read_b32 v229,a177
 v_mfma_f32_16x16x32_bf16 a[116:119],v[44:47],v[84:87],0
 ds_read_b64_tr_b16 v[28:29],v237 offset:12288
 ds_read_b64_tr_b16 v[30:31],v237 offset:18432
 v_mfma_f32_16x16x32_bf16 a[116:119],v[40:43],v[68:71],a[116:119]
 v_accvgpr_read_b32 v230,a178
 v_accvgpr_read_b32 v231,a179
 v_mfma_f32_16x16x32_bf16 a[120:123],v[40:43],v[72:75],0
 v_mul_f32 v224,v224,v10
 v_mul_f32 v225,v225,v10
 v_mfma_f32_16x16x32_bf16 a[120:123],v[44:47],v[88:91],a[120:123]
 v_mul_f32 v226,v226,v10
 v_mul_f32 v227,v227,v10
 v_mfma_f32_16x16x32_bf16 a[124:127],v[44:47],v[92:95],0
 v_mul_f32 v228,v228,v10
 v_mul_f32 v229,v229,v10
 v_mfma_f32_16x16x32_bf16 a[124:127],v[40:43],v[76:79],a[124:127]
 s_waitcnt lgkmcnt(4)
 v_mul_f32 v230,v230,v10
 v_mul_f32 v231,v231,v10
 v_mfma_f32_16x16x32_bf16 a[0:3],v[16:19],v[96:99],a[0:3]
 v_cvt_pk_bf16_f32 v144,v224,v225
 v_cvt_pk_bf16_f32 v145,v226,v227
 v_mfma_f32_16x16x32_bf16 a[0:3],v[20:23],v[112:115],a[0:3]
 ds_read_b64_tr_b16 v[32:33],v238
 ds_read_b64_tr_b16 v[34:35],v238 offset:6144
 v_mfma_f32_16x16x32_bf16 a[4:7],v[20:23],v[116:119],a[4:7]
 v_cvt_pk_bf16_f32 v146,v228,v229
 v_cvt_pk_bf16_f32 v147,v230,v231
 v_mfma_f32_16x16x32_bf16 a[4:7],v[16:19],v[100:103],a[4:7]
 s_add_u32 s47,s46,4096
 buffer_store_dwordx4 v[144:147],v4,s[4:7],s47 offen offset:1024 sc1
 v_accvgpr_read_b32 v232,a164
 v_accvgpr_read_b32 v233,a165
 v_mfma_f32_16x16x32_bf16 a[8:11],v[16:19],v[104:107],a[8:11]
 ds_read_b64_tr_b16 v[36:37],v238 offset:12288
 ds_read_b64_tr_b16 v[38:39],v238 offset:18432
 v_mfma_f32_16x16x32_bf16 a[8:11],v[20:23],v[120:123],a[8:11]
 v_accvgpr_read_b32 v234,a166
 v_accvgpr_read_b32 v235,a167
 v_mfma_f32_16x16x32_bf16 a[12:15],v[20:23],v[124:127],a[12:15]
 v_accvgpr_read_b32 v244,a180
 v_accvgpr_read_b32 v245,a181
 v_mfma_f32_16x16x32_bf16 a[12:15],v[16:19],v[108:111],a[12:15]
 s_waitcnt lgkmcnt(4)
 v_accvgpr_read_b32 v246,a182
 v_accvgpr_read_b32 v247,a183
 v_mfma_f32_16x16x32_bf16 a[16:19],v[24:27],v[96:99],a[16:19]
 ds_read_b64_tr_b16 v[40:41],v239
 ds_read_b64_tr_b16 v[42:43],v239 offset:6144
 v_mfma_f32_16x16x32_bf16 a[16:19],v[28:31],v[112:115],a[16:19]
 v_mul_f32 v232,v232,v11
 v_mul_f32 v233,v233,v11
 v_mfma_f32_16x16x32_bf16 a[20:23],v[28:31],v[116:119],a[20:23]
 v_mul_f32 v234,v234,v11
 v_mul_f32 v235,v235,v11
 v_mfma_f32_16x16x32_bf16 a[20:23],v[24:27],v[100:103],a[20:23]
 ds_read_b64_tr_b16 v[44:45],v239 offset:12288
 ds_read_b64_tr_b16 v[46:47],v239 offset:18432
 v_mfma_f32_16x16x32_bf16 a[24:27],v[24:27],v[104:107],a[24:27]
 v_mul_f32 v244,v244,v11
 v_mul_f32 v245,v245,v11
 v_mfma_f32_16x16x32_bf16 a[24:27],v[28:31],v[120:123],a[24:27]
 v_mul_f32 v246,v246,v11
 v_mul_f32 v247,v247,v11
 v_mfma_f32_16x16x32_bf16 a[28:31],v[28:31],v[124:127],a[28:31]
 v_cvt_pk_bf16_f32 v148,v232,v233
 v_cvt_pk_bf16_f32 v149,v234,v235
 v_mfma_f32_16x16x32_bf16 a[28:31],v[24:27],v[108:111],a[28:31]
 s_waitcnt lgkmcnt(4)
 v_cvt_pk_bf16_f32 v150,v244,v245
 v_cvt_pk_bf16_f32 v151,v246,v247
 v_mfma_f32_16x16x32_bf16 a[32:35],v[32:35],v[96:99],a[32:35]
 s_add_u32 s47,s46,200704
 buffer_store_dwordx4 v[148:151],v4,s[4:7],s47 offen offset:1024 sc1
 ds_read_b64_tr_b16 v[16:17],v236 offset:128
 ds_read_b64_tr_b16 v[18:19],v236 offset:6272
 v_mfma_f32_16x16x32_bf16 a[32:35],v[36:39],v[112:115],a[32:35]
 v_accvgpr_read_b32 v224,a168
 v_accvgpr_read_b32 v225,a169
 v_mfma_f32_16x16x32_bf16 a[36:39],v[36:39],v[116:119],a[36:39]
 v_accvgpr_read_b32 v226,a170
 v_accvgpr_read_b32 v227,a171
 v_mfma_f32_16x16x32_bf16 a[36:39],v[32:35],v[100:103],a[36:39]
 ds_read_b64_tr_b16 v[20:21],v236 offset:12416
 ds_read_b64_tr_b16 v[22:23],v236 offset:18560
 v_mfma_f32_16x16x32_bf16 a[40:43],v[32:35],v[104:107],a[40:43]
 v_accvgpr_read_b32 v228,a184
 v_accvgpr_read_b32 v229,a185
 v_mfma_f32_16x16x32_bf16 a[40:43],v[36:39],v[120:123],a[40:43]
 v_accvgpr_read_b32 v230,a186
 v_accvgpr_read_b32 v231,a187
 v_mfma_f32_16x16x32_bf16 a[44:47],v[36:39],v[124:127],a[44:47]
 v_mul_f32 v224,v224,v12
 v_mul_f32 v225,v225,v12
 v_mfma_f32_16x16x32_bf16 a[44:47],v[32:35],v[108:111],a[44:47]
 s_waitcnt lgkmcnt(4)
 v_mul_f32 v226,v226,v12
 v_mul_f32 v227,v227,v12
 v_mfma_f32_16x16x32_bf16 a[48:51],v[40:43],v[96:99],a[48:51]
 ds_read_b64_tr_b16 v[24:25],v237 offset:128
 ds_read_b64_tr_b16 v[26:27],v237 offset:6272
 v_mfma_f32_16x16x32_bf16 a[48:51],v[44:47],v[112:115],a[48:51]
 v_mul_f32 v228,v228,v12
 v_mul_f32 v229,v229,v12
 v_mfma_f32_16x16x32_bf16 a[52:55],v[44:47],v[116:119],a[52:55]
 v_mul_f32 v230,v230,v12
 v_mul_f32 v231,v231,v12
 v_mfma_f32_16x16x32_bf16 a[52:55],v[40:43],v[100:103],a[52:55]
 ds_read_b64_tr_b16 v[28:29],v237 offset:12416
 ds_read_b64_tr_b16 v[30:31],v237 offset:18560
 v_mfma_f32_16x16x32_bf16 a[56:59],v[40:43],v[104:107],a[56:59]
 v_cvt_pk_bf16_f32 v152,v224,v225
 v_cvt_pk_bf16_f32 v153,v226,v227
 v_mfma_f32_16x16x32_bf16 a[56:59],v[44:47],v[120:123],a[56:59]
 v_cvt_pk_bf16_f32 v154,v228,v229
 v_cvt_pk_bf16_f32 v155,v230,v231
 v_mfma_f32_16x16x32_bf16 a[60:63],v[44:47],v[124:127],a[60:63]
 s_add_u32 s47,s46,397312
 buffer_store_dwordx4 v[152:155],v4,s[4:7],s47 offen offset:1024 sc1
 v_accvgpr_read_b32 v232,a172
 v_accvgpr_read_b32 v233,a173
 v_mfma_f32_16x16x32_bf16 a[60:63],v[40:43],v[108:111],a[60:63]
 s_waitcnt lgkmcnt(4)
 v_accvgpr_read_b32 v234,a174
 v_accvgpr_read_b32 v235,a175
 v_mfma_f32_16x16x32_bf16 a[64:67],v[16:19],v[96:99],a[64:67]
 ds_read_b64_tr_b16 v[32:33],v238 offset:128
 ds_read_b64_tr_b16 v[34:35],v238 offset:6272
 v_mfma_f32_16x16x32_bf16 a[64:67],v[20:23],v[112:115],a[64:67]
 v_accvgpr_read_b32 v244,a188
 v_accvgpr_read_b32 v245,a189
 v_mfma_f32_16x16x32_bf16 a[68:71],v[20:23],v[116:119],a[68:71]
 v_accvgpr_read_b32 v246,a190
 v_accvgpr_read_b32 v247,a191
 v_mfma_f32_16x16x32_bf16 a[68:71],v[16:19],v[100:103],a[68:71]
 ds_read_b64_tr_b16 v[36:37],v238 offset:12416
 ds_read_b64_tr_b16 v[38:39],v238 offset:18560
 v_mfma_f32_16x16x32_bf16 a[72:75],v[16:19],v[104:107],a[72:75]
 v_mul_f32 v232,v232,v13
 v_mul_f32 v233,v233,v13
 v_mfma_f32_16x16x32_bf16 a[72:75],v[20:23],v[120:123],a[72:75]
 v_mul_f32 v234,v234,v13
 v_mul_f32 v235,v235,v13
 v_mfma_f32_16x16x32_bf16 a[76:79],v[20:23],v[124:127],a[76:79]
 v_mul_f32 v244,v244,v13
 v_mul_f32 v245,v245,v13
 v_mfma_f32_16x16x32_bf16 a[76:79],v[16:19],v[108:111],a[76:79]
 s_waitcnt lgkmcnt(4)
 v_mul_f32 v246,v246,v13
 v_mul_f32 v247,v247,v13
 v_mfma_f32_16x16x32_bf16 a[80:83],v[24:27],v[96:99],a[80:83]
 ds_read_b64_tr_b16 v[40:41],v239 offset:128
 ds_read_b64_tr_b16 v[42:43],v239 offset:6272
 v_mfma_f32_16x16x32_bf16 a[80:83],v[28:31],v[112:115],a[80:83]
 v_cvt_pk_bf16_f32 v156,v232,v233
 v_cvt_pk_bf16_f32 v157,v234,v235
 v_mfma_f32_16x16x32_bf16 a[84:87],v[28:31],v[116:119],a[84:87]
 v_cvt_pk_bf16_f32 v158,v244,v245
 v_cvt_pk_bf16_f32 v159,v246,v247
 v_mfma_f32_16x16x32_bf16 a[84:87],v[24:27],v[100:103],a[84:87]
 s_add_u32 s47,s46,593920
 buffer_store_dwordx4 v[156:159],v4,s[4:7],s47 offen offset:1024 sc1
 ds_read_b64_tr_b16 v[44:45],v239 offset:12416
 ds_read_b64_tr_b16 v[46:47],v239 offset:18560
 v_mfma_f32_16x16x32_bf16 a[88:91],v[24:27],v[104:107],a[88:91]
 v_and_b32 v12,3,v0
 v_lshlrev_b32 v12,2,v12
 v_mfma_f32_16x16x32_bf16 a[88:91],v[28:31],v[120:123],a[88:91]
 s_lshl_b32 s42,s34,7
 s_lshl_b32 s41,s52,4
 v_mfma_f32_16x16x32_bf16 a[92:95],v[28:31],v[124:127],a[92:95]
 s_add_u32 s42,s42,s41
 s_add_u32 s42,s42,3072
 v_add_u32 v12,s42,v12
 v_mfma_f32_16x16x32_bf16 a[92:95],v[24:27],v[108:111],a[92:95]
 s_waitcnt lgkmcnt(4)
 s_and_b32 s60,s52,1
 s_lshl_b32 s42,s53,1
 v_mfma_f32_16x16x32_bf16 a[96:99],v[32:35],v[96:99],a[96:99]
 ds_read_b64_tr_b16 v[16:17],v240 offset:256
 ds_read_b64_tr_b16 v[18:19],v240 offset:6400
 v_mfma_f32_16x16x32_bf16 a[96:99],v[36:39],v[112:115],a[96:99]
 s_add_u32 s60,s60,s42
 s_mul_i32 s41,s60,245760
 s_add_u32 s41,s41,s55
 v_mfma_f32_16x16x32_bf16 a[100:103],v[36:39],v[116:119],a[100:103]
 s_add_u32 s41,s41,6537216
 s_add_u32 s24,s88,s41
 s_addc_u32 s25,s89,0
 v_mfma_f32_16x16x32_bf16 a[100:103],v[32:35],v[100:103],a[100:103]
 ds_read_b64_tr_b16 v[20:21],v240 offset:12544
 ds_read_b64_tr_b16 v[22:23],v240 offset:18688
 v_mfma_f32_16x16x32_bf16 a[104:107],v[32:35],v[104:107],a[104:107]
 s_sub_u32 s26,245760,s55
 s_mov_b32 s27,0x20000
 v_mfma_f32_16x16x32_bf16 a[104:107],v[36:39],v[120:123],a[104:107]
 s_mul_i32 s63,s34,3
 s_lshr_b32 s63,s63,1
 v_mfma_f32_16x16x32_bf16 a[108:111],v[36:39],v[124:127],a[108:111]
 s_mul_i32 s41,s53,3
 s_add_u32 s63,s63,s41
 v_mfma_f32_16x16x32_bf16 a[108:111],v[32:35],v[108:111],a[108:111]
 s_waitcnt lgkmcnt(4)
 v_mfma_f32_16x16x32_bf16 a[112:115],v[40:43],v[96:99],a[112:115]
 ds_read_b64_tr_b16 v[24:25],v241 offset:256
 ds_read_b64_tr_b16 v[26:27],v241 offset:6400
 v_mfma_f32_16x16x32_bf16 a[112:115],v[44:47],v[112:115],a[112:115]
 s_cmp_ge_u32 s63,12
 s_cselect_b32 s41,12,0
 s_sub_u32 s63,s63,s41
 v_mfma_f32_16x16x32_bf16 a[116:119],v[44:47],v[116:119],a[116:119]
 s_lshl_b32 s76,s63,12
 s_mul_i32 s63,s63,20480
 v_mfma_f32_16x16x32_bf16 a[116:119],v[40:43],v[100:103],a[116:119]
 ds_read_b64_tr_b16 v[28:29],v241 offset:12544
 ds_read_b64_tr_b16 v[30:31],v241 offset:18688
 v_mfma_f32_16x16x32_bf16 a[120:123],v[40:43],v[104:107],a[120:123]
 s_lshl_b32 s71,s34,2
 s_lshr_b32 s41,s52,1
 s_add_u32 s71,s71,s41
 v_mfma_f32_16x16x32_bf16 a[120:123],v[44:47],v[120:123],a[120:123]
 s_lshl_b32 s71,s71,2
 s_mul_i32 s36,s71,48
 s_add_u32 s71,s71,s32
 v_mfma_f32_16x16x32_bf16 a[124:127],v[44:47],v[124:127],a[124:127]
 s_add_u32 s36,s36,s32
 s_lshl_b32 s36,s36,10
 s_add_u32 s36,s36,8503296
 v_mfma_f32_16x16x32_bf16 a[124:127],v[40:43],v[108:111],a[124:127]
 s_waitcnt lgkmcnt(4)
 s_lshl_b32 s38,s34,2
 s_add_u32 s38,s38,s53
 v_mfma_f32_16x16x32_bf16 a[128:131],v[16:19],v[64:67],0
 ds_read_b64_tr_b16 v[32:33],v236 offset:256
 ds_read_b64_tr_b16 v[34:35],v236 offset:6400
 v_mfma_f32_16x16x32_bf16 a[128:131],v[20:23],v[80:83],a[128:131]
 s_lshl_b32 s38,s38,3
 s_lshl_b32 s41,s32,1
 s_add_u32 s41,s41,s38
 v_mfma_f32_16x16x32_bf16 a[132:135],v[20:23],v[84:87],0
 s_lshl_b32 s41,s41,3
 s_add_u32 s41,s41,s52
 s_mul_i32 s37,s41,10240
 v_mfma_f32_16x16x32_bf16 a[132:135],v[16:19],v[68:71],a[132:135]
 ds_read_b64_tr_b16 v[36:37],v236 offset:12544
 ds_read_b64_tr_b16 v[38:39],v236 offset:18688
 v_mfma_f32_16x16x32_bf16 a[136:139],v[16:19],v[72:75],0
 s_add_u32 s37,s37,39960576
 s_add_u32 s72,s32,0
 s_and_b32 s72,s72,3
 v_mfma_f32_16x16x32_bf16 a[136:139],v[20:23],v[88:91],a[136:139]
 s_waitcnt vmcnt(0)
 s_barrier
 s_cmp_lg_u32 s32,0
 s_cbranch_scc1 Lf24
 v_mov_b32 v14,s51
 s_mov_b64 exec,1
 s_add_u32 s91,s90,3072
 buffer_store_dword v14,off,s[92:95],s91 sc1
 s_mov_b64 exec,-1
Lf24:
 v_mfma_f32_16x16x32_bf16 a[140:143],v[20:23],v[92:95],0
 s_mul_i32 s72,s72,49152
 s_add_u32 s72,s72,s36
 v_mfma_f32_16x16x32_bf16 a[140:143],v[16:19],v[76:79],a[140:143]
 s_waitcnt lgkmcnt(4)
 s_add_u32 s73,s32,1
 s_and_b32 s73,s73,3
 v_mfma_f32_16x16x32_bf16 a[144:147],v[24:27],v[64:67],0
 ds_read_b64_tr_b16 v[40:41],v237 offset:256
 ds_read_b64_tr_b16 v[42:43],v237 offset:6400
 v_mfma_f32_16x16x32_bf16 a[144:147],v[28:31],v[80:83],a[144:147]
 s_mul_i32 s73,s73,49152
 s_add_u32 s73,s73,s36
 v_mfma_f32_16x16x32_bf16 a[148:151],v[28:31],v[84:87],0
 ds_read_b64_tr_b16 v[44:45],v237 offset:12544
 ds_read_b64_tr_b16 v[46:47],v237 offset:18688
 v_mfma_f32_16x16x32_bf16 a[148:151],v[24:27],v[68:71],a[148:151]
 v_add_u32 v236,49152,v236
 v_add_u32 v237,49152,v237
 v_mfma_f32_16x16x32_bf16 a[152:155],v[24:27],v[72:75],0
 v_add_u32 v238,49152,v238
 v_add_u32 v239,49152,v239
 v_mfma_f32_16x16x32_bf16 a[152:155],v[28:31],v[88:91],a[152:155]
 s_add_u32 s78,s32,2
 s_and_b32 s78,s78,3
 v_mfma_f32_16x16x32_bf16 a[156:159],v[28:31],v[92:95],0
 s_mul_i32 s78,s78,49152
 s_add_u32 s78,s78,s36
 v_mfma_f32_16x16x32_bf16 a[156:159],v[24:27],v[76:79],a[156:159]
 s_waitcnt lgkmcnt(4)
 s_add_u32 s79,s32,3
 s_and_b32 s79,s79,3
 v_mfma_f32_16x16x32_bf16 a[128:131],v[32:35],v[96:99],a[128:131]
 s_waitcnt vmcnt(36)
 s_barrier
 v_mfma_f32_16x16x32_bf16 a[128:131],v[36:39],v[112:115],a[128:131]
 ds_read_b64_tr_b16 v[16:17],v236
 ds_read_b64_tr_b16 v[18:19],v236 offset:6144
 v_mfma_f32_16x16x32_bf16 a[132:135],v[36:39],v[116:119],a[132:135]
 s_mul_i32 s79,s79,49152
 s_add_u32 s79,s79,s36
 v_mfma_f32_16x16x32_bf16 a[132:135],v[32:35],v[100:103],a[132:135]
 v_mfma_f32_16x16x32_bf16 a[136:139],v[32:35],v[104:107],a[136:139]
 ds_read_b64_tr_b16 v[20:21],v236 offset:12288
 ds_read_b64_tr_b16 v[22:23],v236 offset:18432
 v_mfma_f32_16x16x32_bf16 a[136:139],v[36:39],v[120:123],a[136:139]
 v_mfma_f32_16x16x32_bf16 a[140:143],v[36:39],v[124:127],a[140:143]
 v_mfma_f32_16x16x32_bf16 a[140:143],v[32:35],v[108:111],a[140:143]
 s_waitcnt lgkmcnt(4)
 v_mfma_f32_16x16x32_bf16 a[144:147],v[40:43],v[96:99],a[144:147]
 ds_read_b64_tr_b16 v[24:25],v237
 ds_read_b64_tr_b16 v[26:27],v237 offset:6144
 v_mfma_f32_16x16x32_bf16 a[144:147],v[44:47],v[112:115],a[144:147]
 v_mfma_f32_16x16x32_bf16 a[148:151],v[44:47],v[116:119],a[148:151]
 v_mfma_f32_16x16x32_bf16 a[148:151],v[40:43],v[100:103],a[148:151]
 ds_read_b64_tr_b16 v[28:29],v237 offset:12288
 ds_read_b64_tr_b16 v[30:31],v237 offset:18432
 v_mfma_f32_16x16x32_bf16 a[152:155],v[40:43],v[104:107],a[152:155]
 v_mfma_f32_16x16x32_bf16 a[152:155],v[44:47],v[120:123],a[152:155]
 v_mfma_f32_16x16x32_bf16 a[156:159],v[44:47],v[124:127],a[156:159]
 v_mfma_f32_16x16x32_bf16 a[156:159],v[40:43],v[108:111],a[156:159]
 s_waitcnt lgkmcnt(4)
 v_mfma_f32_16x16x32_bf16 a[0:3],v[16:19],v[128:131],a[0:3]
 ds_read_b64_tr_b16 v[32:33],v238
 ds_read_b64_tr_b16 v[34:35],v238 offset:6144
 v_mfma_f32_16x16x32_bf16 a[0:3],v[20:23],v[144:147],a[0:3]
 v_mfma_f32_16x16x32_bf16 a[4:7],v[20:23],v[148:151],a[4:7]
 v_mfma_f32_16x16x32_bf16 a[4:7],v[16:19],v[132:135],a[4:7]
 ds_read_b64_tr_b16 v[36:37],v238 offset:12288
 ds_read_b64_tr_b16 v[38:39],v238 offset:18432
 v_mfma_f32_16x16x32_bf16 a[8:11],v[16:19],v[136:139],a[8:11]
 v_mfma_f32_16x16x32_bf16 a[8:11],v[20:23],v[152:155],a[8:11]
 buffer_load_dword v13,v12,s[92:95],0 offen sc1
 v_mfma_f32_16x16x32_bf16 a[12:15],v[20:23],v[156:159],a[12:15]
 v_mfma_f32_16x16x32_bf16 a[12:15],v[16:19],v[140:143],a[12:15]
 s_waitcnt lgkmcnt(4)
 v_mfma_f32_16x16x32_bf16 a[16:19],v[24:27],v[128:131],a[16:19]
 ds_read_b64_tr_b16 v[40:41],v239
 ds_read_b64_tr_b16 v[42:43],v239 offset:6144
 v_mfma_f32_16x16x32_bf16 a[16:19],v[28:31],v[144:147],a[16:19]
 v_mfma_f32_16x16x32_bf16 a[20:23],v[28:31],v[148:151],a[20:23]
 v_mfma_f32_16x16x32_bf16 a[20:23],v[24:27],v[132:135],a[20:23]
 ds_read_b64_tr_b16 v[44:45],v239 offset:12288
 ds_read_b64_tr_b16 v[46:47],v239 offset:18432
 v_mfma_f32_16x16x32_bf16 a[24:27],v[24:27],v[136:139],a[24:27]
 v_mfma_f32_16x16x32_bf16 a[24:27],v[28:31],v[152:155],a[24:27]
 v_mfma_f32_16x16x32_bf16 a[28:31],v[28:31],v[156:159],a[28:31]
 v_mfma_f32_16x16x32_bf16 a[28:31],v[24:27],v[140:143],a[28:31]
 s_waitcnt lgkmcnt(4)
 v_mfma_f32_16x16x32_bf16 a[32:35],v[32:35],v[128:131],a[32:35]
 ds_read_b64_tr_b16 v[16:17],v236 offset:128
 ds_read_b64_tr_b16 v[18:19],v236 offset:6272
 v_mfma_f32_16x16x32_bf16 a[32:35],v[36:39],v[144:147],a[32:35]
 v_mfma_f32_16x16x32_bf16 a[36:39],v[36:39],v[148:151],a[36:39]
 v_mfma_f32_16x16x32_bf16 a[36:39],v[32:35],v[132:135],a[36:39]
 ds_read_b64_tr_b16 v[20:21],v236 offset:12416
 ds_read_b64_tr_b16 v[22:23],v236 offset:18560
 v_mfma_f32_16x16x32_bf16 a[40:43],v[32:35],v[136:139],a[40:43]
 v_mfma_f32_16x16x32_bf16 a[40:43],v[36:39],v[152:155],a[40:43]
 v_mfma_f32_16x16x32_bf16 a[44:47],v[36:39],v[156:159],a[44:47]
 v_mfma_f32_16x16x32_bf16 a[44:47],v[32:35],v[140:143],a[44:47]
 s_waitcnt lgkmcnt(4)
 v_mfma_f32_16x16x32_bf16 a[48:51],v[40:43],v[128:131],a[48:51]
 ds_read_b64_tr_b16 v[24:25],v237 offset:128
 ds_read_b64_tr_b16 v[26:27],v237 offset:6272
 v_mfma_f32_16x16x32_bf16 a[48:51],v[44:47],v[144:147],a[48:51]
 v_mfma_f32_16x16x32_bf16 a[52:55],v[44:47],v[148:151],a[52:55]
 v_mfma_f32_16x16x32_bf16 a[52:55],v[40:43],v[132:135],a[52:55]
 ds_read_b64_tr_b16 v[28:29],v237 offset:12416
 ds_read_b64_tr_b16 v[30:31],v237 offset:18560
 v_mfma_f32_16x16x32_bf16 a[56:59],v[40:43],v[136:139],a[56:59]
 v_mfma_f32_16x16x32_bf16 a[56:59],v[44:47],v[152:155],a[56:59]
 v_mfma_f32_16x16x32_bf16 a[60:63],v[44:47],v[156:159],a[60:63]
 v_mfma_f32_16x16x32_bf16 a[60:63],v[40:43],v[140:143],a[60:63]
 s_waitcnt lgkmcnt(4)
 v_mfma_f32_16x16x32_bf16 a[64:67],v[16:19],v[128:131],a[64:67]
 ds_read_b64_tr_b16 v[32:33],v238 offset:128
 ds_read_b64_tr_b16 v[34:35],v238 offset:6272
 v_mfma_f32_16x16x32_bf16 a[64:67],v[20:23],v[144:147],a[64:67]
 v_mfma_f32_16x16x32_bf16 a[68:71],v[20:23],v[148:151],a[68:71]
 v_mfma_f32_16x16x32_bf16 a[68:71],v[16:19],v[132:135],a[68:71]
 ds_read_b64_tr_b16 v[36:37],v238 offset:12416
 ds_read_b64_tr_b16 v[38:39],v238 offset:18560
 v_mfma_f32_16x16x32_bf16 a[72:75],v[16:19],v[136:139],a[72:75]
 v_mfma_f32_16x16x32_bf16 a[72:75],v[20:23],v[152:155],a[72:75]
 v_mfma_f32_16x16x32_bf16 a[76:79],v[20:23],v[156:159],a[76:79]
 v_mfma_f32_16x16x32_bf16 a[76:79],v[16:19],v[140:143],a[76:79]
 s_waitcnt lgkmcnt(4)
 v_mfma_f32_16x16x32_bf16 a[80:83],v[24:27],v[128:131],a[80:83]
 ds_read_b64_tr_b16 v[40:41],v239 offset:128
 ds_read_b64_tr_b16 v[42:43],v239 offset:6272
 v_mfma_f32_16x16x32_bf16 a[80:83],v[28:31],v[144:147],a[80:83]
 v_mfma_f32_16x16x32_bf16 a[84:87],v[28:31],v[148:151],a[84:87]
 v_mfma_f32_16x16x32_bf16 a[84:87],v[24:27],v[132:135],a[84:87]
 ds_read_b64_tr_b16 v[44:45],v239 offset:12416
 ds_read_b64_tr_b16 v[46:47],v239 offset:18560
 v_mfma_f32_16x16x32_bf16 a[88:91],v[24:27],v[136:139],a[88:91]
 v_mfma_f32_16x16x32_bf16 a[88:91],v[28:31],v[152:155],a[88:91]
 s_waitcnt vmcnt(0)
 v_cmp_ne_u32 vcc,s51,v13
 s_nop 1
 s_cbranch_vccnz Lp25_spin
Lp25_ok:
 s_cmp_le_u32 s53,0
 s_cselect_b32 s74,1,0
 s_mul_i32 s74,s74,6144
 s_add_u32 s75,s74,0
 buffer_load_dwordx4 a[192:195],v4,s[4:7],s75 offen sc1
 buffer_load_dwordx4 a[208:211],v4,s[4:7],s75 offen offset:1024 sc1
 s_add_u32 s75,s74,196608
 buffer_load_dwordx4 a[196:199],v4,s[4:7],s75 offen sc1
 v_mfma_f32_16x16x32_bf16 a[92:95],v[28:31],v[156:159],a[92:95]
 buffer_load_dwordx4 a[212:215],v4,s[4:7],s75 offen offset:1024 sc1
 v_mfma_f32_16x16x32_bf16 a[92:95],v[24:27],v[140:143],a[92:95]
 s_waitcnt lgkmcnt(4)
 v_mfma_f32_16x16x32_bf16 a[96:99],v[32:35],v[128:131],a[96:99]
 s_add_u32 s75,s74,393216
 ds_read_b64_tr_b16 v[16:17],v236 offset:256
 ds_read_b64_tr_b16 v[18:19],v236 offset:6400
 v_mfma_f32_16x16x32_bf16 a[96:99],v[36:39],v[144:147],a[96:99]
 buffer_load_dwordx4 a[200:203],v4,s[4:7],s75 offen sc1
 v_mfma_f32_16x16x32_bf16 a[100:103],v[36:39],v[148:151],a[100:103]
 buffer_load_dwordx4 a[216:219],v4,s[4:7],s75 offen offset:1024 sc1
 v_mfma_f32_16x16x32_bf16 a[100:103],v[32:35],v[132:135],a[100:103]
 s_add_u32 s75,s74,589824
 ds_read_b64_tr_b16 v[20:21],v236 offset:12544
 ds_read_b64_tr_b16 v[22:23],v236 offset:18688
 v_mfma_f32_16x16x32_bf16 a[104:107],v[32:35],v[136:139],a[104:107]
 buffer_load_dwordx4 a[204:207],v4,s[4:7],s75 offen sc1
 v_mfma_f32_16x16x32_bf16 a[104:107],v[36:39],v[152:155],a[104:107]
 buffer_load_dwordx4 a[220:223],v4,s[4:7],s75 offen offset:1024 sc1
 v_mfma_f32_16x16x32_bf16 a[108:111],v[36:39],v[156:159],a[108:111]
 s_add_u32 s75,s74,2048
 buffer_load_dwordx4 a[224:227],v4,s[4:7],s75 offen sc1
 v_mfma_f32_16x16x32_bf16 a[108:111],v[32:35],v[140:143],a[108:111]
 s_waitcnt lgkmcnt(4)
 v_mfma_f32_16x16x32_bf16 a[112:115],v[40:43],v[128:131],a[112:115]
 ds_read_b64_tr_b16 v[24:25],v237 offset:256
 ds_read_b64_tr_b16 v[26:27],v237 offset:6400
 v_mfma_f32_16x16x32_bf16 a[112:115],v[44:47],v[144:147],a[112:115]
 v_mfma_f32_16x16x32_bf16 a[116:119],v[44:47],v[148:151],a[116:119]
 ds_read_b64_tr_b16 v[28:29],v237 offset:12544
 ds_read_b64_tr_b16 v[30:31],v237 offset:18688
 v_mfma_f32_16x16x32_bf16 a[116:119],v[40:43],v[132:135],a[116:119]
 v_add_u32 v236,4294942720,v236
 v_add_u32 v237,4294942720,v237
 v_mfma_f32_16x16x32_bf16 a[120:123],v[40:43],v[136:139],a[120:123]
 v_add_u32 v238,4294942720,v238
 v_add_u32 v239,4294942720,v239
 v_mfma_f32_16x16x32_bf16 a[120:123],v[44:47],v[152:155],a[120:123]
 buffer_load_dwordx4 a[240:243],v4,s[4:7],s75 offen offset:1024 sc1
 v_mfma_f32_16x16x32_bf16 a[124:127],v[44:47],v[156:159],a[124:127]
 v_mfma_f32_16x16x32_bf16 a[124:127],v[40:43],v[140:143],a[124:127]
 s_waitcnt lgkmcnt(4)
 v_mfma_f32_16x16x32_bf16 a[128:131],v[16:19],v[128:131],a[128:131]
 s_barrier
 v_mfma_f32_16x16x32_bf16 a[128:131],v[20:23],v[144:147],a[128:131]
 s_add_u32 s75,s74,198656
 ds_read_b64_tr_b16 v[32:33],v236
 ds_read_b64_tr_b16 v[34:35],v236 offset:6144
 v_mfma_f32_16x16x32_bf16 a[132:135],v[20:23],v[148:151],a[132:135]
 buffer_load_dwordx4 a[228:231],v4,s[4:7],s75 offen sc1
 s_cmp_le_u32 s53,1
 s_cselect_b32 s39,2,1
 v_mfma_f32_16x16x32_bf16 a[132:135],v[16:19],v[132:135],a[132:135]
 s_add_u32 m0,s35,122880
 s_mul_i32 s39,s39,245760
 buffer_load_dwordx4 v1,s[12:15],s39 offen lds
 v_mfma_f32_16x16x32_bf16 a[136:139],v[16:19],v[136:139],a[136:139]
 ds_read_b64_tr_b16 v[36:37],v236 offset:12288
 ds_read_b64_tr_b16 v[38:39],v236 offset:18432
 v_mfma_f32_16x16x32_bf16 a[136:139],v[20:23],v[152:155],a[136:139]
 v_mfma_f32_16x16x32_bf16 a[140:143],v[20:23],v[156:159],a[140:143]
 buffer_load_dwordx4 v2,s[12:15],s39 offen offset:1024 lds
 v_mfma_f32_16x16x32_bf16 a[140:143],v[16:19],v[140:143],a[140:143]
 s_waitcnt lgkmcnt(4)
 v_mfma_f32_16x16x32_bf16 a[144:147],v[24:27],v[128:131],a[144:147]
 ds_read_b64_tr_b16 v[40:41],v237
 ds_read_b64_tr_b16 v[42:43],v237 offset:6144
 v_mfma_f32_16x16x32_bf16 a[144:147],v[28:31],v[144:147],a[144:147]
 buffer_load_dwordx4 a[244:247],v4,s[4:7],s75 offen offset:1024 sc1
 v_mfma_f32_16x16x32_bf16 a[148:151],v[28:31],v[148:151],a[148:151]
 v_mfma_f32_16x16x32_bf16 a[148:151],v[24:27],v[132:135],a[148:151]
 ds_read_b64_tr_b16 v[44:45],v237 offset:12288
 ds_read_b64_tr_b16 v[46:47],v237 offset:18432
 v_mfma_f32_16x16x32_bf16 a[152:155],v[24:27],v[136:139],a[152:155]
 buffer_load_dwordx4 v3,s[12:15],s39 offen offset:2048 lds
 s_add_u32 s75,s74,395264
 v_mfma_f32_16x16x32_bf16 a[152:155],v[28:31],v[152:155],a[152:155]
 buffer_load_dwordx4 a[232:235],v4,s[4:7],s75 offen sc1
 v_mfma_f32_16x16x32_bf16 a[156:159],v[28:31],v[156:159],a[156:159]
 v_mfma_f32_16x16x32_bf16 a[156:159],v[24:27],v[140:143],a[156:159]
 s_waitcnt vmcnt(8) lgkmcnt(4)
 v_mfma_f32_16x16x32_bf16 a[0:3],v[32:35],a[192:195],a[0:3]
 ds_read_b64_tr_b16 v[16:17],v238
 ds_read_b64_tr_b16 v[18:19],v238 offset:6144
 v_mfma_f32_16x16x32_bf16 a[0:3],v[36:39],a[208:211],a[0:3]
 v_mfma_f32_16x16x32_bf16 a[4:7],v[36:39],a[212:215],a[4:7]
 v_mfma_f32_16x16x32_bf16 a[4:7],v[32:35],a[196:199],a[4:7]
 ds_read_b64_tr_b16 v[20:21],v238 offset:12288
 ds_read_b64_tr_b16 v[22:23],v238 offset:18432
 v_mfma_f32_16x16x32_bf16 a[8:11],v[32:35],a[200:203],a[8:11]
 s_add_u32 m0,s35,125952
 s_add_u32 s44,s39,10240
 buffer_load_dwordx4 v1,s[12:15],s44 offen lds
 v_mfma_f32_16x16x32_bf16 a[8:11],v[36:39],a[216:219],a[8:11]
 buffer_load_dwordx4 a[248:251],v4,s[4:7],s75 offen offset:1024 sc1
 v_mfma_f32_16x16x32_bf16 a[12:15],v[36:39],a[220:223],a[12:15]
 v_mfma_f32_16x16x32_bf16 a[12:15],v[32:35],a[204:207],a[12:15]
 s_waitcnt lgkmcnt(4)
 v_mfma_f32_16x16x32_bf16 a[16:19],v[40:43],a[192:195],a[16:19]
 ds_read_b64_tr_b16 v[24:25],v239
 ds_read_b64_tr_b16 v[26:27],v239 offset:6144
 v_mfma_f32_16x16x32_bf16 a[16:19],v[44:47],a[208:211],a[16:19]
 v_mfma_f32_16x16x32_bf16 a[20:23],v[44:47],a[212:215],a[20:23]
 buffer_load_dwordx4 v2,s[12:15],s44 offen offset:1024 lds
 v_mfma_f32_16x16x32_bf16 a[20:23],v[40:43],a[196:199],a[20:23]
 s_add_u32 s75,s74,591872
 ds_read_b64_tr_b16 v[28:29],v239 offset:12288
 ds_read_b64_tr_b16 v[30:31],v239 offset:18432
 v_mfma_f32_16x16x32_bf16 a[24:27],v[40:43],a[200:203],a[24:27]
 buffer_load_dwordx4 a[236:239],v4,s[4:7],s75 offen sc1
 v_mfma_f32_16x16x32_bf16 a[24:27],v[44:47],a[216:219],a[24:27]
 v_mfma_f32_16x16x32_bf16 a[28:31],v[44:47],a[220:223],a[28:31]
 v_mfma_f32_16x16x32_bf16 a[28:31],v[40:43],a[204:207],a[28:31]
 s_waitcnt lgkmcnt(4)
 v_mfma_f32_16x16x32_bf16 a[32:35],v[16:19],a[192:195],a[32:35]
 ds_read_b64_tr_b16 v[32:33],v236 offset:128
 ds_read_b64_tr_b16 v[34:35],v236 offset:6272
 v_mfma_f32_16x16x32_bf16 a[32:35],v[20:23],a[208:211],a[32:35]
 buffer_load_dwordx4 v3,s[12:15],s44 offen offset:2048 lds
 v_mfma_f32_16x16x32_bf16 a[36:39],v[20:23],a[212:215],a[36:39]
 buffer_load_dwordx4 a[252:255],v4,s[4:7],s75 offen offset:1024 sc1
 v_mfma_f32_16x16x32_bf16 a[36:39],v[16:19],a[196:199],a[36:39]
 ds_read_b64_tr_b16 v[36:37],v236 offset:12416
 ds_read_b64_tr_b16 v[38:39],v236 offset:18560
 v_mfma_f32_16x16x32_bf16 a[40:43],v[16:19],a[200:203],a[40:43]
 v_mfma_f32_16x16x32_bf16 a[40:43],v[20:23],a[216:219],a[40:43]
 v_mfma_f32_16x16x32_bf16 a[44:47],v[20:23],a[220:223],a[44:47]
 v_mfma_f32_16x16x32_bf16 a[44:47],v[16:19],a[204:207],a[44:47]
 s_waitcnt lgkmcnt(4)
 v_mfma_f32_16x16x32_bf16 a[48:51],v[24:27],a[192:195],a[48:51]
 ds_read_b64_tr_b16 v[40:41],v237 offset:128
 ds_read_b64_tr_b16 v[42:43],v237 offset:6272
 v_mfma_f32_16x16x32_bf16 a[48:51],v[28:31],a[208:211],a[48:51]
 s_add_u32 m0,s35,24576
 s_add_u32 s39,s39,81920
 buffer_load_dwordx4 v1,s[12:15],s39 offen lds
 v_mfma_f32_16x16x32_bf16 a[52:55],v[28:31],a[212:215],a[52:55]
 v_mfma_f32_16x16x32_bf16 a[52:55],v[24:27],a[196:199],a[52:55]
 ds_read_b64_tr_b16 v[44:45],v237 offset:12416
 ds_read_b64_tr_b16 v[46:47],v237 offset:18560
 v_mfma_f32_16x16x32_bf16 a[56:59],v[24:27],a[200:203],a[56:59]
 buffer_load_dwordx4 v2,s[12:15],s39 offen offset:1024 lds
 v_mfma_f32_16x16x32_bf16 a[56:59],v[28:31],a[216:219],a[56:59]
 v_mfma_f32_16x16x32_bf16 a[60:63],v[28:31],a[220:223],a[60:63]
 v_mfma_f32_16x16x32_bf16 a[60:63],v[24:27],a[204:207],a[60:63]
 s_waitcnt lgkmcnt(4)
 v_mfma_f32_16x16x32_bf16 a[64:67],v[32:35],a[192:195],a[64:67]
 ds_read_b64_tr_b16 v[16:17],v238 offset:128
 ds_read_b64_tr_b16 v[18:19],v238 offset:6272
 v_mfma_f32_16x16x32_bf16 a[64:67],v[36:39],a[208:211],a[64:67]
 buffer_load_dwordx4 v3,s[12:15],s39 offen offset:2048 lds
 v_mfma_f32_16x16x32_bf16 a[68:71],v[36:39],a[212:215],a[68:71]
 v_mfma_f32_16x16x32_bf16 a[68:71],v[32:35],a[196:199],a[68:71]
 s_add_u32 s75,s74,4096
 ds_read_b64_tr_b16 v[20:21],v238 offset:12416
 ds_read_b64_tr_b16 v[22:23],v238 offset:18560
 v_mfma_f32_16x16x32_bf16 a[72:75],v[32:35],a[200:203],a[72:75]
 buffer_load_dwordx4 a[160:163],v4,s[4:7],s75 offen sc1
 v_mfma_f32_16x16x32_bf16 a[72:75],v[36:39],a[216:219],a[72:75]
 v_mfma_f32_16x16x32_bf16 a[76:79],v[36:39],a[220:223],a[76:79]
 v_mfma_f32_16x16x32_bf16 a[76:79],v[32:35],a[204:207],a[76:79]
 s_waitcnt lgkmcnt(4)
 v_mfma_f32_16x16x32_bf16 a[80:83],v[40:43],a[192:195],a[80:83]
 ds_read_b64_tr_b16 v[24:25],v239 offset:128
 ds_read_b64_tr_b16 v[26:27],v239 offset:6272
 v_mfma_f32_16x16x32_bf16 a[80:83],v[44:47],a[208:211],a[80:83]
 buffer_load_dwordx4 a[176:179],v4,s[4:7],s75 offen offset:1024 sc1
 v_mfma_f32_16x16x32_bf16 a[84:87],v[44:47],a[212:215],a[84:87]
 v_mfma_f32_16x16x32_bf16 a[84:87],v[40:43],a[196:199],a[84:87]
 ds_read_b64_tr_b16 v[28:29],v239 offset:12416
 ds_read_b64_tr_b16 v[30:31],v239 offset:18560
 v_mfma_f32_16x16x32_bf16 a[88:91],v[40:43],a[200:203],a[88:91]
 v_mfma_f32_16x16x32_bf16 a[88:91],v[44:47],a[216:219],a[88:91]
 s_add_u32 m0,s35,27648
 s_add_u32 s44,s39,10240
 buffer_load_dwordx4 v1,s[12:15],s44 offen lds
 v_mfma_f32_16x16x32_bf16 a[92:95],v[44:47],a[220:223],a[92:95]
 v_mfma_f32_16x16x32_bf16 a[92:95],v[40:43],a[204:207],a[92:95]
 s_waitcnt lgkmcnt(4)
 v_mfma_f32_16x16x32_bf16 a[96:99],v[16:19],a[192:195],a[96:99]
 ds_read_b64_tr_b16 v[32:33],v236 offset:256
 ds_read_b64_tr_b16 v[34:35],v236 offset:6400
 v_mfma_f32_16x16x32_bf16 a[96:99],v[20:23],a[208:211],a[96:99]
 s_add_u32 s75,s74,200704
 v_mfma_f32_16x16x32_bf16 a[100:103],v[20:23],a[212:215],a[100:103]
 buffer_load_dwordx4 a[164:167],v4,s[4:7],s75 offen sc1
 v_mfma_f32_16x16x32_bf16 a[100:103],v[16:19],a[196:199],a[100:103]
 ds_read_b64_tr_b16 v[36:37],v236 offset:12544
 ds_read_b64_tr_b16 v[38:39],v236 offset:18688
 v_mfma_f32_16x16x32_bf16 a[104:107],v[16:19],a[200:203],a[104:107]
 v_mfma_f32_16x16x32_bf16 a[104:107],v[20:23],a[216:219],a[104:107]
 v_mfma_f32_16x16x32_bf16 a[108:111],v[20:23],a[220:223],a[108:111]
 buffer_load_dwordx4 v2,s[12:15],s44 offen offset:1024 lds
 v_mfma_f32_16x16x32_bf16 a[108:111],v[16:19],a[204:207],a[108:111]
 s_waitcnt lgkmcnt(4)
 v_mfma_f32_16x16x32_bf16 a[112:115],v[24:27],a[192:195],a[112:115]
 ds_read_b64_tr_b16 v[40:41],v237 offset:256
 ds_read_b64_tr_b16 v[42:43],v237 offset:6400
 v_mfma_f32_16x16x32_bf16 a[112:115],v[28:31],a[208:211],a[112:115]
 v_mfma_f32_16x16x32_bf16 a[116:119],v[28:31],a[212:215],a[116:119]
 ds_read_b64_tr_b16 v[44:45],v237 offset:12544
 ds_read_b64_tr_b16 v[46:47],v237 offset:18688
 v_mfma_f32_16x16x32_bf16 a[116:119],v[24:27],a[196:199],a[116:119]
 v_add_u32 v236,49152,v236
 v_add_u32 v237,49152,v237
 v_mfma_f32_16x16x32_bf16 a[120:123],v[24:27],a[200:203],a[120:123]
 v_add_u32 v238,49152,v238
 v_add_u32 v239,49152,v239
 v_mfma_f32_16x16x32_bf16 a[120:123],v[28:31],a[216:219],a[120:123]
 buffer_load_dwordx4 a[180:183],v4,s[4:7],s75 offen offset:1024 sc1
 v_mfma_f32_16x16x32_bf16 a[124:127],v[28:31],a[220:223],a[124:127]
 v_mfma_f32_16x16x32_bf16 a[124:127],v[24:27],a[204:207],a[124:127]
 s_waitcnt lgkmcnt(4)
 v_mfma_f32_16x16x32_bf16 a[128:131],v[32:35],a[192:195],a[128:131]
 s_waitcnt vmcnt(62)
 s_barrier
 v_mfma_f32_16x16x32_bf16 a[128:131],v[36:39],a[208:211],a[128:131]
 s_add_u32 s75,s74,397312
 ds_read_b64_tr_b16 v[16:17],v236
 ds_read_b64_tr_b16 v[18:19],v236 offset:6144
 v_mfma_f32_16x16x32_bf16 a[132:135],v[36:39],a[212:215],a[132:135]
 buffer_load_dwordx4 a[168:171],v4,s[4:7],s75 offen sc1
 buffer_load_dwordx4 v3,s[12:15],s44 offen offset:2048 lds
 v_mfma_f32_16x16x32_bf16 a[132:135],v[32:35],a[196:199],a[132:135]
 v_mfma_f32_16x16x32_bf16 a[136:139],v[32:35],a[200:203],a[136:139]
 ds_read_b64_tr_b16 v[20:21],v236 offset:12288
 ds_read_b64_tr_b16 v[22:23],v236 offset:18432
 v_mfma_f32_16x16x32_bf16 a[136:139],v[36:39],a[216:219],a[136:139]
 v_mfma_f32_16x16x32_bf16 a[140:143],v[36:39],a[220:223],a[140:143]
 v_mfma_f32_16x16x32_bf16 a[140:143],v[32:35],a[204:207],a[140:143]
 s_waitcnt lgkmcnt(4)
 v_mfma_f32_16x16x32_bf16 a[144:147],v[40:43],a[192:195],a[144:147]
 ds_read_b64_tr_b16 v[24:25],v237
 ds_read_b64_tr_b16 v[26:27],v237 offset:6144
 v_mfma_f32_16x16x32_bf16 a[144:147],v[44:47],a[208:211],a[144:147]
 buffer_load_dwordx4 a[184:187],v4,s[4:7],s75 offen offset:1024 sc1
 v_mfma_f32_16x16x32_bf16 a[148:151],v[44:47],a[212:215],a[148:151]
 v_mfma_f32_16x16x32_bf16 a[148:151],v[40:43],a[196:199],a[148:151]
 s_add_u32 s75,s74,593920
 ds_read_b64_tr_b16 v[28:29],v237 offset:12288
 ds_read_b64_tr_b16 v[30:31],v237 offset:18432
 v_mfma_f32_16x16x32_bf16 a[152:155],v[40:43],a[200:203],a[152:155]
 buffer_load_dwordx4 a[172:175],v4,s[4:7],s75 offen sc1
 v_mfma_f32_16x16x32_bf16 a[152:155],v[44:47],a[216:219],a[152:155]
 v_mfma_f32_16x16x32_bf16 a[156:159],v[44:47],a[220:223],a[156:159]
 v_mfma_f32_16x16x32_bf16 a[156:159],v[40:43],a[204:207],a[156:159]
 s_waitcnt vmcnt(13) lgkmcnt(4)
 v_mfma_f32_16x16x32_bf16 a[0:3],v[16:19],a[224:227],a[0:3]
 ds_read_b64_tr_b16 v[32:33],v238
 ds_read_b64_tr_b16 v[34:35],v238 offset:6144
 v_mfma_f32_16x16x32_bf16 a[0:3],v[20:23],a[240:243],a[0:3]
 s_add_u32 m0,s35,73728
 s_add_u32 s39,s39,81920
 buffer_load_dwordx4 v1,s[12:15],s39 offen lds
 v_mfma_f32_16x16x32_bf16 a[4:7],v[20:23],a[244:247],a[4:7]
 v_mfma_f32_16x16x32_bf16 a[4:7],v[16:19],a[228:231],a[4:7]
 ds_read_b64_tr_b16 v[36:37],v238 offset:12288
 ds_read_b64_tr_b16 v[38:39],v238 offset:18432
 v_mfma_f32_16x16x32_bf16 a[8:11],v[16:19],a[232:235],a[8:11]
 buffer_load_dwordx4 a[188:191],v4,s[4:7],s75 offen offset:1024 sc1
 v_mfma_f32_16x16x32_bf16 a[8:11],v[20:23],a[248:251],a[8:11]
 v_mfma_f32_16x16x32_bf16 a[12:15],v[20:23],a[252:255],a[12:15]
 s_cmp_le_u32 s53,1
 s_cselect_b32 s74,2,1
 v_mfma_f32_16x16x32_bf16 a[12:15],v[16:19],a[236:239],a[12:15]
 s_mul_i32 s74,s74,6144
 s_waitcnt lgkmcnt(4)
 v_mfma_f32_16x16x32_bf16 a[16:19],v[24:27],a[224:227],a[16:19]
 s_add_u32 s75,s74,0
 ds_read_b64_tr_b16 v[40:41],v239
 ds_read_b64_tr_b16 v[42:43],v239 offset:6144
 v_mfma_f32_16x16x32_bf16 a[16:19],v[28:31],a[240:243],a[16:19]
 buffer_load_dwordx4 v[64:67],v4,s[4:7],s75 offen sc1
 v_mfma_f32_16x16x32_bf16 a[20:23],v[28:31],a[244:247],a[20:23]
 v_mfma_f32_16x16x32_bf16 a[20:23],v[24:27],a[228:231],a[20:23]
 ds_read_b64_tr_b16 v[44:45],v239 offset:12288
 ds_read_b64_tr_b16 v[46:47],v239 offset:18432
 v_mfma_f32_16x16x32_bf16 a[24:27],v[24:27],a[232:235],a[24:27]
 v_mfma_f32_16x16x32_bf16 a[24:27],v[28:31],a[248:251],a[24:27]
 v_mfma_f32_16x16x32_bf16 a[28:31],v[28:31],a[252:255],a[28:31]
 v_mfma_f32_16x16x32_bf16 a[28:31],v[24:27],a[236:239],a[28:31]
 s_waitcnt lgkmcnt(4)
 v_mfma_f32_16x16x32_bf16 a[32:35],v[32:35],a[224:227],a[32:35]
 ds_read_b64_tr_b16 v[16:17],v236 offset:128
 ds_read_b64_tr_b16 v[18:19],v236 offset:6272
 v_mfma_f32_16x16x32_bf16 a[32:35],v[36:39],a[240:243],a[32:35]
 buffer_load_dwordx4 v[80:83],v4,s[4:7],s75 offen offset:1024 sc1
 v_mfma_f32_16x16x32_bf16 a[36:39],v[36:39],a[244:247],a[36:39]
 v_mfma_f32_16x16x32_bf16 a[36:39],v[32:35],a[228:231],a[36:39]
 ds_read_b64_tr_b16 v[20:21],v236 offset:12416
 ds_read_b64_tr_b16 v[22:23],v236 offset:18560
 v_mfma_f32_16x16x32_bf16 a[40:43],v[32:35],a[232:235],a[40:43]
 s_add_u32 s75,s74,196608
 v_mfma_f32_16x16x32_bf16 a[40:43],v[36:39],a[248:251],a[40:43]
 buffer_load_dwordx4 v[68:71],v4,s[4:7],s75 offen sc1
 v_mfma_f32_16x16x32_bf16 a[44:47],v[36:39],a[252:255],a[44:47]
 v_mfma_f32_16x16x32_bf16 a[44:47],v[32:35],a[236:239],a[44:47]
 s_waitcnt lgkmcnt(4)
 v_mfma_f32_16x16x32_bf16 a[48:51],v[40:43],a[224:227],a[48:51]
 ds_read_b64_tr_b16 v[24:25],v237 offset:128
 ds_read_b64_tr_b16 v[26:27],v237 offset:6272
 v_mfma_f32_16x16x32_bf16 a[48:51],v[44:47],a[240:243],a[48:51]
 v_mfma_f32_16x16x32_bf16 a[52:55],v[44:47],a[244:247],a[52:55]
 v_mfma_f32_16x16x32_bf16 a[52:55],v[40:43],a[228:231],a[52:55]
 ds_read_b64_tr_b16 v[28:29],v237 offset:12416
 ds_read_b64_tr_b16 v[30:31],v237 offset:18560
 v_mfma_f32_16x16x32_bf16 a[56:59],v[40:43],a[232:235],a[56:59]
 buffer_load_dwordx4 v[84:87],v4,s[4:7],s75 offen offset:1024 sc1
 v_mfma_f32_16x16x32_bf16 a[56:59],v[44:47],a[248:251],a[56:59]
 v_mfma_f32_16x16x32_bf16 a[60:63],v[44:47],a[252:255],a[60:63]
 v_mfma_f32_16x16x32_bf16 a[60:63],v[40:43],a[236:239],a[60:63]
 s_waitcnt lgkmcnt(4)
 v_mfma_f32_16x16x32_bf16 a[64:67],v[16:19],a[224:227],a[64:67]
 ds_read_b64_tr_b16 v[32:33],v238 offset:128
 ds_read_b64_tr_b16 v[34:35],v238 offset:6272
 v_mfma_f32_16x16x32_bf16 a[64:67],v[20:23],a[240:243],a[64:67]
 s_getpc_b64 s[66:67]
Lt26:
 s_mul_i32 s41,s48,4
 v_min_u32 v15,3,v0
 v_mfma_f32_16x16x32_bf16 a[68:71],v[20:23],a[244:247],a[68:71]
 v_add_u32 v15,s41,v15
 v_min_u32 v15,(recurrent_scan__mha_block_cached__mixer_s_mlp__prompt_kernel_hot_end-Lt26)/128,v15
 v_mfma_f32_16x16x32_bf16 a[68:71],v[16:19],a[228:231],a[68:71]
 ds_read_b64_tr_b16 v[36:37],v238 offset:12416
 ds_read_b64_tr_b16 v[38:39],v238 offset:18560
 v_mfma_f32_16x16x32_bf16 a[72:75],v[16:19],a[232:235],a[72:75]
 s_add_u32 s75,s74,393216
 v_lshlrev_b32 v15,7,v15
 global_load_dword v255,v15,s[66:67]
 v_mfma_f32_16x16x32_bf16 a[72:75],v[20:23],a[248:251],a[72:75]
 buffer_load_dwordx4 v[72:75],v4,s[4:7],s75 offen sc1
 v_mfma_f32_16x16x32_bf16 a[76:79],v[20:23],a[252:255],a[76:79]
 v_mfma_f32_16x16x32_bf16 a[76:79],v[16:19],a[236:239],a[76:79]
 s_waitcnt lgkmcnt(4)
 v_mfma_f32_16x16x32_bf16 a[80:83],v[24:27],a[224:227],a[80:83]
 ds_read_b64_tr_b16 v[40:41],v239 offset:128
 ds_read_b64_tr_b16 v[42:43],v239 offset:6272
 v_mfma_f32_16x16x32_bf16 a[80:83],v[28:31],a[240:243],a[80:83]
 buffer_load_dwordx4 v[88:91],v4,s[4:7],s75 offen offset:1024 sc1
 v_mfma_f32_16x16x32_bf16 a[84:87],v[28:31],a[244:247],a[84:87]
 v_mfma_f32_16x16x32_bf16 a[84:87],v[24:27],a[228:231],a[84:87]
 ds_read_b64_tr_b16 v[44:45],v239 offset:12416
 ds_read_b64_tr_b16 v[46:47],v239 offset:18560
 v_mfma_f32_16x16x32_bf16 a[88:91],v[24:27],a[232:235],a[88:91]
 v_mfma_f32_16x16x32_bf16 a[88:91],v[28:31],a[248:251],a[88:91]
 s_add_u32 s75,s74,589824
 v_mfma_f32_16x16x32_bf16 a[92:95],v[28:31],a[252:255],a[92:95]
 buffer_load_dwordx4 v[76:79],v4,s[4:7],s75 offen sc1
 v_mfma_f32_16x16x32_bf16 a[92:95],v[24:27],a[236:239],a[92:95]
 s_waitcnt lgkmcnt(4)
 v_mfma_f32_16x16x32_bf16 a[96:99],v[32:35],a[224:227],a[96:99]
 ds_read_b64_tr_b16 v[16:17],v236 offset:256
 ds_read_b64_tr_b16 v[18:19],v236 offset:6400
 v_mfma_f32_16x16x32_bf16 a[96:99],v[36:39],a[240:243],a[96:99]
 v_mfma_f32_16x16x32_bf16 a[100:103],v[36:39],a[244:247],a[100:103]
 v_mfma_f32_16x16x32_bf16 a[100:103],v[32:35],a[228:231],a[100:103]
 ds_read_b64_tr_b16 v[20:21],v236 offset:12544
 ds_read_b64_tr_b16 v[22:23],v236 offset:18688
 v_mfma_f32_16x16x32_bf16 a[104:107],v[32:35],a[232:235],a[104:107]
 v_mfma_f32_16x16x32_bf16 a[104:107],v[36:39],a[248:251],a[104:107]
 buffer_load_dwordx4 v[92:95],v4,s[4:7],s75 offen offset:1024 sc1
 v_mfma_f32_16x16x32_bf16 a[108:111],v[36:39],a[252:255],a[108:111]
 v_mfma_f32_16x16x32_bf16 a[108:111],v[32:35],a[236:239],a[108:111]
 s_waitcnt lgkmcnt(4)
 v_mfma_f32_16x16x32_bf16 a[112:115],v[40:43],a[224:227],a[112:115]
 ds_read_b64_tr_b16 v[24:25],v237 offset:256
 ds_read_b64_tr_b16 v[26:27],v237 offset:6400
 v_mfma_f32_16x16x32_bf16 a[112:115],v[44:47],a[240:243],a[112:115]
 v_mfma_f32_16x16x32_bf16 a[116:119],v[44:47],a[244:247],a[116:119]
 ds_read_b64_tr_b16 v[28:29],v237 offset:12544
 ds_read_b64_tr_b16 v[30:31],v237 offset:18688
 v_mfma_f32_16x16x32_bf16 a[116:119],v[40:43],a[228:231],a[116:119]
 v_add_u32 v236,4294868992,v236
 v_add_u32 v237,4294868992,v237
 v_mfma_f32_16x16x32_bf16 a[120:123],v[40:43],a[232:235],a[120:123]
 s_add_u32 s75,s74,2048
 v_add_u32 v238,4294868992,v238
 v_add_u32 v239,4294868992,v239
 v_mfma_f32_16x16x32_bf16 a[120:123],v[44:47],a[248:251],a[120:123]
 buffer_load_dwordx4 v[96:99],v4,s[4:7],s75 offen sc1
 v_mfma_f32_16x16x32_bf16 a[124:127],v[44:47],a[252:255],a[124:127]
 v_mfma_f32_16x16x32_bf16 a[124:127],v[40:43],a[236:239],a[124:127]
 s_waitcnt lgkmcnt(4)
 v_mfma_f32_16x16x32_bf16 a[128:131],v[16:19],a[224:227],a[128:131]
 s_waitcnt vmcnt(63)
 s_barrier
 v_mfma_f32_16x16x32_bf16 a[128:131],v[20:23],a[240:243],a[128:131]
 ds_read_b64_tr_b16 v[32:33],v236
 ds_read_b64_tr_b16 v[34:35],v236 offset:6144
 v_mfma_f32_16x16x32_bf16 a[132:135],v[20:23],a[244:247],a[132:135]
 buffer_load_dwordx4 v[112:115],v4,s[4:7],s75 offen offset:1024 sc1
 v_mfma_f32_16x16x32_bf16 a[132:135],v[16:19],a[228:231],a[132:135]
 v_mfma_f32_16x16x32_bf16 a[136:139],v[16:19],a[232:235],a[136:139]
 ds_read_b64_tr_b16 v[36:37],v236 offset:12288
 ds_read_b64_tr_b16 v[38:39],v236 offset:18432
 v_mfma_f32_16x16x32_bf16 a[136:139],v[20:23],a[248:251],a[136:139]
 s_add_u32 s75,s74,198656
 v_mfma_f32_16x16x32_bf16 a[140:143],v[20:23],a[252:255],a[140:143]
 buffer_load_dwordx4 v[100:103],v4,s[4:7],s75 offen sc1
 v_mfma_f32_16x16x32_bf16 a[140:143],v[16:19],a[236:239],a[140:143]
 s_waitcnt lgkmcnt(4)
 v_mfma_f32_16x16x32_bf16 a[144:147],v[24:27],a[224:227],a[144:147]
 ds_read_b64_tr_b16 v[40:41],v237
 ds_read_b64_tr_b16 v[42:43],v237 offset:6144
 v_mfma_f32_16x16x32_bf16 a[144:147],v[28:31],a[240:243],a[144:147]
 v_mfma_f32_16x16x32_bf16 a[148:151],v[28:31],a[244:247],a[148:151]
 v_mfma_f32_16x16x32_bf16 a[148:151],v[24:27],a[228:231],a[148:151]
 ds_read_b64_tr_b16 v[44:45],v237 offset:12288
 ds_read_b64_tr_b16 v[46:47],v237 offset:18432
 v_mfma_f32_16x16x32_bf16 a[152:155],v[24:27],a[232:235],a[152:155]
 buffer_load_dwordx4 v[116:119],v4,s[4:7],s75 offen offset:1024 sc1
 v_mfma_f32_16x16x32_bf16 a[152:155],v[28:31],a[248:251],a[152:155]
 v_mfma_f32_16x16x32_bf16 a[156:159],v[28:31],a[252:255],a[156:159]
 v_mfma_f32_16x16x32_bf16 a[156:159],v[24:27],a[236:239],a[156:159]
 s_waitcnt vmcnt(13) lgkmcnt(4)
 v_mfma_f32_16x16x32_bf16 a[0:3],v[32:35],a[160:163],a[0:3]
 ds_read_b64_tr_b16 v[16:17],v238
 ds_read_b64_tr_b16 v[18:19],v238 offset:6144
 v_mfma_f32_16x16x32_bf16 a[0:3],v[36:39],a[176:179],a[0:3]
 v_mfma_f32_16x16x32_bf16 a[4:7],v[36:39],a[180:183],a[4:7]
 v_mfma_f32_16x16x32_bf16 a[4:7],v[32:35],a[164:167],a[4:7]
 s_add_u32 s75,s74,395264
 ds_read_b64_tr_b16 v[20:21],v238 offset:12288
 ds_read_b64_tr_b16 v[22:23],v238 offset:18432
 v_mfma_f32_16x16x32_bf16 a[8:11],v[32:35],a[168:171],a[8:11]
 buffer_load_dwordx4 v[104:107],v4,s[4:7],s75 offen sc1
 v_mfma_f32_16x16x32_bf16 a[8:11],v[36:39],a[184:187],a[8:11]
 v_mfma_f32_16x16x32_bf16 a[12:15],v[36:39],a[188:191],a[12:15]
 v_mfma_f32_16x16x32_bf16 a[12:15],v[32:35],a[172:175],a[12:15]
 s_waitcnt lgkmcnt(4)
 v_mfma_f32_16x16x32_bf16 a[16:19],v[40:43],a[160:163],a[16:19]
 ds_read_b64_tr_b16 v[24:25],v239
 ds_read_b64_tr_b16 v[26:27],v239 offset:6144
 v_mfma_f32_16x16x32_bf16 a[16:19],v[44:47],a[176:179],a[16:19]
 buffer_load_dwordx4 v[120:123],v4,s[4:7],s75 offen offset:1024 sc1
 v_mfma_f32_16x16x32_bf16 a[20:23],v[44:47],a[180:183],a[20:23]
 v_mfma_f32_16x16x32_bf16 a[20:23],v[40:43],a[164:167],a[20:23]
 ds_read_b64_tr_b16 v[28:29],v239 offset:12288
 ds_read_b64_tr_b16 v[30:31],v239 offset:18432
 v_mfma_f32_16x16x32_bf16 a[24:27],v[40:43],a[168:171],a[24:27]
 v_mfma_f32_16x16x32_bf16 a[24:27],v[44:47],a[184:187],a[24:27]
 v_mfma_f32_16x16x32_bf16 a[28:31],v[44:47],a[188:191],a[28:31]
 s_add_u32 s75,s74,591872
 v_mfma_f32_16x16x32_bf16 a[28:31],v[40:43],a[172:175],a[28:31]
 buffer_load_dwordx4 v[108:111],v4,s[4:7],s75 offen sc1
 s_waitcnt lgkmcnt(4)
 v_mfma_f32_16x16x32_bf16 a[32:35],v[16:19],a[160:163],a[32:35]
 ds_read_b64_tr_b16 v[32:33],v236 offset:128
 ds_read_b64_tr_b16 v[34:35],v236 offset:6272
 v_mfma_f32_16x16x32_bf16 a[32:35],v[20:23],a[176:179],a[32:35]
 v_mfma_f32_16x16x32_bf16 a[36:39],v[20:23],a[180:183],a[36:39]
 v_mfma_f32_16x16x32_bf16 a[36:39],v[16:19],a[164:167],a[36:39]
 ds_read_b64_tr_b16 v[36:37],v236 offset:12416
 ds_read_b64_tr_b16 v[38:39],v236 offset:18560
 v_mfma_f32_16x16x32_bf16 a[40:43],v[16:19],a[168:171],a[40:43]
 v_mfma_f32_16x16x32_bf16 a[40:43],v[20:23],a[184:187],a[40:43]
 buffer_load_dwordx4 v[124:127],v4,s[4:7],s75 offen offset:1024 sc1
 v_mfma_f32_16x16x32_bf16 a[44:47],v[20:23],a[188:191],a[44:47]
 v_mfma_f32_16x16x32_bf16 a[44:47],v[16:19],a[172:175],a[44:47]
 s_waitcnt lgkmcnt(4)
 v_mfma_f32_16x16x32_bf16 a[48:51],v[24:27],a[160:163],a[48:51]
 ds_read_b64_tr_b16 v[40:41],v237 offset:128
 ds_read_b64_tr_b16 v[42:43],v237 offset:6272
 v_mfma_f32_16x16x32_bf16 a[48:51],v[28:31],a[176:179],a[48:51]
 v_mfma_f32_16x16x32_bf16 a[52:55],v[28:31],a[180:183],a[52:55]
 v_mfma_f32_16x16x32_bf16 a[52:55],v[24:27],a[164:167],a[52:55]
 s_add_u32 s75,s74,4096
 ds_read_b64_tr_b16 v[44:45],v237 offset:12416
 ds_read_b64_tr_b16 v[46:47],v237 offset:18560
 v_mfma_f32_16x16x32_bf16 a[56:59],v[24:27],a[168:171],a[56:59]
 buffer_load_dwordx4 v[128:131],v4,s[4:7],s75 offen sc1
 v_mfma_f32_16x16x32_bf16 a[56:59],v[28:31],a[184:187],a[56:59]
 v_mfma_f32_16x16x32_bf16 a[60:63],v[28:31],a[188:191],a[60:63]
 v_mfma_f32_16x16x32_bf16 a[60:63],v[24:27],a[172:175],a[60:63]
 s_waitcnt lgkmcnt(4)
 v_mfma_f32_16x16x32_bf16 a[64:67],v[32:35],a[160:163],a[64:67]
 ds_read_b64_tr_b16 v[16:17],v238 offset:128
 ds_read_b64_tr_b16 v[18:19],v238 offset:6272
 v_mfma_f32_16x16x32_bf16 a[64:67],v[36:39],a[176:179],a[64:67]
 buffer_load_dwordx4 v[144:147],v4,s[4:7],s75 offen offset:1024 sc1
 v_mfma_f32_16x16x32_bf16 a[68:71],v[36:39],a[180:183],a[68:71]
 v_mfma_f32_16x16x32_bf16 a[68:71],v[32:35],a[164:167],a[68:71]
 ds_read_b64_tr_b16 v[20:21],v238 offset:12416
 ds_read_b64_tr_b16 v[22:23],v238 offset:18560
 v_mfma_f32_16x16x32_bf16 a[72:75],v[32:35],a[168:171],a[72:75]
 v_mfma_f32_16x16x32_bf16 a[72:75],v[36:39],a[184:187],a[72:75]
 v_mfma_f32_16x16x32_bf16 a[76:79],v[36:39],a[188:191],a[76:79]
 v_mfma_f32_16x16x32_bf16 a[76:79],v[32:35],a[172:175],a[76:79]
 s_waitcnt lgkmcnt(4)
 v_mfma_f32_16x16x32_bf16 a[80:83],v[40:43],a[160:163],a[80:83]
 s_add_u32 s75,s74,200704
 ds_read_b64_tr_b16 v[24:25],v239 offset:128
 ds_read_b64_tr_b16 v[26:27],v239 offset:6272
 v_mfma_f32_16x16x32_bf16 a[80:83],v[44:47],a[176:179],a[80:83]
 buffer_load_dwordx4 v[132:135],v4,s[4:7],s75 offen sc1
 v_mfma_f32_16x16x32_bf16 a[84:87],v[44:47],a[180:183],a[84:87]
 v_mfma_f32_16x16x32_bf16 a[84:87],v[40:43],a[164:167],a[84:87]
 ds_read_b64_tr_b16 v[28:29],v239 offset:12416
 ds_read_b64_tr_b16 v[30:31],v239 offset:18560
 v_mfma_f32_16x16x32_bf16 a[88:91],v[40:43],a[168:171],a[88:91]
 v_mfma_f32_16x16x32_bf16 a[88:91],v[44:47],a[184:187],a[88:91]
 v_mfma_f32_16x16x32_bf16 a[92:95],v[44:47],a[188:191],a[92:95]
 buffer_load_dwordx4 v[148:151],v4,s[4:7],s75 offen offset:1024 sc1
 v_mfma_f32_16x16x32_bf16 a[92:95],v[40:43],a[172:175],a[92:95]
 s_waitcnt lgkmcnt(4)
 v_mfma_f32_16x16x32_bf16 a[96:99],v[16:19],a[160:163],a[96:99]
 ds_read_b64_tr_b16 v[32:33],v236 offset:256
 ds_read_b64_tr_b16 v[34:35],v236 offset:6400
 v_mfma_f32_16x16x32_bf16 a[96:99],v[20:23],a[176:179],a[96:99]
 v_mfma_f32_16x16x32_bf16 a[100:103],v[20:23],a[180:183],a[100:103]
 v_mfma_f32_16x16x32_bf16 a[100:103],v[16:19],a[164:167],a[100:103]
 s_add_u32 s75,s74,397312
 ds_read_b64_tr_b16 v[36:37],v236 offset:12544
 ds_read_b64_tr_b16 v[38:39],v236 offset:18688
 v_mfma_f32_16x16x32_bf16 a[104:107],v[16:19],a[168:171],a[104:107]
 buffer_load_dwordx4 v[136:139],v4,s[4:7],s75 offen sc1
 v_mfma_f32_16x16x32_bf16 a[104:107],v[20:23],a[184:187],a[104:107]
 v_mfma_f32_16x16x32_bf16 a[108:111],v[20:23],a[188:191],a[108:111]
 v_mfma_f32_16x16x32_bf16 a[108:111],v[16:19],a[172:175],a[108:111]
 s_waitcnt lgkmcnt(4)
 v_mfma_f32_16x16x32_bf16 a[112:115],v[24:27],a[160:163],a[112:115]
 ds_read_b64_tr_b16 v[40:41],v237 offset:256
 ds_read_b64_tr_b16 v[42:43],v237 offset:6400
 v_mfma_f32_16x16x32_bf16 a[112:115],v[28:31],a[176:179],a[112:115]
 v_mfma_f32_16x16x32_bf16 a[116:119],v[28:31],a[180:183],a[116:119]
 ds_read_b64_tr_b16 v[44:45],v237 offset:12544
 ds_read_b64_tr_b16 v[46:47],v237 offset:18688
 v_mfma_f32_16x16x32_bf16 a[116:119],v[24:27],a[164:167],a[116:119]
 v_add_u32 v236,122880,v236
 v_add_u32 v237,122880,v237
 v_mfma_f32_16x16x32_bf16 a[120:123],v[24:27],a[168:171],a[120:123]
 v_add_u32 v238,122880,v238
 v_add_u32 v239,122880,v239
 v_mfma_f32_16x16x32_bf16 a[120:123],v[28:31],a[184:187],a[120:123]
 buffer_load_dwordx4 v[152:155],v4,s[4:7],s75 offen offset:1024 sc1
 v_mfma_f32_16x16x32_bf16 a[124:127],v[28:31],a[188:191],a[124:127]
 v_mfma_f32_16x16x32_bf16 a[124:127],v[24:27],a[172:175],a[124:127]
 s_waitcnt lgkmcnt(4)
 v_mfma_f32_16x16x32_bf16 a[128:131],v[32:35],a[160:163],a[128:131]
 s_waitcnt vmcnt(39)
 s_barrier
 v_mfma_f32_16x16x32_bf16 a[128:131],v[36:39],a[176:179],a[128:131]
 s_add_u32 s75,s74,593920
 ds_read_b64_tr_b16 v[16:17],v236
 ds_read_b64_tr_b16 v[18:19],v236 offset:6144
 v_mfma_f32_16x16x32_bf16 a[132:135],v[36:39],a[180:183],a[132:135]
 buffer_load_dwordx4 v[140:143],v4,s[4:7],s75 offen sc1
 v_mfma_f32_16x16x32_bf16 a[132:135],v[32:35],a[164:167],a[132:135]
 v_mfma_f32_16x16x32_bf16 a[136:139],v[32:35],a[168:171],a[136:139]
 ds_read_b64_tr_b16 v[20:21],v236 offset:12288
 ds_read_b64_tr_b16 v[22:23],v236 offset:18432
 v_mfma_f32_16x16x32_bf16 a[136:139],v[36:39],a[184:187],a[136:139]
 buffer_load_dwordx4 v[156:159],v4,s[4:7],s75 offen offset:1024 sc1
 v_mfma_f32_16x16x32_bf16 a[140:143],v[36:39],a[188:191],a[140:143]
 v_mfma_f32_16x16x32_bf16 a[140:143],v[32:35],a[172:175],a[140:143]
 s_waitcnt lgkmcnt(4)
 v_mfma_f32_16x16x32_bf16 a[144:147],v[40:43],a[160:163],a[144:147]
 ds_read_b64_tr_b16 v[24:25],v237
 ds_read_b64_tr_b16 v[26:27],v237 offset:6144
 v_mfma_f32_16x16x32_bf16 a[144:147],v[44:47],a[176:179],a[144:147]
 s_cmp_le_u32 s53,2
 s_cselect_b32 s74,3,2
 v_mfma_f32_16x16x32_bf16 a[148:151],v[44:47],a[180:183],a[148:151]
 s_mul_i32 s74,s74,6144
 v_mfma_f32_16x16x32_bf16 a[148:151],v[40:43],a[164:167],a[148:151]
 s_add_u32 s75,s74,0
 ds_read_b64_tr_b16 v[28:29],v237 offset:12288
 ds_read_b64_tr_b16 v[30:31],v237 offset:18432
 v_mfma_f32_16x16x32_bf16 a[152:155],v[40:43],a[168:171],a[152:155]
 buffer_load_dwordx4 a[192:195],v4,s[4:7],s75 offen sc1
 v_mfma_f32_16x16x32_bf16 a[152:155],v[44:47],a[184:187],a[152:155]
 v_mfma_f32_16x16x32_bf16 a[156:159],v[44:47],a[188:191],a[156:159]
 v_mfma_f32_16x16x32_bf16 a[156:159],v[40:43],a[172:175],a[156:159]
 s_waitcnt vmcnt(17) lgkmcnt(4)
 v_mfma_f32_16x16x32_bf16 a[0:3],v[16:19],v[64:67],a[0:3]
 ds_read_b64_tr_b16 v[32:33],v238
 ds_read_b64_tr_b16 v[34:35],v238 offset:6144
 v_mfma_f32_16x16x32_bf16 a[0:3],v[20:23],v[80:83],a[0:3]
 v_mfma_f32_16x16x32_bf16 a[4:7],v[20:23],v[84:87],a[4:7]
 v_mfma_f32_16x16x32_bf16 a[4:7],v[16:19],v[68:71],a[4:7]
 ds_read_b64_tr_b16 v[36:37],v238 offset:12288
 ds_read_b64_tr_b16 v[38:39],v238 offset:18432
 v_mfma_f32_16x16x32_bf16 a[8:11],v[16:19],v[72:75],a[8:11]
 buffer_load_dwordx4 a[208:211],v4,s[4:7],s75 offen offset:1024 sc1
 v_mfma_f32_16x16x32_bf16 a[8:11],v[20:23],v[88:91],a[8:11]
 v_mfma_f32_16x16x32_bf16 a[12:15],v[20:23],v[92:95],a[12:15]
 v_mfma_f32_16x16x32_bf16 a[12:15],v[16:19],v[76:79],a[12:15]
 s_waitcnt lgkmcnt(4)
 v_mfma_f32_16x16x32_bf16 a[16:19],v[24:27],v[64:67],a[16:19]
 s_add_u32 s75,s74,196608
 ds_read_b64_tr_b16 v[40:41],v239
 ds_read_b64_tr_b16 v[42:43],v239 offset:6144
 v_mfma_f32_16x16x32_bf16 a[16:19],v[28:31],v[80:83],a[16:19]
 buffer_load_dwordx4 a[196:199],v4,s[4:7],s75 offen sc1
 v_mfma_f32_16x16x32_bf16 a[20:23],v[28:31],v[84:87],a[20:23]
 v_mfma_f32_16x16x32_bf16 a[20:23],v[24:27],v[68:71],a[20:23]
 ds_read_b64_tr_b16 v[44:45],v239 offset:12288
 ds_read_b64_tr_b16 v[46:47],v239 offset:18432
 v_mfma_f32_16x16x32_bf16 a[24:27],v[24:27],v[72:75],a[24:27]
 v_mfma_f32_16x16x32_bf16 a[24:27],v[28:31],v[88:91],a[24:27]
 v_mfma_f32_16x16x32_bf16 a[28:31],v[28:31],v[92:95],a[28:31]
 buffer_load_dwordx4 a[212:215],v4,s[4:7],s75 offen offset:1024 sc1
 v_mfma_f32_16x16x32_bf16 a[28:31],v[24:27],v[76:79],a[28:31]
 s_waitcnt lgkmcnt(4)
 v_mfma_f32_16x16x32_bf16 a[32:35],v[32:35],v[64:67],a[32:35]
 ds_read_b64_tr_b16 v[16:17],v236 offset:128
 ds_read_b64_tr_b16 v[18:19],v236 offset:6272
 v_mfma_f32_16x16x32_bf16 a[32:35],v[36:39],v[80:83],a[32:35]
 v_mfma_f32_16x16x32_bf16 a[36:39],v[36:39],v[84:87],a[36:39]
 v_mfma_f32_16x16x32_bf16 a[36:39],v[32:35],v[68:71],a[36:39]
 ds_read_b64_tr_b16 v[20:21],v236 offset:12416
 ds_read_b64_tr_b16 v[22:23],v236 offset:18560
 v_mfma_f32_16x16x32_bf16 a[40:43],v[32:35],v[72:75],a[40:43]
 s_add_u32 s75,s74,393216
 v_mfma_f32_16x16x32_bf16 a[40:43],v[36:39],v[88:91],a[40:43]
 buffer_load_dwordx4 a[200:203],v4,s[4:7],s75 offen sc1
 v_mfma_f32_16x16x32_bf16 a[44:47],v[36:39],v[92:95],a[44:47]
 v_mfma_f32_16x16x32_bf16 a[44:47],v[32:35],v[76:79],a[44:47]
 s_waitcnt lgkmcnt(4)
 v_mfma_f32_16x16x32_bf16 a[48:51],v[40:43],v[64:67],a[48:51]
 ds_read_b64_tr_b16 v[24:25],v237 offset:128
 ds_read_b64_tr_b16 v[26:27],v237 offset:6272
 v_mfma_f32_16x16x32_bf16 a[48:51],v[44:47],v[80:83],a[48:51]
 v_mfma_f32_16x16x32_bf16 a[52:55],v[44:47],v[84:87],a[52:55]
 v_mfma_f32_16x16x32_bf16 a[52:55],v[40:43],v[68:71],a[52:55]
 ds_read_b64_tr_b16 v[28:29],v237 offset:12416
 ds_read_b64_tr_b16 v[30:31],v237 offset:18560
 v_mfma_f32_16x16x32_bf16 a[56:59],v[40:43],v[72:75],a[56:59]
 buffer_load_dwordx4 a[216:219],v4,s[4:7],s75 offen offset:1024 sc1
 v_mfma_f32_16x16x32_bf16 a[56:59],v[44:47],v[88:91],a[56:59]
 v_mfma_f32_16x16x32_bf16 a[60:63],v[44:47],v[92:95],a[60:63]
 v_mfma_f32_16x16x32_bf16 a[60:63],v[40:43],v[76:79],a[60:63]
 s_waitcnt lgkmcnt(4)
 v_mfma_f32_16x16x32_bf16 a[64:67],v[16:19],v[64:67],a[64:67]
 s_add_u32 s75,s74,589824
 ds_read_b64_tr_b16 v[32:33],v238 offset:128
 ds_read_b64_tr_b16 v[34:35],v238 offset:6272
 v_mfma_f32_16x16x32_bf16 a[64:67],v[20:23],v[80:83],a[64:67]
 buffer_load_dwordx4 a[204:207],v4,s[4:7],s75 offen sc1
 v_mfma_f32_16x16x32_bf16 a[68:71],v[20:23],v[84:87],a[68:71]
 v_mfma_f32_16x16x32_bf16 a[68:71],v[16:19],v[68:71],a[68:71]
 ds_read_b64_tr_b16 v[36:37],v238 offset:12416
 ds_read_b64_tr_b16 v[38:39],v238 offset:18560
 v_mfma_f32_16x16x32_bf16 a[72:75],v[16:19],v[72:75],a[72:75]
 v_mfma_f32_16x16x32_bf16 a[72:75],v[20:23],v[88:91],a[72:75]
 v_mfma_f32_16x16x32_bf16 a[76:79],v[20:23],v[92:95],a[76:79]
 v_mfma_f32_16x16x32_bf16 a[76:79],v[16:19],v[76:79],a[76:79]
 s_waitcnt lgkmcnt(4)
 v_mfma_f32_16x16x32_bf16 a[80:83],v[24:27],v[64:67],a[80:83]
 ds_read_b64_tr_b16 v[40:41],v239 offset:128
 ds_read_b64_tr_b16 v[42:43],v239 offset:6272
 v_mfma_f32_16x16x32_bf16 a[80:83],v[28:31],v[80:83],a[80:83]
 buffer_load_dwordx4 v2,s[12:15],s39 offen offset:1024 lds
 v_mfma_f32_16x16x32_bf16 a[84:87],v[28:31],v[84:87],a[84:87]
 v_mfma_f32_16x16x32_bf16 a[84:87],v[24:27],v[68:71],a[84:87]
 ds_read_b64_tr_b16 v[44:45],v239 offset:12416
 ds_read_b64_tr_b16 v[46:47],v239 offset:18560
 v_mfma_f32_16x16x32_bf16 a[88:91],v[24:27],v[72:75],a[88:91]
 buffer_load_dwordx4 a[220:223],v4,s[4:7],s75 offen offset:1024 sc1
 v_mfma_f32_16x16x32_bf16 a[88:91],v[28:31],v[88:91],a[88:91]
 v_mfma_f32_16x16x32_bf16 a[92:95],v[28:31],v[92:95],a[92:95]
 v_mfma_f32_16x16x32_bf16 a[92:95],v[24:27],v[76:79],a[92:95]
 s_waitcnt lgkmcnt(4)
 v_mfma_f32_16x16x32_bf16 a[96:99],v[32:35],v[64:67],a[96:99]
 ds_read_b64_tr_b16 v[16:17],v236 offset:256
 ds_read_b64_tr_b16 v[18:19],v236 offset:6400
 v_mfma_f32_16x16x32_bf16 a[96:99],v[36:39],v[80:83],a[96:99]
 v_mfma_f32_16x16x32_bf16 a[100:103],v[36:39],v[84:87],a[100:103]
 buffer_load_dwordx4 v3,s[12:15],s39 offen offset:2048 lds
 v_mfma_f32_16x16x32_bf16 a[100:103],v[32:35],v[68:71],a[100:103]
 ds_read_b64_tr_b16 v[20:21],v236 offset:12544
 ds_read_b64_tr_b16 v[22:23],v236 offset:18688
 v_mfma_f32_16x16x32_bf16 a[104:107],v[32:35],v[72:75],a[104:107]
 v_mfma_f32_16x16x32_bf16 a[104:107],v[36:39],v[88:91],a[104:107]
 v_mfma_f32_16x16x32_bf16 a[108:111],v[36:39],v[92:95],a[108:111]
 v_mfma_f32_16x16x32_bf16 a[108:111],v[32:35],v[76:79],a[108:111]
 s_waitcnt lgkmcnt(4)
 v_mfma_f32_16x16x32_bf16 a[112:115],v[40:43],v[64:67],a[112:115]
 ds_read_b64_tr_b16 v[24:25],v237 offset:256
 ds_read_b64_tr_b16 v[26:27],v237 offset:6400
 v_mfma_f32_16x16x32_bf16 a[112:115],v[44:47],v[80:83],a[112:115]
 s_add_u32 m0,s35,76800
 s_add_u32 s44,s39,10240
 buffer_load_dwordx4 v1,s[12:15],s44 offen lds
 v_mfma_f32_16x16x32_bf16 a[116:119],v[44:47],v[84:87],a[116:119]
 ds_read_b64_tr_b16 v[28:29],v237 offset:12544
 ds_read_b64_tr_b16 v[30:31],v237 offset:18688
 v_mfma_f32_16x16x32_bf16 a[116:119],v[40:43],v[68:71],a[116:119]
 v_add_u32 v236,4294868992,v236
 v_add_u32 v237,4294868992,v237
 v_mfma_f32_16x16x32_bf16 a[120:123],v[40:43],v[72:75],a[120:123]
 s_add_u32 s75,s74,2048
 v_add_u32 v238,4294868992,v238
 v_add_u32 v239,4294868992,v239
 v_mfma_f32_16x16x32_bf16 a[120:123],v[44:47],v[88:91],a[120:123]
 buffer_load_dwordx4 a[224:227],v4,s[4:7],s75 offen sc1
 v_mfma_f32_16x16x32_bf16 a[124:127],v[44:47],v[92:95],a[124:127]
 v_mfma_f32_16x16x32_bf16 a[124:127],v[40:43],v[76:79],a[124:127]
 s_waitcnt lgkmcnt(4)
 v_mfma_f32_16x16x32_bf16 a[128:131],v[16:19],v[64:67],a[128:131]
 s_waitcnt vmcnt(41)
 s_barrier
 v_mfma_f32_16x16x32_bf16 a[128:131],v[20:23],v[80:83],a[128:131]
 ds_read_b64_tr_b16 v[32:33],v236
 ds_read_b64_tr_b16 v[34:35],v236 offset:6144
 v_mfma_f32_16x16x32_bf16 a[132:135],v[20:23],v[84:87],a[132:135]
 buffer_load_dwordx4 v2,s[12:15],s44 offen offset:1024 lds
 v_mfma_f32_16x16x32_bf16 a[132:135],v[16:19],v[68:71],a[132:135]
 v_mfma_f32_16x16x32_bf16 a[136:139],v[16:19],v[72:75],a[136:139]
 ds_read_b64_tr_b16 v[36:37],v236 offset:12288
 ds_read_b64_tr_b16 v[38:39],v236 offset:18432
 v_mfma_f32_16x16x32_bf16 a[136:139],v[20:23],v[88:91],a[136:139]
 buffer_load_dwordx4 a[240:243],v4,s[4:7],s75 offen offset:1024 sc1
 v_mfma_f32_16x16x32_bf16 a[140:143],v[20:23],v[92:95],a[140:143]
 v_mfma_f32_16x16x32_bf16 a[140:143],v[16:19],v[76:79],a[140:143]
 s_waitcnt lgkmcnt(4)
 v_mfma_f32_16x16x32_bf16 a[144:147],v[24:27],v[64:67],a[144:147]
 ds_read_b64_tr_b16 v[40:41],v237
 ds_read_b64_tr_b16 v[42:43],v237 offset:6144
 v_mfma_f32_16x16x32_bf16 a[144:147],v[28:31],v[80:83],a[144:147]
 v_mfma_f32_16x16x32_bf16 a[148:151],v[28:31],v[84:87],a[148:151]
 buffer_load_dwordx4 v3,s[12:15],s44 offen offset:2048 lds
 v_mfma_f32_16x16x32_bf16 a[148:151],v[24:27],v[68:71],a[148:151]
 ds_read_b64_tr_b16 v[44:45],v237 offset:12288
 ds_read_b64_tr_b16 v[46:47],v237 offset:18432
 v_mfma_f32_16x16x32_bf16 a[152:155],v[24:27],v[72:75],a[152:155]
 v_mfma_f32_16x16x32_bf16 a[152:155],v[28:31],v[88:91],a[152:155]
 v_mfma_f32_16x16x32_bf16 a[156:159],v[28:31],v[92:95],a[156:159]
 v_mfma_f32_16x16x32_bf16 a[156:159],v[24:27],v[76:79],a[156:159]
 s_add_u32 s75,s74,198656
 s_waitcnt vmcnt(23) lgkmcnt(4)
 v_mfma_f32_16x16x32_bf16 a[0:3],v[32:35],v[96:99],a[0:3]
 buffer_load_dwordx4 a[228:231],v4,s[4:7],s75 offen sc1
 ds_read_b64_tr_b16 v[16:17],v238
 ds_read_b64_tr_b16 v[18:19],v238 offset:6144
 v_mfma_f32_16x16x32_bf16 a[0:3],v[36:39],v[112:115],a[0:3]
 v_and_b32 v12,15,v0
 v_lshlrev_b32 v12,2,v12
 v_mfma_f32_16x16x32_bf16 a[4:7],v[36:39],v[116:119],a[4:7]
 s_lshl_b32 s42,s34,6
 s_add_u32 s42,s42,4096
 v_add_u32 v12,s42,v12
 v_mfma_f32_16x16x32_bf16 a[4:7],v[32:35],v[100:103],a[4:7]
 ds_read_b64_tr_b16 v[20:21],v238 offset:12288
 ds_read_b64_tr_b16 v[22:23],v238 offset:18432
 v_mfma_f32_16x16x32_bf16 a[8:11],v[32:35],v[104:107],a[8:11]
 s_cmp_le_u32 s53,2
 s_cselect_b32 s39,3,2
 buffer_load_dword v13,v12,s[92:95],0 offen sc1
 v_mfma_f32_16x16x32_bf16 a[8:11],v[36:39],v[120:123],a[8:11]
 s_add_u32 m0,s35,49152
 s_mul_i32 s39,s39,245760
 buffer_load_dwordx4 v1,s[12:15],s39 offen lds
 v_mfma_f32_16x16x32_bf16 a[12:15],v[36:39],v[124:127],a[12:15]
 v_mfma_f32_16x16x32_bf16 a[12:15],v[32:35],v[108:111],a[12:15]
 s_waitcnt lgkmcnt(4)
 v_mfma_f32_16x16x32_bf16 a[16:19],v[40:43],v[96:99],a[16:19]
 ds_read_b64_tr_b16 v[24:25],v239
 ds_read_b64_tr_b16 v[26:27],v239 offset:6144
 v_mfma_f32_16x16x32_bf16 a[16:19],v[44:47],v[112:115],a[16:19]
 v_mfma_f32_16x16x32_bf16 a[20:23],v[44:47],v[116:119],a[20:23]
 buffer_load_dwordx4 v2,s[12:15],s39 offen offset:1024 lds
 v_mfma_f32_16x16x32_bf16 a[20:23],v[40:43],v[100:103],a[20:23]
 ds_read_b64_tr_b16 v[28:29],v239 offset:12288
 ds_read_b64_tr_b16 v[30:31],v239 offset:18432
 v_mfma_f32_16x16x32_bf16 a[24:27],v[40:43],v[104:107],a[24:27]
 v_mfma_f32_16x16x32_bf16 a[24:27],v[44:47],v[120:123],a[24:27]
 v_mfma_f32_16x16x32_bf16 a[28:31],v[44:47],v[124:127],a[28:31]
 buffer_load_dwordx4 a[244:247],v4,s[4:7],s75 offen offset:1024 sc1
 v_mfma_f32_16x16x32_bf16 a[28:31],v[40:43],v[108:111],a[28:31]
 s_waitcnt lgkmcnt(4)
 v_mfma_f32_16x16x32_bf16 a[32:35],v[16:19],v[96:99],a[32:35]
 ds_read_b64_tr_b16 v[32:33],v236 offset:128
 ds_read_b64_tr_b16 v[34:35],v236 offset:6272
 v_mfma_f32_16x16x32_bf16 a[32:35],v[20:23],v[112:115],a[32:35]
 v_mfma_f32_16x16x32_bf16 a[36:39],v[20:23],v[116:119],a[36:39]
 v_mfma_f32_16x16x32_bf16 a[36:39],v[16:19],v[100:103],a[36:39]
 ds_read_b64_tr_b16 v[36:37],v236 offset:12416
 ds_read_b64_tr_b16 v[38:39],v236 offset:18560
 v_mfma_f32_16x16x32_bf16 a[40:43],v[16:19],v[104:107],a[40:43]
 buffer_load_dwordx4 v3,s[12:15],s39 offen offset:2048 lds
 v_mfma_f32_16x16x32_bf16 a[40:43],v[20:23],v[120:123],a[40:43]
 v_mfma_f32_16x16x32_bf16 a[44:47],v[20:23],v[124:127],a[44:47]
 v_mfma_f32_16x16x32_bf16 a[44:47],v[16:19],v[108:111],a[44:47]
 s_waitcnt lgkmcnt(4)
 v_mfma_f32_16x16x32_bf16 a[48:51],v[24:27],v[96:99],a[48:51]
 s_add_u32 s75,s74,395264
 ds_read_b64_tr_b16 v[40:41],v237 offset:128
 ds_read_b64_tr_b16 v[42:43],v237 offset:6272
 v_mfma_f32_16x16x32_bf16 a[48:51],v[28:31],v[112:115],a[48:51]
 buffer_load_dwordx4 a[232:235],v4,s[4:7],s75 offen sc1
 v_mfma_f32_16x16x32_bf16 a[52:55],v[28:31],v[116:119],a[52:55]
 v_mfma_f32_16x16x32_bf16 a[52:55],v[24:27],v[100:103],a[52:55]
 ds_read_b64_tr_b16 v[44:45],v237 offset:12416
 ds_read_b64_tr_b16 v[46:47],v237 offset:18560
 v_mfma_f32_16x16x32_bf16 a[56:59],v[24:27],v[104:107],a[56:59]
 v_mfma_f32_16x16x32_bf16 a[56:59],v[28:31],v[120:123],a[56:59]
 v_mfma_f32_16x16x32_bf16 a[60:63],v[28:31],v[124:127],a[60:63]
 v_mfma_f32_16x16x32_bf16 a[60:63],v[24:27],v[108:111],a[60:63]
 s_waitcnt lgkmcnt(4)
 v_mfma_f32_16x16x32_bf16 a[64:67],v[32:35],v[96:99],a[64:67]
 ds_read_b64_tr_b16 v[16:17],v238 offset:128
 ds_read_b64_tr_b16 v[18:19],v238 offset:6272
 v_mfma_f32_16x16x32_bf16 a[64:67],v[36:39],v[112:115],a[64:67]
 s_add_u32 m0,s35,52224
 s_add_u32 s44,s39,10240
 buffer_load_dwordx4 v1,s[12:15],s44 offen lds
 v_mfma_f32_16x16x32_bf16 a[68:71],v[36:39],v[116:119],a[68:71]
 v_mfma_f32_16x16x32_bf16 a[68:71],v[32:35],v[100:103],a[68:71]
 ds_read_b64_tr_b16 v[20:21],v238 offset:12416
 ds_read_b64_tr_b16 v[22:23],v238 offset:18560
 v_mfma_f32_16x16x32_bf16 a[72:75],v[32:35],v[104:107],a[72:75]
 buffer_load_dwordx4 v2,s[12:15],s44 offen offset:1024 lds
 v_mfma_f32_16x16x32_bf16 a[72:75],v[36:39],v[120:123],a[72:75]
 buffer_load_dwordx4 a[248:251],v4,s[4:7],s75 offen offset:1024 sc1
 v_mfma_f32_16x16x32_bf16 a[76:79],v[36:39],v[124:127],a[76:79]
 v_mfma_f32_16x16x32_bf16 a[76:79],v[32:35],v[108:111],a[76:79]
 s_waitcnt lgkmcnt(4)
 v_mfma_f32_16x16x32_bf16 a[80:83],v[40:43],v[96:99],a[80:83]
 ds_read_b64_tr_b16 v[24:25],v239 offset:128
 ds_read_b64_tr_b16 v[26:27],v239 offset:6272
 v_mfma_f32_16x16x32_bf16 a[80:83],v[44:47],v[112:115],a[80:83]
 v_mfma_f32_16x16x32_bf16 a[84:87],v[44:47],v[116:119],a[84:87]
 buffer_load_dwordx4 v3,s[12:15],s44 offen offset:2048 lds
 v_mfma_f32_16x16x32_bf16 a[84:87],v[40:43],v[100:103],a[84:87]
 s_add_u32 s75,s74,591872
 ds_read_b64_tr_b16 v[28:29],v239 offset:12416
 ds_read_b64_tr_b16 v[30:31],v239 offset:18560
 v_mfma_f32_16x16x32_bf16 a[88:91],v[40:43],v[104:107],a[88:91]
 buffer_load_dwordx4 a[236:239],v4,s[4:7],s75 offen sc1
 v_mfma_f32_16x16x32_bf16 a[88:91],v[44:47],v[120:123],a[88:91]
 v_mfma_f32_16x16x32_bf16 a[92:95],v[44:47],v[124:127],a[92:95]
 s_add_u32 m0,s35,98304
 s_add_u32 s39,s39,81920
 buffer_load_dwordx4 v1,s[12:15],s39 offen lds
 v_mfma_f32_16x16x32_bf16 a[92:95],v[40:43],v[108:111],a[92:95]
 s_waitcnt lgkmcnt(4)
 v_mfma_f32_16x16x32_bf16 a[96:99],v[16:19],v[96:99],a[96:99]
 ds_read_b64_tr_b16 v[32:33],v236 offset:256
 ds_read_b64_tr_b16 v[34:35],v236 offset:6400
 v_mfma_f32_16x16x32_bf16 a[96:99],v[20:23],v[112:115],a[96:99]
 v_mfma_f32_16x16x32_bf16 a[100:103],v[20:23],v[116:119],a[100:103]
 buffer_load_dwordx4 a[252:255],v4,s[4:7],s75 offen offset:1024 sc1
 v_mfma_f32_16x16x32_bf16 a[100:103],v[16:19],v[100:103],a[100:103]
 ds_read_b64_tr_b16 v[36:37],v236 offset:12544
 ds_read_b64_tr_b16 v[38:39],v236 offset:18688
 v_mfma_f32_16x16x32_bf16 a[104:107],v[16:19],v[104:107],a[104:107]
 buffer_load_dwordx4 v2,s[12:15],s39 offen offset:1024 lds
 v_mfma_f32_16x16x32_bf16 a[104:107],v[20:23],v[120:123],a[104:107]
 v_mfma_f32_16x16x32_bf16 a[108:111],v[20:23],v[124:127],a[108:111]
 v_mfma_f32_16x16x32_bf16 a[108:111],v[16:19],v[108:111],a[108:111]
 s_waitcnt lgkmcnt(4)
 v_mfma_f32_16x16x32_bf16 a[112:115],v[24:27],v[96:99],a[112:115]
 ds_read_b64_tr_b16 v[40:41],v237 offset:256
 ds_read_b64_tr_b16 v[42:43],v237 offset:6400
 v_mfma_f32_16x16x32_bf16 a[112:115],v[28:31],v[112:115],a[112:115]
 buffer_load_dwordx4 v3,s[12:15],s39 offen offset:2048 lds
 v_mfma_f32_16x16x32_bf16 a[116:119],v[28:31],v[116:119],a[116:119]
 ds_read_b64_tr_b16 v[44:45],v237 offset:12544
 ds_read_b64_tr_b16 v[46:47],v237 offset:18688
 v_mfma_f32_16x16x32_bf16 a[116:119],v[24:27],v[100:103],a[116:119]
 v_add_u32 v236,49152,v236
 v_add_u32 v237,49152,v237
 v_mfma_f32_16x16x32_bf16 a[120:123],v[24:27],v[104:107],a[120:123]
 s_add_u32 s75,s74,4096
 v_add_u32 v238,49152,v238
 v_add_u32 v239,49152,v239
 v_mfma_f32_16x16x32_bf16 a[120:123],v[28:31],v[120:123],a[120:123]
 buffer_load_dwordx4 a[160:163],v4,s[4:7],s75 offen sc1
 v_mfma_f32_16x16x32_bf16 a[124:127],v[28:31],v[124:127],a[124:127]
 s_add_u32 m0,s35,101376
 s_add_u32 s44,s39,10240
 buffer_load_dwordx4 v1,s[12:15],s44 offen lds
 v_mfma_f32_16x16x32_bf16 a[124:127],v[24:27],v[108:111],a[124:127]
 s_waitcnt lgkmcnt(4)
 v_mfma_f32_16x16x32_bf16 a[128:131],v[32:35],v[96:99],a[128:131]
 buffer_load_dwordx4 a[176:179],v4,s[4:7],s75 offen offset:1024 sc1
 s_waitcnt vmcnt(19)
 s_barrier
 v_mfma_f32_16x16x32_bf16 a[128:131],v[36:39],v[112:115],a[128:131]
 ds_read_b64_tr_b16 v[16:17],v236
 ds_read_b64_tr_b16 v[18:19],v236 offset:6144
 v_mfma_f32_16x16x32_bf16 a[132:135],v[36:39],v[116:119],a[132:135]
 buffer_load_dwordx4 v2,s[12:15],s44 offen offset:1024 lds
 s_add_u32 s75,s74,200704
 v_mfma_f32_16x16x32_bf16 a[132:135],v[32:35],v[100:103],a[132:135]
 buffer_load_dwordx4 a[164:167],v4,s[4:7],s75 offen sc1
 v_mfma_f32_16x16x32_bf16 a[136:139],v[32:35],v[104:107],a[136:139]
 ds_read_b64_tr_b16 v[20:21],v236 offset:12288
 ds_read_b64_tr_b16 v[22:23],v236 offset:18432
 v_mfma_f32_16x16x32_bf16 a[136:139],v[36:39],v[120:123],a[136:139]
 buffer_load_dwordx4 v3,s[12:15],s44 offen offset:2048 lds
 s_waitcnt vmcnt(20)
 v_cmp_ne_u32 vcc,s51,v13
 s_nop 1
 s_cbranch_vccnz Lp27_spin
Lp27_ok:
 v_mfma_f32_16x16x32_bf16 a[140:143],v[36:39],v[124:127],a[140:143]
 v_mfma_f32_16x16x32_bf16 a[140:143],v[32:35],v[108:111],a[140:143]
 s_waitcnt lgkmcnt(4)
 v_mfma_f32_16x16x32_bf16 a[144:147],v[40:43],v[96:99],a[144:147]
 s_add_u32 m0,s35,0
 s_add_u32 s39,s39,81920
 buffer_load_dwordx4 v1,s[12:15],s39 offen lds
 ds_read_b64_tr_b16 v[24:25],v237
 ds_read_b64_tr_b16 v[26:27],v237 offset:6144
 v_mfma_f32_16x16x32_bf16 a[144:147],v[44:47],v[112:115],a[144:147]
 s_mul_i32 s41,s71,20480
 s_mul_i32 s42,s60,160
 s_add_u32 s41,s41,s42
 v_mfma_f32_16x16x32_bf16 a[148:151],v[44:47],v[116:119],a[148:151]
 buffer_load_dwordx4 a[180:183],v4,s[4:7],s75 offen offset:1024 sc1
 s_and_b32 s58,s60,1
 s_lshl_b32 s59,s58,5
 s_sub_u32 s41,s41,s59
 v_mfma_f32_16x16x32_bf16 a[148:151],v[40:43],v[100:103],a[148:151]
 ds_read_b64_tr_b16 v[28:29],v237 offset:12288
 ds_read_b64_tr_b16 v[30:31],v237 offset:18432
 v_mfma_f32_16x16x32_bf16 a[152:155],v[40:43],v[104:107],a[152:155]
 buffer_load_dwordx4 v2,s[12:15],s39 offen offset:1024 lds
 s_add_u32 s20,s64,s41
 s_addc_u32 s21,s65,0
 v_mfma_f32_16x16x32_bf16 a[152:155],v[44:47],v[120:123],a[152:155]
 s_mov_b32 s22,19392
 s_mov_b32 s23,0x20000
 v_mfma_f32_16x16x32_bf16 a[156:159],v[44:47],v[124:127],a[156:159]
 s_add_u32 s75,s74,397312
 s_add_u32 s8,s84,s41
 s_addc_u32 s9,s85,0
 v_mfma_f32_16x16x32_bf16 a[156:159],v[40:43],v[108:111],a[156:159]
 s_waitcnt vmcnt(40) lgkmcnt(4)
 s_mov_b32 s10,19392
 s_mov_b32 s11,0x20000
 v_mfma_f32_16x16x32_bf16 a[0:3],v[16:19],v[128:131],a[0:3]
 buffer_load_dwordx4 a[168:171],v4,s[4:7],s75 offen sc1
 ds_read_b64_tr_b16 v[32:33],v238
 ds_read_b64_tr_b16 v[34:35],v238 offset:6144
 v_mfma_f32_16x16x32_bf16 a[0:3],v[20:23],v[144:147],a[0:3]
 s_mul_i32 s41,s71,20480
 s_add_u32 s41,s41,2621440
 s_and_b32 s57,s60,1
 v_mfma_f32_16x16x32_bf16 a[4:7],v[20:23],v[148:151],a[4:7]
 buffer_load_dwordx4 v3,s[12:15],s39 offen offset:2048 lds
 s_mul_i32 s56,s60,5
 s_add_u32 s56,s56,s57
 s_lshl_b32 s56,s56,9
 v_mfma_f32_16x16x32_bf16 a[4:7],v[16:19],v[132:135],a[4:7]
 ds_read_b64_tr_b16 v[36:37],v238 offset:12288
 ds_read_b64_tr_b16 v[38:39],v238 offset:18432
 v_mfma_f32_16x16x32_bf16 a[8:11],v[16:19],v[136:139],a[8:11]
 s_add_u32 s56,s56,s41
 s_mul_i32 s57,s57,2560
 s_sub_u32 s57,s56,s57
 v_mfma_f32_16x16x32_bf16 a[8:11],v[20:23],v[152:155],a[8:11]
 s_add_u32 m0,s35,3072
 s_add_u32 s44,s39,10240
 buffer_load_dwordx4 v1,s[12:15],s44 offen lds
 s_add_u32 s57,s57,2048
 v_min_u32 v12,6,v0
 v_mfma_f32_16x16x32_bf16 a[12:15],v[20:23],v[156:159],a[12:15]
 buffer_load_dwordx4 a[184:187],v4,s[4:7],s75 offen offset:1024 sc1
 s_add_u32 s41,s52,1
 v_add_u32 v12,s41,v12
 v_and_b32 v12,7,v12
 v_mfma_f32_16x16x32_bf16 a[12:15],v[16:19],v[140:143],a[12:15]
 s_waitcnt lgkmcnt(4)
 v_lshlrev_b32 v12,4,v12
 v_mfma_f32_16x16x32_bf16 a[16:19],v[24:27],v[128:131],a[16:19]
 ds_read_b64_tr_b16 v[40:41],v239
 ds_read_b64_tr_b16 v[42:43],v239 offset:6144
 v_mfma_f32_16x16x32_bf16 a[16:19],v[28:31],v[144:147],a[16:19]
 s_lshl_b32 s42,s34,7
 s_lshl_b32 s41,s53,2
 v_mfma_f32_16x16x32_bf16 a[20:23],v[28:31],v[148:151],a[20:23]
 buffer_load_dwordx4 v2,s[12:15],s44 offen offset:1024 lds
 s_add_u32 s42,s42,s41
 s_add_u32 s42,s42,5120
 v_add_u32 v12,s42,v12
 v_mfma_f32_16x16x32_bf16 a[20:23],v[24:27],v[132:135],a[20:23]
 ds_read_b64_tr_b16 v[44:45],v239 offset:12288
 ds_read_b64_tr_b16 v[46:47],v239 offset:18432
 v_mfma_f32_16x16x32_bf16 a[24:27],v[24:27],v[136:139],a[24:27]
 v_add_u32 v6,s55,v4
 v_add_u32 v8,49152,v6
 v_mfma_f32_16x16x32_bf16 a[24:27],v[28:31],v[152:155],a[24:27]
 s_add_u32 s75,s74,593920
 v_add_u32 v9,98304,v6
 v_mov_b32 v254,0
 v_mfma_f32_16x16x32_bf16 a[28:31],v[28:31],v[156:159],a[28:31]
 buffer_load_dwordx4 a[172:175],v4,s[4:7],s75 offen sc1
 v_mov_b32 v255,0
 v_mfma_f32_16x16x32_bf16 a[28:31],v[24:27],v[140:143],a[28:31]
 s_waitcnt lgkmcnt(4)
 v_mfma_f32_16x16x32_bf16 a[32:35],v[32:35],v[128:131],a[32:35]
 buffer_load_dwordx4 v3,s[12:15],s44 offen offset:2048 lds
 ds_read_b64_tr_b16 v[16:17],v236 offset:128
 ds_read_b64_tr_b16 v[18:19],v236 offset:6272
 v_mfma_f32_16x16x32_bf16 a[32:35],v[36:39],v[144:147],a[32:35]
 s_mul_i32 s49,s32,24576
 s_add_u32 s49,s49,20480
 s_mov_b32 s61,0
 v_mfma_f32_16x16x32_bf16 a[36:39],v[36:39],v[148:151],a[36:39]
 s_add_u32 s38,s38,s52
 s_mul_i32 s38,s38,81920
 s_mul_i32 s70,s32,2560
 v_mfma_f32_16x16x32_bf16 a[36:39],v[32:35],v[132:135],a[36:39]
 buffer_load_dwordx4 a[188:191],v4,s[4:7],s75 offen offset:1024 sc1
 ds_read_b64_tr_b16 v[20:21],v236 offset:12416
 ds_read_b64_tr_b16 v[22:23],v236 offset:18560
 v_mfma_f32_16x16x32_bf16 a[40:43],v[32:35],v[136:139],a[40:43]
 s_add_u32 s38,s38,s70
 s_add_u32 s38,s38,39960576
 v_mfma_f32_16x16x32_bf16 a[40:43],v[36:39],v[152:155],a[40:43]
 s_mov_b32 s16,s88
 s_mov_b32 s17,s89
 s_mov_b32 s19,0x20000
 v_mfma_f32_16x16x32_bf16 a[44:47],v[36:39],v[156:159],a[44:47]
 s_lshl_b32 s41,s32,1
 s_add_u32 s41,s41,0
 v_mfma_f32_16x16x32_bf16 a[44:47],v[32:35],v[140:143],a[44:47]
 s_waitcnt lgkmcnt(4)
 s_cmp_lg_u32 s41,s52
 s_cselect_b32 s18,60932096,0
 v_mfma_f32_16x16x32_bf16 a[48:51],v[40:43],v[128:131],a[48:51]
 s_add_u32 s63,s63,20480
 ds_read_b64_tr_b16 v[24:25],v237 offset:128
 ds_read_b64_tr_b16 v[26:27],v237 offset:6272
 v_mfma_f32_16x16x32_bf16 a[48:51],v[44:47],v[144:147],a[48:51]
 s_cmp_eq_u32 s63,245760
 s_cselect_b32 s63,0,s63
 s_add_u32 m0,s55,122880
 s_nop 0
 buffer_load_dwordx4 v4,s[24:27],s63 offen sc1 lds
 v_add_u32 v240,24576,v236
 v_add_u32 v232,4294893568,v236
 v_mfma_f32_16x16x32_bf16 a[52:55],v[44:47],v[148:151],a[52:55]
 v_add_u32 v241,24576,v237
 v_add_u32 v233,4294893568,v237
 v_mfma_f32_16x16x32_bf16 a[52:55],v[40:43],v[132:135],a[52:55]
 s_add_u32 s76,s76,4096
 ds_read_b64_tr_b16 v[28:29],v237 offset:12416
 ds_read_b64_tr_b16 v[30:31],v237 offset:18560
 v_mfma_f32_16x16x32_bf16 a[56:59],v[40:43],v[136:139],a[56:59]
 s_cmp_eq_u32 s76,49152
 s_cselect_b32 s76,0,s76
 s_add_u32 s77,s76,s72
 v_add_u32 v242,24576,v238
 v_add_u32 v234,4294893568,v238
 v_mfma_f32_16x16x32_bf16 a[56:59],v[44:47],v[152:155],a[56:59]
 buffer_load_dwordx4 v[160:163],v4,s[28:31],s77 offen sc1
 v_add_u32 v243,24576,v239
 v_add_u32 v235,4294893568,v239
 v_mfma_f32_16x16x32_bf16 a[60:63],v[44:47],v[156:159],a[60:63]
 s_mov_b32 s80,s88
 s_mov_b32 s81,s89
 s_mov_b32 s83,0x20000
 v_mfma_f32_16x16x32_bf16 a[60:63],v[40:43],v[140:143],a[60:63]
 s_waitcnt lgkmcnt(4)
 s_lshl_b32 s41,s32,1
 s_add_u32 s41,s41,1
 v_mfma_f32_16x16x32_bf16 a[64:67],v[16:19],v[128:131],a[64:67]
 ds_read_b64_tr_b16 v[32:33],v238 offset:128
 ds_read_b64_tr_b16 v[34:35],v238 offset:6272
 v_mfma_f32_16x16x32_bf16 a[64:67],v[20:23],v[144:147],a[64:67]
 s_cmp_lg_u32 s41,s52
 s_cselect_b32 s82,60932096,0
 v_add_u32 v10,147456,v4
 v_mfma_f32_16x16x32_bf16 a[68:71],v[20:23],v[148:151],a[68:71]
 v_add_u32 v11,147456,v5
 v_mfma_f32_16x16x32_bf16 a[68:71],v[16:19],v[132:135],a[68:71]
 ds_read_b64_tr_b16 v[36:37],v238 offset:12416
 ds_read_b64_tr_b16 v[38:39],v238 offset:18560
 v_mfma_f32_16x16x32_bf16 a[72:75],v[16:19],v[136:139],a[72:75]
 v_mfma_f32_16x16x32_bf16 a[72:75],v[20:23],v[152:155],a[72:75]
 v_mfma_f32_16x16x32_bf16 a[76:79],v[20:23],v[156:159],a[76:79]
 v_mfma_f32_16x16x32_bf16 a[76:79],v[16:19],v[140:143],a[76:79]
 s_waitcnt lgkmcnt(4)
 v_mfma_f32_16x16x32_bf16 a[80:83],v[24:27],v[128:131],a[80:83]
 ds_read_b64_tr_b16 v[40:41],v239 offset:128
 ds_read_b64_tr_b16 v[42:43],v239 offset:6272
 v_mfma_f32_16x16x32_bf16 a[80:83],v[28:31],v[144:147],a[80:83]
 v_mfma_f32_16x16x32_bf16 a[84:87],v[28:31],v[148:151],a[84:87]
 v_mfma_f32_16x16x32_bf16 a[84:87],v[24:27],v[132:135],a[84:87]
 ds_read_b64_tr_b16 v[44:45],v239 offset:12416
 ds_read_b64_tr_b16 v[46:47],v239 offset:18560
 v_mfma_f32_16x16x32_bf16 a[88:91],v[24:27],v[136:139],a[88:91]
 buffer_load_dwordx4 v4,s[24:27],s63 offen offset:1024 sc1 lds
 v_mfma_f32_16x16x32_bf16 a[88:91],v[28:31],v[152:155],a[88:91]
 v_mfma_f32_16x16x32_bf16 a[92:95],v[28:31],v[156:159],a[92:95]
 v_mfma_f32_16x16x32_bf16 a[92:95],v[24:27],v[140:143],a[92:95]
 s_waitcnt lgkmcnt(4)
 v_mfma_f32_16x16x32_bf16 a[96:99],v[32:35],v[128:131],a[96:99]
 ds_read_b64_tr_b16 v[16:17],v236 offset:256
 ds_read_b64_tr_b16 v[18:19],v236 offset:6400
 v_mfma_f32_16x16x32_bf16 a[96:99],v[36:39],v[144:147],a[96:99]
 v_mfma_f32_16x16x32_bf16 a[100:103],v[36:39],v[148:151],a[100:103]
 v_mfma_f32_16x16x32_bf16 a[100:103],v[32:35],v[132:135],a[100:103]
 ds_read_b64_tr_b16 v[20:21],v236 offset:12544
 ds_read_b64_tr_b16 v[22:23],v236 offset:18688
 v_mfma_f32_16x16x32_bf16 a[104:107],v[32:35],v[136:139],a[104:107]
 v_mfma_f32_16x16x32_bf16 a[104:107],v[36:39],v[152:155],a[104:107]
 v_mfma_f32_16x16x32_bf16 a[108:111],v[36:39],v[156:159],a[108:111]
 v_mfma_f32_16x16x32_bf16 a[108:111],v[32:35],v[140:143],a[108:111]
 s_waitcnt lgkmcnt(4)
 v_mfma_f32_16x16x32_bf16 a[112:115],v[40:43],v[128:131],a[112:115]
 ds_read_b64_tr_b16 v[24:25],v237 offset:256
 ds_read_b64_tr_b16 v[26:27],v237 offset:6400
 v_mfma_f32_16x16x32_bf16 a[112:115],v[44:47],v[144:147],a[112:115]
 buffer_load_dwordx4 v4,s[24:27],s63 offen offset:2048 sc1 lds
 v_mfma_f32_16x16x32_bf16 a[116:119],v[44:47],v[148:151],a[116:119]
 ds_read_b64_tr_b16 v[28:29],v237 offset:12544
 ds_read_b64_tr_b16 v[30:31],v237 offset:18688
 v_mfma_f32_16x16x32_bf16 a[116:119],v[40:43],v[132:135],a[116:119]
 v_add_u32 v236,4294942720,v236
 v_add_u32 v237,4294942720,v237
 v_mfma_f32_16x16x32_bf16 a[120:123],v[40:43],v[136:139],a[120:123]
 v_add_u32 v238,4294942720,v238
 v_add_u32 v239,4294942720,v239
 v_mfma_f32_16x16x32_bf16 a[120:123],v[44:47],v[152:155],a[120:123]
 v_mfma_f32_16x16x32_bf16 a[124:127],v[44:47],v[156:159],a[124:127]
 v_mfma_f32_16x16x32_bf16 a[124:127],v[40:43],v[140:143],a[124:127]
 s_waitcnt lgkmcnt(4)
 v_mfma_f32_16x16x32_bf16 a[128:131],v[16:19],v[128:131],a[128:131]
 s_waitcnt vmcnt(5)
 s_barrier
 v_mfma_f32_16x16x32_bf16 a[128:131],v[20:23],v[144:147],a[128:131]
 ds_read_b64_tr_b16 v[32:33],v236
 ds_read_b64_tr_b16 v[34:35],v236 offset:6144
 v_mfma_f32_16x16x32_bf16 a[132:135],v[20:23],v[148:151],a[132:135]
 buffer_load_dwordx4 v4,s[24:27],s63 offen offset:3072 sc1 lds
 v_mfma_f32_16x16x32_bf16 a[132:135],v[16:19],v[132:135],a[132:135]
 v_mfma_f32_16x16x32_bf16 a[136:139],v[16:19],v[136:139],a[136:139]
 ds_read_b64_tr_b16 v[36:37],v236 offset:12288
 ds_read_b64_tr_b16 v[38:39],v236 offset:18432
 v_mfma_f32_16x16x32_bf16 a[136:139],v[20:23],v[152:155],a[136:139]
 v_mfma_f32_16x16x32_bf16 a[140:143],v[20:23],v[156:159],a[140:143]
 v_mfma_f32_16x16x32_bf16 a[140:143],v[16:19],v[140:143],a[140:143]
 s_waitcnt lgkmcnt(4)
 v_mfma_f32_16x16x32_bf16 a[144:147],v[24:27],v[128:131],a[144:147]
 ds_read_b64_tr_b16 v[40:41],v240
 ds_read_b64_tr_b16 v[42:43],v240 offset:6144
 v_mfma_f32_16x16x32_bf16 a[144:147],v[28:31],v[144:147],a[144:147]
 v_mfma_f32_16x16x32_bf16 a[148:151],v[28:31],v[148:151],a[148:151]
 v_mfma_f32_16x16x32_bf16 a[148:151],v[24:27],v[132:135],a[148:151]
 ds_read_b64_tr_b16 v[44:45],v240 offset:12288
 ds_read_b64_tr_b16 v[46:47],v240 offset:18432
 v_mfma_f32_16x16x32_bf16 a[152:155],v[24:27],v[136:139],a[152:155]
 v_mfma_f32_16x16x32_bf16 a[152:155],v[28:31],v[152:155],a[152:155]
 v_mfma_f32_16x16x32_bf16 a[156:159],v[28:31],v[156:159],a[156:159]
 s_add_u32 m0,s55,126976
 s_add_u32 s44,s63,4096
 buffer_load_dwordx4 v4,s[24:27],s44 offen sc1 lds
 v_mfma_f32_16x16x32_bf16 a[156:159],v[24:27],v[140:143],a[156:159]
 s_waitcnt vmcnt(6) lgkmcnt(4)
 v_mfma_f32_16x16x32_bf16 a[0:3],v[32:35],a[192:195],a[0:3]
 ds_read_b64_tr_b16 v[16:17],v232
 ds_read_b64_tr_b16 v[18:19],v232 offset:6144
 v_mfma_f32_16x16x32_bf16 a[0:3],v[36:39],a[208:211],a[0:3]
 v_mfma_f32_16x16x32_bf16 a[4:7],v[36:39],a[212:215],a[4:7]
 v_mfma_f32_16x16x32_bf16 a[4:7],v[32:35],a[196:199],a[4:7]
 ds_read_b64_tr_b16 v[20:21],v232 offset:12288
 ds_read_b64_tr_b16 v[22:23],v232 offset:18432
 v_mfma_f32_16x16x32_bf16 a[8:11],v[32:35],a[200:203],a[8:11]
 v_mfma_f32_16x16x32_bf16 a[8:11],v[36:39],a[216:219],a[8:11]
 v_mfma_f32_16x16x32_bf16 a[12:15],v[36:39],a[220:223],a[12:15]
 v_mfma_f32_16x16x32_bf16 a[12:15],v[32:35],a[204:207],a[12:15]
 s_waitcnt lgkmcnt(4)
 v_mfma_f32_16x16x32_bf16 a[0:3],v[40:43],a[224:227],a[0:3]
 s_add_u32 s63,s63,20480
 ds_read_b64_tr_b16 v[24:25],v237
 ds_read_b64_tr_b16 v[26:27],v237 offset:6144
 v_mfma_f32_16x16x32_bf16 a[0:3],v[44:47],a[240:243],a[0:3]
 s_cmp_eq_u32 s63,245760
 s_cselect_b32 s63,0,s63
 v_mfma_f32_16x16x32_bf16 a[4:7],v[44:47],a[244:247],a[4:7]
 s_add_u32 m0,s55,24576
 s_nop 0
 buffer_load_dwordx4 v4,s[24:27],s63 offen sc1 lds
 v_mfma_f32_16x16x32_bf16 a[4:7],v[40:43],a[228:231],a[4:7]
 ds_read_b64_tr_b16 v[28:29],v237 offset:12288
 ds_read_b64_tr_b16 v[30:31],v237 offset:18432
 v_mfma_f32_16x16x32_bf16 a[8:11],v[40:43],a[232:235],a[8:11]
 v_mfma_f32_16x16x32_bf16 a[8:11],v[44:47],a[248:251],a[8:11]
 v_mfma_f32_16x16x32_bf16 a[12:15],v[44:47],a[252:255],a[12:15]
 v_mfma_f32_16x16x32_bf16 a[12:15],v[40:43],a[236:239],a[12:15]
 s_waitcnt lgkmcnt(4)
 v_mfma_f32_16x16x32_bf16 a[0:3],v[16:19],a[160:163],a[0:3]
 ds_read_b64_tr_b16 v[32:33],v241
 ds_read_b64_tr_b16 v[34:35],v241 offset:6144
 v_mfma_f32_16x16x32_bf16 a[0:3],v[20:23],a[176:179],a[0:3]
 v_mfma_f32_16x16x32_bf16 a[4:7],v[20:23],a[180:183],a[4:7]
 v_mfma_f32_16x16x32_bf16 a[4:7],v[16:19],a[164:167],a[4:7]
 ds_read_b64_tr_b16 v[36:37],v241 offset:12288
 ds_read_b64_tr_b16 v[38:39],v241 offset:18432
 v_mfma_f32_16x16x32_bf16 a[8:11],v[16:19],a[168:171],a[8:11]
 v_mfma_f32_16x16x32_bf16 a[8:11],v[20:23],a[184:187],a[8:11]
 v_mfma_f32_16x16x32_bf16 a[12:15],v[20:23],a[188:191],a[12:15]
 buffer_load_dwordx4 v4,s[24:27],s63 offen offset:1024 sc1 lds
 v_mfma_f32_16x16x32_bf16 a[12:15],v[16:19],a[172:175],a[12:15]
 s_waitcnt lgkmcnt(4)
 v_mfma_f32_16x16x32_bf16 a[16:19],v[24:27],a[192:195],a[16:19]
 ds_read_b64_tr_b16 v[40:41],v233
 ds_read_b64_tr_b16 v[42:43],v233 offset:6144
 v_mfma_f32_16x16x32_bf16 a[16:19],v[28:31],a[208:211],a[16:19]
 v_mfma_f32_16x16x32_bf16 a[20:23],v[28:31],a[212:215],a[20:23]
 v_mfma_f32_16x16x32_bf16 a[20:23],v[24:27],a[196:199],a[20:23]
 ds_read_b64_tr_b16 v[44:45],v233 offset:12288
 ds_read_b64_tr_b16 v[46:47],v233 offset:18432
 v_mfma_f32_16x16x32_bf16 a[24:27],v[24:27],a[200:203],a[24:27]
 v_mfma_f32_16x16x32_bf16 a[24:27],v[28:31],a[216:219],a[24:27]
 v_accvgpr_read_b32 v48,a0
 v_accvgpr_read_b32 v49,a1
 v_mfma_f32_16x16x32_bf16 a[28:31],v[28:31],a[220:223],a[28:31]
 v_accvgpr_read_b32 v50,a2
 v_accvgpr_read_b32 v51,a3
 v_mfma_f32_16x16x32_bf16 a[28:31],v[24:27],a[204:207],a[28:31]
 s_waitcnt lgkmcnt(4)
 v_cvt_pk_bf16_f32 v64,v48,v49
 v_cvt_pk_bf16_f32 v65,v50,v51
 v_mfma_f32_16x16x32_bf16 a[16:19],v[32:35],a[224:227],a[16:19]
 ds_read_b64_tr_b16 v[16:17],v238
 ds_read_b64_tr_b16 v[18:19],v238 offset:6144
 v_mfma_f32_16x16x32_bf16 a[16:19],v[36:39],a[240:243],a[16:19]
 v_accvgpr_read_b32 v52,a4
 v_accvgpr_read_b32 v53,a5
 v_mfma_f32_16x16x32_bf16 a[20:23],v[36:39],a[244:247],a[20:23]
 s_barrier
 v_accvgpr_read_b32 v54,a6
 v_accvgpr_read_b32 v55,a7
 v_mfma_f32_16x16x32_bf16 a[20:23],v[32:35],a[228:231],a[20:23]
 buffer_load_dwordx4 v4,s[24:27],s63 offen offset:2048 sc1 lds
 ds_read_b64_tr_b16 v[20:21],v238 offset:12288
 ds_read_b64_tr_b16 v[22:23],v238 offset:18432
 v_mfma_f32_16x16x32_bf16 a[24:27],v[32:35],a[232:235],a[24:27]
 v_cvt_pk_bf16_f32 v74,v52,v53
 v_cvt_pk_bf16_f32 v75,v54,v55
 v_mfma_f32_16x16x32_bf16 a[24:27],v[36:39],a[248:251],a[24:27]
 v_accvgpr_read_b32 v56,a8
 v_accvgpr_read_b32 v57,a9
 v_mfma_f32_16x16x32_bf16 a[28:31],v[36:39],a[252:255],a[28:31]
 v_accvgpr_read_b32 v58,a10
 v_accvgpr_read_b32 v59,a11
 v_mfma_f32_16x16x32_bf16 a[28:31],v[32:35],a[236:239],a[28:31]
 s_waitcnt lgkmcnt(4)
 v_cvt_pk_bf16_f32 v84,v56,v57
 v_cvt_pk_bf16_f32 v85,v58,v59
 v_mfma_f32_16x16x32_bf16 a[16:19],v[40:43],a[160:163],a[16:19]
 ds_read_b64_tr_b16 v[24:25],v242
 ds_read_b64_tr_b16 v[26:27],v242 offset:6144
 v_mfma_f32_16x16x32_bf16 a[16:19],v[44:47],a[176:179],a[16:19]
 v_accvgpr_read_b32 v60,a12
 v_accvgpr_read_b32 v61,a13
 v_mfma_f32_16x16x32_bf16 a[20:23],v[44:47],a[180:183],a[20:23]
 v_accvgpr_read_b32 v62,a14
 v_accvgpr_read_b32 v63,a15
 v_mfma_f32_16x16x32_bf16 a[20:23],v[40:43],a[164:167],a[20:23]
 ds_read_b64_tr_b16 v[28:29],v242 offset:12288
 ds_read_b64_tr_b16 v[30:31],v242 offset:18432
 v_mfma_f32_16x16x32_bf16 a[24:27],v[40:43],a[168:171],a[24:27]
 v_cvt_pk_bf16_f32 v94,v60,v61
 v_cvt_pk_bf16_f32 v95,v62,v63
 v_mfma_f32_16x16x32_bf16 a[24:27],v[44:47],a[184:187],a[24:27]
 buffer_load_dwordx4 v4,s[24:27],s63 offen offset:3072 sc1 lds
 v_mfma_f32_16x16x32_bf16 a[28:31],v[44:47],a[188:191],a[28:31]
 v_mfma_f32_16x16x32_bf16 a[28:31],v[40:43],a[172:175],a[28:31]
 s_waitcnt lgkmcnt(4)
 v_mfma_f32_16x16x32_bf16 a[32:35],v[16:19],a[192:195],a[32:35]
 ds_read_b64_tr_b16 v[32:33],v234
 ds_read_b64_tr_b16 v[34:35],v234 offset:6144
 v_mfma_f32_16x16x32_bf16 a[32:35],v[20:23],a[208:211],a[32:35]
 v_mfma_f32_16x16x32_bf16 a[36:39],v[20:23],a[212:215],a[36:39]
 v_mfma_f32_16x16x32_bf16 a[36:39],v[16:19],a[196:199],a[36:39]
 s_add_u32 s77,s76,s73
 ds_read_b64_tr_b16 v[36:37],v234 offset:12288
 ds_read_b64_tr_b16 v[38:39],v234 offset:18432
 v_mfma_f32_16x16x32_bf16 a[40:43],v[16:19],a[200:203],a[40:43]
 buffer_load_dwordx4 v[164:167],v4,s[28:31],s77 offen sc1
 v_mfma_f32_16x16x32_bf16 a[40:43],v[20:23],a[216:219],a[40:43]
 v_accvgpr_read_b32 v48,a16
 v_accvgpr_read_b32 v49,a17
 v_mfma_f32_16x16x32_bf16 a[44:47],v[20:23],a[220:223],a[44:47]
 v_accvgpr_read_b32 v50,a18
 v_accvgpr_read_b32 v51,a19
 v_mfma_f32_16x16x32_bf16 a[44:47],v[16:19],a[204:207],a[44:47]
 s_waitcnt lgkmcnt(4)
 v_cvt_pk_bf16_f32 v66,v48,v49
 v_cvt_pk_bf16_f32 v67,v50,v51
 v_mfma_f32_16x16x32_bf16 a[32:35],v[24:27],a[224:227],a[32:35]
 s_add_u32 s1,s37,0
 buffer_store_dwordx4 v[64:67],v4,s[16:19],s1 offen sc1
 ds_read_b64_tr_b16 v[40:41],v239
 ds_read_b64_tr_b16 v[42:43],v239 offset:6144
 v_mfma_f32_16x16x32_bf16 a[32:35],v[28:31],a[240:243],a[32:35]
 v_accvgpr_read_b32 v52,a20
 v_accvgpr_read_b32 v53,a21
 v_mfma_f32_16x16x32_bf16 a[36:39],v[28:31],a[244:247],a[36:39]
 v_accvgpr_read_b32 v54,a22
 v_accvgpr_read_b32 v55,a23
 v_mfma_f32_16x16x32_bf16 a[36:39],v[24:27],a[228:231],a[36:39]
 ds_read_b64_tr_b16 v[44:45],v239 offset:12288
 ds_read_b64_tr_b16 v[46:47],v239 offset:18432
 v_mfma_f32_16x16x32_bf16 a[40:43],v[24:27],a[232:235],a[40:43]
 v_cvt_pk_bf16_f32 v76,v52,v53
 v_cvt_pk_bf16_f32 v77,v54,v55
 v_mfma_f32_16x16x32_bf16 a[40:43],v[28:31],a[248:251],a[40:43]
 s_add_u32 s1,s37,2560
 buffer_store_dwordx4 v[74:77],v4,s[16:19],s1 offen sc1
 v_accvgpr_read_b32 v56,a24
 v_accvgpr_read_b32 v57,a25
 v_mfma_f32_16x16x32_bf16 a[44:47],v[28:31],a[252:255],a[44:47]
 v_accvgpr_read_b32 v58,a26
 v_accvgpr_read_b32 v59,a27
 v_mfma_f32_16x16x32_bf16 a[44:47],v[24:27],a[236:239],a[44:47]
 s_waitcnt lgkmcnt(4)
 v_cvt_pk_bf16_f32 v86,v56,v57
 v_cvt_pk_bf16_f32 v87,v58,v59
 v_mfma_f32_16x16x32_bf16 a[32:35],v[32:35],a[160:163],a[32:35]
 s_add_u32 s1,s37,5120
 buffer_store_dwordx4 v[84:87],v4,s[16:19],s1 offen sc1
 ds_read_b64_tr_b16 v[16:17],v243
 ds_read_b64_tr_b16 v[18:19],v243 offset:6144
 v_mfma_f32_16x16x32_bf16 a[32:35],v[36:39],a[176:179],a[32:35]
 v_accvgpr_read_b32 v60,a28
 v_accvgpr_read_b32 v61,a29
 v_mfma_f32_16x16x32_bf16 a[36:39],v[36:39],a[180:183],a[36:39]
 v_accvgpr_read_b32 v62,a30
 v_accvgpr_read_b32 v63,a31
 v_mfma_f32_16x16x32_bf16 a[36:39],v[32:35],a[164:167],a[36:39]
 ds_read_b64_tr_b16 v[20:21],v243 offset:12288
 ds_read_b64_tr_b16 v[22:23],v243 offset:18432
 v_mfma_f32_16x16x32_bf16 a[40:43],v[32:35],a[168:171],a[40:43]
 s_add_u32 s77,s76,s78
 v_cvt_pk_bf16_f32 v96,v60,v61
 v_cvt_pk_bf16_f32 v97,v62,v63
 v_mfma_f32_16x16x32_bf16 a[40:43],v[36:39],a[184:187],a[40:43]
 buffer_load_dwordx4 v[168:171],v4,s[28:31],s77 offen sc1
 s_add_u32 s1,s37,7680
 v_mfma_f32_16x16x32_bf16 a[44:47],v[36:39],a[188:191],a[44:47]
 buffer_store_dwordx4 v[94:97],v4,s[16:19],s1 offen sc1
 v_mfma_f32_16x16x32_bf16 a[44:47],v[32:35],a[172:175],a[44:47]
 s_waitcnt lgkmcnt(4)
 v_mfma_f32_16x16x32_bf16 a[48:51],v[40:43],a[192:195],a[48:51]
 ds_read_b64_tr_b16 v[24:25],v235
 ds_read_b64_tr_b16 v[26:27],v235 offset:6144
 v_mfma_f32_16x16x32_bf16 a[48:51],v[44:47],a[208:211],a[48:51]
 v_mfma_f32_16x16x32_bf16 a[52:55],v[44:47],a[212:215],a[52:55]
 v_mfma_f32_16x16x32_bf16 a[52:55],v[40:43],a[196:199],a[52:55]
 ds_read_b64_tr_b16 v[28:29],v235 offset:12288
 ds_read_b64_tr_b16 v[30:31],v235 offset:18432
 v_mfma_f32_16x16x32_bf16 a[56:59],v[40:43],a[200:203],a[56:59]
 v_mfma_f32_16x16x32_bf16 a[56:59],v[44:47],a[216:219],a[56:59]
 v_accvgpr_read_b32 v48,a32
 v_accvgpr_read_b32 v49,a33
 v_mfma_f32_16x16x32_bf16 a[60:63],v[44:47],a[220:223],a[60:63]
 v_accvgpr_read_b32 v50,a34
 v_accvgpr_read_b32 v51,a35
 v_mfma_f32_16x16x32_bf16 a[60:63],v[40:43],a[204:207],a[60:63]
 s_waitcnt lgkmcnt(4)
 v_cvt_pk_bf16_f32 v68,v48,v49
 v_cvt_pk_bf16_f32 v69,v50,v51
 v_mfma_f32_16x16x32_bf16 a[48:51],v[16:19],a[224:227],a[48:51]
 ds_read_b64_tr_b16 v[32:33],v236 offset:128
 ds_read_b64_tr_b16 v[34:35],v236 offset:6272
 v_mfma_f32_16x16x32_bf16 a[48:51],v[20:23],a[240:243],a[48:51]
 v_accvgpr_read_b32 v52,a36
 v_accvgpr_read_b32 v53,a37
 v_mfma_f32_16x16x32_bf16 a[52:55],v[20:23],a[244:247],a[52:55]
 v_accvgpr_read_b32 v54,a38
 v_accvgpr_read_b32 v55,a39
 v_mfma_f32_16x16x32_bf16 a[52:55],v[16:19],a[228:231],a[52:55]
 s_add_u32 s77,s76,s79
 ds_read_b64_tr_b16 v[36:37],v236 offset:12416
 ds_read_b64_tr_b16 v[38:39],v236 offset:18560
 v_mfma_f32_16x16x32_bf16 a[56:59],v[16:19],a[232:235],a[56:59]
 buffer_load_dwordx4 v[172:175],v4,s[28:31],s77 offen sc1
 v_cvt_pk_bf16_f32 v78,v52,v53
 v_cvt_pk_bf16_f32 v79,v54,v55
 v_mfma_f32_16x16x32_bf16 a[56:59],v[20:23],a[248:251],a[56:59]
 v_accvgpr_read_b32 v56,a40
 v_accvgpr_read_b32 v57,a41
 v_mfma_f32_16x16x32_bf16 a[60:63],v[20:23],a[252:255],a[60:63]
 v_accvgpr_read_b32 v58,a42
 v_accvgpr_read_b32 v59,a43
 v_mfma_f32_16x16x32_bf16 a[60:63],v[16:19],a[236:239],a[60:63]
 s_waitcnt lgkmcnt(4)
 v_cvt_pk_bf16_f32 v88,v56,v57
 v_cvt_pk_bf16_f32 v89,v58,v59
 v_mfma_f32_16x16x32_bf16 a[48:51],v[24:27],a[160:163],a[48:51]
 ds_read_b64_tr_b16 v[40:41],v240 offset:128
 ds_read_b64_tr_b16 v[42:43],v240 offset:6272
 v_mfma_f32_16x16x32_bf16 a[48:51],v[28:31],a[176:179],a[48:51]
 v_accvgpr_read_b32 v60,a44
 v_accvgpr_read_b32 v61,a45
 v_mfma_f32_16x16x32_bf16 a[52:55],v[28:31],a[180:183],a[52:55]
 v_accvgpr_read_b32 v62,a46
 v_accvgpr_read_b32 v63,a47
 v_mfma_f32_16x16x32_bf16 a[52:55],v[24:27],a[164:167],a[52:55]
 ds_read_b64_tr_b16 v[44:45],v240 offset:12416
 ds_read_b64_tr_b16 v[46:47],v240 offset:18560
 v_mfma_f32_16x16x32_bf16 a[56:59],v[24:27],a[168:171],a[56:59]
 v_cvt_pk_bf16_f32 v98,v60,v61
 v_cvt_pk_bf16_f32 v99,v62,v63
 v_mfma_f32_16x16x32_bf16 a[56:59],v[28:31],a[184:187],a[56:59]
 v_mfma_f32_16x16x32_bf16 a[60:63],v[28:31],a[188:191],a[60:63]
 v_mfma_f32_16x16x32_bf16 a[60:63],v[24:27],a[172:175],a[60:63]
 s_waitcnt lgkmcnt(4)
 v_mfma_f32_16x16x32_bf16 a[64:67],v[32:35],a[192:195],a[64:67]
 ds_read_b64_tr_b16 v[16:17],v232 offset:128
 ds_read_b64_tr_b16 v[18:19],v232 offset:6272
 v_mfma_f32_16x16x32_bf16 a[64:67],v[36:39],a[208:211],a[64:67]
 s_add_u32 s76,s76,4096
 v_mfma_f32_16x16x32_bf16 a[68:71],v[36:39],a[212:215],a[68:71]
 s_cmp_eq_u32 s76,49152
 s_cselect_b32 s76,0,s76
 v_mfma_f32_16x16x32_bf16 a[68:71],v[32:35],a[196:199],a[68:71]
 s_add_u32 s77,s76,s72
 ds_read_b64_tr_b16 v[20:21],v232 offset:12416
 ds_read_b64_tr_b16 v[22:23],v232 offset:18560
 v_mfma_f32_16x16x32_bf16 a[72:75],v[32:35],a[200:203],a[72:75]
 buffer_load_dwordx4 v[176:179],v4,s[28:31],s77 offen sc1
 v_mfma_f32_16x16x32_bf16 a[72:75],v[36:39],a[216:219],a[72:75]
 v_accvgpr_read_b32 v48,a48
 v_accvgpr_read_b32 v49,a49
 v_mfma_f32_16x16x32_bf16 a[76:79],v[36:39],a[220:223],a[76:79]
 v_accvgpr_read_b32 v50,a50
 v_accvgpr_read_b32 v51,a51
 v_mfma_f32_16x16x32_bf16 a[76:79],v[32:35],a[204:207],a[76:79]
 s_waitcnt lgkmcnt(4)
 v_cvt_pk_bf16_f32 v70,v48,v49
 v_cvt_pk_bf16_f32 v71,v50,v51
 v_mfma_f32_16x16x32_bf16 a[64:67],v[40:43],a[224:227],a[64:67]
 s_add_u32 s1,s37,0
 buffer_store_dwordx4 v[68:71],v4,s[16:19],s1 offen offset:1024 sc1
 ds_read_b64_tr_b16 v[24:25],v237 offset:128
 ds_read_b64_tr_b16 v[26:27],v237 offset:6272
 v_mfma_f32_16x16x32_bf16 a[64:67],v[44:47],a[240:243],a[64:67]
 v_accvgpr_read_b32 v52,a52
 v_accvgpr_read_b32 v53,a53
 v_mfma_f32_16x16x32_bf16 a[68:71],v[44:47],a[244:247],a[68:71]
 v_accvgpr_read_b32 v54,a54
 v_accvgpr_read_b32 v55,a55
 v_mfma_f32_16x16x32_bf16 a[68:71],v[40:43],a[228:231],a[68:71]
 ds_read_b64_tr_b16 v[28:29],v237 offset:12416
 ds_read_b64_tr_b16 v[30:31],v237 offset:18560
 v_mfma_f32_16x16x32_bf16 a[72:75],v[40:43],a[232:235],a[72:75]
 v_cvt_pk_bf16_f32 v80,v52,v53
 v_cvt_pk_bf16_f32 v81,v54,v55
 v_mfma_f32_16x16x32_bf16 a[72:75],v[44:47],a[248:251],a[72:75]
 s_add_u32 s1,s37,2560
 buffer_store_dwordx4 v[78:81],v4,s[16:19],s1 offen offset:1024 sc1
 v_accvgpr_read_b32 v56,a56
 v_accvgpr_read_b32 v57,a57
 v_mfma_f32_16x16x32_bf16 a[76:79],v[44:47],a[252:255],a[76:79]
 v_accvgpr_read_b32 v58,a58
 v_accvgpr_read_b32 v59,a59
 v_mfma_f32_16x16x32_bf16 a[76:79],v[40:43],a[236:239],a[76:79]
 s_waitcnt lgkmcnt(4)
 v_cvt_pk_bf16_f32 v90,v56,v57
 v_cvt_pk_bf16_f32 v91,v58,v59
 v_mfma_f32_16x16x32_bf16 a[64:67],v[16:19],a[160:163],a[64:67]
 s_add_u32 s1,s37,5120
 buffer_store_dwordx4 v[88:91],v4,s[16:19],s1 offen offset:1024 sc1
 ds_read_b64_tr_b16 v[32:33],v241 offset:128
 ds_read_b64_tr_b16 v[34:35],v241 offset:6272
 v_mfma_f32_16x16x32_bf16 a[64:67],v[20:23],a[176:179],a[64:67]
 v_accvgpr_read_b32 v60,a60
 v_accvgpr_read_b32 v61,a61
 v_mfma_f32_16x16x32_bf16 a[68:71],v[20:23],a[180:183],a[68:71]
 v_accvgpr_read_b32 v62,a62
 v_accvgpr_read_b32 v63,a63
 v_mfma_f32_16x16x32_bf16 a[68:71],v[16:19],a[164:167],a[68:71]
 ds_read_b64_tr_b16 v[36:37],v241 offset:12416
 ds_read_b64_tr_b16 v[38:39],v241 offset:18560
 v_mfma_f32_16x16x32_bf16 a[72:75],v[16:19],a[168:171],a[72:75]
 v_cvt_pk_bf16_f32 v100,v60,v61
 v_cvt_pk_bf16_f32 v101,v62,v63
 v_mfma_f32_16x16x32_bf16 a[72:75],v[20:23],a[184:187],a[72:75]
 s_add_u32 s1,s37,7680
 buffer_store_dwordx4 v[98:101],v4,s[16:19],s1 offen offset:1024 sc1
 s_add_u32 s77,s76,s73
 v_mfma_f32_16x16x32_bf16 a[76:79],v[20:23],a[188:191],a[76:79]
 buffer_load_dwordx4 v[180:183],v4,s[28:31],s77 offen sc1
 v_mfma_f32_16x16x32_bf16 a[76:79],v[16:19],a[172:175],a[76:79]
 s_waitcnt lgkmcnt(4)
 v_mfma_f32_16x16x32_bf16 a[80:83],v[24:27],a[192:195],a[80:83]
 ds_read_b64_tr_b16 v[40:41],v233 offset:128
 ds_read_b64_tr_b16 v[42:43],v233 offset:6272
 v_mfma_f32_16x16x32_bf16 a[80:83],v[28:31],a[208:211],a[80:83]
 v_mfma_f32_16x16x32_bf16 a[84:87],v[28:31],a[212:215],a[84:87]
 v_mfma_f32_16x16x32_bf16 a[84:87],v[24:27],a[196:199],a[84:87]
 ds_read_b64_tr_b16 v[44:45],v233 offset:12416
 ds_read_b64_tr_b16 v[46:47],v233 offset:18560
 v_mfma_f32_16x16x32_bf16 a[88:91],v[24:27],a[200:203],a[88:91]
 v_mfma_f32_16x16x32_bf16 a[88:91],v[28:31],a[216:219],a[88:91]
 v_accvgpr_read_b32 v48,a64
 v_accvgpr_read_b32 v49,a65
 v_mfma_f32_16x16x32_bf16 a[92:95],v[28:31],a[220:223],a[92:95]
 v_accvgpr_read_b32 v50,a66
 v_accvgpr_read_b32 v51,a67
 v_mfma_f32_16x16x32_bf16 a[92:95],v[24:27],a[204:207],a[92:95]
 s_waitcnt lgkmcnt(4)
 v_cvt_pk_bf16_f32 v72,v48,v49
 v_cvt_pk_bf16_f32 v73,v50,v51
 v_mfma_f32_16x16x32_bf16 a[80:83],v[32:35],a[224:227],a[80:83]
 s_add_u32 s1,s37,0
 buffer_store_dwordx2 v[72:73],v5,s[16:19],s1 offen offset:2048 sc1
 ds_read_b64_tr_b16 v[16:17],v238 offset:128
 ds_read_b64_tr_b16 v[18:19],v238 offset:6272
 v_mfma_f32_16x16x32_bf16 a[80:83],v[36:39],a[240:243],a[80:83]
 v_accvgpr_read_b32 v52,a68
 v_accvgpr_read_b32 v53,a69
 v_mfma_f32_16x16x32_bf16 a[84:87],v[36:39],a[244:247],a[84:87]
 v_accvgpr_read_b32 v54,a70
 v_accvgpr_read_b32 v55,a71
 v_mfma_f32_16x16x32_bf16 a[84:87],v[32:35],a[228:231],a[84:87]
 s_add_u32 s77,s76,s78
 ds_read_b64_tr_b16 v[20:21],v238 offset:12416
 ds_read_b64_tr_b16 v[22:23],v238 offset:18560
 v_mfma_f32_16x16x32_bf16 a[88:91],v[32:35],a[232:235],a[88:91]
 buffer_load_dwordx4 v[184:187],v4,s[28:31],s77 offen sc1
 v_cvt_pk_bf16_f32 v82,v52,v53
 v_cvt_pk_bf16_f32 v83,v54,v55
 v_mfma_f32_16x16x32_bf16 a[88:91],v[36:39],a[248:251],a[88:91]
 s_add_u32 s1,s37,2560
 buffer_store_dwordx2 v[82:83],v5,s[16:19],s1 offen offset:2048 sc1
 v_accvgpr_read_b32 v56,a72
 v_accvgpr_read_b32 v57,a73
 v_mfma_f32_16x16x32_bf16 a[92:95],v[36:39],a[252:255],a[92:95]
 v_accvgpr_read_b32 v58,a74
 v_accvgpr_read_b32 v59,a75
 v_mfma_f32_16x16x32_bf16 a[92:95],v[32:35],a[236:239],a[92:95]
 s_waitcnt lgkmcnt(4)
 v_cvt_pk_bf16_f32 v92,v56,v57
 v_cvt_pk_bf16_f32 v93,v58,v59
 v_mfma_f32_16x16x32_bf16 a[80:83],v[40:43],a[160:163],a[80:83]
 s_add_u32 s1,s37,5120
 buffer_store_dwordx2 v[92:93],v5,s[16:19],s1 offen offset:2048 sc1
 ds_read_b64_tr_b16 v[24:25],v242 offset:128
 ds_read_b64_tr_b16 v[26:27],v242 offset:6272
 v_mfma_f32_16x16x32_bf16 a[80:83],v[44:47],a[176:179],a[80:83]
 v_accvgpr_read_b32 v60,a76
 v_accvgpr_read_b32 v61,a77
 v_mfma_f32_16x16x32_bf16 a[84:87],v[44:47],a[180:183],a[84:87]
 v_accvgpr_read_b32 v62,a78
 v_accvgpr_read_b32 v63,a79
 v_mfma_f32_16x16x32_bf16 a[84:87],v[40:43],a[164:167],a[84:87]
 ds_read_b64_tr_b16 v[28:29],v242 offset:12416
 ds_read_b64_tr_b16 v[30:31],v242 offset:18560
 v_mfma_f32_16x16x32_bf16 a[88:91],v[40:43],a[168:171],a[88:91]
 v_cvt_pk_bf16_f32 v102,v60,v61
 v_cvt_pk_bf16_f32 v103,v62,v63
 v_mfma_f32_16x16x32_bf16 a[88:91],v[44:47],a[184:187],a[88:91]
 s_add_u32 s1,s37,7680
 buffer_store_dwordx2 v[102:103],v5,s[16:19],s1 offen offset:2048 sc1
 s_cmp_eq_u32 s18,0
 s_cbranch_scc0 Lk28
 ds_write_b128 v10,v[64:67]
 ds_write_b128 v10,v[68:71] offset:1024
 ds_write_b64 v11,v[72:73] offset:2048
 ds_write_b128 v10,v[74:77] offset:2560
 ds_write_b128 v10,v[78:81] offset:3584
 ds_write_b64 v11,v[82:83] offset:4608
 ds_write_b128 v10,v[84:87] offset:5120
 ds_write_b128 v10,v[88:91] offset:6144
 ds_write_b64 v11,v[92:93] offset:7168
 ds_write_b128 v10,v[94:97] offset:7680
 ds_write_b128 v10,v[98:101] offset:8704
 ds_write_b64 v11,v[102:103] offset:9728
Lk28:
 s_add_u32 m0,s55,28672
 s_add_u32 s44,s63,4096
 buffer_load_dwordx4 v4,s[24:27],s44 offen sc1 lds
 v_mfma_f32_16x16x32_bf16 a[92:95],v[44:47],a[188:191],a[92:95]
 s_add_u32 s63,s63,20480
 s_cmp_eq_u32 s63,245760
 s_cselect_b32 s63,0,s63
 s_add_u32 m0,s55,73728
 s_nop 0
 buffer_load_dwordx4 v4,s[24:27],s63 offen sc1 lds
 v_mfma_f32_16x16x32_bf16 a[92:95],v[40:43],a[172:175],a[92:95]
 s_waitcnt lgkmcnt(4)
 v_mfma_f32_16x16x32_bf16 a[96:99],v[16:19],a[192:195],a[96:99]
 s_add_u32 s77,s76,s79
 ds_read_b64_tr_b16 v[32:33],v234 offset:128
 ds_read_b64_tr_b16 v[34:35],v234 offset:6272
 v_mfma_f32_16x16x32_bf16 a[96:99],v[20:23],a[208:211],a[96:99]
 buffer_load_dwordx4 v[188:191],v4,s[28:31],s77 offen sc1
 v_mfma_f32_16x16x32_bf16 a[100:103],v[20:23],a[212:215],a[100:103]
 v_mfma_f32_16x16x32_bf16 a[100:103],v[16:19],a[196:199],a[100:103]
 ds_read_b64_tr_b16 v[36:37],v234 offset:12416
 ds_read_b64_tr_b16 v[38:39],v234 offset:18560
 v_mfma_f32_16x16x32_bf16 a[104:107],v[16:19],a[200:203],a[104:107]
 v_mfma_f32_16x16x32_bf16 a[104:107],v[20:23],a[216:219],a[104:107]
 v_accvgpr_read_b32 v48,a80
 v_accvgpr_read_b32 v49,a81
 v_mfma_f32_16x16x32_bf16 a[108:111],v[20:23],a[220:223],a[108:111]
 v_accvgpr_read_b32 v50,a82
 v_accvgpr_read_b32 v51,a83
 v_mfma_f32_16x16x32_bf16 a[108:111],v[16:19],a[204:207],a[108:111]
 s_waitcnt lgkmcnt(4)
 v_cvt_pk_bf16_f32 v112,v48,v49
 v_cvt_pk_bf16_f32 v113,v50,v51
 v_mfma_f32_16x16x32_bf16 a[96:99],v[24:27],a[224:227],a[96:99]
 s_add_u32 s1,s37,81920
 buffer_store_dwordx2 v[112:113],v5,s[80:83],s1 offen offset:2048 sc1
 ds_read_b64_tr_b16 v[40:41],v239 offset:128
 ds_read_b64_tr_b16 v[42:43],v239 offset:6272
 v_mfma_f32_16x16x32_bf16 a[96:99],v[28:31],a[240:243],a[96:99]
 buffer_load_dwordx4 v4,s[24:27],s63 offen offset:1024 sc1 lds
 v_accvgpr_read_b32 v52,a84
 v_accvgpr_read_b32 v53,a85
 v_mfma_f32_16x16x32_bf16 a[100:103],v[28:31],a[244:247],a[100:103]
 v_accvgpr_read_b32 v54,a86
 v_accvgpr_read_b32 v55,a87
 v_mfma_f32_16x16x32_bf16 a[100:103],v[24:27],a[228:231],a[100:103]
 ds_read_b64_tr_b16 v[44:45],v239 offset:12416
 ds_read_b64_tr_b16 v[46:47],v239 offset:18560
 v_mfma_f32_16x16x32_bf16 a[104:107],v[24:27],a[232:235],a[104:107]
 v_cvt_pk_bf16_f32 v122,v52,v53
 v_cvt_pk_bf16_f32 v123,v54,v55
 v_mfma_f32_16x16x32_bf16 a[104:107],v[28:31],a[248:251],a[104:107]
 s_add_u32 s1,s37,84480
 buffer_store_dwordx2 v[122:123],v5,s[80:83],s1 offen offset:2048 sc1
 v_accvgpr_read_b32 v56,a88
 v_accvgpr_read_b32 v57,a89
 v_mfma_f32_16x16x32_bf16 a[108:111],v[28:31],a[252:255],a[108:111]
 buffer_load_dwordx4 v4,s[24:27],s63 offen offset:2048 sc1 lds
 v_accvgpr_read_b32 v58,a90
 v_accvgpr_read_b32 v59,a91
 v_mfma_f32_16x16x32_bf16 a[108:111],v[24:27],a[236:239],a[108:111]
 s_waitcnt lgkmcnt(4)
 v_cvt_pk_bf16_f32 v132,v56,v57
 v_cvt_pk_bf16_f32 v133,v58,v59
 v_mfma_f32_16x16x32_bf16 a[96:99],v[32:35],a[160:163],a[96:99]
 s_add_u32 s1,s37,87040
 buffer_store_dwordx2 v[132:133],v5,s[80:83],s1 offen offset:2048 sc1
 ds_read_b64_tr_b16 v[16:17],v243 offset:128
 ds_read_b64_tr_b16 v[18:19],v243 offset:6272
 v_mfma_f32_16x16x32_bf16 a[96:99],v[36:39],a[176:179],a[96:99]
 buffer_load_dwordx4 v4,s[24:27],s63 offen offset:3072 sc1 lds
 v_accvgpr_read_b32 v60,a92
 v_accvgpr_read_b32 v61,a93
 v_mfma_f32_16x16x32_bf16 a[100:103],v[36:39],a[180:183],a[100:103]
 v_accvgpr_read_b32 v62,a94
 v_accvgpr_read_b32 v63,a95
 v_mfma_f32_16x16x32_bf16 a[100:103],v[32:35],a[164:167],a[100:103]
 ds_read_b64_tr_b16 v[20:21],v243 offset:12416
 ds_read_b64_tr_b16 v[22:23],v243 offset:18560
 v_mfma_f32_16x16x32_bf16 a[104:107],v[32:35],a[168:171],a[104:107]
 v_cvt_pk_bf16_f32 v142,v60,v61
 v_cvt_pk_bf16_f32 v143,v62,v63
 v_mfma_f32_16x16x32_bf16 a[104:107],v[36:39],a[184:187],a[104:107]
 s_add_u32 s1,s37,89600
 buffer_store_dwordx2 v[142:143],v5,s[80:83],s1 offen offset:2048 sc1
 s_add_u32 s76,s76,4096
 v_mfma_f32_16x16x32_bf16 a[108:111],v[36:39],a[188:191],a[108:111]
 s_add_u32 m0,s55,77824
 s_add_u32 s44,s63,4096
 buffer_load_dwordx4 v4,s[24:27],s44 offen sc1 lds
 v_mfma_f32_16x16x32_bf16 a[108:111],v[32:35],a[172:175],a[108:111]
 s_cmp_eq_u32 s76,49152
 s_cselect_b32 s76,0,s76
 s_waitcnt lgkmcnt(4)
 v_mfma_f32_16x16x32_bf16 a[112:115],v[40:43],a[192:195],a[112:115]
 s_add_u32 s77,s76,s72
 ds_read_b64_tr_b16 v[24:25],v235 offset:128
 ds_read_b64_tr_b16 v[26:27],v235 offset:6272
 v_mfma_f32_16x16x32_bf16 a[112:115],v[44:47],a[208:211],a[112:115]
 buffer_load_dwordx4 v[192:195],v4,s[28:31],s77 offen sc1
 v_mfma_f32_16x16x32_bf16 a[116:119],v[44:47],a[212:215],a[116:119]
 v_mfma_f32_16x16x32_bf16 a[116:119],v[40:43],a[196:199],a[116:119]
 ds_read_b64_tr_b16 v[28:29],v235 offset:12416
 ds_read_b64_tr_b16 v[30:31],v235 offset:18560
 v_mfma_f32_16x16x32_bf16 a[120:123],v[40:43],a[200:203],a[120:123]
 v_mfma_f32_16x16x32_bf16 a[120:123],v[44:47],a[216:219],a[120:123]
 v_accvgpr_read_b32 v48,a96
 v_accvgpr_read_b32 v49,a97
 v_mfma_f32_16x16x32_bf16 a[124:127],v[44:47],a[220:223],a[124:127]
 v_accvgpr_read_b32 v50,a98
 v_accvgpr_read_b32 v51,a99
 v_mfma_f32_16x16x32_bf16 a[124:127],v[40:43],a[204:207],a[124:127]
 s_waitcnt lgkmcnt(4)
 v_cvt_pk_bf16_f32 v104,v48,v49
 v_cvt_pk_bf16_f32 v105,v50,v51
 v_mfma_f32_16x16x32_bf16 a[112:115],v[16:19],a[224:227],a[112:115]
 s_add_u32 s77,s76,s73
 ds_read_b64_tr_b16 v[32:33],v236 offset:256
 ds_read_b64_tr_b16 v[34:35],v236 offset:6400
 v_mfma_f32_16x16x32_bf16 a[112:115],v[20:23],a[240:243],a[112:115]
 buffer_load_dwordx4 v[196:199],v4,s[28:31],s77 offen sc1
 v_accvgpr_read_b32 v52,a100
 v_accvgpr_read_b32 v53,a101
 v_mfma_f32_16x16x32_bf16 a[116:119],v[20:23],a[244:247],a[116:119]
 v_accvgpr_read_b32 v54,a102
 v_accvgpr_read_b32 v55,a103
 v_mfma_f32_16x16x32_bf16 a[116:119],v[16:19],a[228:231],a[116:119]
 ds_read_b64_tr_b16 v[36:37],v236 offset:12544
 ds_read_b64_tr_b16 v[38:39],v236 offset:18688
 v_mfma_f32_16x16x32_bf16 a[120:123],v[16:19],a[232:235],a[120:123]
 v_cvt_pk_bf16_f32 v114,v52,v53
 v_cvt_pk_bf16_f32 v115,v54,v55
 v_mfma_f32_16x16x32_bf16 a[120:123],v[20:23],a[248:251],a[120:123]
 v_accvgpr_read_b32 v56,a104
 v_accvgpr_read_b32 v57,a105
 v_mfma_f32_16x16x32_bf16 a[124:127],v[20:23],a[252:255],a[124:127]
 v_accvgpr_read_b32 v58,a106
 v_accvgpr_read_b32 v59,a107
 v_mfma_f32_16x16x32_bf16 a[124:127],v[16:19],a[236:239],a[124:127]
 s_waitcnt lgkmcnt(4)
 v_cvt_pk_bf16_f32 v124,v56,v57
 v_cvt_pk_bf16_f32 v125,v58,v59
 v_mfma_f32_16x16x32_bf16 a[112:115],v[24:27],a[160:163],a[112:115]
 ds_read_b64_tr_b16 v[40:41],v240 offset:256
 ds_read_b64_tr_b16 v[42:43],v240 offset:6400
 v_mfma_f32_16x16x32_bf16 a[112:115],v[28:31],a[176:179],a[112:115]
 v_accvgpr_read_b32 v60,a108
 v_accvgpr_read_b32 v61,a109
 v_mfma_f32_16x16x32_bf16 a[116:119],v[28:31],a[180:183],a[116:119]
 v_accvgpr_read_b32 v62,a110
 v_accvgpr_read_b32 v63,a111
 v_mfma_f32_16x16x32_bf16 a[116:119],v[24:27],a[164:167],a[116:119]
 ds_read_b64_tr_b16 v[44:45],v240 offset:12544
 ds_read_b64_tr_b16 v[46:47],v240 offset:18688
 v_mfma_f32_16x16x32_bf16 a[120:123],v[24:27],a[168:171],a[120:123]
 v_cvt_pk_bf16_f32 v134,v60,v61
 v_cvt_pk_bf16_f32 v135,v62,v63
 v_mfma_f32_16x16x32_bf16 a[120:123],v[28:31],a[184:187],a[120:123]
 v_mfma_f32_16x16x32_bf16 a[124:127],v[28:31],a[188:191],a[124:127]
 v_mfma_f32_16x16x32_bf16 a[124:127],v[24:27],a[172:175],a[124:127]
 s_waitcnt lgkmcnt(4)
 v_mfma_f32_16x16x32_bf16 a[128:131],v[32:35],a[192:195],a[128:131]
 s_add_u32 s77,s76,s78
 ds_read_b64_tr_b16 v[16:17],v232 offset:256
 ds_read_b64_tr_b16 v[18:19],v232 offset:6400
 v_mfma_f32_16x16x32_bf16 a[128:131],v[36:39],a[208:211],a[128:131]
 buffer_load_dwordx4 v[200:203],v4,s[28:31],s77 offen sc1
 v_mfma_f32_16x16x32_bf16 a[132:135],v[36:39],a[212:215],a[132:135]
 v_mfma_f32_16x16x32_bf16 a[132:135],v[32:35],a[196:199],a[132:135]
 ds_read_b64_tr_b16 v[20:21],v232 offset:12544
 ds_read_b64_tr_b16 v[22:23],v232 offset:18688
 v_mfma_f32_16x16x32_bf16 a[136:139],v[32:35],a[200:203],a[136:139]
 v_mfma_f32_16x16x32_bf16 a[136:139],v[36:39],a[216:219],a[136:139]
 v_accvgpr_read_b32 v48,a112
 v_accvgpr_read_b32 v49,a113
 v_mfma_f32_16x16x32_bf16 a[140:143],v[36:39],a[220:223],a[140:143]
 v_accvgpr_read_b32 v50,a114
 v_accvgpr_read_b32 v51,a115
 v_mfma_f32_16x16x32_bf16 a[140:143],v[32:35],a[204:207],a[140:143]
 s_waitcnt lgkmcnt(4)
 v_cvt_pk_bf16_f32 v106,v48,v49
 v_cvt_pk_bf16_f32 v107,v50,v51
 v_mfma_f32_16x16x32_bf16 a[128:131],v[40:43],a[224:227],a[128:131]
 s_add_u32 s1,s37,81920
 buffer_store_dwordx4 v[104:107],v4,s[80:83],s1 offen sc1
 ds_read_b64_tr_b16 v[24:25],v237 offset:256
 ds_read_b64_tr_b16 v[26:27],v237 offset:6400
 v_mfma_f32_16x16x32_bf16 a[128:131],v[44:47],a[240:243],a[128:131]
 v_accvgpr_read_b32 v52,a116
 v_accvgpr_read_b32 v53,a117
 v_mfma_f32_16x16x32_bf16 a[132:135],v[44:47],a[244:247],a[132:135]
 v_accvgpr_read_b32 v54,a118
 v_accvgpr_read_b32 v55,a119
 v_mfma_f32_16x16x32_bf16 a[132:135],v[40:43],a[228:231],a[132:135]
 ds_read_b64_tr_b16 v[28:29],v237 offset:12544
 ds_read_b64_tr_b16 v[30:31],v237 offset:18688
 v_mfma_f32_16x16x32_bf16 a[136:139],v[40:43],a[232:235],a[136:139]
 v_cvt_pk_bf16_f32 v116,v52,v53
 v_cvt_pk_bf16_f32 v117,v54,v55
 v_mfma_f32_16x16x32_bf16 a[136:139],v[44:47],a[248:251],a[136:139]
 s_add_u32 s1,s37,84480
 buffer_store_dwordx4 v[114:117],v4,s[80:83],s1 offen sc1
 v_accvgpr_read_b32 v56,a120
 v_accvgpr_read_b32 v57,a121
 v_mfma_f32_16x16x32_bf16 a[140:143],v[44:47],a[252:255],a[140:143]
 v_accvgpr_read_b32 v58,a122
 v_accvgpr_read_b32 v59,a123
 v_mfma_f32_16x16x32_bf16 a[140:143],v[40:43],a[236:239],a[140:143]
 s_waitcnt lgkmcnt(4)
 v_cvt_pk_bf16_f32 v126,v56,v57
 v_cvt_pk_bf16_f32 v127,v58,v59
 v_mfma_f32_16x16x32_bf16 a[128:131],v[16:19],a[160:163],a[128:131]
 s_add_u32 s1,s37,87040
 buffer_store_dwordx4 v[124:127],v4,s[80:83],s1 offen sc1
 ds_read_b64_tr_b16 v[32:33],v241 offset:256
 ds_read_b64_tr_b16 v[34:35],v241 offset:6400
 v_mfma_f32_16x16x32_bf16 a[128:131],v[20:23],a[176:179],a[128:131]
 v_accvgpr_read_b32 v60,a124
 v_accvgpr_read_b32 v61,a125
 v_mfma_f32_16x16x32_bf16 a[132:135],v[20:23],a[180:183],a[132:135]
 v_accvgpr_read_b32 v62,a126
 v_accvgpr_read_b32 v63,a127
 v_mfma_f32_16x16x32_bf16 a[132:135],v[16:19],a[164:167],a[132:135]
 ds_read_b64_tr_b16 v[36:37],v241 offset:12544
 ds_read_b64_tr_b16 v[38:39],v241 offset:18688
 v_mfma_f32_16x16x32_bf16 a[136:139],v[16:19],a[168:171],a[136:139]
 v_cvt_pk_bf16_f32 v136,v60,v61
 v_cvt_pk_bf16_f32 v137,v62,v63
 v_mfma_f32_16x16x32_bf16 a[136:139],v[20:23],a[184:187],a[136:139]
 s_add_u32 s1,s37,89600
 buffer_store_dwordx4 v[134:137],v4,s[80:83],s1 offen sc1
 s_add_u32 s77,s76,s79
 v_mfma_f32_16x16x32_bf16 a[140:143],v[20:23],a[188:191],a[140:143]
 buffer_load_dwordx4 v[204:207],v4,s[28:31],s77 offen sc1
 v_mfma_f32_16x16x32_bf16 a[140:143],v[16:19],a[172:175],a[140:143]
 s_add_u32 s76,s76,4096
 s_cmp_eq_u32 s76,49152
 s_cselect_b32 s76,0,s76
 s_waitcnt lgkmcnt(4)
 v_mfma_f32_16x16x32_bf16 a[144:147],v[24:27],a[192:195],a[144:147]
 s_add_u32 s77,s76,s72
 ds_read_b64_tr_b16 v[40:41],v233 offset:256
 ds_read_b64_tr_b16 v[42:43],v233 offset:6400
 v_mfma_f32_16x16x32_bf16 a[144:147],v[28:31],a[208:211],a[144:147]
 buffer_load_dwordx4 v[208:211],v4,s[28:31],s77 offen sc1
 v_mfma_f32_16x16x32_bf16 a[148:151],v[28:31],a[212:215],a[148:151]
 s_add_u32 s77,s76,s73
 buffer_load_dwordx4 v[212:215],v4,s[28:31],s77 offen sc1
 v_mfma_f32_16x16x32_bf16 a[148:151],v[24:27],a[196:199],a[148:151]
 ds_read_b64_tr_b16 v[44:45],v233 offset:12544
 ds_read_b64_tr_b16 v[46:47],v233 offset:18688
 v_mfma_f32_16x16x32_bf16 a[152:155],v[24:27],a[200:203],a[152:155]
 v_mfma_f32_16x16x32_bf16 a[152:155],v[28:31],a[216:219],a[152:155]
 v_accvgpr_read_b32 v48,a128
 v_accvgpr_read_b32 v49,a129
 v_mfma_f32_16x16x32_bf16 a[156:159],v[28:31],a[220:223],a[156:159]
 s_add_u32 s77,s76,s78
 v_accvgpr_read_b32 v50,a130
 v_accvgpr_read_b32 v51,a131
 v_mfma_f32_16x16x32_bf16 a[156:159],v[24:27],a[204:207],a[156:159]
 buffer_load_dwordx4 v[216:219],v4,s[28:31],s77 offen sc1
 s_waitcnt lgkmcnt(4)
 v_cvt_pk_bf16_f32 v108,v48,v49
 v_cvt_pk_bf16_f32 v109,v50,v51
 v_mfma_f32_16x16x32_bf16 a[144:147],v[32:35],a[224:227],a[144:147]
 s_waitcnt vmcnt(21)
 ds_read_b128 v[16:19],v9 offset:24576
 ds_read_b128 v[20:23],v6 offset:24576
 v_mfma_f32_16x16x32_bf16 a[144:147],v[36:39],a[240:243],a[144:147]
 v_accvgpr_read_b32 v52,a132
 v_accvgpr_read_b32 v53,a133
 v_mfma_f32_16x16x32_bf16 a[148:151],v[36:39],a[244:247],a[148:151]
 s_add_u32 s77,s76,s79
 v_accvgpr_read_b32 v54,a134
 v_accvgpr_read_b32 v55,a135
 v_mfma_f32_16x16x32_bf16 a[148:151],v[32:35],a[228:231],a[148:151]
 buffer_load_dwordx4 v[220:223],v4,s[28:31],s77 offen sc1
 v_cvt_pk_bf16_f32 v118,v52,v53
 v_cvt_pk_bf16_f32 v119,v54,v55
 v_mfma_f32_16x16x32_bf16 a[152:155],v[32:35],a[232:235],a[152:155]
 v_accvgpr_read_b32 v56,a136
 v_accvgpr_read_b32 v57,a137
 v_mfma_f32_16x16x32_bf16 a[152:155],v[36:39],a[248:251],a[152:155]
 v_accvgpr_read_b32 v58,a138
 v_accvgpr_read_b32 v59,a139
 v_mfma_f32_16x16x32_bf16 a[156:159],v[36:39],a[252:255],a[156:159]
 v_cvt_pk_bf16_f32 v128,v56,v57
 v_cvt_pk_bf16_f32 v129,v58,v59
 v_mfma_f32_16x16x32_bf16 a[156:159],v[32:35],a[236:239],a[156:159]
 s_waitcnt lgkmcnt(2)
 v_accvgpr_read_b32 v60,a140
 v_accvgpr_read_b32 v61,a141
 v_mfma_f32_16x16x32_bf16 a[144:147],v[40:43],a[160:163],a[144:147]
 ds_read_b128 v[24:27],v9 offset:25600
 ds_read_b128 v[28:31],v6 offset:25600
 v_mfma_f32_16x16x32_bf16 a[144:147],v[44:47],a[176:179],a[144:147]
 s_add_u32 s76,s76,4096
 v_accvgpr_read_b32 v62,a142
 v_accvgpr_read_b32 v63,a143
 v_mfma_f32_16x16x32_bf16 a[148:151],v[44:47],a[180:183],a[148:151]
 s_cmp_eq_u32 s76,49152
 s_cselect_b32 s76,0,s76
 s_add_u32 s77,s76,s72
 v_cvt_pk_bf16_f32 v138,v60,v61
 v_cvt_pk_bf16_f32 v139,v62,v63
 v_mfma_f32_16x16x32_bf16 a[148:151],v[40:43],a[164:167],a[148:151]
 buffer_load_dwordx4 v[144:147],v4,s[28:31],s77 offen sc1
 v_mfma_f32_16x16x32_bf16 a[152:155],v[40:43],a[168:171],a[152:155]
 s_add_u32 s77,s76,s73
 buffer_load_dwordx4 v[148:151],v4,s[28:31],s77 offen sc1
 v_mfma_f32_16x16x32_bf16 a[152:155],v[44:47],a[184:187],a[152:155]
 v_mfma_f32_16x16x32_bf16 a[156:159],v[44:47],a[188:191],a[156:159]
 v_mfma_f32_16x16x32_bf16 a[156:159],v[40:43],a[172:175],a[156:159]
 s_waitcnt vmcnt(22) lgkmcnt(2)
 v_mfma_f32_16x16x32_bf16 v[224:227],v[16:19],v[160:163],0
 s_add_u32 s77,s76,s78
 ds_read_b128 v[32:35],v9 offset:26624
 ds_read_b128 v[36:39],v6 offset:26624
 v_mfma_f32_16x16x32_bf16 v[224:227],v[20:23],v[176:179],v[224:227]
 buffer_load_dwordx4 v[152:155],v4,s[28:31],s77 offen sc1
 v_mfma_f32_16x16x32_bf16 a[0:3],v[20:23],v[180:183],0
 s_barrier
 v_mfma_f32_16x16x32_bf16 a[0:3],v[16:19],v[164:167],a[0:3]
 s_add_u32 s63,s63,20480
 s_cmp_eq_u32 s63,245760
 s_cselect_b32 s63,0,s63
 s_add_u32 m0,s55,49152
 s_nop 0
 buffer_load_dwordx4 v4,s[24:27],s63 offen sc1 lds
 v_mfma_f32_16x16x32_bf16 a[20:23],v[16:19],v[168:171],0
 buffer_load_dwordx4 v4,s[24:27],s63 offen offset:1024 sc1 lds
 v_mfma_f32_16x16x32_bf16 a[20:23],v[20:23],v[184:187],a[20:23]
 v_accvgpr_read_b32 v48,a144
 v_accvgpr_read_b32 v49,a145
 v_mfma_f32_16x16x32_bf16 a[40:43],v[20:23],v[188:191],0
 v_accvgpr_read_b32 v50,a146
 v_accvgpr_read_b32 v51,a147
 v_mfma_f32_16x16x32_bf16 a[40:43],v[16:19],v[172:175],a[40:43]
 s_waitcnt lgkmcnt(2)
 v_cvt_pk_bf16_f32 v110,v48,v49
 v_cvt_pk_bf16_f32 v111,v50,v51
 v_mfma_f32_16x16x32_bf16 v[228:231],v[24:27],v[160:163],0
 s_add_u32 s1,s37,81920
 buffer_store_dwordx4 v[108:111],v4,s[80:83],s1 offen offset:1024 sc1
 ds_read_b128 v[40:43],v9 offset:27648
 ds_read_b128 v[44:47],v6 offset:27648
 v_mfma_f32_16x16x32_bf16 v[228:231],v[28:31],v[176:179],v[228:231]
 v_accvgpr_read_b32 v52,a148
 v_accvgpr_read_b32 v53,a149
 v_mfma_f32_16x16x32_bf16 a[4:7],v[28:31],v[180:183],0
 v_accvgpr_read_b32 v54,a150
 v_accvgpr_read_b32 v55,a151
 v_mfma_f32_16x16x32_bf16 a[4:7],v[24:27],v[164:167],a[4:7]
 v_cvt_pk_bf16_f32 v120,v52,v53
 v_cvt_pk_bf16_f32 v121,v54,v55
 v_mfma_f32_16x16x32_bf16 a[24:27],v[24:27],v[168:171],0
 s_add_u32 s1,s37,84480
 buffer_store_dwordx4 v[118:121],v4,s[80:83],s1 offen offset:1024 sc1
 v_accvgpr_read_b32 v56,a152
 v_accvgpr_read_b32 v57,a153
 v_mfma_f32_16x16x32_bf16 a[24:27],v[28:31],v[184:187],a[24:27]
 v_accvgpr_read_b32 v58,a154
 v_accvgpr_read_b32 v59,a155
 v_mfma_f32_16x16x32_bf16 a[44:47],v[28:31],v[188:191],0
 v_cvt_pk_bf16_f32 v130,v56,v57
 v_cvt_pk_bf16_f32 v131,v58,v59
 v_mfma_f32_16x16x32_bf16 a[44:47],v[24:27],v[172:175],a[44:47]
 s_add_u32 s1,s37,87040
 buffer_store_dwordx4 v[128:131],v4,s[80:83],s1 offen offset:1024 sc1
 s_waitcnt lgkmcnt(2)
 v_accvgpr_read_b32 v60,a156
 v_accvgpr_read_b32 v61,a157
 v_mfma_f32_16x16x32_bf16 v[232:235],v[32:35],v[160:163],0
 ds_read_b128 v[16:19],v9 offset:28672
 ds_read_b128 v[20:23],v6 offset:28672
 v_mfma_f32_16x16x32_bf16 v[232:235],v[36:39],v[176:179],v[232:235]
 v_accvgpr_read_b32 v62,a158
 v_accvgpr_read_b32 v63,a159
 v_mfma_f32_16x16x32_bf16 a[8:11],v[36:39],v[180:183],0
 v_cvt_pk_bf16_f32 v140,v60,v61
 v_cvt_pk_bf16_f32 v141,v62,v63
 v_mfma_f32_16x16x32_bf16 a[8:11],v[32:35],v[164:167],a[8:11]
 s_add_u32 s1,s37,89600
 buffer_store_dwordx4 v[138:141],v4,s[80:83],s1 offen offset:1024 sc1
 s_cmp_eq_u32 s82,0
 s_cbranch_scc0 Lk29
 ds_write_b128 v10,v[104:107]
 ds_write_b128 v10,v[108:111] offset:1024
 ds_write_b64 v11,v[112:113] offset:2048
 ds_write_b128 v10,v[114:117] offset:2560
 ds_write_b128 v10,v[118:121] offset:3584
 ds_write_b64 v11,v[122:123] offset:4608
 ds_write_b128 v10,v[124:127] offset:5120
 ds_write_b128 v10,v[128:131] offset:6144
 ds_write_b64 v11,v[132:133] offset:7168
 ds_write_b128 v10,v[134:137] offset:7680
 ds_write_b128 v10,v[138:141] offset:8704
 ds_write_b64 v11,v[142:143] offset:9728
Lk29:
 buffer_load_dwordx4 v4,s[24:27],s63 offen offset:2048 sc1 lds
 v_mfma_f32_16x16x32_bf16 a[28:31],v[32:35],v[168:171],0
 v_add_u32 v15,0,v0
 v_mul_u32_u24 v7,5462,v15
 v_mfma_f32_16x16x32_bf16 a[28:31],v[36:39],v[184:187],a[28:31]
 buffer_load_dwordx4 v4,s[24:27],s63 offen offset:3072 sc1 lds
 v_lshrrev_b32 v7,16,v7
 v_mul_u32_u24 v1,1088,v7
 v_mfma_f32_16x16x32_bf16 a[48:51],v[36:39],v[188:191],0
 s_add_u32 m0,s55,53248
 s_add_u32 s44,s63,4096
 buffer_load_dwordx4 v4,s[24:27],s44 offen sc1 lds
 v_add_u32 v1,v1,v4
 v_mul_u32_u24 v7,12,v7
 v_mfma_f32_16x16x32_bf16 a[48:51],v[32:35],v[172:175],a[48:51]
 s_waitcnt lgkmcnt(2)
 v_sub_u32 v60,v15,v7
 v_add_u32 v15,64,v0
 v_mfma_f32_16x16x32_bf16 v[236:239],v[40:43],v[160:163],0
 s_add_u32 s63,s63,20480
 s_cmp_eq_u32 s63,245760
 s_cselect_b32 s63,0,s63
 s_add_u32 m0,s55,98304
 s_nop 0
 buffer_load_dwordx4 v4,s[24:27],s63 offen sc1 lds
 s_waitcnt vmcnt(1)
 ds_read_b128 v[24:27],v8 offset:24576
 ds_read_b128 v[28:31],v8
 v_mfma_f32_16x16x32_bf16 v[236:239],v[44:47],v[176:179],v[236:239]
 buffer_load_dwordx4 v4,s[24:27],s63 offen offset:1024 sc1 lds
 v_mul_u32_u24 v7,5462,v15
 v_lshrrev_b32 v7,16,v7
 v_mfma_f32_16x16x32_bf16 a[12:15],v[44:47],v[180:183],0
 buffer_load_dwordx4 v4,s[24:27],s63 offen offset:2048 sc1 lds
 v_mul_u32_u24 v2,1088,v7
 v_add_u32 v2,v2,v4
 v_mfma_f32_16x16x32_bf16 a[12:15],v[40:43],v[164:167],a[12:15]
 buffer_load_dwordx4 v4,s[24:27],s63 offen offset:3072 sc1 lds
 v_mul_u32_u24 v7,12,v7
 v_sub_u32 v61,v15,v7
 v_mfma_f32_16x16x32_bf16 a[32:35],v[40:43],v[168:171],0
 s_add_u32 m0,s55,102400
 s_add_u32 s44,s63,4096
 buffer_load_dwordx4 v4,s[24:27],s44 offen sc1 lds
 v_add_u32 v15,128,v0
 v_mul_u32_u24 v7,5462,v15
 v_mfma_f32_16x16x32_bf16 a[32:35],v[44:47],v[184:187],a[32:35]
 s_add_u32 s63,s63,20480
 s_cmp_eq_u32 s63,245760
 s_cselect_b32 s63,0,s63
 s_add_u32 m0,s55,0
 s_nop 0
 buffer_load_dwordx4 v4,s[24:27],s63 offen sc1 lds
 v_lshrrev_b32 v7,16,v7
 v_mul_u32_u24 v3,1088,v7
 v_mfma_f32_16x16x32_bf16 a[52:55],v[44:47],v[188:191],0
 buffer_load_dwordx4 v4,s[24:27],s63 offen offset:1024 sc1 lds
 v_add_u32 v3,v3,v4
 v_mul_u32_u24 v7,12,v7
 v_mfma_f32_16x16x32_bf16 a[52:55],v[40:43],v[172:175],a[52:55]
 s_waitcnt lgkmcnt(2)
 v_sub_u32 v62,v15,v7
 v_bfe_u32 v15,v0,2,2
 v_mfma_f32_16x16x32_bf16 v[240:243],v[16:19],v[160:163],0
 buffer_load_dwordx4 v4,s[24:27],s63 offen offset:2048 sc1 lds
 ds_read_b128 v[32:35],v8 offset:25600
 ds_read_b128 v[36:39],v8 offset:1024
 v_mfma_f32_16x16x32_bf16 v[240:243],v[20:23],v[176:179],v[240:243]
 v_lshrrev_b32 v7,4,v0
 v_cmp_eq_u32 vcc,v15,v7
 v_mfma_f32_16x16x32_bf16 a[16:19],v[20:23],v[180:183],0
 buffer_load_dwordx4 v4,s[24:27],s63 offen offset:3072 sc1 lds
 v_and_b32 v15,1,v0
 v_lshlrev_b32 v15,4,v15
 v_mfma_f32_16x16x32_bf16 a[16:19],v[16:19],v[164:167],a[16:19]
 s_add_u32 m0,s55,4096
 s_add_u32 s44,s63,4096
 buffer_load_dwordx4 v4,s[24:27],s44 offen sc1 lds
 v_mov_b32 v7,0x3f80
 v_lshlrev_b32 v7,v15,v7
 v_mfma_f32_16x16x32_bf16 a[36:39],v[16:19],v[168:171],0
 s_add_u32 s63,s63,20480
 s_cmp_eq_u32 s63,245760
 s_cselect_b32 s63,0,s63
 s_add_u32 m0,s55,122880
 s_nop 0
 buffer_load_dwordx4 v4,s[24:27],s63 offen sc1 lds
 v_cndmask_b32 v7,0,v7,vcc
 v_and_b32 v15,2,v0
 v_mfma_f32_16x16x32_bf16 a[36:39],v[20:23],v[184:187],a[36:39]
 buffer_load_dwordx4 v4,s[24:27],s63 offen offset:1024 sc1 lds
 v_cmp_eq_u32 vcc,0,v15
 v_mov_b32 v48,0
 v_mfma_f32_16x16x32_bf16 a[56:59],v[20:23],v[188:191],0
 buffer_load_dwordx4 v4,s[24:27],s63 offen offset:2048 sc1 lds
 v_mov_b32 v49,0
 v_cndmask_b32 v50,0,v7,vcc
 v_mfma_f32_16x16x32_bf16 a[56:59],v[16:19],v[172:175],a[56:59]
 s_waitcnt vmcnt(25) lgkmcnt(2)
 v_cndmask_b32 v51,v7,0,vcc
 v_mov_b32 v52,0
 v_mfma_f32_16x16x32_bf16 v[224:227],v[24:27],v[192:195],v[224:227]
 buffer_load_dwordx4 v4,s[24:27],s63 offen offset:3072 sc1 lds
 ds_read_b128 v[40:43],v8 offset:26624
 ds_read_b128 v[44:47],v8 offset:2048
 v_mfma_f32_16x16x32_bf16 v[224:227],v[28:31],v[208:211],v[224:227]
 s_add_u32 m0,s55,126976
 s_add_u32 s44,s63,4096
 buffer_load_dwordx4 v4,s[24:27],s44 offen sc1 lds
 v_mov_b32 v53,0
 v_mov_b32 v54,v50
 v_mfma_f32_16x16x32_bf16 a[0:3],v[28:31],v[212:215],a[0:3]
 s_add_u32 s77,s76,s79
 buffer_load_dwordx4 v[156:159],v4,s[28:31],s77 offen sc1
 v_mov_b32 v55,v51
 v_mov_b32 v56,v50
 v_mfma_f32_16x16x32_bf16 a[0:3],v[24:27],v[196:199],a[0:3]
 s_add_u32 s63,s63,20480
 s_cmp_eq_u32 s63,245760
 s_cselect_b32 s63,0,s63
 s_add_u32 m0,s55,24576
 s_nop 0
 buffer_load_dwordx4 v4,s[24:27],s63 offen sc1 lds
 v_mov_b32 v57,v51
 v_and_b32 v15,15,v0
 v_mfma_f32_16x16x32_bf16 a[20:23],v[24:27],v[200:203],a[20:23]
 s_add_u32 s76,s76,4096
 s_cmp_eq_u32 s76,49152
 s_cselect_b32 s76,0,s76
 s_add_u32 s77,s76,s72
 v_mul_u32_u24 v59,192,v15
 v_lshrrev_b32 v15,4,v0
 v_mfma_f32_16x16x32_bf16 a[20:23],v[28:31],v[216:219],a[20:23]
 buffer_load_dwordx4 a[60:63],v4,s[28:31],s77 offen sc1
 v_lshl_add_u32 v59,v15,3,v59
 v_mfma_f32_16x16x32_bf16 a[40:43],v[28:31],v[220:223],a[40:43]
 s_lshl_b32 s41,s58,6
 s_add_u32 s41,s41,s49
 v_add_u32 v58,s41,v59
 v_mfma_f32_16x16x32_bf16 a[40:43],v[24:27],v[204:207],a[40:43]
 buffer_load_dwordx4 v4,s[24:27],s63 offen offset:1024 sc1 lds
 s_waitcnt lgkmcnt(2)
 s_mul_i32 s41,s58,96
 s_sub_u32 s41,128,s41
 v_mfma_f32_16x16x32_bf16 v[228:231],v[32:35],v[192:195],v[228:231]
 s_add_u32 s77,s76,s73
 buffer_load_dwordx4 a[64:67],v4,s[28:31],s77 offen sc1
 ds_read_b128 v[16:19],v8 offset:27648
 ds_read_b128 v[20:23],v8 offset:3072
 v_mfma_f32_16x16x32_bf16 v[228:231],v[36:39],v[208:211],v[228:231]
 s_add_u32 s41,s41,s49
 v_add_u32 v59,s41,v59
 v_add_u32 v63,s49,v4
 v_mfma_f32_16x16x32_bf16 a[4:7],v[36:39],v[212:215],a[4:7]
 buffer_load_dwordx4 v4,s[24:27],s63 offen offset:2048 sc1 lds
 s_waitcnt vmcnt(24)
 s_barrier
 v_add_u32 v10,s70,v10
 v_mfma_f32_16x16x32_bf16 a[4:7],v[32:35],v[196:199],a[4:7]
 s_add_u32 s77,s76,s78
 buffer_load_dwordx4 a[68:71],v4,s[28:31],s77 offen sc1
 v_add_u32 v11,s70,v11
 v_mfma_f32_16x16x32_bf16 a[24:27],v[32:35],v[200:203],a[24:27]
 s_cmp_lg_u32 s32,0
 s_cbranch_scc1 Lf30
 v_mov_b32 v14,s51
 s_mov_b64 exec,1
 s_add_u32 s91,s90,5120
 buffer_store_dword v14,off,s[92:95],s91 sc1
 s_mov_b64 exec,-1
Lf30:
 buffer_load_dwordx4 v4,s[24:27],s63 offen offset:3072 sc1 lds
 v_mfma_f32_16x16x32_bf16 a[24:27],v[36:39],v[216:219],a[24:27]
 s_sub_u32 s41,s32,1
 s_and_b32 s41,s41,3
 s_mul_i32 s41,s41,5120
 v_mfma_f32_16x16x32_bf16 a[44:47],v[36:39],v[220:223],a[44:47]
 s_add_u32 s77,s76,s79
 s_add_u32 s41,s41,122880
 v_add_u32 v124,s41,v4
 v_mfma_f32_16x16x32_bf16 a[44:47],v[32:35],v[204:207],a[44:47]
 buffer_load_dwordx4 a[72:75],v4,s[28:31],s77 offen sc1
 s_waitcnt lgkmcnt(2)
 v_mfma_f32_16x16x32_bf16 v[232:235],v[40:43],v[192:195],v[232:235]
 s_add_u32 m0,s55,28672
 s_add_u32 s44,s63,4096
 buffer_load_dwordx4 v4,s[24:27],s44 offen sc1 lds
 ds_read_b128 v[24:27],v8 offset:28672
 ds_read_b128 v[28:31],v8 offset:4096
 v_mfma_f32_16x16x32_bf16 v[232:235],v[44:47],v[208:211],v[232:235]
 s_sub_u32 s41,s32,2
 s_and_b32 s41,s41,3
 s_mul_i32 s41,s41,5120
 v_mfma_f32_16x16x32_bf16 a[8:11],v[44:47],v[212:215],a[8:11]
 s_add_u32 s76,s76,4096
 s_cmp_eq_u32 s76,49152
 s_cselect_b32 s76,0,s76
 s_add_u32 s77,s76,s72
 buffer_load_dwordx4 a[76:79],v4,s[28:31],s77 offen sc1
 s_add_u32 s41,s41,24576
 v_add_u32 v125,s41,v4
 v_mfma_f32_16x16x32_bf16 a[8:11],v[40:43],v[196:199],a[8:11]
 s_add_u32 s77,s76,s73
 buffer_load_dwordx4 a[80:83],v4,s[28:31],s77 offen sc1
 s_sub_u32 s41,s32,3
 s_and_b32 s41,s41,3
 s_mul_i32 s41,s41,5120
 v_mfma_f32_16x16x32_bf16 a[28:31],v[40:43],v[200:203],a[28:31]
 s_add_u32 s41,s41,73728
 v_add_u32 v126,s41,v4
 ds_read_b128 a[160:163],v10
 v_mfma_f32_16x16x32_bf16 a[28:31],v[44:47],v[216:219],a[28:31]
 s_add_u32 s77,s76,s78
 ds_read_b128 a[164:167],v10 offset:1024
 ds_read_b64 a[224:225],v11 offset:2048
 v_mfma_f32_16x16x32_bf16 a[48:51],v[44:47],v[220:223],a[48:51]
 buffer_load_dwordx4 a[84:87],v4,s[28:31],s77 offen sc1
 v_mfma_f32_16x16x32_bf16 a[48:51],v[40:43],v[204:207],a[48:51]
 s_add_u32 s77,s76,s79
 s_waitcnt lgkmcnt(5)
 v_mfma_f32_16x16x32_bf16 v[236:239],v[16:19],v[192:195],v[236:239]
 s_waitcnt vmcnt(18)
 ds_read_b128 v[32:35],v9
 ds_read_b128 v[36:39],v6
 v_mfma_f32_16x16x32_bf16 v[236:239],v[20:23],v[208:211],v[236:239]
 buffer_load_dwordx4 a[88:91],v4,s[28:31],s77 offen sc1
 v_mfma_f32_16x16x32_bf16 a[12:15],v[20:23],v[212:215],a[12:15]
 s_add_u32 s76,s76,4096
 s_cmp_eq_u32 s76,49152
 s_cselect_b32 s76,0,s76
 s_add_u32 s77,s76,s72
 buffer_load_dwordx4 a[92:95],v4,s[28:31],s77 offen sc1
 v_mfma_f32_16x16x32_bf16 a[12:15],v[16:19],v[196:199],a[12:15]
 s_add_u32 s77,s76,s73
 buffer_load_dwordx4 a[96:99],v4,s[28:31],s77 offen sc1
 v_mfma_f32_16x16x32_bf16 a[32:35],v[16:19],v[200:203],a[32:35]
 s_add_u32 s77,s76,s78
 buffer_load_dwordx4 a[100:103],v4,s[28:31],s77 offen sc1
 v_mfma_f32_16x16x32_bf16 a[32:35],v[20:23],v[216:219],a[32:35]
 s_add_u32 s77,s76,s79
 buffer_load_dwordx4 a[104:107],v4,s[28:31],s77 offen sc1
 v_mfma_f32_16x16x32_bf16 a[52:55],v[20:23],v[220:223],a[52:55]
 v_mfma_f32_16x16x32_bf16 a[52:55],v[16:19],v[204:207],a[52:55]
 s_waitcnt lgkmcnt(5)
 v_mfma_f32_16x16x32_bf16 v[240:243],v[24:27],v[192:195],v[240:243]
 ds_read_b128 v[40:43],v9 offset:1024
 ds_read_b128 v[44:47],v6 offset:1024
 v_mfma_f32_16x16x32_bf16 v[240:243],v[28:31],v[208:211],v[240:243]
 v_mfma_f32_16x16x32_bf16 a[16:19],v[28:31],v[212:215],a[16:19]
 s_add_u32 s63,s63,20480
 s_cmp_eq_u32 s63,245760
 s_cselect_b32 s63,0,s63
 s_add_u32 m0,s55,73728
 s_nop 0
 buffer_load_dwordx4 v4,s[24:27],s63 offen sc1 lds
 v_mfma_f32_16x16x32_bf16 a[16:19],v[24:27],v[196:199],a[16:19]
 buffer_load_dwordx4 v4,s[24:27],s63 offen offset:1024 sc1 lds
 v_mfma_f32_16x16x32_bf16 a[36:39],v[24:27],v[200:203],a[36:39]
 buffer_load_dwordx4 v4,s[24:27],s63 offen offset:2048 sc1 lds
 v_mfma_f32_16x16x32_bf16 a[36:39],v[28:31],v[216:219],a[36:39]
 buffer_load_dwordx4 v4,s[24:27],s63 offen offset:3072 sc1 lds
 v_mfma_f32_16x16x32_bf16 a[56:59],v[28:31],v[220:223],a[56:59]
 s_add_u32 m0,s55,77824
 s_add_u32 s44,s63,4096
 buffer_load_dwordx4 v4,s[24:27],s44 offen sc1 lds
 v_mfma_f32_16x16x32_bf16 a[56:59],v[24:27],v[204:207],a[56:59]
 s_add_u32 s63,s63,20480
 s_cmp_eq_u32 s63,245760
 s_cselect_b32 s63,0,s63
 s_waitcnt vmcnt(14) lgkmcnt(2)
 v_mfma_f32_16x16x32_bf16 v[224:227],v[32:35],v[144:147],v[224:227]
 ds_read_b128 v[16:19],v9 offset:2048
 ds_read_b128 v[20:23],v6 offset:2048
 v_mfma_f32_16x16x32_bf16 v[224:227],v[36:39],a[60:63],v[224:227]
 s_add_u32 m0,s55,49152
 s_nop 0
 buffer_load_dwordx4 v4,s[24:27],s63 offen sc1 lds
 v_mfma_f32_16x16x32_bf16 a[0:3],v[36:39],a[64:67],a[0:3]
 buffer_load_dwordx4 v4,s[24:27],s63 offen offset:1024 sc1 lds
 s_add_u32 s76,s76,4096
 v_mfma_f32_16x16x32_bf16 a[0:3],v[32:35],v[148:151],a[0:3]
 buffer_load_dwordx4 v4,s[24:27],s63 offen offset:2048 sc1 lds
 s_cmp_eq_u32 s76,49152
 s_cselect_b32 s76,0,s76
 v_mfma_f32_16x16x32_bf16 a[20:23],v[32:35],v[152:155],a[20:23]
 buffer_load_dwordx4 v4,s[24:27],s63 offen offset:3072 sc1 lds
 s_add_u32 s77,s76,s72
 v_mfma_f32_16x16x32_bf16 a[20:23],v[36:39],a[68:71],a[20:23]
 s_add_u32 m0,s55,53248
 s_add_u32 s44,s63,4096
 buffer_load_dwordx4 v4,s[24:27],s44 offen sc1 lds
 v_mfma_f32_16x16x32_bf16 a[40:43],v[36:39],a[72:75],a[40:43]
 buffer_load_dwordx4 a[108:111],v4,s[28:31],s77 offen sc1
 v_mfma_f32_16x16x32_bf16 a[40:43],v[32:35],v[156:159],a[40:43]
 s_waitcnt lgkmcnt(2)
 v_mfma_f32_16x16x32_bf16 v[228:231],v[40:43],v[144:147],v[228:231]
 s_add_u32 s77,s76,s73
 ds_read_b128 v[24:27],v9 offset:3072
 ds_read_b128 v[28:31],v6 offset:3072
 v_mfma_f32_16x16x32_bf16 v[228:231],v[44:47],a[60:63],v[228:231]
 buffer_load_dwordx4 a[112:115],v4,s[28:31],s77 offen sc1
 v_mfma_f32_16x16x32_bf16 a[4:7],v[44:47],a[64:67],a[4:7]
 s_add_u32 s77,s76,s78
 buffer_load_dwordx4 a[116:119],v4,s[28:31],s77 offen sc1
 v_mfma_f32_16x16x32_bf16 a[4:7],v[40:43],v[148:151],a[4:7]
 s_add_u32 s77,s76,s79
 buffer_load_dwordx4 a[120:123],v4,s[28:31],s77 offen sc1
 v_mfma_f32_16x16x32_bf16 a[24:27],v[40:43],v[152:155],a[24:27]
 s_add_u32 s76,s76,4096
 s_cmp_eq_u32 s76,49152
 s_cselect_b32 s76,0,s76
 s_add_u32 s77,s76,s72
 buffer_load_dwordx4 a[124:127],v4,s[28:31],s77 offen sc1
 v_mfma_f32_16x16x32_bf16 a[24:27],v[44:47],a[68:71],a[24:27]
 s_add_u32 s77,s76,s73
 buffer_load_dwordx4 a[128:131],v4,s[28:31],s77 offen sc1
 v_mfma_f32_16x16x32_bf16 a[44:47],v[44:47],a[72:75],a[44:47]
 v_mfma_f32_16x16x32_bf16 a[44:47],v[40:43],v[156:159],a[44:47]
 s_waitcnt lgkmcnt(2)
 v_mfma_f32_16x16x32_bf16 v[232:235],v[16:19],v[144:147],v[232:235]
 ds_read_b128 v[32:35],v9 offset:4096
 ds_read_b128 v[36:39],v6 offset:4096
 v_mfma_f32_16x16x32_bf16 v[232:235],v[20:23],a[60:63],v[232:235]
 s_add_u32 s77,s76,s78
 v_mfma_f32_16x16x32_bf16 a[8:11],v[20:23],a[64:67],a[8:11]
 buffer_load_dwordx4 a[132:135],v4,s[28:31],s77 offen sc1
 v_mfma_f32_16x16x32_bf16 a[8:11],v[16:19],v[148:151],a[8:11]
 v_mfma_f32_16x16x32_bf16 a[28:31],v[16:19],v[152:155],a[28:31]
 v_mfma_f32_16x16x32_bf16 a[28:31],v[20:23],a[68:71],a[28:31]
 s_add_u32 s77,s76,s79
 v_mfma_f32_16x16x32_bf16 a[48:51],v[20:23],a[72:75],a[48:51]
 buffer_load_dwordx4 a[136:139],v4,s[28:31],s77 offen sc1
 v_mfma_f32_16x16x32_bf16 a[48:51],v[16:19],v[156:159],a[48:51]
 s_add_u32 s76,s76,4096
 s_waitcnt lgkmcnt(2)
 v_mfma_f32_16x16x32_bf16 v[236:239],v[24:27],v[144:147],v[236:239]
 s_waitcnt vmcnt(26)
 ds_read_b128 v[40:43],v9 offset:24576
 ds_read_b128 v[44:47],v6 offset:24576
 v_mfma_f32_16x16x32_bf16 v[236:239],v[28:31],a[60:63],v[236:239]
 s_cmp_eq_u32 s76,49152
 s_cselect_b32 s76,0,s76
 v_mfma_f32_16x16x32_bf16 a[12:15],v[28:31],a[64:67],a[12:15]
 s_add_u32 s77,s76,s72
 v_mfma_f32_16x16x32_bf16 a[12:15],v[24:27],v[148:151],a[12:15]
 buffer_load_dwordx4 a[140:143],v4,s[28:31],s77 offen sc1
 v_mfma_f32_16x16x32_bf16 a[32:35],v[24:27],v[152:155],a[32:35]
 v_mfma_f32_16x16x32_bf16 a[32:35],v[28:31],a[68:71],a[32:35]
 v_mfma_f32_16x16x32_bf16 a[52:55],v[28:31],a[72:75],a[52:55]
 v_mfma_f32_16x16x32_bf16 a[52:55],v[24:27],v[156:159],a[52:55]
 s_waitcnt lgkmcnt(2)
 v_mfma_f32_16x16x32_bf16 v[240:243],v[32:35],v[144:147],v[240:243]
 s_add_u32 s77,s76,s73
 ds_read_b128 v[16:19],v9 offset:25600
 ds_read_b128 v[20:23],v6 offset:25600
 v_mfma_f32_16x16x32_bf16 v[240:243],v[36:39],a[60:63],v[240:243]
 buffer_load_dwordx4 a[144:147],v4,s[28:31],s77 offen sc1
 v_mfma_f32_16x16x32_bf16 a[16:19],v[36:39],a[64:67],a[16:19]
 s_add_u32 s63,s63,20480
 s_cmp_eq_u32 s63,245760
 s_cselect_b32 s63,0,s63
 s_add_u32 m0,s55,98304
 s_nop 0
 buffer_load_dwordx4 v4,s[24:27],s63 offen sc1 lds
 v_mfma_f32_16x16x32_bf16 a[16:19],v[32:35],v[148:151],a[16:19]
 buffer_load_dwordx4 v4,s[24:27],s63 offen offset:1024 sc1 lds
 v_mfma_f32_16x16x32_bf16 a[36:39],v[32:35],v[152:155],a[36:39]
 buffer_load_dwordx4 v4,s[24:27],s63 offen offset:2048 sc1 lds
 v_mfma_f32_16x16x32_bf16 a[36:39],v[36:39],a[68:71],a[36:39]
 buffer_load_dwordx4 v4,s[24:27],s63 offen offset:3072 sc1 lds
 v_mfma_f32_16x16x32_bf16 a[56:59],v[36:39],a[72:75],a[56:59]
 s_add_u32 m0,s55,102400
 s_add_u32 s44,s63,4096
 buffer_load_dwordx4 v4,s[24:27],s44 offen sc1 lds
 v_mfma_f32_16x16x32_bf16 a[56:59],v[32:35],v[156:159],a[56:59]
 s_add_u32 s63,s63,20480
 s_cmp_eq_u32 s63,245760
 s_cselect_b32 s63,0,s63
 s_waitcnt vmcnt(25) lgkmcnt(2)
 v_mfma_f32_16x16x32_bf16 v[224:227],v[40:43],a[76:79],v[224:227]
 ds_read_b128 v[24:27],v9 offset:26624
 ds_read_b128 v[28:31],v6 offset:26624
 v_mfma_f32_16x16x32_bf16 v[224:227],v[44:47],a[92:95],v[224:227]
 s_add_u32 m0,s55,0
 s_nop 0
 buffer_load_dwordx4 v4,s[24:27],s63 offen sc1 lds
 v_mfma_f32_16x16x32_bf16 a[0:3],v[44:47],a[96:99],a[0:3]
 buffer_load_dwordx4 v4,s[24:27],s63 offen offset:1024 sc1 lds
 v_mfma_f32_16x16x32_bf16 a[0:3],v[40:43],a[80:83],a[0:3]
 buffer_load_dwordx4 v4,s[24:27],s63 offen offset:2048 sc1 lds
 v_mfma_f32_16x16x32_bf16 a[20:23],v[40:43],a[84:87],a[20:23]
 buffer_load_dwordx4 v4,s[24:27],s63 offen offset:3072 sc1 lds
 s_add_u32 s77,s76,s78
 v_mfma_f32_16x16x32_bf16 a[20:23],v[44:47],a[100:103],a[20:23]
 s_add_u32 m0,s55,4096
 s_add_u32 s44,s63,4096
 buffer_load_dwordx4 v4,s[24:27],s44 offen sc1 lds
 v_mfma_f32_16x16x32_bf16 a[40:43],v[44:47],a[104:107],a[40:43]
 buffer_load_dwordx4 a[148:151],v4,s[28:31],s77 offen sc1
 v_mfma_f32_16x16x32_bf16 a[40:43],v[40:43],a[88:91],a[40:43]
 s_waitcnt lgkmcnt(2)
 v_mfma_f32_16x16x32_bf16 v[228:231],v[16:19],a[76:79],v[228:231]
 s_add_u32 s77,s76,s79
 ds_read_b128 v[32:35],v9 offset:27648
 ds_read_b128 v[36:39],v6 offset:27648
 v_mfma_f32_16x16x32_bf16 v[228:231],v[20:23],a[92:95],v[228:231]
 s_add_u32 m0,s49,0
 s_mov_b32 s44,0
 buffer_load_dwordx4 v1,s[20:23],s44 offen lds
 v_mfma_f32_16x16x32_bf16 a[4:7],v[20:23],a[96:99],a[4:7]
 buffer_load_dwordx4 a[152:155],v4,s[28:31],s77 offen sc1
 v_mfma_f32_16x16x32_bf16 a[4:7],v[16:19],a[80:83],a[4:7]
 s_add_u32 s76,s76,4096
 s_cmp_eq_u32 s76,49152
 s_cselect_b32 s76,0,s76
 s_add_u32 s77,s76,s72
 buffer_load_dwordx4 a[156:159],v4,s[28:31],s77 offen sc1
 v_mfma_f32_16x16x32_bf16 a[24:27],v[16:19],a[84:87],a[24:27]
 buffer_load_dwordx4 v2,s[20:23],s44 offen offset:1024 lds
 s_add_u32 s77,s76,s73
 v_mfma_f32_16x16x32_bf16 a[24:27],v[20:23],a[100:103],a[24:27]
 buffer_load_dwordx4 a[244:247],v4,s[28:31],s77 offen sc1
 v_mfma_f32_16x16x32_bf16 a[44:47],v[20:23],a[104:107],a[44:47]
 v_mfma_f32_16x16x32_bf16 a[44:47],v[16:19],a[88:91],a[44:47]
 s_waitcnt lgkmcnt(2)
 v_mfma_f32_16x16x32_bf16 v[232:235],v[24:27],a[76:79],v[232:235]
 ds_read_b128 v[40:43],v9 offset:28672
 ds_read_b128 v[44:47],v6 offset:28672
 v_mfma_f32_16x16x32_bf16 v[232:235],v[28:31],a[92:95],v[232:235]
 s_add_u32 s77,s76,s78
 v_mfma_f32_16x16x32_bf16 a[8:11],v[28:31],a[96:99],a[8:11]
 buffer_load_dwordx4 a[248:251],v4,s[28:31],s77 offen sc1
 v_mfma_f32_16x16x32_bf16 a[8:11],v[24:27],a[80:83],a[8:11]
 buffer_load_dwordx4 v3,s[20:23],s44 offen offset:2048 lds
 v_mfma_f32_16x16x32_bf16 a[28:31],v[24:27],a[84:87],a[28:31]
 v_mfma_f32_16x16x32_bf16 a[28:31],v[28:31],a[100:103],a[28:31]
 s_add_u32 s77,s76,s79
 v_mfma_f32_16x16x32_bf16 a[48:51],v[28:31],a[104:107],a[48:51]
 buffer_load_dwordx4 a[252:255],v4,s[28:31],s77 offen sc1
 v_mfma_f32_16x16x32_bf16 a[48:51],v[24:27],a[88:91],a[48:51]
 s_waitcnt lgkmcnt(2)
 v_mfma_f32_16x16x32_bf16 v[236:239],v[32:35],a[76:79],v[236:239]
 s_waitcnt vmcnt(29)
 ds_read_b128 v[16:19],v8 offset:24576
 ds_read_b128 v[20:23],v8
 v_mfma_f32_16x16x32_bf16 v[236:239],v[36:39],a[92:95],v[236:239]
 v_mfma_f32_16x16x32_bf16 a[12:15],v[36:39],a[96:99],a[12:15]
 v_mfma_f32_16x16x32_bf16 a[12:15],v[32:35],a[80:83],a[12:15]
 buffer_load_dwordx4 v[244:247],v4,s[28:31],s56 offen sc1
 v_mfma_f32_16x16x32_bf16 a[32:35],v[32:35],a[84:87],a[32:35]
 v_mfma_f32_16x16x32_bf16 a[32:35],v[36:39],a[100:103],a[32:35]
 v_mfma_f32_16x16x32_bf16 a[52:55],v[36:39],a[104:107],a[52:55]
 v_mfma_f32_16x16x32_bf16 a[52:55],v[32:35],a[88:91],a[52:55]
 s_waitcnt lgkmcnt(2)
 v_mfma_f32_16x16x32_bf16 v[240:243],v[40:43],a[76:79],v[240:243]
 ds_read_b128 v[24:27],v8 offset:25600
 ds_read_b128 v[28:31],v8 offset:1024
 v_mfma_f32_16x16x32_bf16 v[240:243],v[44:47],a[92:95],v[240:243]
 v_mfma_f32_16x16x32_bf16 a[16:19],v[44:47],a[96:99],a[16:19]
 buffer_load_dwordx4 v[248:251],v4,s[28:31],s56 offen offset:1024 sc1
 v_mfma_f32_16x16x32_bf16 a[16:19],v[40:43],a[80:83],a[16:19]
 v_mfma_f32_16x16x32_bf16 a[36:39],v[40:43],a[84:87],a[36:39]
 v_mfma_f32_16x16x32_bf16 a[36:39],v[44:47],a[100:103],a[36:39]
 v_mfma_f32_16x16x32_bf16 a[56:59],v[44:47],a[104:107],a[56:59]
 v_mfma_f32_16x16x32_bf16 a[56:59],v[40:43],a[88:91],a[56:59]
 s_waitcnt vmcnt(23) lgkmcnt(2)
 v_mfma_f32_16x16x32_bf16 v[224:227],v[16:19],a[108:111],v[224:227]
 ds_read_b128 v[32:35],v8 offset:26624
 ds_read_b128 v[36:39],v8 offset:2048
 v_mfma_f32_16x16x32_bf16 v[224:227],v[20:23],a[124:127],v[224:227]
 v_mfma_f32_16x16x32_bf16 a[0:3],v[20:23],a[128:131],a[0:3]
 v_mfma_f32_16x16x32_bf16 a[0:3],v[16:19],a[112:115],a[0:3]
 v_mfma_f32_16x16x32_bf16 a[20:23],v[16:19],a[116:119],a[20:23]
 v_mfma_f32_16x16x32_bf16 a[20:23],v[20:23],a[132:135],a[20:23]
 v_mfma_f32_16x16x32_bf16 a[40:43],v[20:23],a[136:139],a[40:43]
 v_mfma_f32_16x16x32_bf16 a[40:43],v[16:19],a[120:123],a[40:43]
 s_waitcnt lgkmcnt(2)
 v_mfma_f32_16x16x32_bf16 v[228:231],v[24:27],a[108:111],v[228:231]
 ds_read_b128 v[40:43],v8 offset:27648
 ds_read_b128 v[44:47],v8 offset:3072
 v_mfma_f32_16x16x32_bf16 v[228:231],v[28:31],a[124:127],v[228:231]
 v_mfma_f32_16x16x32_bf16 a[4:7],v[28:31],a[128:131],a[4:7]
 buffer_load_dwordx2 v[252:253],v5,s[28:31],s57 offen sc1
 v_mfma_f32_16x16x32_bf16 a[4:7],v[24:27],a[112:115],a[4:7]
 v_mfma_f32_16x16x32_bf16 a[24:27],v[24:27],a[116:119],a[24:27]
 v_mfma_f32_16x16x32_bf16 a[24:27],v[28:31],a[132:135],a[24:27]
 v_mfma_f32_16x16x32_bf16 a[44:47],v[28:31],a[136:139],a[44:47]
 v_mfma_f32_16x16x32_bf16 a[44:47],v[24:27],a[120:123],a[44:47]
 s_waitcnt lgkmcnt(2)
 v_mfma_f32_16x16x32_bf16 v[232:235],v[32:35],a[108:111],v[232:235]
 ds_read_b128 v[16:19],v8 offset:28672
 ds_read_b128 v[20:23],v8 offset:4096
 v_mfma_f32_16x16x32_bf16 v[232:235],v[36:39],a[124:127],v[232:235]
 v_mfma_f32_16x16x32_bf16 a[8:11],v[36:39],a[128:131],a[8:11]
 v_mfma_f32_16x16x32_bf16 a[8:11],v[32:35],a[112:115],a[8:11]
 v_mfma_f32_16x16x32_bf16 a[28:31],v[32:35],a[116:119],a[28:31]
 v_mfma_f32_16x16x32_bf16 a[28:31],v[36:39],a[132:135],a[28:31]
 v_mfma_f32_16x16x32_bf16 a[48:51],v[36:39],a[136:139],a[48:51]
 v_mfma_f32_16x16x32_bf16 a[48:51],v[32:35],a[120:123],a[48:51]
 s_waitcnt lgkmcnt(2)
 v_mfma_f32_16x16x32_bf16 v[236:239],v[40:43],a[108:111],v[236:239]
 s_waitcnt vmcnt(12)
 ds_read_b128 v[24:27],v9
 ds_read_b128 v[28:31],v6
 v_mfma_f32_16x16x32_bf16 v[236:239],v[44:47],a[124:127],v[236:239]
 v_mfma_f32_16x16x32_bf16 a[12:15],v[44:47],a[128:131],a[12:15]
 v_mfma_f32_16x16x32_bf16 a[12:15],v[40:43],a[112:115],a[12:15]
 v_mfma_f32_16x16x32_bf16 a[32:35],v[40:43],a[116:119],a[32:35]
 v_mfma_f32_16x16x32_bf16 a[32:35],v[44:47],a[132:135],a[32:35]
 v_mfma_f32_16x16x32_bf16 a[52:55],v[44:47],a[136:139],a[52:55]
 v_mfma_f32_16x16x32_bf16 a[52:55],v[40:43],a[120:123],a[52:55]
 s_waitcnt lgkmcnt(2)
 v_mfma_f32_16x16x32_bf16 v[240:243],v[16:19],a[108:111],v[240:243]
 ds_read_b128 v[32:35],v9 offset:1024
 ds_read_b128 v[36:39],v6 offset:1024
 v_mfma_f32_16x16x32_bf16 v[240:243],v[20:23],a[124:127],v[240:243]
 v_mfma_f32_16x16x32_bf16 a[16:19],v[20:23],a[128:131],a[16:19]
 v_mfma_f32_16x16x32_bf16 a[16:19],v[16:19],a[112:115],a[16:19]
 v_mfma_f32_16x16x32_bf16 a[36:39],v[16:19],a[116:119],a[36:39]
 v_mfma_f32_16x16x32_bf16 a[36:39],v[20:23],a[132:135],a[36:39]
 v_mfma_f32_16x16x32_bf16 a[56:59],v[20:23],a[136:139],a[56:59]
 v_mfma_f32_16x16x32_bf16 a[56:59],v[16:19],a[120:123],a[56:59]
 s_waitcnt vmcnt(3) lgkmcnt(2)
 v_mfma_f32_16x16x32_bf16 v[224:227],v[24:27],a[140:143],v[224:227]
 ds_read_b128 v[40:43],v9 offset:2048
 ds_read_b128 v[44:47],v6 offset:2048
 v_mfma_f32_16x16x32_bf16 v[224:227],v[28:31],a[156:159],v[224:227]
 s_waitcnt vmcnt(4)
 ds_read_b64 v[180:181],v58
 ds_read_b64 v[182:183],v58 offset:32
 v_mfma_f32_16x16x32_bf16 a[0:3],v[28:31],a[244:247],a[0:3]
 ds_read_b64 v[184:185],v58 offset:64
 ds_read_b64 v[186:187],v58 offset:96
 v_mfma_f32_16x16x32_bf16 a[0:3],v[24:27],a[144:147],a[0:3]
 ds_read_b64 v[188:189],v59
 v_mfma_f32_16x16x32_bf16 a[20:23],v[24:27],a[148:151],a[20:23]
 s_lshl_b32 s41,s58,1
 v_subrev_u32 v60,s41,v60
 v_cmp_gt_u32 vcc,10,v60
 v_mfma_f32_16x16x32_bf16 a[20:23],v[28:31],a[248:251],a[20:23]
 v_mov_b32 v7,0x40000000
 v_cndmask_b32 v1,v7,v1,vcc
 v_mfma_f32_16x16x32_bf16 a[40:43],v[28:31],a[252:255],a[40:43]
 s_lshl_b32 s41,s58,1
 v_subrev_u32 v61,s41,v61
 v_cmp_gt_u32 vcc,10,v61
 v_mfma_f32_16x16x32_bf16 a[40:43],v[24:27],a[152:155],a[40:43]
 s_waitcnt lgkmcnt(7)
 v_mov_b32 v7,0x40000000
 v_cndmask_b32 v2,v7,v2,vcc
 v_mfma_f32_16x16x32_bf16 v[228:231],v[32:35],a[140:143],v[228:231]
 ds_read_b128 v[16:19],v9 offset:3072
 ds_read_b128 v[20:23],v6 offset:3072
 v_mfma_f32_16x16x32_bf16 v[228:231],v[36:39],a[156:159],v[228:231]
 s_lshl_b32 s41,s58,1
 v_subrev_u32 v62,s41,v62
 v_cmp_gt_u32 vcc,10,v62
 v_mfma_f32_16x16x32_bf16 a[4:7],v[36:39],a[244:247],a[4:7]
 v_mov_b32 v7,0x40000000
 v_cndmask_b32 v3,v7,v3,vcc
 v_mfma_f32_16x16x32_bf16 a[4:7],v[32:35],a[144:147],a[4:7]
 v_mfma_f32_16x16x32_bf16 a[24:27],v[32:35],a[148:151],a[24:27]
 v_mfma_f32_16x16x32_bf16 a[24:27],v[36:39],a[248:251],a[24:27]
 ds_write_b128 v9,a[0:3] offset:24576
 ds_write_b128 v6,a[20:23] offset:24576
 v_mfma_f32_16x16x32_bf16 a[44:47],v[36:39],a[252:255],a[44:47]
 ds_write_b128 v8,a[40:43] offset:24576
 v_mfma_f32_16x16x32_bf16 a[44:47],v[32:35],a[152:155],a[44:47]
 s_waitcnt lgkmcnt(10)
 v_mfma_f32_16x16x32_bf16 v[232:235],v[40:43],a[140:143],v[232:235]
 ds_read_b128 v[24:27],v9 offset:4096
 ds_read_b128 v[28:31],v6 offset:4096
 v_mfma_f32_16x16x32_bf16 v[232:235],v[44:47],a[156:159],v[232:235]
 v_mfma_f32_16x16x32_bf16 a[8:11],v[44:47],a[244:247],a[8:11]
 v_mfma_f32_16x16x32_bf16 a[8:11],v[40:43],a[144:147],a[8:11]
 v_mfma_f32_16x16x32_bf16 a[28:31],v[40:43],a[148:151],a[28:31]
 buffer_load_dword v13,v12,s[92:95],0 offen sc1
 v_mfma_f32_16x16x32_bf16 a[28:31],v[44:47],a[248:251],a[28:31]
 ds_write_b128 v9,a[4:7] offset:25600
 ds_write_b128 v6,a[24:27] offset:25600
 v_mfma_f32_16x16x32_bf16 a[48:51],v[44:47],a[252:255],a[48:51]
 ds_write_b128 v8,a[44:47] offset:25600
 v_mfma_f32_16x16x32_bf16 a[48:51],v[40:43],a[152:155],a[48:51]
 s_waitcnt lgkmcnt(8)
 v_mfma_f32_16x16x32_bf16 v[236:239],v[16:19],a[140:143],v[236:239]
 v_mfma_f32_16x16x32_bf16 v[236:239],v[20:23],a[156:159],v[236:239]
 v_mfma_f32_16x16x32_bf16 a[12:15],v[20:23],a[244:247],a[12:15]
 v_mfma_f32_16x16x32_bf16 a[12:15],v[16:19],a[144:147],a[12:15]
 v_mfma_f32_16x16x32_bf16 a[32:35],v[16:19],a[148:151],a[32:35]
 v_mfma_f32_16x16x32_bf16 a[32:35],v[20:23],a[248:251],a[32:35]
 ds_write_b128 v9,a[8:11] offset:26624
 ds_write_b128 v6,a[28:31] offset:26624
 v_mfma_f32_16x16x32_bf16 a[52:55],v[20:23],a[252:255],a[52:55]
 ds_write_b128 v8,a[48:51] offset:26624
 v_mfma_f32_16x16x32_bf16 a[52:55],v[16:19],a[152:155],a[52:55]
 s_waitcnt lgkmcnt(6)
 v_mfma_f32_16x16x32_bf16 v[240:243],v[24:27],a[140:143],v[240:243]
 v_mfma_f32_16x16x32_bf16 v[240:243],v[28:31],a[156:159],v[240:243]
 v_mfma_f32_16x16x32_bf16 a[16:19],v[28:31],a[244:247],a[16:19]
 v_mfma_f32_16x16x32_bf16 a[16:19],v[24:27],a[144:147],a[16:19]
 v_mfma_f32_16x16x32_bf16 a[36:39],v[24:27],a[148:151],a[36:39]
 v_mfma_f32_16x16x32_bf16 a[36:39],v[28:31],a[248:251],a[36:39]
 ds_write_b128 v9,a[12:15] offset:27648
 ds_write_b128 v6,a[32:35] offset:27648
 v_mfma_f32_16x16x32_bf16 a[56:59],v[28:31],a[252:255],a[56:59]
 ds_write_b128 v8,a[52:55] offset:27648
 v_mfma_f32_16x16x32_bf16 a[56:59],v[24:27],a[152:155],a[56:59]
 s_waitcnt vmcnt(1)
 v_mfma_f32_16x16x32_bf16 v[224:227],v[50:53],v[244:247],v[224:227]
 v_mfma_f32_16x16x32_bf16 v[228:231],v[48:51],v[244:247],v[228:231]
 v_mfma_f32_16x16x32_bf16 v[232:235],v[50:53],v[248:251],v[232:235]
 v_mfma_f32_16x16x32_bf16 v[236:239],v[48:51],v[248:251],v[236:239]
 v_mfma_f32_16x16x32_bf16 v[240:243],v[50:53],v[252:255],v[240:243]
 ds_write_b128 v9,a[16:19] offset:28672
 ds_write_b128 v6,a[36:39] offset:28672
 ds_write_b128 v8,a[56:59] offset:28672
 s_waitcnt lgkmcnt(0)
 s_barrier
 ds_read_b128 v[64:67],v124
 ds_read_b128 v[68:71],v124 offset:1024
 ds_read_b128 v[72:75],v124 offset:2048
 ds_read_b128 v[76:79],v124 offset:3072
 ds_read_b128 v[80:83],v124 offset:4096
 ds_read_b128 v[84:87],v125
 ds_read_b128 v[88:91],v125 offset:1024
 ds_read_b128 v[92:95],v125 offset:2048
 ds_read_b128 v[96:99],v125 offset:3072
 ds_read_b128 v[100:103],v125 offset:4096
 ds_read_b128 v[104:107],v126
 ds_read_b128 v[108:111],v126 offset:1024
 ds_read_b128 v[112:115],v126 offset:2048
 ds_read_b128 v[116:119],v126 offset:3072
 ds_read_b128 v[120:123],v126 offset:4096
 s_cmp_eq_u32 s61,0
 s_cbranch_scc0 Lz31
 s_waitcnt vmcnt(0)
 v_cmp_ne_u32 vcc,s51,v13
 s_nop 1
 s_cbranch_vccnz Lp32_spin
Lp32_ok:
 s_add_u32 s42,s52,1
 s_and_b32 s42,s42,7
 s_mul_i32 s42,s42,10240
 s_add_u32 s42,s42,s38
 buffer_load_dwordx4 a[168:171],v4,s[28:31],s42 offen sc1
 buffer_load_dwordx4 a[172:175],v4,s[28:31],s42 offen offset:1024 sc1
 buffer_load_dwordx2 a[226:227],v5,s[28:31],s42 offen offset:2048 sc1
 s_add_u32 s42,s52,2
 s_and_b32 s42,s42,7
 s_mul_i32 s42,s42,10240
 s_add_u32 s42,s42,s38
 buffer_load_dwordx4 a[176:179],v4,s[28:31],s42 offen sc1
 buffer_load_dwordx4 a[180:183],v4,s[28:31],s42 offen offset:1024 sc1
 buffer_load_dwordx2 a[228:229],v5,s[28:31],s42 offen offset:2048 sc1
 s_add_u32 s42,s52,3
 s_and_b32 s42,s42,7
 s_mul_i32 s42,s42,10240
 s_add_u32 s42,s42,s38
 buffer_load_dwordx4 a[184:187],v4,s[28:31],s42 offen sc1
 buffer_load_dwordx4 a[188:191],v4,s[28:31],s42 offen offset:1024 sc1
 buffer_load_dwordx2 a[230:231],v5,s[28:31],s42 offen offset:2048 sc1
 s_add_u32 s42,s52,4
 s_and_b32 s42,s42,7
 s_mul_i32 s42,s42,10240
 s_add_u32 s42,s42,s38
 buffer_load_dwordx4 a[192:195],v4,s[28:31],s42 offen sc1
 buffer_load_dwordx4 a[196:199],v4,s[28:31],s42 offen offset:1024 sc1
 buffer_load_dwordx2 a[232:233],v5,s[28:31],s42 offen offset:2048 sc1
 s_add_u32 s42,s52,5
 s_and_b32 s42,s42,7
 s_mul_i32 s42,s42,10240
 s_add_u32 s42,s42,s38
 buffer_load_dwordx4 a[200:203],v4,s[28:31],s42 offen sc1
 buffer_load_dwordx4 a[204:207],v4,s[28:31],s42 offen offset:1024 sc1
 buffer_load_dwordx2 a[234:235],v5,s[28:31],s42 offen offset:2048 sc1
 s_add_u32 s42,s52,6
 s_and_b32 s42,s42,7
 s_mul_i32 s42,s42,10240
 s_add_u32 s42,s42,s38
 buffer_load_dwordx4 a[208:211],v4,s[28:31],s42 offen sc1
 buffer_load_dwordx4 a[212:215],v4,s[28:31],s42 offen offset:1024 sc1
 buffer_load_dwordx2 a[236:237],v5,s[28:31],s42 offen offset:2048 sc1
 s_add_u32 s42,s52,7
 s_and_b32 s42,s42,7
 s_mul_i32 s42,s42,10240
 s_add_u32 s42,s42,s38
 buffer_load_dwordx4 a[216:219],v4,s[28:31],s42 offen sc1
 buffer_load_dwordx4 a[220:223],v4,s[28:31],s42 offen offset:1024 sc1
 buffer_load_dwordx2 a[238:239],v5,s[28:31],s42 offen offset:2048 sc1
Lz31:
 s_waitcnt lgkmcnt(10)
 v_add_f32 v224,v224,v64
 v_add_f32 v225,v225,v65
 v_add_f32 v226,v226,v66
 v_add_f32 v227,v227,v67
 v_add_f32 v228,v228,v68
 v_add_f32 v229,v229,v69
 v_add_f32 v230,v230,v70
 v_add_f32 v231,v231,v71
 v_add_f32 v232,v232,v72
 v_add_f32 v233,v233,v73
 v_add_f32 v234,v234,v74
 v_add_f32 v235,v235,v75
 v_add_f32 v236,v236,v76
 v_add_f32 v237,v237,v77
 v_add_f32 v238,v238,v78
 v_add_f32 v239,v239,v79
 v_add_f32 v240,v240,v80
 v_add_f32 v241,v241,v81
 v_add_f32 v242,v242,v82
 v_add_f32 v243,v243,v83
 s_waitcnt lgkmcnt(5)
 v_add_f32 v224,v224,v84
 v_add_f32 v225,v225,v85
 v_add_f32 v226,v226,v86
 v_add_f32 v227,v227,v87
 v_add_f32 v228,v228,v88
 v_add_f32 v229,v229,v89
 v_add_f32 v230,v230,v90
 v_add_f32 v231,v231,v91
 v_add_f32 v232,v232,v92
 v_add_f32 v233,v233,v93
 v_add_f32 v234,v234,v94
 v_add_f32 v235,v235,v95
 v_add_f32 v236,v236,v96
 v_add_f32 v237,v237,v97
 v_add_f32 v238,v238,v98
 v_add_f32 v239,v239,v99
 v_add_f32 v240,v240,v100
 v_add_f32 v241,v241,v101
 v_add_f32 v242,v242,v102
 v_add_f32 v243,v243,v103
 s_waitcnt lgkmcnt(0)
 v_add_f32 v224,v224,v104
 v_add_f32 v225,v225,v105
 v_add_f32 v226,v226,v106
 v_add_f32 v227,v227,v107
 v_add_f32 v228,v228,v108
 v_add_f32 v229,v229,v109
 v_add_f32 v230,v230,v110
 v_add_f32 v231,v231,v111
 v_add_f32 v232,v232,v112
 v_add_f32 v233,v233,v113
 v_add_f32 v234,v234,v114
 v_add_f32 v235,v235,v115
 v_add_f32 v236,v236,v116
 v_add_f32 v237,v237,v117
 v_add_f32 v238,v238,v118
 v_add_f32 v239,v239,v119
 v_add_f32 v240,v240,v120
 v_add_f32 v241,v241,v121
 v_add_f32 v242,v242,v122
 v_add_f32 v243,v243,v123
 v_mul_f32 v200,0xbfb8aa3b,v224
 v_mul_f32 v201,0xbfb8aa3b,v225
 v_mul_f32 v202,0xbfb8aa3b,v226
 v_mul_f32 v203,0xbfb8aa3b,v227
 v_mul_f32 v204,0xbfb8aa3b,v228
 v_mul_f32 v205,0xbfb8aa3b,v229
 v_mul_f32 v206,0xbfb8aa3b,v230
 v_mul_f32 v207,0xbfb8aa3b,v231
 v_mul_f32 v208,0xbfb8aa3b,v232
 v_mul_f32 v209,0xbfb8aa3b,v233
 v_mul_f32 v210,0xbfb8aa3b,v234
 v_mul_f32 v211,0xbfb8aa3b,v235
 v_mul_f32 v212,0xbfb8aa3b,v236
 v_mul_f32 v213,0xbfb8aa3b,v237
 v_mul_f32 v214,0xbfb8aa3b,v238
 v_mul_f32 v215,0xbfb8aa3b,v239
 v_mul_f32 v216,0xbfb8aa3b,v240
 v_mul_f32 v217,0xbfb8aa3b,v241
 v_mul_f32 v218,0xbfb8aa3b,v242
 v_mul_f32 v219,0xbfb8aa3b,v243
 v_exp_f32 v200,v200
 v_exp_f32 v201,v201
 v_exp_f32 v202,v202
 v_exp_f32 v203,v203
 v_exp_f32 v204,v204
 v_exp_f32 v205,v205
 v_exp_f32 v206,v206
 v_exp_f32 v207,v207
 v_exp_f32 v208,v208
 v_exp_f32 v209,v209
 v_exp_f32 v210,v210
 v_exp_f32 v211,v211
 v_exp_f32 v212,v212
 v_exp_f32 v213,v213
 v_exp_f32 v214,v214
 v_exp_f32 v215,v215
 v_exp_f32 v216,v216
 v_exp_f32 v217,v217
 v_exp_f32 v218,v218
 v_exp_f32 v219,v219
 v_add_f32 v200,1.0,v200
 v_add_f32 v201,1.0,v201
 v_add_f32 v202,1.0,v202
 v_add_f32 v203,1.0,v203
 v_add_f32 v204,1.0,v204
 v_add_f32 v205,1.0,v205
 v_add_f32 v206,1.0,v206
 v_add_f32 v207,1.0,v207
 v_add_f32 v208,1.0,v208
 v_add_f32 v209,1.0,v209
 v_add_f32 v210,1.0,v210
 v_add_f32 v211,1.0,v211
 v_add_f32 v212,1.0,v212
 v_add_f32 v213,1.0,v213
 v_add_f32 v214,1.0,v214
 v_add_f32 v215,1.0,v215
 v_add_f32 v216,1.0,v216
 v_add_f32 v217,1.0,v217
 v_add_f32 v218,1.0,v218
 v_add_f32 v219,1.0,v219
 v_rcp_f32 v200,v200
 v_rcp_f32 v201,v201
 v_rcp_f32 v202,v202
 v_rcp_f32 v203,v203
 v_rcp_f32 v204,v204
 v_rcp_f32 v205,v205
 v_rcp_f32 v206,v206
 v_rcp_f32 v207,v207
 v_rcp_f32 v208,v208
 v_rcp_f32 v209,v209
 v_rcp_f32 v210,v210
 v_rcp_f32 v211,v211
 v_rcp_f32 v212,v212
 v_rcp_f32 v213,v213
 v_rcp_f32 v214,v214
 v_rcp_f32 v215,v215
 v_rcp_f32 v216,v216
 v_rcp_f32 v217,v217
 v_rcp_f32 v218,v218
 v_rcp_f32 v219,v219
 s_waitcnt vmcnt(18)
 v_mfma_f32_16x16x32_bf16 v[160:163],v[50:53],a[160:163],0
 v_mul_f32 v224,v224,v200
 v_mul_f32 v225,v225,v201
 v_mfma_f32_16x16x32_bf16 v[160:163],v[50:53],a[168:171],v[160:163]
 v_mul_f32 v226,v226,v202
 v_mul_f32 v227,v227,v203
 v_mfma_f32_16x16x32_bf16 v[164:167],v[48:51],a[160:163],0
 v_mul_f32 v228,v228,v204
 v_mul_f32 v229,v229,v205
 v_mfma_f32_16x16x32_bf16 v[164:167],v[48:51],a[168:171],v[164:167]
 v_mul_f32 v230,v230,v206
 v_mul_f32 v231,v231,v207
 v_mfma_f32_16x16x32_bf16 v[168:171],v[50:53],a[164:167],0
 v_mul_f32 v232,v232,v208
 v_mul_f32 v233,v233,v209
 v_mfma_f32_16x16x32_bf16 v[168:171],v[50:53],a[172:175],v[168:171]
 v_mul_f32 v234,v234,v210
 v_mul_f32 v235,v235,v211
 v_mfma_f32_16x16x32_bf16 v[172:175],v[48:51],a[164:167],0
 v_mul_f32 v236,v236,v212
 v_mul_f32 v237,v237,v213
 v_mfma_f32_16x16x32_bf16 v[172:175],v[48:51],a[172:175],v[172:175]
 v_mul_f32 v238,v238,v214
 v_mul_f32 v239,v239,v215
 v_mfma_f32_16x16x32_bf16 v[176:179],v[54:57],a[224:227],0
 s_waitcnt vmcnt(12)
 v_mul_f32 v240,v240,v216
 v_mul_f32 v241,v241,v217
 v_mfma_f32_16x16x32_bf16 v[160:163],v[50:53],a[176:179],v[160:163]
 v_mul_f32 v242,v242,v218
 v_mul_f32 v243,v243,v219
 v_mfma_f32_16x16x32_bf16 v[160:163],v[50:53],a[184:187],v[160:163]
 v_lshlrev_b32 v200,16,v180
 v_and_b32 v201,0xffff0000,v180
 v_mfma_f32_16x16x32_bf16 v[164:167],v[48:51],a[176:179],v[164:167]
 v_lshlrev_b32 v202,16,v181
 v_and_b32 v203,0xffff0000,v181
 v_mfma_f32_16x16x32_bf16 v[164:167],v[48:51],a[184:187],v[164:167]
 v_lshlrev_b32 v204,16,v182
 v_and_b32 v205,0xffff0000,v182
 v_mfma_f32_16x16x32_bf16 v[168:171],v[50:53],a[180:183],v[168:171]
 v_lshlrev_b32 v206,16,v183
 v_and_b32 v207,0xffff0000,v183
 v_mfma_f32_16x16x32_bf16 v[168:171],v[50:53],a[188:191],v[168:171]
 v_lshlrev_b32 v208,16,v184
 v_and_b32 v209,0xffff0000,v184
 v_mfma_f32_16x16x32_bf16 v[172:175],v[48:51],a[180:183],v[172:175]
 v_lshlrev_b32 v210,16,v185
 v_and_b32 v211,0xffff0000,v185
 v_mfma_f32_16x16x32_bf16 v[172:175],v[48:51],a[188:191],v[172:175]
 v_lshlrev_b32 v212,16,v186
 v_and_b32 v213,0xffff0000,v186
 v_mfma_f32_16x16x32_bf16 v[176:179],v[54:57],a[228:231],v[176:179]
 s_waitcnt vmcnt(6)
 v_lshlrev_b32 v214,16,v187
 v_and_b32 v215,0xffff0000,v187
 v_mfma_f32_16x16x32_bf16 v[160:163],v[50:53],a[192:195],v[160:163]
 v_lshlrev_b32 v216,16,v188
 v_and_b32 v217,0xffff0000,v188
 v_mfma_f32_16x16x32_bf16 v[160:163],v[50:53],a[200:203],v[160:163]
 v_lshlrev_b32 v218,16,v189
 v_and_b32 v219,0xffff0000,v189
 v_mfma_f32_16x16x32_bf16 v[164:167],v[48:51],a[192:195],v[164:167]
 v_mfma_f32_16x16x32_bf16 v[164:167],v[48:51],a[200:203],v[164:167]
 v_mfma_f32_16x16x32_bf16 v[168:171],v[50:53],a[196:199],v[168:171]
 v_mfma_f32_16x16x32_bf16 v[168:171],v[50:53],a[204:207],v[168:171]
 v_mfma_f32_16x16x32_bf16 v[172:175],v[48:51],a[196:199],v[172:175]
 v_mfma_f32_16x16x32_bf16 v[172:175],v[48:51],a[204:207],v[172:175]
 v_mfma_f32_16x16x32_bf16 v[176:179],v[54:57],a[232:235],v[176:179]
 s_waitcnt vmcnt(0)
 v_mfma_f32_16x16x32_bf16 v[160:163],v[50:53],a[208:211],v[160:163]
 v_mfma_f32_16x16x32_bf16 v[160:163],v[50:53],a[216:219],v[160:163]
 v_mfma_f32_16x16x32_bf16 v[164:167],v[48:51],a[208:211],v[164:167]
 v_mfma_f32_16x16x32_bf16 v[164:167],v[48:51],a[216:219],v[164:167]
 v_mfma_f32_16x16x32_bf16 v[168:171],v[50:53],a[212:215],v[168:171]
 v_mfma_f32_16x16x32_bf16 v[168:171],v[50:53],a[220:223],v[168:171]
 v_mfma_f32_16x16x32_bf16 v[172:175],v[48:51],a[212:215],v[172:175]
 v_mfma_f32_16x16x32_bf16 v[172:175],v[48:51],a[220:223],v[172:175]
 v_mfma_f32_16x16x32_bf16 v[176:179],v[54:57],a[236:239],v[176:179]
 s_nop 0
 v_fmac_f32 v200,v160,v224
 v_fmac_f32 v201,v161,v225
 v_fmac_f32 v202,v162,v226
 v_fmac_f32 v203,v163,v227
 v_cvt_pk_bf16_f32 v180,v200,v201
 v_cvt_pk_bf16_f32 v181,v202,v203
 ds_write_b64 v58,v[180:181]
 v_fmac_f32 v204,v164,v228
 v_fmac_f32 v205,v165,v229
 v_fmac_f32 v206,v166,v230
 v_fmac_f32 v207,v167,v231
 v_cvt_pk_bf16_f32 v182,v204,v205
 v_cvt_pk_bf16_f32 v183,v206,v207
 ds_write_b64 v58,v[182:183] offset:32
 v_fmac_f32 v208,v168,v232
 v_fmac_f32 v209,v169,v233
 v_fmac_f32 v210,v170,v234
 v_fmac_f32 v211,v171,v235
 v_cvt_pk_bf16_f32 v184,v208,v209
 v_cvt_pk_bf16_f32 v185,v210,v211
 ds_write_b64 v58,v[184:185] offset:64
 v_fmac_f32 v212,v172,v236
 v_fmac_f32 v213,v173,v237
 v_fmac_f32 v214,v174,v238
 v_fmac_f32 v215,v175,v239
 v_cvt_pk_bf16_f32 v186,v212,v213
 v_cvt_pk_bf16_f32 v187,v214,v215
 ds_write_b64 v58,v[186:187] offset:96
 v_fmac_f32 v216,v176,v240
 v_fmac_f32 v217,v177,v241
 v_fmac_f32 v218,v178,v242
 v_fmac_f32 v219,v179,v243
 v_cvt_pk_bf16_f32 v188,v216,v217
 v_cvt_pk_bf16_f32 v189,v218,v219
 ds_write_b64 v59,v[188:189]
 ds_read_b128 v[64:67],v63
 ds_read_b128 v[68:71],v63 offset:1024
 ds_read_b128 v[72:75],v63 offset:2048
 s_waitcnt lgkmcnt(2)
 buffer_store_dwordx4 v[64:67],v1,s[8:11],0 offen
 s_waitcnt lgkmcnt(1)
 buffer_store_dwordx4 v[68:71],v2,s[8:11],0 offen offset:1024
 s_waitcnt lgkmcnt(0)
 buffer_store_dwordx4 v[72:75],v3,s[8:11],0 offen offset:2048
recurrent_scan__mha_block_cached__mixer_s_mlp__prompt_kernel_end:
 s_endpgm
Lp18_spin:
 s_mov_b32 s91,0
Lp18_again:
 s_sleep 6
 buffer_load_dword v5,v4,s[92:95],0 offen sc1
 s_add_u32 s91,s91,1
 s_cmp_gt_u32 s91,0x40000
 s_waitcnt vmcnt(0)
 s_cbranch_scc1 Lp18_ok
 v_cmp_ne_u32 vcc,s51,v5
 s_nop 1
 s_cbranch_vccnz Lp18_again
 s_branch Lp18_ok
Lp19_spin:
 s_mov_b32 s91,0
Lp19_again:
 s_sleep 6
 buffer_load_dword v5,v4,s[92:95],0 offen sc1
 s_add_u32 s91,s91,1
 s_cmp_gt_u32 s91,0x40000
 s_waitcnt vmcnt(0)
 s_cbranch_scc1 Lp19_ok
 v_cmp_ne_u32 vcc,s51,v5
 s_nop 1
 s_cbranch_vccnz Lp19_again
 s_branch Lp19_ok
Lp23_spin:
 s_mov_b32 s91,0
Lp23_again:
 s_sleep 6
 buffer_load_dword v241,v240,s[92:95],0 offen sc1
 s_add_u32 s91,s91,1
 s_cmp_gt_u32 s91,0x40000
 s_waitcnt vmcnt(0)
 s_cbranch_scc1 Lp23_ok
 v_cmp_ne_u32 vcc,s51,v241
 s_nop 1
 s_cbranch_vccnz Lp23_again
 s_branch Lp23_ok
Lp25_spin:
 s_mov_b32 s91,0
Lp25_again:
 s_sleep 6
 buffer_load_dword v13,v12,s[92:95],0 offen sc1
 s_add_u32 s91,s91,1
 s_cmp_gt_u32 s91,0x40000
 s_waitcnt vmcnt(0)
 s_cbranch_scc1 Lp25_ok
 v_cmp_ne_u32 vcc,s51,v13
 s_nop 1
 s_cbranch_vccnz Lp25_again
 s_branch Lp25_ok
Lp27_spin:
 s_mov_b32 s91,0
Lp27_again:
 s_sleep 6
 buffer_load_dword v13,v12,s[92:95],0 offen sc1
 s_add_u32 s91,s91,1
 s_cmp_gt_u32 s91,0x40000
 s_waitcnt vmcnt(0)
 s_cbranch_scc1 Lp27_ok
 v_cmp_ne_u32 vcc,s51,v13
 s_nop 1
 s_cbranch_vccnz Lp27_again
 s_branch Lp27_ok
Lp32_spin:
 s_mov_b32 s91,0
Lp32_again:
 s_sleep 6
 buffer_load_dword v13,v12,s[92:95],0 offen sc1
 s_add_u32 s91,s91,1
 s_cmp_gt_u32 s91,0x40000
 s_waitcnt vmcnt(0)
 s_cbranch_scc1 Lp32_ok
 v_cmp_ne_u32 vcc,s51,v13
 s_nop 1
 s_cbranch_vccnz Lp32_again
 s_branch Lp32_ok
recurrent_scan__mha_block_cached__mixer_s_mlp__prompt_kernel_tB:
 s_nop 1
 s_add_u32 m0,s35,76800
 s_add_u32 s44,s39,10240
 buffer_load_dwordx4 v1,s[12:15],s44 offen lds
 buffer_load_dwordx4 v2,s[12:15],s44 offen offset:1024 lds
 buffer_load_dwordx4 v3,s[12:15],s44 offen offset:2048 lds
 s_waitcnt lgkmcnt(0)
 v_mfma_f32_16x16x32_bf16 a[0:3],v[40:43],v[160:163],a[0:3]
 ds_read_b64_tr_b16 v[16:17],v9
 ds_read_b64_tr_b16 v[18:19],v9 offset:6144
 v_mfma_f32_16x16x32_bf16 a[0:3],v[44:47],v[164:167],a[0:3]
 v_lshlrev_b32 v4,4,v0
 v_lshlrev_b32 v5,3,v0
 v_mfma_f32_16x16x32_bf16 a[4:7],v[44:47],v[172:175],a[4:7]
 ds_read_b64_tr_b16 v[20:21],v9 offset:12288
 ds_read_b64_tr_b16 v[22:23],v9 offset:18432
 v_mfma_f32_16x16x32_bf16 a[4:7],v[40:43],v[168:171],a[4:7]
 s_lshl_b32 s41,s34,2
 s_add_u32 s41,s41,s32
 s_mul_i32 s41,s41,786432
 v_mfma_f32_16x16x32_bf16 a[8:11],v[40:43],v[176:179],a[8:11]
 s_add_u32 m0,s35,98304
 s_mov_b32 s44,393216
 buffer_load_dwordx4 v248,s[16:19],s44 offen lds
 ds_read_b64_tr_b16 v[24:25],v6 offset:128
 ds_read_b64_tr_b16 v[26:27],v6 offset:6272
 v_mfma_f32_16x16x32_bf16 a[8:11],v[44:47],v[180:183],a[8:11]
 s_mul_i32 s42,s52,24576
 s_add_u32 s41,s41,s42
 s_add_u32 s41,s41,14794752
 v_mfma_f32_16x16x32_bf16 a[12:15],v[44:47],v[188:191],a[12:15]
 ds_read_b64_tr_b16 v[28:29],v6 offset:12416
 ds_read_b64_tr_b16 v[30:31],v6 offset:18560
 v_mfma_f32_16x16x32_bf16 a[12:15],v[40:43],v[184:187],a[12:15]
 s_add_u32 s4,s88,s41
 s_addc_u32 s5,s89,0
 v_mfma_f32_16x16x32_bf16 a[16:19],v[48:51],v[160:163],a[16:19]
 ds_read_b64_tr_b16 v[32:33],v7 offset:128
 ds_read_b64_tr_b16 v[34:35],v7 offset:6272
 v_mfma_f32_16x16x32_bf16 a[16:19],v[52:55],v[164:167],a[16:19]
 s_mov_b32 s6,614400
 s_mov_b32 s7,0x20000
 v_mfma_f32_16x16x32_bf16 a[20:23],v[52:55],v[172:175],a[20:23]
 buffer_load_dwordx4 v249,s[16:19],s44 offen offset:1024 lds
 ds_read_b64_tr_b16 v[36:37],v7 offset:12416
 ds_read_b64_tr_b16 v[38:39],v7 offset:18560
 v_mfma_f32_16x16x32_bf16 a[20:23],v[48:51],v[168:171],a[20:23]
 s_mul_i32 s41,s54,20480
 s_add_u32 s41,s41,2621440
 v_mfma_f32_16x16x32_bf16 a[24:27],v[48:51],v[176:179],a[24:27]
 s_add_u32 s8,s88,s41
 s_addc_u32 s9,s89,0
 v_mfma_f32_16x16x32_bf16 a[24:27],v[52:55],v[180:183],a[24:27]
 s_mov_b32 s10,40960
 s_mov_b32 s11,0x20000
 s_mul_i32 s46,s53,6144
 v_mfma_f32_16x16x32_bf16 a[28:31],v[52:55],v[188:191],a[28:31]
 s_and_b32 s41,s53,1
 s_lshl_b32 s41,s41,6
 v_mfma_f32_16x16x32_bf16 a[28:31],v[48:51],v[184:187],a[28:31]
 s_lshl_b32 s42,s41,1
 s_add_u32 s42,s42,122880
 v_xor_b32 v240,s41,v6
 v_mfma_f32_16x16x32_bf16 a[32:35],v[56:59],v[160:163],a[32:35]
 buffer_load_dwordx4 v250,s[16:19],s44 offen offset:2048 lds
 v_add_u32 v240,122880,v240
 v_subrev_u32 v236,98304,v240
 v_mfma_f32_16x16x32_bf16 a[32:35],v[60:63],v[164:167],a[32:35]
 v_xor_b32 v241,s41,v7
 v_add_u32 v241,122880,v241
 v_mfma_f32_16x16x32_bf16 a[36:39],v[60:63],v[172:175],a[36:39]
 v_subrev_u32 v237,98304,v241
 v_xor_b32 v242,s41,v8
 v_mfma_f32_16x16x32_bf16 a[36:39],v[56:59],v[168:171],a[36:39]
 v_add_u32 v242,s42,v242
 v_subrev_u32 v238,98304,v242
 v_mfma_f32_16x16x32_bf16 a[40:43],v[56:59],v[176:179],a[40:43]
 v_xor_b32 v243,s41,v9
 v_add_u32 v243,s42,v243
 v_mfma_f32_16x16x32_bf16 a[40:43],v[60:63],v[180:183],a[40:43]
 v_subrev_u32 v239,98304,v243
 v_accvgpr_read_b32 v224,a0
 v_mfma_f32_16x16x32_bf16 a[44:47],v[60:63],v[188:191],a[44:47]
 s_add_u32 m0,s35,101376
 s_add_u32 s44,s44,49152
 buffer_load_dwordx4 v248,s[16:19],s44 offen lds
 v_accvgpr_read_b32 v225,a1
 v_accvgpr_read_b32 v226,a2
 v_mfma_f32_16x16x32_bf16 a[44:47],v[56:59],v[184:187],a[44:47]
 s_waitcnt lgkmcnt(0)
 v_accvgpr_read_b32 v227,a3
 v_accvgpr_read_b32 v228,a16
 v_mfma_f32_16x16x32_bf16 a[48:51],v[16:19],v[160:163],a[48:51]
 ds_read_b64_tr_b16 v[40:41],v8 offset:128
 ds_read_b64_tr_b16 v[42:43],v8 offset:6272
 v_mfma_f32_16x16x32_bf16 a[48:51],v[20:23],v[164:167],a[48:51]
 v_accvgpr_read_b32 v229,a17
 v_accvgpr_read_b32 v230,a18
 v_mfma_f32_16x16x32_bf16 a[52:55],v[20:23],v[172:175],a[52:55]
 ds_read_b64_tr_b16 v[44:45],v8 offset:12416
 ds_read_b64_tr_b16 v[46:47],v8 offset:18560
 v_mfma_f32_16x16x32_bf16 a[52:55],v[16:19],v[168:171],a[52:55]
 v_accvgpr_read_b32 v231,a19
 v_mul_f32 v224,v224,v10
 v_mfma_f32_16x16x32_bf16 a[56:59],v[16:19],v[176:179],a[56:59]
 buffer_load_dwordx4 v249,s[16:19],s44 offen offset:1024 lds
 ds_read_b64_tr_b16 v[48:49],v9 offset:128
 ds_read_b64_tr_b16 v[50:51],v9 offset:6272
 v_mfma_f32_16x16x32_bf16 a[56:59],v[20:23],v[180:183],a[56:59]
 v_mul_f32 v225,v225,v10
 v_mul_f32 v226,v226,v10
 v_mfma_f32_16x16x32_bf16 a[60:63],v[20:23],v[188:191],a[60:63]
 ds_read_b64_tr_b16 v[52:53],v9 offset:12416
 ds_read_b64_tr_b16 v[54:55],v9 offset:18560
 v_mfma_f32_16x16x32_bf16 a[60:63],v[16:19],v[184:187],a[60:63]
 v_mul_f32 v227,v227,v10
 v_mul_f32 v228,v228,v10
 v_mfma_f32_16x16x32_bf16 a[64:67],v[24:27],v[160:163],a[64:67]
 ds_read_b64_tr_b16 v[56:57],v6 offset:256
 ds_read_b64_tr_b16 v[58:59],v6 offset:6400
 v_mfma_f32_16x16x32_bf16 a[64:67],v[28:31],v[164:167],a[64:67]
 v_mul_f32 v229,v229,v10
 v_mul_f32 v230,v230,v10
 v_mfma_f32_16x16x32_bf16 a[68:71],v[28:31],v[172:175],a[68:71]
 buffer_load_dwordx4 v250,s[16:19],s44 offen offset:2048 lds
 ds_read_b64_tr_b16 v[60:61],v6 offset:12544
 ds_read_b64_tr_b16 v[62:63],v6 offset:18688
 v_mfma_f32_16x16x32_bf16 a[68:71],v[24:27],v[168:171],a[68:71]
 v_mul_f32 v231,v231,v10
 v_cvt_pk_bf16_f32 v64,v224,v225
 v_mfma_f32_16x16x32_bf16 a[72:75],v[24:27],v[176:179],a[72:75]
 v_cvt_pk_bf16_f32 v65,v226,v227
 v_cvt_pk_bf16_f32 v66,v228,v229
 v_mfma_f32_16x16x32_bf16 a[72:75],v[28:31],v[180:183],a[72:75]
 v_cvt_pk_bf16_f32 v67,v230,v231
 v_accvgpr_read_b32 v232,a4
 v_mfma_f32_16x16x32_bf16 a[76:79],v[28:31],v[188:191],a[76:79]
 v_accvgpr_read_b32 v233,a5
 v_accvgpr_read_b32 v234,a6
 v_mfma_f32_16x16x32_bf16 a[76:79],v[24:27],v[184:187],a[76:79]
 s_add_u32 s47,s46,0
 v_accvgpr_read_b32 v235,a7
 v_accvgpr_read_b32 v244,a20
 v_mfma_f32_16x16x32_bf16 a[80:83],v[32:35],v[160:163],a[80:83]
 buffer_store_dwordx4 v[64:67],v4,s[4:7],s47 offen sc1
 v_accvgpr_read_b32 v245,a21
 v_accvgpr_read_b32 v246,a22
 v_mfma_f32_16x16x32_bf16 a[80:83],v[36:39],v[164:167],a[80:83]
 v_accvgpr_read_b32 v247,a23
 v_mul_f32 v232,v232,v11
 v_mfma_f32_16x16x32_bf16 a[84:87],v[36:39],v[172:175],a[84:87]
 v_mul_f32 v233,v233,v11
 v_mul_f32 v234,v234,v11
 v_mfma_f32_16x16x32_bf16 a[84:87],v[32:35],v[168:171],a[84:87]
 v_mul_f32 v235,v235,v11
 v_mul_f32 v244,v244,v11
 v_mfma_f32_16x16x32_bf16 a[88:91],v[32:35],v[176:179],a[88:91]
 v_mul_f32 v245,v245,v11
 v_mul_f32 v246,v246,v11
 v_mfma_f32_16x16x32_bf16 a[88:91],v[36:39],v[180:183],a[88:91]
 v_mul_f32 v247,v247,v11
 v_cvt_pk_bf16_f32 v68,v232,v233
 v_mfma_f32_16x16x32_bf16 a[92:95],v[36:39],v[188:191],a[92:95]
 v_cvt_pk_bf16_f32 v69,v234,v235
 v_cvt_pk_bf16_f32 v70,v244,v245
 v_mfma_f32_16x16x32_bf16 a[92:95],v[32:35],v[184:187],a[92:95]
 s_waitcnt lgkmcnt(0)
 v_cvt_pk_bf16_f32 v71,v246,v247
 v_accvgpr_read_b32 v224,a8
 v_mfma_f32_16x16x32_bf16 a[96:99],v[40:43],v[160:163],a[96:99]
 s_add_u32 s47,s46,196608
 ds_read_b64_tr_b16 v[16:17],v7 offset:256
 ds_read_b64_tr_b16 v[18:19],v7 offset:6400
 v_mfma_f32_16x16x32_bf16 a[96:99],v[44:47],v[164:167],a[96:99]
 buffer_store_dwordx4 v[68:71],v4,s[4:7],s47 offen sc1
 v_accvgpr_read_b32 v225,a9
 v_accvgpr_read_b32 v226,a10
 v_mfma_f32_16x16x32_bf16 a[100:103],v[44:47],v[172:175],a[100:103]
 ds_read_b64_tr_b16 v[20:21],v7 offset:12544
 ds_read_b64_tr_b16 v[22:23],v7 offset:18688
 v_mfma_f32_16x16x32_bf16 a[100:103],v[40:43],v[168:171],a[100:103]
 v_accvgpr_read_b32 v227,a11
 v_accvgpr_read_b32 v228,a24
 v_mfma_f32_16x16x32_bf16 a[104:107],v[40:43],v[176:179],a[104:107]
 ds_read_b64_tr_b16 v[24:25],v8 offset:256
 ds_read_b64_tr_b16 v[26:27],v8 offset:6400
 v_mfma_f32_16x16x32_bf16 a[104:107],v[44:47],v[180:183],a[104:107]
 v_accvgpr_read_b32 v229,a25
 v_accvgpr_read_b32 v230,a26
 v_mfma_f32_16x16x32_bf16 a[108:111],v[44:47],v[188:191],a[108:111]
 ds_read_b64_tr_b16 v[28:29],v8 offset:12544
 ds_read_b64_tr_b16 v[30:31],v8 offset:18688
 v_mfma_f32_16x16x32_bf16 a[108:111],v[40:43],v[184:187],a[108:111]
 v_accvgpr_read_b32 v231,a27
 v_mul_f32 v224,v224,v12
 v_mfma_f32_16x16x32_bf16 a[112:115],v[48:51],v[160:163],a[112:115]
 s_mov_b32 s0,0
 ds_read_b64_tr_b16 v[32:33],v9 offset:256
 ds_read_b64_tr_b16 v[34:35],v9 offset:6400
 v_mfma_f32_16x16x32_bf16 a[112:115],v[52:55],v[164:167],a[112:115]
 buffer_load_dwordx4 a[192:195],v4,s[8:11],s0 offen sc1
 v_mul_f32 v225,v225,v12
 v_mul_f32 v226,v226,v12
 v_mfma_f32_16x16x32_bf16 a[116:119],v[52:55],v[172:175],a[116:119]
 ds_read_b64_tr_b16 v[36:37],v9 offset:12544
 ds_read_b64_tr_b16 v[38:39],v9 offset:18688
 v_mfma_f32_16x16x32_bf16 a[116:119],v[48:51],v[168:171],a[116:119]
 v_mul_f32 v227,v227,v12
 v_mul_f32 v228,v228,v12
 v_mfma_f32_16x16x32_bf16 a[120:123],v[48:51],v[176:179],a[120:123]
 v_mul_f32 v229,v229,v12
 v_mul_f32 v230,v230,v12
 v_mfma_f32_16x16x32_bf16 a[120:123],v[52:55],v[180:183],a[120:123]
 v_mul_f32 v231,v231,v12
 v_cvt_pk_bf16_f32 v72,v224,v225
 v_mfma_f32_16x16x32_bf16 a[124:127],v[52:55],v[188:191],a[124:127]
 buffer_load_dwordx4 a[200:203],v4,s[8:11],s0 offen offset:1024 sc1
 v_cvt_pk_bf16_f32 v73,v226,v227
 v_cvt_pk_bf16_f32 v74,v228,v229
 v_mfma_f32_16x16x32_bf16 a[124:127],v[48:51],v[184:187],a[124:127]
 v_cvt_pk_bf16_f32 v75,v230,v231
 v_accvgpr_read_b32 v232,a12
 v_mfma_f32_16x16x32_bf16 a[128:131],v[56:59],v[160:163],a[128:131]
 v_accvgpr_read_b32 v233,a13
 v_accvgpr_read_b32 v234,a14
 v_mfma_f32_16x16x32_bf16 a[128:131],v[60:63],v[164:167],a[128:131]
 s_add_u32 s47,s46,393216
 v_accvgpr_read_b32 v235,a15
 v_accvgpr_read_b32 v244,a28
 v_mfma_f32_16x16x32_bf16 a[132:135],v[60:63],v[172:175],a[132:135]
 buffer_store_dwordx4 v[72:75],v4,s[4:7],s47 offen sc1
 v_accvgpr_read_b32 v245,a29
 v_accvgpr_read_b32 v246,a30
 v_mfma_f32_16x16x32_bf16 a[132:135],v[56:59],v[168:171],a[132:135]
 v_accvgpr_read_b32 v247,a31
 v_mul_f32 v232,v232,v13
 v_mfma_f32_16x16x32_bf16 a[136:139],v[56:59],v[176:179],a[136:139]
 v_mul_f32 v233,v233,v13
 v_mul_f32 v234,v234,v13
 v_mfma_f32_16x16x32_bf16 a[136:139],v[60:63],v[180:183],a[136:139]
 v_mul_f32 v235,v235,v13
 v_mul_f32 v244,v244,v13
 v_mfma_f32_16x16x32_bf16 a[140:143],v[60:63],v[188:191],a[140:143]
 v_mul_f32 v245,v245,v13
 v_mul_f32 v246,v246,v13
 v_mfma_f32_16x16x32_bf16 a[140:143],v[56:59],v[184:187],a[140:143]
 s_waitcnt lgkmcnt(0)
 v_mul_f32 v247,v247,v13
 v_cvt_pk_bf16_f32 v76,v232,v233
 v_mfma_f32_16x16x32_bf16 a[144:147],v[16:19],v[160:163],a[144:147]
 s_waitcnt vmcnt(14)
 s_barrier
 v_cvt_pk_bf16_f32 v77,v234,v235
 v_mfma_f32_16x16x32_bf16 a[144:147],v[20:23],v[164:167],a[144:147]
 buffer_load_dwordx2 a[208:209],v5,s[8:11],s0 offen offset:2048 sc1
 v_cvt_pk_bf16_f32 v78,v244,v245
 v_cvt_pk_bf16_f32 v79,v246,v247
 v_mfma_f32_16x16x32_bf16 a[148:151],v[20:23],v[172:175],a[148:151]
 s_add_u32 s47,s46,589824
 v_accvgpr_read_b32 v224,a32
 v_accvgpr_read_b32 v225,a33
 v_mfma_f32_16x16x32_bf16 a[148:151],v[16:19],v[168:171],a[148:151]
 buffer_store_dwordx4 v[76:79],v4,s[4:7],s47 offen sc1
 v_accvgpr_read_b32 v226,a34
 v_accvgpr_read_b32 v227,a35
 v_mfma_f32_16x16x32_bf16 a[152:155],v[16:19],v[176:179],a[152:155]
 v_accvgpr_read_b32 v228,a48
 v_accvgpr_read_b32 v229,a49
 v_mfma_f32_16x16x32_bf16 a[152:155],v[20:23],v[180:183],a[152:155]
 v_accvgpr_read_b32 v230,a50
 v_accvgpr_read_b32 v231,a51
 v_mfma_f32_16x16x32_bf16 a[156:159],v[20:23],v[188:191],a[156:159]
 v_mul_f32 v224,v224,v10
 v_mul_f32 v225,v225,v10
 v_mfma_f32_16x16x32_bf16 a[156:159],v[16:19],v[184:187],a[156:159]
 v_mul_f32 v226,v226,v10
 v_mul_f32 v227,v227,v10
 v_mfma_f32_16x16x32_bf16 a[160:163],v[24:27],v[160:163],a[160:163]
 v_mul_f32 v228,v228,v10
 v_mul_f32 v229,v229,v10
 v_mfma_f32_16x16x32_bf16 a[160:163],v[28:31],v[164:167],a[160:163]
 v_mul_f32 v230,v230,v10
 v_mul_f32 v231,v231,v10
 v_mfma_f32_16x16x32_bf16 a[164:167],v[28:31],v[172:175],a[164:167]
 v_cvt_pk_bf16_f32 v80,v224,v225
 v_cvt_pk_bf16_f32 v81,v226,v227
 v_mfma_f32_16x16x32_bf16 a[164:167],v[24:27],v[168:171],a[164:167]
 v_cvt_pk_bf16_f32 v82,v228,v229
 v_cvt_pk_bf16_f32 v83,v230,v231
 v_mfma_f32_16x16x32_bf16 a[168:171],v[24:27],v[176:179],a[168:171]
 s_add_u32 s47,s46,0
 buffer_store_dwordx4 v[80:83],v4,s[4:7],s47 offen offset:1024 sc1
 v_accvgpr_read_b32 v232,a36
 v_accvgpr_read_b32 v233,a37
 v_mfma_f32_16x16x32_bf16 a[168:171],v[28:31],v[180:183],a[168:171]
 v_accvgpr_read_b32 v234,a38
 v_accvgpr_read_b32 v235,a39
 v_mfma_f32_16x16x32_bf16 a[172:175],v[28:31],v[188:191],a[172:175]
 v_accvgpr_read_b32 v244,a52
 v_accvgpr_read_b32 v245,a53
 v_mfma_f32_16x16x32_bf16 a[172:175],v[24:27],v[184:187],a[172:175]
 v_accvgpr_read_b32 v246,a54
 v_accvgpr_read_b32 v247,a55
 v_mfma_f32_16x16x32_bf16 a[176:179],v[32:35],v[160:163],a[176:179]
 v_mul_f32 v232,v232,v11
 v_mul_f32 v233,v233,v11
 v_mfma_f32_16x16x32_bf16 a[176:179],v[36:39],v[164:167],a[176:179]
 v_mul_f32 v234,v234,v11
 v_mul_f32 v235,v235,v11
 v_mfma_f32_16x16x32_bf16 a[180:183],v[36:39],v[172:175],a[180:183]
 v_mul_f32 v244,v244,v11
 v_mul_f32 v245,v245,v11
 v_mfma_f32_16x16x32_bf16 a[180:183],v[32:35],v[168:171],a[180:183]
 v_mul_f32 v246,v246,v11
 v_mul_f32 v247,v247,v11
 v_mfma_f32_16x16x32_bf16 a[184:187],v[32:35],v[176:179],a[184:187]
 v_cvt_pk_bf16_f32 v84,v232,v233
 v_cvt_pk_bf16_f32 v85,v234,v235
 v_mfma_f32_16x16x32_bf16 a[184:187],v[36:39],v[180:183],a[184:187]
 v_cvt_pk_bf16_f32 v86,v244,v245
 v_cvt_pk_bf16_f32 v87,v246,v247
 v_mfma_f32_16x16x32_bf16 a[188:191],v[36:39],v[188:191],a[188:191]
 s_add_u32 s47,s46,196608
 v_accvgpr_read_b32 v224,a40
 v_accvgpr_read_b32 v225,a41
 v_mfma_f32_16x16x32_bf16 a[188:191],v[32:35],v[184:187],a[188:191]
 buffer_load_dwordx2 a[210:211],v5,s[8:11],s0 offen offset:2560 sc1
 buffer_store_dwordx4 v[84:87],v4,s[4:7],s47 offen offset:1024 sc1
 v_accvgpr_read_b32 v226,a42
 v_accvgpr_read_b32 v227,a43
 v_accvgpr_read_b32 v228,a56
 v_accvgpr_read_b32 v229,a57
 v_accvgpr_read_b32 v230,a58
 v_accvgpr_read_b32 v231,a59
 v_mul_f32 v224,v224,v12
 v_mul_f32 v225,v225,v12
 v_mul_f32 v226,v226,v12
 v_mul_f32 v227,v227,v12
 v_mul_f32 v228,v228,v12
 v_mul_f32 v229,v229,v12
 v_mul_f32 v230,v230,v12
 v_mul_f32 v231,v231,v12
 v_cvt_pk_bf16_f32 v88,v224,v225
 v_cvt_pk_bf16_f32 v89,v226,v227
 v_cvt_pk_bf16_f32 v90,v228,v229
 v_cvt_pk_bf16_f32 v91,v230,v231
 v_accvgpr_read_b32 v232,a44
 v_accvgpr_read_b32 v233,a45
 v_accvgpr_read_b32 v234,a46
 v_accvgpr_read_b32 v235,a47
 v_accvgpr_read_b32 v244,a60
 v_accvgpr_read_b32 v245,a61
 v_accvgpr_read_b32 v246,a62
 v_accvgpr_read_b32 v247,a63
 v_mul_f32 v232,v232,v13
 v_mul_f32 v233,v233,v13
 v_mul_f32 v234,v234,v13
 v_mul_f32 v235,v235,v13
 v_mul_f32 v244,v244,v13
 v_mul_f32 v245,v245,v13
 v_mul_f32 v246,v246,v13
 v_mul_f32 v247,v247,v13
 s_add_u32 s47,s46,393216
 buffer_store_dwordx4 v[88:91],v4,s[4:7],s47 offen offset:1024 sc1
 v_cvt_pk_bf16_f32 v92,v232,v233
 v_cvt_pk_bf16_f32 v93,v234,v235
 v_cvt_pk_bf16_f32 v94,v244,v245
 v_cvt_pk_bf16_f32 v95,v246,v247
 v_accvgpr_read_b32 v224,a64
 v_accvgpr_read_b32 v225,a65
 v_accvgpr_read_b32 v226,a66
 v_accvgpr_read_b32 v227,a67
 v_accvgpr_read_b32 v228,a80
 v_accvgpr_read_b32 v229,a81
 v_accvgpr_read_b32 v230,a82
 v_accvgpr_read_b32 v231,a83
 v_mul_f32 v224,v224,v10
 v_mul_f32 v225,v225,v10
 v_mul_f32 v226,v226,v10
 v_mul_f32 v227,v227,v10
 v_mul_f32 v228,v228,v10
 v_mul_f32 v229,v229,v10
 v_mul_f32 v230,v230,v10
 v_mul_f32 v231,v231,v10
 v_cvt_pk_bf16_f32 v96,v224,v225
 v_cvt_pk_bf16_f32 v97,v226,v227
 v_cvt_pk_bf16_f32 v98,v228,v229
 v_cvt_pk_bf16_f32 v99,v230,v231
 v_accvgpr_read_b32 v232,a68
 v_accvgpr_read_b32 v233,a69
 v_accvgpr_read_b32 v234,a70
 v_accvgpr_read_b32 v235,a71
 v_accvgpr_read_b32 v244,a84
 v_accvgpr_read_b32 v245,a85
 v_accvgpr_read_b32 v246,a86
 v_accvgpr_read_b32 v247,a87
 v_mul_f32 v232,v232,v11
 v_mul_f32 v233,v233,v11
 v_mul_f32 v234,v234,v11
 s_add_u32 s47,s46,589824
 buffer_store_dwordx4 v[92:95],v4,s[4:7],s47 offen offset:1024 sc1
 v_mul_f32 v235,v235,v11
 v_mul_f32 v244,v244,v11
 v_mul_f32 v245,v245,v11
 v_mul_f32 v246,v246,v11
 v_mul_f32 v247,v247,v11
 v_cvt_pk_bf16_f32 v100,v232,v233
 v_cvt_pk_bf16_f32 v101,v234,v235
 v_cvt_pk_bf16_f32 v102,v244,v245
 v_cvt_pk_bf16_f32 v103,v246,v247
 v_accvgpr_read_b32 v224,a72
 v_accvgpr_read_b32 v225,a73
 v_accvgpr_read_b32 v226,a74
 v_accvgpr_read_b32 v227,a75
 v_accvgpr_read_b32 v228,a88
 v_accvgpr_read_b32 v229,a89
 v_accvgpr_read_b32 v230,a90
 v_accvgpr_read_b32 v231,a91
 v_mul_f32 v224,v224,v12
 v_mul_f32 v225,v225,v12
 v_mul_f32 v226,v226,v12
 v_mul_f32 v227,v227,v12
 v_mul_f32 v228,v228,v12
 v_mul_f32 v229,v229,v12
 v_mul_f32 v230,v230,v12
 v_mul_f32 v231,v231,v12
 v_cvt_pk_bf16_f32 v104,v224,v225
 v_cvt_pk_bf16_f32 v105,v226,v227
 v_cvt_pk_bf16_f32 v106,v228,v229
 v_cvt_pk_bf16_f32 v107,v230,v231
 v_accvgpr_read_b32 v232,a76
 v_accvgpr_read_b32 v233,a77
 ds_read_b64_tr_b16 v[16:17],v240
 ds_read_b64_tr_b16 v[18:19],v240 offset:6144
 ds_read_b64_tr_b16 v[20:21],v240 offset:12288
 ds_read_b64_tr_b16 v[22:23],v240 offset:18432
 s_add_u32 s47,s46,0
 buffer_store_dwordx4 v[96:99],v4,s[4:7],s47 offen offset:2048 sc1
 ds_read_b64_tr_b16 v[24:25],v241
 ds_read_b64_tr_b16 v[26:27],v241 offset:6144
 ds_read_b64_tr_b16 v[28:29],v241 offset:12288
 ds_read_b64_tr_b16 v[30:31],v241 offset:18432
 v_accvgpr_read_b32 v234,a78
 v_accvgpr_read_b32 v235,a79
 v_accvgpr_read_b32 v244,a92
 v_accvgpr_read_b32 v245,a93
 v_accvgpr_read_b32 v246,a94
 v_accvgpr_read_b32 v247,a95
 v_mul_f32 v232,v232,v13
 v_mul_f32 v233,v233,v13
 v_mul_f32 v234,v234,v13
 v_mul_f32 v235,v235,v13
 v_mul_f32 v244,v244,v13
 v_mul_f32 v245,v245,v13
 v_mul_f32 v246,v246,v13
 v_mul_f32 v247,v247,v13
 v_cvt_pk_bf16_f32 v108,v232,v233
 v_cvt_pk_bf16_f32 v109,v234,v235
 v_cvt_pk_bf16_f32 v110,v244,v245
 v_cvt_pk_bf16_f32 v111,v246,v247
 v_accvgpr_read_b32 v224,a96
 v_accvgpr_read_b32 v225,a97
 v_accvgpr_read_b32 v226,a98
 v_accvgpr_read_b32 v227,a99
 v_accvgpr_read_b32 v228,a112
 v_accvgpr_read_b32 v229,a113
 v_accvgpr_read_b32 v230,a114
 v_accvgpr_read_b32 v231,a115
 v_mul_f32 v224,v224,v10
 v_mul_f32 v225,v225,v10
 v_mul_f32 v226,v226,v10
 v_mul_f32 v227,v227,v10
 v_mul_f32 v228,v228,v10
 s_add_u32 s47,s46,196608
 buffer_store_dwordx4 v[100:103],v4,s[4:7],s47 offen offset:2048 sc1
 v_mul_f32 v229,v229,v10
 v_mul_f32 v230,v230,v10
 v_mul_f32 v231,v231,v10
 v_cvt_pk_bf16_f32 v112,v224,v225
 v_cvt_pk_bf16_f32 v113,v226,v227
 v_cvt_pk_bf16_f32 v114,v228,v229
 v_cvt_pk_bf16_f32 v115,v230,v231
 s_waitcnt lgkmcnt(4)
 v_mfma_f32_16x16x32_bf16 a[0:3],v[16:19],v[64:67],0
 ds_read_b64_tr_b16 v[32:33],v242
 ds_read_b64_tr_b16 v[34:35],v242 offset:6144
 v_mfma_f32_16x16x32_bf16 a[0:3],v[20:23],v[80:83],a[0:3]
 v_accvgpr_read_b32 v232,a100
 v_accvgpr_read_b32 v233,a101
 v_mfma_f32_16x16x32_bf16 a[4:7],v[20:23],v[84:87],0
 v_accvgpr_read_b32 v234,a102
 v_accvgpr_read_b32 v235,a103
 v_mfma_f32_16x16x32_bf16 a[4:7],v[16:19],v[68:71],a[4:7]
 ds_read_b64_tr_b16 v[36:37],v242 offset:12288
 ds_read_b64_tr_b16 v[38:39],v242 offset:18432
 v_mfma_f32_16x16x32_bf16 a[8:11],v[16:19],v[72:75],0
 v_accvgpr_read_b32 v244,a116
 v_accvgpr_read_b32 v245,a117
 v_mfma_f32_16x16x32_bf16 a[8:11],v[20:23],v[88:91],a[8:11]
 v_accvgpr_read_b32 v246,a118
 v_accvgpr_read_b32 v247,a119
 v_mfma_f32_16x16x32_bf16 a[12:15],v[20:23],v[92:95],0
 v_mul_f32 v232,v232,v11
 v_mul_f32 v233,v233,v11
 v_mfma_f32_16x16x32_bf16 a[12:15],v[16:19],v[76:79],a[12:15]
 buffer_load_dwordx4 a[216:219],v4,s[8:11],s0 offen offset:3072 sc1
 s_waitcnt lgkmcnt(4)
 v_mul_f32 v234,v234,v11
 v_mul_f32 v235,v235,v11
 v_mfma_f32_16x16x32_bf16 a[16:19],v[24:27],v[64:67],0
 ds_read_b64_tr_b16 v[40:41],v243
 ds_read_b64_tr_b16 v[42:43],v243 offset:6144
 v_mfma_f32_16x16x32_bf16 a[16:19],v[28:31],v[80:83],a[16:19]
 v_mul_f32 v244,v244,v11
 v_mul_f32 v245,v245,v11
 v_mfma_f32_16x16x32_bf16 a[20:23],v[28:31],v[84:87],0
 s_add_u32 s47,s46,393216
 v_mul_f32 v246,v246,v11
 v_mul_f32 v247,v247,v11
 v_mfma_f32_16x16x32_bf16 a[20:23],v[24:27],v[68:71],a[20:23]
 buffer_store_dwordx4 v[104:107],v4,s[4:7],s47 offen offset:2048 sc1
 ds_read_b64_tr_b16 v[44:45],v243 offset:12288
 ds_read_b64_tr_b16 v[46:47],v243 offset:18432
 v_mfma_f32_16x16x32_bf16 a[24:27],v[24:27],v[72:75],0
 v_cvt_pk_bf16_f32 v116,v232,v233
 v_cvt_pk_bf16_f32 v117,v234,v235
 v_mfma_f32_16x16x32_bf16 a[24:27],v[28:31],v[88:91],a[24:27]
 v_cvt_pk_bf16_f32 v118,v244,v245
 v_cvt_pk_bf16_f32 v119,v246,v247
 v_mfma_f32_16x16x32_bf16 a[28:31],v[28:31],v[92:95],0
 v_accvgpr_read_b32 v224,a104
 v_accvgpr_read_b32 v225,a105
 v_mfma_f32_16x16x32_bf16 a[28:31],v[24:27],v[76:79],a[28:31]
 s_waitcnt lgkmcnt(4)
 v_accvgpr_read_b32 v226,a106
 v_accvgpr_read_b32 v227,a107
 v_mfma_f32_16x16x32_bf16 a[32:35],v[32:35],v[64:67],0
 ds_read_b64_tr_b16 v[16:17],v240 offset:128
 ds_read_b64_tr_b16 v[18:19],v240 offset:6272
 v_mfma_f32_16x16x32_bf16 a[32:35],v[36:39],v[80:83],a[32:35]
 v_accvgpr_read_b32 v228,a120
 v_accvgpr_read_b32 v229,a121
 v_mfma_f32_16x16x32_bf16 a[36:39],v[36:39],v[84:87],0
 v_accvgpr_read_b32 v230,a122
 v_accvgpr_read_b32 v231,a123
 v_mfma_f32_16x16x32_bf16 a[36:39],v[32:35],v[68:71],a[36:39]
 s_add_u32 s47,s46,589824
 ds_read_b64_tr_b16 v[20:21],v240 offset:12416
 ds_read_b64_tr_b16 v[22:23],v240 offset:18560
 v_mfma_f32_16x16x32_bf16 a[40:43],v[32:35],v[72:75],0
 buffer_store_dwordx4 v[108:111],v4,s[4:7],s47 offen offset:2048 sc1
 v_mul_f32 v224,v224,v12
 v_mul_f32 v225,v225,v12
 v_mfma_f32_16x16x32_bf16 a[40:43],v[36:39],v[88:91],a[40:43]
 v_mul_f32 v226,v226,v12
 v_mul_f32 v227,v227,v12
 v_mfma_f32_16x16x32_bf16 a[44:47],v[36:39],v[92:95],0
 v_mul_f32 v228,v228,v12
 v_mul_f32 v229,v229,v12
 v_mfma_f32_16x16x32_bf16 a[44:47],v[32:35],v[76:79],a[44:47]
 s_waitcnt lgkmcnt(4)
 v_mul_f32 v230,v230,v12
 v_mul_f32 v231,v231,v12
 v_mfma_f32_16x16x32_bf16 a[48:51],v[40:43],v[64:67],0
 ds_read_b64_tr_b16 v[24:25],v241 offset:128
 ds_read_b64_tr_b16 v[26:27],v241 offset:6272
 v_mfma_f32_16x16x32_bf16 a[48:51],v[44:47],v[80:83],a[48:51]
 v_cvt_pk_bf16_f32 v120,v224,v225
 v_cvt_pk_bf16_f32 v121,v226,v227
 v_mfma_f32_16x16x32_bf16 a[52:55],v[44:47],v[84:87],0
 v_cvt_pk_bf16_f32 v122,v228,v229
 v_cvt_pk_bf16_f32 v123,v230,v231
 v_mfma_f32_16x16x32_bf16 a[52:55],v[40:43],v[68:71],a[52:55]
 ds_read_b64_tr_b16 v[28:29],v241 offset:12416
 ds_read_b64_tr_b16 v[30:31],v241 offset:18560
 v_mfma_f32_16x16x32_bf16 a[56:59],v[40:43],v[72:75],0
 s_mov_b32 s0,20480
 v_accvgpr_read_b32 v232,a108
 v_accvgpr_read_b32 v233,a109
 v_mfma_f32_16x16x32_bf16 a[56:59],v[44:47],v[88:91],a[56:59]
 buffer_load_dwordx4 a[196:199],v4,s[8:11],s0 offen sc1
 v_accvgpr_read_b32 v234,a110
 v_accvgpr_read_b32 v235,a111
 v_mfma_f32_16x16x32_bf16 a[60:63],v[44:47],v[92:95],0
 v_accvgpr_read_b32 v244,a124
 v_accvgpr_read_b32 v245,a125
 v_mfma_f32_16x16x32_bf16 a[60:63],v[40:43],v[76:79],a[60:63]
 s_waitcnt lgkmcnt(4)
 v_accvgpr_read_b32 v246,a126
 v_accvgpr_read_b32 v247,a127
 v_mfma_f32_16x16x32_bf16 a[64:67],v[16:19],v[64:67],0
 s_add_u32 s47,s46,0
 ds_read_b64_tr_b16 v[32:33],v242 offset:128
 ds_read_b64_tr_b16 v[34:35],v242 offset:6272
 v_mfma_f32_16x16x32_bf16 a[64:67],v[20:23],v[80:83],a[64:67]
 buffer_store_dwordx4 v[112:115],v4,s[4:7],s47 offen offset:3072 sc1
 v_mul_f32 v232,v232,v13
 v_mul_f32 v233,v233,v13
 v_mfma_f32_16x16x32_bf16 a[68:71],v[20:23],v[84:87],0
 v_mul_f32 v234,v234,v13
 v_mul_f32 v235,v235,v13
 v_mfma_f32_16x16x32_bf16 a[68:71],v[16:19],v[68:71],a[68:71]
 ds_read_b64_tr_b16 v[36:37],v242 offset:12416
 ds_read_b64_tr_b16 v[38:39],v242 offset:18560
 v_mfma_f32_16x16x32_bf16 a[72:75],v[16:19],v[72:75],0
 v_mul_f32 v244,v244,v13
 v_mul_f32 v245,v245,v13
 v_mfma_f32_16x16x32_bf16 a[72:75],v[20:23],v[88:91],a[72:75]
 v_mul_f32 v246,v246,v13
 v_mul_f32 v247,v247,v13
 v_mfma_f32_16x16x32_bf16 a[76:79],v[20:23],v[92:95],0
 v_cvt_pk_bf16_f32 v124,v232,v233
 v_cvt_pk_bf16_f32 v125,v234,v235
 v_mfma_f32_16x16x32_bf16 a[76:79],v[16:19],v[76:79],a[76:79]
 s_waitcnt lgkmcnt(4)
 v_cvt_pk_bf16_f32 v126,v244,v245
 v_cvt_pk_bf16_f32 v127,v246,v247
 v_mfma_f32_16x16x32_bf16 a[80:83],v[24:27],v[64:67],0
 ds_read_b64_tr_b16 v[40:41],v243 offset:128
 ds_read_b64_tr_b16 v[42:43],v243 offset:6272
 v_mfma_f32_16x16x32_bf16 a[80:83],v[28:31],v[80:83],a[80:83]
 s_add_u32 s47,s46,196608
 v_accvgpr_read_b32 v224,a128
 v_accvgpr_read_b32 v225,a129
 v_mfma_f32_16x16x32_bf16 a[84:87],v[28:31],v[84:87],0
 buffer_store_dwordx4 v[116:119],v4,s[4:7],s47 offen offset:3072 sc1
 v_accvgpr_read_b32 v226,a130
 v_accvgpr_read_b32 v227,a131
 v_mfma_f32_16x16x32_bf16 a[84:87],v[24:27],v[68:71],a[84:87]
 ds_read_b64_tr_b16 v[44:45],v243 offset:12416
 ds_read_b64_tr_b16 v[46:47],v243 offset:18560
 v_mfma_f32_16x16x32_bf16 a[88:91],v[24:27],v[72:75],0
 v_accvgpr_read_b32 v228,a144
 v_accvgpr_read_b32 v229,a145
 v_mfma_f32_16x16x32_bf16 a[88:91],v[28:31],v[88:91],a[88:91]
 v_accvgpr_read_b32 v230,a146
 v_accvgpr_read_b32 v231,a147
 v_mfma_f32_16x16x32_bf16 a[92:95],v[28:31],v[92:95],0
 v_mul_f32 v224,v224,v10
 v_mul_f32 v225,v225,v10
 v_mfma_f32_16x16x32_bf16 a[92:95],v[24:27],v[76:79],a[92:95]
 s_waitcnt lgkmcnt(4)
 v_mul_f32 v226,v226,v10
 v_mul_f32 v227,v227,v10
 v_mfma_f32_16x16x32_bf16 a[96:99],v[32:35],v[64:67],0
 ds_read_b64_tr_b16 v[16:17],v236
 ds_read_b64_tr_b16 v[18:19],v236 offset:6144
 v_mfma_f32_16x16x32_bf16 a[96:99],v[36:39],v[80:83],a[96:99]
 v_mul_f32 v228,v228,v10
 v_mul_f32 v229,v229,v10
 v_mfma_f32_16x16x32_bf16 a[100:103],v[36:39],v[84:87],0
 s_add_u32 s47,s46,393216
 v_mul_f32 v230,v230,v10
 v_mul_f32 v231,v231,v10
 v_mfma_f32_16x16x32_bf16 a[100:103],v[32:35],v[68:71],a[100:103]
 buffer_store_dwordx4 v[120:123],v4,s[4:7],s47 offen offset:3072 sc1
 ds_read_b64_tr_b16 v[20:21],v236 offset:12288
 ds_read_b64_tr_b16 v[22:23],v236 offset:18432
 v_mfma_f32_16x16x32_bf16 a[104:107],v[32:35],v[72:75],0
 v_cvt_pk_bf16_f32 v128,v224,v225
 v_cvt_pk_bf16_f32 v129,v226,v227
 v_mfma_f32_16x16x32_bf16 a[104:107],v[36:39],v[88:91],a[104:107]
 v_cvt_pk_bf16_f32 v130,v228,v229
 v_cvt_pk_bf16_f32 v131,v230,v231
 v_mfma_f32_16x16x32_bf16 a[108:111],v[36:39],v[92:95],0
 v_accvgpr_read_b32 v232,a132
 v_accvgpr_read_b32 v233,a133
 v_mfma_f32_16x16x32_bf16 a[108:111],v[32:35],v[76:79],a[108:111]
 s_waitcnt lgkmcnt(4)
 v_accvgpr_read_b32 v234,a134
 v_accvgpr_read_b32 v235,a135
 v_mfma_f32_16x16x32_bf16 a[112:115],v[40:43],v[64:67],0
 ds_read_b64_tr_b16 v[24:25],v237
 ds_read_b64_tr_b16 v[26:27],v237 offset:6144
 v_mfma_f32_16x16x32_bf16 a[112:115],v[44:47],v[80:83],a[112:115]
 v_accvgpr_read_b32 v244,a148
 v_accvgpr_read_b32 v245,a149
 v_mfma_f32_16x16x32_bf16 a[116:119],v[44:47],v[84:87],0
 ds_read_b64_tr_b16 v[28:29],v237 offset:12288
 ds_read_b64_tr_b16 v[30:31],v237 offset:18432
 v_mfma_f32_16x16x32_bf16 a[116:119],v[40:43],v[68:71],a[116:119]
 buffer_load_dwordx4 a[204:207],v4,s[8:11],s0 offen offset:1024 sc1
 v_accvgpr_read_b32 v246,a150
 v_accvgpr_read_b32 v247,a151
 v_mfma_f32_16x16x32_bf16 a[120:123],v[40:43],v[72:75],0
 v_mul_f32 v232,v232,v11
 v_mul_f32 v233,v233,v11
 v_mfma_f32_16x16x32_bf16 a[120:123],v[44:47],v[88:91],a[120:123]
 v_mul_f32 v234,v234,v11
 v_mul_f32 v235,v235,v11
 v_mfma_f32_16x16x32_bf16 a[124:127],v[44:47],v[92:95],0
 s_add_u32 s47,s46,589824
 v_mul_f32 v244,v244,v11
 v_mul_f32 v245,v245,v11
 v_mfma_f32_16x16x32_bf16 a[124:127],v[40:43],v[76:79],a[124:127]
 s_waitcnt lgkmcnt(4)
 v_mul_f32 v246,v246,v11
 v_mul_f32 v247,v247,v11
 v_mfma_f32_16x16x32_bf16 a[0:3],v[16:19],v[96:99],a[0:3]
 buffer_store_dwordx4 v[124:127],v4,s[4:7],s47 offen offset:3072 sc1
 v_cvt_pk_bf16_f32 v132,v232,v233
 v_cvt_pk_bf16_f32 v133,v234,v235
 v_mfma_f32_16x16x32_bf16 a[0:3],v[20:23],v[112:115],a[0:3]
 ds_read_b64_tr_b16 v[32:33],v238
 ds_read_b64_tr_b16 v[34:35],v238 offset:6144
 v_mfma_f32_16x16x32_bf16 a[4:7],v[20:23],v[116:119],a[4:7]
 v_cvt_pk_bf16_f32 v134,v244,v245
 v_cvt_pk_bf16_f32 v135,v246,v247
 v_mfma_f32_16x16x32_bf16 a[4:7],v[16:19],v[100:103],a[4:7]
 v_accvgpr_read_b32 v224,a136
 v_accvgpr_read_b32 v225,a137
 v_mfma_f32_16x16x32_bf16 a[8:11],v[16:19],v[104:107],a[8:11]
 ds_read_b64_tr_b16 v[36:37],v238 offset:12288
 ds_read_b64_tr_b16 v[38:39],v238 offset:18432
 v_mfma_f32_16x16x32_bf16 a[8:11],v[20:23],v[120:123],a[8:11]
 v_accvgpr_read_b32 v226,a138
 v_accvgpr_read_b32 v227,a139
 v_mfma_f32_16x16x32_bf16 a[12:15],v[20:23],v[124:127],a[12:15]
 v_accvgpr_read_b32 v228,a152
 v_accvgpr_read_b32 v229,a153
 v_mfma_f32_16x16x32_bf16 a[12:15],v[16:19],v[108:111],a[12:15]
 s_waitcnt lgkmcnt(4)
 v_accvgpr_read_b32 v230,a154
 v_accvgpr_read_b32 v231,a155
 v_mfma_f32_16x16x32_bf16 a[16:19],v[24:27],v[96:99],a[16:19]
 s_add_u32 s47,s46,4096
 ds_read_b64_tr_b16 v[40:41],v239
 ds_read_b64_tr_b16 v[42:43],v239 offset:6144
 v_mfma_f32_16x16x32_bf16 a[16:19],v[28:31],v[112:115],a[16:19]
 buffer_store_dwordx4 v[128:131],v4,s[4:7],s47 offen sc1
 v_mul_f32 v224,v224,v12
 v_mul_f32 v225,v225,v12
 v_mfma_f32_16x16x32_bf16 a[20:23],v[28:31],v[116:119],a[20:23]
 v_mul_f32 v226,v226,v12
 v_mul_f32 v227,v227,v12
 v_mfma_f32_16x16x32_bf16 a[20:23],v[24:27],v[100:103],a[20:23]
 ds_read_b64_tr_b16 v[44:45],v239 offset:12288
 ds_read_b64_tr_b16 v[46:47],v239 offset:18432
 v_mfma_f32_16x16x32_bf16 a[24:27],v[24:27],v[104:107],a[24:27]
 v_mul_f32 v228,v228,v12
 v_mul_f32 v229,v229,v12
 v_mfma_f32_16x16x32_bf16 a[24:27],v[28:31],v[120:123],a[24:27]
 v_mul_f32 v230,v230,v12
 v_mul_f32 v231,v231,v12
 v_mfma_f32_16x16x32_bf16 a[28:31],v[28:31],v[124:127],a[28:31]
 v_cvt_pk_bf16_f32 v136,v224,v225
 v_cvt_pk_bf16_f32 v137,v226,v227
 v_mfma_f32_16x16x32_bf16 a[28:31],v[24:27],v[108:111],a[28:31]
 s_waitcnt lgkmcnt(4)
 v_cvt_pk_bf16_f32 v138,v228,v229
 v_cvt_pk_bf16_f32 v139,v230,v231
 v_mfma_f32_16x16x32_bf16 a[32:35],v[32:35],v[96:99],a[32:35]
 ds_read_b64_tr_b16 v[16:17],v236 offset:128
 ds_read_b64_tr_b16 v[18:19],v236 offset:6272
 v_mfma_f32_16x16x32_bf16 a[32:35],v[36:39],v[112:115],a[32:35]
 buffer_load_dwordx2 a[212:213],v5,s[8:11],s0 offen offset:2048 sc1
 v_accvgpr_read_b32 v232,a140
 v_accvgpr_read_b32 v233,a141
 v_mfma_f32_16x16x32_bf16 a[36:39],v[36:39],v[116:119],a[36:39]
 v_accvgpr_read_b32 v234,a142
 v_accvgpr_read_b32 v235,a143
 v_mfma_f32_16x16x32_bf16 a[36:39],v[32:35],v[100:103],a[36:39]
 s_add_u32 s47,s46,200704
 ds_read_b64_tr_b16 v[20:21],v236 offset:12416
 ds_read_b64_tr_b16 v[22:23],v236 offset:18560
 v_mfma_f32_16x16x32_bf16 a[40:43],v[32:35],v[104:107],a[40:43]
 buffer_store_dwordx4 v[132:135],v4,s[4:7],s47 offen sc1
 v_accvgpr_read_b32 v244,a156
 v_accvgpr_read_b32 v245,a157
 v_mfma_f32_16x16x32_bf16 a[40:43],v[36:39],v[120:123],a[40:43]
 v_accvgpr_read_b32 v246,a158
 v_accvgpr_read_b32 v247,a159
 v_mfma_f32_16x16x32_bf16 a[44:47],v[36:39],v[124:127],a[44:47]
 v_mul_f32 v232,v232,v13
 v_mul_f32 v233,v233,v13
 v_mfma_f32_16x16x32_bf16 a[44:47],v[32:35],v[108:111],a[44:47]
 s_waitcnt lgkmcnt(4)
 v_mul_f32 v234,v234,v13
 v_mul_f32 v235,v235,v13
 v_mfma_f32_16x16x32_bf16 a[48:51],v[40:43],v[96:99],a[48:51]
 ds_read_b64_tr_b16 v[24:25],v237 offset:128
 ds_read_b64_tr_b16 v[26:27],v237 offset:6272
 v_mfma_f32_16x16x32_bf16 a[48:51],v[44:47],v[112:115],a[48:51]
 v_mul_f32 v244,v244,v13
 v_mul_f32 v245,v245,v13
 v_mfma_f32_16x16x32_bf16 a[52:55],v[44:47],v[116:119],a[52:55]
 v_mul_f32 v246,v246,v13
 v_mul_f32 v247,v247,v13
 v_mfma_f32_16x16x32_bf16 a[52:55],v[40:43],v[100:103],a[52:55]
 ds_read_b64_tr_b16 v[28:29],v237 offset:12416
 ds_read_b64_tr_b16 v[30:31],v237 offset:18560
 v_mfma_f32_16x16x32_bf16 a[56:59],v[40:43],v[104:107],a[56:59]
 buffer_load_dwordx2 a[214:215],v5,s[8:11],s0 offen offset:2560 sc1
 v_cvt_pk_bf16_f32 v140,v232,v233
 v_cvt_pk_bf16_f32 v141,v234,v235
 v_mfma_f32_16x16x32_bf16 a[56:59],v[44:47],v[120:123],a[56:59]
 v_cvt_pk_bf16_f32 v142,v244,v245
 v_cvt_pk_bf16_f32 v143,v246,v247
 v_mfma_f32_16x16x32_bf16 a[60:63],v[44:47],v[124:127],a[60:63]
 s_add_u32 s47,s46,397312
 v_accvgpr_read_b32 v224,a160
 v_accvgpr_read_b32 v225,a161
 v_mfma_f32_16x16x32_bf16 a[60:63],v[40:43],v[108:111],a[60:63]
 buffer_store_dwordx4 v[136:139],v4,s[4:7],s47 offen sc1
 s_waitcnt lgkmcnt(4)
 v_accvgpr_read_b32 v226,a162
 v_accvgpr_read_b32 v227,a163
 v_mfma_f32_16x16x32_bf16 a[64:67],v[16:19],v[96:99],a[64:67]
 ds_read_b64_tr_b16 v[32:33],v238 offset:128
 ds_read_b64_tr_b16 v[34:35],v238 offset:6272
 v_mfma_f32_16x16x32_bf16 a[64:67],v[20:23],v[112:115],a[64:67]
 v_accvgpr_read_b32 v228,a176
 v_accvgpr_read_b32 v229,a177
 v_mfma_f32_16x16x32_bf16 a[68:71],v[20:23],v[116:119],a[68:71]
 v_accvgpr_read_b32 v230,a178
 v_accvgpr_read_b32 v231,a179
 v_mfma_f32_16x16x32_bf16 a[68:71],v[16:19],v[100:103],a[68:71]
 ds_read_b64_tr_b16 v[36:37],v238 offset:12416
 ds_read_b64_tr_b16 v[38:39],v238 offset:18560
 v_mfma_f32_16x16x32_bf16 a[72:75],v[16:19],v[104:107],a[72:75]
 v_mul_f32 v224,v224,v10
 v_mul_f32 v225,v225,v10
 v_mfma_f32_16x16x32_bf16 a[72:75],v[20:23],v[120:123],a[72:75]
 v_mul_f32 v226,v226,v10
 v_mul_f32 v227,v227,v10
 v_mfma_f32_16x16x32_bf16 a[76:79],v[20:23],v[124:127],a[76:79]
 v_mul_f32 v228,v228,v10
 v_mul_f32 v229,v229,v10
 v_mfma_f32_16x16x32_bf16 a[76:79],v[16:19],v[108:111],a[76:79]
 s_waitcnt lgkmcnt(4)
 v_mul_f32 v230,v230,v10
 v_mul_f32 v231,v231,v10
 v_mfma_f32_16x16x32_bf16 a[80:83],v[24:27],v[96:99],a[80:83]
 buffer_load_dwordx4 a[220:223],v4,s[8:11],s0 offen offset:3072 sc1
 ds_read_b64_tr_b16 v[40:41],v239 offset:128
 ds_read_b64_tr_b16 v[42:43],v239 offset:6272
 v_mfma_f32_16x16x32_bf16 a[80:83],v[28:31],v[112:115],a[80:83]
 v_cvt_pk_bf16_f32 v144,v224,v225
 v_cvt_pk_bf16_f32 v145,v226,v227
 v_mfma_f32_16x16x32_bf16 a[84:87],v[28:31],v[116:119],a[84:87]
 v_cvt_pk_bf16_f32 v146,v228,v229
 v_cvt_pk_bf16_f32 v147,v230,v231
 v_mfma_f32_16x16x32_bf16 a[84:87],v[24:27],v[100:103],a[84:87]
 s_add_u32 s47,s46,593920
 ds_read_b64_tr_b16 v[44:45],v239 offset:12416
 ds_read_b64_tr_b16 v[46:47],v239 offset:18560
 v_mfma_f32_16x16x32_bf16 a[88:91],v[24:27],v[104:107],a[88:91]
 buffer_store_dwordx4 v[140:143],v4,s[4:7],s47 offen sc1
 v_accvgpr_read_b32 v232,a164
 v_accvgpr_read_b32 v233,a165
 v_mfma_f32_16x16x32_bf16 a[88:91],v[28:31],v[120:123],a[88:91]
 v_accvgpr_read_b32 v234,a166
 v_accvgpr_read_b32 v235,a167
 v_mfma_f32_16x16x32_bf16 a[92:95],v[28:31],v[124:127],a[92:95]
 v_accvgpr_read_b32 v244,a180
 v_accvgpr_read_b32 v245,a181
 v_mfma_f32_16x16x32_bf16 a[92:95],v[24:27],v[108:111],a[92:95]
 s_waitcnt lgkmcnt(4)
 v_accvgpr_read_b32 v246,a182
 v_accvgpr_read_b32 v247,a183
 v_mfma_f32_16x16x32_bf16 a[96:99],v[32:35],v[96:99],a[96:99]
 ds_read_b64_tr_b16 v[16:17],v240 offset:256
 ds_read_b64_tr_b16 v[18:19],v240 offset:6400
 v_mfma_f32_16x16x32_bf16 a[96:99],v[36:39],v[112:115],a[96:99]
 v_mul_f32 v232,v232,v11
 v_mul_f32 v233,v233,v11
 v_mfma_f32_16x16x32_bf16 a[100:103],v[36:39],v[116:119],a[100:103]
 v_mul_f32 v234,v234,v11
 v_mul_f32 v235,v235,v11
 v_mfma_f32_16x16x32_bf16 a[100:103],v[32:35],v[100:103],a[100:103]
 ds_read_b64_tr_b16 v[20:21],v240 offset:12544
 ds_read_b64_tr_b16 v[22:23],v240 offset:18688
 v_mfma_f32_16x16x32_bf16 a[104:107],v[32:35],v[104:107],a[104:107]
 s_add_u32 s47,s46,4096
 v_mul_f32 v244,v244,v11
 v_mul_f32 v245,v245,v11
 v_mfma_f32_16x16x32_bf16 a[104:107],v[36:39],v[120:123],a[104:107]
 buffer_store_dwordx4 v[144:147],v4,s[4:7],s47 offen offset:1024 sc1
 v_mul_f32 v246,v246,v11
 v_mul_f32 v247,v247,v11
 v_mfma_f32_16x16x32_bf16 a[108:111],v[36:39],v[124:127],a[108:111]
 v_cvt_pk_bf16_f32 v148,v232,v233
 v_cvt_pk_bf16_f32 v149,v234,v235
 v_mfma_f32_16x16x32_bf16 a[108:111],v[32:35],v[108:111],a[108:111]
 s_waitcnt lgkmcnt(4)
 v_cvt_pk_bf16_f32 v150,v244,v245
 v_cvt_pk_bf16_f32 v151,v246,v247
 v_mfma_f32_16x16x32_bf16 a[112:115],v[40:43],v[96:99],a[112:115]
 ds_read_b64_tr_b16 v[24:25],v241 offset:256
 ds_read_b64_tr_b16 v[26:27],v241 offset:6400
 v_mfma_f32_16x16x32_bf16 a[112:115],v[44:47],v[112:115],a[112:115]
 v_accvgpr_read_b32 v224,a168
 v_accvgpr_read_b32 v225,a169
 v_mfma_f32_16x16x32_bf16 a[116:119],v[44:47],v[116:119],a[116:119]
 v_accvgpr_read_b32 v226,a170
 v_accvgpr_read_b32 v227,a171
 v_mfma_f32_16x16x32_bf16 a[116:119],v[40:43],v[100:103],a[116:119]
 ds_read_b64_tr_b16 v[28:29],v241 offset:12544
 ds_read_b64_tr_b16 v[30:31],v241 offset:18688
 v_mfma_f32_16x16x32_bf16 a[120:123],v[40:43],v[104:107],a[120:123]
 s_add_u32 s47,s46,200704
 v_accvgpr_read_b32 v228,a184
 v_accvgpr_read_b32 v229,a185
 v_mfma_f32_16x16x32_bf16 a[120:123],v[44:47],v[120:123],a[120:123]
 buffer_store_dwordx4 v[148:151],v4,s[4:7],s47 offen offset:1024 sc1
 v_accvgpr_read_b32 v230,a186
 v_accvgpr_read_b32 v231,a187
 v_mfma_f32_16x16x32_bf16 a[124:127],v[44:47],v[124:127],a[124:127]
 v_mul_f32 v224,v224,v12
 v_mul_f32 v225,v225,v12
 v_mfma_f32_16x16x32_bf16 a[124:127],v[40:43],v[108:111],a[124:127]
 s_waitcnt lgkmcnt(4)
 v_mul_f32 v226,v226,v12
 v_mul_f32 v227,v227,v12
 v_mfma_f32_16x16x32_bf16 a[128:131],v[16:19],v[64:67],0
 ds_read_b64_tr_b16 v[32:33],v236 offset:256
 ds_read_b64_tr_b16 v[34:35],v236 offset:6400
 v_mfma_f32_16x16x32_bf16 a[128:131],v[20:23],v[80:83],a[128:131]
 v_mul_f32 v228,v228,v12
 v_mul_f32 v229,v229,v12
 v_mfma_f32_16x16x32_bf16 a[132:135],v[20:23],v[84:87],0
 v_mul_f32 v230,v230,v12
 v_mul_f32 v231,v231,v12
 v_mfma_f32_16x16x32_bf16 a[132:135],v[16:19],v[68:71],a[132:135]
 ds_read_b64_tr_b16 v[36:37],v236 offset:12544
 ds_read_b64_tr_b16 v[38:39],v236 offset:18688
 v_mfma_f32_16x16x32_bf16 a[136:139],v[16:19],v[72:75],0
 v_cvt_pk_bf16_f32 v152,v224,v225
 v_cvt_pk_bf16_f32 v153,v226,v227
 v_mfma_f32_16x16x32_bf16 a[136:139],v[20:23],v[88:91],a[136:139]
 s_mov_b32 s0,4096
 v_cvt_pk_bf16_f32 v154,v228,v229
 v_cvt_pk_bf16_f32 v155,v230,v231
 v_mfma_f32_16x16x32_bf16 a[140:143],v[20:23],v[92:95],0
 buffer_load_dwordx4 a[224:227],v4,s[8:11],s0 offen sc1
 v_accvgpr_read_b32 v232,a172
 v_accvgpr_read_b32 v233,a173
 v_mfma_f32_16x16x32_bf16 a[140:143],v[16:19],v[76:79],a[140:143]
 s_waitcnt lgkmcnt(4)
 v_accvgpr_read_b32 v234,a174
 v_accvgpr_read_b32 v235,a175
 v_mfma_f32_16x16x32_bf16 a[144:147],v[24:27],v[64:67],0
 ds_read_b64_tr_b16 v[40:41],v237 offset:256
 ds_read_b64_tr_b16 v[42:43],v237 offset:6400
 v_mfma_f32_16x16x32_bf16 a[144:147],v[28:31],v[80:83],a[144:147]
 v_accvgpr_read_b32 v244,a188
 v_accvgpr_read_b32 v245,a189
 v_mfma_f32_16x16x32_bf16 a[148:151],v[28:31],v[84:87],0
 ds_read_b64_tr_b16 v[44:45],v237 offset:12544
 ds_read_b64_tr_b16 v[46:47],v237 offset:18688
 v_mfma_f32_16x16x32_bf16 a[148:151],v[24:27],v[68:71],a[148:151]
 buffer_load_dwordx4 a[232:235],v4,s[8:11],s0 offen offset:1024 sc1
 v_add_u32 v236,49152,v236
 v_add_u32 v237,49152,v237
 v_mfma_f32_16x16x32_bf16 a[152:155],v[24:27],v[72:75],0
 v_add_u32 v238,49152,v238
 v_add_u32 v239,49152,v239
 v_mfma_f32_16x16x32_bf16 a[152:155],v[28:31],v[88:91],a[152:155]
 v_accvgpr_read_b32 v246,a190
 v_accvgpr_read_b32 v247,a191
 v_mfma_f32_16x16x32_bf16 a[156:159],v[28:31],v[92:95],0
 s_add_u32 s47,s46,397312
 v_mul_f32 v232,v232,v13
 v_mul_f32 v233,v233,v13
 v_mfma_f32_16x16x32_bf16 a[156:159],v[24:27],v[76:79],a[156:159]
 buffer_store_dwordx4 v[152:155],v4,s[4:7],s47 offen offset:1024 sc1
 s_waitcnt lgkmcnt(4)
 v_mul_f32 v234,v234,v13
 v_mul_f32 v235,v235,v13
 v_mfma_f32_16x16x32_bf16 a[128:131],v[32:35],v[96:99],a[128:131]
 s_waitcnt vmcnt(41)
 s_barrier
 v_mul_f32 v244,v244,v13
 v_mfma_f32_16x16x32_bf16 a[128:131],v[36:39],v[112:115],a[128:131]
 ds_read_b64_tr_b16 v[16:17],v236
 ds_read_b64_tr_b16 v[18:19],v236 offset:6144
 v_mfma_f32_16x16x32_bf16 a[132:135],v[36:39],v[116:119],a[132:135]
 v_mul_f32 v245,v245,v13
 v_mul_f32 v246,v246,v13
 v_mfma_f32_16x16x32_bf16 a[132:135],v[32:35],v[100:103],a[132:135]
 v_mul_f32 v247,v247,v13
 v_cvt_pk_bf16_f32 v156,v232,v233
 v_mfma_f32_16x16x32_bf16 a[136:139],v[32:35],v[104:107],a[136:139]
 ds_read_b64_tr_b16 v[20:21],v236 offset:12288
 ds_read_b64_tr_b16 v[22:23],v236 offset:18432
 v_mfma_f32_16x16x32_bf16 a[136:139],v[36:39],v[120:123],a[136:139]
 v_cvt_pk_bf16_f32 v157,v234,v235
 v_cvt_pk_bf16_f32 v158,v244,v245
 v_mfma_f32_16x16x32_bf16 a[140:143],v[36:39],v[124:127],a[140:143]
 buffer_load_dwordx4 a[240:243],v4,s[8:11],s0 offen offset:2048 sc1
 v_cvt_pk_bf16_f32 v159,v246,v247
 v_mfma_f32_16x16x32_bf16 a[140:143],v[32:35],v[108:111],a[140:143]
 s_waitcnt lgkmcnt(4)
 s_cmp_eq_u32 s32,3
 s_cselect_b32 s56,0,s32
 v_mfma_f32_16x16x32_bf16 a[144:147],v[40:43],v[96:99],a[144:147]
 ds_read_b64_tr_b16 v[24:25],v237
 ds_read_b64_tr_b16 v[26:27],v237 offset:6144
 v_mfma_f32_16x16x32_bf16 a[144:147],v[44:47],v[112:115],a[144:147]
 s_add_u32 s57,s56,1
 s_cmp_eq_u32 s57,3
 s_cselect_b32 s57,0,s57
 v_mfma_f32_16x16x32_bf16 a[148:151],v[44:47],v[116:119],a[148:151]
 s_add_u32 s58,s57,1
 s_cmp_eq_u32 s58,3
 s_cselect_b32 s58,0,s58
 v_mfma_f32_16x16x32_bf16 a[148:151],v[40:43],v[100:103],a[148:151]
 buffer_load_dwordx2 a[248:249],v5,s[8:11],s0 offen offset:3072 sc1
 ds_read_b64_tr_b16 v[28:29],v237 offset:12288
 ds_read_b64_tr_b16 v[30:31],v237 offset:18432
 v_mfma_f32_16x16x32_bf16 a[152:155],v[40:43],v[104:107],a[152:155]
 v_lshrrev_b32 v14,2,v0
 v_mul_u32_u24 v13,192,v14
 v_mfma_f32_16x16x32_bf16 a[152:155],v[44:47],v[120:123],a[152:155]
 buffer_load_dwordx2 a[250:251],v5,s[8:11],s0 offen offset:3584 sc1
 v_and_b32 v15,3,v0
 v_lshl_add_u32 v13,v15,3,v13
 v_mfma_f32_16x16x32_bf16 a[156:159],v[44:47],v[124:127],a[156:159]
 s_add_u32 s47,s46,593920
 v_and_b32 v14,4,v14
 v_lshl_add_u32 v13,v14,3,v13
 v_mfma_f32_16x16x32_bf16 a[156:159],v[40:43],v[108:111],a[156:159]
 buffer_store_dwordx4 v[156:159],v4,s[4:7],s47 offen offset:1024 sc1
 s_waitcnt lgkmcnt(4)
 v_add_u32 v13,49152,v13
 v_lshl_add_u32 v6,s56,6,v13
 v_mfma_f32_16x16x32_bf16 a[0:3],v[16:19],v[128:131],a[0:3]
 ds_read_b64_tr_b16 v[32:33],v238
 ds_read_b64_tr_b16 v[34:35],v238 offset:6144
 v_mfma_f32_16x16x32_bf16 a[0:3],v[20:23],v[144:147],a[0:3]
 v_xor_b32 v7,32,v6
 v_lshl_add_u32 v8,s57,6,v13
 v_mfma_f32_16x16x32_bf16 a[4:7],v[20:23],v[148:151],a[4:7]
 v_xor_b32 v9,32,v8
 v_lshl_add_u32 v10,s58,6,v13
 v_mfma_f32_16x16x32_bf16 a[4:7],v[16:19],v[132:135],a[4:7]
 ds_read_b64_tr_b16 v[36:37],v238 offset:12288
 ds_read_b64_tr_b16 v[38:39],v238 offset:18432
 v_mfma_f32_16x16x32_bf16 a[8:11],v[16:19],v[136:139],a[8:11]
 s_mov_b32 s0,24576
 v_xor_b32 v11,32,v10
 v_mov_b32 v224,0x3f803f80
 v_mfma_f32_16x16x32_bf16 a[8:11],v[20:23],v[152:155],a[8:11]
 s_waitcnt vmcnt(39)
 s_barrier
 v_mov_b32 v225,0x3f803f80
 v_mfma_f32_16x16x32_bf16 a[12:15],v[20:23],v[156:159],a[12:15]
 buffer_load_dwordx4 a[228:231],v4,s[8:11],s0 offen sc1
 v_mov_b32 v226,0x3f803f80
 v_mov_b32 v227,0x3f803f80
 v_mfma_f32_16x16x32_bf16 a[12:15],v[16:19],v[140:143],a[12:15]
 s_waitcnt lgkmcnt(4)
 v_and_b32 v14,48,v0
 v_add_u32 v14,147456,v14
 v_mfma_f32_16x16x32_bf16 a[16:19],v[24:27],v[128:131],a[16:19]
 ds_read_b64_tr_b16 v[40:41],v239
 ds_read_b64_tr_b16 v[42:43],v239 offset:6144
 v_mfma_f32_16x16x32_bf16 a[16:19],v[28:31],v[144:147],a[16:19]
 v_lshl_add_u32 v251,s56,7,v14
 v_lshl_add_u32 v252,s57,7,v14
 v_mfma_f32_16x16x32_bf16 a[20:23],v[28:31],v[148:151],a[20:23]
 buffer_load_dwordx4 a[236:239],v4,s[8:11],s0 offen offset:1024 sc1
 v_lshl_add_u32 v253,s58,7,v14
 v_mfma_f32_16x16x32_bf16 a[20:23],v[24:27],v[132:135],a[20:23]
 ds_read_b64_tr_b16 v[44:45],v239 offset:12288
 ds_read_b64_tr_b16 v[46:47],v239 offset:18432
 v_mfma_f32_16x16x32_bf16 a[24:27],v[24:27],v[136:139],a[24:27]
 v_mfma_f32_16x16x32_bf16 a[24:27],v[28:31],v[152:155],a[24:27]
 v_mfma_f32_16x16x32_bf16 a[28:31],v[28:31],v[156:159],a[28:31]
 buffer_load_dwordx4 a[244:247],v4,s[8:11],s0 offen offset:2048 sc1
 v_mfma_f32_16x16x32_bf16 a[28:31],v[24:27],v[140:143],a[28:31]
 s_waitcnt lgkmcnt(4)
 v_mfma_f32_16x16x32_bf16 a[32:35],v[32:35],v[128:131],a[32:35]
 ds_read_b64_tr_b16 v[16:17],v236 offset:128
 ds_read_b64_tr_b16 v[18:19],v236 offset:6272
 v_mfma_f32_16x16x32_bf16 a[32:35],v[36:39],v[144:147],a[32:35]
 v_mfma_f32_16x16x32_bf16 a[36:39],v[36:39],v[148:151],a[36:39]
 v_mfma_f32_16x16x32_bf16 a[36:39],v[32:35],v[132:135],a[36:39]
 ds_read_b64_tr_b16 v[20:21],v236 offset:12416
 ds_read_b64_tr_b16 v[22:23],v236 offset:18560
 v_mfma_f32_16x16x32_bf16 a[40:43],v[32:35],v[136:139],a[40:43]
 buffer_load_dwordx2 a[252:253],v5,s[8:11],s0 offen offset:3072 sc1
 v_mfma_f32_16x16x32_bf16 a[40:43],v[36:39],v[152:155],a[40:43]
 buffer_load_dwordx2 a[254:255],v5,s[8:11],s0 offen offset:3584 sc1
 v_mfma_f32_16x16x32_bf16 a[44:47],v[36:39],v[156:159],a[44:47]
 v_mfma_f32_16x16x32_bf16 a[44:47],v[32:35],v[140:143],a[44:47]
 s_waitcnt lgkmcnt(4)
 v_mfma_f32_16x16x32_bf16 a[48:51],v[40:43],v[128:131],a[48:51]
 ds_read_b64_tr_b16 v[24:25],v237 offset:128
 ds_read_b64_tr_b16 v[26:27],v237 offset:6272
 v_mfma_f32_16x16x32_bf16 a[48:51],v[44:47],v[144:147],a[48:51]
 s_add_u32 m0,s35,0
 s_mov_b32 s44,786432
 buffer_load_dwordx4 v248,s[16:19],s44 offen lds
 v_mfma_f32_16x16x32_bf16 a[52:55],v[44:47],v[148:151],a[52:55]
 v_mfma_f32_16x16x32_bf16 a[52:55],v[40:43],v[132:135],a[52:55]
 ds_read_b64_tr_b16 v[28:29],v237 offset:12416
 ds_read_b64_tr_b16 v[30:31],v237 offset:18560
 v_mfma_f32_16x16x32_bf16 a[56:59],v[40:43],v[136:139],a[56:59]
 v_mfma_f32_16x16x32_bf16 a[56:59],v[44:47],v[152:155],a[56:59]
 buffer_load_dwordx4 v249,s[16:19],s44 offen offset:1024 lds
 v_mfma_f32_16x16x32_bf16 a[60:63],v[44:47],v[156:159],a[60:63]
 v_mfma_f32_16x16x32_bf16 a[60:63],v[40:43],v[140:143],a[60:63]
 s_waitcnt lgkmcnt(4)
 v_mfma_f32_16x16x32_bf16 a[64:67],v[16:19],v[128:131],a[64:67]
 ds_read_b64_tr_b16 v[32:33],v238 offset:128
 ds_read_b64_tr_b16 v[34:35],v238 offset:6272
 v_mfma_f32_16x16x32_bf16 a[64:67],v[20:23],v[144:147],a[64:67]
 v_mfma_f32_16x16x32_bf16 a[68:71],v[20:23],v[148:151],a[68:71]
 v_mfma_f32_16x16x32_bf16 a[68:71],v[16:19],v[132:135],a[68:71]
 ds_read_b64_tr_b16 v[36:37],v238 offset:12416
 ds_read_b64_tr_b16 v[38:39],v238 offset:18560
 v_mfma_f32_16x16x32_bf16 a[72:75],v[16:19],v[136:139],a[72:75]
 buffer_load_dwordx4 v250,s[16:19],s44 offen offset:2048 lds
 v_mfma_f32_16x16x32_bf16 a[72:75],v[20:23],v[152:155],a[72:75]
 v_mfma_f32_16x16x32_bf16 a[76:79],v[20:23],v[156:159],a[76:79]
 v_mfma_f32_16x16x32_bf16 a[76:79],v[16:19],v[140:143],a[76:79]
 s_waitcnt lgkmcnt(4)
 v_mfma_f32_16x16x32_bf16 a[80:83],v[24:27],v[128:131],a[80:83]
 ds_read_b64_tr_b16 v[40:41],v239 offset:128
 ds_read_b64_tr_b16 v[42:43],v239 offset:6272
 v_mfma_f32_16x16x32_bf16 a[80:83],v[28:31],v[144:147],a[80:83]
 s_add_u32 m0,s35,3072
 s_add_u32 s44,s44,49152
 buffer_load_dwordx4 v248,s[16:19],s44 offen lds
 v_mfma_f32_16x16x32_bf16 a[84:87],v[28:31],v[148:151],a[84:87]
 v_mfma_f32_16x16x32_bf16 a[84:87],v[24:27],v[132:135],a[84:87]
 ds_read_b64_tr_b16 v[44:45],v239 offset:12416
 ds_read_b64_tr_b16 v[46:47],v239 offset:18560
 v_mfma_f32_16x16x32_bf16 a[88:91],v[24:27],v[136:139],a[88:91]
 v_mfma_f32_16x16x32_bf16 a[88:91],v[28:31],v[152:155],a[88:91]
 v_mfma_f32_16x16x32_bf16 a[92:95],v[28:31],v[156:159],a[92:95]
 v_mfma_f32_16x16x32_bf16 a[92:95],v[24:27],v[140:143],a[92:95]
 s_waitcnt lgkmcnt(4)
 v_mfma_f32_16x16x32_bf16 a[96:99],v[32:35],v[128:131],a[96:99]
 s_mov_b32 s3,8192
 ds_read_b64_tr_b16 v[16:17],v236 offset:256
 ds_read_b64_tr_b16 v[18:19],v236 offset:6400
 v_mfma_f32_16x16x32_bf16 a[96:99],v[36:39],v[144:147],a[96:99]
 buffer_load_dwordx4 a[160:163],v4,s[8:11],s3 offen sc1
 v_mfma_f32_16x16x32_bf16 a[100:103],v[36:39],v[148:151],a[100:103]
 v_mfma_f32_16x16x32_bf16 a[100:103],v[32:35],v[132:135],a[100:103]
 ds_read_b64_tr_b16 v[20:21],v236 offset:12544
 ds_read_b64_tr_b16 v[22:23],v236 offset:18688
 v_mfma_f32_16x16x32_bf16 a[104:107],v[32:35],v[136:139],a[104:107]
 buffer_load_dwordx4 a[168:171],v4,s[8:11],s3 offen offset:1024 sc1
 v_mfma_f32_16x16x32_bf16 a[104:107],v[36:39],v[152:155],a[104:107]
 v_mfma_f32_16x16x32_bf16 a[108:111],v[36:39],v[156:159],a[108:111]
 v_mfma_f32_16x16x32_bf16 a[108:111],v[32:35],v[140:143],a[108:111]
 s_waitcnt lgkmcnt(4)
 v_mfma_f32_16x16x32_bf16 a[112:115],v[40:43],v[128:131],a[112:115]
 ds_read_b64_tr_b16 v[24:25],v237 offset:256
 ds_read_b64_tr_b16 v[26:27],v237 offset:6400
 v_mfma_f32_16x16x32_bf16 a[112:115],v[44:47],v[144:147],a[112:115]
 buffer_load_dwordx4 v249,s[16:19],s44 offen offset:1024 lds
 v_mfma_f32_16x16x32_bf16 a[116:119],v[44:47],v[148:151],a[116:119]
 ds_read_b64_tr_b16 v[28:29],v237 offset:12544
 ds_read_b64_tr_b16 v[30:31],v237 offset:18688
 v_mfma_f32_16x16x32_bf16 a[116:119],v[40:43],v[132:135],a[116:119]
 v_mfma_f32_16x16x32_bf16 a[120:123],v[40:43],v[136:139],a[120:123]
 v_mfma_f32_16x16x32_bf16 a[120:123],v[44:47],v[152:155],a[120:123]
 v_mfma_f32_16x16x32_bf16 a[124:127],v[44:47],v[156:159],a[124:127]
 buffer_load_dwordx4 a[176:179],v4,s[8:11],s3 offen offset:2048 sc1
 v_mfma_f32_16x16x32_bf16 a[124:127],v[40:43],v[140:143],a[124:127]
 s_waitcnt lgkmcnt(4)
 v_mfma_f32_16x16x32_bf16 a[128:131],v[16:19],v[128:131],a[128:131]
 ds_read_b64_tr_b16 v[32:33],v6
 ds_read_b64_tr_b16 v[34:35],v6 offset:3072
 v_mfma_f32_16x16x32_bf16 a[128:131],v[20:23],v[144:147],a[128:131]
 ds_read_b64_tr_b16 v[36:37],v6 offset:6144
 ds_read_b64_tr_b16 v[38:39],v6 offset:9216
 v_mfma_f32_16x16x32_bf16 a[132:135],v[20:23],v[148:151],a[132:135]
 v_mfma_f32_16x16x32_bf16 a[132:135],v[16:19],v[132:135],a[132:135]
 ds_read_b64_tr_b16 v[40:41],v7
 ds_read_b64_tr_b16 v[42:43],v7 offset:3072
 v_mfma_f32_16x16x32_bf16 a[136:139],v[16:19],v[136:139],a[136:139]
 ds_read_b64_tr_b16 v[44:45],v7 offset:6144
 ds_read_b64_tr_b16 v[46:47],v7 offset:9216
 v_mfma_f32_16x16x32_bf16 a[136:139],v[20:23],v[152:155],a[136:139]
 buffer_load_dwordx4 v250,s[16:19],s44 offen offset:2048 lds
 v_mfma_f32_16x16x32_bf16 a[140:143],v[20:23],v[156:159],a[140:143]
 v_mfma_f32_16x16x32_bf16 a[140:143],v[16:19],v[140:143],a[140:143]
 s_waitcnt lgkmcnt(8)
 v_mfma_f32_16x16x32_bf16 a[144:147],v[24:27],v[128:131],a[144:147]
 v_mfma_f32_16x16x32_bf16 a[144:147],v[28:31],v[144:147],a[144:147]
 ds_read_b64_tr_b16 v[16:17],v8
 ds_read_b64_tr_b16 v[18:19],v8 offset:3072
 v_mfma_f32_16x16x32_bf16 a[148:151],v[28:31],v[148:151],a[148:151]
 buffer_load_dwordx4 a[184:187],v4,s[8:11],s3 offen offset:3072 sc1
 v_mfma_f32_16x16x32_bf16 a[148:151],v[24:27],v[132:135],a[148:151]
 ds_read_b64_tr_b16 v[20:21],v8 offset:6144
 ds_read_b64_tr_b16 v[22:23],v8 offset:9216
 v_mfma_f32_16x16x32_bf16 a[152:155],v[24:27],v[136:139],a[152:155]
 s_mov_b32 s3,28672
 v_mfma_f32_16x16x32_bf16 a[152:155],v[28:31],v[152:155],a[152:155]
 buffer_load_dwordx4 a[164:167],v4,s[8:11],s3 offen sc1
 v_mfma_f32_16x16x32_bf16 a[156:159],v[28:31],v[156:159],a[156:159]
 v_mfma_f32_16x16x32_bf16 a[156:159],v[24:27],v[140:143],a[156:159]
 s_waitcnt vmcnt(26) lgkmcnt(8)
 v_mfma_f32_16x16x32_bf16 v[112:115],v[32:35],a[192:195],0
 ds_read_b64_tr_b16 v[24:25],v9
 v_mfma_f32_16x16x32_bf16 v[112:115],v[36:39],a[200:203],v[112:115]
 ds_read_b64_tr_b16 v[26:27],v9 offset:3072
 v_mfma_f32_16x16x32_bf16 v[116:119],v[36:39],a[204:207],0
 buffer_load_dwordx4 a[172:175],v4,s[8:11],s3 offen offset:1024 sc1
 ds_read_b64_tr_b16 v[28:29],v9 offset:6144
 v_mfma_f32_16x16x32_bf16 v[116:119],v[32:35],a[196:199],v[116:119]
 ds_read_b64_tr_b16 v[30:31],v9 offset:9216
 v_mfma_f32_16x16x32_bf16 v[228:231],v[32:35],v[224:227],0
 v_mfma_f32_16x16x32_bf16 v[228:231],v[36:39],v[224:227],v[228:231]
 s_waitcnt lgkmcnt(8)
 v_mfma_f32_16x16x32_bf16 v[120:123],v[40:43],a[192:195],0
 ds_read_b64_tr_b16 v[32:33],v10
 v_mfma_f32_16x16x32_bf16 v[120:123],v[44:47],a[200:203],v[120:123]
 buffer_load_dwordx4 a[180:183],v4,s[8:11],s3 offen offset:2048 sc1
 ds_read_b64_tr_b16 v[34:35],v10 offset:3072
 v_mfma_f32_16x16x32_bf16 v[124:127],v[44:47],a[204:207],0
 ds_read_b64_tr_b16 v[36:37],v10 offset:6144
 v_mfma_f32_16x16x32_bf16 v[124:127],v[40:43],a[196:199],v[124:127]
 ds_read_b64_tr_b16 v[38:39],v10 offset:9216
 v_mfma_f32_16x16x32_bf16 v[232:235],v[40:43],v[224:227],0
 v_mfma_f32_16x16x32_bf16 v[232:235],v[44:47],v[224:227],v[232:235]
 s_waitcnt lgkmcnt(8)
 v_mfma_f32_16x16x32_bf16 v[128:131],v[16:19],a[192:195],0
 buffer_load_dwordx4 a[188:191],v4,s[8:11],s3 offen offset:3072 sc1
 ds_read_b64_tr_b16 v[40:41],v11
 v_mfma_f32_16x16x32_bf16 v[128:131],v[20:23],a[200:203],v[128:131]
 ds_read_b64_tr_b16 v[42:43],v11 offset:3072
 v_mfma_f32_16x16x32_bf16 v[132:135],v[20:23],a[204:207],0
 ds_read_b64_tr_b16 v[44:45],v11 offset:6144
 v_mfma_f32_16x16x32_bf16 v[132:135],v[16:19],a[196:199],v[132:135]
 s_waitcnt lgkmcnt(7)
 ds_read_b64_tr_b16 v[46:47],v11 offset:9216
 v_mfma_f32_16x16x32_bf16 v[136:139],v[24:27],a[192:195],0
 s_add_u32 m0,s35,122880
 s_mov_b32 s44,1179648
 buffer_load_dwordx4 v248,s[16:19],s44 offen lds
 ds_read_b64_tr_b16 v[16:17],v6 offset:12288
 v_mfma_f32_16x16x32_bf16 v[136:139],v[28:31],a[200:203],v[136:139]
 ds_read_b64_tr_b16 v[18:19],v6 offset:15360
 v_mfma_f32_16x16x32_bf16 v[140:143],v[28:31],a[204:207],0
 ds_read_b64_tr_b16 v[20:21],v6 offset:18432
 v_mfma_f32_16x16x32_bf16 v[140:143],v[24:27],a[196:199],v[140:143]
 s_waitcnt lgkmcnt(7)
 ds_read_b64_tr_b16 v[22:23],v6 offset:21504
 v_mfma_f32_16x16x32_bf16 v[144:147],v[32:35],a[192:195],0
 ds_read_b64_tr_b16 v[24:25],v7 offset:12288
 v_mfma_f32_16x16x32_bf16 v[144:147],v[36:39],a[200:203],v[144:147]
 ds_read_b64_tr_b16 v[26:27],v7 offset:15360
 v_mfma_f32_16x16x32_bf16 v[148:151],v[36:39],a[204:207],0
 buffer_load_dwordx4 v249,s[16:19],s44 offen offset:1024 lds
 ds_read_b64_tr_b16 v[28:29],v7 offset:18432
 v_mfma_f32_16x16x32_bf16 v[148:151],v[32:35],a[196:199],v[148:151]
 s_waitcnt lgkmcnt(7)
 ds_read_b64_tr_b16 v[30:31],v7 offset:21504
 v_mfma_f32_16x16x32_bf16 v[152:155],v[40:43],a[192:195],0
 ds_read_b64_tr_b16 v[32:33],v8 offset:12288
 v_mfma_f32_16x16x32_bf16 v[152:155],v[44:47],a[200:203],v[152:155]
 ds_read_b64_tr_b16 v[34:35],v8 offset:15360
 v_mfma_f32_16x16x32_bf16 v[156:159],v[44:47],a[204:207],0
 ds_read_b64_tr_b16 v[36:37],v8 offset:18432
 v_mfma_f32_16x16x32_bf16 v[156:159],v[40:43],a[196:199],v[156:159]
 s_waitcnt lgkmcnt(7)
 ds_read_b64_tr_b16 v[38:39],v8 offset:21504
 v_mfma_f32_16x16x32_bf16 v[112:115],v[16:19],a[208:211],v[112:115]
 buffer_load_dwordx4 v250,s[16:19],s44 offen offset:2048 lds
 ds_read_b64_tr_b16 v[40:41],v9 offset:12288
 v_mfma_f32_16x16x32_bf16 v[112:115],v[20:23],a[216:219],v[112:115]
 ds_read_b64_tr_b16 v[42:43],v9 offset:15360
 v_mfma_f32_16x16x32_bf16 v[116:119],v[20:23],a[220:223],v[116:119]
 ds_read_b64_tr_b16 v[44:45],v9 offset:18432
 v_mfma_f32_16x16x32_bf16 v[116:119],v[16:19],a[212:215],v[116:119]
 ds_read_b64_tr_b16 v[46:47],v9 offset:21504
 v_mfma_f32_16x16x32_bf16 v[228:231],v[16:19],v[224:227],v[228:231]
 v_mfma_f32_16x16x32_bf16 v[228:231],v[20:23],v[224:227],v[228:231]
 s_mov_b32 s0,12288
 s_waitcnt lgkmcnt(8)
 v_mfma_f32_16x16x32_bf16 v[120:123],v[24:27],a[208:211],v[120:123]
 buffer_load_dwordx2 v[160:161],v5,s[8:11],s0 offen sc1
 ds_read_b64_tr_b16 v[16:17],v10 offset:12288
 v_mfma_f32_16x16x32_bf16 v[120:123],v[28:31],a[216:219],v[120:123]
 ds_read_b64_tr_b16 v[18:19],v10 offset:15360
 v_mfma_f32_16x16x32_bf16 v[124:127],v[28:31],a[220:223],v[124:127]
 buffer_load_dwordx2 v[162:163],v5,s[8:11],s0 offen offset:512 sc1
 ds_read_b64_tr_b16 v[20:21],v10 offset:18432
 v_mfma_f32_16x16x32_bf16 v[124:127],v[24:27],a[212:215],v[124:127]
 ds_read_b64_tr_b16 v[22:23],v10 offset:21504
 v_mfma_f32_16x16x32_bf16 v[232:235],v[24:27],v[224:227],v[232:235]
 s_add_u32 m0,s35,125952
 s_add_u32 s44,s44,49152
 buffer_load_dwordx4 v248,s[16:19],s44 offen lds
 v_mfma_f32_16x16x32_bf16 v[232:235],v[28:31],v[224:227],v[232:235]
 s_waitcnt lgkmcnt(8)
 v_mfma_f32_16x16x32_bf16 v[128:131],v[32:35],a[208:211],v[128:131]
 ds_read_b64_tr_b16 v[24:25],v11 offset:12288
 v_and_b32 v12,3,v0
 v_mfma_f32_16x16x32_bf16 v[128:131],v[36:39],a[216:219],v[128:131]
 ds_read_b64_tr_b16 v[26:27],v11 offset:15360
 v_lshlrev_b32 v12,2,v12
 v_mfma_f32_16x16x32_bf16 v[132:135],v[36:39],a[220:223],v[132:135]
 ds_read_b64_tr_b16 v[28:29],v11 offset:18432
 v_mfma_f32_16x16x32_bf16 v[132:135],v[32:35],a[212:215],v[132:135]
 s_waitcnt lgkmcnt(7)
 ds_read_b64_tr_b16 v[30:31],v11 offset:21504
 v_mfma_f32_16x16x32_bf16 v[136:139],v[40:43],a[208:211],v[136:139]
 s_barrier
 v_add_u32 v6,49152,v6
 ds_read_b64_tr_b16 v[32:33],v6
 v_mfma_f32_16x16x32_bf16 v[136:139],v[44:47],a[216:219],v[136:139]
 buffer_load_dwordx4 v[168:171],v4,s[8:11],s0 offen offset:1024 sc1
 ds_read_b64_tr_b16 v[34:35],v6 offset:3072
 v_mfma_f32_16x16x32_bf16 v[140:143],v[44:47],a[220:223],v[140:143]
 ds_read_b64_tr_b16 v[36:37],v6 offset:6144
 v_mfma_f32_16x16x32_bf16 v[140:143],v[40:43],a[212:215],v[140:143]
 s_waitcnt lgkmcnt(7)
 ds_read_b64_tr_b16 v[38:39],v6 offset:9216
 v_mfma_f32_16x16x32_bf16 v[144:147],v[16:19],a[208:211],v[144:147]
 v_add_u32 v7,49152,v7
 ds_read_b64_tr_b16 v[40:41],v7
 v_mfma_f32_16x16x32_bf16 v[144:147],v[20:23],a[216:219],v[144:147]
 buffer_load_dwordx4 v249,s[16:19],s44 offen offset:1024 lds
 ds_read_b64_tr_b16 v[42:43],v7 offset:3072
 v_mfma_f32_16x16x32_bf16 v[148:151],v[20:23],a[220:223],v[148:151]
 ds_read_b64_tr_b16 v[44:45],v7 offset:6144
 v_mfma_f32_16x16x32_bf16 v[148:151],v[16:19],a[212:215],v[148:151]
 s_waitcnt lgkmcnt(7)
 ds_read_b64_tr_b16 v[46:47],v7 offset:9216
 v_mfma_f32_16x16x32_bf16 v[152:155],v[24:27],a[208:211],v[152:155]
 v_add_u32 v8,49152,v8
 ds_read_b64_tr_b16 v[16:17],v8
 v_mfma_f32_16x16x32_bf16 v[152:155],v[28:31],a[216:219],v[152:155]
 buffer_load_dwordx4 v[176:179],v4,s[8:11],s0 offen offset:2048 sc1
 ds_read_b64_tr_b16 v[18:19],v8 offset:3072
 v_mfma_f32_16x16x32_bf16 v[156:159],v[28:31],a[220:223],v[156:159]
 ds_read_b64_tr_b16 v[20:21],v8 offset:6144
 v_mfma_f32_16x16x32_bf16 v[156:159],v[24:27],a[212:215],v[156:159]
 s_waitcnt vmcnt(23) lgkmcnt(7)
 ds_read_b64_tr_b16 v[22:23],v8 offset:9216
 v_mfma_f32_16x16x32_bf16 v[112:115],v[32:35],a[224:227],v[112:115]
 v_add_u32 v9,49152,v9
 ds_read_b64_tr_b16 v[24:25],v9
 v_mfma_f32_16x16x32_bf16 v[112:115],v[36:39],a[232:235],v[112:115]
 ds_read_b64_tr_b16 v[26:27],v9 offset:3072
 v_mfma_f32_16x16x32_bf16 v[116:119],v[36:39],a[236:239],v[116:119]
 buffer_load_dwordx4 v250,s[16:19],s44 offen offset:2048 lds
 ds_read_b64_tr_b16 v[28:29],v9 offset:6144
 v_mfma_f32_16x16x32_bf16 v[116:119],v[32:35],a[228:231],v[116:119]
 ds_read_b64_tr_b16 v[30:31],v9 offset:9216
 v_mfma_f32_16x16x32_bf16 v[228:231],v[32:35],v[224:227],v[228:231]
 s_lshl_b32 s42,s34,7
 s_lshl_b32 s41,s52,4
 v_mfma_f32_16x16x32_bf16 v[228:231],v[36:39],v[224:227],v[228:231]
 s_waitcnt lgkmcnt(8)
 v_mfma_f32_16x16x32_bf16 v[120:123],v[40:43],a[224:227],v[120:123]
 v_add_u32 v10,49152,v10
 ds_read_b64_tr_b16 v[32:33],v10
 v_mfma_f32_16x16x32_bf16 v[120:123],v[44:47],a[232:235],v[120:123]
 ds_read_b64_tr_b16 v[34:35],v10 offset:3072
 v_mfma_f32_16x16x32_bf16 v[124:127],v[44:47],a[236:239],v[124:127]
 buffer_load_dwordx4 v[184:187],v4,s[8:11],s0 offen offset:3072 sc1
 ds_read_b64_tr_b16 v[36:37],v10 offset:6144
 v_mfma_f32_16x16x32_bf16 v[124:127],v[40:43],a[228:231],v[124:127]
 s_mov_b32 s0,32768
 ds_read_b64_tr_b16 v[38:39],v10 offset:9216
 v_mfma_f32_16x16x32_bf16 v[232:235],v[40:43],v[224:227],v[232:235]
 s_add_u32 s42,s42,s41
 s_add_u32 s42,s42,3072
 v_add_u32 v12,s42,v12
 v_mfma_f32_16x16x32_bf16 v[232:235],v[44:47],v[224:227],v[232:235]
 s_waitcnt lgkmcnt(8)
 s_and_b32 s60,s52,1
 s_lshl_b32 s42,s53,1
 v_mfma_f32_16x16x32_bf16 v[128:131],v[16:19],a[224:227],v[128:131]
 buffer_load_dwordx2 v[164:165],v5,s[8:11],s0 offen sc1
 v_add_u32 v11,49152,v11
 ds_read_b64_tr_b16 v[40:41],v11
 v_mfma_f32_16x16x32_bf16 v[128:131],v[20:23],a[232:235],v[128:131]
 ds_read_b64_tr_b16 v[42:43],v11 offset:3072
 s_add_u32 s60,s60,s42
 s_mul_i32 s41,s60,245760
 v_mfma_f32_16x16x32_bf16 v[132:135],v[20:23],a[236:239],v[132:135]
 ds_read_b64_tr_b16 v[44:45],v11 offset:6144
 s_add_u32 s41,s41,s55
 s_add_u32 s41,s41,6537216
 v_mfma_f32_16x16x32_bf16 v[132:135],v[16:19],a[228:231],v[132:135]
 s_waitcnt lgkmcnt(7)
 ds_read_b64_tr_b16 v[46:47],v11 offset:9216
 v_mfma_f32_16x16x32_bf16 v[136:139],v[24:27],a[224:227],v[136:139]
 buffer_load_dwordx2 v[166:167],v5,s[8:11],s0 offen offset:512 sc1
 s_add_u32 m0,s35,24576
 s_mov_b32 s44,1572864
 buffer_load_dwordx4 v248,s[16:19],s44 offen lds
 ds_read_b64_tr_b16 v[16:17],v6 offset:12288
 v_mfma_f32_16x16x32_bf16 v[136:139],v[28:31],a[232:235],v[136:139]
 ds_read_b64_tr_b16 v[18:19],v6 offset:15360
 v_mfma_f32_16x16x32_bf16 v[140:143],v[28:31],a[236:239],v[140:143]
 ds_read_b64_tr_b16 v[20:21],v6 offset:18432
 v_mfma_f32_16x16x32_bf16 v[140:143],v[24:27],a[228:231],v[140:143]
 s_waitcnt lgkmcnt(7)
 ds_read_b64_tr_b16 v[22:23],v6 offset:21504
 v_mfma_f32_16x16x32_bf16 v[144:147],v[32:35],a[224:227],v[144:147]
 ds_read_b64_tr_b16 v[24:25],v7 offset:12288
 v_mfma_f32_16x16x32_bf16 v[144:147],v[36:39],a[232:235],v[144:147]
 ds_read_b64_tr_b16 v[26:27],v7 offset:15360
 v_mfma_f32_16x16x32_bf16 v[148:151],v[36:39],a[236:239],v[148:151]
 buffer_load_dwordx4 v[172:175],v4,s[8:11],s0 offen offset:1024 sc1
 ds_read_b64_tr_b16 v[28:29],v7 offset:18432
 v_mfma_f32_16x16x32_bf16 v[148:151],v[32:35],a[228:231],v[148:151]
 s_waitcnt lgkmcnt(7)
 ds_read_b64_tr_b16 v[30:31],v7 offset:21504
 v_mfma_f32_16x16x32_bf16 v[152:155],v[40:43],a[224:227],v[152:155]
 ds_read_b64_tr_b16 v[32:33],v8 offset:12288
 v_mfma_f32_16x16x32_bf16 v[152:155],v[44:47],a[232:235],v[152:155]
 ds_read_b64_tr_b16 v[34:35],v8 offset:15360
 v_mfma_f32_16x16x32_bf16 v[156:159],v[44:47],a[236:239],v[156:159]
 ds_read_b64_tr_b16 v[36:37],v8 offset:18432
 v_mfma_f32_16x16x32_bf16 v[156:159],v[40:43],a[228:231],v[156:159]
 s_waitcnt lgkmcnt(7)
 ds_read_b64_tr_b16 v[38:39],v8 offset:21504
 v_mfma_f32_16x16x32_bf16 v[112:115],v[16:19],a[240:243],v[112:115]
 buffer_load_dwordx4 v[180:183],v4,s[8:11],s0 offen offset:2048 sc1
 ds_read_b64_tr_b16 v[40:41],v9 offset:12288
 v_mfma_f32_16x16x32_bf16 v[112:115],v[20:23],a[248:251],v[112:115]
 ds_read_b64_tr_b16 v[42:43],v9 offset:15360
 v_mfma_f32_16x16x32_bf16 v[116:119],v[20:23],a[252:255],v[116:119]
 ds_read_b64_tr_b16 v[44:45],v9 offset:18432
 v_mfma_f32_16x16x32_bf16 v[116:119],v[16:19],a[244:247],v[116:119]
 buffer_load_dwordx4 v[188:191],v4,s[8:11],s0 offen offset:3072 sc1
 ds_read_b64_tr_b16 v[46:47],v9 offset:21504
 v_mfma_f32_16x16x32_bf16 v[228:231],v[16:19],v[224:227],v[228:231]
 s_add_u32 s24,s88,s41
 s_addc_u32 s25,s89,0
 v_mfma_f32_16x16x32_bf16 v[228:231],v[20:23],v[224:227],v[228:231]
 s_waitcnt lgkmcnt(8)
 s_sub_u32 s26,245760,s55
 s_mov_b32 s27,0x20000
 v_mfma_f32_16x16x32_bf16 v[120:123],v[24:27],a[240:243],v[120:123]
 ds_read_b64_tr_b16 v[16:17],v10 offset:12288
 v_mfma_f32_16x16x32_bf16 v[120:123],v[28:31],a[248:251],v[120:123]
 ds_read_b64_tr_b16 v[18:19],v10 offset:15360
 v_mfma_f32_16x16x32_bf16 v[124:127],v[28:31],a[252:255],v[124:127]
 buffer_load_dwordx4 v249,s[16:19],s44 offen offset:1024 lds
 ds_read_b64_tr_b16 v[20:21],v10 offset:18432
 v_mfma_f32_16x16x32_bf16 v[124:127],v[24:27],a[244:247],v[124:127]
 ds_read_b64_tr_b16 v[22:23],v10 offset:21504
 v_mfma_f32_16x16x32_bf16 v[232:235],v[24:27],v[224:227],v[232:235]
 s_mul_i32 s63,s34,3
 s_lshr_b32 s63,s63,1
 v_mfma_f32_16x16x32_bf16 v[232:235],v[28:31],v[224:227],v[232:235]
 s_waitcnt lgkmcnt(8)
 s_mul_i32 s41,s53,3
 s_add_u32 s63,s63,s41
 v_mfma_f32_16x16x32_bf16 v[128:131],v[32:35],a[240:243],v[128:131]
 ds_read_b64_tr_b16 v[24:25],v11 offset:12288
 v_mfma_f32_16x16x32_bf16 v[128:131],v[36:39],a[248:251],v[128:131]
 ds_read_b64_tr_b16 v[26:27],v11 offset:15360
 v_mfma_f32_16x16x32_bf16 v[132:135],v[36:39],a[252:255],v[132:135]
 buffer_load_dwordx4 v250,s[16:19],s44 offen offset:2048 lds
 ds_read_b64_tr_b16 v[28:29],v11 offset:18432
 v_mfma_f32_16x16x32_bf16 v[132:135],v[32:35],a[244:247],v[132:135]
 s_mov_b32 s0,16384
 s_waitcnt lgkmcnt(7)
 ds_read_b64_tr_b16 v[30:31],v11 offset:21504
 v_mfma_f32_16x16x32_bf16 v[136:139],v[40:43],a[240:243],v[136:139]
 s_waitcnt vmcnt(24)
 s_barrier
 v_add_u32 v6,4294868992,v6
 ds_read_b64_tr_b16 v[32:33],v6
 v_mfma_f32_16x16x32_bf16 v[136:139],v[44:47],a[248:251],v[136:139]
 buffer_load_dwordx4 v[192:195],v4,s[8:11],s0 offen sc1
 ds_read_b64_tr_b16 v[34:35],v6 offset:3072
 v_mfma_f32_16x16x32_bf16 v[140:143],v[44:47],a[252:255],v[140:143]
 ds_read_b64_tr_b16 v[36:37],v6 offset:6144
 v_mfma_f32_16x16x32_bf16 v[140:143],v[40:43],a[244:247],v[140:143]
 s_waitcnt lgkmcnt(7)
 ds_read_b64_tr_b16 v[38:39],v6 offset:9216
 s_cmp_lg_u32 s32,0
 s_cbranch_scc1 Lf33
 v_mov_b32 v14,s51
 s_mov_b64 exec,1
 s_add_u32 s91,s90,3072
 buffer_store_dword v14,off,s[92:95],s91 sc1
 s_mov_b64 exec,-1
Lf33:
 v_mfma_f32_16x16x32_bf16 v[144:147],v[16:19],a[240:243],v[144:147]
 s_add_u32 m0,s35,27648
 s_add_u32 s44,s44,49152
 buffer_load_dwordx4 v248,s[16:19],s44 offen lds
 v_add_u32 v7,4294868992,v7
 ds_read_b64_tr_b16 v[40:41],v7
 v_mfma_f32_16x16x32_bf16 v[144:147],v[20:23],a[248:251],v[144:147]
 ds_read_b64_tr_b16 v[42:43],v7 offset:3072
 v_mfma_f32_16x16x32_bf16 v[148:151],v[20:23],a[252:255],v[148:151]
 ds_read_b64_tr_b16 v[44:45],v7 offset:6144
 v_mfma_f32_16x16x32_bf16 v[148:151],v[16:19],a[244:247],v[148:151]
 s_waitcnt lgkmcnt(7)
 ds_read_b64_tr_b16 v[46:47],v7 offset:9216
 v_mfma_f32_16x16x32_bf16 v[152:155],v[24:27],a[240:243],v[152:155]
 v_add_u32 v8,4294868992,v8
 ds_read_b64_tr_b16 v[16:17],v8
 v_mfma_f32_16x16x32_bf16 v[152:155],v[28:31],a[248:251],v[152:155]
 ds_read_b64_tr_b16 v[18:19],v8 offset:3072
 v_mfma_f32_16x16x32_bf16 v[156:159],v[28:31],a[252:255],v[156:159]
 buffer_load_dwordx2 v[200:201],v5,s[8:11],s0 offen offset:1024 sc1
 ds_read_b64_tr_b16 v[20:21],v8 offset:6144
 v_mfma_f32_16x16x32_bf16 v[156:159],v[24:27],a[244:247],v[156:159]
 s_waitcnt vmcnt(22) lgkmcnt(7)
 ds_read_b64_tr_b16 v[22:23],v8 offset:9216
 v_mfma_f32_16x16x32_bf16 v[112:115],v[32:35],a[160:163],v[112:115]
 v_add_u32 v9,4294868992,v9
 ds_read_b64_tr_b16 v[24:25],v9
 v_mfma_f32_16x16x32_bf16 v[112:115],v[36:39],a[168:171],v[112:115]
 buffer_load_dwordx2 v[202:203],v5,s[8:11],s0 offen offset:1536 sc1
 ds_read_b64_tr_b16 v[26:27],v9 offset:3072
 v_mfma_f32_16x16x32_bf16 v[116:119],v[36:39],a[172:175],v[116:119]
 ds_read_b64_tr_b16 v[28:29],v9 offset:6144
 v_mfma_f32_16x16x32_bf16 v[116:119],v[32:35],a[164:167],v[116:119]
 buffer_load_dwordx4 v249,s[16:19],s44 offen offset:1024 lds
 ds_read_b64_tr_b16 v[30:31],v9 offset:9216
 v_mfma_f32_16x16x32_bf16 v[228:231],v[32:35],v[224:227],v[228:231]
 s_cmp_ge_u32 s63,12
 s_cselect_b32 s41,12,0
 s_sub_u32 s63,s63,s41
 v_mfma_f32_16x16x32_bf16 v[228:231],v[36:39],v[224:227],v[228:231]
 s_waitcnt lgkmcnt(8)
 s_lshl_b32 s76,s63,12
 s_mul_i32 s63,s63,20480
 v_mfma_f32_16x16x32_bf16 v[120:123],v[40:43],a[160:163],v[120:123]
 v_add_u32 v10,4294868992,v10
 ds_read_b64_tr_b16 v[32:33],v10
 v_mfma_f32_16x16x32_bf16 v[120:123],v[44:47],a[168:171],v[120:123]
 ds_read_b64_tr_b16 v[34:35],v10 offset:3072
 v_mfma_f32_16x16x32_bf16 v[124:127],v[44:47],a[172:175],v[124:127]
 ds_read_b64_tr_b16 v[36:37],v10 offset:6144
 v_mfma_f32_16x16x32_bf16 v[124:127],v[40:43],a[164:167],v[124:127]
 buffer_load_dwordx4 v[208:211],v4,s[8:11],s0 offen offset:2048 sc1
 ds_read_b64_tr_b16 v[38:39],v10 offset:9216
 v_mfma_f32_16x16x32_bf16 v[232:235],v[40:43],v[224:227],v[232:235]
 s_lshl_b32 s71,s34,2
 s_lshr_b32 s41,s52,1
 s_add_u32 s71,s71,s41
 v_mfma_f32_16x16x32_bf16 v[232:235],v[44:47],v[224:227],v[232:235]
 s_waitcnt lgkmcnt(8)
 v_mfma_f32_16x16x32_bf16 v[128:131],v[16:19],a[160:163],v[128:131]
 v_add_u32 v11,4294868992,v11
 ds_read_b64_tr_b16 v[40:41],v11
 v_mfma_f32_16x16x32_bf16 v[128:131],v[20:23],a[168:171],v[128:131]
 buffer_load_dwordx4 v250,s[16:19],s44 offen offset:2048 lds
 ds_read_b64_tr_b16 v[42:43],v11 offset:3072
 v_mfma_f32_16x16x32_bf16 v[132:135],v[20:23],a[172:175],v[132:135]
 ds_read_b64_tr_b16 v[44:45],v11 offset:6144
 v_mfma_f32_16x16x32_bf16 v[132:135],v[16:19],a[164:167],v[132:135]
 s_waitcnt lgkmcnt(7)
 ds_read_b64_tr_b16 v[46:47],v11 offset:9216
 v_mfma_f32_16x16x32_bf16 v[136:139],v[24:27],a[160:163],v[136:139]
 ds_read_b64_tr_b16 v[16:17],v6 offset:12288
 v_mfma_f32_16x16x32_bf16 v[136:139],v[28:31],a[168:171],v[136:139]
 ds_read_b64_tr_b16 v[18:19],v6 offset:15360
 v_mfma_f32_16x16x32_bf16 v[140:143],v[28:31],a[172:175],v[140:143]
 ds_read_b64_tr_b16 v[20:21],v6 offset:18432
 v_mfma_f32_16x16x32_bf16 v[140:143],v[24:27],a[164:167],v[140:143]
 s_waitcnt lgkmcnt(7)
 ds_read_b64_tr_b16 v[22:23],v6 offset:21504
 v_mfma_f32_16x16x32_bf16 v[144:147],v[32:35],a[160:163],v[144:147]
 buffer_load_dwordx4 v[216:219],v4,s[8:11],s0 offen offset:3072 sc1
 ds_read_b64_tr_b16 v[24:25],v7 offset:12288
 v_mfma_f32_16x16x32_bf16 v[144:147],v[36:39],a[168:171],v[144:147]
 ds_read_b64_tr_b16 v[26:27],v7 offset:15360
 v_mfma_f32_16x16x32_bf16 v[148:151],v[36:39],a[172:175],v[148:151]
 ds_read_b64_tr_b16 v[28:29],v7 offset:18432
 v_mfma_f32_16x16x32_bf16 v[148:151],v[32:35],a[164:167],v[148:151]
 s_mov_b32 s0,36864
 s_waitcnt lgkmcnt(7)
 ds_read_b64_tr_b16 v[30:31],v7 offset:21504
 v_mfma_f32_16x16x32_bf16 v[152:155],v[40:43],a[160:163],v[152:155]
 buffer_load_dwordx4 v[196:199],v4,s[8:11],s0 offen sc1
 ds_read_b64_tr_b16 v[32:33],v8 offset:12288
 v_mfma_f32_16x16x32_bf16 v[152:155],v[44:47],a[168:171],v[152:155]
 ds_read_b64_tr_b16 v[34:35],v8 offset:15360
 v_mfma_f32_16x16x32_bf16 v[156:159],v[44:47],a[172:175],v[156:159]
 ds_read_b64_tr_b16 v[36:37],v8 offset:18432
 v_mfma_f32_16x16x32_bf16 v[156:159],v[40:43],a[164:167],v[156:159]
 s_waitcnt lgkmcnt(7)
 ds_read_b64_tr_b16 v[38:39],v8 offset:21504
 v_mfma_f32_16x16x32_bf16 v[112:115],v[16:19],a[176:179],v[112:115]
 buffer_load_dwordx2 v[204:205],v5,s[8:11],s0 offen offset:1024 sc1
 ds_read_b64_tr_b16 v[40:41],v9 offset:12288
 v_mfma_f32_16x16x32_bf16 v[112:115],v[20:23],a[184:187],v[112:115]
 ds_read_b64_tr_b16 v[42:43],v9 offset:15360
 v_mfma_f32_16x16x32_bf16 v[116:119],v[20:23],a[188:191],v[116:119]
 ds_read_b64_tr_b16 v[44:45],v9 offset:18432
 v_mfma_f32_16x16x32_bf16 v[116:119],v[16:19],a[180:183],v[116:119]
 buffer_load_dwordx2 v[206:207],v5,s[8:11],s0 offen offset:1536 sc1
 ds_read_b64_tr_b16 v[46:47],v9 offset:21504
 v_mfma_f32_16x16x32_bf16 v[228:231],v[16:19],v[224:227],v[228:231]
 s_lshl_b32 s71,s71,2
 s_mul_i32 s36,s71,48
 s_add_u32 s71,s71,s32
 v_mfma_f32_16x16x32_bf16 v[228:231],v[20:23],v[224:227],v[228:231]
 buffer_load_dwordx4 v[212:215],v4,s[8:11],s0 offen offset:2048 sc1
 s_waitcnt lgkmcnt(8)
 v_mfma_f32_16x16x32_bf16 v[120:123],v[24:27],a[176:179],v[120:123]
 ds_read_b64_tr_b16 v[16:17],v10 offset:12288
 v_mfma_f32_16x16x32_bf16 v[120:123],v[28:31],a[184:187],v[120:123]
 ds_read_b64_tr_b16 v[18:19],v10 offset:15360
 v_mfma_f32_16x16x32_bf16 v[124:127],v[28:31],a[188:191],v[124:127]
 ds_read_b64_tr_b16 v[20:21],v10 offset:18432
 v_mfma_f32_16x16x32_bf16 v[124:127],v[24:27],a[180:183],v[124:127]
 buffer_load_dwordx4 v[220:223],v4,s[8:11],s0 offen offset:3072 sc1
 ds_read_b64_tr_b16 v[22:23],v10 offset:21504
 v_mfma_f32_16x16x32_bf16 v[232:235],v[24:27],v[224:227],v[232:235]
 s_add_u32 s36,s36,s32
 s_lshl_b32 s36,s36,10
 s_add_u32 s36,s36,8503296
 v_mfma_f32_16x16x32_bf16 v[232:235],v[28:31],v[224:227],v[232:235]
 s_waitcnt lgkmcnt(8)
 s_lshl_b32 s38,s34,2
 s_add_u32 s38,s38,s53
 v_mfma_f32_16x16x32_bf16 v[128:131],v[32:35],a[176:179],v[128:131]
 ds_read_b64_tr_b16 v[24:25],v11 offset:12288
 v_mfma_f32_16x16x32_bf16 v[128:131],v[36:39],a[184:187],v[128:131]
 ds_read_b64_tr_b16 v[26:27],v11 offset:15360
 v_mfma_f32_16x16x32_bf16 v[132:135],v[36:39],a[188:191],v[132:135]
 s_add_u32 m0,s35,73728
 s_mov_b32 s44,192
 buffer_load_dwordx4 v248,s[16:19],s44 offen lds
 ds_read_b64_tr_b16 v[28:29],v11 offset:18432
 v_mfma_f32_16x16x32_bf16 v[132:135],v[32:35],a[180:183],v[132:135]
 s_waitcnt lgkmcnt(7)
 ds_read_b64_tr_b16 v[30:31],v11 offset:21504
 v_mfma_f32_16x16x32_bf16 v[136:139],v[40:43],a[176:179],v[136:139]
 s_waitcnt vmcnt(23)
 s_barrier
 v_add_u32 v6,122880,v6
 ds_read_b64_tr_b16 v[32:33],v6
 v_mfma_f32_16x16x32_bf16 v[136:139],v[44:47],a[184:187],v[136:139]
 ds_read_b64_tr_b16 v[34:35],v6 offset:3072
 v_mfma_f32_16x16x32_bf16 v[140:143],v[44:47],a[188:191],v[140:143]
 buffer_load_dwordx4 v249,s[16:19],s44 offen offset:1024 lds
 ds_read_b64_tr_b16 v[36:37],v6 offset:6144
 v_mfma_f32_16x16x32_bf16 v[140:143],v[40:43],a[180:183],v[140:143]
 s_waitcnt lgkmcnt(7)
 ds_read_b64_tr_b16 v[38:39],v6 offset:9216
 v_mfma_f32_16x16x32_bf16 v[144:147],v[16:19],a[176:179],v[144:147]
 v_add_u32 v7,122880,v7
 ds_read_b64_tr_b16 v[40:41],v7
 v_mfma_f32_16x16x32_bf16 v[144:147],v[20:23],a[184:187],v[144:147]
 ds_read_b64_tr_b16 v[42:43],v7 offset:3072
 v_mfma_f32_16x16x32_bf16 v[148:151],v[20:23],a[188:191],v[148:151]
 ds_read_b64_tr_b16 v[44:45],v7 offset:6144
 v_mfma_f32_16x16x32_bf16 v[148:151],v[16:19],a[180:183],v[148:151]
 s_waitcnt lgkmcnt(7)
 ds_read_b64_tr_b16 v[46:47],v7 offset:9216
 v_mfma_f32_16x16x32_bf16 v[152:155],v[24:27],a[176:179],v[152:155]
 v_add_u32 v8,122880,v8
 ds_read_b64_tr_b16 v[16:17],v8
 v_mfma_f32_16x16x32_bf16 v[152:155],v[28:31],a[184:187],v[152:155]
 buffer_load_dwordx4 v250,s[16:19],s44 offen offset:2048 lds
 ds_read_b64_tr_b16 v[18:19],v8 offset:3072
 v_mfma_f32_16x16x32_bf16 v[156:159],v[28:31],a[188:191],v[156:159]
 ds_read_b64_tr_b16 v[20:21],v8 offset:6144
 v_mfma_f32_16x16x32_bf16 v[156:159],v[24:27],a[180:183],v[156:159]
 s_waitcnt vmcnt(18) lgkmcnt(7)
 ds_read_b64_tr_b16 v[22:23],v8 offset:9216
 v_mfma_f32_16x16x32_bf16 v[112:115],v[32:35],v[160:163],v[112:115]
 v_add_u32 v9,122880,v9
 ds_read_b64_tr_b16 v[24:25],v9
 v_mfma_f32_16x16x32_bf16 v[112:115],v[36:39],v[168:171],v[112:115]
 ds_read_b64_tr_b16 v[26:27],v9 offset:3072
 v_mfma_f32_16x16x32_bf16 v[116:119],v[36:39],v[172:175],v[116:119]
 s_add_u32 m0,s35,76800
 s_add_u32 s44,s44,49152
 buffer_load_dwordx4 v248,s[16:19],s44 offen lds
 ds_read_b64_tr_b16 v[28:29],v9 offset:6144
 v_mfma_f32_16x16x32_bf16 v[116:119],v[32:35],v[164:167],v[116:119]
 ds_read_b64_tr_b16 v[30:31],v9 offset:9216
 v_mfma_f32_16x16x32_bf16 v[228:231],v[32:35],v[224:227],v[228:231]
 s_lshl_b32 s38,s38,3
 s_lshl_b32 s41,s32,1
 s_add_u32 s41,s41,s38
 v_mfma_f32_16x16x32_bf16 v[228:231],v[36:39],v[224:227],v[228:231]
 s_waitcnt lgkmcnt(8)
 v_mfma_f32_16x16x32_bf16 v[120:123],v[40:43],v[160:163],v[120:123]
 s_lshl_b32 s1,s54,10
 v_add_u32 v10,122880,v10
 ds_read_b64_tr_b16 v[32:33],v10
 v_mfma_f32_16x16x32_bf16 v[120:123],v[44:47],v[168:171],v[120:123]
 s_add_u32 s1,s1,5242880
 ds_read_b64_tr_b16 v[34:35],v10 offset:3072
 v_mfma_f32_16x16x32_bf16 v[124:127],v[44:47],v[172:175],v[124:127]
 buffer_load_dwordx2 v[240:241],v5,s[28:31],s1 offen sc1
 ds_read_b64_tr_b16 v[36:37],v10 offset:6144
 v_mfma_f32_16x16x32_bf16 v[124:127],v[40:43],v[164:167],v[124:127]
 ds_read_b64_tr_b16 v[38:39],v10 offset:9216
 v_mfma_f32_16x16x32_bf16 v[232:235],v[40:43],v[224:227],v[232:235]
 s_lshl_b32 s41,s41,3
 s_add_u32 s41,s41,s52
 s_mul_i32 s37,s41,10240
 v_mfma_f32_16x16x32_bf16 v[232:235],v[44:47],v[224:227],v[232:235]
 s_waitcnt lgkmcnt(8)
 s_add_u32 s37,s37,39960576
 v_mfma_f32_16x16x32_bf16 v[128:131],v[16:19],v[160:163],v[128:131]
 v_add_u32 v11,122880,v11
 ds_read_b64_tr_b16 v[40:41],v11
 v_mfma_f32_16x16x32_bf16 v[128:131],v[20:23],v[168:171],v[128:131]
 buffer_load_dwordx2 v[242:243],v5,s[28:31],s1 offen offset:512 sc1
 ds_read_b64_tr_b16 v[42:43],v11 offset:3072
 v_mfma_f32_16x16x32_bf16 v[132:135],v[20:23],v[172:175],v[132:135]
 buffer_load_dwordx4 v249,s[16:19],s44 offen offset:1024 lds
 ds_read_b64_tr_b16 v[44:45],v11 offset:6144
 v_mfma_f32_16x16x32_bf16 v[132:135],v[16:19],v[164:167],v[132:135]
 s_waitcnt lgkmcnt(7)
 ds_read_b64_tr_b16 v[46:47],v11 offset:9216
 v_mfma_f32_16x16x32_bf16 v[136:139],v[24:27],v[160:163],v[136:139]
 ds_read_b64_tr_b16 v[16:17],v6 offset:12288
 v_mfma_f32_16x16x32_bf16 v[136:139],v[28:31],v[168:171],v[136:139]
 ds_read_b64_tr_b16 v[18:19],v6 offset:15360
 v_mfma_f32_16x16x32_bf16 v[140:143],v[28:31],v[172:175],v[140:143]
 buffer_load_dwordx2 v[244:245],v5,s[28:31],s1 offen offset:1024 sc1
 ds_read_b64_tr_b16 v[20:21],v6 offset:18432
 v_mfma_f32_16x16x32_bf16 v[140:143],v[24:27],v[164:167],v[140:143]
 s_waitcnt lgkmcnt(7)
 ds_read_b64_tr_b16 v[22:23],v6 offset:21504
 v_mfma_f32_16x16x32_bf16 v[144:147],v[32:35],v[160:163],v[144:147]
 ds_read_b64_tr_b16 v[24:25],v7 offset:12288
 v_mfma_f32_16x16x32_bf16 v[144:147],v[36:39],v[168:171],v[144:147]
 buffer_load_dwordx2 v[246:247],v5,s[28:31],s1 offen offset:1536 sc1
 ds_read_b64_tr_b16 v[26:27],v7 offset:15360
 v_mfma_f32_16x16x32_bf16 v[148:151],v[36:39],v[172:175],v[148:151]
 ds_read_b64_tr_b16 v[28:29],v7 offset:18432
 v_mfma_f32_16x16x32_bf16 v[148:151],v[32:35],v[164:167],v[148:151]
 s_waitcnt lgkmcnt(7)
 ds_read_b64_tr_b16 v[30:31],v7 offset:21504
 v_mfma_f32_16x16x32_bf16 v[152:155],v[40:43],v[160:163],v[152:155]
 buffer_load_dwordx4 v250,s[16:19],s44 offen offset:2048 lds
 ds_read_b64_tr_b16 v[32:33],v8 offset:12288
 v_mfma_f32_16x16x32_bf16 v[152:155],v[44:47],v[168:171],v[152:155]
 ds_read_b64_tr_b16 v[34:35],v8 offset:15360
 v_mfma_f32_16x16x32_bf16 v[156:159],v[44:47],v[172:175],v[156:159]
 ds_read_b64_tr_b16 v[36:37],v8 offset:18432
 v_mfma_f32_16x16x32_bf16 v[156:159],v[40:43],v[164:167],v[156:159]
 s_waitcnt lgkmcnt(7)
 ds_read_b64_tr_b16 v[38:39],v8 offset:21504
 v_mfma_f32_16x16x32_bf16 v[112:115],v[16:19],v[176:179],v[112:115]
 ds_read_b64_tr_b16 v[40:41],v9 offset:12288
 v_mfma_f32_16x16x32_bf16 v[112:115],v[20:23],v[184:187],v[112:115]
 s_add_u32 m0,s35,49152
 s_mov_b32 s44,393408
 buffer_load_dwordx4 v248,s[16:19],s44 offen lds
 ds_read_b64_tr_b16 v[42:43],v9 offset:15360
 v_mfma_f32_16x16x32_bf16 v[116:119],v[20:23],v[188:191],v[116:119]
 ds_read_b64_tr_b16 v[44:45],v9 offset:18432
 v_mfma_f32_16x16x32_bf16 v[116:119],v[16:19],v[180:183],v[116:119]
 ds_read_b64_tr_b16 v[46:47],v9 offset:21504
 v_mfma_f32_16x16x32_bf16 v[228:231],v[16:19],v[224:227],v[228:231]
 s_add_u32 s72,s32,0
 s_and_b32 s72,s72,3
 v_mfma_f32_16x16x32_bf16 v[228:231],v[20:23],v[224:227],v[228:231]
 s_waitcnt lgkmcnt(8)
 s_mul_i32 s72,s72,49152
 s_add_u32 s72,s72,s36
 v_mfma_f32_16x16x32_bf16 v[120:123],v[24:27],v[176:179],v[120:123]
 ds_read_b64_tr_b16 v[16:17],v10 offset:12288
 v_mfma_f32_16x16x32_bf16 v[120:123],v[28:31],v[184:187],v[120:123]
 buffer_load_dwordx4 v249,s[16:19],s44 offen offset:1024 lds
 ds_read_b64_tr_b16 v[18:19],v10 offset:15360
 v_mfma_f32_16x16x32_bf16 v[124:127],v[28:31],v[188:191],v[124:127]
 ds_read_b64_tr_b16 v[20:21],v10 offset:18432
 v_mfma_f32_16x16x32_bf16 v[124:127],v[24:27],v[180:183],v[124:127]
 ds_read_b64_tr_b16 v[22:23],v10 offset:21504
 v_mfma_f32_16x16x32_bf16 v[232:235],v[24:27],v[224:227],v[232:235]
 s_add_u32 s73,s32,1
 s_and_b32 s73,s73,3
 v_mfma_f32_16x16x32_bf16 v[232:235],v[28:31],v[224:227],v[232:235]
 s_waitcnt lgkmcnt(8)
 s_mul_i32 s73,s73,49152
 s_add_u32 s73,s73,s36
 v_mfma_f32_16x16x32_bf16 v[128:131],v[32:35],v[176:179],v[128:131]
 ds_read_b64_tr_b16 v[24:25],v11 offset:12288
 v_mfma_f32_16x16x32_bf16 v[128:131],v[36:39],v[184:187],v[128:131]
 buffer_load_dwordx4 v250,s[16:19],s44 offen offset:2048 lds
 ds_read_b64_tr_b16 v[26:27],v11 offset:15360
 v_mfma_f32_16x16x32_bf16 v[132:135],v[36:39],v[188:191],v[132:135]
 ds_read_b64_tr_b16 v[28:29],v11 offset:18432
 v_mfma_f32_16x16x32_bf16 v[132:135],v[32:35],v[180:183],v[132:135]
 s_waitcnt lgkmcnt(7)
 ds_read_b64_tr_b16 v[30:31],v11 offset:21504
 v_mfma_f32_16x16x32_bf16 v[136:139],v[40:43],v[176:179],v[136:139]
 s_waitcnt vmcnt(19)
 s_barrier
 v_add_u32 v6,4294868992,v6
 ds_read_b64_tr_b16 v[32:33],v6
 v_mfma_f32_16x16x32_bf16 v[136:139],v[44:47],v[184:187],v[136:139]
 s_add_u32 m0,s35,52224
 s_add_u32 s44,s44,49152
 buffer_load_dwordx4 v248,s[16:19],s44 offen lds
 ds_read_b64_tr_b16 v[34:35],v6 offset:3072
 v_mfma_f32_16x16x32_bf16 v[140:143],v[44:47],v[188:191],v[140:143]
 ds_read_b64_tr_b16 v[36:37],v6 offset:6144
 v_mfma_f32_16x16x32_bf16 v[140:143],v[40:43],v[180:183],v[140:143]
 s_waitcnt lgkmcnt(7)
 ds_read_b64_tr_b16 v[38:39],v6 offset:9216
 v_mfma_f32_16x16x32_bf16 v[144:147],v[16:19],v[176:179],v[144:147]
 v_add_u32 v7,4294868992,v7
 ds_read_b64_tr_b16 v[40:41],v7
 v_mfma_f32_16x16x32_bf16 v[144:147],v[20:23],v[184:187],v[144:147]
 ds_read_b64_tr_b16 v[42:43],v7 offset:3072
 v_mfma_f32_16x16x32_bf16 v[148:151],v[20:23],v[188:191],v[148:151]
 ds_read_b64_tr_b16 v[44:45],v7 offset:6144
 v_mfma_f32_16x16x32_bf16 v[148:151],v[16:19],v[180:183],v[148:151]
 s_waitcnt lgkmcnt(7)
 ds_read_b64_tr_b16 v[46:47],v7 offset:9216
 v_mfma_f32_16x16x32_bf16 v[152:155],v[24:27],v[176:179],v[152:155]
 v_add_u32 v8,4294868992,v8
 ds_read_b64_tr_b16 v[16:17],v8
 v_mfma_f32_16x16x32_bf16 v[152:155],v[28:31],v[184:187],v[152:155]
 buffer_load_dwordx4 v249,s[16:19],s44 offen offset:1024 lds
 ds_read_b64_tr_b16 v[18:19],v8 offset:3072
 v_mfma_f32_16x16x32_bf16 v[156:159],v[28:31],v[188:191],v[156:159]
 ds_read_b64_tr_b16 v[20:21],v8 offset:6144
 v_mfma_f32_16x16x32_bf16 v[156:159],v[24:27],v[180:183],v[156:159]
 s_waitcnt vmcnt(15) lgkmcnt(7)
 ds_read_b64_tr_b16 v[22:23],v8 offset:9216
 v_mfma_f32_16x16x32_bf16 v[112:115],v[32:35],v[192:195],v[112:115]
 v_add_u32 v9,4294868992,v9
 ds_read_b64_tr_b16 v[24:25],v9
 v_mfma_f32_16x16x32_bf16 v[112:115],v[36:39],v[200:203],v[112:115]
 buffer_load_dwordx4 v250,s[16:19],s44 offen offset:2048 lds
 ds_read_b64_tr_b16 v[26:27],v9 offset:3072
 v_mfma_f32_16x16x32_bf16 v[116:119],v[36:39],v[204:207],v[116:119]
 ds_read_b64_tr_b16 v[28:29],v9 offset:6144
 v_mfma_f32_16x16x32_bf16 v[116:119],v[32:35],v[196:199],v[116:119]
 ds_read_b64_tr_b16 v[30:31],v9 offset:9216
 v_mfma_f32_16x16x32_bf16 v[228:231],v[32:35],v[224:227],v[228:231]
 s_add_u32 s78,s32,2
 s_and_b32 s78,s78,3
 v_mfma_f32_16x16x32_bf16 v[228:231],v[36:39],v[224:227],v[228:231]
 s_waitcnt lgkmcnt(8)
 s_mul_i32 s78,s78,49152
 s_add_u32 s78,s78,s36
 v_mfma_f32_16x16x32_bf16 v[120:123],v[40:43],v[192:195],v[120:123]
 v_add_u32 v10,4294868992,v10
 ds_read_b64_tr_b16 v[32:33],v10
 v_mfma_f32_16x16x32_bf16 v[120:123],v[44:47],v[200:203],v[120:123]
 s_add_u32 m0,s35,98304
 s_mov_b32 s44,786624
 buffer_load_dwordx4 v248,s[16:19],s44 offen lds
 ds_read_b64_tr_b16 v[34:35],v10 offset:3072
 v_mfma_f32_16x16x32_bf16 v[124:127],v[44:47],v[204:207],v[124:127]
 ds_read_b64_tr_b16 v[36:37],v10 offset:6144
 v_mfma_f32_16x16x32_bf16 v[124:127],v[40:43],v[196:199],v[124:127]
 ds_read_b64_tr_b16 v[38:39],v10 offset:9216
 v_mfma_f32_16x16x32_bf16 v[232:235],v[40:43],v[224:227],v[232:235]
 s_add_u32 s79,s32,3
 s_and_b32 s79,s79,3
 v_mfma_f32_16x16x32_bf16 v[232:235],v[44:47],v[224:227],v[232:235]
 s_waitcnt lgkmcnt(8)
 s_mul_i32 s79,s79,49152
 s_add_u32 s79,s79,s36
 v_mfma_f32_16x16x32_bf16 v[128:131],v[16:19],v[192:195],v[128:131]
 v_add_u32 v11,4294868992,v11
 ds_read_b64_tr_b16 v[40:41],v11
 v_mfma_f32_16x16x32_bf16 v[128:131],v[20:23],v[200:203],v[128:131]
 buffer_load_dwordx4 v249,s[16:19],s44 offen offset:1024 lds
 ds_read_b64_tr_b16 v[42:43],v11 offset:3072
 v_mfma_f32_16x16x32_bf16 v[132:135],v[20:23],v[204:207],v[132:135]
 ds_read_b64_tr_b16 v[44:45],v11 offset:6144
 v_mfma_f32_16x16x32_bf16 v[132:135],v[16:19],v[196:199],v[132:135]
 s_waitcnt lgkmcnt(7)
 ds_read_b64_tr_b16 v[46:47],v11 offset:9216
 v_mfma_f32_16x16x32_bf16 v[136:139],v[24:27],v[192:195],v[136:139]
 ds_read_b64_tr_b16 v[16:17],v6 offset:12288
 v_mfma_f32_16x16x32_bf16 v[136:139],v[28:31],v[200:203],v[136:139]
 ds_read_b64_tr_b16 v[18:19],v6 offset:15360
 v_mfma_f32_16x16x32_bf16 v[140:143],v[28:31],v[204:207],v[140:143]
 ds_read_b64_tr_b16 v[20:21],v6 offset:18432
 v_mfma_f32_16x16x32_bf16 v[140:143],v[24:27],v[196:199],v[140:143]
 s_waitcnt lgkmcnt(7)
 ds_read_b64_tr_b16 v[22:23],v6 offset:21504
 v_mfma_f32_16x16x32_bf16 v[144:147],v[32:35],v[192:195],v[144:147]
 buffer_load_dwordx4 v250,s[16:19],s44 offen offset:2048 lds
 ds_read_b64_tr_b16 v[24:25],v7 offset:12288
 v_mfma_f32_16x16x32_bf16 v[144:147],v[36:39],v[200:203],v[144:147]
 ds_read_b64_tr_b16 v[26:27],v7 offset:15360
 v_mfma_f32_16x16x32_bf16 v[148:151],v[36:39],v[204:207],v[148:151]
 ds_read_b64_tr_b16 v[28:29],v7 offset:18432
 v_mfma_f32_16x16x32_bf16 v[148:151],v[32:35],v[196:199],v[148:151]
 s_waitcnt lgkmcnt(7)
 ds_read_b64_tr_b16 v[30:31],v7 offset:21504
 v_mfma_f32_16x16x32_bf16 v[152:155],v[40:43],v[192:195],v[152:155]
 ds_read_b64_tr_b16 v[32:33],v8 offset:12288
 v_mfma_f32_16x16x32_bf16 v[152:155],v[44:47],v[200:203],v[152:155]
 s_add_u32 m0,s35,101376
 s_add_u32 s44,s44,49152
 buffer_load_dwordx4 v248,s[16:19],s44 offen lds
 ds_read_b64_tr_b16 v[34:35],v8 offset:15360
 v_mfma_f32_16x16x32_bf16 v[156:159],v[44:47],v[204:207],v[156:159]
 ds_read_b64_tr_b16 v[36:37],v8 offset:18432
 v_mfma_f32_16x16x32_bf16 v[156:159],v[40:43],v[196:199],v[156:159]
 s_waitcnt lgkmcnt(7)
 ds_read_b64_tr_b16 v[38:39],v8 offset:21504
 v_mfma_f32_16x16x32_bf16 v[112:115],v[16:19],v[208:211],v[112:115]
 ds_read_b64_tr_b16 v[40:41],v9 offset:12288
 v_mfma_f32_16x16x32_bf16 v[112:115],v[20:23],v[216:219],v[112:115]
 ds_read_b64_tr_b16 v[42:43],v9 offset:15360
 v_mfma_f32_16x16x32_bf16 v[116:119],v[20:23],v[220:223],v[116:119]
 ds_read_b64_tr_b16 v[44:45],v9 offset:18432
 v_mfma_f32_16x16x32_bf16 v[116:119],v[16:19],v[212:215],v[116:119]
 buffer_load_dwordx4 v249,s[16:19],s44 offen offset:1024 lds
 ds_read_b64_tr_b16 v[46:47],v9 offset:21504
 v_mfma_f32_16x16x32_bf16 v[228:231],v[16:19],v[224:227],v[228:231]
 s_mul_i32 s41,s54,49152
 s_bfe_u32 s42,s62,0x30003
 s_mul_i32 s42,s42,6144
 v_mfma_f32_16x16x32_bf16 v[228:231],v[20:23],v[224:227],v[228:231]
 s_waitcnt lgkmcnt(8)
 s_add_u32 s41,s41,s42
 s_add_u32 s41,s41,8503296
 v_mfma_f32_16x16x32_bf16 v[120:123],v[24:27],v[208:211],v[120:123]
 ds_read_b64_tr_b16 v[16:17],v10 offset:12288
 v_mfma_f32_16x16x32_bf16 v[120:123],v[28:31],v[216:219],v[120:123]
 ds_read_b64_tr_b16 v[18:19],v10 offset:15360
 v_mfma_f32_16x16x32_bf16 v[124:127],v[28:31],v[220:223],v[124:127]
 ds_read_b64_tr_b16 v[20:21],v10 offset:18432
 v_mfma_f32_16x16x32_bf16 v[124:127],v[24:27],v[212:215],v[124:127]
 buffer_load_dwordx4 v250,s[16:19],s44 offen offset:2048 lds
 ds_read_b64_tr_b16 v[22:23],v10 offset:21504
 v_mfma_f32_16x16x32_bf16 v[232:235],v[24:27],v[224:227],v[232:235]
 s_lshl_b32 s56,s56,10
 s_add_u32 s56,s56,s41
 v_mfma_f32_16x16x32_bf16 v[232:235],v[28:31],v[224:227],v[232:235]
 s_waitcnt lgkmcnt(8)
 s_lshl_b32 s57,s57,10
 s_add_u32 s57,s57,s41
 v_mfma_f32_16x16x32_bf16 v[128:131],v[32:35],v[208:211],v[128:131]
 ds_read_b64_tr_b16 v[24:25],v11 offset:12288
 v_mfma_f32_16x16x32_bf16 v[128:131],v[36:39],v[216:219],v[128:131]
 ds_read_b64_tr_b16 v[26:27],v11 offset:15360
 v_mfma_f32_16x16x32_bf16 v[132:135],v[36:39],v[220:223],v[132:135]
 ds_read_b64_tr_b16 v[28:29],v11 offset:18432
 v_mfma_f32_16x16x32_bf16 v[132:135],v[32:35],v[212:215],v[132:135]
 s_add_u32 m0,s35,0
 s_mov_b32 s44,1179840
 buffer_load_dwordx4 v248,s[16:19],s44 offen lds
 s_waitcnt lgkmcnt(7)
 ds_read_b64_tr_b16 v[30:31],v11 offset:21504
 v_mfma_f32_16x16x32_bf16 v[136:139],v[40:43],v[208:211],v[136:139]
 s_waitcnt vmcnt(13)
 s_barrier
 v_add_u32 v6,49152,v6
 ds_read_b64_tr_b16 v[32:33],v6
 v_mfma_f32_16x16x32_bf16 v[136:139],v[44:47],v[216:219],v[136:139]
 ds_read_b64_tr_b16 v[34:35],v6 offset:3072
 v_mfma_f32_16x16x32_bf16 v[140:143],v[44:47],v[220:223],v[140:143]
 ds_read_b64_tr_b16 v[36:37],v6 offset:6144
 ds_read_b64_tr_b16 v[38:39],v6 offset:9216
 v_mfma_f32_16x16x32_bf16 v[140:143],v[40:43],v[212:215],v[140:143]
 buffer_load_dwordx4 v249,s[16:19],s44 offen offset:1024 lds
 s_waitcnt lgkmcnt(8)
 s_lshl_b32 s58,s58,10
 s_add_u32 s58,s58,s41
 v_mfma_f32_16x16x32_bf16 v[144:147],v[16:19],v[208:211],v[144:147]
 v_add_u32 v7,49152,v7
 ds_read_b64_tr_b16 v[40:41],v7
 v_mfma_f32_16x16x32_bf16 v[144:147],v[20:23],v[216:219],v[144:147]
 ds_read_b64_tr_b16 v[42:43],v7 offset:3072
 ds_write_b128 v251,v[228:231]
 ds_write_b128 v251,v[232:235] offset:64
 v_mfma_f32_16x16x32_bf16 v[148:151],v[20:23],v[220:223],v[148:151]
 ds_read_b64_tr_b16 v[44:45],v7 offset:6144
 ds_read_b64_tr_b16 v[46:47],v7 offset:9216
 v_mfma_f32_16x16x32_bf16 v[148:151],v[16:19],v[212:215],v[148:151]
 s_waitcnt lgkmcnt(10)
 v_add_u32 v236,4294918144,v236
 v_add_u32 v237,4294918144,v237
 v_mfma_f32_16x16x32_bf16 v[152:155],v[24:27],v[208:211],v[152:155]
 buffer_load_dwordx4 v250,s[16:19],s44 offen offset:2048 lds
 v_add_u32 v8,49152,v8
 ds_read_b64_tr_b16 v[16:17],v8
 v_mfma_f32_16x16x32_bf16 v[152:155],v[28:31],v[216:219],v[152:155]
 ds_read_b64_tr_b16 v[18:19],v8 offset:3072
 v_add_u32 v238,4294918144,v238
 v_mfma_f32_16x16x32_bf16 v[156:159],v[28:31],v[220:223],v[156:159]
 ds_read_b64_tr_b16 v[20:21],v8 offset:6144
 ds_read_b64_tr_b16 v[22:23],v8 offset:9216
 v_mfma_f32_16x16x32_bf16 v[156:159],v[24:27],v[212:215],v[156:159]
 s_waitcnt lgkmcnt(10)
 v_add_u32 v239,4294918144,v239
 v_mfma_f32_16x16x32_bf16 v[64:67],v[32:35],a[192:195],0
 v_add_u32 v9,49152,v9
 ds_read_b64_tr_b16 v[24:25],v9
 v_mfma_f32_16x16x32_bf16 v[64:67],v[36:39],a[200:203],v[64:67]
 ds_read_b64_tr_b16 v[26:27],v9 offset:3072
 v_mfma_f32_16x16x32_bf16 v[68:71],v[36:39],a[204:207],0
 s_add_u32 m0,s35,3072
 s_add_u32 s44,s44,49152
 buffer_load_dwordx4 v248,s[16:19],s44 offen lds
 ds_read_b64_tr_b16 v[28:29],v9 offset:6144
 ds_read_b64_tr_b16 v[30:31],v9 offset:9216
 v_mfma_f32_16x16x32_bf16 v[68:71],v[32:35],a[196:199],v[68:71]
 s_getpc_b64 s[66:67]
Lt35:
 s_mul_i32 s41,s48,4
 v_min_u32 v15,3,v0
 v_mfma_f32_16x16x32_bf16 v[228:231],v[32:35],v[224:227],0
 v_add_u32 v15,s41,v15
 v_min_u32 v15,(recurrent_scan__mha_block_cached__mixer_s_mlp__prompt_kernel_hot_end-Lt35)/128,v15
 v_mfma_f32_16x16x32_bf16 v[228:231],v[36:39],v[224:227],v[228:231]
 s_waitcnt lgkmcnt(8)
 v_lshlrev_b32 v15,7,v15
 global_load_dword v255,v15,s[66:67]
 v_mfma_f32_16x16x32_bf16 v[72:75],v[40:43],a[192:195],0
 v_add_u32 v10,49152,v10
 ds_read_b64_tr_b16 v[32:33],v10
 v_mfma_f32_16x16x32_bf16 v[72:75],v[44:47],a[200:203],v[72:75]
 ds_read_b64_tr_b16 v[34:35],v10 offset:3072
 s_waitcnt vmcnt(18)
 v_add_f32 v240,v240,v242
 v_mfma_f32_16x16x32_bf16 v[76:79],v[44:47],a[204:207],0
 buffer_load_dwordx4 v249,s[16:19],s44 offen offset:1024 lds
 ds_read_b64_tr_b16 v[36:37],v10 offset:6144
 ds_read_b64_tr_b16 v[38:39],v10 offset:9216
 v_mfma_f32_16x16x32_bf16 v[76:79],v[40:43],a[196:199],v[76:79]
 v_add_f32 v241,v241,v243
 v_add_f32 v244,v244,v246
 v_mfma_f32_16x16x32_bf16 v[232:235],v[40:43],v[224:227],0
 v_add_f32 v245,v245,v247
 v_mov_b32 v242,v240
 v_mfma_f32_16x16x32_bf16 v[232:235],v[44:47],v[224:227],v[232:235]
 s_waitcnt lgkmcnt(8)
 v_mov_b32 v243,v241
 v_mov_b32 v246,v244
 v_mfma_f32_16x16x32_bf16 v[80:83],v[16:19],a[192:195],0
 v_add_u32 v11,49152,v11
 ds_read_b64_tr_b16 v[40:41],v11
 v_mfma_f32_16x16x32_bf16 v[80:83],v[20:23],a[200:203],v[80:83]
 ds_read_b64_tr_b16 v[42:43],v11 offset:3072
 v_mov_b32 v247,v245
 v_mfma_f32_16x16x32_bf16 v[84:87],v[20:23],a[204:207],0
 buffer_load_dwordx4 v250,s[16:19],s44 offen offset:2048 lds
 ds_read_b64_tr_b16 v[44:45],v11 offset:6144
 ds_read_b64_tr_b16 v[46:47],v11 offset:9216
 s_barrier
 v_mfma_f32_16x16x32_bf16 v[84:87],v[16:19],a[196:199],v[84:87]
 s_waitcnt lgkmcnt(8)
 v_permlane32_swap_b32 v240,v242
 v_permlane32_swap_b32 v241,v243
 v_mfma_f32_16x16x32_bf16 v[88:91],v[24:27],a[192:195],0
 ds_read_b64_tr_b16 v[16:17],v6 offset:12288
 ds_read_b64_tr_b16 v[18:19],v6 offset:15360
 v_mfma_f32_16x16x32_bf16 v[88:91],v[28:31],a[200:203],v[88:91]
 v_permlane32_swap_b32 v244,v246
 v_permlane32_swap_b32 v245,v247
 v_mfma_f32_16x16x32_bf16 v[92:95],v[28:31],a[204:207],0
 s_add_u32 m0,s35,122880
 s_mov_b32 s44,1573056
 buffer_load_dwordx4 v248,s[16:19],s44 offen lds
 ds_read_b64_tr_b16 v[20:21],v6 offset:18432
 ds_read_b64_tr_b16 v[22:23],v6 offset:21504
 v_mfma_f32_16x16x32_bf16 v[92:95],v[24:27],a[196:199],v[92:95]
 s_waitcnt lgkmcnt(8)
 v_add_f32 v240,v240,v242
 v_add_f32 v241,v241,v243
 v_mfma_f32_16x16x32_bf16 v[96:99],v[32:35],a[192:195],0
 ds_read_b64_tr_b16 v[24:25],v7 offset:12288
 ds_read_b64_tr_b16 v[26:27],v7 offset:15360
 v_mfma_f32_16x16x32_bf16 v[96:99],v[36:39],a[200:203],v[96:99]
 v_add_f32 v244,v244,v246
 v_add_f32 v245,v245,v247
 v_mfma_f32_16x16x32_bf16 v[100:103],v[36:39],a[204:207],0
 ds_read_b64_tr_b16 v[28:29],v7 offset:18432
 ds_read_b64_tr_b16 v[30:31],v7 offset:21504
 v_mfma_f32_16x16x32_bf16 v[100:103],v[32:35],a[196:199],v[100:103]
 s_waitcnt lgkmcnt(8)
 v_mov_b32 v242,v240
 v_mov_b32 v243,v241
 v_mfma_f32_16x16x32_bf16 v[104:107],v[40:43],a[192:195],0
 buffer_load_dwordx4 v249,s[16:19],s44 offen offset:1024 lds
 ds_read_b64_tr_b16 v[32:33],v8 offset:12288
 ds_read_b64_tr_b16 v[34:35],v8 offset:15360
 v_mfma_f32_16x16x32_bf16 v[104:107],v[44:47],a[200:203],v[104:107]
 v_mov_b32 v246,v244
 v_mov_b32 v247,v245
 v_mfma_f32_16x16x32_bf16 v[108:111],v[44:47],a[204:207],0
 ds_read_b64_tr_b16 v[36:37],v8 offset:18432
 ds_read_b64_tr_b16 v[38:39],v8 offset:21504
 v_mfma_f32_16x16x32_bf16 v[108:111],v[40:43],a[196:199],v[108:111]
 s_waitcnt lgkmcnt(8)
 v_permlane16_swap_b32 v240,v242
 v_permlane16_swap_b32 v241,v243
 v_mfma_f32_16x16x32_bf16 v[64:67],v[16:19],a[208:211],v[64:67]
 ds_read_b64_tr_b16 v[40:41],v9 offset:12288
 ds_read_b64_tr_b16 v[42:43],v9 offset:15360
 v_mfma_f32_16x16x32_bf16 v[64:67],v[20:23],a[216:219],v[64:67]
 v_permlane16_swap_b32 v244,v246
 v_permlane16_swap_b32 v245,v247
 v_mfma_f32_16x16x32_bf16 v[68:71],v[20:23],a[220:223],v[68:71]
 buffer_load_dwordx4 v250,s[16:19],s44 offen offset:2048 lds
 ds_read_b64_tr_b16 v[44:45],v9 offset:18432
 ds_read_b64_tr_b16 v[46:47],v9 offset:21504
 v_mfma_f32_16x16x32_bf16 v[68:71],v[16:19],a[212:215],v[68:71]
 v_add_f32 v240,v240,v242
 v_add_f32 v241,v241,v243
 v_mfma_f32_16x16x32_bf16 v[228:231],v[16:19],v[224:227],v[228:231]
 v_add_f32 v244,v244,v246
 v_add_f32 v245,v245,v247
 v_mfma_f32_16x16x32_bf16 v[228:231],v[20:23],v[224:227],v[228:231]
 s_waitcnt lgkmcnt(8)
 v_mul_f32 v240,0xbacccccd,v240
 v_mul_f32 v241,0x3acccccd,v241
 v_mfma_f32_16x16x32_bf16 v[72:75],v[24:27],a[208:211],v[72:75]
 ds_read_b64_tr_b16 v[16:17],v10 offset:12288
 ds_read_b64_tr_b16 v[18:19],v10 offset:15360
 v_mfma_f32_16x16x32_bf16 v[72:75],v[28:31],a[216:219],v[72:75]
 v_fma_f32 v241,-v240,v240,v241
 v_max_f32 v241,0,v241
 v_mfma_f32_16x16x32_bf16 v[76:79],v[28:31],a[220:223],v[76:79]
 s_add_u32 m0,s35,125952
 s_add_u32 s44,s44,49152
 buffer_load_dwordx4 v248,s[16:19],s44 offen lds
 ds_read_b64_tr_b16 v[20:21],v10 offset:18432
 ds_read_b64_tr_b16 v[22:23],v10 offset:21504
 v_mfma_f32_16x16x32_bf16 v[76:79],v[24:27],a[212:215],v[76:79]
 v_add_f32 v241,0x3727c5ac,v241
 v_mfma_f32_16x16x32_bf16 v[232:235],v[24:27],v[224:227],v[232:235]
 v_rsq_f32 v241,v241
 v_mfma_f32_16x16x32_bf16 v[232:235],v[28:31],v[224:227],v[232:235]
 s_waitcnt lgkmcnt(8)
 v_mul_f32 v243,0xc0135761,v241
 v_mul_f32 v242,v241,v241
 v_mfma_f32_16x16x32_bf16 v[80:83],v[32:35],a[208:211],v[80:83]
 ds_read_b64_tr_b16 v[24:25],v11 offset:12288
 ds_read_b64_tr_b16 v[26:27],v11 offset:15360
 v_mfma_f32_16x16x32_bf16 v[80:83],v[36:39],a[216:219],v[80:83]
 v_mul_f32 v242,v242,v243
 v_mul_f32 v242,0x3d372713,v242
 v_mfma_f32_16x16x32_bf16 v[84:87],v[36:39],a[220:223],v[84:87]
 buffer_load_dwordx4 v249,s[16:19],s44 offen offset:1024 lds
 ds_read_b64_tr_b16 v[28:29],v11 offset:18432
 ds_read_b64_tr_b16 v[30:31],v11 offset:21504
 v_mfma_f32_16x16x32_bf16 v[84:87],v[32:35],a[212:215],v[84:87]
 s_waitcnt lgkmcnt(8)
 v_rcp_f32 v241,v241
 v_mfma_f32_16x16x32_bf16 v[88:91],v[40:43],a[208:211],v[88:91]
 s_waitcnt vmcnt(18)
 s_barrier
 v_add_u32 v6,4294942720,v6
 ds_read_b64_tr_b16 v[32:33],v6
 v_mfma_f32_16x16x32_bf16 v[88:91],v[44:47],a[216:219],v[88:91]
 ds_read_b64_tr_b16 v[34:35],v6 offset:3072
 v_mul_f32 v244,0xbacccccd,v244
 v_mfma_f32_16x16x32_bf16 v[92:95],v[44:47],a[220:223],v[92:95]
 buffer_load_dwordx4 v250,s[16:19],s44 offen offset:2048 lds
 ds_read_b64_tr_b16 v[36:37],v6 offset:6144
 ds_read_b64_tr_b16 v[38:39],v6 offset:9216
 v_mfma_f32_16x16x32_bf16 v[92:95],v[40:43],a[212:215],v[92:95]
 s_waitcnt lgkmcnt(8)
 v_mul_f32 v245,0x3acccccd,v245
 v_fma_f32 v245,-v244,v244,v245
 v_mfma_f32_16x16x32_bf16 v[96:99],v[16:19],a[208:211],v[96:99]
 v_add_u32 v7,4294942720,v7
 ds_read_b64_tr_b16 v[40:41],v7
 v_mfma_f32_16x16x32_bf16 v[96:99],v[20:23],a[216:219],v[96:99]
 ds_read_b64_tr_b16 v[42:43],v7 offset:3072
 v_max_f32 v245,0,v245
 v_mfma_f32_16x16x32_bf16 v[100:103],v[20:23],a[220:223],v[100:103]
 ds_read_b64_tr_b16 v[44:45],v7 offset:6144
 ds_read_b64_tr_b16 v[46:47],v7 offset:9216
 v_mfma_f32_16x16x32_bf16 v[100:103],v[16:19],a[212:215],v[100:103]
 s_waitcnt lgkmcnt(8)
 v_add_f32 v245,0x3727c5ac,v245
 v_mfma_f32_16x16x32_bf16 v[104:107],v[24:27],a[208:211],v[104:107]
 s_cmp_le_u32 s53,0
 s_cselect_b32 s39,1,0
 s_add_u32 m0,s35,24576
 s_mul_i32 s39,s39,245760
 buffer_load_dwordx4 v1,s[12:15],s39 offen lds
 v_add_u32 v8,4294942720,v8
 ds_read_b64_tr_b16 v[16:17],v8
 v_mfma_f32_16x16x32_bf16 v[104:107],v[28:31],a[216:219],v[104:107]
 ds_read_b64_tr_b16 v[18:19],v8 offset:3072
 v_mfma_f32_16x16x32_bf16 v[108:111],v[28:31],a[220:223],v[108:111]
 ds_read_b64_tr_b16 v[20:21],v8 offset:6144
 ds_read_b64_tr_b16 v[22:23],v8 offset:9216
 v_mfma_f32_16x16x32_bf16 v[108:111],v[24:27],a[212:215],v[108:111]
 s_waitcnt lgkmcnt(8)
 v_rsq_f32 v245,v245
 v_mfma_f32_16x16x32_bf16 v[64:67],v[32:35],a[224:227],v[64:67]
 v_add_u32 v9,4294942720,v9
 ds_read_b64_tr_b16 v[24:25],v9
 v_mfma_f32_16x16x32_bf16 v[64:67],v[36:39],a[232:235],v[64:67]
 ds_read_b64_tr_b16 v[26:27],v9 offset:3072
 v_mul_f32 v247,0xc0135761,v245
 v_mfma_f32_16x16x32_bf16 v[68:71],v[36:39],a[236:239],v[68:71]
 ds_read_b64_tr_b16 v[28:29],v9 offset:6144
 ds_read_b64_tr_b16 v[30:31],v9 offset:9216
 v_mfma_f32_16x16x32_bf16 v[68:71],v[32:35],a[228:231],v[68:71]
 v_mul_f32 v246,v245,v245
 v_mul_f32 v246,v246,v247
 v_mfma_f32_16x16x32_bf16 v[228:231],v[32:35],v[224:227],v[228:231]
 buffer_load_dwordx4 v2,s[12:15],s39 offen offset:1024 lds
 v_mul_f32 v246,0x3d372713,v246
 v_mfma_f32_16x16x32_bf16 v[228:231],v[36:39],v[224:227],v[228:231]
 buffer_load_dwordx4 v3,s[12:15],s39 offen offset:2048 lds
 s_waitcnt lgkmcnt(8)
 v_rcp_f32 v245,v245
 v_mfma_f32_16x16x32_bf16 v[72:75],v[40:43],a[224:227],v[72:75]
 v_add_u32 v10,4294942720,v10
 ds_read_b64_tr_b16 v[32:33],v10
 v_mfma_f32_16x16x32_bf16 v[72:75],v[44:47],a[232:235],v[72:75]
 ds_read_b64_tr_b16 v[34:35],v10 offset:3072
 ds_read_b128 v[56:59],v251
 v_mfma_f32_16x16x32_bf16 v[76:79],v[44:47],a[236:239],v[76:79]
 ds_read_b64_tr_b16 v[36:37],v10 offset:6144
 ds_read_b64_tr_b16 v[38:39],v10 offset:9216
 v_mfma_f32_16x16x32_bf16 v[76:79],v[40:43],a[228:231],v[76:79]
 s_add_u32 m0,s35,27648
 s_add_u32 s44,s39,10240
 buffer_load_dwordx4 v1,s[12:15],s44 offen lds
 ds_read_b128 v[60:63],v251 offset:64
 s_waitcnt lgkmcnt(0)
 v_fmac_f32 v112,v56,v240
 v_mfma_f32_16x16x32_bf16 v[232:235],v[40:43],v[224:227],v[232:235]
 buffer_load_dword v13,v12,s[92:95],0 offen sc1
 v_fmac_f32 v113,v57,v240
 v_mfma_f32_16x16x32_bf16 v[232:235],v[44:47],v[224:227],v[232:235]
 s_waitcnt lgkmcnt(10)
 v_fmac_f32 v114,v58,v240
 v_fmac_f32 v115,v59,v240
 v_mfma_f32_16x16x32_bf16 v[80:83],v[16:19],a[224:227],v[80:83]
 v_add_u32 v11,4294942720,v11
 ds_read_b64_tr_b16 v[40:41],v11
 v_mfma_f32_16x16x32_bf16 v[80:83],v[20:23],a[232:235],v[80:83]
 ds_read_b64_tr_b16 v[42:43],v11 offset:3072
 v_fmac_f32 v120,v60,v240
 v_mfma_f32_16x16x32_bf16 v[84:87],v[20:23],a[236:239],v[84:87]
 buffer_load_dwordx4 v2,s[12:15],s44 offen offset:1024 lds
 ds_read_b64_tr_b16 v[44:45],v11 offset:6144
 ds_read_b64_tr_b16 v[46:47],v11 offset:9216
 v_mfma_f32_16x16x32_bf16 v[84:87],v[16:19],a[228:231],v[84:87]
 s_waitcnt lgkmcnt(10)
 v_fmac_f32 v121,v61,v240
 v_fmac_f32 v122,v62,v240
 v_mfma_f32_16x16x32_bf16 v[88:91],v[24:27],a[224:227],v[88:91]
 ds_read_b64_tr_b16 v[16:17],v6 offset:12288
 ds_read_b64_tr_b16 v[18:19],v6 offset:15360
 v_mfma_f32_16x16x32_bf16 v[88:91],v[28:31],a[232:235],v[88:91]
 v_fmac_f32 v123,v63,v240
 v_mul_f32 v48,v112,v112
 v_mfma_f32_16x16x32_bf16 v[92:95],v[28:31],a[236:239],v[92:95]
 buffer_load_dwordx4 v3,s[12:15],s44 offen offset:2048 lds
 ds_read_b64_tr_b16 v[20:21],v6 offset:18432
 ds_read_b64_tr_b16 v[22:23],v6 offset:21504
 v_mfma_f32_16x16x32_bf16 v[92:95],v[24:27],a[228:231],v[92:95]
 s_waitcnt lgkmcnt(9)
 v_mul_f32 v49,v113,v113
 v_mul_f32 v50,v114,v114
 v_mfma_f32_16x16x32_bf16 v[96:99],v[32:35],a[224:227],v[96:99]
 ds_read_b64_tr_b16 v[24:25],v7 offset:12288
 ds_read_b64_tr_b16 v[26:27],v7 offset:15360
 v_mfma_f32_16x16x32_bf16 v[96:99],v[36:39],a[232:235],v[96:99]
 v_mul_f32 v51,v115,v115
 v_mul_f32 v52,v120,v120
 v_mfma_f32_16x16x32_bf16 v[100:103],v[36:39],a[236:239],v[100:103]
 ds_read_b64_tr_b16 v[28:29],v7 offset:18432
 ds_read_b64_tr_b16 v[30:31],v7 offset:21504
 v_mfma_f32_16x16x32_bf16 v[100:103],v[32:35],a[228:231],v[100:103]
 s_waitcnt lgkmcnt(8)
 v_mul_f32 v53,v121,v121
 v_mul_f32 v54,v122,v122
 v_mfma_f32_16x16x32_bf16 v[104:107],v[40:43],a[224:227],v[104:107]
 ds_read_b64_tr_b16 v[32:33],v8 offset:12288
 ds_read_b64_tr_b16 v[34:35],v8 offset:15360
 v_mfma_f32_16x16x32_bf16 v[104:107],v[44:47],a[232:235],v[104:107]
 v_mul_f32 v55,v123,v123
 v_fma_f32 v48,v48,v242,v243
 v_mfma_f32_16x16x32_bf16 v[108:111],v[44:47],a[236:239],v[108:111]
 ds_read_b64_tr_b16 v[36:37],v8 offset:18432
 ds_read_b64_tr_b16 v[38:39],v8 offset:21504
 v_mfma_f32_16x16x32_bf16 v[108:111],v[40:43],a[228:231],v[108:111]
 s_waitcnt lgkmcnt(8)
 v_fma_f32 v49,v49,v242,v243
 v_fma_f32 v50,v50,v242,v243
 v_mfma_f32_16x16x32_bf16 v[64:67],v[16:19],a[240:243],v[64:67]
 ds_read_b64_tr_b16 v[40:41],v9 offset:12288
 ds_read_b64_tr_b16 v[42:43],v9 offset:15360
 v_mfma_f32_16x16x32_bf16 v[64:67],v[20:23],a[248:251],v[64:67]
 v_fma_f32 v51,v51,v242,v243
 v_fma_f32 v52,v52,v242,v243
 v_mfma_f32_16x16x32_bf16 v[68:71],v[20:23],a[252:255],v[68:71]
 ds_read_b64_tr_b16 v[44:45],v9 offset:18432
 ds_read_b64_tr_b16 v[46:47],v9 offset:21504
 v_mfma_f32_16x16x32_bf16 v[68:71],v[16:19],a[244:247],v[68:71]
 v_fma_f32 v53,v53,v242,v243
 v_fma_f32 v54,v54,v242,v243
 v_mfma_f32_16x16x32_bf16 v[228:231],v[16:19],v[224:227],v[228:231]
 v_fma_f32 v55,v55,v242,v243
 v_mul_f32 v48,v48,v112
 v_mfma_f32_16x16x32_bf16 v[228:231],v[20:23],v[224:227],v[228:231]
 s_waitcnt lgkmcnt(8)
 v_mul_f32 v49,v49,v113
 v_mul_f32 v50,v50,v114
 v_mfma_f32_16x16x32_bf16 v[72:75],v[24:27],a[240:243],v[72:75]
 ds_read_b64_tr_b16 v[16:17],v10 offset:12288
 ds_read_b64_tr_b16 v[18:19],v10 offset:15360
 v_mfma_f32_16x16x32_bf16 v[72:75],v[28:31],a[248:251],v[72:75]
 v_mul_f32 v51,v51,v115
 v_mul_f32 v52,v52,v120
 v_mfma_f32_16x16x32_bf16 v[76:79],v[28:31],a[252:255],v[76:79]
 ds_read_b64_tr_b16 v[20:21],v10 offset:18432
 ds_read_b64_tr_b16 v[22:23],v10 offset:21504
 v_mfma_f32_16x16x32_bf16 v[76:79],v[24:27],a[244:247],v[76:79]
 v_mul_f32 v53,v53,v121
 v_mul_f32 v54,v54,v122
 v_mfma_f32_16x16x32_bf16 v[232:235],v[24:27],v[224:227],v[232:235]
 v_mul_f32 v55,v55,v123
 v_mfma_f32_16x16x32_bf16 v[232:235],v[28:31],v[224:227],v[232:235]
 s_waitcnt lgkmcnt(8)
 v_exp_f32 v48,v48
 v_mfma_f32_16x16x32_bf16 v[80:83],v[32:35],a[240:243],v[80:83]
 ds_read_b64_tr_b16 v[24:25],v11 offset:12288
 ds_read_b64_tr_b16 v[26:27],v11 offset:15360
 v_mfma_f32_16x16x32_bf16 v[80:83],v[36:39],a[248:251],v[80:83]
 v_exp_f32 v49,v49
 v_mfma_f32_16x16x32_bf16 v[84:87],v[36:39],a[252:255],v[84:87]
 ds_read_b64_tr_b16 v[28:29],v11 offset:18432
 ds_read_b64_tr_b16 v[30:31],v11 offset:21504
 v_mfma_f32_16x16x32_bf16 v[84:87],v[32:35],a[244:247],v[84:87]
 s_waitcnt lgkmcnt(8)
 v_exp_f32 v50,v50
 v_mfma_f32_16x16x32_bf16 v[88:91],v[40:43],a[240:243],v[88:91]
 s_waitcnt vmcnt(20)
 s_barrier
 v_add_u32 v6,49152,v6
 ds_read_b64_tr_b16 v[32:33],v6
 v_mfma_f32_16x16x32_bf16 v[88:91],v[44:47],a[248:251],v[88:91]
 s_add_u32 m0,s35,73728
 s_add_u32 s39,s39,81920
 buffer_load_dwordx4 v1,s[12:15],s39 offen lds
 ds_read_b64_tr_b16 v[34:35],v6 offset:3072
 v_mfma_f32_16x16x32_bf16 v[92:95],v[44:47],a[252:255],v[92:95]
 ds_read_b64_tr_b16 v[36:37],v6 offset:6144
 ds_read_b64_tr_b16 v[38:39],v6 offset:9216
 v_mfma_f32_16x16x32_bf16 v[92:95],v[40:43],a[244:247],v[92:95]
 s_waitcnt lgkmcnt(8)
 v_exp_f32 v51,v51
 v_mfma_f32_16x16x32_bf16 v[96:99],v[16:19],a[240:243],v[96:99]
 v_add_u32 v7,49152,v7
 ds_read_b64_tr_b16 v[40:41],v7
 v_mfma_f32_16x16x32_bf16 v[96:99],v[20:23],a[248:251],v[96:99]
 buffer_load_dwordx4 v2,s[12:15],s39 offen offset:1024 lds
 ds_read_b64_tr_b16 v[42:43],v7 offset:3072
 v_mfma_f32_16x16x32_bf16 v[100:103],v[20:23],a[252:255],v[100:103]
 ds_read_b64_tr_b16 v[44:45],v7 offset:6144
 ds_read_b64_tr_b16 v[46:47],v7 offset:9216
 v_mfma_f32_16x16x32_bf16 v[100:103],v[16:19],a[244:247],v[100:103]
 s_waitcnt lgkmcnt(8)
 v_exp_f32 v52,v52
 v_mfma_f32_16x16x32_bf16 v[104:107],v[24:27],a[240:243],v[104:107]
 v_add_u32 v8,49152,v8
 ds_read_b64_tr_b16 v[16:17],v8
 v_mfma_f32_16x16x32_bf16 v[104:107],v[28:31],a[248:251],v[104:107]
 buffer_load_dwordx4 v3,s[12:15],s39 offen offset:2048 lds
 s_add_u32 m0,s35,76800
 s_add_u32 s44,s39,10240
 buffer_load_dwordx4 v1,s[12:15],s44 offen lds
 ds_read_b64_tr_b16 v[18:19],v8 offset:3072
 v_mfma_f32_16x16x32_bf16 v[108:111],v[28:31],a[252:255],v[108:111]
 ds_read_b64_tr_b16 v[20:21],v8 offset:6144
 ds_read_b64_tr_b16 v[22:23],v8 offset:9216
 v_mfma_f32_16x16x32_bf16 v[108:111],v[24:27],a[244:247],v[108:111]
 s_waitcnt lgkmcnt(8)
 v_exp_f32 v53,v53
 v_mfma_f32_16x16x32_bf16 v[64:67],v[32:35],a[160:163],v[64:67]
 v_add_u32 v9,49152,v9
 ds_read_b64_tr_b16 v[24:25],v9
 v_mfma_f32_16x16x32_bf16 v[64:67],v[36:39],a[168:171],v[64:67]
 buffer_load_dwordx4 v2,s[12:15],s44 offen offset:1024 lds
 ds_read_b64_tr_b16 v[26:27],v9 offset:3072
 v_mfma_f32_16x16x32_bf16 v[68:71],v[36:39],a[172:175],v[68:71]
 ds_read_b64_tr_b16 v[28:29],v9 offset:6144
 ds_read_b64_tr_b16 v[30:31],v9 offset:9216
 v_mfma_f32_16x16x32_bf16 v[68:71],v[32:35],a[164:167],v[68:71]
 buffer_load_dwordx4 v3,s[12:15],s44 offen offset:2048 lds
 v_exp_f32 v54,v54
 v_mfma_f32_16x16x32_bf16 v[228:231],v[32:35],v[224:227],v[228:231]
 v_exp_f32 v55,v55
 v_mfma_f32_16x16x32_bf16 v[228:231],v[36:39],v[224:227],v[228:231]
 s_waitcnt lgkmcnt(8)
 v_fma_f32 v48,v48,v241,v241
 v_fma_f32 v49,v49,v241,v241
 v_mfma_f32_16x16x32_bf16 v[72:75],v[40:43],a[160:163],v[72:75]
 v_add_u32 v10,49152,v10
 ds_read_b64_tr_b16 v[32:33],v10
 v_mfma_f32_16x16x32_bf16 v[72:75],v[44:47],a[168:171],v[72:75]
 ds_read_b64_tr_b16 v[34:35],v10 offset:3072
 v_fma_f32 v50,v50,v241,v241
 v_mfma_f32_16x16x32_bf16 v[76:79],v[44:47],a[172:175],v[76:79]
 ds_read_b64_tr_b16 v[36:37],v10 offset:6144
 ds_read_b64_tr_b16 v[38:39],v10 offset:9216
 v_mfma_f32_16x16x32_bf16 v[76:79],v[40:43],a[164:167],v[76:79]
 v_fma_f32 v51,v51,v241,v241
 v_fma_f32 v52,v52,v241,v241
 v_mfma_f32_16x16x32_bf16 v[232:235],v[40:43],v[224:227],v[232:235]
 v_fma_f32 v53,v53,v241,v241
 v_fma_f32 v54,v54,v241,v241
 v_mfma_f32_16x16x32_bf16 v[232:235],v[44:47],v[224:227],v[232:235]
 s_waitcnt lgkmcnt(8)
 v_fma_f32 v55,v55,v241,v241
 v_mfma_f32_16x16x32_bf16 v[80:83],v[16:19],a[160:163],v[80:83]
 v_add_u32 v11,49152,v11
 ds_read_b64_tr_b16 v[40:41],v11
 v_mfma_f32_16x16x32_bf16 v[80:83],v[20:23],a[168:171],v[80:83]
 ds_read_b64_tr_b16 v[42:43],v11 offset:3072
 v_mfma_f32_16x16x32_bf16 v[84:87],v[20:23],a[172:175],v[84:87]
 ds_read_b64_tr_b16 v[44:45],v11 offset:6144
 ds_read_b64_tr_b16 v[46:47],v11 offset:9216
 v_mfma_f32_16x16x32_bf16 v[84:87],v[16:19],a[164:167],v[84:87]
 s_waitcnt lgkmcnt(8)
 v_rcp_f32 v48,v48
 v_mfma_f32_16x16x32_bf16 v[88:91],v[24:27],a[160:163],v[88:91]
 ds_read_b64_tr_b16 v[16:17],v6 offset:12288
 ds_read_b64_tr_b16 v[18:19],v6 offset:15360
 v_mfma_f32_16x16x32_bf16 v[88:91],v[28:31],a[168:171],v[88:91]
 v_rcp_f32 v49,v49
 v_mfma_f32_16x16x32_bf16 v[92:95],v[28:31],a[172:175],v[92:95]
 ds_read_b64_tr_b16 v[20:21],v6 offset:18432
 ds_read_b64_tr_b16 v[22:23],v6 offset:21504
 v_mfma_f32_16x16x32_bf16 v[92:95],v[24:27],a[164:167],v[92:95]
 s_waitcnt lgkmcnt(8)
 v_rcp_f32 v50,v50
 v_mfma_f32_16x16x32_bf16 v[96:99],v[32:35],a[160:163],v[96:99]
 ds_read_b64_tr_b16 v[24:25],v7 offset:12288
 ds_read_b64_tr_b16 v[26:27],v7 offset:15360
 v_mfma_f32_16x16x32_bf16 v[96:99],v[36:39],a[168:171],v[96:99]
 v_rcp_f32 v51,v51
 v_mfma_f32_16x16x32_bf16 v[100:103],v[36:39],a[172:175],v[100:103]
 ds_read_b64_tr_b16 v[28:29],v7 offset:18432
 ds_read_b64_tr_b16 v[30:31],v7 offset:21504
 v_mfma_f32_16x16x32_bf16 v[100:103],v[32:35],a[164:167],v[100:103]
 s_waitcnt lgkmcnt(8)
 v_rcp_f32 v52,v52
 v_mfma_f32_16x16x32_bf16 v[104:107],v[40:43],a[160:163],v[104:107]
 ds_read_b64_tr_b16 v[32:33],v8 offset:12288
 ds_read_b64_tr_b16 v[34:35],v8 offset:15360
 v_mfma_f32_16x16x32_bf16 v[104:107],v[44:47],a[168:171],v[104:107]
 v_rcp_f32 v53,v53
 v_mfma_f32_16x16x32_bf16 v[108:111],v[44:47],a[172:175],v[108:111]
 ds_read_b64_tr_b16 v[36:37],v8 offset:18432
 ds_read_b64_tr_b16 v[38:39],v8 offset:21504
 v_mfma_f32_16x16x32_bf16 v[108:111],v[40:43],a[164:167],v[108:111]
 s_waitcnt lgkmcnt(8)
 v_rcp_f32 v54,v54
 v_mfma_f32_16x16x32_bf16 v[64:67],v[16:19],a[176:179],v[64:67]
 ds_read_b64_tr_b16 v[40:41],v9 offset:12288
 ds_read_b64_tr_b16 v[42:43],v9 offset:15360
 v_mfma_f32_16x16x32_bf16 v[64:67],v[20:23],a[184:187],v[64:67]
 v_rcp_f32 v55,v55
 v_mfma_f32_16x16x32_bf16 v[68:71],v[20:23],a[188:191],v[68:71]
 ds_read_b64_tr_b16 v[44:45],v9 offset:18432
 ds_read_b64_tr_b16 v[46:47],v9 offset:21504
 v_mfma_f32_16x16x32_bf16 v[68:71],v[16:19],a[180:183],v[68:71]
 v_mul_f32 v112,v112,v48
 v_mul_f32 v113,v113,v49
 v_mfma_f32_16x16x32_bf16 v[228:231],v[16:19],v[224:227],v[228:231]
 v_mul_f32 v114,v114,v50
 v_mul_f32 v115,v115,v51
 v_mfma_f32_16x16x32_bf16 v[228:231],v[20:23],v[224:227],v[228:231]
 s_waitcnt lgkmcnt(8)
 v_mul_f32 v120,v120,v52
 v_mul_f32 v121,v121,v53
 v_mfma_f32_16x16x32_bf16 v[72:75],v[24:27],a[176:179],v[72:75]
 ds_read_b64_tr_b16 v[16:17],v10 offset:12288
 ds_read_b64_tr_b16 v[18:19],v10 offset:15360
 v_mfma_f32_16x16x32_bf16 v[72:75],v[28:31],a[184:187],v[72:75]
 v_mul_f32 v122,v122,v54
 v_mul_f32 v123,v123,v55
 v_mfma_f32_16x16x32_bf16 v[76:79],v[28:31],a[188:191],v[76:79]
 ds_read_b64_tr_b16 v[20:21],v10 offset:18432
 ds_read_b64_tr_b16 v[22:23],v10 offset:21504
 v_mfma_f32_16x16x32_bf16 v[76:79],v[24:27],a[180:183],v[76:79]
 v_cvt_pk_bf16_f32 v112,v112,v113
 v_cvt_pk_bf16_f32 v113,v114,v115
 v_mfma_f32_16x16x32_bf16 v[232:235],v[24:27],v[224:227],v[232:235]
 v_cvt_pk_bf16_f32 v114,v120,v121
 v_cvt_pk_bf16_f32 v115,v122,v123
 v_mfma_f32_16x16x32_bf16 v[232:235],v[28:31],v[224:227],v[232:235]
 s_add_u32 s47,s56,0
 buffer_store_dwordx4 v[112:115],v4,s[28:31],s47 offen sc1
 s_waitcnt lgkmcnt(8)
 v_fmac_f32 v116,v56,v244
 v_fmac_f32 v117,v57,v244
 v_mfma_f32_16x16x32_bf16 v[80:83],v[32:35],a[176:179],v[80:83]
 ds_read_b64_tr_b16 v[24:25],v11 offset:12288
 ds_read_b64_tr_b16 v[26:27],v11 offset:15360
 v_mfma_f32_16x16x32_bf16 v[80:83],v[36:39],a[184:187],v[80:83]
 v_fmac_f32 v118,v58,v244
 v_fmac_f32 v119,v59,v244
 v_mfma_f32_16x16x32_bf16 v[84:87],v[36:39],a[188:191],v[84:87]
 ds_read_b64_tr_b16 v[28:29],v11 offset:18432
 ds_read_b64_tr_b16 v[30:31],v11 offset:21504
 v_mfma_f32_16x16x32_bf16 v[84:87],v[32:35],a[180:183],v[84:87]
 s_waitcnt lgkmcnt(8)
 v_fmac_f32 v124,v60,v244
 v_fmac_f32 v125,v61,v244
 v_mfma_f32_16x16x32_bf16 v[88:91],v[40:43],a[176:179],v[88:91]
 s_waitcnt vmcnt(20)
 s_barrier
 v_add_u32 v6,4294868992,v6
 ds_read_b64_tr_b16 v[32:33],v6
 v_mfma_f32_16x16x32_bf16 v[88:91],v[44:47],a[184:187],v[88:91]
 s_add_u32 m0,s35,49152
 s_add_u32 s39,s39,81920
 buffer_load_dwordx4 v1,s[12:15],s39 offen lds
 buffer_load_dwordx4 v2,s[12:15],s39 offen offset:1024 lds
 buffer_load_dwordx4 v3,s[12:15],s39 offen offset:2048 lds
 ds_read_b64_tr_b16 v[34:35],v6 offset:3072
 v_fmac_f32 v126,v62,v244
 v_mfma_f32_16x16x32_bf16 v[92:95],v[44:47],a[188:191],v[92:95]
 ds_read_b64_tr_b16 v[36:37],v6 offset:6144
 ds_read_b64_tr_b16 v[38:39],v6 offset:9216
 v_mfma_f32_16x16x32_bf16 v[92:95],v[40:43],a[180:183],v[92:95]
 s_waitcnt lgkmcnt(8)
 v_fmac_f32 v127,v63,v244
 v_mul_f32 v48,v116,v116
 v_mfma_f32_16x16x32_bf16 v[96:99],v[16:19],a[176:179],v[96:99]
 v_add_u32 v7,4294868992,v7
 ds_read_b64_tr_b16 v[40:41],v7
 v_mfma_f32_16x16x32_bf16 v[96:99],v[20:23],a[184:187],v[96:99]
 ds_read_b64_tr_b16 v[42:43],v7 offset:3072
 v_mul_f32 v49,v117,v117
 v_mfma_f32_16x16x32_bf16 v[100:103],v[20:23],a[188:191],v[100:103]
 s_add_u32 m0,s35,52224
 s_add_u32 s44,s39,10240
 buffer_load_dwordx4 v1,s[12:15],s44 offen lds
 ds_read_b64_tr_b16 v[44:45],v7 offset:6144
 ds_read_b64_tr_b16 v[46:47],v7 offset:9216
 v_mfma_f32_16x16x32_bf16 v[100:103],v[16:19],a[180:183],v[100:103]
 s_waitcnt lgkmcnt(8)
 v_mul_f32 v50,v118,v118
 v_mul_f32 v51,v119,v119
 v_mfma_f32_16x16x32_bf16 v[104:107],v[24:27],a[176:179],v[104:107]
 v_add_u32 v8,4294868992,v8
 ds_read_b64_tr_b16 v[16:17],v8
 v_mfma_f32_16x16x32_bf16 v[104:107],v[28:31],a[184:187],v[104:107]
 ds_read_b64_tr_b16 v[18:19],v8 offset:3072
 v_mul_f32 v52,v124,v124
 v_mfma_f32_16x16x32_bf16 v[108:111],v[28:31],a[188:191],v[108:111]
 buffer_load_dwordx4 v2,s[12:15],s44 offen offset:1024 lds
 ds_read_b64_tr_b16 v[20:21],v8 offset:6144
 ds_read_b64_tr_b16 v[22:23],v8 offset:9216
 v_mfma_f32_16x16x32_bf16 v[108:111],v[24:27],a[180:183],v[108:111]
 s_waitcnt lgkmcnt(8)
 v_mul_f32 v53,v125,v125
 v_mul_f32 v54,v126,v126
 v_mfma_f32_16x16x32_bf16 v[64:67],v[32:35],v[160:163],v[64:67]
 v_add_u32 v9,4294868992,v9
 ds_read_b64_tr_b16 v[24:25],v9
 v_mfma_f32_16x16x32_bf16 v[64:67],v[36:39],v[168:171],v[64:67]
 ds_read_b64_tr_b16 v[26:27],v9 offset:3072
 v_mul_f32 v55,v127,v127
 v_mfma_f32_16x16x32_bf16 v[68:71],v[36:39],v[172:175],v[68:71]
 ds_read_b64_tr_b16 v[28:29],v9 offset:6144
 ds_read_b64_tr_b16 v[30:31],v9 offset:9216
 v_mfma_f32_16x16x32_bf16 v[68:71],v[32:35],v[164:167],v[68:71]
 buffer_load_dwordx4 v3,s[12:15],s44 offen offset:2048 lds
 v_fma_f32 v48,v48,v246,v247
 v_fma_f32 v49,v49,v246,v247
 v_mfma_f32_16x16x32_bf16 v[228:231],v[32:35],v[224:227],v[228:231]
 v_fma_f32 v50,v50,v246,v247
 v_fma_f32 v51,v51,v246,v247
 v_mfma_f32_16x16x32_bf16 v[228:231],v[36:39],v[224:227],v[228:231]
 s_waitcnt lgkmcnt(8)
 v_fma_f32 v52,v52,v246,v247
 v_fma_f32 v53,v53,v246,v247
 v_mfma_f32_16x16x32_bf16 v[72:75],v[40:43],v[160:163],v[72:75]
 v_add_u32 v10,4294868992,v10
 ds_read_b64_tr_b16 v[32:33],v10
 v_mfma_f32_16x16x32_bf16 v[72:75],v[44:47],v[168:171],v[72:75]
 ds_read_b64_tr_b16 v[34:35],v10 offset:3072
 v_fma_f32 v54,v54,v246,v247
 v_mfma_f32_16x16x32_bf16 v[76:79],v[44:47],v[172:175],v[76:79]
 ds_read_b64_tr_b16 v[36:37],v10 offset:6144
 ds_read_b64_tr_b16 v[38:39],v10 offset:9216
 v_mfma_f32_16x16x32_bf16 v[76:79],v[40:43],v[164:167],v[76:79]
 v_fma_f32 v55,v55,v246,v247
 v_mul_f32 v48,v48,v116
 v_mfma_f32_16x16x32_bf16 v[232:235],v[40:43],v[224:227],v[232:235]
 s_waitcnt vmcnt(15)
 v_cmp_ne_u32 vcc,s51,v13
 s_nop 1
 s_cbranch_vccnz Lp34_spin
Lp34_ok:
 s_cmp_le_u32 s53,0
 s_cselect_b32 s74,1,0
 s_mul_i32 s74,s74,6144
 s_add_u32 s75,s74,0
 buffer_load_dwordx4 a[192:195],v4,s[4:7],s75 offen sc1
 v_mfma_f32_16x16x32_bf16 v[232:235],v[44:47],v[224:227],v[232:235]
 s_waitcnt lgkmcnt(8)
 v_mul_f32 v49,v49,v117
 v_mul_f32 v50,v50,v118
 v_mfma_f32_16x16x32_bf16 v[80:83],v[16:19],v[160:163],v[80:83]
 buffer_load_dwordx4 a[208:211],v4,s[4:7],s75 offen offset:1024 sc1
 v_add_u32 v11,4294868992,v11
 ds_read_b64_tr_b16 v[40:41],v11
 v_mfma_f32_16x16x32_bf16 v[80:83],v[20:23],v[168:171],v[80:83]
 ds_read_b64_tr_b16 v[42:43],v11 offset:3072
 v_mul_f32 v51,v51,v119
 v_mfma_f32_16x16x32_bf16 v[84:87],v[20:23],v[172:175],v[84:87]
 ds_read_b64_tr_b16 v[44:45],v11 offset:6144
 ds_read_b64_tr_b16 v[46:47],v11 offset:9216
 v_mfma_f32_16x16x32_bf16 v[84:87],v[16:19],v[164:167],v[84:87]
 s_waitcnt lgkmcnt(8)
 v_mul_f32 v52,v52,v124
 v_mul_f32 v53,v53,v125
 v_mfma_f32_16x16x32_bf16 v[88:91],v[24:27],v[160:163],v[88:91]
 ds_read_b64_tr_b16 v[16:17],v6 offset:12288
 ds_read_b64_tr_b16 v[18:19],v6 offset:15360
 v_mfma_f32_16x16x32_bf16 v[88:91],v[28:31],v[168:171],v[88:91]
 v_mul_f32 v54,v54,v126
 v_mul_f32 v55,v55,v127
 v_mfma_f32_16x16x32_bf16 v[92:95],v[28:31],v[172:175],v[92:95]
 s_add_u32 s75,s74,196608
 ds_read_b64_tr_b16 v[20:21],v6 offset:18432
 ds_read_b64_tr_b16 v[22:23],v6 offset:21504
 v_mfma_f32_16x16x32_bf16 v[92:95],v[24:27],v[164:167],v[92:95]
 s_waitcnt lgkmcnt(8)
 v_exp_f32 v48,v48
 v_mfma_f32_16x16x32_bf16 v[96:99],v[32:35],v[160:163],v[96:99]
 buffer_load_dwordx4 a[196:199],v4,s[4:7],s75 offen sc1
 ds_read_b64_tr_b16 v[24:25],v7 offset:12288
 ds_read_b64_tr_b16 v[26:27],v7 offset:15360
 v_mfma_f32_16x16x32_bf16 v[96:99],v[36:39],v[168:171],v[96:99]
 v_exp_f32 v49,v49
 v_mfma_f32_16x16x32_bf16 v[100:103],v[36:39],v[172:175],v[100:103]
 ds_read_b64_tr_b16 v[28:29],v7 offset:18432
 ds_read_b64_tr_b16 v[30:31],v7 offset:21504
 v_mfma_f32_16x16x32_bf16 v[100:103],v[32:35],v[164:167],v[100:103]
 s_waitcnt lgkmcnt(8)
 v_exp_f32 v50,v50
 v_mfma_f32_16x16x32_bf16 v[104:107],v[40:43],v[160:163],v[104:107]
 ds_read_b64_tr_b16 v[32:33],v8 offset:12288
 ds_read_b64_tr_b16 v[34:35],v8 offset:15360
 v_mfma_f32_16x16x32_bf16 v[104:107],v[44:47],v[168:171],v[104:107]
 v_exp_f32 v51,v51
 v_mfma_f32_16x16x32_bf16 v[108:111],v[44:47],v[172:175],v[108:111]
 ds_read_b64_tr_b16 v[36:37],v8 offset:18432
 ds_read_b64_tr_b16 v[38:39],v8 offset:21504
 v_mfma_f32_16x16x32_bf16 v[108:111],v[40:43],v[164:167],v[108:111]
 s_waitcnt lgkmcnt(8)
 v_exp_f32 v52,v52
 v_mfma_f32_16x16x32_bf16 v[64:67],v[16:19],v[176:179],v[64:67]
 ds_read_b64_tr_b16 v[40:41],v9 offset:12288
 ds_read_b64_tr_b16 v[42:43],v9 offset:15360
 v_mfma_f32_16x16x32_bf16 v[64:67],v[20:23],v[184:187],v[64:67]
 buffer_load_dwordx4 a[212:215],v4,s[4:7],s75 offen offset:1024 sc1
 v_exp_f32 v53,v53
 v_mfma_f32_16x16x32_bf16 v[68:71],v[20:23],v[188:191],v[68:71]
 ds_read_b64_tr_b16 v[44:45],v9 offset:18432
 ds_read_b64_tr_b16 v[46:47],v9 offset:21504
 v_mfma_f32_16x16x32_bf16 v[68:71],v[16:19],v[180:183],v[68:71]
 v_exp_f32 v54,v54
 v_mfma_f32_16x16x32_bf16 v[228:231],v[16:19],v[224:227],v[228:231]
 v_exp_f32 v55,v55
 v_mfma_f32_16x16x32_bf16 v[228:231],v[20:23],v[224:227],v[228:231]
 s_waitcnt lgkmcnt(8)
 v_fma_f32 v48,v48,v245,v245
 v_fma_f32 v49,v49,v245,v245
 v_mfma_f32_16x16x32_bf16 v[72:75],v[24:27],v[176:179],v[72:75]
 ds_read_b64_tr_b16 v[16:17],v10 offset:12288
 ds_read_b64_tr_b16 v[18:19],v10 offset:15360
 v_mfma_f32_16x16x32_bf16 v[72:75],v[28:31],v[184:187],v[72:75]
 v_fma_f32 v50,v50,v245,v245
 v_fma_f32 v51,v51,v245,v245
 v_mfma_f32_16x16x32_bf16 v[76:79],v[28:31],v[188:191],v[76:79]
 ds_read_b64_tr_b16 v[20:21],v10 offset:18432
 ds_read_b64_tr_b16 v[22:23],v10 offset:21504
 v_mfma_f32_16x16x32_bf16 v[76:79],v[24:27],v[180:183],v[76:79]
 v_fma_f32 v52,v52,v245,v245
 v_fma_f32 v53,v53,v245,v245
 v_mfma_f32_16x16x32_bf16 v[232:235],v[24:27],v[224:227],v[232:235]
 s_add_u32 s75,s74,393216
 v_fma_f32 v54,v54,v245,v245
 v_fma_f32 v55,v55,v245,v245
 v_mfma_f32_16x16x32_bf16 v[232:235],v[28:31],v[224:227],v[232:235]
 buffer_load_dwordx4 a[200:203],v4,s[4:7],s75 offen sc1
 s_waitcnt lgkmcnt(8)
 v_rcp_f32 v48,v48
 v_mfma_f32_16x16x32_bf16 v[80:83],v[32:35],v[176:179],v[80:83]
 ds_read_b64_tr_b16 v[24:25],v11 offset:12288
 ds_read_b64_tr_b16 v[26:27],v11 offset:15360
 v_mfma_f32_16x16x32_bf16 v[80:83],v[36:39],v[184:187],v[80:83]
 v_rcp_f32 v49,v49
 v_mfma_f32_16x16x32_bf16 v[84:87],v[36:39],v[188:191],v[84:87]
 ds_read_b64_tr_b16 v[28:29],v11 offset:18432
 ds_read_b64_tr_b16 v[30:31],v11 offset:21504
 v_mfma_f32_16x16x32_bf16 v[84:87],v[32:35],v[180:183],v[84:87]
 s_waitcnt lgkmcnt(8)
 v_rcp_f32 v50,v50
 v_mfma_f32_16x16x32_bf16 v[88:91],v[40:43],v[176:179],v[88:91]
 s_waitcnt vmcnt(25)
 s_barrier
 v_add_u32 v6,122880,v6
 ds_read_b64_tr_b16 v[32:33],v6
 v_mfma_f32_16x16x32_bf16 v[88:91],v[44:47],v[184:187],v[88:91]
 s_cmp_le_u32 s53,1
 s_cselect_b32 s39,2,1
 s_add_u32 m0,s35,98304
 s_mul_i32 s39,s39,245760
 buffer_load_dwordx4 v1,s[12:15],s39 offen lds
 ds_read_b64_tr_b16 v[34:35],v6 offset:3072
 v_mfma_f32_16x16x32_bf16 v[92:95],v[44:47],v[188:191],v[92:95]
 buffer_load_dwordx4 a[216:219],v4,s[4:7],s75 offen offset:1024 sc1
 ds_read_b64_tr_b16 v[36:37],v6 offset:6144
 ds_read_b64_tr_b16 v[38:39],v6 offset:9216
 v_mfma_f32_16x16x32_bf16 v[92:95],v[40:43],v[180:183],v[92:95]
 s_waitcnt lgkmcnt(8)
 v_rcp_f32 v51,v51
 v_mfma_f32_16x16x32_bf16 v[96:99],v[16:19],v[176:179],v[96:99]
 v_add_u32 v7,122880,v7
 ds_read_b64_tr_b16 v[40:41],v7
 v_mfma_f32_16x16x32_bf16 v[96:99],v[20:23],v[184:187],v[96:99]
 buffer_load_dwordx4 v2,s[12:15],s39 offen offset:1024 lds
 ds_read_b64_tr_b16 v[42:43],v7 offset:3072
 v_mfma_f32_16x16x32_bf16 v[100:103],v[20:23],v[188:191],v[100:103]
 ds_read_b64_tr_b16 v[44:45],v7 offset:6144
 ds_read_b64_tr_b16 v[46:47],v7 offset:9216
 v_mfma_f32_16x16x32_bf16 v[100:103],v[16:19],v[180:183],v[100:103]
 s_waitcnt lgkmcnt(8)
 v_rcp_f32 v52,v52
 v_mfma_f32_16x16x32_bf16 v[104:107],v[24:27],v[176:179],v[104:107]
 v_add_u32 v8,122880,v8
 ds_read_b64_tr_b16 v[16:17],v8
 v_mfma_f32_16x16x32_bf16 v[104:107],v[28:31],v[184:187],v[104:107]
 buffer_load_dwordx4 v3,s[12:15],s39 offen offset:2048 lds
 ds_read_b64_tr_b16 v[18:19],v8 offset:3072
 v_mfma_f32_16x16x32_bf16 v[108:111],v[28:31],v[188:191],v[108:111]
 s_add_u32 m0,s35,101376
 s_add_u32 s44,s39,10240
 buffer_load_dwordx4 v1,s[12:15],s44 offen lds
 ds_read_b64_tr_b16 v[20:21],v8 offset:6144
 ds_read_b64_tr_b16 v[22:23],v8 offset:9216
 v_mfma_f32_16x16x32_bf16 v[108:111],v[24:27],v[180:183],v[108:111]
 s_waitcnt lgkmcnt(8)
 v_rcp_f32 v53,v53
 v_mfma_f32_16x16x32_bf16 v[64:67],v[32:35],v[192:195],v[64:67]
 v_add_u32 v9,122880,v9
 ds_read_b64_tr_b16 v[24:25],v9
 v_mfma_f32_16x16x32_bf16 v[64:67],v[36:39],v[200:203],v[64:67]
 ds_read_b64_tr_b16 v[26:27],v9 offset:3072
 v_mfma_f32_16x16x32_bf16 v[68:71],v[36:39],v[204:207],v[68:71]
 s_add_u32 s75,s74,589824
 ds_read_b64_tr_b16 v[28:29],v9 offset:6144
 ds_read_b64_tr_b16 v[30:31],v9 offset:9216
 v_mfma_f32_16x16x32_bf16 v[68:71],v[32:35],v[196:199],v[68:71]
 buffer_load_dwordx4 a[204:207],v4,s[4:7],s75 offen sc1
 v_rcp_f32 v54,v54
 v_mfma_f32_16x16x32_bf16 v[228:231],v[32:35],v[224:227],v[228:231]
 v_rcp_f32 v55,v55
 v_mfma_f32_16x16x32_bf16 v[228:231],v[36:39],v[224:227],v[228:231]
 s_waitcnt lgkmcnt(8)
 v_mul_f32 v116,v116,v48
 v_mul_f32 v117,v117,v49
 v_mfma_f32_16x16x32_bf16 v[72:75],v[40:43],v[192:195],v[72:75]
 v_add_u32 v10,122880,v10
 ds_read_b64_tr_b16 v[32:33],v10
 v_mfma_f32_16x16x32_bf16 v[72:75],v[44:47],v[200:203],v[72:75]
 buffer_load_dwordx4 v2,s[12:15],s44 offen offset:1024 lds
 ds_read_b64_tr_b16 v[34:35],v10 offset:3072
 v_mul_f32 v118,v118,v50
 v_mfma_f32_16x16x32_bf16 v[76:79],v[44:47],v[204:207],v[76:79]
 ds_read_b64_tr_b16 v[36:37],v10 offset:6144
 ds_read_b64_tr_b16 v[38:39],v10 offset:9216
 v_mfma_f32_16x16x32_bf16 v[76:79],v[40:43],v[196:199],v[76:79]
 v_mul_f32 v119,v119,v51
 v_mul_f32 v124,v124,v52
 v_mfma_f32_16x16x32_bf16 v[232:235],v[40:43],v[224:227],v[232:235]
 v_mul_f32 v125,v125,v53
 v_mul_f32 v126,v126,v54
 v_mfma_f32_16x16x32_bf16 v[232:235],v[44:47],v[224:227],v[232:235]
 s_waitcnt lgkmcnt(8)
 v_mul_f32 v127,v127,v55
 v_cvt_pk_bf16_f32 v116,v116,v117
 v_mfma_f32_16x16x32_bf16 v[80:83],v[16:19],v[192:195],v[80:83]
 buffer_load_dwordx4 a[220:223],v4,s[4:7],s75 offen offset:1024 sc1
 v_add_u32 v11,122880,v11
 ds_read_b64_tr_b16 v[40:41],v11
 v_mfma_f32_16x16x32_bf16 v[80:83],v[20:23],v[200:203],v[80:83]
 ds_read_b64_tr_b16 v[42:43],v11 offset:3072
 v_cvt_pk_bf16_f32 v117,v118,v119
 v_mfma_f32_16x16x32_bf16 v[84:87],v[20:23],v[204:207],v[84:87]
 ds_read_b64_tr_b16 v[44:45],v11 offset:6144
 ds_read_b64_tr_b16 v[46:47],v11 offset:9216
 v_mfma_f32_16x16x32_bf16 v[84:87],v[16:19],v[196:199],v[84:87]
 s_waitcnt lgkmcnt(8)
 v_cvt_pk_bf16_f32 v118,v124,v125
 v_cvt_pk_bf16_f32 v119,v126,v127
 v_mfma_f32_16x16x32_bf16 v[88:91],v[24:27],v[192:195],v[88:91]
 buffer_load_dwordx4 v3,s[12:15],s44 offen offset:2048 lds
 ds_read_b64_tr_b16 v[16:17],v6 offset:12288
 ds_read_b64_tr_b16 v[18:19],v6 offset:15360
 v_mfma_f32_16x16x32_bf16 v[88:91],v[28:31],v[200:203],v[88:91]
 ds_read_b128 v[56:59],v252
 ds_read_b128 v[60:63],v252 offset:64
 v_mfma_f32_16x16x32_bf16 v[92:95],v[28:31],v[204:207],v[92:95]
 ds_read_b64_tr_b16 v[20:21],v6 offset:18432
 ds_read_b64_tr_b16 v[22:23],v6 offset:21504
 v_mfma_f32_16x16x32_bf16 v[92:95],v[24:27],v[196:199],v[92:95]
 s_waitcnt lgkmcnt(10)
 s_waitcnt lgkmcnt(2)
 v_fmac_f32 v128,v56,v240
 v_mfma_f32_16x16x32_bf16 v[96:99],v[32:35],v[192:195],v[96:99]
 s_add_u32 s47,s56,49152
 ds_read_b64_tr_b16 v[24:25],v7 offset:12288
 ds_read_b64_tr_b16 v[26:27],v7 offset:15360
 v_mfma_f32_16x16x32_bf16 v[96:99],v[36:39],v[200:203],v[96:99]
 buffer_store_dwordx4 v[116:119],v4,s[28:31],s47 offen sc1
 v_fmac_f32 v129,v57,v240
 v_fmac_f32 v130,v58,v240
 v_mfma_f32_16x16x32_bf16 v[100:103],v[36:39],v[204:207],v[100:103]
 ds_read_b64_tr_b16 v[28:29],v7 offset:18432
 ds_read_b64_tr_b16 v[30:31],v7 offset:21504
 v_mfma_f32_16x16x32_bf16 v[100:103],v[32:35],v[196:199],v[100:103]
 s_waitcnt lgkmcnt(10)
 v_fmac_f32 v131,v59,v240
 v_fmac_f32 v136,v60,v240
 v_mfma_f32_16x16x32_bf16 v[104:107],v[40:43],v[192:195],v[104:107]
 ds_read_b64_tr_b16 v[32:33],v8 offset:12288
 ds_read_b64_tr_b16 v[34:35],v8 offset:15360
 v_mfma_f32_16x16x32_bf16 v[104:107],v[44:47],v[200:203],v[104:107]
 v_fmac_f32 v137,v61,v240
 v_fmac_f32 v138,v62,v240
 v_mfma_f32_16x16x32_bf16 v[108:111],v[44:47],v[204:207],v[108:111]
 ds_read_b64_tr_b16 v[36:37],v8 offset:18432
 ds_read_b64_tr_b16 v[38:39],v8 offset:21504
 v_mfma_f32_16x16x32_bf16 v[108:111],v[40:43],v[196:199],v[108:111]
 s_waitcnt lgkmcnt(8)
 v_fmac_f32 v139,v63,v240
 v_mul_f32 v48,v128,v128
 v_mfma_f32_16x16x32_bf16 v[64:67],v[16:19],v[208:211],v[64:67]
 ds_read_b64_tr_b16 v[40:41],v9 offset:12288
 ds_read_b64_tr_b16 v[42:43],v9 offset:15360
 v_mfma_f32_16x16x32_bf16 v[64:67],v[20:23],v[216:219],v[64:67]
 s_add_u32 s75,s74,2048
 v_mul_f32 v49,v129,v129
 v_mul_f32 v50,v130,v130
 v_mfma_f32_16x16x32_bf16 v[68:71],v[20:23],v[220:223],v[68:71]
 buffer_load_dwordx4 a[224:227],v4,s[4:7],s75 offen sc1
 ds_read_b64_tr_b16 v[44:45],v9 offset:18432
 ds_read_b64_tr_b16 v[46:47],v9 offset:21504
 v_mfma_f32_16x16x32_bf16 v[68:71],v[16:19],v[212:215],v[68:71]
 v_mul_f32 v51,v131,v131
 v_mul_f32 v52,v136,v136
 v_mfma_f32_16x16x32_bf16 v[228:231],v[16:19],v[224:227],v[228:231]
 v_mul_f32 v53,v137,v137
 v_mul_f32 v54,v138,v138
 v_mfma_f32_16x16x32_bf16 v[228:231],v[20:23],v[224:227],v[228:231]
 s_waitcnt lgkmcnt(8)
 v_mul_f32 v55,v139,v139
 v_fma_f32 v48,v48,v242,v243
 v_mfma_f32_16x16x32_bf16 v[72:75],v[24:27],v[208:211],v[72:75]
 ds_read_b64_tr_b16 v[16:17],v10 offset:12288
 ds_read_b64_tr_b16 v[18:19],v10 offset:15360
 v_mfma_f32_16x16x32_bf16 v[72:75],v[28:31],v[216:219],v[72:75]
 v_fma_f32 v49,v49,v242,v243
 v_fma_f32 v50,v50,v242,v243
 v_mfma_f32_16x16x32_bf16 v[76:79],v[28:31],v[220:223],v[76:79]
 ds_read_b64_tr_b16 v[20:21],v10 offset:18432
 ds_read_b64_tr_b16 v[22:23],v10 offset:21504
 v_mfma_f32_16x16x32_bf16 v[76:79],v[24:27],v[212:215],v[76:79]
 v_fma_f32 v51,v51,v242,v243
 v_fma_f32 v52,v52,v242,v243
 v_mfma_f32_16x16x32_bf16 v[232:235],v[24:27],v[224:227],v[232:235]
 v_fma_f32 v53,v53,v242,v243
 v_fma_f32 v54,v54,v242,v243
 v_mfma_f32_16x16x32_bf16 v[232:235],v[28:31],v[224:227],v[232:235]
 buffer_load_dwordx4 a[240:243],v4,s[4:7],s75 offen offset:1024 sc1
 s_waitcnt lgkmcnt(8)
 v_fma_f32 v55,v55,v242,v243
 v_mul_f32 v48,v48,v128
 v_mfma_f32_16x16x32_bf16 v[80:83],v[32:35],v[208:211],v[80:83]
 ds_read_b64_tr_b16 v[24:25],v11 offset:12288
 ds_read_b64_tr_b16 v[26:27],v11 offset:15360
 v_mfma_f32_16x16x32_bf16 v[80:83],v[36:39],v[216:219],v[80:83]
 v_mul_f32 v49,v49,v129
 v_mul_f32 v50,v50,v130
 v_mfma_f32_16x16x32_bf16 v[84:87],v[36:39],v[220:223],v[84:87]
 ds_read_b64_tr_b16 v[28:29],v11 offset:18432
 ds_read_b64_tr_b16 v[30:31],v11 offset:21504
 v_mfma_f32_16x16x32_bf16 v[84:87],v[32:35],v[212:215],v[84:87]
 s_waitcnt lgkmcnt(8)
 v_mul_f32 v51,v51,v131
 v_mul_f32 v52,v52,v136
 v_mfma_f32_16x16x32_bf16 v[88:91],v[40:43],v[208:211],v[88:91]
 v_mul_f32 v53,v53,v137
 v_mul_f32 v54,v54,v138
 v_mfma_f32_16x16x32_bf16 v[88:91],v[44:47],v[216:219],v[88:91]
 v_mul_f32 v55,v55,v139
 v_mfma_f32_16x16x32_bf16 v[92:95],v[44:47],v[220:223],v[92:95]
 s_add_u32 s75,s74,198656
 v_exp_f32 v48,v48
 v_mfma_f32_16x16x32_bf16 v[92:95],v[40:43],v[212:215],v[92:95]
 s_waitcnt lgkmcnt(4)
 v_exp_f32 v49,v49
 v_mfma_f32_16x16x32_bf16 v[96:99],v[16:19],v[208:211],v[96:99]
 buffer_load_dwordx4 a[228:231],v4,s[4:7],s75 offen sc1
 v_exp_f32 v50,v50
 v_mfma_f32_16x16x32_bf16 v[96:99],v[20:23],v[216:219],v[96:99]
 ds_write_b128 v251,v[228:231] offset:512
 ds_write_b128 v251,v[232:235] offset:576
 v_mfma_f32_16x16x32_bf16 v[100:103],v[20:23],v[220:223],v[100:103]
 v_exp_f32 v51,v51
 v_mfma_f32_16x16x32_bf16 v[100:103],v[16:19],v[212:215],v[100:103]
 s_waitcnt lgkmcnt(2)
 v_exp_f32 v52,v52
 v_mfma_f32_16x16x32_bf16 v[104:107],v[24:27],v[208:211],v[104:107]
 v_exp_f32 v53,v53
 v_mfma_f32_16x16x32_bf16 v[104:107],v[28:31],v[216:219],v[104:107]
 v_exp_f32 v54,v54
 v_mfma_f32_16x16x32_bf16 v[108:111],v[28:31],v[220:223],v[108:111]
 s_waitcnt lgkmcnt(0)
 s_barrier
 v_mfma_f32_16x16x32_bf16 v[108:111],v[24:27],v[212:215],v[108:111]
 s_add_u32 m0,s35,0
 s_add_u32 s39,s39,81920
 buffer_load_dwordx4 v1,s[12:15],s39 offen lds
 buffer_load_dwordx4 v2,s[12:15],s39 offen offset:1024 lds
 buffer_load_dwordx4 v3,s[12:15],s39 offen offset:2048 lds
 v_exp_f32 v55,v55
 ds_read_b128 v[168:171],v251 offset:512
 ds_read_b128 v[172:175],v251 offset:576
 ds_read_b128 v[176:179],v252 offset:512
 ds_read_b128 v[180:183],v252 offset:576
 ds_read_b128 v[184:187],v253 offset:512
 ds_read_b128 v[188:191],v253 offset:576
 v_fma_f32 v48,v48,v241,v241
 v_fma_f32 v49,v49,v241,v241
 v_fma_f32 v50,v50,v241,v241
 v_fma_f32 v51,v51,v241,v241
 v_fma_f32 v52,v52,v241,v241
 v_fma_f32 v53,v53,v241,v241
 v_fma_f32 v54,v54,v241,v241
 v_fma_f32 v55,v55,v241,v241
 v_rcp_f32 v48,v48
 buffer_load_dwordx4 a[244:247],v4,s[4:7],s75 offen offset:1024 sc1
 v_rcp_f32 v49,v49
 v_rcp_f32 v50,v50
 v_rcp_f32 v51,v51
 v_rcp_f32 v52,v52
 v_rcp_f32 v53,v53
 v_rcp_f32 v54,v54
 v_rcp_f32 v55,v55
 v_mul_f32 v128,v128,v48
 v_mul_f32 v129,v129,v49
 v_mul_f32 v130,v130,v50
 s_add_u32 m0,s35,3072
 s_add_u32 s44,s39,10240
 buffer_load_dwordx4 v1,s[12:15],s44 offen lds
 v_mul_f32 v131,v131,v51
 v_mul_f32 v136,v136,v52
 v_mul_f32 v137,v137,v53
 v_mul_f32 v138,v138,v54
 v_mul_f32 v139,v139,v55
 v_cvt_pk_bf16_f32 v128,v128,v129
 v_cvt_pk_bf16_f32 v129,v130,v131
 v_cvt_pk_bf16_f32 v130,v136,v137
 v_cvt_pk_bf16_f32 v131,v138,v139
 v_fmac_f32 v132,v56,v244
 v_fmac_f32 v133,v57,v244
 v_fmac_f32 v134,v58,v244
 v_fmac_f32 v135,v59,v244
 v_fmac_f32 v140,v60,v244
 v_fmac_f32 v141,v61,v244
 v_fmac_f32 v142,v62,v244
 v_fmac_f32 v143,v63,v244
 v_mul_f32 v48,v132,v132
 s_add_u32 s47,s57,0
 buffer_store_dwordx4 v[128:131],v4,s[28:31],s47 offen sc1
 v_mul_f32 v49,v133,v133
 v_mul_f32 v50,v134,v134
 v_mul_f32 v51,v135,v135
 v_mul_f32 v52,v140,v140
 v_mul_f32 v53,v141,v141
 v_mul_f32 v54,v142,v142
 v_mul_f32 v55,v143,v143
 v_fma_f32 v48,v48,v246,v247
 v_fma_f32 v49,v49,v246,v247
 v_fma_f32 v50,v50,v246,v247
 v_fma_f32 v51,v51,v246,v247
 v_fma_f32 v52,v52,v246,v247
 v_fma_f32 v53,v53,v246,v247
 v_fma_f32 v54,v54,v246,v247
 v_fma_f32 v55,v55,v246,v247
 v_mul_f32 v48,v48,v132
 v_mul_f32 v49,v49,v133
 v_mul_f32 v50,v50,v134
 v_mul_f32 v51,v51,v135
 v_mul_f32 v52,v52,v140
 v_mul_f32 v53,v53,v141
 v_mul_f32 v54,v54,v142
 v_mul_f32 v55,v55,v143
 v_exp_f32 v48,v48
 v_exp_f32 v49,v49
 v_exp_f32 v50,v50
 v_exp_f32 v51,v51
 v_exp_f32 v52,v52
 v_exp_f32 v53,v53
 buffer_load_dwordx4 v2,s[12:15],s44 offen offset:1024 lds
 v_exp_f32 v54,v54
 v_exp_f32 v55,v55
 v_fma_f32 v48,v48,v245,v245
 v_fma_f32 v49,v49,v245,v245
 v_fma_f32 v50,v50,v245,v245
 v_fma_f32 v51,v51,v245,v245
 v_fma_f32 v52,v52,v245,v245
 v_fma_f32 v53,v53,v245,v245
 v_fma_f32 v54,v54,v245,v245
 v_fma_f32 v55,v55,v245,v245
 v_rcp_f32 v48,v48
 v_rcp_f32 v49,v49
 v_rcp_f32 v50,v50
 s_add_u32 s75,s74,395264
 buffer_load_dwordx4 a[232:235],v4,s[4:7],s75 offen sc1
 v_rcp_f32 v51,v51
 v_rcp_f32 v52,v52
 v_rcp_f32 v53,v53
 v_rcp_f32 v54,v54
 v_rcp_f32 v55,v55
 v_mul_f32 v132,v132,v48
 v_mul_f32 v133,v133,v49
 v_mul_f32 v134,v134,v50
 v_mul_f32 v135,v135,v51
 v_mul_f32 v140,v140,v52
 v_mul_f32 v141,v141,v53
 v_mul_f32 v142,v142,v54
 v_mul_f32 v143,v143,v55
 buffer_load_dwordx4 v3,s[12:15],s44 offen offset:2048 lds
 v_cvt_pk_bf16_f32 v132,v132,v133
 v_cvt_pk_bf16_f32 v133,v134,v135
 v_cvt_pk_bf16_f32 v134,v140,v141
 v_cvt_pk_bf16_f32 v135,v142,v143
 ds_read_b128 v[56:59],v253
 ds_read_b128 v[60:63],v253 offset:64
 s_waitcnt lgkmcnt(0)
 v_fmac_f32 v144,v56,v240
 v_fmac_f32 v145,v57,v240
 v_fmac_f32 v146,v58,v240
 v_fmac_f32 v147,v59,v240
 v_fmac_f32 v152,v60,v240
 v_fmac_f32 v153,v61,v240
 v_fmac_f32 v154,v62,v240
 v_fmac_f32 v155,v63,v240
 v_mul_f32 v48,v144,v144
 v_mul_f32 v49,v145,v145
 v_mul_f32 v50,v146,v146
 s_add_u32 s47,s57,49152
 buffer_store_dwordx4 v[132:135],v4,s[28:31],s47 offen sc1
 v_mul_f32 v51,v147,v147
 v_mul_f32 v52,v152,v152
 v_mul_f32 v53,v153,v153
 v_mul_f32 v54,v154,v154
 v_mul_f32 v55,v155,v155
 v_fma_f32 v48,v48,v242,v243
 v_fma_f32 v49,v49,v242,v243
 v_fma_f32 v50,v50,v242,v243
 v_fma_f32 v51,v51,v242,v243
 v_fma_f32 v52,v52,v242,v243
 v_fma_f32 v53,v53,v242,v243
 v_fma_f32 v54,v54,v242,v243
 v_fma_f32 v55,v55,v242,v243
 v_mul_f32 v48,v48,v144
 v_mul_f32 v49,v49,v145
 v_mul_f32 v50,v50,v146
 v_mul_f32 v51,v51,v147
 v_mul_f32 v52,v52,v152
 v_mul_f32 v53,v53,v153
 v_mul_f32 v54,v54,v154
 v_mul_f32 v55,v55,v155
 v_exp_f32 v48,v48
 v_exp_f32 v49,v49
 v_exp_f32 v50,v50
 v_exp_f32 v51,v51
 v_exp_f32 v52,v52
 v_exp_f32 v53,v53
 v_exp_f32 v54,v54
 buffer_load_dwordx4 a[248:251],v4,s[4:7],s75 offen offset:1024 sc1
 v_exp_f32 v55,v55
 v_fma_f32 v48,v48,v241,v241
 v_fma_f32 v49,v49,v241,v241
 v_fma_f32 v50,v50,v241,v241
 v_fma_f32 v51,v51,v241,v241
 v_fma_f32 v52,v52,v241,v241
 v_fma_f32 v53,v53,v241,v241
 v_fma_f32 v54,v54,v241,v241
 v_fma_f32 v55,v55,v241,v241
 v_rcp_f32 v48,v48
 v_rcp_f32 v49,v49
 v_rcp_f32 v50,v50
 v_rcp_f32 v51,v51
 s_add_u32 m0,s35,122880
 s_add_u32 s39,s39,81920
 buffer_load_dwordx4 v1,s[12:15],s39 offen lds
 v_rcp_f32 v52,v52
 v_rcp_f32 v53,v53
 v_rcp_f32 v54,v54
 v_rcp_f32 v55,v55
 v_mul_f32 v144,v144,v48
 v_mul_f32 v145,v145,v49
 v_mul_f32 v146,v146,v50
 v_mul_f32 v147,v147,v51
 v_mul_f32 v152,v152,v52
 v_mul_f32 v153,v153,v53
 v_mul_f32 v154,v154,v54
 v_mul_f32 v155,v155,v55
 v_cvt_pk_bf16_f32 v144,v144,v145
 v_cvt_pk_bf16_f32 v145,v146,v147
 buffer_load_dwordx4 v2,s[12:15],s39 offen offset:1024 lds
 v_cvt_pk_bf16_f32 v146,v152,v153
 v_cvt_pk_bf16_f32 v147,v154,v155
 v_fmac_f32 v148,v56,v244
 v_fmac_f32 v149,v57,v244
 v_fmac_f32 v150,v58,v244
 v_fmac_f32 v151,v59,v244
 v_fmac_f32 v156,v60,v244
 v_fmac_f32 v157,v61,v244
 v_fmac_f32 v158,v62,v244
 v_fmac_f32 v159,v63,v244
 v_mul_f32 v48,v148,v148
 v_mul_f32 v49,v149,v149
 v_mul_f32 v50,v150,v150
 v_mul_f32 v51,v151,v151
 v_mul_f32 v52,v156,v156
 v_mul_f32 v53,v157,v157
 v_mul_f32 v54,v158,v158
 v_mul_f32 v55,v159,v159
 s_add_u32 s47,s58,0
 buffer_store_dwordx4 v[144:147],v4,s[28:31],s47 offen sc1
 v_fma_f32 v48,v48,v246,v247
 v_fma_f32 v49,v49,v246,v247
 v_fma_f32 v50,v50,v246,v247
 v_fma_f32 v51,v51,v246,v247
 v_fma_f32 v52,v52,v246,v247
 v_fma_f32 v53,v53,v246,v247
 v_fma_f32 v54,v54,v246,v247
 v_fma_f32 v55,v55,v246,v247
 v_mul_f32 v48,v48,v148
 v_mul_f32 v49,v49,v149
 v_mul_f32 v50,v50,v150
 v_mul_f32 v51,v51,v151
 v_mul_f32 v52,v52,v156
 v_mul_f32 v53,v53,v157
 v_mul_f32 v54,v54,v158
 v_mul_f32 v55,v55,v159
 v_exp_f32 v48,v48
 v_exp_f32 v49,v49
 v_exp_f32 v50,v50
 v_exp_f32 v51,v51
 v_exp_f32 v52,v52
 v_exp_f32 v53,v53
 v_exp_f32 v54,v54
 v_exp_f32 v55,v55
 v_fma_f32 v48,v48,v245,v245
 v_fma_f32 v49,v49,v245,v245
 v_fma_f32 v50,v50,v245,v245
 s_add_u32 s75,s74,591872
 buffer_load_dwordx4 a[236:239],v4,s[4:7],s75 offen sc1
 v_fma_f32 v51,v51,v245,v245
 v_fma_f32 v52,v52,v245,v245
 v_fma_f32 v53,v53,v245,v245
 v_fma_f32 v54,v54,v245,v245
 v_fma_f32 v55,v55,v245,v245
 v_rcp_f32 v48,v48
 v_rcp_f32 v49,v49
 v_rcp_f32 v50,v50
 v_rcp_f32 v51,v51
 v_rcp_f32 v52,v52
 v_rcp_f32 v53,v53
 v_rcp_f32 v54,v54
 buffer_load_dwordx4 v3,s[12:15],s39 offen offset:2048 lds
 v_rcp_f32 v55,v55
 v_mul_f32 v148,v148,v48
 v_mul_f32 v149,v149,v49
 v_mul_f32 v150,v150,v50
 v_mul_f32 v151,v151,v51
 v_mul_f32 v156,v156,v52
 v_mul_f32 v157,v157,v53
 v_mul_f32 v158,v158,v54
 v_mul_f32 v159,v159,v55
 v_cvt_pk_bf16_f32 v148,v148,v149
 v_cvt_pk_bf16_f32 v149,v150,v151
 v_cvt_pk_bf16_f32 v150,v156,v157
 v_cvt_pk_bf16_f32 v151,v158,v159
 s_waitcnt lgkmcnt(6)
 v_fmac_f32 v64,v168,v240
 v_fmac_f32 v65,v169,v240
 s_add_u32 s47,s58,49152
 buffer_store_dwordx4 v[148:151],v4,s[28:31],s47 offen sc1
 v_fmac_f32 v66,v170,v240
 v_fmac_f32 v67,v171,v240
 v_fmac_f32 v72,v172,v240
 v_fmac_f32 v73,v173,v240
 v_fmac_f32 v74,v174,v240
 v_fmac_f32 v75,v175,v240
 v_mul_f32 v160,v64,v64
 v_mul_f32 v161,v65,v65
 v_mul_f32 v162,v66,v66
 v_mul_f32 v163,v67,v67
 v_mul_f32 v164,v72,v72
 v_mul_f32 v165,v73,v73
 v_mul_f32 v166,v74,v74
 v_mul_f32 v167,v75,v75
 v_fma_f32 v160,v160,v242,v243
 v_fma_f32 v161,v161,v242,v243
 v_fma_f32 v162,v162,v242,v243
 v_fma_f32 v163,v163,v242,v243
 v_fma_f32 v164,v164,v242,v243
 v_fma_f32 v165,v165,v242,v243
 v_fma_f32 v166,v166,v242,v243
 v_fma_f32 v167,v167,v242,v243
 v_mul_f32 v160,v160,v64
 v_mul_f32 v161,v161,v65
 v_mul_f32 v162,v162,v66
 v_mul_f32 v163,v163,v67
 v_mul_f32 v164,v164,v72
 v_mul_f32 v165,v165,v73
 v_mul_f32 v166,v166,v74
 v_mul_f32 v167,v167,v75
 v_exp_f32 v160,v160
 v_exp_f32 v161,v161
 v_exp_f32 v162,v162
 s_add_u32 m0,s35,125952
 s_add_u32 s44,s39,10240
 buffer_load_dwordx4 v1,s[12:15],s44 offen lds
 v_exp_f32 v163,v163
 v_exp_f32 v164,v164
 v_exp_f32 v165,v165
 v_exp_f32 v166,v166
 v_exp_f32 v167,v167
 v_fma_f32 v160,v160,v241,v241
 v_fma_f32 v161,v161,v241,v241
 v_fma_f32 v162,v162,v241,v241
 v_fma_f32 v163,v163,v241,v241
 v_fma_f32 v164,v164,v241,v241
 v_fma_f32 v165,v165,v241,v241
 v_fma_f32 v166,v166,v241,v241
 buffer_load_dwordx4 a[252:255],v4,s[4:7],s75 offen offset:1024 sc1
 v_fma_f32 v167,v167,v241,v241
 v_rcp_f32 v160,v160
 v_rcp_f32 v161,v161
 v_rcp_f32 v162,v162
 v_rcp_f32 v163,v163
 v_rcp_f32 v164,v164
 v_rcp_f32 v165,v165
 v_rcp_f32 v166,v166
 v_rcp_f32 v167,v167
 v_mul_f32 v64,v64,v160
 buffer_load_dwordx4 v2,s[12:15],s44 offen offset:1024 lds
 v_mul_f32 v65,v65,v161
 v_mul_f32 v66,v66,v162
 v_mul_f32 v67,v67,v163
 v_mul_f32 v72,v72,v164
 v_mul_f32 v73,v73,v165
 v_mul_f32 v74,v74,v166
 v_mul_f32 v75,v75,v167
 v_cvt_pk_bf16_f32 v64,v64,v65
 v_cvt_pk_bf16_f32 v65,v66,v67
 v_cvt_pk_bf16_f32 v66,v72,v73
 v_cvt_pk_bf16_f32 v67,v74,v75
 v_fmac_f32 v68,v168,v244
 v_fmac_f32 v69,v169,v244
 v_fmac_f32 v70,v170,v244
 v_fmac_f32 v71,v171,v244
 v_fmac_f32 v76,v172,v244
 v_fmac_f32 v77,v173,v244
 v_fmac_f32 v78,v174,v244
 s_add_u32 s47,s56,3072
 buffer_store_dwordx4 v[64:67],v4,s[28:31],s47 offen sc1
 v_fmac_f32 v79,v175,v244
 v_mul_f32 v160,v68,v68
 v_mul_f32 v161,v69,v69
 v_mul_f32 v162,v70,v70
 v_mul_f32 v163,v71,v71
 v_mul_f32 v164,v76,v76
 v_mul_f32 v165,v77,v77
 v_mul_f32 v166,v78,v78
 v_mul_f32 v167,v79,v79
 v_fma_f32 v160,v160,v246,v247
 v_fma_f32 v161,v161,v246,v247
 v_fma_f32 v162,v162,v246,v247
 v_fma_f32 v163,v163,v246,v247
 v_fma_f32 v164,v164,v246,v247
 v_fma_f32 v165,v165,v246,v247
 v_fma_f32 v166,v166,v246,v247
 v_fma_f32 v167,v167,v246,v247
 v_mul_f32 v160,v160,v68
 v_mul_f32 v161,v161,v69
 v_mul_f32 v162,v162,v70
 v_mul_f32 v163,v163,v71
 v_mul_f32 v164,v164,v76
 v_mul_f32 v165,v165,v77
 v_mul_f32 v166,v166,v78
 v_mul_f32 v167,v167,v79
 v_exp_f32 v160,v160
 v_exp_f32 v161,v161
 v_exp_f32 v162,v162
 v_exp_f32 v163,v163
 v_exp_f32 v164,v164
 buffer_load_dwordx4 v3,s[12:15],s44 offen offset:2048 lds
 v_exp_f32 v165,v165
 v_exp_f32 v166,v166
 v_exp_f32 v167,v167
 v_fma_f32 v160,v160,v245,v245
 v_fma_f32 v161,v161,v245,v245
 v_fma_f32 v162,v162,v245,v245
 v_fma_f32 v163,v163,v245,v245
 v_fma_f32 v164,v164,v245,v245
 v_fma_f32 v165,v165,v245,v245
 v_fma_f32 v166,v166,v245,v245
 v_fma_f32 v167,v167,v245,v245
 v_rcp_f32 v160,v160
 v_rcp_f32 v161,v161
 s_add_u32 s75,s74,4096
 buffer_load_dwordx4 a[160:163],v4,s[4:7],s75 offen sc1
 v_rcp_f32 v162,v162
 v_rcp_f32 v163,v163
 v_rcp_f32 v164,v164
 v_rcp_f32 v165,v165
 v_rcp_f32 v166,v166
 v_rcp_f32 v167,v167
 v_mul_f32 v68,v68,v160
 v_mul_f32 v69,v69,v161
 v_mul_f32 v70,v70,v162
 v_mul_f32 v71,v71,v163
 v_mul_f32 v76,v76,v164
 v_mul_f32 v77,v77,v165
 v_mul_f32 v78,v78,v166
 v_mul_f32 v79,v79,v167
 v_cvt_pk_bf16_f32 v68,v68,v69
 v_cvt_pk_bf16_f32 v69,v70,v71
 v_cvt_pk_bf16_f32 v70,v76,v77
 v_cvt_pk_bf16_f32 v71,v78,v79
 s_waitcnt lgkmcnt(4)
 v_fmac_f32 v80,v176,v240
 v_fmac_f32 v81,v177,v240
 v_fmac_f32 v82,v178,v240
 v_fmac_f32 v83,v179,v240
 v_fmac_f32 v88,v180,v240
 v_fmac_f32 v89,v181,v240
 s_add_u32 s47,s56,52224
 buffer_store_dwordx4 v[68:71],v4,s[28:31],s47 offen sc1
 v_fmac_f32 v90,v182,v240
 v_fmac_f32 v91,v183,v240
 v_mul_f32 v160,v80,v80
 v_mul_f32 v161,v81,v81
 v_mul_f32 v162,v82,v82
 v_mul_f32 v163,v83,v83
 v_mul_f32 v164,v88,v88
 v_mul_f32 v165,v89,v89
 v_mul_f32 v166,v90,v90
 v_mul_f32 v167,v91,v91
 v_fma_f32 v160,v160,v242,v243
 v_fma_f32 v161,v161,v242,v243
 v_fma_f32 v162,v162,v242,v243
 v_fma_f32 v163,v163,v242,v243
 v_fma_f32 v164,v164,v242,v243
 v_fma_f32 v165,v165,v242,v243
 v_fma_f32 v166,v166,v242,v243
 v_fma_f32 v167,v167,v242,v243
 v_mul_f32 v160,v160,v80
 v_mul_f32 v161,v161,v81
 v_mul_f32 v162,v162,v82
 v_mul_f32 v163,v163,v83
 v_mul_f32 v164,v164,v88
 v_mul_f32 v165,v165,v89
 v_mul_f32 v166,v166,v90
 v_mul_f32 v167,v167,v91
 v_exp_f32 v160,v160
 v_exp_f32 v161,v161
 v_exp_f32 v162,v162
 v_exp_f32 v163,v163
 v_exp_f32 v164,v164
 v_exp_f32 v165,v165
 v_exp_f32 v166,v166
 v_exp_f32 v167,v167
 v_fma_f32 v160,v160,v241,v241
 v_fma_f32 v161,v161,v241,v241
 v_fma_f32 v162,v162,v241,v241
 v_fma_f32 v163,v163,v241,v241
 v_fma_f32 v164,v164,v241,v241
 v_fma_f32 v165,v165,v241,v241
 v_fma_f32 v166,v166,v241,v241
 v_fma_f32 v167,v167,v241,v241
 buffer_load_dwordx4 a[176:179],v4,s[4:7],s75 offen offset:1024 sc1
 v_rcp_f32 v160,v160
 v_rcp_f32 v161,v161
 v_rcp_f32 v162,v162
 v_rcp_f32 v163,v163
 v_rcp_f32 v164,v164
 v_rcp_f32 v165,v165
 v_rcp_f32 v166,v166
 v_rcp_f32 v167,v167
 v_mul_f32 v80,v80,v160
 v_mul_f32 v81,v81,v161
 v_mul_f32 v82,v82,v162
 v_mul_f32 v83,v83,v163
 v_mul_f32 v88,v88,v164
 v_mul_f32 v89,v89,v165
 v_mul_f32 v90,v90,v166
 v_mul_f32 v91,v91,v167
 v_cvt_pk_bf16_f32 v80,v80,v81
 v_cvt_pk_bf16_f32 v81,v82,v83
 v_cvt_pk_bf16_f32 v82,v88,v89
 v_cvt_pk_bf16_f32 v83,v90,v91
 v_fmac_f32 v84,v176,v244
 v_fmac_f32 v85,v177,v244
 v_fmac_f32 v86,v178,v244
 v_fmac_f32 v87,v179,v244
 v_fmac_f32 v92,v180,v244
 v_fmac_f32 v93,v181,v244
 v_fmac_f32 v94,v182,v244
 v_fmac_f32 v95,v183,v244
 v_mul_f32 v160,v84,v84
 s_add_u32 s47,s57,3072
 buffer_store_dwordx4 v[80:83],v4,s[28:31],s47 offen sc1
 v_mul_f32 v161,v85,v85
 v_mul_f32 v162,v86,v86
 v_mul_f32 v163,v87,v87
 v_mul_f32 v164,v92,v92
 v_mul_f32 v165,v93,v93
 v_mul_f32 v166,v94,v94
 v_mul_f32 v167,v95,v95
 v_fma_f32 v160,v160,v246,v247
 v_fma_f32 v161,v161,v246,v247
 v_fma_f32 v162,v162,v246,v247
 v_fma_f32 v163,v163,v246,v247
 v_fma_f32 v164,v164,v246,v247
 v_fma_f32 v165,v165,v246,v247
 v_fma_f32 v166,v166,v246,v247
 v_fma_f32 v167,v167,v246,v247
 v_mul_f32 v160,v160,v84
 v_mul_f32 v161,v161,v85
 v_mul_f32 v162,v162,v86
 v_mul_f32 v163,v163,v87
 v_mul_f32 v164,v164,v92
 v_mul_f32 v165,v165,v93
 v_mul_f32 v166,v166,v94
 v_mul_f32 v167,v167,v95
 v_exp_f32 v160,v160
 v_exp_f32 v161,v161
 v_exp_f32 v162,v162
 v_exp_f32 v163,v163
 v_exp_f32 v164,v164
 v_exp_f32 v165,v165
 v_exp_f32 v166,v166
 v_exp_f32 v167,v167
 v_fma_f32 v160,v160,v245,v245
 v_fma_f32 v161,v161,v245,v245
 v_fma_f32 v162,v162,v245,v245
 v_fma_f32 v163,v163,v245,v245
 v_fma_f32 v164,v164,v245,v245
 v_fma_f32 v165,v165,v245,v245
 v_fma_f32 v166,v166,v245,v245
 v_fma_f32 v167,v167,v245,v245
 v_rcp_f32 v160,v160
 v_rcp_f32 v161,v161
 s_add_u32 s75,s74,200704
 buffer_load_dwordx4 a[164:167],v4,s[4:7],s75 offen sc1
 v_rcp_f32 v162,v162
 v_rcp_f32 v163,v163
 v_rcp_f32 v164,v164
 v_rcp_f32 v165,v165
 v_rcp_f32 v166,v166
 v_rcp_f32 v167,v167
 v_mul_f32 v84,v84,v160
 v_mul_f32 v85,v85,v161
 v_mul_f32 v86,v86,v162
 v_mul_f32 v87,v87,v163
 v_mul_f32 v92,v92,v164
 v_mul_f32 v93,v93,v165
 v_mul_f32 v94,v94,v166
 v_mul_f32 v95,v95,v167
 v_cvt_pk_bf16_f32 v84,v84,v85
 v_cvt_pk_bf16_f32 v85,v86,v87
 v_cvt_pk_bf16_f32 v86,v92,v93
 v_cvt_pk_bf16_f32 v87,v94,v95
 s_waitcnt lgkmcnt(2)
 v_fmac_f32 v96,v184,v240
 v_fmac_f32 v97,v185,v240
 v_fmac_f32 v98,v186,v240
 v_fmac_f32 v99,v187,v240
 v_fmac_f32 v104,v188,v240
 v_fmac_f32 v105,v189,v240
 v_fmac_f32 v106,v190,v240
 v_fmac_f32 v107,v191,v240
 v_mul_f32 v160,v96,v96
 v_mul_f32 v161,v97,v97
 v_mul_f32 v162,v98,v98
 s_add_u32 s47,s57,52224
 buffer_store_dwordx4 v[84:87],v4,s[28:31],s47 offen sc1
 v_mul_f32 v163,v99,v99
 v_mul_f32 v164,v104,v104
 v_mul_f32 v165,v105,v105
 v_mul_f32 v166,v106,v106
 v_mul_f32 v167,v107,v107
 v_fma_f32 v160,v160,v242,v243
 v_fma_f32 v161,v161,v242,v243
 v_fma_f32 v162,v162,v242,v243
 v_fma_f32 v163,v163,v242,v243
 v_fma_f32 v164,v164,v242,v243
 v_fma_f32 v165,v165,v242,v243
 v_fma_f32 v166,v166,v242,v243
 v_fma_f32 v167,v167,v242,v243
 v_mul_f32 v160,v160,v96
 v_mul_f32 v161,v161,v97
 s_waitcnt vmcnt(59)
 s_barrier
 ds_read_b64_tr_b16 v[32:33],v236
 ds_read_b64_tr_b16 v[34:35],v236 offset:6144
 ds_read_b64_tr_b16 v[36:37],v236 offset:12288
 ds_read_b64_tr_b16 v[38:39],v236 offset:18432
 ds_read_b64_tr_b16 v[40:41],v237
 ds_read_b64_tr_b16 v[42:43],v237 offset:6144
 ds_read_b64_tr_b16 v[44:45],v237 offset:12288
 ds_read_b64_tr_b16 v[46:47],v237 offset:18432
 v_mul_f32 v162,v162,v98
 v_mul_f32 v163,v163,v99
 v_mul_f32 v164,v164,v104
 v_mul_f32 v165,v165,v105
 v_mul_f32 v166,v166,v106
 v_mul_f32 v167,v167,v107
 v_exp_f32 v160,v160
 v_exp_f32 v161,v161
 v_exp_f32 v162,v162
 v_exp_f32 v163,v163
 v_exp_f32 v164,v164
 v_exp_f32 v165,v165
 buffer_load_dwordx4 a[180:183],v4,s[4:7],s75 offen offset:1024 sc1
 v_exp_f32 v166,v166
 v_exp_f32 v167,v167
 v_fma_f32 v160,v160,v241,v241
 v_fma_f32 v161,v161,v241,v241
 v_fma_f32 v162,v162,v241,v241
 v_fma_f32 v163,v163,v241,v241
 v_fma_f32 v164,v164,v241,v241
 v_fma_f32 v165,v165,v241,v241
 v_fma_f32 v166,v166,v241,v241
 v_fma_f32 v167,v167,v241,v241
 v_rcp_f32 v160,v160
 v_rcp_f32 v161,v161
 v_rcp_f32 v162,v162
 v_rcp_f32 v163,v163
 v_rcp_f32 v164,v164
 v_rcp_f32 v165,v165
 v_rcp_f32 v166,v166
 v_rcp_f32 v167,v167
 v_mul_f32 v96,v96,v160
 v_mul_f32 v97,v97,v161
 v_mul_f32 v98,v98,v162
 v_mul_f32 v99,v99,v163
 v_mul_f32 v104,v104,v164
 v_mul_f32 v105,v105,v165
 v_mul_f32 v106,v106,v166
 v_mul_f32 v107,v107,v167
 s_add_u32 s75,s74,397312
 buffer_load_dwordx4 a[168:171],v4,s[4:7],s75 offen sc1
 v_cvt_pk_bf16_f32 v96,v96,v97
 v_cvt_pk_bf16_f32 v97,v98,v99
 s_waitcnt vmcnt(35) lgkmcnt(4)
 v_mfma_f32_16x16x32_bf16 a[0:3],v[32:35],a[192:195],a[0:3]
 ds_read_b64_tr_b16 v[16:17],v238
 ds_read_b64_tr_b16 v[18:19],v238 offset:6144
 v_mfma_f32_16x16x32_bf16 a[0:3],v[36:39],a[208:211],a[0:3]
 v_cvt_pk_bf16_f32 v98,v104,v105
 v_cvt_pk_bf16_f32 v99,v106,v107
 v_mfma_f32_16x16x32_bf16 a[4:7],v[36:39],a[212:215],a[4:7]
 v_fmac_f32 v100,v184,v244
 v_fmac_f32 v101,v185,v244
 v_mfma_f32_16x16x32_bf16 a[4:7],v[32:35],a[196:199],a[4:7]
 ds_read_b64_tr_b16 v[20:21],v238 offset:12288
 ds_read_b64_tr_b16 v[22:23],v238 offset:18432
 v_mfma_f32_16x16x32_bf16 a[8:11],v[32:35],a[200:203],a[8:11]
 v_fmac_f32 v102,v186,v244
 v_fmac_f32 v103,v187,v244
 v_mfma_f32_16x16x32_bf16 a[8:11],v[36:39],a[216:219],a[8:11]
 v_fmac_f32 v108,v188,v244
 v_fmac_f32 v109,v189,v244
 v_mfma_f32_16x16x32_bf16 a[12:15],v[36:39],a[220:223],a[12:15]
 s_add_u32 s47,s58,3072
 v_fmac_f32 v110,v190,v244
 v_fmac_f32 v111,v191,v244
 v_mfma_f32_16x16x32_bf16 a[12:15],v[32:35],a[204:207],a[12:15]
 s_waitcnt lgkmcnt(4)
 v_mul_f32 v160,v100,v100
 v_mul_f32 v161,v101,v101
 v_mfma_f32_16x16x32_bf16 a[16:19],v[40:43],a[192:195],a[16:19]
 buffer_store_dwordx4 v[96:99],v4,s[28:31],s47 offen sc1
 ds_read_b64_tr_b16 v[24:25],v239
 ds_read_b64_tr_b16 v[26:27],v239 offset:6144
 v_mfma_f32_16x16x32_bf16 a[16:19],v[44:47],a[208:211],a[16:19]
 v_mul_f32 v162,v102,v102
 v_mul_f32 v163,v103,v103
 v_mfma_f32_16x16x32_bf16 a[20:23],v[44:47],a[212:215],a[20:23]
 v_mul_f32 v164,v108,v108
 v_mul_f32 v165,v109,v109
 v_mfma_f32_16x16x32_bf16 a[20:23],v[40:43],a[196:199],a[20:23]
 ds_read_b64_tr_b16 v[28:29],v239 offset:12288
 ds_read_b64_tr_b16 v[30:31],v239 offset:18432
 v_mfma_f32_16x16x32_bf16 a[24:27],v[40:43],a[200:203],a[24:27]
 v_mul_f32 v166,v110,v110
 v_mul_f32 v167,v111,v111
 v_mfma_f32_16x16x32_bf16 a[24:27],v[44:47],a[216:219],a[24:27]
 v_fma_f32 v160,v160,v246,v247
 v_fma_f32 v161,v161,v246,v247
 v_mfma_f32_16x16x32_bf16 a[28:31],v[44:47],a[220:223],a[28:31]
 v_fma_f32 v162,v162,v246,v247
 v_fma_f32 v163,v163,v246,v247
 v_mfma_f32_16x16x32_bf16 a[28:31],v[40:43],a[204:207],a[28:31]
 s_waitcnt lgkmcnt(4)
 v_fma_f32 v164,v164,v246,v247
 v_fma_f32 v165,v165,v246,v247
 v_mfma_f32_16x16x32_bf16 a[32:35],v[16:19],a[192:195],a[32:35]
 ds_read_b64_tr_b16 v[32:33],v236 offset:128
 ds_read_b64_tr_b16 v[34:35],v236 offset:6272
 v_mfma_f32_16x16x32_bf16 a[32:35],v[20:23],a[208:211],a[32:35]
 v_fma_f32 v166,v166,v246,v247
 v_fma_f32 v167,v167,v246,v247
 v_mfma_f32_16x16x32_bf16 a[36:39],v[20:23],a[212:215],a[36:39]
 v_mul_f32 v160,v160,v100
 v_mul_f32 v161,v161,v101
 v_mfma_f32_16x16x32_bf16 a[36:39],v[16:19],a[196:199],a[36:39]
 ds_read_b64_tr_b16 v[36:37],v236 offset:12416
 ds_read_b64_tr_b16 v[38:39],v236 offset:18560
 v_mfma_f32_16x16x32_bf16 a[40:43],v[16:19],a[200:203],a[40:43]
 v_mul_f32 v162,v162,v102
 v_mul_f32 v163,v163,v103
 v_mfma_f32_16x16x32_bf16 a[40:43],v[20:23],a[216:219],a[40:43]
 buffer_load_dwordx4 a[184:187],v4,s[4:7],s75 offen offset:1024 sc1
 v_mul_f32 v164,v164,v108
 v_mul_f32 v165,v165,v109
 v_mfma_f32_16x16x32_bf16 a[44:47],v[20:23],a[220:223],a[44:47]
 v_mul_f32 v166,v166,v110
 v_mul_f32 v167,v167,v111
 v_mfma_f32_16x16x32_bf16 a[44:47],v[16:19],a[204:207],a[44:47]
 s_waitcnt lgkmcnt(4)
 v_exp_f32 v160,v160
 v_mfma_f32_16x16x32_bf16 a[48:51],v[24:27],a[192:195],a[48:51]
 ds_read_b64_tr_b16 v[40:41],v237 offset:128
 ds_read_b64_tr_b16 v[42:43],v237 offset:6272
 v_mfma_f32_16x16x32_bf16 a[48:51],v[28:31],a[208:211],a[48:51]
 v_exp_f32 v161,v161
 v_mfma_f32_16x16x32_bf16 a[52:55],v[28:31],a[212:215],a[52:55]
 v_exp_f32 v162,v162
 v_mfma_f32_16x16x32_bf16 a[52:55],v[24:27],a[196:199],a[52:55]
 ds_read_b64_tr_b16 v[44:45],v237 offset:12416
 ds_read_b64_tr_b16 v[46:47],v237 offset:18560
 v_mfma_f32_16x16x32_bf16 a[56:59],v[24:27],a[200:203],a[56:59]
 v_exp_f32 v163,v163
 v_mfma_f32_16x16x32_bf16 a[56:59],v[28:31],a[216:219],a[56:59]
 s_add_u32 s75,s74,593920
 v_exp_f32 v164,v164
 v_mfma_f32_16x16x32_bf16 a[60:63],v[28:31],a[220:223],a[60:63]
 buffer_load_dwordx4 a[172:175],v4,s[4:7],s75 offen sc1
 v_exp_f32 v165,v165
 v_mfma_f32_16x16x32_bf16 a[60:63],v[24:27],a[204:207],a[60:63]
 s_waitcnt lgkmcnt(4)
 v_exp_f32 v166,v166
 v_mfma_f32_16x16x32_bf16 a[64:67],v[32:35],a[192:195],a[64:67]
 ds_read_b64_tr_b16 v[16:17],v238 offset:128
 ds_read_b64_tr_b16 v[18:19],v238 offset:6272
 v_mfma_f32_16x16x32_bf16 a[64:67],v[36:39],a[208:211],a[64:67]
 v_exp_f32 v167,v167
 v_mfma_f32_16x16x32_bf16 a[68:71],v[36:39],a[212:215],a[68:71]
 v_fma_f32 v160,v160,v245,v245
 v_fma_f32 v161,v161,v245,v245
 v_mfma_f32_16x16x32_bf16 a[68:71],v[32:35],a[196:199],a[68:71]
 ds_read_b64_tr_b16 v[20:21],v238 offset:12416
 ds_read_b64_tr_b16 v[22:23],v238 offset:18560
 v_mfma_f32_16x16x32_bf16 a[72:75],v[32:35],a[200:203],a[72:75]
 v_fma_f32 v162,v162,v245,v245
 v_fma_f32 v163,v163,v245,v245
 v_mfma_f32_16x16x32_bf16 a[72:75],v[36:39],a[216:219],a[72:75]
 v_fma_f32 v164,v164,v245,v245
 v_fma_f32 v165,v165,v245,v245
 v_mfma_f32_16x16x32_bf16 a[76:79],v[36:39],a[220:223],a[76:79]
 v_fma_f32 v166,v166,v245,v245
 v_fma_f32 v167,v167,v245,v245
 v_mfma_f32_16x16x32_bf16 a[76:79],v[32:35],a[204:207],a[76:79]
 s_waitcnt lgkmcnt(4)
 v_rcp_f32 v160,v160
 v_mfma_f32_16x16x32_bf16 a[80:83],v[40:43],a[192:195],a[80:83]
 buffer_load_dwordx4 a[188:191],v4,s[4:7],s75 offen offset:1024 sc1
 s_cmp_le_u32 s53,1
 s_cselect_b32 s74,2,1
 s_mul_i32 s74,s74,6144
 s_add_u32 s75,s74,0
 buffer_load_dwordx4 v[64:67],v4,s[4:7],s75 offen sc1
 ds_read_b64_tr_b16 v[24:25],v239 offset:128
 ds_read_b64_tr_b16 v[26:27],v239 offset:6272
 v_mfma_f32_16x16x32_bf16 a[80:83],v[44:47],a[208:211],a[80:83]
 v_rcp_f32 v161,v161
 v_mfma_f32_16x16x32_bf16 a[84:87],v[44:47],a[212:215],a[84:87]
 buffer_load_dwordx4 v[80:83],v4,s[4:7],s75 offen offset:1024 sc1
 v_rcp_f32 v162,v162
 v_mfma_f32_16x16x32_bf16 a[84:87],v[40:43],a[196:199],a[84:87]
 ds_read_b64_tr_b16 v[28:29],v239 offset:12416
 ds_read_b64_tr_b16 v[30:31],v239 offset:18560
 v_mfma_f32_16x16x32_bf16 a[88:91],v[40:43],a[200:203],a[88:91]
 v_rcp_f32 v163,v163
 v_mfma_f32_16x16x32_bf16 a[88:91],v[44:47],a[216:219],a[88:91]
 v_rcp_f32 v164,v164
 v_mfma_f32_16x16x32_bf16 a[92:95],v[44:47],a[220:223],a[92:95]
 s_add_u32 s75,s74,196608
 v_rcp_f32 v165,v165
 v_mfma_f32_16x16x32_bf16 a[92:95],v[40:43],a[204:207],a[92:95]
 s_waitcnt lgkmcnt(4)
 v_rcp_f32 v166,v166
 v_mfma_f32_16x16x32_bf16 a[96:99],v[16:19],a[192:195],a[96:99]
 buffer_load_dwordx4 v[68:71],v4,s[4:7],s75 offen sc1
 ds_read_b64_tr_b16 v[32:33],v236 offset:256
 ds_read_b64_tr_b16 v[34:35],v236 offset:6400
 v_mfma_f32_16x16x32_bf16 a[96:99],v[20:23],a[208:211],a[96:99]
 v_rcp_f32 v167,v167
 v_mfma_f32_16x16x32_bf16 a[100:103],v[20:23],a[212:215],a[100:103]
 v_mul_f32 v100,v100,v160
 v_mul_f32 v101,v101,v161
 v_mfma_f32_16x16x32_bf16 a[100:103],v[16:19],a[196:199],a[100:103]
 ds_read_b64_tr_b16 v[36:37],v236 offset:12544
 ds_read_b64_tr_b16 v[38:39],v236 offset:18688
 v_mfma_f32_16x16x32_bf16 a[104:107],v[16:19],a[200:203],a[104:107]
 v_mul_f32 v102,v102,v162
 v_mul_f32 v103,v103,v163
 v_mfma_f32_16x16x32_bf16 a[104:107],v[20:23],a[216:219],a[104:107]
 v_mul_f32 v108,v108,v164
 v_mul_f32 v109,v109,v165
 v_mfma_f32_16x16x32_bf16 a[108:111],v[20:23],a[220:223],a[108:111]
 buffer_load_dwordx4 v[84:87],v4,s[4:7],s75 offen offset:1024 sc1
 v_mul_f32 v110,v110,v166
 v_mul_f32 v111,v111,v167
 v_mfma_f32_16x16x32_bf16 a[108:111],v[16:19],a[204:207],a[108:111]
 s_waitcnt lgkmcnt(4)
 v_cvt_pk_bf16_f32 v100,v100,v101
 v_cvt_pk_bf16_f32 v101,v102,v103
 v_mfma_f32_16x16x32_bf16 a[112:115],v[24:27],a[192:195],a[112:115]
 ds_read_b64_tr_b16 v[40:41],v237 offset:256
 ds_read_b64_tr_b16 v[42:43],v237 offset:6400
 v_mfma_f32_16x16x32_bf16 a[112:115],v[28:31],a[208:211],a[112:115]
 v_cvt_pk_bf16_f32 v102,v108,v109
 v_cvt_pk_bf16_f32 v103,v110,v111
 v_mfma_f32_16x16x32_bf16 a[116:119],v[28:31],a[212:215],a[116:119]
 ds_read_b64_tr_b16 v[44:45],v237 offset:12544
 ds_read_b64_tr_b16 v[46:47],v237 offset:18688
 v_mfma_f32_16x16x32_bf16 a[116:119],v[24:27],a[196:199],a[116:119]
 v_add_u32 v236,49152,v236
 v_add_u32 v237,49152,v237
 v_mfma_f32_16x16x32_bf16 a[120:123],v[24:27],a[200:203],a[120:123]
 s_add_u32 s47,s58,52224
 v_add_u32 v238,49152,v238
 v_add_u32 v239,49152,v239
 v_mfma_f32_16x16x32_bf16 a[120:123],v[28:31],a[216:219],a[120:123]
 buffer_store_dwordx4 v[100:103],v4,s[28:31],s47 offen sc1
 v_mfma_f32_16x16x32_bf16 a[124:127],v[28:31],a[220:223],a[124:127]
 v_mfma_f32_16x16x32_bf16 a[124:127],v[24:27],a[204:207],a[124:127]
 s_waitcnt lgkmcnt(4)
 v_mfma_f32_16x16x32_bf16 a[128:131],v[32:35],a[192:195],a[128:131]
 s_waitcnt vmcnt(63)
 s_barrier
 v_mfma_f32_16x16x32_bf16 a[128:131],v[36:39],a[208:211],a[128:131]
 ds_read_b64_tr_b16 v[16:17],v236
 ds_read_b64_tr_b16 v[18:19],v236 offset:6144
 v_mfma_f32_16x16x32_bf16 a[132:135],v[36:39],a[212:215],a[132:135]
 s_add_u32 s75,s74,393216
 v_mfma_f32_16x16x32_bf16 a[132:135],v[32:35],a[196:199],a[132:135]
 buffer_load_dwordx4 v[72:75],v4,s[4:7],s75 offen sc1
 v_mfma_f32_16x16x32_bf16 a[136:139],v[32:35],a[200:203],a[136:139]
 ds_read_b64_tr_b16 v[20:21],v236 offset:12288
 ds_read_b64_tr_b16 v[22:23],v236 offset:18432
 v_mfma_f32_16x16x32_bf16 a[136:139],v[36:39],a[216:219],a[136:139]
 v_mfma_f32_16x16x32_bf16 a[140:143],v[36:39],a[220:223],a[140:143]
 v_mfma_f32_16x16x32_bf16 a[140:143],v[32:35],a[204:207],a[140:143]
 s_waitcnt lgkmcnt(4)
 v_mfma_f32_16x16x32_bf16 a[144:147],v[40:43],a[192:195],a[144:147]
 ds_read_b64_tr_b16 v[24:25],v237
 ds_read_b64_tr_b16 v[26:27],v237 offset:6144
 v_mfma_f32_16x16x32_bf16 a[144:147],v[44:47],a[208:211],a[144:147]
 buffer_load_dwordx4 v[88:91],v4,s[4:7],s75 offen offset:1024 sc1
 v_mfma_f32_16x16x32_bf16 a[148:151],v[44:47],a[212:215],a[148:151]
 v_mfma_f32_16x16x32_bf16 a[148:151],v[40:43],a[196:199],a[148:151]
 ds_read_b64_tr_b16 v[28:29],v237 offset:12288
 ds_read_b64_tr_b16 v[30:31],v237 offset:18432
 v_mfma_f32_16x16x32_bf16 a[152:155],v[40:43],a[200:203],a[152:155]
 v_mfma_f32_16x16x32_bf16 a[152:155],v[44:47],a[216:219],a[152:155]
 v_mfma_f32_16x16x32_bf16 a[156:159],v[44:47],a[220:223],a[156:159]
 v_mfma_f32_16x16x32_bf16 a[156:159],v[40:43],a[204:207],a[156:159]
 s_waitcnt vmcnt(22) lgkmcnt(4)
 v_mfma_f32_16x16x32_bf16 a[0:3],v[16:19],a[224:227],a[0:3]
 s_add_u32 s75,s74,589824
 ds_read_b64_tr_b16 v[32:33],v238
 ds_read_b64_tr_b16 v[34:35],v238 offset:6144
 v_mfma_f32_16x16x32_bf16 a[0:3],v[20:23],a[240:243],a[0:3]
 buffer_load_dwordx4 v[76:79],v4,s[4:7],s75 offen sc1
 v_mfma_f32_16x16x32_bf16 a[4:7],v[20:23],a[244:247],a[4:7]
 v_mfma_f32_16x16x32_bf16 a[4:7],v[16:19],a[228:231],a[4:7]
 ds_read_b64_tr_b16 v[36:37],v238 offset:12288
 ds_read_b64_tr_b16 v[38:39],v238 offset:18432
 v_mfma_f32_16x16x32_bf16 a[8:11],v[16:19],a[232:235],a[8:11]
 v_mfma_f32_16x16x32_bf16 a[8:11],v[20:23],a[248:251],a[8:11]
 v_mfma_f32_16x16x32_bf16 a[12:15],v[20:23],a[252:255],a[12:15]
 buffer_load_dwordx4 v[92:95],v4,s[4:7],s75 offen offset:1024 sc1
 v_mfma_f32_16x16x32_bf16 a[12:15],v[16:19],a[236:239],a[12:15]
 s_waitcnt lgkmcnt(4)
 v_mfma_f32_16x16x32_bf16 a[16:19],v[24:27],a[224:227],a[16:19]
 ds_read_b64_tr_b16 v[40:41],v239
 ds_read_b64_tr_b16 v[42:43],v239 offset:6144
 v_mfma_f32_16x16x32_bf16 a[16:19],v[28:31],a[240:243],a[16:19]
 v_mfma_f32_16x16x32_bf16 a[20:23],v[28:31],a[244:247],a[20:23]
 v_mfma_f32_16x16x32_bf16 a[20:23],v[24:27],a[228:231],a[20:23]
 ds_read_b64_tr_b16 v[44:45],v239 offset:12288
 ds_read_b64_tr_b16 v[46:47],v239 offset:18432
 v_mfma_f32_16x16x32_bf16 a[24:27],v[24:27],a[232:235],a[24:27]
 v_mfma_f32_16x16x32_bf16 a[24:27],v[28:31],a[248:251],a[24:27]
 v_mfma_f32_16x16x32_bf16 a[28:31],v[28:31],a[252:255],a[28:31]
 v_mfma_f32_16x16x32_bf16 a[28:31],v[24:27],a[236:239],a[28:31]
 s_waitcnt lgkmcnt(4)
 v_mfma_f32_16x16x32_bf16 a[32:35],v[32:35],a[224:227],a[32:35]
 ds_read_b64_tr_b16 v[16:17],v236 offset:128
 ds_read_b64_tr_b16 v[18:19],v236 offset:6272
 v_mfma_f32_16x16x32_bf16 a[32:35],v[36:39],a[240:243],a[32:35]
 v_mfma_f32_16x16x32_bf16 a[36:39],v[36:39],a[244:247],a[36:39]
 v_mfma_f32_16x16x32_bf16 a[36:39],v[32:35],a[228:231],a[36:39]
 ds_read_b64_tr_b16 v[20:21],v236 offset:12416
 ds_read_b64_tr_b16 v[22:23],v236 offset:18560
 v_mfma_f32_16x16x32_bf16 a[40:43],v[32:35],a[232:235],a[40:43]
 v_mfma_f32_16x16x32_bf16 a[40:43],v[36:39],a[248:251],a[40:43]
 v_mfma_f32_16x16x32_bf16 a[44:47],v[36:39],a[252:255],a[44:47]
 s_add_u32 s75,s74,2048
 buffer_load_dwordx4 v[96:99],v4,s[4:7],s75 offen sc1
 buffer_load_dwordx4 v[112:115],v4,s[4:7],s75 offen offset:1024 sc1
 v_mfma_f32_16x16x32_bf16 a[44:47],v[32:35],a[236:239],a[44:47]
 s_waitcnt lgkmcnt(4)
 v_mfma_f32_16x16x32_bf16 a[48:51],v[40:43],a[224:227],a[48:51]
 ds_read_b64_tr_b16 v[24:25],v237 offset:128
 ds_read_b64_tr_b16 v[26:27],v237 offset:6272
 v_mfma_f32_16x16x32_bf16 a[48:51],v[44:47],a[240:243],a[48:51]
 s_add_u32 s75,s74,198656
 v_mfma_f32_16x16x32_bf16 a[52:55],v[44:47],a[244:247],a[52:55]
 buffer_load_dwordx4 v[100:103],v4,s[4:7],s75 offen sc1
 v_mfma_f32_16x16x32_bf16 a[52:55],v[40:43],a[228:231],a[52:55]
 ds_read_b64_tr_b16 v[28:29],v237 offset:12416
 ds_read_b64_tr_b16 v[30:31],v237 offset:18560
 v_mfma_f32_16x16x32_bf16 a[56:59],v[40:43],a[232:235],a[56:59]
 v_mfma_f32_16x16x32_bf16 a[56:59],v[44:47],a[248:251],a[56:59]
 v_mfma_f32_16x16x32_bf16 a[60:63],v[44:47],a[252:255],a[60:63]
 v_mfma_f32_16x16x32_bf16 a[60:63],v[40:43],a[236:239],a[60:63]
 s_waitcnt lgkmcnt(4)
 v_mfma_f32_16x16x32_bf16 a[64:67],v[16:19],a[224:227],a[64:67]
 buffer_load_dwordx4 v[116:119],v4,s[4:7],s75 offen offset:1024 sc1
 ds_read_b64_tr_b16 v[32:33],v238 offset:128
 ds_read_b64_tr_b16 v[34:35],v238 offset:6272
 v_mfma_f32_16x16x32_bf16 a[64:67],v[20:23],a[240:243],a[64:67]
 s_getpc_b64 s[66:67]
Lt37:
 s_mul_i32 s41,s48,4
 v_min_u32 v15,3,v0
 v_mfma_f32_16x16x32_bf16 a[68:71],v[20:23],a[244:247],a[68:71]
 v_add_u32 v15,s41,v15
 v_min_u32 v15,(recurrent_scan__mha_block_cached__mixer_s_mlp__prompt_kernel_hot_end-Lt37)/128,v15
 v_mfma_f32_16x16x32_bf16 a[68:71],v[16:19],a[228:231],a[68:71]
 ds_read_b64_tr_b16 v[36:37],v238 offset:12416
 ds_read_b64_tr_b16 v[38:39],v238 offset:18560
 v_mfma_f32_16x16x32_bf16 a[72:75],v[16:19],a[232:235],a[72:75]
 v_lshlrev_b32 v15,7,v15
 global_load_dword v255,v15,s[66:67]
 v_mfma_f32_16x16x32_bf16 a[72:75],v[20:23],a[248:251],a[72:75]
 s_add_u32 s75,s74,395264
 v_mfma_f32_16x16x32_bf16 a[76:79],v[20:23],a[252:255],a[76:79]
 buffer_load_dwordx4 v[104:107],v4,s[4:7],s75 offen sc1
 v_mfma_f32_16x16x32_bf16 a[76:79],v[16:19],a[236:239],a[76:79]
 s_waitcnt lgkmcnt(4)
 v_mfma_f32_16x16x32_bf16 a[80:83],v[24:27],a[224:227],a[80:83]
 ds_read_b64_tr_b16 v[40:41],v239 offset:128
 ds_read_b64_tr_b16 v[42:43],v239 offset:6272
 v_mfma_f32_16x16x32_bf16 a[80:83],v[28:31],a[240:243],a[80:83]
 v_mfma_f32_16x16x32_bf16 a[84:87],v[28:31],a[244:247],a[84:87]
 v_mfma_f32_16x16x32_bf16 a[84:87],v[24:27],a[228:231],a[84:87]
 ds_read_b64_tr_b16 v[44:45],v239 offset:12416
 ds_read_b64_tr_b16 v[46:47],v239 offset:18560
 v_mfma_f32_16x16x32_bf16 a[88:91],v[24:27],a[232:235],a[88:91]
 buffer_load_dwordx4 v[120:123],v4,s[4:7],s75 offen offset:1024 sc1
 v_mfma_f32_16x16x32_bf16 a[88:91],v[28:31],a[248:251],a[88:91]
 v_mfma_f32_16x16x32_bf16 a[92:95],v[28:31],a[252:255],a[92:95]
 v_mfma_f32_16x16x32_bf16 a[92:95],v[24:27],a[236:239],a[92:95]
 s_waitcnt lgkmcnt(4)
 v_mfma_f32_16x16x32_bf16 a[96:99],v[32:35],a[224:227],a[96:99]
 ds_read_b64_tr_b16 v[16:17],v236 offset:256
 ds_read_b64_tr_b16 v[18:19],v236 offset:6400
 v_mfma_f32_16x16x32_bf16 a[96:99],v[36:39],a[240:243],a[96:99]
 v_mfma_f32_16x16x32_bf16 a[100:103],v[36:39],a[244:247],a[100:103]
 v_mfma_f32_16x16x32_bf16 a[100:103],v[32:35],a[228:231],a[100:103]
 s_add_u32 s75,s74,591872
 ds_read_b64_tr_b16 v[20:21],v236 offset:12544
 ds_read_b64_tr_b16 v[22:23],v236 offset:18688
 v_mfma_f32_16x16x32_bf16 a[104:107],v[32:35],a[232:235],a[104:107]
 buffer_load_dwordx4 v[108:111],v4,s[4:7],s75 offen sc1
 v_mfma_f32_16x16x32_bf16 a[104:107],v[36:39],a[248:251],a[104:107]
 v_mfma_f32_16x16x32_bf16 a[108:111],v[36:39],a[252:255],a[108:111]
 v_mfma_f32_16x16x32_bf16 a[108:111],v[32:35],a[236:239],a[108:111]
 s_waitcnt lgkmcnt(4)
 v_mfma_f32_16x16x32_bf16 a[112:115],v[40:43],a[224:227],a[112:115]
 ds_read_b64_tr_b16 v[24:25],v237 offset:256
 ds_read_b64_tr_b16 v[26:27],v237 offset:6400
 v_mfma_f32_16x16x32_bf16 a[112:115],v[44:47],a[240:243],a[112:115]
 buffer_load_dwordx4 v[124:127],v4,s[4:7],s75 offen offset:1024 sc1
 v_mfma_f32_16x16x32_bf16 a[116:119],v[44:47],a[244:247],a[116:119]
 ds_read_b64_tr_b16 v[28:29],v237 offset:12544
 ds_read_b64_tr_b16 v[30:31],v237 offset:18688
 v_mfma_f32_16x16x32_bf16 a[116:119],v[40:43],a[228:231],a[116:119]
 v_add_u32 v236,4294942720,v236
 v_add_u32 v237,4294942720,v237
 v_mfma_f32_16x16x32_bf16 a[120:123],v[40:43],a[232:235],a[120:123]
 v_add_u32 v238,4294942720,v238
 v_add_u32 v239,4294942720,v239
 v_mfma_f32_16x16x32_bf16 a[120:123],v[44:47],a[248:251],a[120:123]
 v_mfma_f32_16x16x32_bf16 a[124:127],v[44:47],a[252:255],a[124:127]
 v_mfma_f32_16x16x32_bf16 a[124:127],v[40:43],a[236:239],a[124:127]
 s_waitcnt lgkmcnt(4)
 v_mfma_f32_16x16x32_bf16 a[128:131],v[16:19],a[224:227],a[128:131]
 s_waitcnt vmcnt(13)
 s_barrier
 v_mfma_f32_16x16x32_bf16 a[128:131],v[20:23],a[240:243],a[128:131]
 s_add_u32 s75,s74,4096
 ds_read_b64_tr_b16 v[32:33],v236
 ds_read_b64_tr_b16 v[34:35],v236 offset:6144
 v_mfma_f32_16x16x32_bf16 a[132:135],v[20:23],a[244:247],a[132:135]
 buffer_load_dwordx4 v[128:131],v4,s[4:7],s75 offen sc1
 v_mfma_f32_16x16x32_bf16 a[132:135],v[16:19],a[228:231],a[132:135]
 s_cmp_lg_u32 s32,0
 s_cbranch_scc1 Lf36
 v_mov_b32 v14,s51
 s_mov_b64 exec,1
 s_add_u32 s91,s62,4096
 buffer_store_dword v14,off,s[92:95],s91 sc1
 s_mov_b64 exec,-1
Lf36:
 buffer_load_dwordx4 v[144:147],v4,s[4:7],s75 offen offset:1024 sc1
 v_mfma_f32_16x16x32_bf16 a[136:139],v[16:19],a[232:235],a[136:139]
 ds_read_b64_tr_b16 v[36:37],v236 offset:12288
 ds_read_b64_tr_b16 v[38:39],v236 offset:18432
 v_mfma_f32_16x16x32_bf16 a[136:139],v[20:23],a[248:251],a[136:139]
 v_mfma_f32_16x16x32_bf16 a[140:143],v[20:23],a[252:255],a[140:143]
 v_mfma_f32_16x16x32_bf16 a[140:143],v[16:19],a[236:239],a[140:143]
 s_waitcnt lgkmcnt(4)
 v_mfma_f32_16x16x32_bf16 a[144:147],v[24:27],a[224:227],a[144:147]
 s_add_u32 s75,s74,200704
 ds_read_b64_tr_b16 v[40:41],v237
 ds_read_b64_tr_b16 v[42:43],v237 offset:6144
 v_mfma_f32_16x16x32_bf16 a[144:147],v[28:31],a[240:243],a[144:147]
 buffer_load_dwordx4 v[132:135],v4,s[4:7],s75 offen sc1
 v_mfma_f32_16x16x32_bf16 a[148:151],v[28:31],a[244:247],a[148:151]
 v_mfma_f32_16x16x32_bf16 a[148:151],v[24:27],a[228:231],a[148:151]
 ds_read_b64_tr_b16 v[44:45],v237 offset:12288
 ds_read_b64_tr_b16 v[46:47],v237 offset:18432
 v_mfma_f32_16x16x32_bf16 a[152:155],v[24:27],a[232:235],a[152:155]
 v_mfma_f32_16x16x32_bf16 a[152:155],v[28:31],a[248:251],a[152:155]
 v_mfma_f32_16x16x32_bf16 a[156:159],v[28:31],a[252:255],a[156:159]
 v_mfma_f32_16x16x32_bf16 a[156:159],v[24:27],a[236:239],a[156:159]
 s_waitcnt vmcnt(21) lgkmcnt(4)
 v_mfma_f32_16x16x32_bf16 a[0:3],v[32:35],a[160:163],a[0:3]
 ds_read_b64_tr_b16 v[16:17],v238
 ds_read_b64_tr_b16 v[18:19],v238 offset:6144
 v_mfma_f32_16x16x32_bf16 a[0:3],v[36:39],a[176:179],a[0:3]
 buffer_load_dwordx4 v[148:151],v4,s[4:7],s75 offen offset:1024 sc1
 v_mfma_f32_16x16x32_bf16 a[4:7],v[36:39],a[180:183],a[4:7]
 v_mfma_f32_16x16x32_bf16 a[4:7],v[32:35],a[164:167],a[4:7]
 ds_read_b64_tr_b16 v[20:21],v238 offset:12288
 ds_read_b64_tr_b16 v[22:23],v238 offset:18432
 v_mfma_f32_16x16x32_bf16 a[8:11],v[32:35],a[168:171],a[8:11]
 s_add_u32 s75,s74,397312
 v_mfma_f32_16x16x32_bf16 a[8:11],v[36:39],a[184:187],a[8:11]
 buffer_load_dwordx4 v[136:139],v4,s[4:7],s75 offen sc1
 v_mfma_f32_16x16x32_bf16 a[12:15],v[36:39],a[188:191],a[12:15]
 v_mfma_f32_16x16x32_bf16 a[12:15],v[32:35],a[172:175],a[12:15]
 s_waitcnt lgkmcnt(4)
 v_mfma_f32_16x16x32_bf16 a[16:19],v[40:43],a[160:163],a[16:19]
 ds_read_b64_tr_b16 v[24:25],v239
 ds_read_b64_tr_b16 v[26:27],v239 offset:6144
 v_mfma_f32_16x16x32_bf16 a[16:19],v[44:47],a[176:179],a[16:19]
 v_mfma_f32_16x16x32_bf16 a[20:23],v[44:47],a[180:183],a[20:23]
 v_mfma_f32_16x16x32_bf16 a[20:23],v[40:43],a[164:167],a[20:23]
 ds_read_b64_tr_b16 v[28:29],v239 offset:12288
 ds_read_b64_tr_b16 v[30:31],v239 offset:18432
 v_mfma_f32_16x16x32_bf16 a[24:27],v[40:43],a[168:171],a[24:27]
 buffer_load_dwordx4 v[152:155],v4,s[4:7],s75 offen offset:1024 sc1
 v_mfma_f32_16x16x32_bf16 a[24:27],v[44:47],a[184:187],a[24:27]
 v_mfma_f32_16x16x32_bf16 a[28:31],v[44:47],a[188:191],a[28:31]
 v_mfma_f32_16x16x32_bf16 a[28:31],v[40:43],a[172:175],a[28:31]
 s_waitcnt lgkmcnt(4)
 v_mfma_f32_16x16x32_bf16 a[32:35],v[16:19],a[160:163],a[32:35]
 ds_read_b64_tr_b16 v[32:33],v236 offset:128
 ds_read_b64_tr_b16 v[34:35],v236 offset:6272
 v_mfma_f32_16x16x32_bf16 a[32:35],v[20:23],a[176:179],a[32:35]
 s_add_u32 s75,s74,593920
 v_mfma_f32_16x16x32_bf16 a[36:39],v[20:23],a[180:183],a[36:39]
 buffer_load_dwordx4 v[140:143],v4,s[4:7],s75 offen sc1
 v_mfma_f32_16x16x32_bf16 a[36:39],v[16:19],a[164:167],a[36:39]
 ds_read_b64_tr_b16 v[36:37],v236 offset:12416
 ds_read_b64_tr_b16 v[38:39],v236 offset:18560
 v_mfma_f32_16x16x32_bf16 a[40:43],v[16:19],a[168:171],a[40:43]
 v_mfma_f32_16x16x32_bf16 a[40:43],v[20:23],a[184:187],a[40:43]
 v_mfma_f32_16x16x32_bf16 a[44:47],v[20:23],a[188:191],a[44:47]
 v_mfma_f32_16x16x32_bf16 a[44:47],v[16:19],a[172:175],a[44:47]
 s_waitcnt lgkmcnt(4)
 v_mfma_f32_16x16x32_bf16 a[48:51],v[24:27],a[160:163],a[48:51]
 ds_read_b64_tr_b16 v[40:41],v237 offset:128
 ds_read_b64_tr_b16 v[42:43],v237 offset:6272
 v_mfma_f32_16x16x32_bf16 a[48:51],v[28:31],a[176:179],a[48:51]
 buffer_load_dwordx4 v[156:159],v4,s[4:7],s75 offen offset:1024 sc1
 v_mfma_f32_16x16x32_bf16 a[52:55],v[28:31],a[180:183],a[52:55]
 s_cmp_le_u32 s53,2
 s_cselect_b32 s74,3,2
 v_mfma_f32_16x16x32_bf16 a[52:55],v[24:27],a[164:167],a[52:55]
 ds_read_b64_tr_b16 v[44:45],v237 offset:12416
 ds_read_b64_tr_b16 v[46:47],v237 offset:18560
 v_mfma_f32_16x16x32_bf16 a[56:59],v[24:27],a[168:171],a[56:59]
 s_mul_i32 s74,s74,6144
 v_mfma_f32_16x16x32_bf16 a[56:59],v[28:31],a[184:187],a[56:59]
 s_add_u32 s75,s74,0
 v_mfma_f32_16x16x32_bf16 a[60:63],v[28:31],a[188:191],a[60:63]
 buffer_load_dwordx4 a[192:195],v4,s[4:7],s75 offen sc1
 v_mfma_f32_16x16x32_bf16 a[60:63],v[24:27],a[172:175],a[60:63]
 s_waitcnt lgkmcnt(4)
 v_mfma_f32_16x16x32_bf16 a[64:67],v[32:35],a[160:163],a[64:67]
 ds_read_b64_tr_b16 v[16:17],v238 offset:128
 ds_read_b64_tr_b16 v[18:19],v238 offset:6272
 v_mfma_f32_16x16x32_bf16 a[64:67],v[36:39],a[176:179],a[64:67]
 v_mfma_f32_16x16x32_bf16 a[68:71],v[36:39],a[180:183],a[68:71]
 v_mfma_f32_16x16x32_bf16 a[68:71],v[32:35],a[164:167],a[68:71]
 ds_read_b64_tr_b16 v[20:21],v238 offset:12416
 ds_read_b64_tr_b16 v[22:23],v238 offset:18560
 v_mfma_f32_16x16x32_bf16 a[72:75],v[32:35],a[168:171],a[72:75]
 v_mfma_f32_16x16x32_bf16 a[72:75],v[36:39],a[184:187],a[72:75]
 buffer_load_dwordx4 a[208:211],v4,s[4:7],s75 offen offset:1024 sc1
 v_mfma_f32_16x16x32_bf16 a[76:79],v[36:39],a[188:191],a[76:79]
 v_mfma_f32_16x16x32_bf16 a[76:79],v[32:35],a[172:175],a[76:79]
 s_waitcnt lgkmcnt(4)
 v_mfma_f32_16x16x32_bf16 a[80:83],v[40:43],a[160:163],a[80:83]
 ds_read_b64_tr_b16 v[24:25],v239 offset:128
 ds_read_b64_tr_b16 v[26:27],v239 offset:6272
 v_mfma_f32_16x16x32_bf16 a[80:83],v[44:47],a[176:179],a[80:83]
 v_mfma_f32_16x16x32_bf16 a[84:87],v[44:47],a[180:183],a[84:87]
 v_mfma_f32_16x16x32_bf16 a[84:87],v[40:43],a[164:167],a[84:87]
 s_add_u32 s75,s74,196608
 ds_read_b64_tr_b16 v[28:29],v239 offset:12416
 ds_read_b64_tr_b16 v[30:31],v239 offset:18560
 v_mfma_f32_16x16x32_bf16 a[88:91],v[40:43],a[168:171],a[88:91]
 buffer_load_dwordx4 a[196:199],v4,s[4:7],s75 offen sc1
 v_mfma_f32_16x16x32_bf16 a[88:91],v[44:47],a[184:187],a[88:91]
 v_mfma_f32_16x16x32_bf16 a[92:95],v[44:47],a[188:191],a[92:95]
 v_mfma_f32_16x16x32_bf16 a[92:95],v[40:43],a[172:175],a[92:95]
 s_waitcnt lgkmcnt(4)
 v_mfma_f32_16x16x32_bf16 a[96:99],v[16:19],a[160:163],a[96:99]
 ds_read_b64_tr_b16 v[32:33],v236 offset:256
 ds_read_b64_tr_b16 v[34:35],v236 offset:6400
 v_mfma_f32_16x16x32_bf16 a[96:99],v[20:23],a[176:179],a[96:99]
 buffer_load_dwordx4 a[212:215],v4,s[4:7],s75 offen offset:1024 sc1
 v_mfma_f32_16x16x32_bf16 a[100:103],v[20:23],a[180:183],a[100:103]
 v_mfma_f32_16x16x32_bf16 a[100:103],v[16:19],a[164:167],a[100:103]
 ds_read_b64_tr_b16 v[36:37],v236 offset:12544
 ds_read_b64_tr_b16 v[38:39],v236 offset:18688
 v_mfma_f32_16x16x32_bf16 a[104:107],v[16:19],a[168:171],a[104:107]
 v_mfma_f32_16x16x32_bf16 a[104:107],v[20:23],a[184:187],a[104:107]
 v_mfma_f32_16x16x32_bf16 a[108:111],v[20:23],a[188:191],a[108:111]
 v_mfma_f32_16x16x32_bf16 a[108:111],v[16:19],a[172:175],a[108:111]
 s_waitcnt lgkmcnt(4)
 v_mfma_f32_16x16x32_bf16 a[112:115],v[24:27],a[160:163],a[112:115]
 s_add_u32 s75,s74,393216
 ds_read_b64_tr_b16 v[40:41],v237 offset:256
 ds_read_b64_tr_b16 v[42:43],v237 offset:6400
 v_mfma_f32_16x16x32_bf16 a[112:115],v[28:31],a[176:179],a[112:115]
 buffer_load_dwordx4 a[200:203],v4,s[4:7],s75 offen sc1
 v_mfma_f32_16x16x32_bf16 a[116:119],v[28:31],a[180:183],a[116:119]
 ds_read_b64_tr_b16 v[44:45],v237 offset:12544
 ds_read_b64_tr_b16 v[46:47],v237 offset:18688
 v_mfma_f32_16x16x32_bf16 a[116:119],v[24:27],a[164:167],a[116:119]
 v_add_u32 v236,49152,v236
 v_add_u32 v237,49152,v237
 v_mfma_f32_16x16x32_bf16 a[120:123],v[24:27],a[168:171],a[120:123]
 v_add_u32 v238,49152,v238
 v_add_u32 v239,49152,v239
 v_mfma_f32_16x16x32_bf16 a[120:123],v[28:31],a[184:187],a[120:123]
 v_mfma_f32_16x16x32_bf16 a[124:127],v[28:31],a[188:191],a[124:127]
 buffer_load_dwordx4 a[216:219],v4,s[4:7],s75 offen offset:1024 sc1
 v_mfma_f32_16x16x32_bf16 a[124:127],v[24:27],a[172:175],a[124:127]
 s_waitcnt lgkmcnt(4)
 v_mfma_f32_16x16x32_bf16 a[128:131],v[32:35],a[160:163],a[128:131]
 s_waitcnt vmcnt(63)
 s_barrier
 v_mfma_f32_16x16x32_bf16 a[128:131],v[36:39],a[176:179],a[128:131]
 s_add_u32 s75,s74,589824
 ds_read_b64_tr_b16 v[16:17],v236
 ds_read_b64_tr_b16 v[18:19],v236 offset:6144
 v_mfma_f32_16x16x32_bf16 a[132:135],v[36:39],a[180:183],a[132:135]
 buffer_load_dwordx4 a[204:207],v4,s[4:7],s75 offen sc1
 v_mfma_f32_16x16x32_bf16 a[132:135],v[32:35],a[164:167],a[132:135]
 v_mfma_f32_16x16x32_bf16 a[136:139],v[32:35],a[168:171],a[136:139]
 ds_read_b64_tr_b16 v[20:21],v236 offset:12288
 ds_read_b64_tr_b16 v[22:23],v236 offset:18432
 v_mfma_f32_16x16x32_bf16 a[136:139],v[36:39],a[184:187],a[136:139]
 v_mfma_f32_16x16x32_bf16 a[140:143],v[36:39],a[188:191],a[140:143]
 v_mfma_f32_16x16x32_bf16 a[140:143],v[32:35],a[172:175],a[140:143]
 s_waitcnt lgkmcnt(4)
 v_mfma_f32_16x16x32_bf16 a[144:147],v[40:43],a[160:163],a[144:147]
 ds_read_b64_tr_b16 v[24:25],v237
 ds_read_b64_tr_b16 v[26:27],v237 offset:6144
 v_mfma_f32_16x16x32_bf16 a[144:147],v[44:47],a[176:179],a[144:147]
 buffer_load_dwordx4 a[220:223],v4,s[4:7],s75 offen offset:1024 sc1
 v_mfma_f32_16x16x32_bf16 a[148:151],v[44:47],a[180:183],a[148:151]
 v_mfma_f32_16x16x32_bf16 a[148:151],v[40:43],a[164:167],a[148:151]
 ds_read_b64_tr_b16 v[28:29],v237 offset:12288
 ds_read_b64_tr_b16 v[30:31],v237 offset:18432
 v_mfma_f32_16x16x32_bf16 a[152:155],v[40:43],a[168:171],a[152:155]
 v_mfma_f32_16x16x32_bf16 a[152:155],v[44:47],a[184:187],a[152:155]
 v_mfma_f32_16x16x32_bf16 a[156:159],v[44:47],a[188:191],a[156:159]
 v_mfma_f32_16x16x32_bf16 a[156:159],v[40:43],a[172:175],a[156:159]
 s_waitcnt vmcnt(25) lgkmcnt(4)
 v_mfma_f32_16x16x32_bf16 a[0:3],v[16:19],v[64:67],a[0:3]
 s_add_u32 s75,s74,2048
 ds_read_b64_tr_b16 v[32:33],v238
 ds_read_b64_tr_b16 v[34:35],v238 offset:6144
 v_mfma_f32_16x16x32_bf16 a[0:3],v[20:23],v[80:83],a[0:3]
 buffer_load_dwordx4 a[224:227],v4,s[4:7],s75 offen sc1
 v_mfma_f32_16x16x32_bf16 a[4:7],v[20:23],v[84:87],a[4:7]
 v_mfma_f32_16x16x32_bf16 a[4:7],v[16:19],v[68:71],a[4:7]
 ds_read_b64_tr_b16 v[36:37],v238 offset:12288
 ds_read_b64_tr_b16 v[38:39],v238 offset:18432
 v_mfma_f32_16x16x32_bf16 a[8:11],v[16:19],v[72:75],a[8:11]
 v_mfma_f32_16x16x32_bf16 a[8:11],v[20:23],v[88:91],a[8:11]
 buffer_load_dwordx4 a[240:243],v4,s[4:7],s75 offen offset:1024 sc1
 v_mfma_f32_16x16x32_bf16 a[12:15],v[20:23],v[92:95],a[12:15]
 v_mfma_f32_16x16x32_bf16 a[12:15],v[16:19],v[76:79],a[12:15]
 s_waitcnt lgkmcnt(4)
 v_mfma_f32_16x16x32_bf16 a[16:19],v[24:27],v[64:67],a[16:19]
 ds_read_b64_tr_b16 v[40:41],v239
 ds_read_b64_tr_b16 v[42:43],v239 offset:6144
 v_mfma_f32_16x16x32_bf16 a[16:19],v[28:31],v[80:83],a[16:19]
 v_mfma_f32_16x16x32_bf16 a[20:23],v[28:31],v[84:87],a[20:23]
 v_mfma_f32_16x16x32_bf16 a[20:23],v[24:27],v[68:71],a[20:23]
 s_add_u32 s75,s74,198656
 ds_read_b64_tr_b16 v[44:45],v239 offset:12288
 ds_read_b64_tr_b16 v[46:47],v239 offset:18432
 v_mfma_f32_16x16x32_bf16 a[24:27],v[24:27],v[72:75],a[24:27]
 buffer_load_dwordx4 a[228:231],v4,s[4:7],s75 offen sc1
 v_mfma_f32_16x16x32_bf16 a[24:27],v[28:31],v[88:91],a[24:27]
 v_mfma_f32_16x16x32_bf16 a[28:31],v[28:31],v[92:95],a[28:31]
 v_mfma_f32_16x16x32_bf16 a[28:31],v[24:27],v[76:79],a[28:31]
 s_waitcnt lgkmcnt(4)
 v_mfma_f32_16x16x32_bf16 a[32:35],v[32:35],v[64:67],a[32:35]
 ds_read_b64_tr_b16 v[16:17],v236 offset:128
 ds_read_b64_tr_b16 v[18:19],v236 offset:6272
 v_mfma_f32_16x16x32_bf16 a[32:35],v[36:39],v[80:83],a[32:35]
 s_cmp_le_u32 s53,2
 s_cselect_b32 s39,3,2
 v_mfma_f32_16x16x32_bf16 a[36:39],v[36:39],v[84:87],a[36:39]
 s_add_u32 m0,s35,24576
 s_mul_i32 s39,s39,245760
 buffer_load_dwordx4 v1,s[12:15],s39 offen lds
 v_mfma_f32_16x16x32_bf16 a[36:39],v[32:35],v[68:71],a[36:39]
 ds_read_b64_tr_b16 v[20:21],v236 offset:12416
 ds_read_b64_tr_b16 v[22:23],v236 offset:18560
 v_mfma_f32_16x16x32_bf16 a[40:43],v[32:35],v[72:75],a[40:43]
 v_mfma_f32_16x16x32_bf16 a[40:43],v[36:39],v[88:91],a[40:43]
 v_mfma_f32_16x16x32_bf16 a[44:47],v[36:39],v[92:95],a[44:47]
 buffer_load_dwordx4 v2,s[12:15],s39 offen offset:1024 lds
 v_mfma_f32_16x16x32_bf16 a[44:47],v[32:35],v[76:79],a[44:47]
 s_waitcnt lgkmcnt(4)
 v_mfma_f32_16x16x32_bf16 a[48:51],v[40:43],v[64:67],a[48:51]
 ds_read_b64_tr_b16 v[24:25],v237 offset:128
 ds_read_b64_tr_b16 v[26:27],v237 offset:6272
 v_mfma_f32_16x16x32_bf16 a[48:51],v[44:47],v[80:83],a[48:51]
 v_mfma_f32_16x16x32_bf16 a[52:55],v[44:47],v[84:87],a[52:55]
 v_mfma_f32_16x16x32_bf16 a[52:55],v[40:43],v[68:71],a[52:55]
 ds_read_b64_tr_b16 v[28:29],v237 offset:12416
 ds_read_b64_tr_b16 v[30:31],v237 offset:18560
 v_mfma_f32_16x16x32_bf16 a[56:59],v[40:43],v[72:75],a[56:59]
 buffer_load_dwordx4 a[244:247],v4,s[4:7],s75 offen offset:1024 sc1
 v_mfma_f32_16x16x32_bf16 a[56:59],v[44:47],v[88:91],a[56:59]
 v_mfma_f32_16x16x32_bf16 a[60:63],v[44:47],v[92:95],a[60:63]
 v_mfma_f32_16x16x32_bf16 a[60:63],v[40:43],v[76:79],a[60:63]
 s_waitcnt lgkmcnt(4)
 v_mfma_f32_16x16x32_bf16 a[64:67],v[16:19],v[64:67],a[64:67]
 ds_read_b64_tr_b16 v[32:33],v238 offset:128
 ds_read_b64_tr_b16 v[34:35],v238 offset:6272
 v_mfma_f32_16x16x32_bf16 a[64:67],v[20:23],v[80:83],a[64:67]
 v_and_b32 v12,15,v0
 v_lshlrev_b32 v12,2,v12
 v_mfma_f32_16x16x32_bf16 a[68:71],v[20:23],v[84:87],a[68:71]
 s_lshl_b32 s42,s34,6
 s_add_u32 s42,s42,4096
 v_add_u32 v12,s42,v12
 v_mfma_f32_16x16x32_bf16 a[68:71],v[16:19],v[68:71],a[68:71]
 ds_read_b64_tr_b16 v[36:37],v238 offset:12416
 ds_read_b64_tr_b16 v[38:39],v238 offset:18560
 v_mfma_f32_16x16x32_bf16 a[72:75],v[16:19],v[72:75],a[72:75]
 buffer_load_dwordx4 v3,s[12:15],s39 offen offset:2048 lds
 s_add_u32 s75,s74,395264
 buffer_load_dword v13,v12,s[92:95],0 offen sc1
 v_mfma_f32_16x16x32_bf16 a[72:75],v[20:23],v[88:91],a[72:75]
 buffer_load_dwordx4 a[232:235],v4,s[4:7],s75 offen sc1
 v_mfma_f32_16x16x32_bf16 a[76:79],v[20:23],v[92:95],a[76:79]
 v_mfma_f32_16x16x32_bf16 a[76:79],v[16:19],v[76:79],a[76:79]
 s_waitcnt lgkmcnt(4)
 v_mfma_f32_16x16x32_bf16 a[80:83],v[24:27],v[64:67],a[80:83]
 ds_read_b64_tr_b16 v[40:41],v239 offset:128
 ds_read_b64_tr_b16 v[42:43],v239 offset:6272
 v_mfma_f32_16x16x32_bf16 a[80:83],v[28:31],v[80:83],a[80:83]
 v_mfma_f32_16x16x32_bf16 a[84:87],v[28:31],v[84:87],a[84:87]
 v_mfma_f32_16x16x32_bf16 a[84:87],v[24:27],v[68:71],a[84:87]
 ds_read_b64_tr_b16 v[44:45],v239 offset:12416
 ds_read_b64_tr_b16 v[46:47],v239 offset:18560
 v_mfma_f32_16x16x32_bf16 a[88:91],v[24:27],v[72:75],a[88:91]
 s_add_u32 m0,s35,27648
 s_add_u32 s44,s39,10240
 buffer_load_dwordx4 v1,s[12:15],s44 offen lds
 v_mfma_f32_16x16x32_bf16 a[88:91],v[28:31],v[88:91],a[88:91]
 v_mfma_f32_16x16x32_bf16 a[92:95],v[28:31],v[92:95],a[92:95]
 v_mfma_f32_16x16x32_bf16 a[92:95],v[24:27],v[76:79],a[92:95]
 s_waitcnt lgkmcnt(4)
 v_mfma_f32_16x16x32_bf16 a[96:99],v[32:35],v[64:67],a[96:99]
 ds_read_b64_tr_b16 v[16:17],v236 offset:256
 ds_read_b64_tr_b16 v[18:19],v236 offset:6400
 v_mfma_f32_16x16x32_bf16 a[96:99],v[36:39],v[80:83],a[96:99]
 buffer_load_dwordx4 v2,s[12:15],s44 offen offset:1024 lds
 v_mfma_f32_16x16x32_bf16 a[100:103],v[36:39],v[84:87],a[100:103]
 v_mfma_f32_16x16x32_bf16 a[100:103],v[32:35],v[68:71],a[100:103]
 ds_read_b64_tr_b16 v[20:21],v236 offset:12544
 ds_read_b64_tr_b16 v[22:23],v236 offset:18688
 v_mfma_f32_16x16x32_bf16 a[104:107],v[32:35],v[72:75],a[104:107]
 v_mfma_f32_16x16x32_bf16 a[104:107],v[36:39],v[88:91],a[104:107]
 buffer_load_dwordx4 a[248:251],v4,s[4:7],s75 offen offset:1024 sc1
 v_mfma_f32_16x16x32_bf16 a[108:111],v[36:39],v[92:95],a[108:111]
 v_mfma_f32_16x16x32_bf16 a[108:111],v[32:35],v[76:79],a[108:111]
 s_waitcnt lgkmcnt(4)
 v_mfma_f32_16x16x32_bf16 a[112:115],v[40:43],v[64:67],a[112:115]
 ds_read_b64_tr_b16 v[24:25],v237 offset:256
 ds_read_b64_tr_b16 v[26:27],v237 offset:6400
 v_mfma_f32_16x16x32_bf16 a[112:115],v[44:47],v[80:83],a[112:115]
 v_mfma_f32_16x16x32_bf16 a[116:119],v[44:47],v[84:87],a[116:119]
 ds_read_b64_tr_b16 v[28:29],v237 offset:12544
 ds_read_b64_tr_b16 v[30:31],v237 offset:18688
 v_mfma_f32_16x16x32_bf16 a[116:119],v[40:43],v[68:71],a[116:119]
 v_add_u32 v236,4294868992,v236
 v_add_u32 v237,4294868992,v237
 v_mfma_f32_16x16x32_bf16 a[120:123],v[40:43],v[72:75],a[120:123]
 v_add_u32 v238,4294868992,v238
 v_add_u32 v239,4294868992,v239
 v_mfma_f32_16x16x32_bf16 a[120:123],v[44:47],v[88:91],a[120:123]
 buffer_load_dwordx4 v3,s[12:15],s44 offen offset:2048 lds
 v_mfma_f32_16x16x32_bf16 a[124:127],v[44:47],v[92:95],a[124:127]
 v_mfma_f32_16x16x32_bf16 a[124:127],v[40:43],v[76:79],a[124:127]
 s_waitcnt lgkmcnt(4)
 v_mfma_f32_16x16x32_bf16 a[128:131],v[16:19],v[64:67],a[128:131]
 s_waitcnt vmcnt(63)
 s_barrier
 v_mfma_f32_16x16x32_bf16 a[128:131],v[20:23],v[80:83],a[128:131]
 s_add_u32 s75,s74,591872
 ds_read_b64_tr_b16 v[32:33],v236
 ds_read_b64_tr_b16 v[34:35],v236 offset:6144
 v_mfma_f32_16x16x32_bf16 a[132:135],v[20:23],v[84:87],a[132:135]
 buffer_load_dwordx4 a[236:239],v4,s[4:7],s75 offen sc1
 v_mfma_f32_16x16x32_bf16 a[132:135],v[16:19],v[68:71],a[132:135]
 v_mfma_f32_16x16x32_bf16 a[136:139],v[16:19],v[72:75],a[136:139]
 ds_read_b64_tr_b16 v[36:37],v236 offset:12288
 ds_read_b64_tr_b16 v[38:39],v236 offset:18432
 v_mfma_f32_16x16x32_bf16 a[136:139],v[20:23],v[88:91],a[136:139]
 s_add_u32 m0,s35,73728
 s_add_u32 s39,s39,81920
 buffer_load_dwordx4 v1,s[12:15],s39 offen lds
 v_mfma_f32_16x16x32_bf16 a[140:143],v[20:23],v[92:95],a[140:143]
 v_mfma_f32_16x16x32_bf16 a[140:143],v[16:19],v[76:79],a[140:143]
 s_waitcnt lgkmcnt(4)
 v_mfma_f32_16x16x32_bf16 a[144:147],v[24:27],v[64:67],a[144:147]
 ds_read_b64_tr_b16 v[40:41],v237
 ds_read_b64_tr_b16 v[42:43],v237 offset:6144
 v_mfma_f32_16x16x32_bf16 a[144:147],v[28:31],v[80:83],a[144:147]
 buffer_load_dwordx4 a[252:255],v4,s[4:7],s75 offen offset:1024 sc1
 v_mfma_f32_16x16x32_bf16 a[148:151],v[28:31],v[84:87],a[148:151]
 v_mfma_f32_16x16x32_bf16 a[148:151],v[24:27],v[68:71],a[148:151]
 ds_read_b64_tr_b16 v[44:45],v237 offset:12288
 ds_read_b64_tr_b16 v[46:47],v237 offset:18432
 v_mfma_f32_16x16x32_bf16 a[152:155],v[24:27],v[72:75],a[152:155]
 v_mfma_f32_16x16x32_bf16 a[152:155],v[28:31],v[88:91],a[152:155]
 v_mfma_f32_16x16x32_bf16 a[156:159],v[28:31],v[92:95],a[156:159]
 v_mfma_f32_16x16x32_bf16 a[156:159],v[24:27],v[76:79],a[156:159]
 buffer_load_dwordx4 v2,s[12:15],s39 offen offset:1024 lds
 s_waitcnt vmcnt(33) lgkmcnt(4)
 v_mfma_f32_16x16x32_bf16 a[0:3],v[32:35],v[96:99],a[0:3]
 ds_read_b64_tr_b16 v[16:17],v238
 ds_read_b64_tr_b16 v[18:19],v238 offset:6144
 v_mfma_f32_16x16x32_bf16 a[0:3],v[36:39],v[112:115],a[0:3]
 v_mfma_f32_16x16x32_bf16 a[4:7],v[36:39],v[116:119],a[4:7]
 v_mfma_f32_16x16x32_bf16 a[4:7],v[32:35],v[100:103],a[4:7]
 ds_read_b64_tr_b16 v[20:21],v238 offset:12288
 ds_read_b64_tr_b16 v[22:23],v238 offset:18432
 v_mfma_f32_16x16x32_bf16 a[8:11],v[32:35],v[104:107],a[8:11]
 buffer_load_dwordx4 v3,s[12:15],s39 offen offset:2048 lds
 v_mfma_f32_16x16x32_bf16 a[8:11],v[36:39],v[120:123],a[8:11]
 v_mfma_f32_16x16x32_bf16 a[12:15],v[36:39],v[124:127],a[12:15]
 v_mfma_f32_16x16x32_bf16 a[12:15],v[32:35],v[108:111],a[12:15]
 s_waitcnt lgkmcnt(4)
 v_mfma_f32_16x16x32_bf16 a[16:19],v[40:43],v[96:99],a[16:19]
 s_add_u32 s75,s74,4096
 ds_read_b64_tr_b16 v[24:25],v239
 ds_read_b64_tr_b16 v[26:27],v239 offset:6144
 v_mfma_f32_16x16x32_bf16 a[16:19],v[44:47],v[112:115],a[16:19]
 buffer_load_dwordx4 a[160:163],v4,s[4:7],s75 offen sc1
 v_mfma_f32_16x16x32_bf16 a[20:23],v[44:47],v[116:119],a[20:23]
 v_mfma_f32_16x16x32_bf16 a[20:23],v[40:43],v[100:103],a[20:23]
 ds_read_b64_tr_b16 v[28:29],v239 offset:12288
 ds_read_b64_tr_b16 v[30:31],v239 offset:18432
 v_mfma_f32_16x16x32_bf16 a[24:27],v[40:43],v[104:107],a[24:27]
 v_mfma_f32_16x16x32_bf16 a[24:27],v[44:47],v[120:123],a[24:27]
 v_mfma_f32_16x16x32_bf16 a[28:31],v[44:47],v[124:127],a[28:31]
 s_add_u32 m0,s35,76800
 s_add_u32 s44,s39,10240
 buffer_load_dwordx4 v1,s[12:15],s44 offen lds
 v_mfma_f32_16x16x32_bf16 a[28:31],v[40:43],v[108:111],a[28:31]
 s_waitcnt lgkmcnt(4)
 v_mfma_f32_16x16x32_bf16 a[32:35],v[16:19],v[96:99],a[32:35]
 ds_read_b64_tr_b16 v[32:33],v236 offset:128
 ds_read_b64_tr_b16 v[34:35],v236 offset:6272
 v_mfma_f32_16x16x32_bf16 a[32:35],v[20:23],v[112:115],a[32:35]
 v_mfma_f32_16x16x32_bf16 a[36:39],v[20:23],v[116:119],a[36:39]
 buffer_load_dwordx4 a[176:179],v4,s[4:7],s75 offen offset:1024 sc1
 v_mfma_f32_16x16x32_bf16 a[36:39],v[16:19],v[100:103],a[36:39]
 ds_read_b64_tr_b16 v[36:37],v236 offset:12416
 ds_read_b64_tr_b16 v[38:39],v236 offset:18560
 v_mfma_f32_16x16x32_bf16 a[40:43],v[16:19],v[104:107],a[40:43]
 v_mfma_f32_16x16x32_bf16 a[40:43],v[20:23],v[120:123],a[40:43]
 s_waitcnt vmcnt(13)
 v_cmp_ne_u32 vcc,s51,v13
 s_nop 1
 s_cbranch_vccnz Lp38_spin
Lp38_ok:
 v_mfma_f32_16x16x32_bf16 a[44:47],v[20:23],v[124:127],a[44:47]
 v_mfma_f32_16x16x32_bf16 a[44:47],v[16:19],v[108:111],a[44:47]
 s_waitcnt lgkmcnt(4)
 v_mfma_f32_16x16x32_bf16 a[48:51],v[24:27],v[96:99],a[48:51]
 ds_read_b64_tr_b16 v[40:41],v237 offset:128
 ds_read_b64_tr_b16 v[42:43],v237 offset:6272
 v_mfma_f32_16x16x32_bf16 a[48:51],v[28:31],v[112:115],a[48:51]
 buffer_load_dwordx4 v2,s[12:15],s44 offen offset:1024 lds
 s_mul_i32 s41,s71,20480
 s_mul_i32 s42,s60,160
 s_add_u32 s41,s41,s42
 v_mfma_f32_16x16x32_bf16 a[52:55],v[28:31],v[116:119],a[52:55]
 s_and_b32 s58,s60,1
 s_lshl_b32 s59,s58,5
 s_sub_u32 s41,s41,s59
 v_mfma_f32_16x16x32_bf16 a[52:55],v[24:27],v[100:103],a[52:55]
 ds_read_b64_tr_b16 v[44:45],v237 offset:12416
 ds_read_b64_tr_b16 v[46:47],v237 offset:18560
 v_mfma_f32_16x16x32_bf16 a[56:59],v[24:27],v[104:107],a[56:59]
 s_add_u32 s75,s74,200704
 s_add_u32 s20,s64,s41
 s_addc_u32 s21,s65,0
 v_mfma_f32_16x16x32_bf16 a[56:59],v[28:31],v[120:123],a[56:59]
 buffer_load_dwordx4 a[164:167],v4,s[4:7],s75 offen sc1
 s_mov_b32 s22,19392
 s_mov_b32 s23,0x20000
 v_mfma_f32_16x16x32_bf16 a[60:63],v[28:31],v[124:127],a[60:63]
 s_add_u32 s8,s84,s41
 s_addc_u32 s9,s85,0
 v_mfma_f32_16x16x32_bf16 a[60:63],v[24:27],v[108:111],a[60:63]
 s_waitcnt lgkmcnt(4)
 s_mov_b32 s10,19392
 s_mov_b32 s11,0x20000
 v_mfma_f32_16x16x32_bf16 a[64:67],v[32:35],v[96:99],a[64:67]
 ds_read_b64_tr_b16 v[16:17],v238 offset:128
 ds_read_b64_tr_b16 v[18:19],v238 offset:6272
 v_mfma_f32_16x16x32_bf16 a[64:67],v[36:39],v[112:115],a[64:67]
 s_mul_i32 s41,s71,20480
 s_add_u32 s41,s41,2621440
 s_and_b32 s57,s60,1
 v_mfma_f32_16x16x32_bf16 a[68:71],v[36:39],v[116:119],a[68:71]
 s_mul_i32 s56,s60,5
 s_add_u32 s56,s56,s57
 s_lshl_b32 s56,s56,9
 v_mfma_f32_16x16x32_bf16 a[68:71],v[32:35],v[100:103],a[68:71]
 buffer_load_dwordx4 v3,s[12:15],s44 offen offset:2048 lds
 ds_read_b64_tr_b16 v[20:21],v238 offset:12416
 ds_read_b64_tr_b16 v[22:23],v238 offset:18560
 v_mfma_f32_16x16x32_bf16 a[72:75],v[32:35],v[104:107],a[72:75]
 s_add_u32 s56,s56,s41
 s_mul_i32 s57,s57,2560
 s_sub_u32 s57,s56,s57
 v_mfma_f32_16x16x32_bf16 a[72:75],v[36:39],v[120:123],a[72:75]
 s_add_u32 s57,s57,2048
 v_min_u32 v12,6,v0
 v_mfma_f32_16x16x32_bf16 a[76:79],v[36:39],v[124:127],a[76:79]
 s_add_u32 s41,s52,1
 v_add_u32 v12,s41,v12
 v_and_b32 v12,7,v12
 v_mfma_f32_16x16x32_bf16 a[76:79],v[32:35],v[108:111],a[76:79]
 s_waitcnt lgkmcnt(4)
 v_lshlrev_b32 v12,4,v12
 v_mfma_f32_16x16x32_bf16 a[80:83],v[40:43],v[96:99],a[80:83]
 s_add_u32 m0,s35,49152
 s_add_u32 s39,s39,81920
 buffer_load_dwordx4 v1,s[12:15],s39 offen lds
 ds_read_b64_tr_b16 v[24:25],v239 offset:128
 ds_read_b64_tr_b16 v[26:27],v239 offset:6272
 v_mfma_f32_16x16x32_bf16 a[80:83],v[44:47],v[112:115],a[80:83]
 s_lshl_b32 s42,s34,7
 s_lshl_b32 s41,s53,2
 v_mfma_f32_16x16x32_bf16 a[84:87],v[44:47],v[116:119],a[84:87]
 s_add_u32 s42,s42,s41
 s_add_u32 s42,s42,5120
 v_add_u32 v12,s42,v12
 v_mfma_f32_16x16x32_bf16 a[84:87],v[40:43],v[100:103],a[84:87]
 ds_read_b64_tr_b16 v[28:29],v239 offset:12416
 ds_read_b64_tr_b16 v[30:31],v239 offset:18560
 v_mfma_f32_16x16x32_bf16 a[88:91],v[40:43],v[104:107],a[88:91]
 v_add_u32 v6,s55,v4
 v_add_u32 v8,49152,v6
 v_mfma_f32_16x16x32_bf16 a[88:91],v[44:47],v[120:123],a[88:91]
 v_add_u32 v9,98304,v6
 v_mov_b32 v254,0
 v_mfma_f32_16x16x32_bf16 a[92:95],v[44:47],v[124:127],a[92:95]
 buffer_load_dwordx4 a[180:183],v4,s[4:7],s75 offen offset:1024 sc1
 v_mov_b32 v255,0
 v_mfma_f32_16x16x32_bf16 a[92:95],v[40:43],v[108:111],a[92:95]
 s_waitcnt lgkmcnt(4)
 v_mfma_f32_16x16x32_bf16 a[96:99],v[16:19],v[96:99],a[96:99]
 ds_read_b64_tr_b16 v[32:33],v236 offset:256
 ds_read_b64_tr_b16 v[34:35],v236 offset:6400
 v_mfma_f32_16x16x32_bf16 a[96:99],v[20:23],v[112:115],a[96:99]
 s_mul_i32 s49,s32,24576
 s_add_u32 s49,s49,20480
 s_mov_b32 s61,0
 v_mfma_f32_16x16x32_bf16 a[100:103],v[20:23],v[116:119],a[100:103]
 s_add_u32 s38,s38,s52
 s_mul_i32 s38,s38,81920
 s_mul_i32 s70,s32,2560
 v_mfma_f32_16x16x32_bf16 a[100:103],v[16:19],v[100:103],a[100:103]
 buffer_load_dwordx4 v2,s[12:15],s39 offen offset:1024 lds
 ds_read_b64_tr_b16 v[36:37],v236 offset:12544
 ds_read_b64_tr_b16 v[38:39],v236 offset:18688
 v_mfma_f32_16x16x32_bf16 a[104:107],v[16:19],v[104:107],a[104:107]
 s_add_u32 s38,s38,s70
 s_add_u32 s38,s38,39960576
 v_mfma_f32_16x16x32_bf16 a[104:107],v[20:23],v[120:123],a[104:107]
 s_mov_b32 s16,s88
 s_mov_b32 s17,s89
 s_mov_b32 s19,0x20000
 v_mfma_f32_16x16x32_bf16 a[108:111],v[20:23],v[124:127],a[108:111]
 s_add_u32 s75,s74,397312
 s_lshl_b32 s41,s32,1
 s_add_u32 s41,s41,0
 v_mfma_f32_16x16x32_bf16 a[108:111],v[16:19],v[108:111],a[108:111]
 buffer_load_dwordx4 a[168:171],v4,s[4:7],s75 offen sc1
 s_waitcnt lgkmcnt(4)
 s_cmp_lg_u32 s41,s52
 s_cselect_b32 s18,60932096,0
 v_mfma_f32_16x16x32_bf16 a[112:115],v[24:27],v[96:99],a[112:115]
 ds_read_b64_tr_b16 v[40:41],v237 offset:256
 ds_read_b64_tr_b16 v[42:43],v237 offset:6400
 v_mfma_f32_16x16x32_bf16 a[112:115],v[28:31],v[112:115],a[112:115]
 s_mov_b32 s80,s88
 s_mov_b32 s81,s89
 s_mov_b32 s83,0x20000
 v_mfma_f32_16x16x32_bf16 a[116:119],v[28:31],v[116:119],a[116:119]
 ds_read_b64_tr_b16 v[44:45],v237 offset:12544
 ds_read_b64_tr_b16 v[46:47],v237 offset:18688
 v_mfma_f32_16x16x32_bf16 a[116:119],v[24:27],v[100:103],a[116:119]
 v_add_u32 v236,122880,v236
 v_add_u32 v237,122880,v237
 v_mfma_f32_16x16x32_bf16 a[120:123],v[24:27],v[104:107],a[120:123]
 v_add_u32 v238,122880,v238
 v_add_u32 v239,122880,v239
 v_mfma_f32_16x16x32_bf16 a[120:123],v[28:31],v[120:123],a[120:123]
 s_lshl_b32 s41,s32,1
 s_add_u32 s41,s41,1
 v_mfma_f32_16x16x32_bf16 a[124:127],v[28:31],v[124:127],a[124:127]
 buffer_load_dwordx4 v3,s[12:15],s39 offen offset:2048 lds
 s_cmp_lg_u32 s41,s52
 s_cselect_b32 s82,60932096,0
 v_add_u32 v10,147456,v4
 v_mfma_f32_16x16x32_bf16 a[124:127],v[24:27],v[108:111],a[124:127]
 s_waitcnt lgkmcnt(4)
 v_add_u32 v11,147456,v5
 v_mfma_f32_16x16x32_bf16 a[128:131],v[32:35],v[96:99],a[128:131]
 s_waitcnt vmcnt(63)
 s_barrier
 v_mfma_f32_16x16x32_bf16 a[128:131],v[36:39],v[112:115],a[128:131]
 ds_read_b64_tr_b16 v[16:17],v236
 ds_read_b64_tr_b16 v[18:19],v236 offset:6144
 v_mfma_f32_16x16x32_bf16 a[132:135],v[36:39],v[116:119],a[132:135]
 s_add_u32 m0,s35,52224
 s_add_u32 s44,s39,10240
 buffer_load_dwordx4 v1,s[12:15],s44 offen lds
 v_mfma_f32_16x16x32_bf16 a[132:135],v[32:35],v[100:103],a[132:135]
 v_mfma_f32_16x16x32_bf16 a[136:139],v[32:35],v[104:107],a[136:139]
 ds_read_b64_tr_b16 v[20:21],v236 offset:12288
 ds_read_b64_tr_b16 v[22:23],v236 offset:18432
 v_mfma_f32_16x16x32_bf16 a[136:139],v[36:39],v[120:123],a[136:139]
 buffer_load_dwordx4 a[184:187],v4,s[4:7],s75 offen offset:1024 sc1
 v_mfma_f32_16x16x32_bf16 a[140:143],v[36:39],v[124:127],a[140:143]
 v_mfma_f32_16x16x32_bf16 a[140:143],v[32:35],v[108:111],a[140:143]
 s_waitcnt lgkmcnt(4)
 v_mfma_f32_16x16x32_bf16 a[144:147],v[40:43],v[96:99],a[144:147]
 ds_read_b64_tr_b16 v[24:25],v237
 ds_read_b64_tr_b16 v[26:27],v237 offset:6144
 v_mfma_f32_16x16x32_bf16 a[144:147],v[44:47],v[112:115],a[144:147]
 v_mfma_f32_16x16x32_bf16 a[148:151],v[44:47],v[116:119],a[148:151]
 v_mfma_f32_16x16x32_bf16 a[148:151],v[40:43],v[100:103],a[148:151]
 ds_read_b64_tr_b16 v[28:29],v237 offset:12288
 ds_read_b64_tr_b16 v[30:31],v237 offset:18432
 v_mfma_f32_16x16x32_bf16 a[152:155],v[40:43],v[104:107],a[152:155]
 buffer_load_dwordx4 v2,s[12:15],s44 offen offset:1024 lds
 v_mfma_f32_16x16x32_bf16 a[152:155],v[44:47],v[120:123],a[152:155]
 v_mfma_f32_16x16x32_bf16 a[156:159],v[44:47],v[124:127],a[156:159]
 v_mfma_f32_16x16x32_bf16 a[156:159],v[40:43],v[108:111],a[156:159]
 s_waitcnt vmcnt(40) lgkmcnt(4)
 v_mfma_f32_16x16x32_bf16 a[0:3],v[16:19],v[128:131],a[0:3]
 s_add_u32 s75,s74,593920
 ds_read_b64_tr_b16 v[32:33],v238
 ds_read_b64_tr_b16 v[34:35],v238 offset:6144
 v_mfma_f32_16x16x32_bf16 a[0:3],v[20:23],v[144:147],a[0:3]
 buffer_load_dwordx4 a[172:175],v4,s[4:7],s75 offen sc1
 v_mfma_f32_16x16x32_bf16 a[4:7],v[20:23],v[148:151],a[4:7]
 v_mfma_f32_16x16x32_bf16 a[4:7],v[16:19],v[132:135],a[4:7]
 ds_read_b64_tr_b16 v[36:37],v238 offset:12288
 ds_read_b64_tr_b16 v[38:39],v238 offset:18432
 v_mfma_f32_16x16x32_bf16 a[8:11],v[16:19],v[136:139],a[8:11]
 v_mfma_f32_16x16x32_bf16 a[8:11],v[20:23],v[152:155],a[8:11]
 buffer_load_dwordx4 v3,s[12:15],s44 offen offset:2048 lds
 v_mfma_f32_16x16x32_bf16 a[12:15],v[20:23],v[156:159],a[12:15]
 v_mfma_f32_16x16x32_bf16 a[12:15],v[16:19],v[140:143],a[12:15]
 s_waitcnt lgkmcnt(4)
 v_mfma_f32_16x16x32_bf16 a[16:19],v[24:27],v[128:131],a[16:19]
 ds_read_b64_tr_b16 v[40:41],v239
 ds_read_b64_tr_b16 v[42:43],v239 offset:6144
 v_mfma_f32_16x16x32_bf16 a[16:19],v[28:31],v[144:147],a[16:19]
 v_mfma_f32_16x16x32_bf16 a[20:23],v[28:31],v[148:151],a[20:23]
 buffer_load_dwordx4 a[188:191],v4,s[4:7],s75 offen offset:1024 sc1
 v_mfma_f32_16x16x32_bf16 a[20:23],v[24:27],v[132:135],a[20:23]
 ds_read_b64_tr_b16 v[44:45],v239 offset:12288
 ds_read_b64_tr_b16 v[46:47],v239 offset:18432
 v_mfma_f32_16x16x32_bf16 a[24:27],v[24:27],v[136:139],a[24:27]
 v_mfma_f32_16x16x32_bf16 a[24:27],v[28:31],v[152:155],a[24:27]
 v_mfma_f32_16x16x32_bf16 a[28:31],v[28:31],v[156:159],a[28:31]
 s_add_u32 s63,s63,20480
 v_mfma_f32_16x16x32_bf16 a[28:31],v[24:27],v[140:143],a[28:31]
 s_cmp_eq_u32 s63,245760
 s_cselect_b32 s63,0,s63
 s_waitcnt lgkmcnt(4)
 v_mfma_f32_16x16x32_bf16 a[32:35],v[32:35],v[128:131],a[32:35]
 s_add_u32 s76,s76,4096
 ds_read_b64_tr_b16 v[16:17],v236 offset:128
 ds_read_b64_tr_b16 v[18:19],v236 offset:6272
 v_mfma_f32_16x16x32_bf16 a[32:35],v[36:39],v[144:147],a[32:35]
 s_add_u32 m0,s55,98304
 s_nop 0
 buffer_load_dwordx4 v4,s[24:27],s63 offen sc1 lds
 v_mfma_f32_16x16x32_bf16 a[36:39],v[36:39],v[148:151],a[36:39]
 s_cmp_eq_u32 s76,49152
 s_cselect_b32 s76,0,s76
 v_mfma_f32_16x16x32_bf16 a[36:39],v[32:35],v[132:135],a[36:39]
 ds_read_b64_tr_b16 v[20:21],v236 offset:12416
 ds_read_b64_tr_b16 v[22:23],v236 offset:18560
 v_mfma_f32_16x16x32_bf16 a[40:43],v[32:35],v[136:139],a[40:43]
 s_add_u32 s77,s76,s72
 v_mfma_f32_16x16x32_bf16 a[40:43],v[36:39],v[152:155],a[40:43]
 buffer_load_dwordx4 v[160:163],v4,s[28:31],s77 offen sc1
 v_mfma_f32_16x16x32_bf16 a[44:47],v[36:39],v[156:159],a[44:47]
 v_mfma_f32_16x16x32_bf16 a[44:47],v[32:35],v[140:143],a[44:47]
 s_waitcnt lgkmcnt(4)
 v_mfma_f32_16x16x32_bf16 a[48:51],v[40:43],v[128:131],a[48:51]
 ds_read_b64_tr_b16 v[24:25],v237 offset:128
 ds_read_b64_tr_b16 v[26:27],v237 offset:6272
 v_mfma_f32_16x16x32_bf16 a[48:51],v[44:47],v[144:147],a[48:51]
 v_add_u32 v240,4294918144,v236
 v_add_u32 v232,4294893568,v236
 v_mfma_f32_16x16x32_bf16 a[52:55],v[44:47],v[148:151],a[52:55]
 v_add_u32 v241,4294918144,v237
 v_add_u32 v233,4294893568,v237
 v_mfma_f32_16x16x32_bf16 a[52:55],v[40:43],v[132:135],a[52:55]
 ds_read_b64_tr_b16 v[28:29],v237 offset:12416
 ds_read_b64_tr_b16 v[30:31],v237 offset:18560
 v_mfma_f32_16x16x32_bf16 a[56:59],v[40:43],v[136:139],a[56:59]
 v_add_u32 v242,4294918144,v238
 v_add_u32 v234,4294893568,v238
 v_mfma_f32_16x16x32_bf16 a[56:59],v[44:47],v[152:155],a[56:59]
 v_add_u32 v243,4294918144,v239
 v_add_u32 v235,4294893568,v239
 v_mfma_f32_16x16x32_bf16 a[60:63],v[44:47],v[156:159],a[60:63]
 v_mfma_f32_16x16x32_bf16 a[60:63],v[40:43],v[140:143],a[60:63]
 s_waitcnt lgkmcnt(4)
 v_mfma_f32_16x16x32_bf16 a[64:67],v[16:19],v[128:131],a[64:67]
 ds_read_b64_tr_b16 v[32:33],v238 offset:128
 ds_read_b64_tr_b16 v[34:35],v238 offset:6272
 v_mfma_f32_16x16x32_bf16 a[64:67],v[20:23],v[144:147],a[64:67]
 v_mfma_f32_16x16x32_bf16 a[68:71],v[20:23],v[148:151],a[68:71]
 v_mfma_f32_16x16x32_bf16 a[68:71],v[16:19],v[132:135],a[68:71]
 ds_read_b64_tr_b16 v[36:37],v238 offset:12416
 ds_read_b64_tr_b16 v[38:39],v238 offset:18560
 v_mfma_f32_16x16x32_bf16 a[72:75],v[16:19],v[136:139],a[72:75]
 buffer_load_dwordx4 v4,s[24:27],s63 offen offset:1024 sc1 lds
 v_mfma_f32_16x16x32_bf16 a[72:75],v[20:23],v[152:155],a[72:75]
 v_mfma_f32_16x16x32_bf16 a[76:79],v[20:23],v[156:159],a[76:79]
 v_mfma_f32_16x16x32_bf16 a[76:79],v[16:19],v[140:143],a[76:79]
 s_waitcnt lgkmcnt(4)
 v_mfma_f32_16x16x32_bf16 a[80:83],v[24:27],v[128:131],a[80:83]
 ds_read_b64_tr_b16 v[40:41],v239 offset:128
 ds_read_b64_tr_b16 v[42:43],v239 offset:6272
 v_mfma_f32_16x16x32_bf16 a[80:83],v[28:31],v[144:147],a[80:83]
 v_mfma_f32_16x16x32_bf16 a[84:87],v[28:31],v[148:151],a[84:87]
 v_mfma_f32_16x16x32_bf16 a[84:87],v[24:27],v[132:135],a[84:87]
 ds_read_b64_tr_b16 v[44:45],v239 offset:12416
 ds_read_b64_tr_b16 v[46:47],v239 offset:18560
 v_mfma_f32_16x16x32_bf16 a[88:91],v[24:27],v[136:139],a[88:91]
 v_mfma_f32_16x16x32_bf16 a[88:91],v[28:31],v[152:155],a[88:91]
 v_mfma_f32_16x16x32_bf16 a[92:95],v[28:31],v[156:159],a[92:95]
 v_mfma_f32_16x16x32_bf16 a[92:95],v[24:27],v[140:143],a[92:95]
 s_waitcnt lgkmcnt(4)
 v_mfma_f32_16x16x32_bf16 a[96:99],v[32:35],v[128:131],a[96:99]
 ds_read_b64_tr_b16 v[16:17],v236 offset:256
 ds_read_b64_tr_b16 v[18:19],v236 offset:6400
 v_mfma_f32_16x16x32_bf16 a[96:99],v[36:39],v[144:147],a[96:99]
 buffer_load_dwordx4 v4,s[24:27],s63 offen offset:2048 sc1 lds
 v_mfma_f32_16x16x32_bf16 a[100:103],v[36:39],v[148:151],a[100:103]
 v_mfma_f32_16x16x32_bf16 a[100:103],v[32:35],v[132:135],a[100:103]
 ds_read_b64_tr_b16 v[20:21],v236 offset:12544
 ds_read_b64_tr_b16 v[22:23],v236 offset:18688
 v_mfma_f32_16x16x32_bf16 a[104:107],v[32:35],v[136:139],a[104:107]
 v_mfma_f32_16x16x32_bf16 a[104:107],v[36:39],v[152:155],a[104:107]
 v_mfma_f32_16x16x32_bf16 a[108:111],v[36:39],v[156:159],a[108:111]
 v_mfma_f32_16x16x32_bf16 a[108:111],v[32:35],v[140:143],a[108:111]
 s_waitcnt lgkmcnt(4)
 v_mfma_f32_16x16x32_bf16 a[112:115],v[40:43],v[128:131],a[112:115]
 ds_read_b64_tr_b16 v[24:25],v237 offset:256
 ds_read_b64_tr_b16 v[26:27],v237 offset:6400
 v_mfma_f32_16x16x32_bf16 a[112:115],v[44:47],v[144:147],a[112:115]
 v_mfma_f32_16x16x32_bf16 a[116:119],v[44:47],v[148:151],a[116:119]
 ds_read_b64_tr_b16 v[28:29],v237 offset:12544
 ds_read_b64_tr_b16 v[30:31],v237 offset:18688
 v_mfma_f32_16x16x32_bf16 a[116:119],v[40:43],v[132:135],a[116:119]
 v_add_u32 v236,4294868992,v236
 v_add_u32 v237,4294868992,v237
 v_mfma_f32_16x16x32_bf16 a[120:123],v[40:43],v[136:139],a[120:123]
 v_add_u32 v238,4294868992,v238
 v_add_u32 v239,4294868992,v239
 v_mfma_f32_16x16x32_bf16 a[120:123],v[44:47],v[152:155],a[120:123]
 buffer_load_dwordx4 v4,s[24:27],s63 offen offset:3072 sc1 lds
 v_mfma_f32_16x16x32_bf16 a[124:127],v[44:47],v[156:159],a[124:127]
 v_mfma_f32_16x16x32_bf16 a[124:127],v[40:43],v[140:143],a[124:127]
 s_waitcnt lgkmcnt(4)
 v_mfma_f32_16x16x32_bf16 a[128:131],v[16:19],v[128:131],a[128:131]
 s_waitcnt vmcnt(6)
 s_barrier
 v_mfma_f32_16x16x32_bf16 a[128:131],v[20:23],v[144:147],a[128:131]
 ds_read_b64_tr_b16 v[32:33],v236
 ds_read_b64_tr_b16 v[34:35],v236 offset:6144
 v_mfma_f32_16x16x32_bf16 a[132:135],v[20:23],v[148:151],a[132:135]
 v_mfma_f32_16x16x32_bf16 a[132:135],v[16:19],v[132:135],a[132:135]
 v_mfma_f32_16x16x32_bf16 a[136:139],v[16:19],v[136:139],a[136:139]
 ds_read_b64_tr_b16 v[36:37],v236 offset:12288
 ds_read_b64_tr_b16 v[38:39],v236 offset:18432
 v_mfma_f32_16x16x32_bf16 a[136:139],v[20:23],v[152:155],a[136:139]
 v_mfma_f32_16x16x32_bf16 a[140:143],v[20:23],v[156:159],a[140:143]
 s_add_u32 m0,s55,102400
 s_add_u32 s44,s63,4096
 buffer_load_dwordx4 v4,s[24:27],s44 offen sc1 lds
 v_mfma_f32_16x16x32_bf16 a[140:143],v[16:19],v[140:143],a[140:143]
 s_waitcnt lgkmcnt(4)
 v_mfma_f32_16x16x32_bf16 a[144:147],v[24:27],v[128:131],a[144:147]
 ds_read_b64_tr_b16 v[40:41],v240
 ds_read_b64_tr_b16 v[42:43],v240 offset:6144
 v_mfma_f32_16x16x32_bf16 a[144:147],v[28:31],v[144:147],a[144:147]
 v_mfma_f32_16x16x32_bf16 a[148:151],v[28:31],v[148:151],a[148:151]
 v_mfma_f32_16x16x32_bf16 a[148:151],v[24:27],v[132:135],a[148:151]
 ds_read_b64_tr_b16 v[44:45],v240 offset:12288
 ds_read_b64_tr_b16 v[46:47],v240 offset:18432
 v_mfma_f32_16x16x32_bf16 a[152:155],v[24:27],v[136:139],a[152:155]
 v_mfma_f32_16x16x32_bf16 a[152:155],v[28:31],v[152:155],a[152:155]
 v_mfma_f32_16x16x32_bf16 a[156:159],v[28:31],v[156:159],a[156:159]
 v_mfma_f32_16x16x32_bf16 a[156:159],v[24:27],v[140:143],a[156:159]
 s_waitcnt vmcnt(6) lgkmcnt(4)
 v_mfma_f32_16x16x32_bf16 a[0:3],v[32:35],a[192:195],a[0:3]
 ds_read_b64_tr_b16 v[16:17],v232
 ds_read_b64_tr_b16 v[18:19],v232 offset:6144
 v_mfma_f32_16x16x32_bf16 a[0:3],v[36:39],a[208:211],a[0:3]
 s_add_u32 s63,s63,20480
 v_mfma_f32_16x16x32_bf16 a[4:7],v[36:39],a[212:215],a[4:7]
 s_cmp_eq_u32 s63,245760
 s_cselect_b32 s63,0,s63
 v_mfma_f32_16x16x32_bf16 a[4:7],v[32:35],a[196:199],a[4:7]
 ds_read_b64_tr_b16 v[20:21],v232 offset:12288
 ds_read_b64_tr_b16 v[22:23],v232 offset:18432
 v_mfma_f32_16x16x32_bf16 a[8:11],v[32:35],a[200:203],a[8:11]
 s_add_u32 m0,s55,0
 s_nop 0
 buffer_load_dwordx4 v4,s[24:27],s63 offen sc1 lds
 v_mfma_f32_16x16x32_bf16 a[8:11],v[36:39],a[216:219],a[8:11]
 v_mfma_f32_16x16x32_bf16 a[12:15],v[36:39],a[220:223],a[12:15]
 v_mfma_f32_16x16x32_bf16 a[12:15],v[32:35],a[204:207],a[12:15]
 s_waitcnt lgkmcnt(4)
 v_mfma_f32_16x16x32_bf16 a[0:3],v[40:43],a[224:227],a[0:3]
 ds_read_b64_tr_b16 v[24:25],v237
 ds_read_b64_tr_b16 v[26:27],v237 offset:6144
 v_mfma_f32_16x16x32_bf16 a[0:3],v[44:47],a[240:243],a[0:3]
 v_mfma_f32_16x16x32_bf16 a[4:7],v[44:47],a[244:247],a[4:7]
 v_mfma_f32_16x16x32_bf16 a[4:7],v[40:43],a[228:231],a[4:7]
 ds_read_b64_tr_b16 v[28:29],v237 offset:12288
 ds_read_b64_tr_b16 v[30:31],v237 offset:18432
 v_mfma_f32_16x16x32_bf16 a[8:11],v[40:43],a[232:235],a[8:11]
 v_mfma_f32_16x16x32_bf16 a[8:11],v[44:47],a[248:251],a[8:11]
 v_mfma_f32_16x16x32_bf16 a[12:15],v[44:47],a[252:255],a[12:15]
 buffer_load_dwordx4 v4,s[24:27],s63 offen offset:1024 sc1 lds
 v_mfma_f32_16x16x32_bf16 a[12:15],v[40:43],a[236:239],a[12:15]
 s_waitcnt lgkmcnt(4)
 v_mfma_f32_16x16x32_bf16 a[0:3],v[16:19],a[160:163],a[0:3]
 ds_read_b64_tr_b16 v[32:33],v241
 ds_read_b64_tr_b16 v[34:35],v241 offset:6144
 v_mfma_f32_16x16x32_bf16 a[0:3],v[20:23],a[176:179],a[0:3]
 v_mfma_f32_16x16x32_bf16 a[4:7],v[20:23],a[180:183],a[4:7]
 v_mfma_f32_16x16x32_bf16 a[4:7],v[16:19],a[164:167],a[4:7]
 ds_read_b64_tr_b16 v[36:37],v241 offset:12288
 ds_read_b64_tr_b16 v[38:39],v241 offset:18432
 v_mfma_f32_16x16x32_bf16 a[8:11],v[16:19],a[168:171],a[8:11]
 v_mfma_f32_16x16x32_bf16 a[8:11],v[20:23],a[184:187],a[8:11]
 v_mfma_f32_16x16x32_bf16 a[12:15],v[20:23],a[188:191],a[12:15]
 v_mfma_f32_16x16x32_bf16 a[12:15],v[16:19],a[172:175],a[12:15]
 s_waitcnt lgkmcnt(4)
 v_mfma_f32_16x16x32_bf16 a[16:19],v[24:27],a[192:195],a[16:19]
 ds_read_b64_tr_b16 v[40:41],v233
 ds_read_b64_tr_b16 v[42:43],v233 offset:6144
 v_mfma_f32_16x16x32_bf16 a[16:19],v[28:31],a[208:211],a[16:19]
 v_mfma_f32_16x16x32_bf16 a[20:23],v[28:31],a[212:215],a[20:23]
 buffer_load_dwordx4 v4,s[24:27],s63 offen offset:2048 sc1 lds
 v_mfma_f32_16x16x32_bf16 a[20:23],v[24:27],a[196:199],a[20:23]
 ds_read_b64_tr_b16 v[44:45],v233 offset:12288
 ds_read_b64_tr_b16 v[46:47],v233 offset:18432
 v_mfma_f32_16x16x32_bf16 a[24:27],v[24:27],a[200:203],a[24:27]
 v_mfma_f32_16x16x32_bf16 a[24:27],v[28:31],a[216:219],a[24:27]
 v_accvgpr_read_b32 v48,a0
 v_accvgpr_read_b32 v49,a1
 v_mfma_f32_16x16x32_bf16 a[28:31],v[28:31],a[220:223],a[28:31]
 v_accvgpr_read_b32 v50,a2
 v_accvgpr_read_b32 v51,a3
 v_mfma_f32_16x16x32_bf16 a[28:31],v[24:27],a[204:207],a[28:31]
 s_waitcnt lgkmcnt(4)
 v_cvt_pk_bf16_f32 v64,v48,v49
 v_cvt_pk_bf16_f32 v65,v50,v51
 v_mfma_f32_16x16x32_bf16 a[16:19],v[32:35],a[224:227],a[16:19]
 ds_read_b64_tr_b16 v[16:17],v238
 ds_read_b64_tr_b16 v[18:19],v238 offset:6144
 v_mfma_f32_16x16x32_bf16 a[16:19],v[36:39],a[240:243],a[16:19]
 v_accvgpr_read_b32 v52,a4
 v_accvgpr_read_b32 v53,a5
 v_mfma_f32_16x16x32_bf16 a[20:23],v[36:39],a[244:247],a[20:23]
 s_barrier
 v_accvgpr_read_b32 v54,a6
 v_accvgpr_read_b32 v55,a7
 v_mfma_f32_16x16x32_bf16 a[20:23],v[32:35],a[228:231],a[20:23]
 ds_read_b64_tr_b16 v[20:21],v238 offset:12288
 ds_read_b64_tr_b16 v[22:23],v238 offset:18432
 v_mfma_f32_16x16x32_bf16 a[24:27],v[32:35],a[232:235],a[24:27]
 v_cvt_pk_bf16_f32 v74,v52,v53
 v_cvt_pk_bf16_f32 v75,v54,v55
 v_mfma_f32_16x16x32_bf16 a[24:27],v[36:39],a[248:251],a[24:27]
 buffer_load_dwordx4 v4,s[24:27],s63 offen offset:3072 sc1 lds
 v_accvgpr_read_b32 v56,a8
 v_accvgpr_read_b32 v57,a9
 v_mfma_f32_16x16x32_bf16 a[28:31],v[36:39],a[252:255],a[28:31]
 v_accvgpr_read_b32 v58,a10
 v_accvgpr_read_b32 v59,a11
 v_mfma_f32_16x16x32_bf16 a[28:31],v[32:35],a[236:239],a[28:31]
 s_waitcnt lgkmcnt(4)
 v_cvt_pk_bf16_f32 v84,v56,v57
 v_cvt_pk_bf16_f32 v85,v58,v59
 v_mfma_f32_16x16x32_bf16 a[16:19],v[40:43],a[160:163],a[16:19]
 ds_read_b64_tr_b16 v[24:25],v242
 ds_read_b64_tr_b16 v[26:27],v242 offset:6144
 v_mfma_f32_16x16x32_bf16 a[16:19],v[44:47],a[176:179],a[16:19]
 v_accvgpr_read_b32 v60,a12
 v_accvgpr_read_b32 v61,a13
 v_mfma_f32_16x16x32_bf16 a[20:23],v[44:47],a[180:183],a[20:23]
 v_accvgpr_read_b32 v62,a14
 v_accvgpr_read_b32 v63,a15
 v_mfma_f32_16x16x32_bf16 a[20:23],v[40:43],a[164:167],a[20:23]
 ds_read_b64_tr_b16 v[28:29],v242 offset:12288
 ds_read_b64_tr_b16 v[30:31],v242 offset:18432
 v_mfma_f32_16x16x32_bf16 a[24:27],v[40:43],a[168:171],a[24:27]
 v_cvt_pk_bf16_f32 v94,v60,v61
 v_cvt_pk_bf16_f32 v95,v62,v63
 v_mfma_f32_16x16x32_bf16 a[24:27],v[44:47],a[184:187],a[24:27]
 v_mfma_f32_16x16x32_bf16 a[28:31],v[44:47],a[188:191],a[28:31]
 v_mfma_f32_16x16x32_bf16 a[28:31],v[40:43],a[172:175],a[28:31]
 s_waitcnt lgkmcnt(4)
 v_mfma_f32_16x16x32_bf16 a[32:35],v[16:19],a[192:195],a[32:35]
 ds_read_b64_tr_b16 v[32:33],v234
 ds_read_b64_tr_b16 v[34:35],v234 offset:6144
 v_mfma_f32_16x16x32_bf16 a[32:35],v[20:23],a[208:211],a[32:35]
 s_add_u32 m0,s55,4096
 s_add_u32 s44,s63,4096
 buffer_load_dwordx4 v4,s[24:27],s44 offen sc1 lds
 v_mfma_f32_16x16x32_bf16 a[36:39],v[20:23],a[212:215],a[36:39]
 s_add_u32 s63,s63,20480
 s_cmp_eq_u32 s63,245760
 s_cselect_b32 s63,0,s63
 s_add_u32 m0,s55,122880
 s_nop 0
 buffer_load_dwordx4 v4,s[24:27],s63 offen sc1 lds
 v_mfma_f32_16x16x32_bf16 a[36:39],v[16:19],a[196:199],a[36:39]
 ds_read_b64_tr_b16 v[36:37],v234 offset:12288
 ds_read_b64_tr_b16 v[38:39],v234 offset:18432
 v_mfma_f32_16x16x32_bf16 a[40:43],v[16:19],a[200:203],a[40:43]
 buffer_load_dwordx4 v4,s[24:27],s63 offen offset:1024 sc1 lds
 v_mfma_f32_16x16x32_bf16 a[40:43],v[20:23],a[216:219],a[40:43]
 s_add_u32 s77,s76,s73
 v_accvgpr_read_b32 v48,a16
 v_accvgpr_read_b32 v49,a17
 v_mfma_f32_16x16x32_bf16 a[44:47],v[20:23],a[220:223],a[44:47]
 buffer_load_dwordx4 v[164:167],v4,s[28:31],s77 offen sc1
 v_accvgpr_read_b32 v50,a18
 v_accvgpr_read_b32 v51,a19
 v_mfma_f32_16x16x32_bf16 a[44:47],v[16:19],a[204:207],a[44:47]
 s_waitcnt lgkmcnt(4)
 v_cvt_pk_bf16_f32 v66,v48,v49
 v_cvt_pk_bf16_f32 v67,v50,v51
 v_mfma_f32_16x16x32_bf16 a[32:35],v[24:27],a[224:227],a[32:35]
 s_add_u32 s1,s37,0
 buffer_store_dwordx4 v[64:67],v4,s[16:19],s1 offen sc1
 ds_read_b64_tr_b16 v[40:41],v239
 ds_read_b64_tr_b16 v[42:43],v239 offset:6144
 v_mfma_f32_16x16x32_bf16 a[32:35],v[28:31],a[240:243],a[32:35]
 v_accvgpr_read_b32 v52,a20
 v_accvgpr_read_b32 v53,a21
 v_mfma_f32_16x16x32_bf16 a[36:39],v[28:31],a[244:247],a[36:39]
 v_accvgpr_read_b32 v54,a22
 v_accvgpr_read_b32 v55,a23
 v_mfma_f32_16x16x32_bf16 a[36:39],v[24:27],a[228:231],a[36:39]
 ds_read_b64_tr_b16 v[44:45],v239 offset:12288
 ds_read_b64_tr_b16 v[46:47],v239 offset:18432
 v_mfma_f32_16x16x32_bf16 a[40:43],v[24:27],a[232:235],a[40:43]
 v_cvt_pk_bf16_f32 v76,v52,v53
 v_cvt_pk_bf16_f32 v77,v54,v55
 v_mfma_f32_16x16x32_bf16 a[40:43],v[28:31],a[248:251],a[40:43]
 s_add_u32 s1,s37,2560
 buffer_store_dwordx4 v[74:77],v4,s[16:19],s1 offen sc1
 v_accvgpr_read_b32 v56,a24
 v_accvgpr_read_b32 v57,a25
 v_mfma_f32_16x16x32_bf16 a[44:47],v[28:31],a[252:255],a[44:47]
 v_accvgpr_read_b32 v58,a26
 v_accvgpr_read_b32 v59,a27
 v_mfma_f32_16x16x32_bf16 a[44:47],v[24:27],a[236:239],a[44:47]
 s_waitcnt lgkmcnt(4)
 v_cvt_pk_bf16_f32 v86,v56,v57
 v_cvt_pk_bf16_f32 v87,v58,v59
 v_mfma_f32_16x16x32_bf16 a[32:35],v[32:35],a[160:163],a[32:35]
 s_add_u32 s1,s37,5120
 buffer_store_dwordx4 v[84:87],v4,s[16:19],s1 offen sc1
 ds_read_b64_tr_b16 v[16:17],v243
 ds_read_b64_tr_b16 v[18:19],v243 offset:6144
 v_mfma_f32_16x16x32_bf16 a[32:35],v[36:39],a[176:179],a[32:35]
 v_accvgpr_read_b32 v60,a28
 v_accvgpr_read_b32 v61,a29
 v_mfma_f32_16x16x32_bf16 a[36:39],v[36:39],a[180:183],a[36:39]
 v_accvgpr_read_b32 v62,a30
 v_accvgpr_read_b32 v63,a31
 v_mfma_f32_16x16x32_bf16 a[36:39],v[32:35],a[164:167],a[36:39]
 ds_read_b64_tr_b16 v[20:21],v243 offset:12288
 ds_read_b64_tr_b16 v[22:23],v243 offset:18432
 v_mfma_f32_16x16x32_bf16 a[40:43],v[32:35],a[168:171],a[40:43]
 v_cvt_pk_bf16_f32 v96,v60,v61
 v_cvt_pk_bf16_f32 v97,v62,v63
 v_mfma_f32_16x16x32_bf16 a[40:43],v[36:39],a[184:187],a[40:43]
 s_add_u32 s1,s37,7680
 buffer_store_dwordx4 v[94:97],v4,s[16:19],s1 offen sc1
 s_add_u32 s77,s76,s78
 v_mfma_f32_16x16x32_bf16 a[44:47],v[36:39],a[188:191],a[44:47]
 buffer_load_dwordx4 v[168:171],v4,s[28:31],s77 offen sc1
 v_mfma_f32_16x16x32_bf16 a[44:47],v[32:35],a[172:175],a[44:47]
 s_waitcnt lgkmcnt(4)
 v_mfma_f32_16x16x32_bf16 a[48:51],v[40:43],a[192:195],a[48:51]
 ds_read_b64_tr_b16 v[24:25],v235
 ds_read_b64_tr_b16 v[26:27],v235 offset:6144
 v_mfma_f32_16x16x32_bf16 a[48:51],v[44:47],a[208:211],a[48:51]
 v_mfma_f32_16x16x32_bf16 a[52:55],v[44:47],a[212:215],a[52:55]
 v_mfma_f32_16x16x32_bf16 a[52:55],v[40:43],a[196:199],a[52:55]
 ds_read_b64_tr_b16 v[28:29],v235 offset:12288
 ds_read_b64_tr_b16 v[30:31],v235 offset:18432
 v_mfma_f32_16x16x32_bf16 a[56:59],v[40:43],a[200:203],a[56:59]
 buffer_load_dwordx4 v4,s[24:27],s63 offen offset:2048 sc1 lds
 v_mfma_f32_16x16x32_bf16 a[56:59],v[44:47],a[216:219],a[56:59]
 v_accvgpr_read_b32 v48,a32
 v_accvgpr_read_b32 v49,a33
 v_mfma_f32_16x16x32_bf16 a[60:63],v[44:47],a[220:223],a[60:63]
 v_accvgpr_read_b32 v50,a34
 v_accvgpr_read_b32 v51,a35
 v_mfma_f32_16x16x32_bf16 a[60:63],v[40:43],a[204:207],a[60:63]
 s_waitcnt lgkmcnt(4)
 v_cvt_pk_bf16_f32 v68,v48,v49
 v_cvt_pk_bf16_f32 v69,v50,v51
 v_mfma_f32_16x16x32_bf16 a[48:51],v[16:19],a[224:227],a[48:51]
 ds_read_b64_tr_b16 v[32:33],v236 offset:128
 ds_read_b64_tr_b16 v[34:35],v236 offset:6272
 v_mfma_f32_16x16x32_bf16 a[48:51],v[20:23],a[240:243],a[48:51]
 buffer_load_dwordx4 v4,s[24:27],s63 offen offset:3072 sc1 lds
 v_accvgpr_read_b32 v52,a36
 v_accvgpr_read_b32 v53,a37
 v_mfma_f32_16x16x32_bf16 a[52:55],v[20:23],a[244:247],a[52:55]
 v_accvgpr_read_b32 v54,a38
 v_accvgpr_read_b32 v55,a39
 v_mfma_f32_16x16x32_bf16 a[52:55],v[16:19],a[228:231],a[52:55]
 s_add_u32 s77,s76,s79
 ds_read_b64_tr_b16 v[36:37],v236 offset:12416
 ds_read_b64_tr_b16 v[38:39],v236 offset:18560
 v_mfma_f32_16x16x32_bf16 a[56:59],v[16:19],a[232:235],a[56:59]
 buffer_load_dwordx4 v[172:175],v4,s[28:31],s77 offen sc1
 v_cvt_pk_bf16_f32 v78,v52,v53
 v_cvt_pk_bf16_f32 v79,v54,v55
 v_mfma_f32_16x16x32_bf16 a[56:59],v[20:23],a[248:251],a[56:59]
 v_accvgpr_read_b32 v56,a40
 v_accvgpr_read_b32 v57,a41
 v_mfma_f32_16x16x32_bf16 a[60:63],v[20:23],a[252:255],a[60:63]
 v_accvgpr_read_b32 v58,a42
 v_accvgpr_read_b32 v59,a43
 v_mfma_f32_16x16x32_bf16 a[60:63],v[16:19],a[236:239],a[60:63]
 s_waitcnt lgkmcnt(4)
 v_cvt_pk_bf16_f32 v88,v56,v57
 v_cvt_pk_bf16_f32 v89,v58,v59
 v_mfma_f32_16x16x32_bf16 a[48:51],v[24:27],a[160:163],a[48:51]
 ds_read_b64_tr_b16 v[40:41],v240 offset:128
 ds_read_b64_tr_b16 v[42:43],v240 offset:6272
 v_mfma_f32_16x16x32_bf16 a[48:51],v[28:31],a[176:179],a[48:51]
 v_accvgpr_read_b32 v60,a44
 v_accvgpr_read_b32 v61,a45
 v_mfma_f32_16x16x32_bf16 a[52:55],v[28:31],a[180:183],a[52:55]
 v_accvgpr_read_b32 v62,a46
 v_accvgpr_read_b32 v63,a47
 v_mfma_f32_16x16x32_bf16 a[52:55],v[24:27],a[164:167],a[52:55]
 ds_read_b64_tr_b16 v[44:45],v240 offset:12416
 ds_read_b64_tr_b16 v[46:47],v240 offset:18560
 v_mfma_f32_16x16x32_bf16 a[56:59],v[24:27],a[168:171],a[56:59]
 v_cvt_pk_bf16_f32 v98,v60,v61
 v_cvt_pk_bf16_f32 v99,v62,v63
 v_mfma_f32_16x16x32_bf16 a[56:59],v[28:31],a[184:187],a[56:59]
 s_add_u32 m0,s55,126976
 s_add_u32 s44,s63,4096
 buffer_load_dwordx4 v4,s[24:27],s44 offen sc1 lds
 v_mfma_f32_16x16x32_bf16 a[60:63],v[28:31],a[188:191],a[60:63]
 v_mfma_f32_16x16x32_bf16 a[60:63],v[24:27],a[172:175],a[60:63]
 s_waitcnt lgkmcnt(4)
 v_mfma_f32_16x16x32_bf16 a[64:67],v[32:35],a[192:195],a[64:67]
 ds_read_b64_tr_b16 v[16:17],v232 offset:128
 ds_read_b64_tr_b16 v[18:19],v232 offset:6272
 v_mfma_f32_16x16x32_bf16 a[64:67],v[36:39],a[208:211],a[64:67]
 s_add_u32 s76,s76,4096
 v_mfma_f32_16x16x32_bf16 a[68:71],v[36:39],a[212:215],a[68:71]
 s_cmp_eq_u32 s76,49152
 s_cselect_b32 s76,0,s76
 v_mfma_f32_16x16x32_bf16 a[68:71],v[32:35],a[196:199],a[68:71]
 s_add_u32 s77,s76,s72
 ds_read_b64_tr_b16 v[20:21],v232 offset:12416
 ds_read_b64_tr_b16 v[22:23],v232 offset:18560
 v_mfma_f32_16x16x32_bf16 a[72:75],v[32:35],a[200:203],a[72:75]
 buffer_load_dwordx4 v[176:179],v4,s[28:31],s77 offen sc1
 v_mfma_f32_16x16x32_bf16 a[72:75],v[36:39],a[216:219],a[72:75]
 v_accvgpr_read_b32 v48,a48
 v_accvgpr_read_b32 v49,a49
 v_mfma_f32_16x16x32_bf16 a[76:79],v[36:39],a[220:223],a[76:79]
 v_accvgpr_read_b32 v50,a50
 v_accvgpr_read_b32 v51,a51
 v_mfma_f32_16x16x32_bf16 a[76:79],v[32:35],a[204:207],a[76:79]
 s_waitcnt lgkmcnt(4)
 v_cvt_pk_bf16_f32 v70,v48,v49
 v_cvt_pk_bf16_f32 v71,v50,v51
 v_mfma_f32_16x16x32_bf16 a[64:67],v[40:43],a[224:227],a[64:67]
 s_add_u32 s1,s37,0
 buffer_store_dwordx4 v[68:71],v4,s[16:19],s1 offen offset:1024 sc1
 ds_read_b64_tr_b16 v[24:25],v237 offset:128
 ds_read_b64_tr_b16 v[26:27],v237 offset:6272
 v_mfma_f32_16x16x32_bf16 a[64:67],v[44:47],a[240:243],a[64:67]
 v_accvgpr_read_b32 v52,a52
 v_accvgpr_read_b32 v53,a53
 v_mfma_f32_16x16x32_bf16 a[68:71],v[44:47],a[244:247],a[68:71]
 v_accvgpr_read_b32 v54,a54
 v_accvgpr_read_b32 v55,a55
 v_mfma_f32_16x16x32_bf16 a[68:71],v[40:43],a[228:231],a[68:71]
 ds_read_b64_tr_b16 v[28:29],v237 offset:12416
 ds_read_b64_tr_b16 v[30:31],v237 offset:18560
 v_mfma_f32_16x16x32_bf16 a[72:75],v[40:43],a[232:235],a[72:75]
 v_cvt_pk_bf16_f32 v80,v52,v53
 v_cvt_pk_bf16_f32 v81,v54,v55
 v_mfma_f32_16x16x32_bf16 a[72:75],v[44:47],a[248:251],a[72:75]
 s_add_u32 s1,s37,2560
 buffer_store_dwordx4 v[78:81],v4,s[16:19],s1 offen offset:1024 sc1
 v_accvgpr_read_b32 v56,a56
 v_accvgpr_read_b32 v57,a57
 v_mfma_f32_16x16x32_bf16 a[76:79],v[44:47],a[252:255],a[76:79]
 v_accvgpr_read_b32 v58,a58
 v_accvgpr_read_b32 v59,a59
 v_mfma_f32_16x16x32_bf16 a[76:79],v[40:43],a[236:239],a[76:79]
 s_waitcnt lgkmcnt(4)
 v_cvt_pk_bf16_f32 v90,v56,v57
 v_cvt_pk_bf16_f32 v91,v58,v59
 v_mfma_f32_16x16x32_bf16 a[64:67],v[16:19],a[160:163],a[64:67]
 s_add_u32 s1,s37,5120
 buffer_store_dwordx4 v[88:91],v4,s[16:19],s1 offen offset:1024 sc1
 ds_read_b64_tr_b16 v[32:33],v241 offset:128
 ds_read_b64_tr_b16 v[34:35],v241 offset:6272
 v_mfma_f32_16x16x32_bf16 a[64:67],v[20:23],a[176:179],a[64:67]
 v_accvgpr_read_b32 v60,a60
 v_accvgpr_read_b32 v61,a61
 v_mfma_f32_16x16x32_bf16 a[68:71],v[20:23],a[180:183],a[68:71]
 v_accvgpr_read_b32 v62,a62
 v_accvgpr_read_b32 v63,a63
 v_mfma_f32_16x16x32_bf16 a[68:71],v[16:19],a[164:167],a[68:71]
 ds_read_b64_tr_b16 v[36:37],v241 offset:12416
 ds_read_b64_tr_b16 v[38:39],v241 offset:18560
 v_mfma_f32_16x16x32_bf16 a[72:75],v[16:19],a[168:171],a[72:75]
 v_cvt_pk_bf16_f32 v100,v60,v61
 v_cvt_pk_bf16_f32 v101,v62,v63
 v_mfma_f32_16x16x32_bf16 a[72:75],v[20:23],a[184:187],a[72:75]
 s_add_u32 s1,s37,7680
 buffer_store_dwordx4 v[98:101],v4,s[16:19],s1 offen offset:1024 sc1
 s_add_u32 s77,s76,s73
 v_mfma_f32_16x16x32_bf16 a[76:79],v[20:23],a[188:191],a[76:79]
 buffer_load_dwordx4 v[180:183],v4,s[28:31],s77 offen sc1
 v_mfma_f32_16x16x32_bf16 a[76:79],v[16:19],a[172:175],a[76:79]
 s_waitcnt lgkmcnt(4)
 v_mfma_f32_16x16x32_bf16 a[80:83],v[24:27],a[192:195],a[80:83]
 ds_read_b64_tr_b16 v[40:41],v233 offset:128
 ds_read_b64_tr_b16 v[42:43],v233 offset:6272
 v_mfma_f32_16x16x32_bf16 a[80:83],v[28:31],a[208:211],a[80:83]
 v_mfma_f32_16x16x32_bf16 a[84:87],v[28:31],a[212:215],a[84:87]
 v_mfma_f32_16x16x32_bf16 a[84:87],v[24:27],a[196:199],a[84:87]
 ds_read_b64_tr_b16 v[44:45],v233 offset:12416
 ds_read_b64_tr_b16 v[46:47],v233 offset:18560
 v_mfma_f32_16x16x32_bf16 a[88:91],v[24:27],a[200:203],a[88:91]
 v_mfma_f32_16x16x32_bf16 a[88:91],v[28:31],a[216:219],a[88:91]
 v_accvgpr_read_b32 v48,a64
 v_accvgpr_read_b32 v49,a65
 v_mfma_f32_16x16x32_bf16 a[92:95],v[28:31],a[220:223],a[92:95]
 v_accvgpr_read_b32 v50,a66
 v_accvgpr_read_b32 v51,a67
 v_mfma_f32_16x16x32_bf16 a[92:95],v[24:27],a[204:207],a[92:95]
 s_waitcnt lgkmcnt(4)
 v_cvt_pk_bf16_f32 v72,v48,v49
 v_cvt_pk_bf16_f32 v73,v50,v51
 v_mfma_f32_16x16x32_bf16 a[80:83],v[32:35],a[224:227],a[80:83]
 s_add_u32 s1,s37,0
 buffer_store_dwordx2 v[72:73],v5,s[16:19],s1 offen offset:2048 sc1
 ds_read_b64_tr_b16 v[16:17],v238 offset:128
 ds_read_b64_tr_b16 v[18:19],v238 offset:6272
 v_mfma_f32_16x16x32_bf16 a[80:83],v[36:39],a[240:243],a[80:83]
 v_accvgpr_read_b32 v52,a68
 v_accvgpr_read_b32 v53,a69
 v_mfma_f32_16x16x32_bf16 a[84:87],v[36:39],a[244:247],a[84:87]
 v_accvgpr_read_b32 v54,a70
 v_accvgpr_read_b32 v55,a71
 v_mfma_f32_16x16x32_bf16 a[84:87],v[32:35],a[228:231],a[84:87]
 s_add_u32 s77,s76,s78
 ds_read_b64_tr_b16 v[20:21],v238 offset:12416
 ds_read_b64_tr_b16 v[22:23],v238 offset:18560
 v_mfma_f32_16x16x32_bf16 a[88:91],v[32:35],a[232:235],a[88:91]
 buffer_load_dwordx4 v[184:187],v4,s[28:31],s77 offen sc1
 v_cvt_pk_bf16_f32 v82,v52,v53
 v_cvt_pk_bf16_f32 v83,v54,v55
 v_mfma_f32_16x16x32_bf16 a[88:91],v[36:39],a[248:251],a[88:91]
 s_add_u32 s1,s37,2560
 buffer_store_dwordx2 v[82:83],v5,s[16:19],s1 offen offset:2048 sc1
 v_accvgpr_read_b32 v56,a72
 v_accvgpr_read_b32 v57,a73
 v_mfma_f32_16x16x32_bf16 a[92:95],v[36:39],a[252:255],a[92:95]
 v_accvgpr_read_b32 v58,a74
 v_accvgpr_read_b32 v59,a75
 v_mfma_f32_16x16x32_bf16 a[92:95],v[32:35],a[236:239],a[92:95]
 s_waitcnt lgkmcnt(4)
 v_cvt_pk_bf16_f32 v92,v56,v57
 v_cvt_pk_bf16_f32 v93,v58,v59
 v_mfma_f32_16x16x32_bf16 a[80:83],v[40:43],a[160:163],a[80:83]
 s_add_u32 s1,s37,5120
 buffer_store_dwordx2 v[92:93],v5,s[16:19],s1 offen offset:2048 sc1
 ds_read_b64_tr_b16 v[24:25],v242 offset:128
 ds_read_b64_tr_b16 v[26:27],v242 offset:6272
 v_mfma_f32_16x16x32_bf16 a[80:83],v[44:47],a[176:179],a[80:83]
 v_accvgpr_read_b32 v60,a76
 v_accvgpr_read_b32 v61,a77
 v_mfma_f32_16x16x32_bf16 a[84:87],v[44:47],a[180:183],a[84:87]
 v_accvgpr_read_b32 v62,a78
 v_accvgpr_read_b32 v63,a79
 v_mfma_f32_16x16x32_bf16 a[84:87],v[40:43],a[164:167],a[84:87]
 ds_read_b64_tr_b16 v[28:29],v242 offset:12416
 ds_read_b64_tr_b16 v[30:31],v242 offset:18560
 v_mfma_f32_16x16x32_bf16 a[88:91],v[40:43],a[168:171],a[88:91]
 v_cvt_pk_bf16_f32 v102,v60,v61
 v_cvt_pk_bf16_f32 v103,v62,v63
 v_mfma_f32_16x16x32_bf16 a[88:91],v[44:47],a[184:187],a[88:91]
 s_add_u32 s1,s37,7680
 buffer_store_dwordx2 v[102:103],v5,s[16:19],s1 offen offset:2048 sc1
 s_cmp_eq_u32 s18,0
 s_cbranch_scc0 Lk39
 ds_write_b128 v10,v[64:67]
 ds_write_b128 v10,v[68:71] offset:1024
 ds_write_b64 v11,v[72:73] offset:2048
 ds_write_b128 v10,v[74:77] offset:2560
 ds_write_b128 v10,v[78:81] offset:3584
 ds_write_b64 v11,v[82:83] offset:4608
 ds_write_b128 v10,v[84:87] offset:5120
 ds_write_b128 v10,v[88:91] offset:6144
 ds_write_b64 v11,v[92:93] offset:7168
 ds_write_b128 v10,v[94:97] offset:7680
 ds_write_b128 v10,v[98:101] offset:8704
 ds_write_b64 v11,v[102:103] offset:9728
Lk39:
 v_mfma_f32_16x16x32_bf16 a[92:95],v[44:47],a[188:191],a[92:95]
 v_mfma_f32_16x16x32_bf16 a[92:95],v[40:43],a[172:175],a[92:95]
 s_waitcnt lgkmcnt(4)
 v_mfma_f32_16x16x32_bf16 a[96:99],v[16:19],a[192:195],a[96:99]
 s_add_u32 s77,s76,s79
 ds_read_b64_tr_b16 v[32:33],v234 offset:128
 ds_read_b64_tr_b16 v[34:35],v234 offset:6272
 v_mfma_f32_16x16x32_bf16 a[96:99],v[20:23],a[208:211],a[96:99]
 buffer_load_dwordx4 v[188:191],v4,s[28:31],s77 offen sc1
 v_mfma_f32_16x16x32_bf16 a[100:103],v[20:23],a[212:215],a[100:103]
 v_mfma_f32_16x16x32_bf16 a[100:103],v[16:19],a[196:199],a[100:103]
 ds_read_b64_tr_b16 v[36:37],v234 offset:12416
 ds_read_b64_tr_b16 v[38:39],v234 offset:18560
 v_mfma_f32_16x16x32_bf16 a[104:107],v[16:19],a[200:203],a[104:107]
 v_mfma_f32_16x16x32_bf16 a[104:107],v[20:23],a[216:219],a[104:107]
 v_accvgpr_read_b32 v48,a80
 v_accvgpr_read_b32 v49,a81
 v_mfma_f32_16x16x32_bf16 a[108:111],v[20:23],a[220:223],a[108:111]
 v_accvgpr_read_b32 v50,a82
 v_accvgpr_read_b32 v51,a83
 v_mfma_f32_16x16x32_bf16 a[108:111],v[16:19],a[204:207],a[108:111]
 s_waitcnt lgkmcnt(4)
 v_cvt_pk_bf16_f32 v112,v48,v49
 v_cvt_pk_bf16_f32 v113,v50,v51
 v_mfma_f32_16x16x32_bf16 a[96:99],v[24:27],a[224:227],a[96:99]
 s_add_u32 s1,s37,81920
 buffer_store_dwordx2 v[112:113],v5,s[80:83],s1 offen offset:2048 sc1
 ds_read_b64_tr_b16 v[40:41],v239 offset:128
 ds_read_b64_tr_b16 v[42:43],v239 offset:6272
 v_mfma_f32_16x16x32_bf16 a[96:99],v[28:31],a[240:243],a[96:99]
 v_accvgpr_read_b32 v52,a84
 v_accvgpr_read_b32 v53,a85
 v_mfma_f32_16x16x32_bf16 a[100:103],v[28:31],a[244:247],a[100:103]
 v_accvgpr_read_b32 v54,a86
 v_accvgpr_read_b32 v55,a87
 v_mfma_f32_16x16x32_bf16 a[100:103],v[24:27],a[228:231],a[100:103]
 ds_read_b64_tr_b16 v[44:45],v239 offset:12416
 ds_read_b64_tr_b16 v[46:47],v239 offset:18560
 v_mfma_f32_16x16x32_bf16 a[104:107],v[24:27],a[232:235],a[104:107]
 s_add_u32 s76,s76,4096
 v_cvt_pk_bf16_f32 v122,v52,v53
 v_cvt_pk_bf16_f32 v123,v54,v55
 v_mfma_f32_16x16x32_bf16 a[104:107],v[28:31],a[248:251],a[104:107]
 s_add_u32 s1,s37,84480
 buffer_store_dwordx2 v[122:123],v5,s[80:83],s1 offen offset:2048 sc1
 v_accvgpr_read_b32 v56,a88
 v_accvgpr_read_b32 v57,a89
 v_mfma_f32_16x16x32_bf16 a[108:111],v[28:31],a[252:255],a[108:111]
 s_cmp_eq_u32 s76,49152
 s_cselect_b32 s76,0,s76
 s_add_u32 s77,s76,s72
 v_accvgpr_read_b32 v58,a90
 v_accvgpr_read_b32 v59,a91
 v_mfma_f32_16x16x32_bf16 a[108:111],v[24:27],a[236:239],a[108:111]
 s_waitcnt lgkmcnt(4)
 v_cvt_pk_bf16_f32 v132,v56,v57
 v_cvt_pk_bf16_f32 v133,v58,v59
 v_mfma_f32_16x16x32_bf16 a[96:99],v[32:35],a[160:163],a[96:99]
 s_add_u32 s1,s37,87040
 buffer_store_dwordx2 v[132:133],v5,s[80:83],s1 offen offset:2048 sc1
 ds_read_b64_tr_b16 v[16:17],v243 offset:128
 ds_read_b64_tr_b16 v[18:19],v243 offset:6272
 v_mfma_f32_16x16x32_bf16 a[96:99],v[36:39],a[176:179],a[96:99]
 buffer_load_dwordx4 v[192:195],v4,s[28:31],s77 offen sc1
 v_accvgpr_read_b32 v60,a92
 v_accvgpr_read_b32 v61,a93
 v_mfma_f32_16x16x32_bf16 a[100:103],v[36:39],a[180:183],a[100:103]
 v_accvgpr_read_b32 v62,a94
 v_accvgpr_read_b32 v63,a95
 v_mfma_f32_16x16x32_bf16 a[100:103],v[32:35],a[164:167],a[100:103]
 ds_read_b64_tr_b16 v[20:21],v243 offset:12416
 ds_read_b64_tr_b16 v[22:23],v243 offset:18560
 v_mfma_f32_16x16x32_bf16 a[104:107],v[32:35],a[168:171],a[104:107]
 v_cvt_pk_bf16_f32 v142,v60,v61
 v_cvt_pk_bf16_f32 v143,v62,v63
 v_mfma_f32_16x16x32_bf16 a[104:107],v[36:39],a[184:187],a[104:107]
 s_add_u32 s1,s37,89600
 buffer_store_dwordx2 v[142:143],v5,s[80:83],s1 offen offset:2048 sc1
 v_mfma_f32_16x16x32_bf16 a[108:111],v[36:39],a[188:191],a[108:111]
 v_mfma_f32_16x16x32_bf16 a[108:111],v[32:35],a[172:175],a[108:111]
 s_waitcnt lgkmcnt(4)
 v_mfma_f32_16x16x32_bf16 a[112:115],v[40:43],a[192:195],a[112:115]
 ds_read_b64_tr_b16 v[24:25],v235 offset:128
 ds_read_b64_tr_b16 v[26:27],v235 offset:6272
 v_mfma_f32_16x16x32_bf16 a[112:115],v[44:47],a[208:211],a[112:115]
 v_mfma_f32_16x16x32_bf16 a[116:119],v[44:47],a[212:215],a[116:119]
 v_mfma_f32_16x16x32_bf16 a[116:119],v[40:43],a[196:199],a[116:119]
 ds_read_b64_tr_b16 v[28:29],v235 offset:12416
 ds_read_b64_tr_b16 v[30:31],v235 offset:18560
 v_mfma_f32_16x16x32_bf16 a[120:123],v[40:43],a[200:203],a[120:123]
 v_mfma_f32_16x16x32_bf16 a[120:123],v[44:47],a[216:219],a[120:123]
 v_accvgpr_read_b32 v48,a96
 v_accvgpr_read_b32 v49,a97
 v_mfma_f32_16x16x32_bf16 a[124:127],v[44:47],a[220:223],a[124:127]
 v_accvgpr_read_b32 v50,a98
 v_accvgpr_read_b32 v51,a99
 v_mfma_f32_16x16x32_bf16 a[124:127],v[40:43],a[204:207],a[124:127]
 s_waitcnt lgkmcnt(4)
 v_cvt_pk_bf16_f32 v104,v48,v49
 v_cvt_pk_bf16_f32 v105,v50,v51
 v_mfma_f32_16x16x32_bf16 a[112:115],v[16:19],a[224:227],a[112:115]
 s_add_u32 s77,s76,s73
 ds_read_b64_tr_b16 v[32:33],v236 offset:256
 ds_read_b64_tr_b16 v[34:35],v236 offset:6400
 v_mfma_f32_16x16x32_bf16 a[112:115],v[20:23],a[240:243],a[112:115]
 buffer_load_dwordx4 v[196:199],v4,s[28:31],s77 offen sc1
 v_accvgpr_read_b32 v52,a100
 v_accvgpr_read_b32 v53,a101
 v_mfma_f32_16x16x32_bf16 a[116:119],v[20:23],a[244:247],a[116:119]
 v_accvgpr_read_b32 v54,a102
 v_accvgpr_read_b32 v55,a103
 v_mfma_f32_16x16x32_bf16 a[116:119],v[16:19],a[228:231],a[116:119]
 ds_read_b64_tr_b16 v[36:37],v236 offset:12544
 ds_read_b64_tr_b16 v[38:39],v236 offset:18688
 v_mfma_f32_16x16x32_bf16 a[120:123],v[16:19],a[232:235],a[120:123]
 v_cvt_pk_bf16_f32 v114,v52,v53
 v_cvt_pk_bf16_f32 v115,v54,v55
 v_mfma_f32_16x16x32_bf16 a[120:123],v[20:23],a[248:251],a[120:123]
 v_accvgpr_read_b32 v56,a104
 v_accvgpr_read_b32 v57,a105
 v_mfma_f32_16x16x32_bf16 a[124:127],v[20:23],a[252:255],a[124:127]
 v_accvgpr_read_b32 v58,a106
 v_accvgpr_read_b32 v59,a107
 v_mfma_f32_16x16x32_bf16 a[124:127],v[16:19],a[236:239],a[124:127]
 s_waitcnt lgkmcnt(4)
 v_cvt_pk_bf16_f32 v124,v56,v57
 v_cvt_pk_bf16_f32 v125,v58,v59
 v_mfma_f32_16x16x32_bf16 a[112:115],v[24:27],a[160:163],a[112:115]
 ds_read_b64_tr_b16 v[40:41],v240 offset:256
 ds_read_b64_tr_b16 v[42:43],v240 offset:6400
 v_mfma_f32_16x16x32_bf16 a[112:115],v[28:31],a[176:179],a[112:115]
 v_accvgpr_read_b32 v60,a108
 v_accvgpr_read_b32 v61,a109
 v_mfma_f32_16x16x32_bf16 a[116:119],v[28:31],a[180:183],a[116:119]
 v_accvgpr_read_b32 v62,a110
 v_accvgpr_read_b32 v63,a111
 v_mfma_f32_16x16x32_bf16 a[116:119],v[24:27],a[164:167],a[116:119]
 ds_read_b64_tr_b16 v[44:45],v240 offset:12544
 ds_read_b64_tr_b16 v[46:47],v240 offset:18688
 v_mfma_f32_16x16x32_bf16 a[120:123],v[24:27],a[168:171],a[120:123]
 v_cvt_pk_bf16_f32 v134,v60,v61
 v_cvt_pk_bf16_f32 v135,v62,v63
 v_mfma_f32_16x16x32_bf16 a[120:123],v[28:31],a[184:187],a[120:123]
 v_mfma_f32_16x16x32_bf16 a[124:127],v[28:31],a[188:191],a[124:127]
 v_mfma_f32_16x16x32_bf16 a[124:127],v[24:27],a[172:175],a[124:127]
 s_waitcnt lgkmcnt(4)
 v_mfma_f32_16x16x32_bf16 a[128:131],v[32:35],a[192:195],a[128:131]
 s_add_u32 s77,s76,s78
 ds_read_b64_tr_b16 v[16:17],v232 offset:256
 ds_read_b64_tr_b16 v[18:19],v232 offset:6400
 v_mfma_f32_16x16x32_bf16 a[128:131],v[36:39],a[208:211],a[128:131]
 buffer_load_dwordx4 v[200:203],v4,s[28:31],s77 offen sc1
 v_mfma_f32_16x16x32_bf16 a[132:135],v[36:39],a[212:215],a[132:135]
 v_mfma_f32_16x16x32_bf16 a[132:135],v[32:35],a[196:199],a[132:135]
 ds_read_b64_tr_b16 v[20:21],v232 offset:12544
 ds_read_b64_tr_b16 v[22:23],v232 offset:18688
 v_mfma_f32_16x16x32_bf16 a[136:139],v[32:35],a[200:203],a[136:139]
 v_mfma_f32_16x16x32_bf16 a[136:139],v[36:39],a[216:219],a[136:139]
 v_accvgpr_read_b32 v48,a112
 v_accvgpr_read_b32 v49,a113
 v_mfma_f32_16x16x32_bf16 a[140:143],v[36:39],a[220:223],a[140:143]
 v_accvgpr_read_b32 v50,a114
 v_accvgpr_read_b32 v51,a115
 v_mfma_f32_16x16x32_bf16 a[140:143],v[32:35],a[204:207],a[140:143]
 s_waitcnt lgkmcnt(4)
 v_cvt_pk_bf16_f32 v106,v48,v49
 v_cvt_pk_bf16_f32 v107,v50,v51
 v_mfma_f32_16x16x32_bf16 a[128:131],v[40:43],a[224:227],a[128:131]
 s_add_u32 s1,s37,81920
 buffer_store_dwordx4 v[104:107],v4,s[80:83],s1 offen sc1
 ds_read_b64_tr_b16 v[24:25],v237 offset:256
 ds_read_b64_tr_b16 v[26:27],v237 offset:6400
 v_mfma_f32_16x16x32_bf16 a[128:131],v[44:47],a[240:243],a[128:131]
 v_accvgpr_read_b32 v52,a116
 v_accvgpr_read_b32 v53,a117
 v_mfma_f32_16x16x32_bf16 a[132:135],v[44:47],a[244:247],a[132:135]
 v_accvgpr_read_b32 v54,a118
 v_accvgpr_read_b32 v55,a119
 v_mfma_f32_16x16x32_bf16 a[132:135],v[40:43],a[228:231],a[132:135]
 ds_read_b64_tr_b16 v[28:29],v237 offset:12544
 ds_read_b64_tr_b16 v[30:31],v237 offset:18688
 v_mfma_f32_16x16x32_bf16 a[136:139],v[40:43],a[232:235],a[136:139]
 v_cvt_pk_bf16_f32 v116,v52,v53
 v_cvt_pk_bf16_f32 v117,v54,v55
 v_mfma_f32_16x16x32_bf16 a[136:139],v[44:47],a[248:251],a[136:139]
 s_add_u32 s1,s37,84480
 buffer_store_dwordx4 v[114:117],v4,s[80:83],s1 offen sc1
 v_accvgpr_read_b32 v56,a120
 v_accvgpr_read_b32 v57,a121
 v_mfma_f32_16x16x32_bf16 a[140:143],v[44:47],a[252:255],a[140:143]
 v_accvgpr_read_b32 v58,a122
 v_accvgpr_read_b32 v59,a123
 v_mfma_f32_16x16x32_bf16 a[140:143],v[40:43],a[236:239],a[140:143]
 s_waitcnt lgkmcnt(4)
 v_cvt_pk_bf16_f32 v126,v56,v57
 v_cvt_pk_bf16_f32 v127,v58,v59
 v_mfma_f32_16x16x32_bf16 a[128:131],v[16:19],a[160:163],a[128:131]
 s_add_u32 s1,s37,87040
 buffer_store_dwordx4 v[124:127],v4,s[80:83],s1 offen sc1
 ds_read_b64_tr_b16 v[32:33],v241 offset:256
 ds_read_b64_tr_b16 v[34:35],v241 offset:6400
 v_mfma_f32_16x16x32_bf16 a[128:131],v[20:23],a[176:179],a[128:131]
 v_accvgpr_read_b32 v60,a124
 v_accvgpr_read_b32 v61,a125
 v_mfma_f32_16x16x32_bf16 a[132:135],v[20:23],a[180:183],a[132:135]
 v_accvgpr_read_b32 v62,a126
 v_accvgpr_read_b32 v63,a127
 v_mfma_f32_16x16x32_bf16 a[132:135],v[16:19],a[164:167],a[132:135]
 ds_read_b64_tr_b16 v[36:37],v241 offset:12544
 ds_read_b64_tr_b16 v[38:39],v241 offset:18688
 v_mfma_f32_16x16x32_bf16 a[136:139],v[16:19],a[168:171],a[136:139]
 v_cvt_pk_bf16_f32 v136,v60,v61
 v_cvt_pk_bf16_f32 v137,v62,v63
 v_mfma_f32_16x16x32_bf16 a[136:139],v[20:23],a[184:187],a[136:139]
 s_add_u32 s1,s37,89600
 buffer_store_dwordx4 v[134:137],v4,s[80:83],s1 offen sc1
 s_add_u32 s77,s76,s79
 v_mfma_f32_16x16x32_bf16 a[140:143],v[20:23],a[188:191],a[140:143]
 buffer_load_dwordx4 v[204:207],v4,s[28:31],s77 offen sc1
 v_mfma_f32_16x16x32_bf16 a[140:143],v[16:19],a[172:175],a[140:143]
 s_add_u32 s76,s76,4096
 s_cmp_eq_u32 s76,49152
 s_cselect_b32 s76,0,s76
 s_waitcnt lgkmcnt(4)
 v_mfma_f32_16x16x32_bf16 a[144:147],v[24:27],a[192:195],a[144:147]
 s_add_u32 s77,s76,s72
 ds_read_b64_tr_b16 v[40:41],v233 offset:256
 ds_read_b64_tr_b16 v[42:43],v233 offset:6400
 v_mfma_f32_16x16x32_bf16 a[144:147],v[28:31],a[208:211],a[144:147]
 buffer_load_dwordx4 v[208:211],v4,s[28:31],s77 offen sc1
 v_mfma_f32_16x16x32_bf16 a[148:151],v[28:31],a[212:215],a[148:151]
 s_add_u32 s77,s76,s73
 buffer_load_dwordx4 v[212:215],v4,s[28:31],s77 offen sc1
 v_mfma_f32_16x16x32_bf16 a[148:151],v[24:27],a[196:199],a[148:151]
 ds_read_b64_tr_b16 v[44:45],v233 offset:12544
 ds_read_b64_tr_b16 v[46:47],v233 offset:18688
 v_mfma_f32_16x16x32_bf16 a[152:155],v[24:27],a[200:203],a[152:155]
 v_mfma_f32_16x16x32_bf16 a[152:155],v[28:31],a[216:219],a[152:155]
 v_accvgpr_read_b32 v48,a128
 v_accvgpr_read_b32 v49,a129
 v_mfma_f32_16x16x32_bf16 a[156:159],v[28:31],a[220:223],a[156:159]
 s_add_u32 s77,s76,s78
 v_accvgpr_read_b32 v50,a130
 v_accvgpr_read_b32 v51,a131
 v_mfma_f32_16x16x32_bf16 a[156:159],v[24:27],a[204:207],a[156:159]
 buffer_load_dwordx4 v[216:219],v4,s[28:31],s77 offen sc1
 s_waitcnt lgkmcnt(4)
 v_cvt_pk_bf16_f32 v108,v48,v49
 v_cvt_pk_bf16_f32 v109,v50,v51
 v_mfma_f32_16x16x32_bf16 a[144:147],v[32:35],a[224:227],a[144:147]
 s_waitcnt vmcnt(39)
 ds_read_b128 v[16:19],v9
 ds_read_b128 v[20:23],v6
 v_mfma_f32_16x16x32_bf16 a[144:147],v[36:39],a[240:243],a[144:147]
 v_accvgpr_read_b32 v52,a132
 v_accvgpr_read_b32 v53,a133
 v_mfma_f32_16x16x32_bf16 a[148:151],v[36:39],a[244:247],a[148:151]
 s_add_u32 s77,s76,s79
 v_accvgpr_read_b32 v54,a134
 v_accvgpr_read_b32 v55,a135
 v_mfma_f32_16x16x32_bf16 a[148:151],v[32:35],a[228:231],a[148:151]
 buffer_load_dwordx4 v[220:223],v4,s[28:31],s77 offen sc1
 v_cvt_pk_bf16_f32 v118,v52,v53
 v_cvt_pk_bf16_f32 v119,v54,v55
 v_mfma_f32_16x16x32_bf16 a[152:155],v[32:35],a[232:235],a[152:155]
 v_accvgpr_read_b32 v56,a136
 v_accvgpr_read_b32 v57,a137
 v_mfma_f32_16x16x32_bf16 a[152:155],v[36:39],a[248:251],a[152:155]
 v_accvgpr_read_b32 v58,a138
 v_accvgpr_read_b32 v59,a139
 v_mfma_f32_16x16x32_bf16 a[156:159],v[36:39],a[252:255],a[156:159]
 v_cvt_pk_bf16_f32 v128,v56,v57
 v_cvt_pk_bf16_f32 v129,v58,v59
 v_mfma_f32_16x16x32_bf16 a[156:159],v[32:35],a[236:239],a[156:159]
 s_waitcnt lgkmcnt(2)
 v_accvgpr_read_b32 v60,a140
 v_accvgpr_read_b32 v61,a141
 v_mfma_f32_16x16x32_bf16 a[144:147],v[40:43],a[160:163],a[144:147]
 ds_read_b128 v[24:27],v9 offset:1024
 ds_read_b128 v[28:31],v6 offset:1024
 v_mfma_f32_16x16x32_bf16 a[144:147],v[44:47],a[176:179],a[144:147]
 s_add_u32 s76,s76,4096
 v_accvgpr_read_b32 v62,a142
 v_accvgpr_read_b32 v63,a143
 v_mfma_f32_16x16x32_bf16 a[148:151],v[44:47],a[180:183],a[148:151]
 s_cmp_eq_u32 s76,49152
 s_cselect_b32 s76,0,s76
 s_add_u32 s77,s76,s72
 v_cvt_pk_bf16_f32 v138,v60,v61
 v_cvt_pk_bf16_f32 v139,v62,v63
 v_mfma_f32_16x16x32_bf16 a[148:151],v[40:43],a[164:167],a[148:151]
 buffer_load_dwordx4 v[144:147],v4,s[28:31],s77 offen sc1
 v_mfma_f32_16x16x32_bf16 a[152:155],v[40:43],a[168:171],a[152:155]
 s_add_u32 s77,s76,s73
 buffer_load_dwordx4 v[148:151],v4,s[28:31],s77 offen sc1
 v_mfma_f32_16x16x32_bf16 a[152:155],v[44:47],a[184:187],a[152:155]
 v_mfma_f32_16x16x32_bf16 a[156:159],v[44:47],a[188:191],a[156:159]
 v_mfma_f32_16x16x32_bf16 a[156:159],v[40:43],a[172:175],a[156:159]
 s_waitcnt vmcnt(18) lgkmcnt(2)
 v_mfma_f32_16x16x32_bf16 v[224:227],v[16:19],v[160:163],0
 s_add_u32 s77,s76,s78
 ds_read_b128 v[32:35],v9 offset:2048
 ds_read_b128 v[36:39],v6 offset:2048
 v_mfma_f32_16x16x32_bf16 v[224:227],v[20:23],v[176:179],v[224:227]
 buffer_load_dwordx4 v[152:155],v4,s[28:31],s77 offen sc1
 v_mfma_f32_16x16x32_bf16 a[0:3],v[20:23],v[180:183],0
 s_barrier
 v_mfma_f32_16x16x32_bf16 a[0:3],v[16:19],v[164:167],a[0:3]
 s_add_u32 s63,s63,20480
 s_cmp_eq_u32 s63,245760
 s_cselect_b32 s63,0,s63
 s_add_u32 m0,s55,24576
 s_nop 0
 buffer_load_dwordx4 v4,s[24:27],s63 offen sc1 lds
 v_mfma_f32_16x16x32_bf16 a[20:23],v[16:19],v[168:171],0
 buffer_load_dwordx4 v4,s[24:27],s63 offen offset:1024 sc1 lds
 v_mfma_f32_16x16x32_bf16 a[20:23],v[20:23],v[184:187],a[20:23]
 v_accvgpr_read_b32 v48,a144
 v_accvgpr_read_b32 v49,a145
 v_mfma_f32_16x16x32_bf16 a[40:43],v[20:23],v[188:191],0
 v_accvgpr_read_b32 v50,a146
 v_accvgpr_read_b32 v51,a147
 v_mfma_f32_16x16x32_bf16 a[40:43],v[16:19],v[172:175],a[40:43]
 s_waitcnt lgkmcnt(2)
 v_cvt_pk_bf16_f32 v110,v48,v49
 v_cvt_pk_bf16_f32 v111,v50,v51
 v_mfma_f32_16x16x32_bf16 v[228:231],v[24:27],v[160:163],0
 s_add_u32 s1,s37,81920
 buffer_store_dwordx4 v[108:111],v4,s[80:83],s1 offen offset:1024 sc1
 ds_read_b128 v[40:43],v9 offset:3072
 ds_read_b128 v[44:47],v6 offset:3072
 v_mfma_f32_16x16x32_bf16 v[228:231],v[28:31],v[176:179],v[228:231]
 v_accvgpr_read_b32 v52,a148
 v_accvgpr_read_b32 v53,a149
 v_mfma_f32_16x16x32_bf16 a[4:7],v[28:31],v[180:183],0
 v_accvgpr_read_b32 v54,a150
 v_accvgpr_read_b32 v55,a151
 v_mfma_f32_16x16x32_bf16 a[4:7],v[24:27],v[164:167],a[4:7]
 v_cvt_pk_bf16_f32 v120,v52,v53
 v_cvt_pk_bf16_f32 v121,v54,v55
 v_mfma_f32_16x16x32_bf16 a[24:27],v[24:27],v[168:171],0
 s_add_u32 s1,s37,84480
 buffer_store_dwordx4 v[118:121],v4,s[80:83],s1 offen offset:1024 sc1
 v_accvgpr_read_b32 v56,a152
 v_accvgpr_read_b32 v57,a153
 v_mfma_f32_16x16x32_bf16 a[24:27],v[28:31],v[184:187],a[24:27]
 v_accvgpr_read_b32 v58,a154
 v_accvgpr_read_b32 v59,a155
 v_mfma_f32_16x16x32_bf16 a[44:47],v[28:31],v[188:191],0
 v_cvt_pk_bf16_f32 v130,v56,v57
 v_cvt_pk_bf16_f32 v131,v58,v59
 v_mfma_f32_16x16x32_bf16 a[44:47],v[24:27],v[172:175],a[44:47]
 s_add_u32 s1,s37,87040
 buffer_store_dwordx4 v[128:131],v4,s[80:83],s1 offen offset:1024 sc1
 s_waitcnt lgkmcnt(2)
 v_accvgpr_read_b32 v60,a156
 v_accvgpr_read_b32 v61,a157
 v_mfma_f32_16x16x32_bf16 v[232:235],v[32:35],v[160:163],0
 ds_read_b128 v[16:19],v9 offset:4096
 ds_read_b128 v[20:23],v6 offset:4096
 v_mfma_f32_16x16x32_bf16 v[232:235],v[36:39],v[176:179],v[232:235]
 v_accvgpr_read_b32 v62,a158
 v_accvgpr_read_b32 v63,a159
 v_mfma_f32_16x16x32_bf16 a[8:11],v[36:39],v[180:183],0
 v_cvt_pk_bf16_f32 v140,v60,v61
 v_cvt_pk_bf16_f32 v141,v62,v63
 v_mfma_f32_16x16x32_bf16 a[8:11],v[32:35],v[164:167],a[8:11]
 s_add_u32 s1,s37,89600
 buffer_store_dwordx4 v[138:141],v4,s[80:83],s1 offen offset:1024 sc1
 s_cmp_eq_u32 s82,0
 s_cbranch_scc0 Lk40
 ds_write_b128 v10,v[104:107]
 ds_write_b128 v10,v[108:111] offset:1024
 ds_write_b64 v11,v[112:113] offset:2048
 ds_write_b128 v10,v[114:117] offset:2560
 ds_write_b128 v10,v[118:121] offset:3584
 ds_write_b64 v11,v[122:123] offset:4608
 ds_write_b128 v10,v[124:127] offset:5120
 ds_write_b128 v10,v[128:131] offset:6144
 ds_write_b64 v11,v[132:133] offset:7168
 ds_write_b128 v10,v[134:137] offset:7680
 ds_write_b128 v10,v[138:141] offset:8704
 ds_write_b64 v11,v[142:143] offset:9728
Lk40:
 buffer_load_dwordx4 v4,s[24:27],s63 offen offset:2048 sc1 lds
 v_mfma_f32_16x16x32_bf16 a[28:31],v[32:35],v[168:171],0
 v_add_u32 v15,0,v0
 v_mul_u32_u24 v7,5462,v15
 v_mfma_f32_16x16x32_bf16 a[28:31],v[36:39],v[184:187],a[28:31]
 buffer_load_dwordx4 v4,s[24:27],s63 offen offset:3072 sc1 lds
 v_lshrrev_b32 v7,16,v7
 v_mul_u32_u24 v1,1088,v7
 v_mfma_f32_16x16x32_bf16 a[48:51],v[36:39],v[188:191],0
 s_add_u32 m0,s55,28672
 s_add_u32 s44,s63,4096
 buffer_load_dwordx4 v4,s[24:27],s44 offen sc1 lds
 v_add_u32 v1,v1,v4
 v_mul_u32_u24 v7,12,v7
 v_mfma_f32_16x16x32_bf16 a[48:51],v[32:35],v[172:175],a[48:51]
 s_waitcnt lgkmcnt(2)
 v_sub_u32 v60,v15,v7
 v_add_u32 v15,64,v0
 v_mfma_f32_16x16x32_bf16 v[236:239],v[40:43],v[160:163],0
 s_add_u32 s63,s63,20480
 s_cmp_eq_u32 s63,245760
 s_cselect_b32 s63,0,s63
 s_add_u32 m0,s55,73728
 s_nop 0
 buffer_load_dwordx4 v4,s[24:27],s63 offen sc1 lds
 s_waitcnt vmcnt(1)
 ds_read_b128 v[24:27],v9 offset:24576
 ds_read_b128 v[28:31],v6 offset:24576
 v_mfma_f32_16x16x32_bf16 v[236:239],v[44:47],v[176:179],v[236:239]
 buffer_load_dwordx4 v4,s[24:27],s63 offen offset:1024 sc1 lds
 v_mul_u32_u24 v7,5462,v15
 v_lshrrev_b32 v7,16,v7
 v_mfma_f32_16x16x32_bf16 a[12:15],v[44:47],v[180:183],0
 buffer_load_dwordx4 v4,s[24:27],s63 offen offset:2048 sc1 lds
 v_mul_u32_u24 v2,1088,v7
 v_add_u32 v2,v2,v4
 v_mfma_f32_16x16x32_bf16 a[12:15],v[40:43],v[164:167],a[12:15]
 buffer_load_dwordx4 v4,s[24:27],s63 offen offset:3072 sc1 lds
 v_mul_u32_u24 v7,12,v7
 v_sub_u32 v61,v15,v7
 v_mfma_f32_16x16x32_bf16 a[32:35],v[40:43],v[168:171],0
 s_add_u32 m0,s55,77824
 s_add_u32 s44,s63,4096
 buffer_load_dwordx4 v4,s[24:27],s44 offen sc1 lds
 v_add_u32 v15,128,v0
 v_mul_u32_u24 v7,5462,v15
 v_mfma_f32_16x16x32_bf16 a[32:35],v[44:47],v[184:187],a[32:35]
 s_add_u32 s63,s63,20480
 s_cmp_eq_u32 s63,245760
 s_cselect_b32 s63,0,s63
 s_add_u32 m0,s55,49152
 s_nop 0
 buffer_load_dwordx4 v4,s[24:27],s63 offen sc1 lds
 v_lshrrev_b32 v7,16,v7
 v_mul_u32_u24 v3,1088,v7
 v_mfma_f32_16x16x32_bf16 a[52:55],v[44:47],v[188:191],0
 buffer_load_dwordx4 v4,s[24:27],s63 offen offset:1024 sc1 lds
 v_add_u32 v3,v3,v4
 v_mul_u32_u24 v7,12,v7
 v_mfma_f32_16x16x32_bf16 a[52:55],v[40:43],v[172:175],a[52:55]
 s_waitcnt lgkmcnt(2)
 v_sub_u32 v62,v15,v7
 v_bfe_u32 v15,v0,2,2
 v_mfma_f32_16x16x32_bf16 v[240:243],v[16:19],v[160:163],0
 buffer_load_dwordx4 v4,s[24:27],s63 offen offset:2048 sc1 lds
 ds_read_b128 v[32:35],v9 offset:25600
 ds_read_b128 v[36:39],v6 offset:25600
 v_mfma_f32_16x16x32_bf16 v[240:243],v[20:23],v[176:179],v[240:243]
 v_lshrrev_b32 v7,4,v0
 v_cmp_eq_u32 vcc,v15,v7
 v_mfma_f32_16x16x32_bf16 a[16:19],v[20:23],v[180:183],0
 buffer_load_dwordx4 v4,s[24:27],s63 offen offset:3072 sc1 lds
 v_and_b32 v15,1,v0
 v_lshlrev_b32 v15,4,v15
 v_mfma_f32_16x16x32_bf16 a[16:19],v[16:19],v[164:167],a[16:19]
 s_add_u32 m0,s55,53248
 s_add_u32 s44,s63,4096
 buffer_load_dwordx4 v4,s[24:27],s44 offen sc1 lds
 v_mov_b32 v7,0x3f80
 v_lshlrev_b32 v7,v15,v7
 v_mfma_f32_16x16x32_bf16 a[36:39],v[16:19],v[168:171],0
 s_add_u32 s63,s63,20480
 s_cmp_eq_u32 s63,245760
 s_cselect_b32 s63,0,s63
 s_add_u32 m0,s55,98304
 s_nop 0
 buffer_load_dwordx4 v4,s[24:27],s63 offen sc1 lds
 v_cndmask_b32 v7,0,v7,vcc
 v_and_b32 v15,2,v0
 v_mfma_f32_16x16x32_bf16 a[36:39],v[20:23],v[184:187],a[36:39]
 buffer_load_dwordx4 v4,s[24:27],s63 offen offset:1024 sc1 lds
 v_cmp_eq_u32 vcc,0,v15
 v_mov_b32 v48,0
 v_mfma_f32_16x16x32_bf16 a[56:59],v[20:23],v[188:191],0
 buffer_load_dwordx4 v4,s[24:27],s63 offen offset:2048 sc1 lds
 v_mov_b32 v49,0
 v_cndmask_b32 v50,0,v7,vcc
 v_mfma_f32_16x16x32_bf16 a[56:59],v[16:19],v[172:175],a[56:59]
 s_waitcnt vmcnt(25) lgkmcnt(2)
 v_cndmask_b32 v51,v7,0,vcc
 v_mov_b32 v52,0
 v_mfma_f32_16x16x32_bf16 v[224:227],v[24:27],v[192:195],v[224:227]
 buffer_load_dwordx4 v4,s[24:27],s63 offen offset:3072 sc1 lds
 ds_read_b128 v[40:43],v9 offset:26624
 ds_read_b128 v[44:47],v6 offset:26624
 v_mfma_f32_16x16x32_bf16 v[224:227],v[28:31],v[208:211],v[224:227]
 s_add_u32 m0,s55,102400
 s_add_u32 s44,s63,4096
 buffer_load_dwordx4 v4,s[24:27],s44 offen sc1 lds
 v_mov_b32 v53,0
 v_mov_b32 v54,v50
 v_mfma_f32_16x16x32_bf16 a[0:3],v[28:31],v[212:215],a[0:3]
 s_add_u32 s77,s76,s79
 buffer_load_dwordx4 v[156:159],v4,s[28:31],s77 offen sc1
 v_mov_b32 v55,v51
 v_mov_b32 v56,v50
 v_mfma_f32_16x16x32_bf16 a[0:3],v[24:27],v[196:199],a[0:3]
 s_add_u32 s63,s63,20480
 s_cmp_eq_u32 s63,245760
 s_cselect_b32 s63,0,s63
 s_add_u32 m0,s55,0
 s_nop 0
 buffer_load_dwordx4 v4,s[24:27],s63 offen sc1 lds
 v_mov_b32 v57,v51
 v_and_b32 v15,15,v0
 v_mfma_f32_16x16x32_bf16 a[20:23],v[24:27],v[200:203],a[20:23]
 s_add_u32 s76,s76,4096
 s_cmp_eq_u32 s76,49152
 s_cselect_b32 s76,0,s76
 s_add_u32 s77,s76,s72
 v_mul_u32_u24 v59,192,v15
 v_lshrrev_b32 v15,4,v0
 v_mfma_f32_16x16x32_bf16 a[20:23],v[28:31],v[216:219],a[20:23]
 buffer_load_dwordx4 a[60:63],v4,s[28:31],s77 offen sc1
 v_lshl_add_u32 v59,v15,3,v59
 v_mfma_f32_16x16x32_bf16 a[40:43],v[28:31],v[220:223],a[40:43]
 s_lshl_b32 s41,s58,6
 s_add_u32 s41,s41,s49
 v_add_u32 v58,s41,v59
 v_mfma_f32_16x16x32_bf16 a[40:43],v[24:27],v[204:207],a[40:43]
 buffer_load_dwordx4 v4,s[24:27],s63 offen offset:1024 sc1 lds
 s_waitcnt lgkmcnt(2)
 s_mul_i32 s41,s58,96
 s_sub_u32 s41,128,s41
 v_mfma_f32_16x16x32_bf16 v[228:231],v[32:35],v[192:195],v[228:231]
 s_add_u32 s77,s76,s73
 buffer_load_dwordx4 a[64:67],v4,s[28:31],s77 offen sc1
 ds_read_b128 v[16:19],v9 offset:27648
 ds_read_b128 v[20:23],v6 offset:27648
 v_mfma_f32_16x16x32_bf16 v[228:231],v[36:39],v[208:211],v[228:231]
 s_add_u32 s41,s41,s49
 v_add_u32 v59,s41,v59
 v_add_u32 v63,s49,v4
 v_mfma_f32_16x16x32_bf16 a[4:7],v[36:39],v[212:215],a[4:7]
 buffer_load_dwordx4 v4,s[24:27],s63 offen offset:2048 sc1 lds
 s_waitcnt vmcnt(24)
 s_barrier
 v_add_u32 v10,s70,v10
 v_mfma_f32_16x16x32_bf16 a[4:7],v[32:35],v[196:199],a[4:7]
 s_add_u32 s77,s76,s78
 buffer_load_dwordx4 a[68:71],v4,s[28:31],s77 offen sc1
 v_add_u32 v11,s70,v11
 v_mfma_f32_16x16x32_bf16 a[24:27],v[32:35],v[200:203],a[24:27]
 s_cmp_lg_u32 s32,0
 s_cbranch_scc1 Lf41
 v_mov_b32 v14,s51
 s_mov_b64 exec,1
 s_add_u32 s91,s90,5120
 buffer_store_dword v14,off,s[92:95],s91 sc1
 s_mov_b64 exec,-1
Lf41:
 buffer_load_dwordx4 v4,s[24:27],s63 offen offset:3072 sc1 lds
 v_mfma_f32_16x16x32_bf16 a[24:27],v[36:39],v[216:219],a[24:27]
 s_sub_u32 s41,s32,1
 s_and_b32 s41,s41,3
 s_mul_i32 s41,s41,5120
 v_mfma_f32_16x16x32_bf16 a[44:47],v[36:39],v[220:223],a[44:47]
 s_add_u32 s77,s76,s79
 s_add_u32 s41,s41,98304
 v_add_u32 v124,s41,v4
 v_mfma_f32_16x16x32_bf16 a[44:47],v[32:35],v[204:207],a[44:47]
 buffer_load_dwordx4 a[72:75],v4,s[28:31],s77 offen sc1
 s_waitcnt lgkmcnt(2)
 v_mfma_f32_16x16x32_bf16 v[232:235],v[40:43],v[192:195],v[232:235]
 s_add_u32 m0,s55,4096
 s_add_u32 s44,s63,4096
 buffer_load_dwordx4 v4,s[24:27],s44 offen sc1 lds
 ds_read_b128 v[24:27],v9 offset:28672
 ds_read_b128 v[28:31],v6 offset:28672
 v_mfma_f32_16x16x32_bf16 v[232:235],v[44:47],v[208:211],v[232:235]
 s_sub_u32 s41,s32,2
 s_and_b32 s41,s41,3
 s_mul_i32 s41,s41,5120
 v_mfma_f32_16x16x32_bf16 a[8:11],v[44:47],v[212:215],a[8:11]
 s_add_u32 s76,s76,4096
 s_cmp_eq_u32 s76,49152
 s_cselect_b32 s76,0,s76
 s_add_u32 s77,s76,s72
 buffer_load_dwordx4 a[76:79],v4,s[28:31],s77 offen sc1
 s_add_u32 s41,s41,0
 v_add_u32 v125,s41,v4
 v_mfma_f32_16x16x32_bf16 a[8:11],v[40:43],v[196:199],a[8:11]
 s_add_u32 s77,s76,s73
 buffer_load_dwordx4 a[80:83],v4,s[28:31],s77 offen sc1
 s_sub_u32 s41,s32,3
 s_and_b32 s41,s41,3
 s_mul_i32 s41,s41,5120
 v_mfma_f32_16x16x32_bf16 a[28:31],v[40:43],v[200:203],a[28:31]
 s_add_u32 s41,s41,122880
 v_add_u32 v126,s41,v4
 ds_read_b128 a[160:163],v10
 v_mfma_f32_16x16x32_bf16 a[28:31],v[44:47],v[216:219],a[28:31]
 s_add_u32 s77,s76,s78
 ds_read_b128 a[164:167],v10 offset:1024
 ds_read_b64 a[224:225],v11 offset:2048
 v_mfma_f32_16x16x32_bf16 a[48:51],v[44:47],v[220:223],a[48:51]
 buffer_load_dwordx4 a[84:87],v4,s[28:31],s77 offen sc1
 v_mfma_f32_16x16x32_bf16 a[48:51],v[40:43],v[204:207],a[48:51]
 s_add_u32 s77,s76,s79
 s_waitcnt lgkmcnt(5)
 v_mfma_f32_16x16x32_bf16 v[236:239],v[16:19],v[192:195],v[236:239]
 s_waitcnt vmcnt(18)
 ds_read_b128 v[32:35],v8 offset:24576
 ds_read_b128 v[36:39],v8
 v_mfma_f32_16x16x32_bf16 v[236:239],v[20:23],v[208:211],v[236:239]
 buffer_load_dwordx4 a[88:91],v4,s[28:31],s77 offen sc1
 v_mfma_f32_16x16x32_bf16 a[12:15],v[20:23],v[212:215],a[12:15]
 s_add_u32 s76,s76,4096
 s_cmp_eq_u32 s76,49152
 s_cselect_b32 s76,0,s76
 s_add_u32 s77,s76,s72
 buffer_load_dwordx4 a[92:95],v4,s[28:31],s77 offen sc1
 v_mfma_f32_16x16x32_bf16 a[12:15],v[16:19],v[196:199],a[12:15]
 s_add_u32 s77,s76,s73
 buffer_load_dwordx4 a[96:99],v4,s[28:31],s77 offen sc1
 v_mfma_f32_16x16x32_bf16 a[32:35],v[16:19],v[200:203],a[32:35]
 s_add_u32 s77,s76,s78
 buffer_load_dwordx4 a[100:103],v4,s[28:31],s77 offen sc1
 v_mfma_f32_16x16x32_bf16 a[32:35],v[20:23],v[216:219],a[32:35]
 s_add_u32 s77,s76,s79
 buffer_load_dwordx4 a[104:107],v4,s[28:31],s77 offen sc1
 v_mfma_f32_16x16x32_bf16 a[52:55],v[20:23],v[220:223],a[52:55]
 v_mfma_f32_16x16x32_bf16 a[52:55],v[16:19],v[204:207],a[52:55]
 s_waitcnt lgkmcnt(5)
 v_mfma_f32_16x16x32_bf16 v[240:243],v[24:27],v[192:195],v[240:243]
 ds_read_b128 v[40:43],v8 offset:25600
 ds_read_b128 v[44:47],v8 offset:1024
 v_mfma_f32_16x16x32_bf16 v[240:243],v[28:31],v[208:211],v[240:243]
 v_mfma_f32_16x16x32_bf16 a[16:19],v[28:31],v[212:215],a[16:19]
 s_add_u32 s63,s63,20480
 s_cmp_eq_u32 s63,245760
 s_cselect_b32 s63,0,s63
 s_add_u32 m0,s55,122880
 s_nop 0
 buffer_load_dwordx4 v4,s[24:27],s63 offen sc1 lds
 v_mfma_f32_16x16x32_bf16 a[16:19],v[24:27],v[196:199],a[16:19]
 buffer_load_dwordx4 v4,s[24:27],s63 offen offset:1024 sc1 lds
 v_mfma_f32_16x16x32_bf16 a[36:39],v[24:27],v[200:203],a[36:39]
 buffer_load_dwordx4 v4,s[24:27],s63 offen offset:2048 sc1 lds
 v_mfma_f32_16x16x32_bf16 a[36:39],v[28:31],v[216:219],a[36:39]
 buffer_load_dwordx4 v4,s[24:27],s63 offen offset:3072 sc1 lds
 v_mfma_f32_16x16x32_bf16 a[56:59],v[28:31],v[220:223],a[56:59]
 s_add_u32 m0,s55,126976
 s_add_u32 s44,s63,4096
 buffer_load_dwordx4 v4,s[24:27],s44 offen sc1 lds
 v_mfma_f32_16x16x32_bf16 a[56:59],v[24:27],v[204:207],a[56:59]
 s_add_u32 s63,s63,20480
 s_cmp_eq_u32 s63,245760
 s_cselect_b32 s63,0,s63
 s_waitcnt vmcnt(14) lgkmcnt(2)
 v_mfma_f32_16x16x32_bf16 v[224:227],v[32:35],v[144:147],v[224:227]
 ds_read_b128 v[16:19],v8 offset:26624
 ds_read_b128 v[20:23],v8 offset:2048
 v_mfma_f32_16x16x32_bf16 v[224:227],v[36:39],a[60:63],v[224:227]
 s_add_u32 m0,s55,24576
 s_nop 0
 buffer_load_dwordx4 v4,s[24:27],s63 offen sc1 lds
 v_mfma_f32_16x16x32_bf16 a[0:3],v[36:39],a[64:67],a[0:3]
 buffer_load_dwordx4 v4,s[24:27],s63 offen offset:1024 sc1 lds
 s_add_u32 s76,s76,4096
 v_mfma_f32_16x16x32_bf16 a[0:3],v[32:35],v[148:151],a[0:3]
 buffer_load_dwordx4 v4,s[24:27],s63 offen offset:2048 sc1 lds
 s_cmp_eq_u32 s76,49152
 s_cselect_b32 s76,0,s76
 v_mfma_f32_16x16x32_bf16 a[20:23],v[32:35],v[152:155],a[20:23]
 buffer_load_dwordx4 v4,s[24:27],s63 offen offset:3072 sc1 lds
 s_add_u32 s77,s76,s72
 v_mfma_f32_16x16x32_bf16 a[20:23],v[36:39],a[68:71],a[20:23]
 s_add_u32 m0,s55,28672
 s_add_u32 s44,s63,4096
 buffer_load_dwordx4 v4,s[24:27],s44 offen sc1 lds
 v_mfma_f32_16x16x32_bf16 a[40:43],v[36:39],a[72:75],a[40:43]
 buffer_load_dwordx4 a[108:111],v4,s[28:31],s77 offen sc1
 v_mfma_f32_16x16x32_bf16 a[40:43],v[32:35],v[156:159],a[40:43]
 s_waitcnt lgkmcnt(2)
 v_mfma_f32_16x16x32_bf16 v[228:231],v[40:43],v[144:147],v[228:231]
 s_add_u32 s77,s76,s73
 ds_read_b128 v[24:27],v8 offset:27648
 ds_read_b128 v[28:31],v8 offset:3072
 v_mfma_f32_16x16x32_bf16 v[228:231],v[44:47],a[60:63],v[228:231]
 buffer_load_dwordx4 a[112:115],v4,s[28:31],s77 offen sc1
 v_mfma_f32_16x16x32_bf16 a[4:7],v[44:47],a[64:67],a[4:7]
 s_add_u32 s77,s76,s78
 buffer_load_dwordx4 a[116:119],v4,s[28:31],s77 offen sc1
 v_mfma_f32_16x16x32_bf16 a[4:7],v[40:43],v[148:151],a[4:7]
 s_add_u32 s77,s76,s79
 buffer_load_dwordx4 a[120:123],v4,s[28:31],s77 offen sc1
 v_mfma_f32_16x16x32_bf16 a[24:27],v[40:43],v[152:155],a[24:27]
 s_add_u32 s76,s76,4096
 s_cmp_eq_u32 s76,49152
 s_cselect_b32 s76,0,s76
 s_add_u32 s77,s76,s72
 buffer_load_dwordx4 a[124:127],v4,s[28:31],s77 offen sc1
 v_mfma_f32_16x16x32_bf16 a[24:27],v[44:47],a[68:71],a[24:27]
 s_add_u32 s77,s76,s73
 buffer_load_dwordx4 a[128:131],v4,s[28:31],s77 offen sc1
 v_mfma_f32_16x16x32_bf16 a[44:47],v[44:47],a[72:75],a[44:47]
 v_mfma_f32_16x16x32_bf16 a[44:47],v[40:43],v[156:159],a[44:47]
 s_waitcnt lgkmcnt(2)
 v_mfma_f32_16x16x32_bf16 v[232:235],v[16:19],v[144:147],v[232:235]
 ds_read_b128 v[32:35],v8 offset:28672
 ds_read_b128 v[36:39],v8 offset:4096
 v_mfma_f32_16x16x32_bf16 v[232:235],v[20:23],a[60:63],v[232:235]
 s_add_u32 s77,s76,s78
 v_mfma_f32_16x16x32_bf16 a[8:11],v[20:23],a[64:67],a[8:11]
 buffer_load_dwordx4 a[132:135],v4,s[28:31],s77 offen sc1
 v_mfma_f32_16x16x32_bf16 a[8:11],v[16:19],v[148:151],a[8:11]
 v_mfma_f32_16x16x32_bf16 a[28:31],v[16:19],v[152:155],a[28:31]
 v_mfma_f32_16x16x32_bf16 a[28:31],v[20:23],a[68:71],a[28:31]
 s_add_u32 s77,s76,s79
 v_mfma_f32_16x16x32_bf16 a[48:51],v[20:23],a[72:75],a[48:51]
 buffer_load_dwordx4 a[136:139],v4,s[28:31],s77 offen sc1
 v_mfma_f32_16x16x32_bf16 a[48:51],v[16:19],v[156:159],a[48:51]
 s_add_u32 s76,s76,4096
 s_waitcnt lgkmcnt(2)
 v_mfma_f32_16x16x32_bf16 v[236:239],v[24:27],v[144:147],v[236:239]
 s_waitcnt vmcnt(26)
 ds_read_b128 v[40:43],v9
 ds_read_b128 v[44:47],v6
 v_mfma_f32_16x16x32_bf16 v[236:239],v[28:31],a[60:63],v[236:239]
 s_cmp_eq_u32 s76,49152
 s_cselect_b32 s76,0,s76
 v_mfma_f32_16x16x32_bf16 a[12:15],v[28:31],a[64:67],a[12:15]
 s_add_u32 s77,s76,s72
 v_mfma_f32_16x16x32_bf16 a[12:15],v[24:27],v[148:151],a[12:15]
 buffer_load_dwordx4 a[140:143],v4,s[28:31],s77 offen sc1
 v_mfma_f32_16x16x32_bf16 a[32:35],v[24:27],v[152:155],a[32:35]
 v_mfma_f32_16x16x32_bf16 a[32:35],v[28:31],a[68:71],a[32:35]
 v_mfma_f32_16x16x32_bf16 a[52:55],v[28:31],a[72:75],a[52:55]
 v_mfma_f32_16x16x32_bf16 a[52:55],v[24:27],v[156:159],a[52:55]
 s_waitcnt lgkmcnt(2)
 v_mfma_f32_16x16x32_bf16 v[240:243],v[32:35],v[144:147],v[240:243]
 s_add_u32 s77,s76,s73
 ds_read_b128 v[16:19],v9 offset:1024
 ds_read_b128 v[20:23],v6 offset:1024
 v_mfma_f32_16x16x32_bf16 v[240:243],v[36:39],a[60:63],v[240:243]
 buffer_load_dwordx4 a[144:147],v4,s[28:31],s77 offen sc1
 v_mfma_f32_16x16x32_bf16 a[16:19],v[36:39],a[64:67],a[16:19]
 s_add_u32 s63,s63,20480
 s_cmp_eq_u32 s63,245760
 s_cselect_b32 s63,0,s63
 s_add_u32 m0,s55,73728
 s_nop 0
 buffer_load_dwordx4 v4,s[24:27],s63 offen sc1 lds
 v_mfma_f32_16x16x32_bf16 a[16:19],v[32:35],v[148:151],a[16:19]
 buffer_load_dwordx4 v4,s[24:27],s63 offen offset:1024 sc1 lds
 v_mfma_f32_16x16x32_bf16 a[36:39],v[32:35],v[152:155],a[36:39]
 buffer_load_dwordx4 v4,s[24:27],s63 offen offset:2048 sc1 lds
 v_mfma_f32_16x16x32_bf16 a[36:39],v[36:39],a[68:71],a[36:39]
 buffer_load_dwordx4 v4,s[24:27],s63 offen offset:3072 sc1 lds
 v_mfma_f32_16x16x32_bf16 a[56:59],v[36:39],a[72:75],a[56:59]
 s_add_u32 m0,s55,77824
 s_add_u32 s44,s63,4096
 buffer_load_dwordx4 v4,s[24:27],s44 offen sc1 lds
 v_mfma_f32_16x16x32_bf16 a[56:59],v[32:35],v[156:159],a[56:59]
 s_add_u32 s63,s63,20480
 s_cmp_eq_u32 s63,245760
 s_cselect_b32 s63,0,s63
 s_waitcnt vmcnt(25) lgkmcnt(2)
 v_mfma_f32_16x16x32_bf16 v[224:227],v[40:43],a[76:79],v[224:227]
 ds_read_b128 v[24:27],v9 offset:2048
 ds_read_b128 v[28:31],v6 offset:2048
 v_mfma_f32_16x16x32_bf16 v[224:227],v[44:47],a[92:95],v[224:227]
 s_add_u32 m0,s55,49152
 s_nop 0
 buffer_load_dwordx4 v4,s[24:27],s63 offen sc1 lds
 v_mfma_f32_16x16x32_bf16 a[0:3],v[44:47],a[96:99],a[0:3]
 buffer_load_dwordx4 v4,s[24:27],s63 offen offset:1024 sc1 lds
 v_mfma_f32_16x16x32_bf16 a[0:3],v[40:43],a[80:83],a[0:3]
 buffer_load_dwordx4 v4,s[24:27],s63 offen offset:2048 sc1 lds
 v_mfma_f32_16x16x32_bf16 a[20:23],v[40:43],a[84:87],a[20:23]
 buffer_load_dwordx4 v4,s[24:27],s63 offen offset:3072 sc1 lds
 s_add_u32 s77,s76,s78
 v_mfma_f32_16x16x32_bf16 a[20:23],v[44:47],a[100:103],a[20:23]
 s_add_u32 m0,s55,53248
 s_add_u32 s44,s63,4096
 buffer_load_dwordx4 v4,s[24:27],s44 offen sc1 lds
 v_mfma_f32_16x16x32_bf16 a[40:43],v[44:47],a[104:107],a[40:43]
 buffer_load_dwordx4 a[148:151],v4,s[28:31],s77 offen sc1
 v_mfma_f32_16x16x32_bf16 a[40:43],v[40:43],a[88:91],a[40:43]
 s_waitcnt lgkmcnt(2)
 v_mfma_f32_16x16x32_bf16 v[228:231],v[16:19],a[76:79],v[228:231]
 s_add_u32 s77,s76,s79
 ds_read_b128 v[32:35],v9 offset:3072
 ds_read_b128 v[36:39],v6 offset:3072
 v_mfma_f32_16x16x32_bf16 v[228:231],v[20:23],a[92:95],v[228:231]
 s_add_u32 m0,s49,0
 s_mov_b32 s44,0
 buffer_load_dwordx4 v1,s[20:23],s44 offen lds
 v_mfma_f32_16x16x32_bf16 a[4:7],v[20:23],a[96:99],a[4:7]
 buffer_load_dwordx4 a[152:155],v4,s[28:31],s77 offen sc1
 v_mfma_f32_16x16x32_bf16 a[4:7],v[16:19],a[80:83],a[4:7]
 s_add_u32 s76,s76,4096
 s_cmp_eq_u32 s76,49152
 s_cselect_b32 s76,0,s76
 s_add_u32 s77,s76,s72
 buffer_load_dwordx4 a[156:159],v4,s[28:31],s77 offen sc1
 v_mfma_f32_16x16x32_bf16 a[24:27],v[16:19],a[84:87],a[24:27]
 buffer_load_dwordx4 v2,s[20:23],s44 offen offset:1024 lds
 s_add_u32 s77,s76,s73
 v_mfma_f32_16x16x32_bf16 a[24:27],v[20:23],a[100:103],a[24:27]
 buffer_load_dwordx4 a[244:247],v4,s[28:31],s77 offen sc1
 v_mfma_f32_16x16x32_bf16 a[44:47],v[20:23],a[104:107],a[44:47]
 v_mfma_f32_16x16x32_bf16 a[44:47],v[16:19],a[88:91],a[44:47]
 s_waitcnt lgkmcnt(2)
 v_mfma_f32_16x16x32_bf16 v[232:235],v[24:27],a[76:79],v[232:235]
 ds_read_b128 v[40:43],v9 offset:4096
 ds_read_b128 v[44:47],v6 offset:4096
 v_mfma_f32_16x16x32_bf16 v[232:235],v[28:31],a[92:95],v[232:235]
 s_add_u32 s77,s76,s78
 v_mfma_f32_16x16x32_bf16 a[8:11],v[28:31],a[96:99],a[8:11]
 buffer_load_dwordx4 a[248:251],v4,s[28:31],s77 offen sc1
 v_mfma_f32_16x16x32_bf16 a[8:11],v[24:27],a[80:83],a[8:11]
 buffer_load_dwordx4 v3,s[20:23],s44 offen offset:2048 lds
 v_mfma_f32_16x16x32_bf16 a[28:31],v[24:27],a[84:87],a[28:31]
 v_mfma_f32_16x16x32_bf16 a[28:31],v[28:31],a[100:103],a[28:31]
 s_add_u32 s77,s76,s79
 v_mfma_f32_16x16x32_bf16 a[48:51],v[28:31],a[104:107],a[48:51]
 buffer_load_dwordx4 a[252:255],v4,s[28:31],s77 offen sc1
 v_mfma_f32_16x16x32_bf16 a[48:51],v[24:27],a[88:91],a[48:51]
 s_waitcnt lgkmcnt(2)
 v_mfma_f32_16x16x32_bf16 v[236:239],v[32:35],a[76:79],v[236:239]
 s_waitcnt vmcnt(29)
 ds_read_b128 v[16:19],v9 offset:24576
 ds_read_b128 v[20:23],v6 offset:24576
 v_mfma_f32_16x16x32_bf16 v[236:239],v[36:39],a[92:95],v[236:239]
 v_mfma_f32_16x16x32_bf16 a[12:15],v[36:39],a[96:99],a[12:15]
 v_mfma_f32_16x16x32_bf16 a[12:15],v[32:35],a[80:83],a[12:15]
 buffer_load_dwordx4 v[244:247],v4,s[28:31],s56 offen sc1
 v_mfma_f32_16x16x32_bf16 a[32:35],v[32:35],a[84:87],a[32:35]
 v_mfma_f32_16x16x32_bf16 a[32:35],v[36:39],a[100:103],a[32:35]
 v_mfma_f32_16x16x32_bf16 a[52:55],v[36:39],a[104:107],a[52:55]
 v_mfma_f32_16x16x32_bf16 a[52:55],v[32:35],a[88:91],a[52:55]
 s_waitcnt lgkmcnt(2)
 v_mfma_f32_16x16x32_bf16 v[240:243],v[40:43],a[76:79],v[240:243]
 ds_read_b128 v[24:27],v9 offset:25600
 ds_read_b128 v[28:31],v6 offset:25600
 v_mfma_f32_16x16x32_bf16 v[240:243],v[44:47],a[92:95],v[240:243]
 v_mfma_f32_16x16x32_bf16 a[16:19],v[44:47],a[96:99],a[16:19]
 buffer_load_dwordx4 v[248:251],v4,s[28:31],s56 offen offset:1024 sc1
 v_mfma_f32_16x16x32_bf16 a[16:19],v[40:43],a[80:83],a[16:19]
 v_mfma_f32_16x16x32_bf16 a[36:39],v[40:43],a[84:87],a[36:39]
 v_mfma_f32_16x16x32_bf16 a[36:39],v[44:47],a[100:103],a[36:39]
 v_mfma_f32_16x16x32_bf16 a[56:59],v[44:47],a[104:107],a[56:59]
 v_mfma_f32_16x16x32_bf16 a[56:59],v[40:43],a[88:91],a[56:59]
 s_waitcnt vmcnt(23) lgkmcnt(2)
 v_mfma_f32_16x16x32_bf16 v[224:227],v[16:19],a[108:111],v[224:227]
 ds_read_b128 v[32:35],v9 offset:26624
 ds_read_b128 v[36:39],v6 offset:26624
 v_mfma_f32_16x16x32_bf16 v[224:227],v[20:23],a[124:127],v[224:227]
 v_mfma_f32_16x16x32_bf16 a[0:3],v[20:23],a[128:131],a[0:3]
 v_mfma_f32_16x16x32_bf16 a[0:3],v[16:19],a[112:115],a[0:3]
 v_mfma_f32_16x16x32_bf16 a[20:23],v[16:19],a[116:119],a[20:23]
 v_mfma_f32_16x16x32_bf16 a[20:23],v[20:23],a[132:135],a[20:23]
 v_mfma_f32_16x16x32_bf16 a[40:43],v[20:23],a[136:139],a[40:43]
 v_mfma_f32_16x16x32_bf16 a[40:43],v[16:19],a[120:123],a[40:43]
 s_waitcnt lgkmcnt(2)
 v_mfma_f32_16x16x32_bf16 v[228:231],v[24:27],a[108:111],v[228:231]
 ds_read_b128 v[40:43],v9 offset:27648
 ds_read_b128 v[44:47],v6 offset:27648
 v_mfma_f32_16x16x32_bf16 v[228:231],v[28:31],a[124:127],v[228:231]
 v_mfma_f32_16x16x32_bf16 a[4:7],v[28:31],a[128:131],a[4:7]
 buffer_load_dwordx2 v[252:253],v5,s[28:31],s57 offen sc1
 v_mfma_f32_16x16x32_bf16 a[4:7],v[24:27],a[112:115],a[4:7]
 v_mfma_f32_16x16x32_bf16 a[24:27],v[24:27],a[116:119],a[24:27]
 v_mfma_f32_16x16x32_bf16 a[24:27],v[28:31],a[132:135],a[24:27]
 v_mfma_f32_16x16x32_bf16 a[44:47],v[28:31],a[136:139],a[44:47]
 v_mfma_f32_16x16x32_bf16 a[44:47],v[24:27],a[120:123],a[44:47]
 s_waitcnt lgkmcnt(2)
 v_mfma_f32_16x16x32_bf16 v[232:235],v[32:35],a[108:111],v[232:235]
 ds_read_b128 v[16:19],v9 offset:28672
 ds_read_b128 v[20:23],v6 offset:28672
 v_mfma_f32_16x16x32_bf16 v[232:235],v[36:39],a[124:127],v[232:235]
 v_mfma_f32_16x16x32_bf16 a[8:11],v[36:39],a[128:131],a[8:11]
 v_mfma_f32_16x16x32_bf16 a[8:11],v[32:35],a[112:115],a[8:11]
 v_mfma_f32_16x16x32_bf16 a[28:31],v[32:35],a[116:119],a[28:31]
 v_mfma_f32_16x16x32_bf16 a[28:31],v[36:39],a[132:135],a[28:31]
 v_mfma_f32_16x16x32_bf16 a[48:51],v[36:39],a[136:139],a[48:51]
 v_mfma_f32_16x16x32_bf16 a[48:51],v[32:35],a[120:123],a[48:51]
 s_waitcnt lgkmcnt(2)
 v_mfma_f32_16x16x32_bf16 v[236:239],v[40:43],a[108:111],v[236:239]
 s_waitcnt vmcnt(12)
 ds_read_b128 v[24:27],v8 offset:24576
 ds_read_b128 v[28:31],v8
 v_mfma_f32_16x16x32_bf16 v[236:239],v[44:47],a[124:127],v[236:239]
 v_mfma_f32_16x16x32_bf16 a[12:15],v[44:47],a[128:131],a[12:15]
 v_mfma_f32_16x16x32_bf16 a[12:15],v[40:43],a[112:115],a[12:15]
 v_mfma_f32_16x16x32_bf16 a[32:35],v[40:43],a[116:119],a[32:35]
 v_mfma_f32_16x16x32_bf16 a[32:35],v[44:47],a[132:135],a[32:35]
 v_mfma_f32_16x16x32_bf16 a[52:55],v[44:47],a[136:139],a[52:55]
 v_mfma_f32_16x16x32_bf16 a[52:55],v[40:43],a[120:123],a[52:55]
 s_waitcnt lgkmcnt(2)
 v_mfma_f32_16x16x32_bf16 v[240:243],v[16:19],a[108:111],v[240:243]
 ds_read_b128 v[32:35],v8 offset:25600
 ds_read_b128 v[36:39],v8 offset:1024
 v_mfma_f32_16x16x32_bf16 v[240:243],v[20:23],a[124:127],v[240:243]
 v_mfma_f32_16x16x32_bf16 a[16:19],v[20:23],a[128:131],a[16:19]
 v_mfma_f32_16x16x32_bf16 a[16:19],v[16:19],a[112:115],a[16:19]
 v_mfma_f32_16x16x32_bf16 a[36:39],v[16:19],a[116:119],a[36:39]
 v_mfma_f32_16x16x32_bf16 a[36:39],v[20:23],a[132:135],a[36:39]
 v_mfma_f32_16x16x32_bf16 a[56:59],v[20:23],a[136:139],a[56:59]
 v_mfma_f32_16x16x32_bf16 a[56:59],v[16:19],a[120:123],a[56:59]
 s_waitcnt vmcnt(3) lgkmcnt(2)
 v_mfma_f32_16x16x32_bf16 v[224:227],v[24:27],a[140:143],v[224:227]
 ds_read_b128 v[40:43],v8 offset:26624
 ds_read_b128 v[44:47],v8 offset:2048
 v_mfma_f32_16x16x32_bf16 v[224:227],v[28:31],a[156:159],v[224:227]
 s_waitcnt vmcnt(4)
 ds_read_b64 v[180:181],v58
 ds_read_b64 v[182:183],v58 offset:32
 v_mfma_f32_16x16x32_bf16 a[0:3],v[28:31],a[244:247],a[0:3]
 ds_read_b64 v[184:185],v58 offset:64
 ds_read_b64 v[186:187],v58 offset:96
 v_mfma_f32_16x16x32_bf16 a[0:3],v[24:27],a[144:147],a[0:3]
 ds_read_b64 v[188:189],v59
 v_mfma_f32_16x16x32_bf16 a[20:23],v[24:27],a[148:151],a[20:23]
 s_lshl_b32 s41,s58,1
 v_subrev_u32 v60,s41,v60
 v_cmp_gt_u32 vcc,10,v60
 v_mfma_f32_16x16x32_bf16 a[20:23],v[28:31],a[248:251],a[20:23]
 v_mov_b32 v7,0x40000000
 v_cndmask_b32 v1,v7,v1,vcc
 v_mfma_f32_16x16x32_bf16 a[40:43],v[28:31],a[252:255],a[40:43]
 s_lshl_b32 s41,s58,1
 v_subrev_u32 v61,s41,v61
 v_cmp_gt_u32 vcc,10,v61
 v_mfma_f32_16x16x32_bf16 a[40:43],v[24:27],a[152:155],a[40:43]
 s_waitcnt lgkmcnt(7)
 v_mov_b32 v7,0x40000000
 v_cndmask_b32 v2,v7,v2,vcc
 v_mfma_f32_16x16x32_bf16 v[228:231],v[32:35],a[140:143],v[228:231]
 ds_read_b128 v[16:19],v8 offset:27648
 ds_read_b128 v[20:23],v8 offset:3072
 v_mfma_f32_16x16x32_bf16 v[228:231],v[36:39],a[156:159],v[228:231]
 s_lshl_b32 s41,s58,1
 v_subrev_u32 v62,s41,v62
 v_cmp_gt_u32 vcc,10,v62
 v_mfma_f32_16x16x32_bf16 a[4:7],v[36:39],a[244:247],a[4:7]
 v_mov_b32 v7,0x40000000
 v_cndmask_b32 v3,v7,v3,vcc
 v_mfma_f32_16x16x32_bf16 a[4:7],v[32:35],a[144:147],a[4:7]
 v_mfma_f32_16x16x32_bf16 a[24:27],v[32:35],a[148:151],a[24:27]
 v_mfma_f32_16x16x32_bf16 a[24:27],v[36:39],a[248:251],a[24:27]
 ds_write_b128 v9,a[0:3]
 ds_write_b128 v6,a[20:23]
 v_mfma_f32_16x16x32_bf16 a[44:47],v[36:39],a[252:255],a[44:47]
 ds_write_b128 v9,a[40:43] offset:24576
 v_mfma_f32_16x16x32_bf16 a[44:47],v[32:35],a[152:155],a[44:47]
 s_waitcnt lgkmcnt(10)
 v_mfma_f32_16x16x32_bf16 v[232:235],v[40:43],a[140:143],v[232:235]
 ds_read_b128 v[24:27],v8 offset:28672
 ds_read_b128 v[28:31],v8 offset:4096
 v_mfma_f32_16x16x32_bf16 v[232:235],v[44:47],a[156:159],v[232:235]
 v_mfma_f32_16x16x32_bf16 a[8:11],v[44:47],a[244:247],a[8:11]
 v_mfma_f32_16x16x32_bf16 a[8:11],v[40:43],a[144:147],a[8:11]
 v_mfma_f32_16x16x32_bf16 a[28:31],v[40:43],a[148:151],a[28:31]
 buffer_load_dword v13,v12,s[92:95],0 offen sc1
 v_mfma_f32_16x16x32_bf16 a[28:31],v[44:47],a[248:251],a[28:31]
 ds_write_b128 v9,a[4:7] offset:1024
 ds_write_b128 v6,a[24:27] offset:1024
 v_mfma_f32_16x16x32_bf16 a[48:51],v[44:47],a[252:255],a[48:51]
 ds_write_b128 v9,a[44:47] offset:25600
 v_mfma_f32_16x16x32_bf16 a[48:51],v[40:43],a[152:155],a[48:51]
 s_waitcnt lgkmcnt(8)
 v_mfma_f32_16x16x32_bf16 v[236:239],v[16:19],a[140:143],v[236:239]
 v_mfma_f32_16x16x32_bf16 v[236:239],v[20:23],a[156:159],v[236:239]
 v_mfma_f32_16x16x32_bf16 a[12:15],v[20:23],a[244:247],a[12:15]
 v_mfma_f32_16x16x32_bf16 a[12:15],v[16:19],a[144:147],a[12:15]
 v_mfma_f32_16x16x32_bf16 a[32:35],v[16:19],a[148:151],a[32:35]
 v_mfma_f32_16x16x32_bf16 a[32:35],v[20:23],a[248:251],a[32:35]
 ds_write_b128 v9,a[8:11] offset:2048
 ds_write_b128 v6,a[28:31] offset:2048
 v_mfma_f32_16x16x32_bf16 a[52:55],v[20:23],a[252:255],a[52:55]
 ds_write_b128 v9,a[48:51] offset:26624
 v_mfma_f32_16x16x32_bf16 a[52:55],v[16:19],a[152:155],a[52:55]
 s_waitcnt lgkmcnt(6)
 v_mfma_f32_16x16x32_bf16 v[240:243],v[24:27],a[140:143],v[240:243]
 v_mfma_f32_16x16x32_bf16 v[240:243],v[28:31],a[156:159],v[240:243]
 v_mfma_f32_16x16x32_bf16 a[16:19],v[28:31],a[244:247],a[16:19]
 v_mfma_f32_16x16x32_bf16 a[16:19],v[24:27],a[144:147],a[16:19]
 v_mfma_f32_16x16x32_bf16 a[36:39],v[24:27],a[148:151],a[36:39]
 v_mfma_f32_16x16x32_bf16 a[36:39],v[28:31],a[248:251],a[36:39]
 ds_write_b128 v9,a[12:15] offset:3072
 ds_write_b128 v6,a[32:35] offset:3072
 v_mfma_f32_16x16x32_bf16 a[56:59],v[28:31],a[252:255],a[56:59]
 ds_write_b128 v9,a[52:55] offset:27648
 v_mfma_f32_16x16x32_bf16 a[56:59],v[24:27],a[152:155],a[56:59]
 s_waitcnt vmcnt(1)
 v_mfma_f32_16x16x32_bf16 v[224:227],v[50:53],v[244:247],v[224:227]
 v_mfma_f32_16x16x32_bf16 v[228:231],v[48:51],v[244:247],v[228:231]
 v_mfma_f32_16x16x32_bf16 v[232:235],v[50:53],v[248:251],v[232:235]
 v_mfma_f32_16x16x32_bf16 v[236:239],v[48:51],v[248:251],v[236:239]
 v_mfma_f32_16x16x32_bf16 v[240:243],v[50:53],v[252:255],v[240:243]
 ds_write_b128 v9,a[16:19] offset:4096
 ds_write_b128 v6,a[36:39] offset:4096
 ds_write_b128 v9,a[56:59] offset:28672
 s_waitcnt lgkmcnt(0)
 s_barrier
 ds_read_b128 v[64:67],v124
 ds_read_b128 v[68:71],v124 offset:1024
 ds_read_b128 v[72:75],v124 offset:2048
 ds_read_b128 v[76:79],v124 offset:3072
 ds_read_b128 v[80:83],v124 offset:4096
 ds_read_b128 v[84:87],v125
 ds_read_b128 v[88:91],v125 offset:1024
 ds_read_b128 v[92:95],v125 offset:2048
 ds_read_b128 v[96:99],v125 offset:3072
 ds_read_b128 v[100:103],v125 offset:4096
 ds_read_b128 v[104:107],v126
 ds_read_b128 v[108:111],v126 offset:1024
 ds_read_b128 v[112:115],v126 offset:2048
 ds_read_b128 v[116:119],v126 offset:3072
 ds_read_b128 v[120:123],v126 offset:4096
 s_cmp_eq_u32 s61,0
 s_cbranch_scc0 Lz42
 s_waitcnt vmcnt(0)
 v_cmp_ne_u32 vcc,s51,v13
 s_nop 1
 s_cbranch_vccnz Lp43_spin
Lp43_ok:
 s_add_u32 s42,s52,1
 s_and_b32 s42,s42,7
 s_mul_i32 s42,s42,10240
 s_add_u32 s42,s42,s38
 buffer_load_dwordx4 a[168:171],v4,s[28:31],s42 offen sc1
 buffer_load_dwordx4 a[172:175],v4,s[28:31],s42 offen offset:1024 sc1
 buffer_load_dwordx2 a[226:227],v5,s[28:31],s42 offen offset:2048 sc1
 s_add_u32 s42,s52,2
 s_and_b32 s42,s42,7
 s_mul_i32 s42,s42,10240
 s_add_u32 s42,s42,s38
 buffer_load_dwordx4 a[176:179],v4,s[28:31],s42 offen sc1
 buffer_load_dwordx4 a[180:183],v4,s[28:31],s42 offen offset:1024 sc1
 buffer_load_dwordx2 a[228:229],v5,s[28:31],s42 offen offset:2048 sc1
 s_add_u32 s42,s52,3
 s_and_b32 s42,s42,7
 s_mul_i32 s42,s42,10240
 s_add_u32 s42,s42,s38
 buffer_load_dwordx4 a[184:187],v4,s[28:31],s42 offen sc1
 buffer_load_dwordx4 a[188:191],v4,s[28:31],s42 offen offset:1024 sc1
 buffer_load_dwordx2 a[230:231],v5,s[28:31],s42 offen offset:2048 sc1
 s_add_u32 s42,s52,4
 s_and_b32 s42,s42,7
 s_mul_i32 s42,s42,10240
 s_add_u32 s42,s42,s38
 buffer_load_dwordx4 a[192:195],v4,s[28:31],s42 offen sc1
 buffer_load_dwordx4 a[196:199],v4,s[28:31],s42 offen offset:1024 sc1
 buffer_load_dwordx2 a[232:233],v5,s[28:31],s42 offen offset:2048 sc1
 s_add_u32 s42,s52,5
 s_and_b32 s42,s42,7
 s_mul_i32 s42,s42,10240
 s_add_u32 s42,s42,s38
 buffer_load_dwordx4 a[200:203],v4,s[28:31],s42 offen sc1
 buffer_load_dwordx4 a[204:207],v4,s[28:31],s42 offen offset:1024 sc1
 buffer_load_dwordx2 a[234:235],v5,s[28:31],s42 offen offset:2048 sc1
 s_add_u32 s42,s52,6
 s_and_b32 s42,s42,7
 s_mul_i32 s42,s42,10240
 s_add_u32 s42,s42,s38
 buffer_load_dwordx4 a[208:211],v4,s[28:31],s42 offen sc1
 buffer_load_dwordx4 a[212:215],v4,s[28:31],s42 offen offset:1024 sc1
 buffer_load_dwordx2 a[236:237],v5,s[28:31],s42 offen offset:2048 sc1
 s_add_u32 s42,s52,7
 s_and_b32 s42,s42,7
 s_mul_i32 s42,s42,10240
 s_add_u32 s42,s42,s38
 buffer_load_dwordx4 a[216:219],v4,s[28:31],s42 offen sc1
 buffer_load_dwordx4 a[220:223],v4,s[28:31],s42 offen offset:1024 sc1
 buffer_load_dwordx2 a[238:239],v5,s[28:31],s42 offen offset:2048 sc1
Lz42:
 s_waitcnt lgkmcnt(10)
 v_add_f32 v224,v224,v64
 v_add_f32 v225,v225,v65
 v_add_f32 v226,v226,v66
 v_add_f32 v227,v227,v67
 v_add_f32 v228,v228,v68
 v_add_f32 v229,v229,v69
 v_add_f32 v230,v230,v70
 v_add_f32 v231,v231,v71
 v_add_f32 v232,v232,v72
 v_add_f32 v233,v233,v73
 v_add_f32 v234,v234,v74
 v_add_f32 v235,v235,v75
 v_add_f32 v236,v236,v76
 v_add_f32 v237,v237,v77
 v_add_f32 v238,v238,v78
 v_add_f32 v239,v239,v79
 v_add_f32 v240,v240,v80
 v_add_f32 v241,v241,v81
 v_add_f32 v242,v242,v82
 v_add_f32 v243,v243,v83
 s_waitcnt lgkmcnt(5)
 v_add_f32 v224,v224,v84
 v_add_f32 v225,v225,v85
 v_add_f32 v226,v226,v86
 v_add_f32 v227,v227,v87
 v_add_f32 v228,v228,v88
 v_add_f32 v229,v229,v89
 v_add_f32 v230,v230,v90
 v_add_f32 v231,v231,v91
 v_add_f32 v232,v232,v92
 v_add_f32 v233,v233,v93
 v_add_f32 v234,v234,v94
 v_add_f32 v235,v235,v95
 v_add_f32 v236,v236,v96
 v_add_f32 v237,v237,v97
 v_add_f32 v238,v238,v98
 v_add_f32 v239,v239,v99
 v_add_f32 v240,v240,v100
 v_add_f32 v241,v241,v101
 v_add_f32 v242,v242,v102
 v_add_f32 v243,v243,v103
 s_waitcnt lgkmcnt(0)
 v_add_f32 v224,v224,v104
 v_add_f32 v225,v225,v105
 v_add_f32 v226,v226,v106
 v_add_f32 v227,v227,v107
 v_add_f32 v228,v228,v108
 v_add_f32 v229,v229,v109
 v_add_f32 v230,v230,v110
 v_add_f32 v231,v231,v111
 v_add_f32 v232,v232,v112
 v_add_f32 v233,v233,v113
 v_add_f32 v234,v234,v114
 v_add_f32 v235,v235,v115
 v_add_f32 v236,v236,v116
 v_add_f32 v237,v237,v117
 v_add_f32 v238,v238,v118
 v_add_f32 v239,v239,v119
 v_add_f32 v240,v240,v120
 v_add_f32 v241,v241,v121
 v_add_f32 v242,v242,v122
 v_add_f32 v243,v243,v123
 v_mul_f32 v200,0xbfb8aa3b,v224
 v_mul_f32 v201,0xbfb8aa3b,v225
 v_mul_f32 v202,0xbfb8aa3b,v226
 v_mul_f32 v203,0xbfb8aa3b,v227
 v_mul_f32 v204,0xbfb8aa3b,v228
 v_mul_f32 v205,0xbfb8aa3b,v229
 v_mul_f32 v206,0xbfb8aa3b,v230
 v_mul_f32 v207,0xbfb8aa3b,v231
 v_mul_f32 v208,0xbfb8aa3b,v232
 v_mul_f32 v209,0xbfb8aa3b,v233
 v_mul_f32 v210,0xbfb8aa3b,v234
 v_mul_f32 v211,0xbfb8aa3b,v235
 v_mul_f32 v212,0xbfb8aa3b,v236
 v_mul_f32 v213,0xbfb8aa3b,v237
 v_mul_f32 v214,0xbfb8aa3b,v238
 v_mul_f32 v215,0xbfb8aa3b,v239
 v_mul_f32 v216,0xbfb8aa3b,v240
 v_mul_f32 v217,0xbfb8aa3b,v241
 v_mul_f32 v218,0xbfb8aa3b,v242
 v_mul_f32 v219,0xbfb8aa3b,v243
 v_exp_f32 v200,v200
 v_exp_f32 v201,v201
 v_exp_f32 v202,v202
 v_exp_f32 v203,v203
 v_exp_f32 v204,v204
 v_exp_f32 v205,v205
 v_exp_f32 v206,v206
 v_exp_f32 v207,v207
 v_exp_f32 v208,v208
 v_exp_f32 v209,v209
 v_exp_f32 v210,v210
 v_exp_f32 v211,v211
 v_exp_f32 v212,v212
 v_exp_f32 v213,v213
 v_exp_f32 v214,v214
 v_exp_f32 v215,v215
 v_exp_f32 v216,v216
 v_exp_f32 v217,v217
 v_exp_f32 v218,v218
 v_exp_f32 v219,v219
 v_add_f32 v200,1.0,v200
 v_add_f32 v201,1.0,v201
 v_add_f32 v202,1.0,v202
 v_add_f32 v203,1.0,v203
 v_add_f32 v204,1.0,v204
 v_add_f32 v205,1.0,v205
 v_add_f32 v206,1.0,v206
 v_add_f32 v207,1.0,v207
 v_add_f32 v208,1.0,v208
 v_add_f32 v209,1.0,v209
 v_add_f32 v210,1.0,v210
 v_add_f32 v211,1.0,v211
 v_add_f32 v212,1.0,v212
 v_add_f32 v213,1.0,v213
 v_add_f32 v214,1.0,v214
 v_add_f32 v215,1.0,v215
 v_add_f32 v216,1.0,v216
 v_add_f32 v217,1.0,v217
 v_add_f32 v218,1.0,v218
 v_add_f32 v219,1.0,v219
 v_rcp_f32 v200,v200
 v_rcp_f32 v201,v201
 v_rcp_f32 v202,v202
 v_rcp_f32 v203,v203
 v_rcp_f32 v204,v204
 v_rcp_f32 v205,v205
 v_rcp_f32 v206,v206
 v_rcp_f32 v207,v207
 v_rcp_f32 v208,v208
 v_rcp_f32 v209,v209
 v_rcp_f32 v210,v210
 v_rcp_f32 v211,v211
 v_rcp_f32 v212,v212
 v_rcp_f32 v213,v213
 v_rcp_f32 v214,v214
 v_rcp_f32 v215,v215
 v_rcp_f32 v216,v216
 v_rcp_f32 v217,v217
 v_rcp_f32 v218,v218
 v_rcp_f32 v219,v219
 s_waitcnt vmcnt(18)
 v_mfma_f32_16x16x32_bf16 v[160:163],v[50:53],a[160:163],0
 v_mul_f32 v224,v224,v200
 v_mul_f32 v225,v225,v201
 v_mfma_f32_16x16x32_bf16 v[160:163],v[50:53],a[168:171],v[160:163]
 v_mul_f32 v226,v226,v202
 v_mul_f32 v227,v227,v203
 v_mfma_f32_16x16x32_bf16 v[164:167],v[48:51],a[160:163],0
 v_mul_f32 v228,v228,v204
 v_mul_f32 v229,v229,v205
 v_mfma_f32_16x16x32_bf16 v[164:167],v[48:51],a[168:171],v[164:167]
 v_mul_f32 v230,v230,v206
 v_mul_f32 v231,v231,v207
 v_mfma_f32_16x16x32_bf16 v[168:171],v[50:53],a[164:167],0
 v_mul_f32 v232,v232,v208
 v_mul_f32 v233,v233,v209
 v_mfma_f32_16x16x32_bf16 v[168:171],v[50:53],a[172:175],v[168:171]
 v_mul_f32 v234,v234,v210
 v_mul_f32 v235,v235,v211
 v_mfma_f32_16x16x32_bf16 v[172:175],v[48:51],a[164:167],0
 v_mul_f32 v236,v236,v212
 v_mul_f32 v237,v237,v213
 v_mfma_f32_16x16x32_bf16 v[172:175],v[48:51],a[172:175],v[172:175]
 v_mul_f32 v238,v238,v214
 v_mul_f32 v239,v239,v215
 v_mfma_f32_16x16x32_bf16 v[176:179],v[54:57],a[224:227],0
 s_waitcnt vmcnt(12)
 v_mul_f32 v240,v240,v216
 v_mul_f32 v241,v241,v217
 v_mfma_f32_16x16x32_bf16 v[160:163],v[50:53],a[176:179],v[160:163]
 v_mul_f32 v242,v242,v218
 v_mul_f32 v243,v243,v219
 v_mfma_f32_16x16x32_bf16 v[160:163],v[50:53],a[184:187],v[160:163]
 v_lshlrev_b32 v200,16,v180
 v_and_b32 v201,0xffff0000,v180
 v_mfma_f32_16x16x32_bf16 v[164:167],v[48:51],a[176:179],v[164:167]
 v_lshlrev_b32 v202,16,v181
 v_and_b32 v203,0xffff0000,v181
 v_mfma_f32_16x16x32_bf16 v[164:167],v[48:51],a[184:187],v[164:167]
 v_lshlrev_b32 v204,16,v182
 v_and_b32 v205,0xffff0000,v182
 v_mfma_f32_16x16x32_bf16 v[168:171],v[50:53],a[180:183],v[168:171]
 v_lshlrev_b32 v206,16,v183
 v_and_b32 v207,0xffff0000,v183
 v_mfma_f32_16x16x32_bf16 v[168:171],v[50:53],a[188:191],v[168:171]
 v_lshlrev_b32 v208,16,v184
 v_and_b32 v209,0xffff0000,v184
 v_mfma_f32_16x16x32_bf16 v[172:175],v[48:51],a[180:183],v[172:175]
 v_lshlrev_b32 v210,16,v185
 v_and_b32 v211,0xffff0000,v185
 v_mfma_f32_16x16x32_bf16 v[172:175],v[48:51],a[188:191],v[172:175]
 v_lshlrev_b32 v212,16,v186
 v_and_b32 v213,0xffff0000,v186
 v_mfma_f32_16x16x32_bf16 v[176:179],v[54:57],a[228:231],v[176:179]
 s_waitcnt vmcnt(6)
 v_lshlrev_b32 v214,16,v187
 v_and_b32 v215,0xffff0000,v187
 v_mfma_f32_16x16x32_bf16 v[160:163],v[50:53],a[192:195],v[160:163]
 v_lshlrev_b32 v216,16,v188
 v_and_b32 v217,0xffff0000,v188
 v_mfma_f32_16x16x32_bf16 v[160:163],v[50:53],a[200:203],v[160:163]
 v_lshlrev_b32 v218,16,v189
 v_and_b32 v219,0xffff0000,v189
 v_mfma_f32_16x16x32_bf16 v[164:167],v[48:51],a[192:195],v[164:167]
 v_mfma_f32_16x16x32_bf16 v[164:167],v[48:51],a[200:203],v[164:167]
 v_mfma_f32_16x16x32_bf16 v[168:171],v[50:53],a[196:199],v[168:171]
 v_mfma_f32_16x16x32_bf16 v[168:171],v[50:53],a[204:207],v[168:171]
 v_mfma_f32_16x16x32_bf16 v[172:175],v[48:51],a[196:199],v[172:175]
 v_mfma_f32_16x16x32_bf16 v[172:175],v[48:51],a[204:207],v[172:175]
 v_mfma_f32_16x16x32_bf16 v[176:179],v[54:57],a[232:235],v[176:179]
 s_waitcnt vmcnt(0)
 v_mfma_f32_16x16x32_bf16 v[160:163],v[50:53],a[208:211],v[160:163]
 v_mfma_f32_16x16x32_bf16 v[160:163],v[50:53],a[216:219],v[160:163]
 v_mfma_f32_16x16x32_bf16 v[164:167],v[48:51],a[208:211],v[164:167]
 v_mfma_f32_16x16x32_bf16 v[164:167],v[48:51],a[216:219],v[164:167]
 v_mfma_f32_16x16x32_bf16 v[168:171],v[50:53],a[212:215],v[168:171]
 v_mfma_f32_16x16x32_bf16 v[168:171],v[50:53],a[220:223],v[168:171]
 v_mfma_f32_16x16x32_bf16 v[172:175],v[48:51],a[212:215],v[172:175]
 v_mfma_f32_16x16x32_bf16 v[172:175],v[48:51],a[220:223],v[172:175]
 v_mfma_f32_16x16x32_bf16 v[176:179],v[54:57],a[236:239],v[176:179]
 s_nop 0
 v_fmac_f32 v200,v160,v224
 v_fmac_f32 v201,v161,v225
 v_fmac_f32 v202,v162,v226
 v_fmac_f32 v203,v163,v227
 v_cvt_pk_bf16_f32 v180,v200,v201
 v_cvt_pk_bf16_f32 v181,v202,v203
 ds_write_b64 v58,v[180:181]
 v_fmac_f32 v204,v164,v228
 v_fmac_f32 v205,v165,v229
 v_fmac_f32 v206,v166,v230
 v_fmac_f32 v207,v167,v231
 v_cvt_pk_bf16_f32 v182,v204,v205
 v_cvt_pk_bf16_f32 v183,v206,v207
 ds_write_b64 v58,v[182:183] offset:32
 v_fmac_f32 v208,v168,v232
 v_fmac_f32 v209,v169,v233
 v_fmac_f32 v210,v170,v234
 v_fmac_f32 v211,v171,v235
 v_cvt_pk_bf16_f32 v184,v208,v209
 v_cvt_pk_bf16_f32 v185,v210,v211
 ds_write_b64 v58,v[184:185] offset:64
 v_fmac_f32 v212,v172,v236
 v_fmac_f32 v213,v173,v237
 v_fmac_f32 v214,v174,v238
 v_fmac_f32 v215,v175,v239
 v_cvt_pk_bf16_f32 v186,v212,v213
 v_cvt_pk_bf16_f32 v187,v214,v215
 ds_write_b64 v58,v[186:187] offset:96
 v_fmac_f32 v216,v176,v240
 v_fmac_f32 v217,v177,v241
 v_fmac_f32 v218,v178,v242
 v_fmac_f32 v219,v179,v243
 v_cvt_pk_bf16_f32 v188,v216,v217
 v_cvt_pk_bf16_f32 v189,v218,v219
 ds_write_b64 v59,v[188:189]
 ds_read_b128 v[64:67],v63
 ds_read_b128 v[68:71],v63 offset:1024
 ds_read_b128 v[72:75],v63 offset:2048
 s_waitcnt lgkmcnt(2)
 buffer_store_dwordx4 v[64:67],v1,s[8:11],0 offen
 s_waitcnt lgkmcnt(1)
 buffer_store_dwordx4 v[68:71],v2,s[8:11],0 offen offset:1024
 s_waitcnt lgkmcnt(0)
 buffer_store_dwordx4 v[72:75],v3,s[8:11],0 offen offset:2048
 s_endpgm
Lp34_spin:
 s_mov_b32 s91,0
Lp34_again:
 s_sleep 6
 buffer_load_dword v13,v12,s[92:95],0 offen sc1
 s_add_u32 s91,s91,1
 s_cmp_gt_u32 s91,0x40000
 s_waitcnt vmcnt(0)
 s_cbranch_scc1 Lp34_ok
 v_cmp_ne_u32 vcc,s51,v13
 s_nop 1
 s_cbranch_vccnz Lp34_again
 s_branch Lp34_ok
Lp38_spin:
 s_mov_b32 s91,0
Lp38_again:
 s_sleep 6
 buffer_load_dword v13,v12,s[92:95],0 offen sc1
 s_add_u32 s91,s91,1
 s_cmp_gt_u32 s91,0x40000
 s_waitcnt vmcnt(0)
 s_cbranch_scc1 Lp38_ok
 v_cmp_ne_u32 vcc,s51,v13
 s_nop 1
 s_cbranch_vccnz Lp38_again
 s_branch Lp38_ok
Lp43_spin:
 s_mov_b32 s91,0
Lp43_again:
 s_sleep 6
 buffer_load_dword v13,v12,s[92:95],0 offen sc1
 s_add_u32 s91,s91,1
 s_cmp_gt_u32 s91,0x40000
 s_waitcnt vmcnt(0)
 s_cbranch_scc1 Lp43_ok
 v_cmp_ne_u32 vcc,s51,v13
 s_nop 1
 s_cbranch_vccnz Lp43_again
 s_branch Lp43_ok
recurrent_scan__mha_block_cached__mixer_s_mlp__prompt_kernel_hot_end:
recurrent_scan__mha_block_cached__mixer_s_mlp__prompt_kernel_exact:
 s_waitcnt vmcnt(0) lgkmcnt(0)
 s_mov_b32 s78,m0
 s_nop 15
 v_accvgpr_write_b32 a0,0
 v_accvgpr_write_b32 a1,0
 v_accvgpr_write_b32 a2,0
 v_accvgpr_write_b32 a3,0
 v_accvgpr_write_b32 a4,0
 v_accvgpr_write_b32 a5,0
 v_accvgpr_write_b32 a6,0
 v_accvgpr_write_b32 a7,0
 v_accvgpr_write_b32 a8,0
 v_accvgpr_write_b32 a9,0
 v_accvgpr_write_b32 a10,0
 v_accvgpr_write_b32 a11,0
 v_accvgpr_write_b32 a12,0
 v_accvgpr_write_b32 a13,0
 v_accvgpr_write_b32 a14,0
 v_accvgpr_write_b32 a15,0
 v_accvgpr_write_b32 a16,0
 v_accvgpr_write_b32 a17,0
 v_accvgpr_write_b32 a18,0
 v_accvgpr_write_b32 a19,0
 v_accvgpr_write_b32 a20,0
 v_accvgpr_write_b32 a21,0
 v_accvgpr_write_b32 a22,0
 v_accvgpr_write_b32 a23,0
 v_accvgpr_write_b32 a24,0
 v_accvgpr_write_b32 a25,0
 v_accvgpr_write_b32 a26,0
 v_accvgpr_write_b32 a27,0
 v_accvgpr_write_b32 a28,0
 v_accvgpr_write_b32 a29,0
 v_accvgpr_write_b32 a30,0
 v_accvgpr_write_b32 a31,0
 v_accvgpr_write_b32 a32,0
 v_accvgpr_write_b32 a33,0
 v_accvgpr_write_b32 a34,0
 v_accvgpr_write_b32 a35,0
 v_accvgpr_write_b32 a36,0
 v_accvgpr_write_b32 a37,0
 v_accvgpr_write_b32 a38,0
 v_accvgpr_write_b32 a39,0
 v_accvgpr_write_b32 a40,0
 v_accvgpr_write_b32 a41,0
 v_accvgpr_write_b32 a42,0
 v_accvgpr_write_b32 a43,0
 v_accvgpr_write_b32 a44,0
 v_accvgpr_write_b32 a45,0
 v_accvgpr_write_b32 a46,0
 v_accvgpr_write_b32 a47,0
 v_accvgpr_write_b32 a48,0
 v_accvgpr_write_b32 a49,0
 v_accvgpr_write_b32 a50,0
 v_accvgpr_write_b32 a51,0
 v_accvgpr_write_b32 a52,0
 v_accvgpr_write_b32 a53,0
 v_accvgpr_write_b32 a54,0
 v_accvgpr_write_b32 a55,0
 v_accvgpr_write_b32 a56,0
 v_accvgpr_write_b32 a57,0
 v_accvgpr_write_b32 a58,0
 v_accvgpr_write_b32 a59,0
 v_accvgpr_write_b32 a60,0
 v_accvgpr_write_b32 a61,0
 v_accvgpr_write_b32 a62,0
 v_accvgpr_write_b32 a63,0
 v_accvgpr_write_b32 a64,0
 v_accvgpr_write_b32 a65,0
 v_accvgpr_write_b32 a66,0
 v_accvgpr_write_b32 a67,0
 v_accvgpr_write_b32 a68,0
 v_accvgpr_write_b32 a69,0
 v_accvgpr_write_b32 a70,0
 v_accvgpr_write_b32 a71,0
 v_accvgpr_write_b32 a72,0
 v_accvgpr_write_b32 a73,0
 v_accvgpr_write_b32 a74,0
 v_accvgpr_write_b32 a75,0
 v_accvgpr_write_b32 a76,0
 v_accvgpr_write_b32 a77,0
 v_accvgpr_write_b32 a78,0
 v_accvgpr_write_b32 a79,0
 v_accvgpr_write_b32 a80,0
 v_accvgpr_write_b32 a81,0
 v_accvgpr_write_b32 a82,0
 v_accvgpr_write_b32 a83,0
 v_accvgpr_write_b32 a84,0
 v_accvgpr_write_b32 a85,0
 v_accvgpr_write_b32 a86,0
 v_accvgpr_write_b32 a87,0
 v_accvgpr_write_b32 a88,0
 v_accvgpr_write_b32 a89,0
 v_accvgpr_write_b32 a90,0
 v_accvgpr_write_b32 a91,0
 v_accvgpr_write_b32 a92,0
 v_accvgpr_write_b32 a93,0
 v_accvgpr_write_b32 a94,0
 v_accvgpr_write_b32 a95,0
 v_accvgpr_write_b32 a96,0
 v_accvgpr_write_b32 a97,0
 v_accvgpr_write_b32 a98,0
 v_accvgpr_write_b32 a99,0
 v_accvgpr_write_b32 a100,0
 v_accvgpr_write_b32 a101,0
 v_accvgpr_write_b32 a102,0
 v_accvgpr_write_b32 a103,0
 v_accvgpr_write_b32 a104,0
 v_accvgpr_write_b32 a105,0
 v_accvgpr_write_b32 a106,0
 v_accvgpr_write_b32 a107,0
 v_accvgpr_write_b32 a108,0
 v_accvgpr_write_b32 a109,0
 v_accvgpr_write_b32 a110,0
 v_accvgpr_write_b32 a111,0
 v_accvgpr_write_b32 a112,0
 v_accvgpr_write_b32 a113,0
 v_accvgpr_write_b32 a114,0
 v_accvgpr_write_b32 a115,0
 v_accvgpr_write_b32 a116,0
 v_accvgpr_write_b32 a117,0
 v_accvgpr_write_b32 a118,0
 v_accvgpr_write_b32 a119,0
 v_accvgpr_write_b32 a120,0
 v_accvgpr_write_b32 a121,0
 v_accvgpr_write_b32 a122,0
 v_accvgpr_write_b32 a123,0
 v_accvgpr_write_b32 a124,0
 v_accvgpr_write_b32 a125,0
 v_accvgpr_write_b32 a126,0
 v_accvgpr_write_b32 a127,0
 v_accvgpr_write_b32 a128,0
 v_accvgpr_write_b32 a129,0
 v_accvgpr_write_b32 a130,0
 v_accvgpr_write_b32 a131,0
 v_accvgpr_write_b32 a132,0
 v_accvgpr_write_b32 a133,0
 v_accvgpr_write_b32 a134,0
 v_accvgpr_write_b32 a135,0
 v_accvgpr_write_b32 a136,0
 v_accvgpr_write_b32 a137,0
 v_accvgpr_write_b32 a138,0
 v_accvgpr_write_b32 a139,0
 v_accvgpr_write_b32 a140,0
 v_accvgpr_write_b32 a141,0
 v_accvgpr_write_b32 a142,0
 v_accvgpr_write_b32 a143,0
 v_accvgpr_write_b32 a144,0
 v_accvgpr_write_b32 a145,0
 v_accvgpr_write_b32 a146,0
 v_accvgpr_write_b32 a147,0
 v_accvgpr_write_b32 a148,0
 v_accvgpr_write_b32 a149,0
 v_accvgpr_write_b32 a150,0
 v_accvgpr_write_b32 a151,0
 v_accvgpr_write_b32 a152,0
 v_accvgpr_write_b32 a153,0
 v_accvgpr_write_b32 a154,0
 v_accvgpr_write_b32 a155,0
 v_accvgpr_write_b32 a156,0
 v_accvgpr_write_b32 a157,0
 v_accvgpr_write_b32 a158,0
 v_accvgpr_write_b32 a159,0
 v_accvgpr_write_b32 a160,0
 v_accvgpr_write_b32 a161,0
 v_accvgpr_write_b32 a162,0
 v_accvgpr_write_b32 a163,0
 v_accvgpr_write_b32 a164,0
 v_accvgpr_write_b32 a165,0
 v_accvgpr_write_b32 a166,0
 v_accvgpr_write_b32 a167,0
 v_accvgpr_write_b32 a168,0
 v_accvgpr_write_b32 a169,0
 v_accvgpr_write_b32 a170,0
 v_accvgpr_write_b32 a171,0
 v_accvgpr_write_b32 a172,0
 v_accvgpr_write_b32 a173,0
 v_accvgpr_write_b32 a174,0
 v_accvgpr_write_b32 a175,0
 v_accvgpr_write_b32 a176,0
 v_accvgpr_write_b32 a177,0
 v_accvgpr_write_b32 a178,0
 v_accvgpr_write_b32 a179,0
 v_accvgpr_write_b32 a180,0
 v_accvgpr_write_b32 a181,0
 v_accvgpr_write_b32 a182,0
 v_accvgpr_write_b32 a183,0
 v_accvgpr_write_b32 a184,0
 v_accvgpr_write_b32 a185,0
 v_accvgpr_write_b32 a186,0
 v_accvgpr_write_b32 a187,0
 v_accvgpr_write_b32 a188,0
 v_accvgpr_write_b32 a189,0
 v_accvgpr_write_b32 a190,0
 v_accvgpr_write_b32 a191,0
 v_mov_b32 v208,0xff61b1e6
 v_mov_b32 v209,0xff61b1e6
 v_mov_b32 v210,0xff61b1e6
 v_mov_b32 v211,0xff61b1e6
 v_mov_b32 v10,0
 v_mov_b32 v11,0
 v_mov_b32 v12,0
 v_mov_b32 v13,0
 v_and_b32 v14,15,v0
 v_mul_u32_u24 v224,384,v14
 v_and_b32 v15,48,v0
 v_add_u32 v224,v224,v15
 v_lshrrev_b32 v14,3,v0
 v_and_b32 v15,6,v14
 v_xor_b32 v15,v15,v0
 v_lshlrev_b32 v15,4,v15
 v_mul_u32_u24 v14,256,v14
 v_add_u32 v225,v14,v15
 s_lshl_b32 s79,s32,12
 s_add_u32 s79,s79,147456
 v_lshrrev_b32 v14,2,v0
 v_and_b32 v15,6,v14
 v_lshlrev_b32 v15,4,v15
 v_lshl_add_u32 v226,v14,7,v15
 v_and_b32 v15,3,v0
 v_lshl_add_u32 v226,v15,3,v226
 v_add_u32 v226,s79,v226
 v_xor_b32 v227,32,v226
 v_xor_b32 v228,64,v226
 v_xor_b32 v229,0x60,v226
 s_mov_b32 s43,0
recurrent_scan__mha_block_cached__mixer_s_mlp__prompt_kernel_xl:
 s_add_u32 s41,s43,0
 buffer_load_dwordx4 v[128:131],v224,s[20:23],s41 offen
 buffer_load_dwordx4 v[132:135],v224,s[20:23],s41 offen offset:64
 buffer_load_dwordx4 v[136:139],v224,s[20:23],s41 offen offset:128
 buffer_load_dwordx4 v[140:143],v224,s[20:23],s41 offen offset:192
 buffer_load_dwordx4 v[144:147],v224,s[20:23],s41 offen offset:256
 buffer_load_dwordx4 v[148:151],v224,s[20:23],s41 offen offset:320
 s_add_u32 s41,s43,6144
 buffer_load_dwordx4 v[152:155],v224,s[20:23],s41 offen
 buffer_load_dwordx4 v[156:159],v224,s[20:23],s41 offen offset:64
 buffer_load_dwordx4 v[160:163],v224,s[20:23],s41 offen offset:128
 buffer_load_dwordx4 v[164:167],v224,s[20:23],s41 offen offset:192
 buffer_load_dwordx4 v[168:171],v224,s[20:23],s41 offen offset:256
 buffer_load_dwordx4 v[172:175],v224,s[20:23],s41 offen offset:320
 s_waitcnt vmcnt(0)
 v_mfma_f32_16x16x32_bf16 v[96:99],v[128:131],a[192:195],0
 v_mfma_f32_16x16x32_bf16 v[96:99],v[132:135],a[208:211],v[96:99]
 v_mfma_f32_16x16x32_bf16 v[96:99],v[136:139],a[224:227],v[96:99]
 v_mfma_f32_16x16x32_bf16 v[96:99],v[140:143],a[240:243],v[96:99]
 v_mfma_f32_16x16x32_bf16 v[96:99],v[144:147],v[64:67],v[96:99]
 v_mfma_f32_16x16x32_bf16 v[96:99],v[148:151],v[80:83],v[96:99]
 v_mfma_f32_16x16x32_bf16 v[104:107],v[128:131],a[196:199],0
 v_mfma_f32_16x16x32_bf16 v[104:107],v[132:135],a[212:215],v[104:107]
 v_mfma_f32_16x16x32_bf16 v[104:107],v[136:139],a[228:231],v[104:107]
 v_mfma_f32_16x16x32_bf16 v[104:107],v[140:143],a[244:247],v[104:107]
 v_mfma_f32_16x16x32_bf16 v[104:107],v[144:147],v[68:71],v[104:107]
 v_mfma_f32_16x16x32_bf16 v[104:107],v[148:151],v[84:87],v[104:107]
 v_mfma_f32_16x16x32_bf16 v[112:115],v[128:131],a[200:203],0
 v_mfma_f32_16x16x32_bf16 v[112:115],v[132:135],a[216:219],v[112:115]
 v_mfma_f32_16x16x32_bf16 v[112:115],v[136:139],a[232:235],v[112:115]
 v_mfma_f32_16x16x32_bf16 v[112:115],v[140:143],a[248:251],v[112:115]
 v_mfma_f32_16x16x32_bf16 v[112:115],v[144:147],v[72:75],v[112:115]
 v_mfma_f32_16x16x32_bf16 v[112:115],v[148:151],v[88:91],v[112:115]
 v_mfma_f32_16x16x32_bf16 v[120:123],v[128:131],a[204:207],0
 v_mfma_f32_16x16x32_bf16 v[120:123],v[132:135],a[220:223],v[120:123]
 v_mfma_f32_16x16x32_bf16 v[120:123],v[136:139],a[236:239],v[120:123]
 v_mfma_f32_16x16x32_bf16 v[120:123],v[140:143],a[252:255],v[120:123]
 v_mfma_f32_16x16x32_bf16 v[120:123],v[144:147],v[76:79],v[120:123]
 v_mfma_f32_16x16x32_bf16 v[120:123],v[148:151],v[92:95],v[120:123]
 v_mfma_f32_16x16x32_bf16 v[100:103],v[152:155],a[192:195],0
 v_mfma_f32_16x16x32_bf16 v[100:103],v[156:159],a[208:211],v[100:103]
 v_mfma_f32_16x16x32_bf16 v[100:103],v[160:163],a[224:227],v[100:103]
 v_mfma_f32_16x16x32_bf16 v[100:103],v[164:167],a[240:243],v[100:103]
 v_mfma_f32_16x16x32_bf16 v[100:103],v[168:171],v[64:67],v[100:103]
 v_mfma_f32_16x16x32_bf16 v[100:103],v[172:175],v[80:83],v[100:103]
 v_mfma_f32_16x16x32_bf16 v[108:111],v[152:155],a[196:199],0
 v_mfma_f32_16x16x32_bf16 v[108:111],v[156:159],a[212:215],v[108:111]
 v_mfma_f32_16x16x32_bf16 v[108:111],v[160:163],a[228:231],v[108:111]
 v_mfma_f32_16x16x32_bf16 v[108:111],v[164:167],a[244:247],v[108:111]
 v_mfma_f32_16x16x32_bf16 v[108:111],v[168:171],v[68:71],v[108:111]
 v_mfma_f32_16x16x32_bf16 v[108:111],v[172:175],v[84:87],v[108:111]
 v_mfma_f32_16x16x32_bf16 v[116:119],v[152:155],a[200:203],0
 v_mfma_f32_16x16x32_bf16 v[116:119],v[156:159],a[216:219],v[116:119]
 v_mfma_f32_16x16x32_bf16 v[116:119],v[160:163],a[232:235],v[116:119]
 v_mfma_f32_16x16x32_bf16 v[116:119],v[164:167],a[248:251],v[116:119]
 v_mfma_f32_16x16x32_bf16 v[116:119],v[168:171],v[72:75],v[116:119]
 v_mfma_f32_16x16x32_bf16 v[116:119],v[172:175],v[88:91],v[116:119]
 v_mfma_f32_16x16x32_bf16 v[124:127],v[152:155],a[204:207],0
 v_mfma_f32_16x16x32_bf16 v[124:127],v[156:159],a[220:223],v[124:127]
 v_mfma_f32_16x16x32_bf16 v[124:127],v[160:163],a[236:239],v[124:127]
 v_mfma_f32_16x16x32_bf16 v[124:127],v[164:167],a[252:255],v[124:127]
 v_mfma_f32_16x16x32_bf16 v[124:127],v[168:171],v[76:79],v[124:127]
 v_mfma_f32_16x16x32_bf16 v[124:127],v[172:175],v[92:95],v[124:127]
 v_max3_f32 v212,v96,v97,v208
 v_max3_f32 v212,v98,v99,v212
 v_max3_f32 v212,v100,v101,v212
 v_max3_f32 v212,v102,v103,v212
 v_max3_f32 v213,v104,v105,v209
 v_max3_f32 v213,v106,v107,v213
 v_max3_f32 v213,v108,v109,v213
 v_max3_f32 v213,v110,v111,v213
 v_max3_f32 v214,v112,v113,v210
 v_max3_f32 v214,v114,v115,v214
 v_max3_f32 v214,v116,v117,v214
 v_max3_f32 v214,v118,v119,v214
 v_max3_f32 v215,v120,v121,v211
 v_max3_f32 v215,v122,v123,v215
 v_max3_f32 v215,v124,v125,v215
 v_max3_f32 v215,v126,v127,v215
 v_mov_b32 v216,v212
 v_mov_b32 v217,v213
 v_mov_b32 v218,v214
 v_mov_b32 v219,v215
 v_permlane32_swap_b32 v212,v216
 v_permlane32_swap_b32 v213,v217
 v_permlane32_swap_b32 v214,v218
 v_permlane32_swap_b32 v215,v219
 v_max_f32 v212,v212,v216
 v_max_f32 v213,v213,v217
 v_max_f32 v214,v214,v218
 v_max_f32 v215,v215,v219
 v_mov_b32 v216,v212
 v_mov_b32 v217,v213
 v_mov_b32 v218,v214
 v_mov_b32 v219,v215
 v_permlane16_swap_b32 v212,v216
 v_permlane16_swap_b32 v213,v217
 v_permlane16_swap_b32 v214,v218
 v_permlane16_swap_b32 v215,v219
 v_max_f32 v212,v212,v216
 v_max_f32 v213,v213,v217
 v_max_f32 v214,v214,v218
 v_max_f32 v215,v215,v219
 v_sub_f32 v216,v208,v212
 v_mov_b32 v208,v212
 v_exp_f32 v212,v216
 v_sub_f32 v216,v209,v213
 v_mov_b32 v209,v213
 v_exp_f32 v213,v216
 v_sub_f32 v216,v210,v214
 v_mov_b32 v210,v214
 v_exp_f32 v214,v216
 v_sub_f32 v216,v211,v215
 v_mov_b32 v211,v215
 v_exp_f32 v215,v216
 v_mul_f32 v10,v10,v212
 v_sub_f32 v96,v96,v208
 v_sub_f32 v97,v97,v208
 v_sub_f32 v98,v98,v208
 v_sub_f32 v99,v99,v208
 v_sub_f32 v100,v100,v208
 v_sub_f32 v101,v101,v208
 v_sub_f32 v102,v102,v208
 v_sub_f32 v103,v103,v208
 v_exp_f32 v96,v96
 v_exp_f32 v97,v97
 v_exp_f32 v98,v98
 v_exp_f32 v99,v99
 v_exp_f32 v100,v100
 v_exp_f32 v101,v101
 v_exp_f32 v102,v102
 v_exp_f32 v103,v103
 v_add_f32 v10,v10,v96
 v_add_f32 v10,v10,v97
 v_add_f32 v10,v10,v98
 v_add_f32 v10,v10,v99
 v_add_f32 v10,v10,v100
 v_add_f32 v10,v10,v101
 v_add_f32 v10,v10,v102
 v_add_f32 v10,v10,v103
 v_cvt_pk_bf16_f32 v176,v96,v97
 v_cvt_pk_bf16_f32 v177,v98,v99
 v_cvt_pk_bf16_f32 v178,v100,v101
 v_cvt_pk_bf16_f32 v179,v102,v103
 v_mul_f32 v11,v11,v213
 v_sub_f32 v104,v104,v209
 v_sub_f32 v105,v105,v209
 v_sub_f32 v106,v106,v209
 v_sub_f32 v107,v107,v209
 v_sub_f32 v108,v108,v209
 v_sub_f32 v109,v109,v209
 v_sub_f32 v110,v110,v209
 v_sub_f32 v111,v111,v209
 v_exp_f32 v104,v104
 v_exp_f32 v105,v105
 v_exp_f32 v106,v106
 v_exp_f32 v107,v107
 v_exp_f32 v108,v108
 v_exp_f32 v109,v109
 v_exp_f32 v110,v110
 v_exp_f32 v111,v111
 v_add_f32 v11,v11,v104
 v_add_f32 v11,v11,v105
 v_add_f32 v11,v11,v106
 v_add_f32 v11,v11,v107
 v_add_f32 v11,v11,v108
 v_add_f32 v11,v11,v109
 v_add_f32 v11,v11,v110
 v_add_f32 v11,v11,v111
 v_cvt_pk_bf16_f32 v180,v104,v105
 v_cvt_pk_bf16_f32 v181,v106,v107
 v_cvt_pk_bf16_f32 v182,v108,v109
 v_cvt_pk_bf16_f32 v183,v110,v111
 v_mul_f32 v12,v12,v214
 v_sub_f32 v112,v112,v210
 v_sub_f32 v113,v113,v210
 v_sub_f32 v114,v114,v210
 v_sub_f32 v115,v115,v210
 v_sub_f32 v116,v116,v210
 v_sub_f32 v117,v117,v210
 v_sub_f32 v118,v118,v210
 v_sub_f32 v119,v119,v210
 v_exp_f32 v112,v112
 v_exp_f32 v113,v113
 v_exp_f32 v114,v114
 v_exp_f32 v115,v115
 v_exp_f32 v116,v116
 v_exp_f32 v117,v117
 v_exp_f32 v118,v118
 v_exp_f32 v119,v119
 v_add_f32 v12,v12,v112
 v_add_f32 v12,v12,v113
 v_add_f32 v12,v12,v114
 v_add_f32 v12,v12,v115
 v_add_f32 v12,v12,v116
 v_add_f32 v12,v12,v117
 v_add_f32 v12,v12,v118
 v_add_f32 v12,v12,v119
 v_cvt_pk_bf16_f32 v184,v112,v113
 v_cvt_pk_bf16_f32 v185,v114,v115
 v_cvt_pk_bf16_f32 v186,v116,v117
 v_cvt_pk_bf16_f32 v187,v118,v119
 v_mul_f32 v13,v13,v215
 v_sub_f32 v120,v120,v211
 v_sub_f32 v121,v121,v211
 v_sub_f32 v122,v122,v211
 v_sub_f32 v123,v123,v211
 v_sub_f32 v124,v124,v211
 v_sub_f32 v125,v125,v211
 v_sub_f32 v126,v126,v211
 v_sub_f32 v127,v127,v211
 v_exp_f32 v120,v120
 v_exp_f32 v121,v121
 v_exp_f32 v122,v122
 v_exp_f32 v123,v123
 v_exp_f32 v124,v124
 v_exp_f32 v125,v125
 v_exp_f32 v126,v126
 v_exp_f32 v127,v127
 v_add_f32 v13,v13,v120
 v_add_f32 v13,v13,v121
 v_add_f32 v13,v13,v122
 v_add_f32 v13,v13,v123
 v_add_f32 v13,v13,v124
 v_add_f32 v13,v13,v125
 v_add_f32 v13,v13,v126
 v_add_f32 v13,v13,v127
 v_cvt_pk_bf16_f32 v188,v120,v121
 v_cvt_pk_bf16_f32 v189,v122,v123
 v_cvt_pk_bf16_f32 v190,v124,v125
 v_cvt_pk_bf16_f32 v191,v126,v127
 v_accvgpr_read_b32 v216,a0
 v_accvgpr_read_b32 v217,a1
 v_accvgpr_read_b32 v218,a2
 v_accvgpr_read_b32 v219,a3
 v_mul_f32 v216,v216,v212
 v_mul_f32 v217,v217,v212
 v_mul_f32 v218,v218,v212
 v_mul_f32 v219,v219,v212
 v_accvgpr_write_b32 a0,v216
 v_accvgpr_write_b32 a1,v217
 v_accvgpr_write_b32 a2,v218
 v_accvgpr_write_b32 a3,v219
 v_accvgpr_read_b32 v216,a4
 v_accvgpr_read_b32 v217,a5
 v_accvgpr_read_b32 v218,a6
 v_accvgpr_read_b32 v219,a7
 v_mul_f32 v216,v216,v213
 v_mul_f32 v217,v217,v213
 v_mul_f32 v218,v218,v213
 v_mul_f32 v219,v219,v213
 v_accvgpr_write_b32 a4,v216
 v_accvgpr_write_b32 a5,v217
 v_accvgpr_write_b32 a6,v218
 v_accvgpr_write_b32 a7,v219
 v_accvgpr_read_b32 v216,a8
 v_accvgpr_read_b32 v217,a9
 v_accvgpr_read_b32 v218,a10
 v_accvgpr_read_b32 v219,a11
 v_mul_f32 v216,v216,v214
 v_mul_f32 v217,v217,v214
 v_mul_f32 v218,v218,v214
 v_mul_f32 v219,v219,v214
 v_accvgpr_write_b32 a8,v216
 v_accvgpr_write_b32 a9,v217
 v_accvgpr_write_b32 a10,v218
 v_accvgpr_write_b32 a11,v219
 v_accvgpr_read_b32 v216,a12
 v_accvgpr_read_b32 v217,a13
 v_accvgpr_read_b32 v218,a14
 v_accvgpr_read_b32 v219,a15
 v_mul_f32 v216,v216,v215
 v_mul_f32 v217,v217,v215
 v_mul_f32 v218,v218,v215
 v_mul_f32 v219,v219,v215
 v_accvgpr_write_b32 a12,v216
 v_accvgpr_write_b32 a13,v217
 v_accvgpr_write_b32 a14,v218
 v_accvgpr_write_b32 a15,v219
 v_accvgpr_read_b32 v216,a16
 v_accvgpr_read_b32 v217,a17
 v_accvgpr_read_b32 v218,a18
 v_accvgpr_read_b32 v219,a19
 v_mul_f32 v216,v216,v212
 v_mul_f32 v217,v217,v212
 v_mul_f32 v218,v218,v212
 v_mul_f32 v219,v219,v212
 v_accvgpr_write_b32 a16,v216
 v_accvgpr_write_b32 a17,v217
 v_accvgpr_write_b32 a18,v218
 v_accvgpr_write_b32 a19,v219
 v_accvgpr_read_b32 v216,a20
 v_accvgpr_read_b32 v217,a21
 v_accvgpr_read_b32 v218,a22
 v_accvgpr_read_b32 v219,a23
 v_mul_f32 v216,v216,v213
 v_mul_f32 v217,v217,v213
 v_mul_f32 v218,v218,v213
 v_mul_f32 v219,v219,v213
 v_accvgpr_write_b32 a20,v216
 v_accvgpr_write_b32 a21,v217
 v_accvgpr_write_b32 a22,v218
 v_accvgpr_write_b32 a23,v219
 v_accvgpr_read_b32 v216,a24
 v_accvgpr_read_b32 v217,a25
 v_accvgpr_read_b32 v218,a26
 v_accvgpr_read_b32 v219,a27
 v_mul_f32 v216,v216,v214
 v_mul_f32 v217,v217,v214
 v_mul_f32 v218,v218,v214
 v_mul_f32 v219,v219,v214
 v_accvgpr_write_b32 a24,v216
 v_accvgpr_write_b32 a25,v217
 v_accvgpr_write_b32 a26,v218
 v_accvgpr_write_b32 a27,v219
 v_accvgpr_read_b32 v216,a28
 v_accvgpr_read_b32 v217,a29
 v_accvgpr_read_b32 v218,a30
 v_accvgpr_read_b32 v219,a31
 v_mul_f32 v216,v216,v215
 v_mul_f32 v217,v217,v215
 v_mul_f32 v218,v218,v215
 v_mul_f32 v219,v219,v215
 v_accvgpr_write_b32 a28,v216
 v_accvgpr_write_b32 a29,v217
 v_accvgpr_write_b32 a30,v218
 v_accvgpr_write_b32 a31,v219
 v_accvgpr_read_b32 v216,a32
 v_accvgpr_read_b32 v217,a33
 v_accvgpr_read_b32 v218,a34
 v_accvgpr_read_b32 v219,a35
 v_mul_f32 v216,v216,v212
 v_mul_f32 v217,v217,v212
 v_mul_f32 v218,v218,v212
 v_mul_f32 v219,v219,v212
 v_accvgpr_write_b32 a32,v216
 v_accvgpr_write_b32 a33,v217
 v_accvgpr_write_b32 a34,v218
 v_accvgpr_write_b32 a35,v219
 v_accvgpr_read_b32 v216,a36
 v_accvgpr_read_b32 v217,a37
 v_accvgpr_read_b32 v218,a38
 v_accvgpr_read_b32 v219,a39
 v_mul_f32 v216,v216,v213
 v_mul_f32 v217,v217,v213
 v_mul_f32 v218,v218,v213
 v_mul_f32 v219,v219,v213
 v_accvgpr_write_b32 a36,v216
 v_accvgpr_write_b32 a37,v217
 v_accvgpr_write_b32 a38,v218
 v_accvgpr_write_b32 a39,v219
 v_accvgpr_read_b32 v216,a40
 v_accvgpr_read_b32 v217,a41
 v_accvgpr_read_b32 v218,a42
 v_accvgpr_read_b32 v219,a43
 v_mul_f32 v216,v216,v214
 v_mul_f32 v217,v217,v214
 v_mul_f32 v218,v218,v214
 v_mul_f32 v219,v219,v214
 v_accvgpr_write_b32 a40,v216
 v_accvgpr_write_b32 a41,v217
 v_accvgpr_write_b32 a42,v218
 v_accvgpr_write_b32 a43,v219
 v_accvgpr_read_b32 v216,a44
 v_accvgpr_read_b32 v217,a45
 v_accvgpr_read_b32 v218,a46
 v_accvgpr_read_b32 v219,a47
 v_mul_f32 v216,v216,v215
 v_mul_f32 v217,v217,v215
 v_mul_f32 v218,v218,v215
 v_mul_f32 v219,v219,v215
 v_accvgpr_write_b32 a44,v216
 v_accvgpr_write_b32 a45,v217
 v_accvgpr_write_b32 a46,v218
 v_accvgpr_write_b32 a47,v219
 v_accvgpr_read_b32 v216,a48
 v_accvgpr_read_b32 v217,a49
 v_accvgpr_read_b32 v218,a50
 v_accvgpr_read_b32 v219,a51
 v_mul_f32 v216,v216,v212
 v_mul_f32 v217,v217,v212
 v_mul_f32 v218,v218,v212
 v_mul_f32 v219,v219,v212
 v_accvgpr_write_b32 a48,v216
 v_accvgpr_write_b32 a49,v217
 v_accvgpr_write_b32 a50,v218
 v_accvgpr_write_b32 a51,v219
 v_accvgpr_read_b32 v216,a52
 v_accvgpr_read_b32 v217,a53
 v_accvgpr_read_b32 v218,a54
 v_accvgpr_read_b32 v219,a55
 v_mul_f32 v216,v216,v213
 v_mul_f32 v217,v217,v213
 v_mul_f32 v218,v218,v213
 v_mul_f32 v219,v219,v213
 v_accvgpr_write_b32 a52,v216
 v_accvgpr_write_b32 a53,v217
 v_accvgpr_write_b32 a54,v218
 v_accvgpr_write_b32 a55,v219
 v_accvgpr_read_b32 v216,a56
 v_accvgpr_read_b32 v217,a57
 v_accvgpr_read_b32 v218,a58
 v_accvgpr_read_b32 v219,a59
 v_mul_f32 v216,v216,v214
 v_mul_f32 v217,v217,v214
 v_mul_f32 v218,v218,v214
 v_mul_f32 v219,v219,v214
 v_accvgpr_write_b32 a56,v216
 v_accvgpr_write_b32 a57,v217
 v_accvgpr_write_b32 a58,v218
 v_accvgpr_write_b32 a59,v219
 v_accvgpr_read_b32 v216,a60
 v_accvgpr_read_b32 v217,a61
 v_accvgpr_read_b32 v218,a62
 v_accvgpr_read_b32 v219,a63
 v_mul_f32 v216,v216,v215
 v_mul_f32 v217,v217,v215
 v_mul_f32 v218,v218,v215
 v_mul_f32 v219,v219,v215
 v_accvgpr_write_b32 a60,v216
 v_accvgpr_write_b32 a61,v217
 v_accvgpr_write_b32 a62,v218
 v_accvgpr_write_b32 a63,v219
 v_accvgpr_read_b32 v216,a64
 v_accvgpr_read_b32 v217,a65
 v_accvgpr_read_b32 v218,a66
 v_accvgpr_read_b32 v219,a67
 v_mul_f32 v216,v216,v212
 v_mul_f32 v217,v217,v212
 v_mul_f32 v218,v218,v212
 v_mul_f32 v219,v219,v212
 v_accvgpr_write_b32 a64,v216
 v_accvgpr_write_b32 a65,v217
 v_accvgpr_write_b32 a66,v218
 v_accvgpr_write_b32 a67,v219
 v_accvgpr_read_b32 v216,a68
 v_accvgpr_read_b32 v217,a69
 v_accvgpr_read_b32 v218,a70
 v_accvgpr_read_b32 v219,a71
 v_mul_f32 v216,v216,v213
 v_mul_f32 v217,v217,v213
 v_mul_f32 v218,v218,v213
 v_mul_f32 v219,v219,v213
 v_accvgpr_write_b32 a68,v216
 v_accvgpr_write_b32 a69,v217
 v_accvgpr_write_b32 a70,v218
 v_accvgpr_write_b32 a71,v219
 v_accvgpr_read_b32 v216,a72
 v_accvgpr_read_b32 v217,a73
 v_accvgpr_read_b32 v218,a74
 v_accvgpr_read_b32 v219,a75
 v_mul_f32 v216,v216,v214
 v_mul_f32 v217,v217,v214
 v_mul_f32 v218,v218,v214
 v_mul_f32 v219,v219,v214
 v_accvgpr_write_b32 a72,v216
 v_accvgpr_write_b32 a73,v217
 v_accvgpr_write_b32 a74,v218
 v_accvgpr_write_b32 a75,v219
 v_accvgpr_read_b32 v216,a76
 v_accvgpr_read_b32 v217,a77
 v_accvgpr_read_b32 v218,a78
 v_accvgpr_read_b32 v219,a79
 v_mul_f32 v216,v216,v215
 v_mul_f32 v217,v217,v215
 v_mul_f32 v218,v218,v215
 v_mul_f32 v219,v219,v215
 v_accvgpr_write_b32 a76,v216
 v_accvgpr_write_b32 a77,v217
 v_accvgpr_write_b32 a78,v218
 v_accvgpr_write_b32 a79,v219
 v_accvgpr_read_b32 v216,a80
 v_accvgpr_read_b32 v217,a81
 v_accvgpr_read_b32 v218,a82
 v_accvgpr_read_b32 v219,a83
 v_mul_f32 v216,v216,v212
 v_mul_f32 v217,v217,v212
 v_mul_f32 v218,v218,v212
 v_mul_f32 v219,v219,v212
 v_accvgpr_write_b32 a80,v216
 v_accvgpr_write_b32 a81,v217
 v_accvgpr_write_b32 a82,v218
 v_accvgpr_write_b32 a83,v219
 v_accvgpr_read_b32 v216,a84
 v_accvgpr_read_b32 v217,a85
 v_accvgpr_read_b32 v218,a86
 v_accvgpr_read_b32 v219,a87
 v_mul_f32 v216,v216,v213
 v_mul_f32 v217,v217,v213
 v_mul_f32 v218,v218,v213
 v_mul_f32 v219,v219,v213
 v_accvgpr_write_b32 a84,v216
 v_accvgpr_write_b32 a85,v217
 v_accvgpr_write_b32 a86,v218
 v_accvgpr_write_b32 a87,v219
 v_accvgpr_read_b32 v216,a88
 v_accvgpr_read_b32 v217,a89
 v_accvgpr_read_b32 v218,a90
 v_accvgpr_read_b32 v219,a91
 v_mul_f32 v216,v216,v214
 v_mul_f32 v217,v217,v214
 v_mul_f32 v218,v218,v214
 v_mul_f32 v219,v219,v214
 v_accvgpr_write_b32 a88,v216
 v_accvgpr_write_b32 a89,v217
 v_accvgpr_write_b32 a90,v218
 v_accvgpr_write_b32 a91,v219
 v_accvgpr_read_b32 v216,a92
 v_accvgpr_read_b32 v217,a93
 v_accvgpr_read_b32 v218,a94
 v_accvgpr_read_b32 v219,a95
 v_mul_f32 v216,v216,v215
 v_mul_f32 v217,v217,v215
 v_mul_f32 v218,v218,v215
 v_mul_f32 v219,v219,v215
 v_accvgpr_write_b32 a92,v216
 v_accvgpr_write_b32 a93,v217
 v_accvgpr_write_b32 a94,v218
 v_accvgpr_write_b32 a95,v219
 v_accvgpr_read_b32 v216,a96
 v_accvgpr_read_b32 v217,a97
 v_accvgpr_read_b32 v218,a98
 v_accvgpr_read_b32 v219,a99
 v_mul_f32 v216,v216,v212
 v_mul_f32 v217,v217,v212
 v_mul_f32 v218,v218,v212
 v_mul_f32 v219,v219,v212
 v_accvgpr_write_b32 a96,v216
 v_accvgpr_write_b32 a97,v217
 v_accvgpr_write_b32 a98,v218
 v_accvgpr_write_b32 a99,v219
 v_accvgpr_read_b32 v216,a100
 v_accvgpr_read_b32 v217,a101
 v_accvgpr_read_b32 v218,a102
 v_accvgpr_read_b32 v219,a103
 v_mul_f32 v216,v216,v213
 v_mul_f32 v217,v217,v213
 v_mul_f32 v218,v218,v213
 v_mul_f32 v219,v219,v213
 v_accvgpr_write_b32 a100,v216
 v_accvgpr_write_b32 a101,v217
 v_accvgpr_write_b32 a102,v218
 v_accvgpr_write_b32 a103,v219
 v_accvgpr_read_b32 v216,a104
 v_accvgpr_read_b32 v217,a105
 v_accvgpr_read_b32 v218,a106
 v_accvgpr_read_b32 v219,a107
 v_mul_f32 v216,v216,v214
 v_mul_f32 v217,v217,v214
 v_mul_f32 v218,v218,v214
 v_mul_f32 v219,v219,v214
 v_accvgpr_write_b32 a104,v216
 v_accvgpr_write_b32 a105,v217
 v_accvgpr_write_b32 a106,v218
 v_accvgpr_write_b32 a107,v219
 v_accvgpr_read_b32 v216,a108
 v_accvgpr_read_b32 v217,a109
 v_accvgpr_read_b32 v218,a110
 v_accvgpr_read_b32 v219,a111
 v_mul_f32 v216,v216,v215
 v_mul_f32 v217,v217,v215
 v_mul_f32 v218,v218,v215
 v_mul_f32 v219,v219,v215
 v_accvgpr_write_b32 a108,v216
 v_accvgpr_write_b32 a109,v217
 v_accvgpr_write_b32 a110,v218
 v_accvgpr_write_b32 a111,v219
 v_accvgpr_read_b32 v216,a112
 v_accvgpr_read_b32 v217,a113
 v_accvgpr_read_b32 v218,a114
 v_accvgpr_read_b32 v219,a115
 v_mul_f32 v216,v216,v212
 v_mul_f32 v217,v217,v212
 v_mul_f32 v218,v218,v212
 v_mul_f32 v219,v219,v212
 v_accvgpr_write_b32 a112,v216
 v_accvgpr_write_b32 a113,v217
 v_accvgpr_write_b32 a114,v218
 v_accvgpr_write_b32 a115,v219
 v_accvgpr_read_b32 v216,a116
 v_accvgpr_read_b32 v217,a117
 v_accvgpr_read_b32 v218,a118
 v_accvgpr_read_b32 v219,a119
 v_mul_f32 v216,v216,v213
 v_mul_f32 v217,v217,v213
 v_mul_f32 v218,v218,v213
 v_mul_f32 v219,v219,v213
 v_accvgpr_write_b32 a116,v216
 v_accvgpr_write_b32 a117,v217
 v_accvgpr_write_b32 a118,v218
 v_accvgpr_write_b32 a119,v219
 v_accvgpr_read_b32 v216,a120
 v_accvgpr_read_b32 v217,a121
 v_accvgpr_read_b32 v218,a122
 v_accvgpr_read_b32 v219,a123
 v_mul_f32 v216,v216,v214
 v_mul_f32 v217,v217,v214
 v_mul_f32 v218,v218,v214
 v_mul_f32 v219,v219,v214
 v_accvgpr_write_b32 a120,v216
 v_accvgpr_write_b32 a121,v217
 v_accvgpr_write_b32 a122,v218
 v_accvgpr_write_b32 a123,v219
 v_accvgpr_read_b32 v216,a124
 v_accvgpr_read_b32 v217,a125
 v_accvgpr_read_b32 v218,a126
 v_accvgpr_read_b32 v219,a127
 v_mul_f32 v216,v216,v215
 v_mul_f32 v217,v217,v215
 v_mul_f32 v218,v218,v215
 v_mul_f32 v219,v219,v215
 v_accvgpr_write_b32 a124,v216
 v_accvgpr_write_b32 a125,v217
 v_accvgpr_write_b32 a126,v218
 v_accvgpr_write_b32 a127,v219
 v_accvgpr_read_b32 v216,a128
 v_accvgpr_read_b32 v217,a129
 v_accvgpr_read_b32 v218,a130
 v_accvgpr_read_b32 v219,a131
 v_mul_f32 v216,v216,v212
 v_mul_f32 v217,v217,v212
 v_mul_f32 v218,v218,v212
 v_mul_f32 v219,v219,v212
 v_accvgpr_write_b32 a128,v216
 v_accvgpr_write_b32 a129,v217
 v_accvgpr_write_b32 a130,v218
 v_accvgpr_write_b32 a131,v219
 v_accvgpr_read_b32 v216,a132
 v_accvgpr_read_b32 v217,a133
 v_accvgpr_read_b32 v218,a134
 v_accvgpr_read_b32 v219,a135
 v_mul_f32 v216,v216,v213
 v_mul_f32 v217,v217,v213
 v_mul_f32 v218,v218,v213
 v_mul_f32 v219,v219,v213
 v_accvgpr_write_b32 a132,v216
 v_accvgpr_write_b32 a133,v217
 v_accvgpr_write_b32 a134,v218
 v_accvgpr_write_b32 a135,v219
 v_accvgpr_read_b32 v216,a136
 v_accvgpr_read_b32 v217,a137
 v_accvgpr_read_b32 v218,a138
 v_accvgpr_read_b32 v219,a139
 v_mul_f32 v216,v216,v214
 v_mul_f32 v217,v217,v214
 v_mul_f32 v218,v218,v214
 v_mul_f32 v219,v219,v214
 v_accvgpr_write_b32 a136,v216
 v_accvgpr_write_b32 a137,v217
 v_accvgpr_write_b32 a138,v218
 v_accvgpr_write_b32 a139,v219
 v_accvgpr_read_b32 v216,a140
 v_accvgpr_read_b32 v217,a141
 v_accvgpr_read_b32 v218,a142
 v_accvgpr_read_b32 v219,a143
 v_mul_f32 v216,v216,v215
 v_mul_f32 v217,v217,v215
 v_mul_f32 v218,v218,v215
 v_mul_f32 v219,v219,v215
 v_accvgpr_write_b32 a140,v216
 v_accvgpr_write_b32 a141,v217
 v_accvgpr_write_b32 a142,v218
 v_accvgpr_write_b32 a143,v219
 v_accvgpr_read_b32 v216,a144
 v_accvgpr_read_b32 v217,a145
 v_accvgpr_read_b32 v218,a146
 v_accvgpr_read_b32 v219,a147
 v_mul_f32 v216,v216,v212
 v_mul_f32 v217,v217,v212
 v_mul_f32 v218,v218,v212
 v_mul_f32 v219,v219,v212
 v_accvgpr_write_b32 a144,v216
 v_accvgpr_write_b32 a145,v217
 v_accvgpr_write_b32 a146,v218
 v_accvgpr_write_b32 a147,v219
 v_accvgpr_read_b32 v216,a148
 v_accvgpr_read_b32 v217,a149
 v_accvgpr_read_b32 v218,a150
 v_accvgpr_read_b32 v219,a151
 v_mul_f32 v216,v216,v213
 v_mul_f32 v217,v217,v213
 v_mul_f32 v218,v218,v213
 v_mul_f32 v219,v219,v213
 v_accvgpr_write_b32 a148,v216
 v_accvgpr_write_b32 a149,v217
 v_accvgpr_write_b32 a150,v218
 v_accvgpr_write_b32 a151,v219
 v_accvgpr_read_b32 v216,a152
 v_accvgpr_read_b32 v217,a153
 v_accvgpr_read_b32 v218,a154
 v_accvgpr_read_b32 v219,a155
 v_mul_f32 v216,v216,v214
 v_mul_f32 v217,v217,v214
 v_mul_f32 v218,v218,v214
 v_mul_f32 v219,v219,v214
 v_accvgpr_write_b32 a152,v216
 v_accvgpr_write_b32 a153,v217
 v_accvgpr_write_b32 a154,v218
 v_accvgpr_write_b32 a155,v219
 v_accvgpr_read_b32 v216,a156
 v_accvgpr_read_b32 v217,a157
 v_accvgpr_read_b32 v218,a158
 v_accvgpr_read_b32 v219,a159
 v_mul_f32 v216,v216,v215
 v_mul_f32 v217,v217,v215
 v_mul_f32 v218,v218,v215
 v_mul_f32 v219,v219,v215
 v_accvgpr_write_b32 a156,v216
 v_accvgpr_write_b32 a157,v217
 v_accvgpr_write_b32 a158,v218
 v_accvgpr_write_b32 a159,v219
 v_accvgpr_read_b32 v216,a160
 v_accvgpr_read_b32 v217,a161
 v_accvgpr_read_b32 v218,a162
 v_accvgpr_read_b32 v219,a163
 v_mul_f32 v216,v216,v212
 v_mul_f32 v217,v217,v212
 v_mul_f32 v218,v218,v212
 v_mul_f32 v219,v219,v212
 v_accvgpr_write_b32 a160,v216
 v_accvgpr_write_b32 a161,v217
 v_accvgpr_write_b32 a162,v218
 v_accvgpr_write_b32 a163,v219
 v_accvgpr_read_b32 v216,a164
 v_accvgpr_read_b32 v217,a165
 v_accvgpr_read_b32 v218,a166
 v_accvgpr_read_b32 v219,a167
 v_mul_f32 v216,v216,v213
 v_mul_f32 v217,v217,v213
 v_mul_f32 v218,v218,v213
 v_mul_f32 v219,v219,v213
 v_accvgpr_write_b32 a164,v216
 v_accvgpr_write_b32 a165,v217
 v_accvgpr_write_b32 a166,v218
 v_accvgpr_write_b32 a167,v219
 v_accvgpr_read_b32 v216,a168
 v_accvgpr_read_b32 v217,a169
 v_accvgpr_read_b32 v218,a170
 v_accvgpr_read_b32 v219,a171
 v_mul_f32 v216,v216,v214
 v_mul_f32 v217,v217,v214
 v_mul_f32 v218,v218,v214
 v_mul_f32 v219,v219,v214
 v_accvgpr_write_b32 a168,v216
 v_accvgpr_write_b32 a169,v217
 v_accvgpr_write_b32 a170,v218
 v_accvgpr_write_b32 a171,v219
 v_accvgpr_read_b32 v216,a172
 v_accvgpr_read_b32 v217,a173
 v_accvgpr_read_b32 v218,a174
 v_accvgpr_read_b32 v219,a175
 v_mul_f32 v216,v216,v215
 v_mul_f32 v217,v217,v215
 v_mul_f32 v218,v218,v215
 v_mul_f32 v219,v219,v215
 v_accvgpr_write_b32 a172,v216
 v_accvgpr_write_b32 a173,v217
 v_accvgpr_write_b32 a174,v218
 v_accvgpr_write_b32 a175,v219
 v_accvgpr_read_b32 v216,a176
 v_accvgpr_read_b32 v217,a177
 v_accvgpr_read_b32 v218,a178
 v_accvgpr_read_b32 v219,a179
 v_mul_f32 v216,v216,v212
 v_mul_f32 v217,v217,v212
 v_mul_f32 v218,v218,v212
 v_mul_f32 v219,v219,v212
 v_accvgpr_write_b32 a176,v216
 v_accvgpr_write_b32 a177,v217
 v_accvgpr_write_b32 a178,v218
 v_accvgpr_write_b32 a179,v219
 v_accvgpr_read_b32 v216,a180
 v_accvgpr_read_b32 v217,a181
 v_accvgpr_read_b32 v218,a182
 v_accvgpr_read_b32 v219,a183
 v_mul_f32 v216,v216,v213
 v_mul_f32 v217,v217,v213
 v_mul_f32 v218,v218,v213
 v_mul_f32 v219,v219,v213
 v_accvgpr_write_b32 a180,v216
 v_accvgpr_write_b32 a181,v217
 v_accvgpr_write_b32 a182,v218
 v_accvgpr_write_b32 a183,v219
 v_accvgpr_read_b32 v216,a184
 v_accvgpr_read_b32 v217,a185
 v_accvgpr_read_b32 v218,a186
 v_accvgpr_read_b32 v219,a187
 v_mul_f32 v216,v216,v214
 v_mul_f32 v217,v217,v214
 v_mul_f32 v218,v218,v214
 v_mul_f32 v219,v219,v214
 v_accvgpr_write_b32 a184,v216
 v_accvgpr_write_b32 a185,v217
 v_accvgpr_write_b32 a186,v218
 v_accvgpr_write_b32 a187,v219
 v_accvgpr_read_b32 v216,a188
 v_accvgpr_read_b32 v217,a189
 v_accvgpr_read_b32 v218,a190
 v_accvgpr_read_b32 v219,a191
 v_mul_f32 v216,v216,v215
 v_mul_f32 v217,v217,v215
 v_mul_f32 v218,v218,v215
 v_mul_f32 v219,v219,v215
 v_accvgpr_write_b32 a188,v216
 v_accvgpr_write_b32 a189,v217
 v_accvgpr_write_b32 a190,v218
 v_accvgpr_write_b32 a191,v219
 s_add_u32 m0,s79,0
 s_add_u32 s41,s43,0
 buffer_load_dwordx4 v225,s[24:27],s41 offen lds
 s_add_u32 m0,s79,1024
 s_add_u32 s41,s43,3072
 buffer_load_dwordx4 v225,s[24:27],s41 offen lds
 s_add_u32 m0,s79,2048
 s_add_u32 s41,s43,6144
 buffer_load_dwordx4 v225,s[24:27],s41 offen lds
 s_add_u32 m0,s79,3072
 s_add_u32 s41,s43,9216
 buffer_load_dwordx4 v225,s[24:27],s41 offen lds
 s_waitcnt vmcnt(0)
 ds_read_b64_tr_b16 v[192:193],v226
 ds_read_b64_tr_b16 v[194:195],v226 offset:2048
 ds_read_b64_tr_b16 v[196:197],v227
 ds_read_b64_tr_b16 v[198:199],v227 offset:2048
 ds_read_b64_tr_b16 v[200:201],v228
 ds_read_b64_tr_b16 v[202:203],v228 offset:2048
 ds_read_b64_tr_b16 v[204:205],v229
 ds_read_b64_tr_b16 v[206:207],v229 offset:2048
 s_waitcnt lgkmcnt(0)
 v_mfma_f32_16x16x32_bf16 a[0:3],v[192:195],v[176:179],a[0:3]
 v_mfma_f32_16x16x32_bf16 a[4:7],v[192:195],v[180:183],a[4:7]
 v_mfma_f32_16x16x32_bf16 a[8:11],v[192:195],v[184:187],a[8:11]
 v_mfma_f32_16x16x32_bf16 a[12:15],v[192:195],v[188:191],a[12:15]
 v_mfma_f32_16x16x32_bf16 a[16:19],v[196:199],v[176:179],a[16:19]
 v_mfma_f32_16x16x32_bf16 a[20:23],v[196:199],v[180:183],a[20:23]
 v_mfma_f32_16x16x32_bf16 a[24:27],v[196:199],v[184:187],a[24:27]
 v_mfma_f32_16x16x32_bf16 a[28:31],v[196:199],v[188:191],a[28:31]
 v_mfma_f32_16x16x32_bf16 a[32:35],v[200:203],v[176:179],a[32:35]
 v_mfma_f32_16x16x32_bf16 a[36:39],v[200:203],v[180:183],a[36:39]
 v_mfma_f32_16x16x32_bf16 a[40:43],v[200:203],v[184:187],a[40:43]
 v_mfma_f32_16x16x32_bf16 a[44:47],v[200:203],v[188:191],a[44:47]
 v_mfma_f32_16x16x32_bf16 a[48:51],v[204:207],v[176:179],a[48:51]
 v_mfma_f32_16x16x32_bf16 a[52:55],v[204:207],v[180:183],a[52:55]
 v_mfma_f32_16x16x32_bf16 a[56:59],v[204:207],v[184:187],a[56:59]
 v_mfma_f32_16x16x32_bf16 a[60:63],v[204:207],v[188:191],a[60:63]
 s_add_u32 m0,s79,0
 s_add_u32 s41,s43,128
 buffer_load_dwordx4 v225,s[24:27],s41 offen lds
 s_add_u32 m0,s79,1024
 s_add_u32 s41,s43,3200
 buffer_load_dwordx4 v225,s[24:27],s41 offen lds
 s_add_u32 m0,s79,2048
 s_add_u32 s41,s43,6272
 buffer_load_dwordx4 v225,s[24:27],s41 offen lds
 s_add_u32 m0,s79,3072
 s_add_u32 s41,s43,9344
 buffer_load_dwordx4 v225,s[24:27],s41 offen lds
 s_waitcnt vmcnt(0)
 ds_read_b64_tr_b16 v[192:193],v226
 ds_read_b64_tr_b16 v[194:195],v226 offset:2048
 ds_read_b64_tr_b16 v[196:197],v227
 ds_read_b64_tr_b16 v[198:199],v227 offset:2048
 ds_read_b64_tr_b16 v[200:201],v228
 ds_read_b64_tr_b16 v[202:203],v228 offset:2048
 ds_read_b64_tr_b16 v[204:205],v229
 ds_read_b64_tr_b16 v[206:207],v229 offset:2048
 s_waitcnt lgkmcnt(0)
 v_mfma_f32_16x16x32_bf16 a[64:67],v[192:195],v[176:179],a[64:67]
 v_mfma_f32_16x16x32_bf16 a[68:71],v[192:195],v[180:183],a[68:71]
 v_mfma_f32_16x16x32_bf16 a[72:75],v[192:195],v[184:187],a[72:75]
 v_mfma_f32_16x16x32_bf16 a[76:79],v[192:195],v[188:191],a[76:79]
 v_mfma_f32_16x16x32_bf16 a[80:83],v[196:199],v[176:179],a[80:83]
 v_mfma_f32_16x16x32_bf16 a[84:87],v[196:199],v[180:183],a[84:87]
 v_mfma_f32_16x16x32_bf16 a[88:91],v[196:199],v[184:187],a[88:91]
 v_mfma_f32_16x16x32_bf16 a[92:95],v[196:199],v[188:191],a[92:95]
 v_mfma_f32_16x16x32_bf16 a[96:99],v[200:203],v[176:179],a[96:99]
 v_mfma_f32_16x16x32_bf16 a[100:103],v[200:203],v[180:183],a[100:103]
 v_mfma_f32_16x16x32_bf16 a[104:107],v[200:203],v[184:187],a[104:107]
 v_mfma_f32_16x16x32_bf16 a[108:111],v[200:203],v[188:191],a[108:111]
 v_mfma_f32_16x16x32_bf16 a[112:115],v[204:207],v[176:179],a[112:115]
 v_mfma_f32_16x16x32_bf16 a[116:119],v[204:207],v[180:183],a[116:119]
 v_mfma_f32_16x16x32_bf16 a[120:123],v[204:207],v[184:187],a[120:123]
 v_mfma_f32_16x16x32_bf16 a[124:127],v[204:207],v[188:191],a[124:127]
 s_add_u32 m0,s79,0
 s_add_u32 s41,s43,256
 buffer_load_dwordx4 v225,s[24:27],s41 offen lds
 s_add_u32 m0,s79,1024
 s_add_u32 s41,s43,3328
 buffer_load_dwordx4 v225,s[24:27],s41 offen lds
 s_add_u32 m0,s79,2048
 s_add_u32 s41,s43,6400
 buffer_load_dwordx4 v225,s[24:27],s41 offen lds
 s_add_u32 m0,s79,3072
 s_add_u32 s41,s43,9472
 buffer_load_dwordx4 v225,s[24:27],s41 offen lds
 s_waitcnt vmcnt(0)
 ds_read_b64_tr_b16 v[192:193],v226
 ds_read_b64_tr_b16 v[194:195],v226 offset:2048
 ds_read_b64_tr_b16 v[196:197],v227
 ds_read_b64_tr_b16 v[198:199],v227 offset:2048
 ds_read_b64_tr_b16 v[200:201],v228
 ds_read_b64_tr_b16 v[202:203],v228 offset:2048
 ds_read_b64_tr_b16 v[204:205],v229
 ds_read_b64_tr_b16 v[206:207],v229 offset:2048
 s_waitcnt lgkmcnt(0)
 v_mfma_f32_16x16x32_bf16 a[128:131],v[192:195],v[176:179],a[128:131]
 v_mfma_f32_16x16x32_bf16 a[132:135],v[192:195],v[180:183],a[132:135]
 v_mfma_f32_16x16x32_bf16 a[136:139],v[192:195],v[184:187],a[136:139]
 v_mfma_f32_16x16x32_bf16 a[140:143],v[192:195],v[188:191],a[140:143]
 v_mfma_f32_16x16x32_bf16 a[144:147],v[196:199],v[176:179],a[144:147]
 v_mfma_f32_16x16x32_bf16 a[148:151],v[196:199],v[180:183],a[148:151]
 v_mfma_f32_16x16x32_bf16 a[152:155],v[196:199],v[184:187],a[152:155]
 v_mfma_f32_16x16x32_bf16 a[156:159],v[196:199],v[188:191],a[156:159]
 v_mfma_f32_16x16x32_bf16 a[160:163],v[200:203],v[176:179],a[160:163]
 v_mfma_f32_16x16x32_bf16 a[164:167],v[200:203],v[180:183],a[164:167]
 v_mfma_f32_16x16x32_bf16 a[168:171],v[200:203],v[184:187],a[168:171]
 v_mfma_f32_16x16x32_bf16 a[172:175],v[200:203],v[188:191],a[172:175]
 v_mfma_f32_16x16x32_bf16 a[176:179],v[204:207],v[176:179],a[176:179]
 v_mfma_f32_16x16x32_bf16 a[180:183],v[204:207],v[180:183],a[180:183]
 v_mfma_f32_16x16x32_bf16 a[184:187],v[204:207],v[184:187],a[184:187]
 v_mfma_f32_16x16x32_bf16 a[188:191],v[204:207],v[188:191],a[188:191]
 s_add_u32 s43,s43,12288
 s_cmp_lt_u32 s43,786432
 s_nop 15
 s_cbranch_scc1 recurrent_scan__mha_block_cached__mixer_s_mlp__prompt_kernel_xl
 v_mov_b32 v216,v10
 v_mov_b32 v217,v11
 v_mov_b32 v218,v12
 v_mov_b32 v219,v13
 v_permlane32_swap_b32 v10,v216
 v_permlane32_swap_b32 v11,v217
 v_permlane32_swap_b32 v12,v218
 v_permlane32_swap_b32 v13,v219
 v_add_f32 v10,v10,v216
 v_add_f32 v11,v11,v217
 v_add_f32 v12,v12,v218
 v_add_f32 v13,v13,v219
 v_mov_b32 v216,v10
 v_mov_b32 v217,v11
 v_mov_b32 v218,v12
 v_mov_b32 v219,v13
 v_permlane16_swap_b32 v10,v216
 v_permlane16_swap_b32 v11,v217
 v_permlane16_swap_b32 v12,v218
 v_permlane16_swap_b32 v13,v219
 v_add_f32 v10,v10,v216
 v_add_f32 v11,v11,v217
 v_add_f32 v12,v12,v218
 v_add_f32 v13,v13,v219
 v_mov_b32 v160,0
 v_mov_b32 v161,0
 v_mov_b32 v162,0
 v_mov_b32 v163,0
 v_mov_b32 v164,0
 v_mov_b32 v165,0
 v_mov_b32 v166,0
 v_mov_b32 v167,0
 v_mov_b32 v168,0
 v_mov_b32 v169,0
 v_mov_b32 v170,0
 v_mov_b32 v171,0
 v_mov_b32 v172,0
 v_mov_b32 v173,0
 v_mov_b32 v174,0
 v_mov_b32 v175,0
 v_mov_b32 v176,0
 v_mov_b32 v177,0
 v_mov_b32 v178,0
 v_mov_b32 v179,0
 v_mov_b32 v180,0
 v_mov_b32 v181,0
 v_mov_b32 v182,0
 v_mov_b32 v183,0
 v_mov_b32 v184,0
 v_mov_b32 v185,0
 v_mov_b32 v186,0
 v_mov_b32 v187,0
 v_mov_b32 v188,0
 v_mov_b32 v189,0
 v_mov_b32 v190,0
 v_mov_b32 v191,0
 s_mov_b32 m0,s78
 s_nop 3
 s_branch recurrent_scan__mha_block_cached__mixer_s_mlp__prompt_kernel_back
.section .rodata,"a"
.p2align 6
.amdhsa_kernel recurrent_scan__mha_block_cached__mixer_s_mlp__prompt_kernel
  .amdhsa_next_free_vgpr 512
  .amdhsa_next_free_sgpr 102
  .amdhsa_accum_offset 256
  .amdhsa_group_segment_fixed_size 0
  .amdhsa_kernarg_size 104
  .amdhsa_user_sgpr_count 2
  .amdhsa_user_sgpr_kernarg_segment_ptr 1
  .amdhsa_system_sgpr_workgroup_id_x 1
.end_amdhsa_kernel
```
